```python
import torch

def _softmax(x, axis=-1):
    return torch.softmax(x, dim=axis)

def _gelu(x):
    return torch.nn.functional.gelu(x, approximate='tanh')

def _silu(x):
    return torch.nn.functional.silu(x)

def _sigmoid(x):
    return torch.sigmoid(x)

def _layernorm(x, axis=-1, eps=1e-05):
    m = x.mean(dim=axis, keepdim=True)
    v = x.var(dim=axis, keepdim=True, unbiased=False)
    return (x - m) / torch.sqrt(v + eps)

def _scatter_add(tgt, idx, src, axis=0):
    return tgt.clone().index_add_(axis, idx, src)

def _segment_sum(src, seg, n):
    out = torch.zeros((n,) + src.shape[1:], dtype=src.dtype)
    return out.index_add_(0, seg, src)

def _pad(x, pw):
    flat = tuple((v for pair in reversed(pw) for v in pair))
    return torch.nn.functional.pad(x, flat)
kernel_name = 'interleave_layers__ssm_conv_s4d__memory_aug_recurrent_mem_tr__prompt'

def setup_inputs():

    _w = lambda a: (lambda t: t.to(torch.bfloat16) if t.is_floating_point() else t)(torch.as_tensor(a))

    def _A_setup():
        Bsz, L, D, N = (1, 2048, 512, 128)
        return {'u': _w((lambda *s: torch.randn(*s, dtype=torch.bfloat16) * 0.05)(Bsz, L, D)), 'log_A_real': _w((lambda *s: torch.randn(*s, dtype=torch.bfloat16) * 3.2)(D, N) * 0.5), 'A_imag': _w((lambda *s: torch.randn(*s, dtype=torch.bfloat16) * 0.05)(D, N) * 3.14), 'C_real': _w((lambda *s: torch.randn(*s, dtype=torch.bfloat16) * 0.05)(D, N) / N ** 0.5), 'C_imag': _w((lambda *s: torch.randn(*s, dtype=torch.bfloat16) * 0.05)(D, N) / N ** 0.5), 'log_dt': _w((lambda *s: torch.randn(*s, dtype=torch.bfloat16) * 0.05)(D) * 0.5 - 4.0), 'D_skip': _w((lambda *s: torch.randn(*s, dtype=torch.bfloat16) * 0.05)(D))}
    _A_in = _A_setup()

    def _B_setup():
        B, S, Dm = (1, 2048, 512)
        H, Dh = (32, 128)
        M, seg = (8, 32)
        seg = min(seg, S)
        S = S // seg * seg
        return {'x': _w((lambda *s: torch.randn(*s, dtype=torch.bfloat16) * 0.05)(B, S, Dm)), 'mem0': _w((lambda *s: torch.randn(*s, dtype=torch.bfloat16) * 0.8)(B, M, Dm)), 'Wq': _w((lambda *s: torch.randn(*s, dtype=torch.bfloat16) * 1.6)(Dm, H, Dh) * Dm ** (-0.5)), 'Wk': _w((lambda *s: torch.randn(*s, dtype=torch.bfloat16) * 1.6)(Dm, H, Dh) * Dm ** (-0.5)), 'Wv': _w((lambda *s: torch.randn(*s, dtype=torch.bfloat16) * 0.8)(Dm, H, Dh) * Dm ** (-0.5)), 'Wo': _w((lambda *s: torch.randn(*s, dtype=torch.bfloat16) * 0.8)(H, Dh, Dm) * (H * Dh) ** (-0.5)), 'seg_len': seg}
    _B_in = _B_setup()
    return {'A_u': _A_in['u'], 'A_log_A_real': _A_in['log_A_real'], 'A_A_imag': _A_in['A_imag'], 'A_C_real': _A_in['C_real'], 'A_C_imag': _A_in['C_imag'], 'A_log_dt': _A_in['log_dt'], 'A_D_skip': _A_in['D_skip'], 'B_x': _B_in['x'], 'B_mem0': _B_in['mem0'], 'B_Wq': _B_in['Wq'], 'B_Wk': _B_in['Wk'], 'B_Wv': _B_in['Wv'], 'B_Wo': _B_in['Wo'], 'B_seg_len': _B_in['seg_len']}

def reference(A_u, A_log_A_real, A_A_imag, A_C_real, A_C_imag, A_log_dt, A_D_skip, B_x, B_mem0, B_Wq, B_Wk, B_Wv, B_Wo, B_seg_len):

    def _A_ref(u, log_A_real, A_imag, C_real, C_imag, log_dt, D_skip):
        L = u.shape[1]
        dt = torch.exp(log_dt)
        A = -torch.exp(log_A_real) + 1j * A_imag
        C = (C_real + 1j * C_imag) * dt[:, None]
        pos = (lambda x, dt: x.to(dt))(torch.arange(L), log_dt.dtype)
        P = torch.exp((A * dt[:, None])[:, :, None] * pos[None, None, :])
        K = 2.0 * torch.einsum('dn,dnl->dl', C, P).real
        L2 = 2 * L
        u_t = (lambda x, *d: x.permute(*d))(u, 0, 2, 1)
        Kf = (lambda x, *a, **k: torch.fft.rfft(x.float(), *a, **k))(K, L2)
        Uf = (lambda x, *a, **k: torch.fft.rfft(x.float(), *a, **k))(u_t, L2)
        y = (lambda x, *a, **k: torch.fft.irfft(x, *a, **k).to(torch.bfloat16))(Uf * Kf[None, :, :], L2)[:, :, :L]
        y = (lambda x, *d: x.permute(*d))(y, 0, 2, 1)
        return y + u * D_skip[None, None, :]

    def _B_ref(x, mem0, Wq, Wk, Wv, Wo, seg_len):
        B, S, Dm = x.shape
        H, Dh = (Wq.shape[1], Wq.shape[2])
        M = mem0.shape[1]
        scale = Dh ** (-0.5)
        n_seg = S // seg_len
        L = M + seg_len
        idx = torch.arange(L)
        mask = (idx[:, None] < M) | (idx[:, None] >= idx[None, :])
        mem = mem0
        outs = []
        for s in range(n_seg):
            xs = x[:, s * seg_len:(s + 1) * seg_len, :].clone()
            h = torch.concatenate([mem, xs], axis=1)
            q = torch.einsum('btd,dhe->bhte', h, Wq)
            k = torch.einsum('btd,dhe->bhte', h, Wk)
            v = torch.einsum('btd,dhe->bhte', h, Wv)
            scores = torch.einsum('bhqe,bhke->bhqk', q, k) * scale
            scores = torch.where(mask[None, None], scores, -1000000000.0)
            p = _softmax(scores, axis=-1)
            o = torch.einsum('bhqk,bhke->bhqe', p, v)
            o = torch.einsum('bhte,hed->btd', o, Wo)
            mem = o[:, :M, :].clone()
            outs.append(o[:, M:, :])
        return torch.concatenate(outs, axis=1)
    x = A_u
    x = x + _A_ref(_layernorm(x, axis=-1), A_log_A_real, A_A_imag, A_C_real, A_C_imag, A_log_dt, A_D_skip)
    x = x + _B_ref(_layernorm(x, axis=-1), B_mem0, B_Wq, B_Wk, B_Wv, B_Wo, B_seg_len)
    x = x + _A_ref(_layernorm(x, axis=-1), A_log_A_real, A_A_imag, A_C_real, A_C_imag, A_log_dt, A_D_skip)
    x = x + _B_ref(_layernorm(x, axis=-1), B_mem0, B_Wq, B_Wk, B_Wv, B_Wo, B_seg_len)
    return x
```

```asm
; @launch grid=(256,1,1) block=(256,1,1) lds=163840
.amdgcn_target "amdgcn-amd-amdhsa--gfx950"
.text
.globl interleave_layers__ssm_conv_s4d__memory_aug_recurrent_mem_tr__prompt_kernel
.p2align 8
.type interleave_layers__ssm_conv_s4d__memory_aug_recurrent_mem_tr__prompt_kernel,@function
interleave_layers__ssm_conv_s4d__memory_aug_recurrent_mem_tr__prompt_kernel:
  s_cmp_ge_u32 s2, 256
  s_cbranch_scc1 L_end
  s_load_dwordx16 s[64:79], s[0:1], 0
  s_load_dwordx16 s[80:95], s[0:1], 64
  s_load_dwordx2 s[96:97], s[0:1], 128
  s_getreg_b32 s4, hwreg(HW_REG_XCC_ID,0,4)
  v_lshrrev_b32 v1, 6, v0
  v_and_b32 v0, 63, v0
  s_and_b32 s4, s4, 7
  v_readfirstlane_b32 s3, v1
  s_waitcnt lgkmcnt(0)
  s_mov_b32 s12, s94
  s_mov_b32 s13, s95
  s_mov_b32 s14, 0x100
  s_mov_b32 s15, 0x20000
  s_mov_b32 s8, s96
  s_mov_b32 s9, s97
  s_mov_b32 s10, 0x10000000
  s_mov_b32 s11, 0x20000
  s_mov_b32 s16, s64
  s_mov_b32 s17, s65
  s_mov_b32 s18, 0x200000
  s_mov_b32 s19, 0x20000
  s_cmp_lg_u32 s3, 0
  s_cbranch_scc1 L_tk_1
  s_lshl_b32 s6, s4, 2
  s_mov_b64 exec, 1
  v_mov_b32 v2, s6
  v_mov_b32 v3, 1
  buffer_atomic_add v3, v2, s[12:15], 0 offen sc0 sc1
  s_mov_b64 exec, -1
L_tk_1:
  s_lshl_b32 s6, s2, 3
  s_lshl_b32 s7, s3, 1
  s_add_u32 s32, s6, s7
  s_lshl_b32 s6, s32, 10
  v_lshlrev_b32 v4, 5, v0
  buffer_load_dwordx4 v[40:43], v4, s[16:19], s6 offen
  buffer_load_dwordx4 v[44:47], v4, s[16:19], s6 offen offset:16
  s_cmp_lg_u32 s3, 0
  s_cbranch_scc1 L_rl_2
  s_waitcnt vmcnt(2)
  v_readfirstlane_b32 s5, v3
  s_cmp_lt_u32 s5, 32
  s_cbranch_scc1 L_rok_3
  s_mov_b64 exec, 1
  v_mov_b32 v2, 32
  v_mov_b32 v3, 1
  buffer_atomic_add v3, v2, s[12:15], 0 offen sc0 sc1
  s_waitcnt vmcnt(0)
  v_readfirstlane_b32 s33, v3
  s_mov_b64 exec, -1
  s_mov_b32 s7, 0
  v_lshlrev_b32 v2, 2, v0
L_row_4:
  buffer_load_dword v3, v2, s[12:15], 0 offen sc1
  s_waitcnt vmcnt(0)
  s_mov_b32 s34, 0
  v_readlane_b32 s40, v3, 0
  v_readlane_b32 s41, v3, 1
  v_readlane_b32 s42, v3, 2
  v_readlane_b32 s43, v3, 3
  v_readlane_b32 s44, v3, 4
  v_readlane_b32 s45, v3, 5
  v_readlane_b32 s46, v3, 6
  v_readlane_b32 s47, v3, 7
  s_add_u32 s34, s34, s40
  s_add_u32 s34, s34, s41
  s_add_u32 s34, s34, s42
  s_add_u32 s34, s34, s43
  s_add_u32 s34, s34, s44
  s_add_u32 s34, s34, s45
  s_add_u32 s34, s34, s46
  s_add_u32 s34, s34, s47
  s_cmp_eq_u32 s34, 256
  s_cbranch_scc1 L_row2_5
  s_add_u32 s7, s7, 1
  s_cmp_lt_u32 s7, 131072
  s_cbranch_scc1 L_row_4
  s_mov_b32 s6, 1
  s_branch L_err
L_row2_5:
  s_min_u32 s5, s40, 32
  s_sub_u32 s35, 32, s5
  s_cmp_ge_u32 s33, s35
  s_cbranch_scc1 L_ovn_6
  s_add_u32 s5, s5, s33
  s_mov_b32 s4, 0
  s_branch L_rok_3
L_ovn_6:
  s_sub_u32 s33, s33, s35
  s_min_u32 s5, s41, 32
  s_sub_u32 s35, 32, s5
  s_cmp_ge_u32 s33, s35
  s_cbranch_scc1 L_ovn_7
  s_add_u32 s5, s5, s33
  s_mov_b32 s4, 1
  s_branch L_rok_3
L_ovn_7:
  s_sub_u32 s33, s33, s35
  s_min_u32 s5, s42, 32
  s_sub_u32 s35, 32, s5
  s_cmp_ge_u32 s33, s35
  s_cbranch_scc1 L_ovn_8
  s_add_u32 s5, s5, s33
  s_mov_b32 s4, 2
  s_branch L_rok_3
L_ovn_8:
  s_sub_u32 s33, s33, s35
  s_min_u32 s5, s43, 32
  s_sub_u32 s35, 32, s5
  s_cmp_ge_u32 s33, s35
  s_cbranch_scc1 L_ovn_9
  s_add_u32 s5, s5, s33
  s_mov_b32 s4, 3
  s_branch L_rok_3
L_ovn_9:
  s_sub_u32 s33, s33, s35
  s_min_u32 s5, s44, 32
  s_sub_u32 s35, 32, s5
  s_cmp_ge_u32 s33, s35
  s_cbranch_scc1 L_ovn_10
  s_add_u32 s5, s5, s33
  s_mov_b32 s4, 4
  s_branch L_rok_3
L_ovn_10:
  s_sub_u32 s33, s33, s35
  s_min_u32 s5, s45, 32
  s_sub_u32 s35, 32, s5
  s_cmp_ge_u32 s33, s35
  s_cbranch_scc1 L_ovn_11
  s_add_u32 s5, s5, s33
  s_mov_b32 s4, 5
  s_branch L_rok_3
L_ovn_11:
  s_sub_u32 s33, s33, s35
  s_min_u32 s5, s46, 32
  s_sub_u32 s35, 32, s5
  s_cmp_ge_u32 s33, s35
  s_cbranch_scc1 L_ovn_12
  s_add_u32 s5, s5, s33
  s_mov_b32 s4, 6
  s_branch L_rok_3
L_ovn_12:
  s_sub_u32 s33, s33, s35
  s_min_u32 s5, s47, 32
  s_sub_u32 s35, 32, s5
  s_cmp_ge_u32 s33, s35
  s_cbranch_scc1 L_ovn_13
  s_add_u32 s5, s5, s33
  s_mov_b32 s4, 7
  s_branch L_rok_3
L_ovn_13:
  s_sub_u32 s33, s33, s35
  s_mov_b32 s6, 2
  s_branch L_err
L_rok_3:
  s_lshl_b32 s6, s4, 5
  s_add_u32 s6, s6, s5
  v_mov_b32 v2, 0
  v_mov_b32 v3, s6
  ds_write_b32 v2, v3
L_rl_2:
  s_waitcnt vmcnt(0)
  v_mov_b32 v5, 0
  v_mov_b32 v6, 0
  v_mov_b32 v7, 0x3f803f80
  v_dot2c_f32_bf16 v5, v40, v7
  v_dot2c_f32_bf16 v6, v40, v40
  v_dot2c_f32_bf16 v5, v41, v7
  v_dot2c_f32_bf16 v6, v41, v41
  v_dot2c_f32_bf16 v5, v42, v7
  v_dot2c_f32_bf16 v6, v42, v42
  v_dot2c_f32_bf16 v5, v43, v7
  v_dot2c_f32_bf16 v6, v43, v43
  v_dot2c_f32_bf16 v5, v44, v7
  v_dot2c_f32_bf16 v6, v44, v44
  v_dot2c_f32_bf16 v5, v45, v7
  v_dot2c_f32_bf16 v6, v45, v45
  v_dot2c_f32_bf16 v5, v46, v7
  v_dot2c_f32_bf16 v6, v46, v46
  v_dot2c_f32_bf16 v5, v47, v7
  v_dot2c_f32_bf16 v6, v47, v47
  s_nop 1
  v_add_f32_dpp v5, v5, v5 quad_perm:[1,0,3,2] row_mask:0xf bank_mask:0xf
  v_add_f32_dpp v6, v6, v6 quad_perm:[1,0,3,2] row_mask:0xf bank_mask:0xf
  s_nop 0
  v_add_f32_dpp v5, v5, v5 quad_perm:[2,3,0,1] row_mask:0xf bank_mask:0xf
  v_add_f32_dpp v6, v6, v6 quad_perm:[2,3,0,1] row_mask:0xf bank_mask:0xf
  s_nop 0
  v_add_f32_dpp v5, v5, v5 row_half_mirror row_mask:0xf bank_mask:0xf
  v_add_f32_dpp v6, v6, v6 row_half_mirror row_mask:0xf bank_mask:0xf
  s_nop 0
  v_add_f32_dpp v5, v5, v5 row_mirror row_mask:0xf bank_mask:0xf
  v_add_f32_dpp v6, v6, v6 row_mirror row_mask:0xf bank_mask:0xf
  v_mov_b32 v8, v5
  v_mov_b32 v9, v6
  s_nop 0
  v_permlane16_swap_b32 v5, v8
  v_permlane16_swap_b32 v6, v9
  v_add_f32 v8, v5, v8
  v_add_f32 v9, v6, v9
  v_mul_f32 v8, 0x3b000000, v8
  v_mul_f32 v10, v8, v8
  v_mul_f32 v9, 0x3b000000, v9
  v_sub_f32 v9, v9, v10
  v_max_f32 v9, 0, v9
  v_cvt_pk_bf16_f32 v9, v9, v9
  v_and_b32 v9, 0xffff0000, v9
  v_add_f32 v9, 0x3727c5ac, v9
  v_cvt_pk_bf16_f32 v9, v9, v9
  v_and_b32 v9, 0xffff0000, v9
  v_sqrt_f32 v9, v9
  v_cvt_pk_bf16_f32 v8, v8, v8
  v_and_b32 v8, 0xffff0000, v8
  v_cvt_pk_bf16_f32 v9, v9, v9
  v_and_b32 v9, 0xffff0000, v9
  v_rcp_f32 v9, v9
  v_lshlrev_b32 v16, 16, v40
  v_and_b32 v17, 0xffff0000, v40
  v_lshlrev_b32 v18, 16, v41
  v_and_b32 v19, 0xffff0000, v41
  v_lshlrev_b32 v20, 16, v42
  v_and_b32 v21, 0xffff0000, v42
  v_lshlrev_b32 v22, 16, v43
  v_and_b32 v23, 0xffff0000, v43
  v_lshlrev_b32 v24, 16, v44
  v_and_b32 v25, 0xffff0000, v44
  v_lshlrev_b32 v26, 16, v45
  v_and_b32 v27, 0xffff0000, v45
  v_lshlrev_b32 v28, 16, v46
  v_and_b32 v29, 0xffff0000, v46
  v_lshlrev_b32 v30, 16, v47
  v_and_b32 v31, 0xffff0000, v47
  v_sub_f32 v16, v16, v8
  v_sub_f32 v17, v17, v8
  v_sub_f32 v18, v18, v8
  v_sub_f32 v19, v19, v8
  v_sub_f32 v20, v20, v8
  v_sub_f32 v21, v21, v8
  v_sub_f32 v22, v22, v8
  v_sub_f32 v23, v23, v8
  v_sub_f32 v24, v24, v8
  v_sub_f32 v25, v25, v8
  v_sub_f32 v26, v26, v8
  v_sub_f32 v27, v27, v8
  v_sub_f32 v28, v28, v8
  v_sub_f32 v29, v29, v8
  v_sub_f32 v30, v30, v8
  v_sub_f32 v31, v31, v8
  v_cvt_pk_bf16_f32 v32, v16, v17
  v_cvt_pk_bf16_f32 v33, v18, v19
  v_cvt_pk_bf16_f32 v34, v20, v21
  v_cvt_pk_bf16_f32 v35, v22, v23
  v_cvt_pk_bf16_f32 v36, v24, v25
  v_cvt_pk_bf16_f32 v37, v26, v27
  v_cvt_pk_bf16_f32 v38, v28, v29
  v_cvt_pk_bf16_f32 v39, v30, v31
  v_lshlrev_b32 v16, 16, v32
  v_and_b32 v17, 0xffff0000, v32
  v_lshlrev_b32 v18, 16, v33
  v_and_b32 v19, 0xffff0000, v33
  v_lshlrev_b32 v20, 16, v34
  v_and_b32 v21, 0xffff0000, v34
  v_lshlrev_b32 v22, 16, v35
  v_and_b32 v23, 0xffff0000, v35
  v_lshlrev_b32 v24, 16, v36
  v_and_b32 v25, 0xffff0000, v36
  v_lshlrev_b32 v26, 16, v37
  v_and_b32 v27, 0xffff0000, v37
  v_lshlrev_b32 v28, 16, v38
  v_and_b32 v29, 0xffff0000, v38
  v_lshlrev_b32 v30, 16, v39
  v_and_b32 v31, 0xffff0000, v39
  v_mul_f32 v16, v16, v9
  v_mul_f32 v17, v17, v9
  v_mul_f32 v18, v18, v9
  v_mul_f32 v19, v19, v9
  v_mul_f32 v20, v20, v9
  v_mul_f32 v21, v21, v9
  v_mul_f32 v22, v22, v9
  v_mul_f32 v23, v23, v9
  v_mul_f32 v24, v24, v9
  v_mul_f32 v25, v25, v9
  v_mul_f32 v26, v26, v9
  v_mul_f32 v27, v27, v9
  v_mul_f32 v28, v28, v9
  v_mul_f32 v29, v29, v9
  v_mul_f32 v30, v30, v9
  v_mul_f32 v31, v31, v9
  v_cvt_pk_bf16_f32 v32, v16, v17
  v_cvt_pk_bf16_f32 v33, v18, v19
  v_cvt_pk_bf16_f32 v34, v20, v21
  v_cvt_pk_bf16_f32 v35, v22, v23
  v_cvt_pk_bf16_f32 v36, v24, v25
  v_cvt_pk_bf16_f32 v37, v26, v27
  v_cvt_pk_bf16_f32 v38, v28, v29
  v_cvt_pk_bf16_f32 v39, v30, v31
  s_mov_b32 s6, 0x05040100
  s_mov_b32 s7, 0x07060302
  v_and_b32 v4, 31, v0
  v_mul_u32_u24 v4, 528, v4
  v_lshrrev_b32 v5, 5, v0
  v_lshl_add_u32 v4, v5, 8, v4
  s_lshl_b32 s34, s3, 2
  s_add_u32 s34, s34, 64
  v_add_u32 v4, s34, v4
  v_permlane32_swap_b32 v32, v36
  v_permlane32_swap_b32 v33, v37
  v_permlane32_swap_b32 v34, v38
  v_permlane32_swap_b32 v35, v39
  v_perm_b32 v16, v36, v32, s6
  ds_write_b32 v4, v16 offset:0
  v_perm_b32 v17, v36, v32, s7
  ds_write_b32 v4, v17 offset:16
  v_perm_b32 v18, v37, v33, s6
  ds_write_b32 v4, v18 offset:32
  v_perm_b32 v19, v37, v33, s7
  ds_write_b32 v4, v19 offset:48
  v_perm_b32 v20, v38, v34, s6
  ds_write_b32 v4, v20 offset:128
  v_perm_b32 v21, v38, v34, s7
  ds_write_b32 v4, v21 offset:144
  v_perm_b32 v22, v39, v35, s6
  ds_write_b32 v4, v22 offset:160
  v_perm_b32 v23, v39, v35, s7
  ds_write_b32 v4, v23 offset:176
  v_permlane32_swap_b32 v40, v44
  v_permlane32_swap_b32 v41, v45
  v_permlane32_swap_b32 v42, v46
  v_permlane32_swap_b32 v43, v47
  v_perm_b32 v24, v44, v40, s6
  ds_write_b32 v4, v24 offset:64
  v_perm_b32 v25, v44, v40, s7
  ds_write_b32 v4, v25 offset:80
  v_perm_b32 v26, v45, v41, s6
  ds_write_b32 v4, v26 offset:96
  v_perm_b32 v27, v45, v41, s7
  ds_write_b32 v4, v27 offset:112
  v_perm_b32 v28, v46, v42, s6
  ds_write_b32 v4, v28 offset:192
  v_perm_b32 v29, v46, v42, s7
  ds_write_b32 v4, v29 offset:208
  v_perm_b32 v30, v47, v43, s6
  ds_write_b32 v4, v30 offset:224
  v_perm_b32 v31, v47, v43, s7
  ds_write_b32 v4, v31 offset:240
  v_lshrrev_b32 v4, 5, v0
  s_lshl_b32 s6, s3, 1
  v_add_u32 v4, s6, v4
  v_mul_u32_u24 v4, 528, v4
  v_and_b32 v5, 31, v0
  v_lshl_add_u32 v4, v5, 4, v4
  v_lshrrev_b32 v5, 3, v0
  v_lshlrev_b32 v5, 15, v5
  v_and_b32 v6, 7, v0
  v_lshl_or_b32 v5, v6, 4, v5
  s_lshl_b32 s6, s3, 18
  s_lshl_b32 s7, s2, 7
  s_add_u32 s6, s6, s7
  s_add_u32 s6, s6, 0xb000000
  s_waitcnt lgkmcnt(0)
  s_barrier
  ds_read_b128 v[16:19], v4 offset:64
  ds_read_b128 v[20:23], v4 offset:4288
  ds_read_b128 v[24:27], v4 offset:8512
  ds_read_b128 v[28:31], v4 offset:12736
  s_waitcnt lgkmcnt(3)
  buffer_store_dwordx4 v[16:19], v5, s[8:11], s6 offen sc1
  s_add_u32 s6, s6, 1048576
  s_waitcnt lgkmcnt(2)
  buffer_store_dwordx4 v[20:23], v5, s[8:11], s6 offen sc1
  s_add_u32 s6, s6, 1048576
  s_waitcnt lgkmcnt(1)
  buffer_store_dwordx4 v[24:27], v5, s[8:11], s6 offen sc1
  s_add_u32 s6, s6, 1048576
  s_waitcnt lgkmcnt(0)
  buffer_store_dwordx4 v[28:31], v5, s[8:11], s6 offen sc1
  s_add_u32 s6, s6, 1048576
  v_mov_b32 v2, 0
  ds_read_b32 v3, v2
  s_waitcnt lgkmcnt(0)
  v_readfirstlane_b32 s6, v3
  s_barrier
  s_lshr_b32 s4, s6, 5
  s_and_b32 s4, s4, 7
  s_and_b32 s5, s6, 31
  s_cmp_eq_u32 s4, 0
  s_cbranch_scc1 L_rec
  s_cmp_eq_u32 s4, 1
  s_cbranch_scc1 L_rec
  s_cmp_eq_u32 s4, 2
  s_cbranch_scc1 L_p
  s_cmp_eq_u32 s4, 3
  s_cbranch_scc1 L_p
  s_cmp_eq_u32 s4, 4
  s_cbranch_scc1 L_p
  s_cmp_eq_u32 s4, 5
  s_cbranch_scc1 L_p
  s_cmp_eq_u32 s4, 6
  s_cbranch_scc1 L_o
  s_cmp_eq_u32 s4, 7
  s_cbranch_scc1 L_c
  s_waitcnt vmcnt(0)
  s_barrier
  s_cmp_lg_u32 s3, 0
  s_cbranch_scc1 L_sd_14
  s_mov_b64 exec, 1
  v_mov_b32 v2, 128
  v_mov_b32 v3, 1
  buffer_atomic_add v3, v2, s[12:15], 0 offen sc1
  s_mov_b64 exec, -1
L_sd_14:
  s_waitcnt vmcnt(0)
  s_endpgm
L_err:
  s_mov_b64 exec, 1
  s_lshl_b32 s7, s4, 2
  s_add_u32 s7, s7, 160
  v_mov_b32 v2, s7
  v_mov_b32 v3, s6
  buffer_store_dword v3, v2, s[12:15], 0 offen sc1
  s_waitcnt vmcnt(0)
L_end:
  s_endpgm
L_rec:
  s_and_b32 s58, s4, 1
  s_mul_i32 s35, s58, 0x2000000
  s_add_u32 s35, s35, 0x800000
  s_mul_i32 s36, s58, 0x1000000
  s_add_u32 s36, s36, 0x4800000
  s_mul_i32 s39, s58, 0x40000
  s_add_u32 s39, s39, 0x740000
  s_mul_i32 s44, s58, 0x2000
  s_add_u32 s44, s44, 0x708000
  s_lshl_b32 s6, s5, 14
  s_lshl_b32 s7, s3, 11
  s_add_u32 s35, s35, s6
  s_add_u32 s35, s35, s7
  s_mov_b32 s48, s7
  s_lshl_b32 s6, s5, 8
  s_add_u32 s43, s44, s6
  s_add_u32 s44, s44, s7
  s_lshl_b32 s7, s5, 13
  s_add_u32 s41, s39, s7
  s_add_u32 s42, s41, 4096
  s_add_u32 s39, s39, s6
  s_add_u32 s40, s39, 32768
  s_lshl_b32 s7, s5, 12
  s_add_u32 s36, s36, s7
  s_lshl_b32 s7, s3, 10
  s_add_u32 s36, s36, s7
  s_add_u32 s53, s48, 8192
  s_add_u32 s37, s48, 16384
  s_lshl_b32 s6, s58, 13
  s_lshl_b32 s7, s5, 7
  s_add_u32 s38, s6, s7
  s_add_u32 s38, s38, 0x714000
  s_mov_b32 s54, 0x00ff00ff
  s_mov_b32 s55, 0x00ff00ff
  s_mov_b32 s56, 0x33333333
  s_mov_b32 s57, 0x33333333
  s_mov_b32 s34, 0x3e0293ee
  s_add_u32 s6, s3, 1
  s_and_b32 s6, s6, 3
  s_lshl_b32 s45, s6, 11
  s_add_u32 s6, s3, 2
  s_and_b32 s6, s6, 3
  s_lshl_b32 s46, s6, 11
  s_add_u32 s6, s3, 3
  s_and_b32 s6, s6, 3
  s_lshl_b32 s47, s6, 11
  v_and_b32 v16, 15, v0
  v_lshrrev_b32 v17, 4, v0
  v_lshlrev_b32 v1, 4, v0
  s_lshl_b32 s6, s3, 8
  s_add_u32 s6, s6, 24576
  v_mul_u32_u24 v18, 1088, v17
  v_lshl_add_u32 v18, v16, 3, v18
  v_add_u32 v2, s6, v18
  v_and_b32 v18, 3, v0
  v_mul_u32_u24 v18, 1088, v18
  v_bfe_u32 v19, v0, 2, 3
  v_lshl_add_u32 v18, v19, 3, v18
  v_lshrrev_b32 v19, 5, v0
  v_lshl_add_u32 v18, v19, 7, v18
  v_add_u32 v3, 24576, v18
  v_and_b32 v18, 7, v0
  v_bfe_u32 v19, v0, 3, 1
  v_lshl_or_b32 v18, v19, 4, v18
  v_lshlrev_b32 v18, 4, v18
  v_lshl_add_u32 v18, v17, 9, v18
  v_add_u32 v4, 8192, v18
  v_lshrrev_b32 v18, 2, v16
  v_and_b32 v19, 1, v0
  v_lshl_or_b32 v18, v18, 1, v19
  v_mul_u32_u24 v18, 288, v18
  v_lshl_add_u32 v18, v17, 2, v18
  s_lshl_b32 s6, s3, 6
  s_add_u32 s6, s6, 28928
  v_add_u32 v5, s6, v18
  v_lshrrev_b32 v18, 1, v16
  v_mul_u32_u24 v18, 288, v18
  v_lshl_add_u32 v18, v17, 5, v18
  v_lshl_add_u32 v18, v19, 4, v18
  v_add_u32 v6, 28928, v18
  s_lshl_b32 s6, s3, 15
  s_add_u32 s6, s6, 32768
  v_add_u32 v7, s6, v1
  v_lshrrev_b32 v18, 2, v16
  v_lshlrev_b32 v18, 13, v18
  v_and_b32 v19, 3, v0
  v_lshl_or_b32 v19, v17, 2, v19
  v_lshl_or_b32 v18, v19, 4, v18
  s_lshl_b32 s6, s3, 16
  v_add_u32 v8, s6, v18
  v_lshlrev_b32 v18, 4, v16
  v_lshl_or_b32 v18, v17, 9, v18
  v_add_u32 v9, s37, v18
  v_mov_b32 v10, 0x3f803f80
  v_mov_b32 v11, 0x3f803f80
  v_mov_b32 v12, 0
  v_mov_b32 v13, 0
  v_mov_b32 v14, 0
  v_mov_b32 v15, 0
  buffer_store_dwordx4 v[12:15], v8, s[8:11], s39 offen sc1
  buffer_store_dwordx4 v[12:15], v8, s[8:11], s40 offen sc1
  s_add_u32 s6, s36, 0
  buffer_store_dwordx4 v[12:15], v1, s[8:11], s6 offen sc1
  s_add_u32 s6, s36, 131072
  buffer_store_dwordx4 v[12:15], v1, s[8:11], s6 offen sc1
  s_add_u32 s6, s36, 262144
  buffer_store_dwordx4 v[12:15], v1, s[8:11], s6 offen sc1
  s_add_u32 s6, s36, 393216
  buffer_store_dwordx4 v[12:15], v1, s[8:11], s6 offen sc1
  s_mov_b64 exec, 0xffff
  buffer_store_dwordx4 v[12:15], v1, s[8:11], s43 offen sc1
  s_mov_b64 exec, -1
  s_cmp_eq_u32 s4, 1
  s_cbranch_scc1 L_pro
  s_branch L_rec3
L_rec2:
  v_and_b32 v16, 15, v0
  v_lshrrev_b32 v17, 4, v0
  v_lshlrev_b32 v1, 4, v0
  s_lshl_b32 s6, s3, 8
  s_add_u32 s6, s6, 24576
  v_mul_u32_u24 v18, 1088, v17
  v_lshl_add_u32 v18, v16, 3, v18
  v_add_u32 v2, s6, v18
  v_and_b32 v18, 3, v0
  v_mul_u32_u24 v18, 1088, v18
  v_bfe_u32 v19, v0, 2, 3
  v_lshl_add_u32 v18, v19, 3, v18
  v_lshrrev_b32 v19, 5, v0
  v_lshl_add_u32 v18, v19, 7, v18
  v_add_u32 v3, 24576, v18
  v_and_b32 v18, 7, v0
  v_bfe_u32 v19, v0, 3, 1
  v_lshl_or_b32 v18, v19, 4, v18
  v_lshlrev_b32 v18, 4, v18
  v_lshl_add_u32 v18, v17, 9, v18
  v_add_u32 v4, 8192, v18
  v_lshrrev_b32 v18, 2, v16
  v_and_b32 v19, 1, v0
  v_lshl_or_b32 v18, v18, 1, v19
  v_mul_u32_u24 v18, 288, v18
  v_lshl_add_u32 v18, v17, 2, v18
  s_lshl_b32 s6, s3, 6
  s_add_u32 s6, s6, 28928
  v_add_u32 v5, s6, v18
  v_lshrrev_b32 v18, 1, v16
  v_mul_u32_u24 v18, 288, v18
  v_lshl_add_u32 v18, v17, 5, v18
  v_lshl_add_u32 v18, v19, 4, v18
  v_add_u32 v6, 28928, v18
  s_lshl_b32 s6, s3, 15
  s_add_u32 s6, s6, 32768
  v_add_u32 v7, s6, v1
  v_lshrrev_b32 v18, 2, v16
  v_lshlrev_b32 v18, 13, v18
  v_and_b32 v19, 3, v0
  v_lshl_or_b32 v19, v17, 2, v19
  v_lshl_or_b32 v18, v19, 4, v18
  s_lshl_b32 s6, s3, 16
  v_add_u32 v8, s6, v18
  v_lshlrev_b32 v18, 4, v16
  v_lshl_or_b32 v18, v17, 9, v18
  v_add_u32 v9, s37, v18
  v_mov_b32 v10, 0x3f803f80
  v_mov_b32 v11, 0x3f803f80
  v_mov_b32 v12, 0
  v_mov_b32 v13, 0
  v_mov_b32 v14, 0
  v_mov_b32 v15, 0
L_rec3:
  s_mov_b32 s16, s82
  s_mov_b32 s17, s83
  s_mov_b32 s18, 0x400000
  s_mov_b32 s19, 0x20000
  s_mov_b32 s20, s84
  s_mov_b32 s21, s85
  s_mov_b32 s22, 0x400000
  s_mov_b32 s23, 0x20000
  s_mov_b32 s24, s86
  s_mov_b32 s25, s87
  s_mov_b32 s26, 0x400000
  s_mov_b32 s27, 0x20000
  s_mov_b32 s28, s88
  s_mov_b32 s29, s89
  s_mov_b32 s30, 0x400000
  s_mov_b32 s31, 0x20000
  v_lshrrev_b32 v16, 2, v0
  v_and_b32 v17, 1, v16
  v_bfe_u32 v18, v16, 1, 1
  v_lshl_or_b32 v17, v18, 5, v17
  v_bfe_u32 v18, v16, 2, 2
  v_lshl_or_b32 v17, v18, 1, v17
  v_lshlrev_b32 v17, 13, v17
  v_and_b32 v18, 3, v0
  v_lshl_or_b32 v116, v18, 4, v17
  v_xor_b32 v117, 32, v116
  v_lshrrev_b32 v16, 4, v0
  v_and_b32 v17, 15, v0
  v_lshlrev_b32 v18, 1, v16
  v_xor_b32 v17, v17, v18
  v_lshlrev_b32 v17, 4, v17
  v_lshl_or_b32 v118, v16, 10, v17
  v_xor_b32 v119, 0x80, v118
  v_bfe_u32 v17, v0, 2, 2
  v_lshrrev_b32 v18, 5, v0
  v_lshl_or_b32 v17, v18, 3, v17
  v_bfe_u32 v18, v0, 4, 1
  v_lshl_or_b32 v17, v18, 5, v17
  v_lshlrev_b32 v17, 6, v17
  v_lshl_or_b32 v17, v18, 5, v17
  v_and_b32 v19, 3, v0
  v_lshl_or_b32 v17, v19, 3, v17
  s_lshl_b32 s60, s3, 15
  s_add_u32 s60, s60, 32768
  v_add_u32 v120, s60, v17
  v_xor_b32 v121, 32, v120
  v_bfe_u32 v17, v0, 2, 2
  v_lshl_or_b32 v18, v18, 2, v17
  v_lshl_or_b32 v17, v16, 3, v17
  v_lshlrev_b32 v17, 8, v17
  v_lshl_or_b32 v17, v18, 5, v17
  v_lshl_or_b32 v17, v19, 3, v17
  v_add_u32 v122, s60, v17
  s_add_u32 s61, s3, 0
  s_and_b32 s61, s61, 3
  s_lshl_b32 s61, s61, 20
  s_lshl_b32 s62, s5, 8
  s_add_u32 s61, s61, s62
  s_lshl_b32 s62, s3, 6
  s_add_u32 s61, s61, s62
  s_add_u32 m0, s60, 0
  s_add_u32 s62, s61, 0
  buffer_load_dwordx4 v116, s[16:19], s62 offen lds
  s_add_u32 m0, s60, 1024
  s_add_u32 s62, s61, 65536
  buffer_load_dwordx4 v116, s[16:19], s62 offen lds
  s_add_u32 m0, s60, 2048
  s_add_u32 s62, s61, 131072
  buffer_load_dwordx4 v117, s[16:19], s62 offen lds
  s_add_u32 m0, s60, 3072
  s_add_u32 s62, s61, 196608
  buffer_load_dwordx4 v117, s[16:19], s62 offen lds
  s_add_u32 m0, s60, 4096
  s_add_u32 s62, s61, 524288
  buffer_load_dwordx4 v116, s[16:19], s62 offen lds
  s_add_u32 m0, s60, 5120
  s_add_u32 s62, s61, 589824
  buffer_load_dwordx4 v116, s[16:19], s62 offen lds
  s_add_u32 m0, s60, 6144
  s_add_u32 s62, s61, 655360
  buffer_load_dwordx4 v117, s[16:19], s62 offen lds
  s_add_u32 m0, s60, 7168
  s_add_u32 s62, s61, 720896
  buffer_load_dwordx4 v117, s[16:19], s62 offen lds
  s_add_u32 s61, s3, 1
  s_and_b32 s61, s61, 3
  s_lshl_b32 s61, s61, 20
  s_lshl_b32 s62, s5, 8
  s_add_u32 s61, s61, s62
  s_lshl_b32 s62, s3, 6
  s_add_u32 s61, s61, s62
  s_add_u32 m0, s60, 8192
  s_add_u32 s62, s61, 0
  buffer_load_dwordx4 v116, s[16:19], s62 offen lds
  s_add_u32 m0, s60, 9216
  s_add_u32 s62, s61, 65536
  buffer_load_dwordx4 v116, s[16:19], s62 offen lds
  s_add_u32 m0, s60, 10240
  s_add_u32 s62, s61, 131072
  buffer_load_dwordx4 v117, s[16:19], s62 offen lds
  s_add_u32 m0, s60, 11264
  s_add_u32 s62, s61, 196608
  buffer_load_dwordx4 v117, s[16:19], s62 offen lds
  s_add_u32 m0, s60, 12288
  s_add_u32 s62, s61, 524288
  buffer_load_dwordx4 v116, s[16:19], s62 offen lds
  s_add_u32 m0, s60, 13312
  s_add_u32 s62, s61, 589824
  buffer_load_dwordx4 v116, s[16:19], s62 offen lds
  s_add_u32 m0, s60, 14336
  s_add_u32 s62, s61, 655360
  buffer_load_dwordx4 v117, s[16:19], s62 offen lds
  s_add_u32 m0, s60, 15360
  s_add_u32 s62, s61, 720896
  buffer_load_dwordx4 v117, s[16:19], s62 offen lds
  s_add_u32 s61, s3, 2
  s_and_b32 s61, s61, 3
  s_lshl_b32 s61, s61, 20
  s_lshl_b32 s62, s5, 8
  s_add_u32 s61, s61, s62
  s_lshl_b32 s62, s3, 6
  s_add_u32 s61, s61, s62
  s_add_u32 m0, s60, 16384
  s_add_u32 s62, s61, 0
  buffer_load_dwordx4 v116, s[16:19], s62 offen lds
  s_add_u32 m0, s60, 17408
  s_add_u32 s62, s61, 65536
  buffer_load_dwordx4 v116, s[16:19], s62 offen lds
  s_add_u32 m0, s60, 18432
  s_add_u32 s62, s61, 131072
  buffer_load_dwordx4 v117, s[16:19], s62 offen lds
  s_add_u32 m0, s60, 19456
  s_add_u32 s62, s61, 196608
  buffer_load_dwordx4 v117, s[16:19], s62 offen lds
  s_add_u32 m0, s60, 20480
  s_add_u32 s62, s61, 524288
  buffer_load_dwordx4 v116, s[16:19], s62 offen lds
  s_add_u32 m0, s60, 21504
  s_add_u32 s62, s61, 589824
  buffer_load_dwordx4 v116, s[16:19], s62 offen lds
  s_add_u32 m0, s60, 22528
  s_add_u32 s62, s61, 655360
  buffer_load_dwordx4 v117, s[16:19], s62 offen lds
  s_add_u32 m0, s60, 23552
  s_add_u32 s62, s61, 720896
  buffer_load_dwordx4 v117, s[16:19], s62 offen lds
  s_add_u32 s61, s3, 3
  s_and_b32 s61, s61, 3
  s_lshl_b32 s61, s61, 20
  s_lshl_b32 s62, s5, 8
  s_add_u32 s61, s61, s62
  s_lshl_b32 s62, s3, 6
  s_add_u32 s61, s61, s62
  s_add_u32 m0, s60, 24576
  s_add_u32 s62, s61, 0
  buffer_load_dwordx4 v116, s[16:19], s62 offen lds
  s_add_u32 m0, s60, 25600
  s_add_u32 s62, s61, 65536
  buffer_load_dwordx4 v116, s[16:19], s62 offen lds
  s_add_u32 m0, s60, 26624
  s_add_u32 s62, s61, 131072
  buffer_load_dwordx4 v117, s[16:19], s62 offen lds
  s_add_u32 m0, s60, 27648
  s_add_u32 s62, s61, 196608
  buffer_load_dwordx4 v117, s[16:19], s62 offen lds
  s_add_u32 m0, s60, 28672
  s_add_u32 s62, s61, 524288
  buffer_load_dwordx4 v116, s[16:19], s62 offen lds
  s_add_u32 m0, s60, 29696
  s_add_u32 s62, s61, 589824
  buffer_load_dwordx4 v116, s[16:19], s62 offen lds
  s_add_u32 m0, s60, 30720
  s_add_u32 s62, s61, 655360
  buffer_load_dwordx4 v117, s[16:19], s62 offen lds
  s_add_u32 m0, s60, 31744
  s_add_u32 s62, s61, 720896
  buffer_load_dwordx4 v117, s[16:19], s62 offen lds
  s_lshr_b32 s6, 0x72, s4
  s_bitcmp1_b32 s6, 0
  s_cbranch_scc1 L_rdn_15
  s_waitcnt vmcnt(32)
  s_barrier
  s_cmp_lg_u32 s3, 0
  s_cbranch_scc1 L_sd_16
  s_mov_b64 exec, 1
  v_mov_b32 v18, 128
  v_mov_b32 v19, 1
  buffer_atomic_add v19, v18, s[12:15], 0 offen sc1
  s_mov_b64 exec, -1
L_sd_16:
L_rdn_15:
  s_waitcnt vmcnt(24)
  ds_read_b64_tr_b16 a[0:1], v120 offset:0
  ds_read_b64_tr_b16 a[2:3], v120 offset:256
  ds_read_b64_tr_b16 a[4:5], v120 offset:1024
  ds_read_b64_tr_b16 a[6:7], v120 offset:1280
  ds_read_b64_tr_b16 a[8:9], v121 offset:0
  ds_read_b64_tr_b16 a[10:11], v121 offset:256
  ds_read_b64_tr_b16 a[12:13], v121 offset:1024
  ds_read_b64_tr_b16 a[14:15], v121 offset:1280
  ds_read_b64_tr_b16 a[16:17], v120 offset:4096
  ds_read_b64_tr_b16 a[18:19], v120 offset:4352
  ds_read_b64_tr_b16 a[20:21], v120 offset:5120
  ds_read_b64_tr_b16 a[22:23], v120 offset:5376
  ds_read_b64_tr_b16 a[24:25], v121 offset:4096
  ds_read_b64_tr_b16 a[26:27], v121 offset:4352
  ds_read_b64_tr_b16 a[28:29], v121 offset:5120
  ds_read_b64_tr_b16 a[30:31], v121 offset:5376
  s_waitcnt lgkmcnt(0)
  s_add_u32 s61, s3, 0
  s_and_b32 s61, s61, 3
  s_lshl_b32 s61, s61, 20
  s_lshl_b32 s62, s5, 8
  s_add_u32 s61, s61, s62
  s_lshl_b32 s62, s3, 6
  s_add_u32 s61, s61, s62
  s_add_u32 m0, s60, 0
  s_add_u32 s62, s61, 0
  buffer_load_dwordx4 v116, s[20:23], s62 offen lds
  s_add_u32 m0, s60, 1024
  s_add_u32 s62, s61, 65536
  buffer_load_dwordx4 v116, s[20:23], s62 offen lds
  s_add_u32 m0, s60, 2048
  s_add_u32 s62, s61, 131072
  buffer_load_dwordx4 v117, s[20:23], s62 offen lds
  s_add_u32 m0, s60, 3072
  s_add_u32 s62, s61, 196608
  buffer_load_dwordx4 v117, s[20:23], s62 offen lds
  s_add_u32 m0, s60, 4096
  s_add_u32 s62, s61, 524288
  buffer_load_dwordx4 v116, s[20:23], s62 offen lds
  s_add_u32 m0, s60, 5120
  s_add_u32 s62, s61, 589824
  buffer_load_dwordx4 v116, s[20:23], s62 offen lds
  s_add_u32 m0, s60, 6144
  s_add_u32 s62, s61, 655360
  buffer_load_dwordx4 v117, s[20:23], s62 offen lds
  s_add_u32 m0, s60, 7168
  s_add_u32 s62, s61, 720896
  buffer_load_dwordx4 v117, s[20:23], s62 offen lds
  s_waitcnt vmcnt(24)
  ds_read_b64_tr_b16 a[32:33], v120 offset:8192
  ds_read_b64_tr_b16 a[34:35], v120 offset:8448
  ds_read_b64_tr_b16 a[36:37], v120 offset:9216
  ds_read_b64_tr_b16 a[38:39], v120 offset:9472
  ds_read_b64_tr_b16 a[40:41], v121 offset:8192
  ds_read_b64_tr_b16 a[42:43], v121 offset:8448
  ds_read_b64_tr_b16 a[44:45], v121 offset:9216
  ds_read_b64_tr_b16 a[46:47], v121 offset:9472
  ds_read_b64_tr_b16 a[48:49], v120 offset:12288
  ds_read_b64_tr_b16 a[50:51], v120 offset:12544
  ds_read_b64_tr_b16 a[52:53], v120 offset:13312
  ds_read_b64_tr_b16 a[54:55], v120 offset:13568
  ds_read_b64_tr_b16 a[56:57], v121 offset:12288
  ds_read_b64_tr_b16 a[58:59], v121 offset:12544
  ds_read_b64_tr_b16 a[60:61], v121 offset:13312
  ds_read_b64_tr_b16 a[62:63], v121 offset:13568
  s_waitcnt lgkmcnt(0)
  s_add_u32 s61, s3, 1
  s_and_b32 s61, s61, 3
  s_lshl_b32 s61, s61, 20
  s_lshl_b32 s62, s5, 8
  s_add_u32 s61, s61, s62
  s_lshl_b32 s62, s3, 6
  s_add_u32 s61, s61, s62
  s_add_u32 m0, s60, 8192
  s_add_u32 s62, s61, 0
  buffer_load_dwordx4 v116, s[20:23], s62 offen lds
  s_add_u32 m0, s60, 9216
  s_add_u32 s62, s61, 65536
  buffer_load_dwordx4 v116, s[20:23], s62 offen lds
  s_add_u32 m0, s60, 10240
  s_add_u32 s62, s61, 131072
  buffer_load_dwordx4 v117, s[20:23], s62 offen lds
  s_add_u32 m0, s60, 11264
  s_add_u32 s62, s61, 196608
  buffer_load_dwordx4 v117, s[20:23], s62 offen lds
  s_add_u32 m0, s60, 12288
  s_add_u32 s62, s61, 524288
  buffer_load_dwordx4 v116, s[20:23], s62 offen lds
  s_add_u32 m0, s60, 13312
  s_add_u32 s62, s61, 589824
  buffer_load_dwordx4 v116, s[20:23], s62 offen lds
  s_add_u32 m0, s60, 14336
  s_add_u32 s62, s61, 655360
  buffer_load_dwordx4 v117, s[20:23], s62 offen lds
  s_add_u32 m0, s60, 15360
  s_add_u32 s62, s61, 720896
  buffer_load_dwordx4 v117, s[20:23], s62 offen lds
  s_waitcnt vmcnt(24)
  ds_read_b64_tr_b16 a[64:65], v120 offset:16384
  ds_read_b64_tr_b16 a[66:67], v120 offset:16640
  ds_read_b64_tr_b16 a[68:69], v120 offset:17408
  ds_read_b64_tr_b16 a[70:71], v120 offset:17664
  ds_read_b64_tr_b16 a[72:73], v121 offset:16384
  ds_read_b64_tr_b16 a[74:75], v121 offset:16640
  ds_read_b64_tr_b16 a[76:77], v121 offset:17408
  ds_read_b64_tr_b16 a[78:79], v121 offset:17664
  ds_read_b64_tr_b16 a[80:81], v120 offset:20480
  ds_read_b64_tr_b16 a[82:83], v120 offset:20736
  ds_read_b64_tr_b16 a[84:85], v120 offset:21504
  ds_read_b64_tr_b16 a[86:87], v120 offset:21760
  ds_read_b64_tr_b16 a[88:89], v121 offset:20480
  ds_read_b64_tr_b16 a[90:91], v121 offset:20736
  ds_read_b64_tr_b16 a[92:93], v121 offset:21504
  ds_read_b64_tr_b16 a[94:95], v121 offset:21760
  s_waitcnt lgkmcnt(0)
  s_add_u32 s61, s3, 2
  s_and_b32 s61, s61, 3
  s_lshl_b32 s61, s61, 20
  s_lshl_b32 s62, s5, 8
  s_add_u32 s61, s61, s62
  s_lshl_b32 s62, s3, 6
  s_add_u32 s61, s61, s62
  s_add_u32 m0, s60, 16384
  s_add_u32 s62, s61, 0
  buffer_load_dwordx4 v116, s[20:23], s62 offen lds
  s_add_u32 m0, s60, 17408
  s_add_u32 s62, s61, 65536
  buffer_load_dwordx4 v116, s[20:23], s62 offen lds
  s_add_u32 m0, s60, 18432
  s_add_u32 s62, s61, 131072
  buffer_load_dwordx4 v117, s[20:23], s62 offen lds
  s_add_u32 m0, s60, 19456
  s_add_u32 s62, s61, 196608
  buffer_load_dwordx4 v117, s[20:23], s62 offen lds
  s_add_u32 m0, s60, 20480
  s_add_u32 s62, s61, 524288
  buffer_load_dwordx4 v116, s[20:23], s62 offen lds
  s_add_u32 m0, s60, 21504
  s_add_u32 s62, s61, 589824
  buffer_load_dwordx4 v116, s[20:23], s62 offen lds
  s_add_u32 m0, s60, 22528
  s_add_u32 s62, s61, 655360
  buffer_load_dwordx4 v117, s[20:23], s62 offen lds
  s_add_u32 m0, s60, 23552
  s_add_u32 s62, s61, 720896
  buffer_load_dwordx4 v117, s[20:23], s62 offen lds
  s_waitcnt vmcnt(24)
  ds_read_b64_tr_b16 a[96:97], v120 offset:24576
  ds_read_b64_tr_b16 a[98:99], v120 offset:24832
  ds_read_b64_tr_b16 a[100:101], v120 offset:25600
  ds_read_b64_tr_b16 a[102:103], v120 offset:25856
  ds_read_b64_tr_b16 a[104:105], v121 offset:24576
  ds_read_b64_tr_b16 a[106:107], v121 offset:24832
  ds_read_b64_tr_b16 a[108:109], v121 offset:25600
  ds_read_b64_tr_b16 a[110:111], v121 offset:25856
  ds_read_b64_tr_b16 a[112:113], v120 offset:28672
  ds_read_b64_tr_b16 a[114:115], v120 offset:28928
  ds_read_b64_tr_b16 a[116:117], v120 offset:29696
  ds_read_b64_tr_b16 a[118:119], v120 offset:29952
  ds_read_b64_tr_b16 a[120:121], v121 offset:28672
  ds_read_b64_tr_b16 a[122:123], v121 offset:28928
  ds_read_b64_tr_b16 a[124:125], v121 offset:29696
  ds_read_b64_tr_b16 a[126:127], v121 offset:29952
  s_waitcnt lgkmcnt(0)
  s_add_u32 s61, s3, 3
  s_and_b32 s61, s61, 3
  s_lshl_b32 s61, s61, 20
  s_lshl_b32 s62, s5, 8
  s_add_u32 s61, s61, s62
  s_lshl_b32 s62, s3, 6
  s_add_u32 s61, s61, s62
  s_add_u32 m0, s60, 24576
  s_add_u32 s62, s61, 0
  buffer_load_dwordx4 v116, s[20:23], s62 offen lds
  s_add_u32 m0, s60, 25600
  s_add_u32 s62, s61, 65536
  buffer_load_dwordx4 v116, s[20:23], s62 offen lds
  s_add_u32 m0, s60, 26624
  s_add_u32 s62, s61, 131072
  buffer_load_dwordx4 v117, s[20:23], s62 offen lds
  s_add_u32 m0, s60, 27648
  s_add_u32 s62, s61, 196608
  buffer_load_dwordx4 v117, s[20:23], s62 offen lds
  s_add_u32 m0, s60, 28672
  s_add_u32 s62, s61, 524288
  buffer_load_dwordx4 v116, s[20:23], s62 offen lds
  s_add_u32 m0, s60, 29696
  s_add_u32 s62, s61, 589824
  buffer_load_dwordx4 v116, s[20:23], s62 offen lds
  s_add_u32 m0, s60, 30720
  s_add_u32 s62, s61, 655360
  buffer_load_dwordx4 v117, s[20:23], s62 offen lds
  s_add_u32 m0, s60, 31744
  s_add_u32 s62, s61, 720896
  buffer_load_dwordx4 v117, s[20:23], s62 offen lds
  s_waitcnt vmcnt(24)
  ds_read_b64_tr_b16 a[128:129], v120 offset:0
  ds_read_b64_tr_b16 a[130:131], v120 offset:256
  ds_read_b64_tr_b16 a[132:133], v120 offset:1024
  ds_read_b64_tr_b16 a[134:135], v120 offset:1280
  ds_read_b64_tr_b16 a[136:137], v121 offset:0
  ds_read_b64_tr_b16 a[138:139], v121 offset:256
  ds_read_b64_tr_b16 a[140:141], v121 offset:1024
  ds_read_b64_tr_b16 a[142:143], v121 offset:1280
  ds_read_b64_tr_b16 a[144:145], v120 offset:4096
  ds_read_b64_tr_b16 a[146:147], v120 offset:4352
  ds_read_b64_tr_b16 a[148:149], v120 offset:5120
  ds_read_b64_tr_b16 a[150:151], v120 offset:5376
  ds_read_b64_tr_b16 a[152:153], v121 offset:4096
  ds_read_b64_tr_b16 a[154:155], v121 offset:4352
  ds_read_b64_tr_b16 a[156:157], v121 offset:5120
  ds_read_b64_tr_b16 a[158:159], v121 offset:5376
  s_waitcnt lgkmcnt(0)
  s_add_u32 s61, s3, 0
  s_and_b32 s61, s61, 3
  s_lshl_b32 s61, s61, 20
  s_lshl_b32 s62, s5, 8
  s_add_u32 s61, s61, s62
  s_lshl_b32 s62, s3, 6
  s_add_u32 s61, s61, s62
  s_add_u32 m0, s60, 0
  s_add_u32 s62, s61, 0
  buffer_load_dwordx4 v116, s[24:27], s62 offen lds
  s_add_u32 m0, s60, 1024
  s_add_u32 s62, s61, 65536
  buffer_load_dwordx4 v116, s[24:27], s62 offen lds
  s_add_u32 m0, s60, 2048
  s_add_u32 s62, s61, 131072
  buffer_load_dwordx4 v117, s[24:27], s62 offen lds
  s_add_u32 m0, s60, 3072
  s_add_u32 s62, s61, 196608
  buffer_load_dwordx4 v117, s[24:27], s62 offen lds
  s_add_u32 m0, s60, 4096
  s_add_u32 s62, s61, 524288
  buffer_load_dwordx4 v116, s[24:27], s62 offen lds
  s_add_u32 m0, s60, 5120
  s_add_u32 s62, s61, 589824
  buffer_load_dwordx4 v116, s[24:27], s62 offen lds
  s_add_u32 m0, s60, 6144
  s_add_u32 s62, s61, 655360
  buffer_load_dwordx4 v117, s[24:27], s62 offen lds
  s_add_u32 m0, s60, 7168
  s_add_u32 s62, s61, 720896
  buffer_load_dwordx4 v117, s[24:27], s62 offen lds
  s_waitcnt vmcnt(24)
  ds_read_b64_tr_b16 a[160:161], v120 offset:8192
  ds_read_b64_tr_b16 a[162:163], v120 offset:8448
  ds_read_b64_tr_b16 a[164:165], v120 offset:9216
  ds_read_b64_tr_b16 a[166:167], v120 offset:9472
  ds_read_b64_tr_b16 a[168:169], v121 offset:8192
  ds_read_b64_tr_b16 a[170:171], v121 offset:8448
  ds_read_b64_tr_b16 a[172:173], v121 offset:9216
  ds_read_b64_tr_b16 a[174:175], v121 offset:9472
  ds_read_b64_tr_b16 a[176:177], v120 offset:12288
  ds_read_b64_tr_b16 a[178:179], v120 offset:12544
  ds_read_b64_tr_b16 a[180:181], v120 offset:13312
  ds_read_b64_tr_b16 a[182:183], v120 offset:13568
  ds_read_b64_tr_b16 a[184:185], v121 offset:12288
  ds_read_b64_tr_b16 a[186:187], v121 offset:12544
  ds_read_b64_tr_b16 a[188:189], v121 offset:13312
  ds_read_b64_tr_b16 a[190:191], v121 offset:13568
  s_waitcnt lgkmcnt(0)
  s_add_u32 s61, s3, 1
  s_and_b32 s61, s61, 3
  s_lshl_b32 s61, s61, 20
  s_lshl_b32 s62, s5, 8
  s_add_u32 s61, s61, s62
  s_lshl_b32 s62, s3, 6
  s_add_u32 s61, s61, s62
  s_add_u32 m0, s60, 8192
  s_add_u32 s62, s61, 0
  buffer_load_dwordx4 v116, s[24:27], s62 offen lds
  s_add_u32 m0, s60, 9216
  s_add_u32 s62, s61, 65536
  buffer_load_dwordx4 v116, s[24:27], s62 offen lds
  s_add_u32 m0, s60, 10240
  s_add_u32 s62, s61, 131072
  buffer_load_dwordx4 v117, s[24:27], s62 offen lds
  s_add_u32 m0, s60, 11264
  s_add_u32 s62, s61, 196608
  buffer_load_dwordx4 v117, s[24:27], s62 offen lds
  s_add_u32 m0, s60, 12288
  s_add_u32 s62, s61, 524288
  buffer_load_dwordx4 v116, s[24:27], s62 offen lds
  s_add_u32 m0, s60, 13312
  s_add_u32 s62, s61, 589824
  buffer_load_dwordx4 v116, s[24:27], s62 offen lds
  s_add_u32 m0, s60, 14336
  s_add_u32 s62, s61, 655360
  buffer_load_dwordx4 v117, s[24:27], s62 offen lds
  s_add_u32 m0, s60, 15360
  s_add_u32 s62, s61, 720896
  buffer_load_dwordx4 v117, s[24:27], s62 offen lds
  s_waitcnt vmcnt(24)
  ds_read_b64_tr_b16 a[192:193], v120 offset:16384
  ds_read_b64_tr_b16 a[194:195], v120 offset:16640
  ds_read_b64_tr_b16 a[196:197], v120 offset:17408
  ds_read_b64_tr_b16 a[198:199], v120 offset:17664
  ds_read_b64_tr_b16 a[200:201], v121 offset:16384
  ds_read_b64_tr_b16 a[202:203], v121 offset:16640
  ds_read_b64_tr_b16 a[204:205], v121 offset:17408
  ds_read_b64_tr_b16 a[206:207], v121 offset:17664
  ds_read_b64_tr_b16 a[208:209], v120 offset:20480
  ds_read_b64_tr_b16 a[210:211], v120 offset:20736
  ds_read_b64_tr_b16 a[212:213], v120 offset:21504
  ds_read_b64_tr_b16 a[214:215], v120 offset:21760
  ds_read_b64_tr_b16 a[216:217], v121 offset:20480
  ds_read_b64_tr_b16 a[218:219], v121 offset:20736
  ds_read_b64_tr_b16 a[220:221], v121 offset:21504
  ds_read_b64_tr_b16 a[222:223], v121 offset:21760
  s_waitcnt lgkmcnt(0)
  s_add_u32 s61, s3, 2
  s_and_b32 s61, s61, 3
  s_lshl_b32 s61, s61, 20
  s_lshl_b32 s62, s5, 8
  s_add_u32 s61, s61, s62
  s_lshl_b32 s62, s3, 6
  s_add_u32 s61, s61, s62
  s_add_u32 m0, s60, 16384
  s_add_u32 s62, s61, 0
  buffer_load_dwordx4 v116, s[24:27], s62 offen lds
  s_add_u32 m0, s60, 17408
  s_add_u32 s62, s61, 65536
  buffer_load_dwordx4 v116, s[24:27], s62 offen lds
  s_add_u32 m0, s60, 18432
  s_add_u32 s62, s61, 131072
  buffer_load_dwordx4 v117, s[24:27], s62 offen lds
  s_add_u32 m0, s60, 19456
  s_add_u32 s62, s61, 196608
  buffer_load_dwordx4 v117, s[24:27], s62 offen lds
  s_add_u32 m0, s60, 20480
  s_add_u32 s62, s61, 524288
  buffer_load_dwordx4 v116, s[24:27], s62 offen lds
  s_add_u32 m0, s60, 21504
  s_add_u32 s62, s61, 589824
  buffer_load_dwordx4 v116, s[24:27], s62 offen lds
  s_add_u32 m0, s60, 22528
  s_add_u32 s62, s61, 655360
  buffer_load_dwordx4 v117, s[24:27], s62 offen lds
  s_add_u32 m0, s60, 23552
  s_add_u32 s62, s61, 720896
  buffer_load_dwordx4 v117, s[24:27], s62 offen lds
  s_waitcnt vmcnt(24)
  ds_read_b64_tr_b16 a[224:225], v120 offset:24576
  ds_read_b64_tr_b16 a[226:227], v120 offset:24832
  ds_read_b64_tr_b16 a[228:229], v120 offset:25600
  ds_read_b64_tr_b16 a[230:231], v120 offset:25856
  ds_read_b64_tr_b16 a[232:233], v121 offset:24576
  ds_read_b64_tr_b16 a[234:235], v121 offset:24832
  ds_read_b64_tr_b16 a[236:237], v121 offset:25600
  ds_read_b64_tr_b16 a[238:239], v121 offset:25856
  ds_read_b64_tr_b16 a[240:241], v120 offset:28672
  ds_read_b64_tr_b16 a[242:243], v120 offset:28928
  ds_read_b64_tr_b16 a[244:245], v120 offset:29696
  ds_read_b64_tr_b16 a[246:247], v120 offset:29952
  ds_read_b64_tr_b16 a[248:249], v121 offset:28672
  ds_read_b64_tr_b16 a[250:251], v121 offset:28928
  ds_read_b64_tr_b16 a[252:253], v121 offset:29696
  ds_read_b64_tr_b16 a[254:255], v121 offset:29952
  s_waitcnt lgkmcnt(0)
  s_add_u32 s61, s3, 3
  s_and_b32 s61, s61, 3
  s_lshl_b32 s61, s61, 20
  s_lshl_b32 s62, s5, 8
  s_add_u32 s61, s61, s62
  s_lshl_b32 s62, s3, 6
  s_add_u32 s61, s61, s62
  s_add_u32 m0, s60, 24576
  s_add_u32 s62, s61, 0
  buffer_load_dwordx4 v116, s[24:27], s62 offen lds
  s_add_u32 m0, s60, 25600
  s_add_u32 s62, s61, 65536
  buffer_load_dwordx4 v116, s[24:27], s62 offen lds
  s_add_u32 m0, s60, 26624
  s_add_u32 s62, s61, 131072
  buffer_load_dwordx4 v117, s[24:27], s62 offen lds
  s_add_u32 m0, s60, 27648
  s_add_u32 s62, s61, 196608
  buffer_load_dwordx4 v117, s[24:27], s62 offen lds
  s_add_u32 m0, s60, 28672
  s_add_u32 s62, s61, 524288
  buffer_load_dwordx4 v116, s[24:27], s62 offen lds
  s_add_u32 m0, s60, 29696
  s_add_u32 s62, s61, 589824
  buffer_load_dwordx4 v116, s[24:27], s62 offen lds
  s_add_u32 m0, s60, 30720
  s_add_u32 s62, s61, 655360
  buffer_load_dwordx4 v117, s[24:27], s62 offen lds
  s_add_u32 m0, s60, 31744
  s_add_u32 s62, s61, 720896
  buffer_load_dwordx4 v117, s[24:27], s62 offen lds
  s_waitcnt vmcnt(24)
  ds_read_b64_tr_b16 v[128:129], v120 offset:0
  ds_read_b64_tr_b16 v[130:131], v120 offset:256
  ds_read_b64_tr_b16 v[132:133], v120 offset:1024
  ds_read_b64_tr_b16 v[134:135], v120 offset:1280
  ds_read_b64_tr_b16 v[136:137], v121 offset:0
  ds_read_b64_tr_b16 v[138:139], v121 offset:256
  ds_read_b64_tr_b16 v[140:141], v121 offset:1024
  ds_read_b64_tr_b16 v[142:143], v121 offset:1280
  ds_read_b64_tr_b16 v[144:145], v120 offset:4096
  ds_read_b64_tr_b16 v[146:147], v120 offset:4352
  ds_read_b64_tr_b16 v[148:149], v120 offset:5120
  ds_read_b64_tr_b16 v[150:151], v120 offset:5376
  ds_read_b64_tr_b16 v[152:153], v121 offset:4096
  ds_read_b64_tr_b16 v[154:155], v121 offset:4352
  ds_read_b64_tr_b16 v[156:157], v121 offset:5120
  ds_read_b64_tr_b16 v[158:159], v121 offset:5376
  s_waitcnt lgkmcnt(0)
  s_lshl_b32 s61, s5, 17
  s_lshl_b32 s62, s3, 8
  s_add_u32 s61, s61, s62
  s_add_u32 s61, s61, 0
  s_add_u32 m0, s60, 0
  s_add_u32 s62, s61, 0
  buffer_load_dwordx4 v118, s[28:31], s62 offen lds
  s_add_u32 m0, s60, 1024
  s_add_u32 s62, s61, 4096
  buffer_load_dwordx4 v118, s[28:31], s62 offen lds
  s_add_u32 m0, s60, 2048
  s_add_u32 s62, s61, 8192
  buffer_load_dwordx4 v119, s[28:31], s62 offen lds
  s_add_u32 m0, s60, 3072
  s_add_u32 s62, s61, 12288
  buffer_load_dwordx4 v119, s[28:31], s62 offen lds
  s_add_u32 m0, s60, 4096
  s_add_u32 s62, s61, 16384
  buffer_load_dwordx4 v118, s[28:31], s62 offen lds
  s_add_u32 m0, s60, 5120
  s_add_u32 s62, s61, 20480
  buffer_load_dwordx4 v118, s[28:31], s62 offen lds
  s_add_u32 m0, s60, 6144
  s_add_u32 s62, s61, 24576
  buffer_load_dwordx4 v119, s[28:31], s62 offen lds
  s_add_u32 m0, s60, 7168
  s_add_u32 s62, s61, 28672
  buffer_load_dwordx4 v119, s[28:31], s62 offen lds
  s_waitcnt vmcnt(24)
  ds_read_b64_tr_b16 v[160:161], v120 offset:8192
  ds_read_b64_tr_b16 v[162:163], v120 offset:8448
  ds_read_b64_tr_b16 v[164:165], v120 offset:9216
  ds_read_b64_tr_b16 v[166:167], v120 offset:9472
  ds_read_b64_tr_b16 v[168:169], v121 offset:8192
  ds_read_b64_tr_b16 v[170:171], v121 offset:8448
  ds_read_b64_tr_b16 v[172:173], v121 offset:9216
  ds_read_b64_tr_b16 v[174:175], v121 offset:9472
  ds_read_b64_tr_b16 v[176:177], v120 offset:12288
  ds_read_b64_tr_b16 v[178:179], v120 offset:12544
  ds_read_b64_tr_b16 v[180:181], v120 offset:13312
  ds_read_b64_tr_b16 v[182:183], v120 offset:13568
  ds_read_b64_tr_b16 v[184:185], v121 offset:12288
  ds_read_b64_tr_b16 v[186:187], v121 offset:12544
  ds_read_b64_tr_b16 v[188:189], v121 offset:13312
  ds_read_b64_tr_b16 v[190:191], v121 offset:13568
  s_waitcnt lgkmcnt(0)
  s_lshl_b32 s61, s5, 17
  s_lshl_b32 s62, s3, 8
  s_add_u32 s61, s61, s62
  s_add_u32 s61, s61, 32768
  s_add_u32 m0, s60, 8192
  s_add_u32 s62, s61, 0
  buffer_load_dwordx4 v118, s[28:31], s62 offen lds
  s_add_u32 m0, s60, 9216
  s_add_u32 s62, s61, 4096
  buffer_load_dwordx4 v118, s[28:31], s62 offen lds
  s_add_u32 m0, s60, 10240
  s_add_u32 s62, s61, 8192
  buffer_load_dwordx4 v119, s[28:31], s62 offen lds
  s_add_u32 m0, s60, 11264
  s_add_u32 s62, s61, 12288
  buffer_load_dwordx4 v119, s[28:31], s62 offen lds
  s_add_u32 m0, s60, 12288
  s_add_u32 s62, s61, 16384
  buffer_load_dwordx4 v118, s[28:31], s62 offen lds
  s_add_u32 m0, s60, 13312
  s_add_u32 s62, s61, 20480
  buffer_load_dwordx4 v118, s[28:31], s62 offen lds
  s_add_u32 m0, s60, 14336
  s_add_u32 s62, s61, 24576
  buffer_load_dwordx4 v119, s[28:31], s62 offen lds
  s_add_u32 m0, s60, 15360
  s_add_u32 s62, s61, 28672
  buffer_load_dwordx4 v119, s[28:31], s62 offen lds
  s_waitcnt vmcnt(24)
  ds_read_b64_tr_b16 v[192:193], v120 offset:16384
  ds_read_b64_tr_b16 v[194:195], v120 offset:16640
  ds_read_b64_tr_b16 v[196:197], v120 offset:17408
  ds_read_b64_tr_b16 v[198:199], v120 offset:17664
  ds_read_b64_tr_b16 v[200:201], v121 offset:16384
  ds_read_b64_tr_b16 v[202:203], v121 offset:16640
  ds_read_b64_tr_b16 v[204:205], v121 offset:17408
  ds_read_b64_tr_b16 v[206:207], v121 offset:17664
  ds_read_b64_tr_b16 v[208:209], v120 offset:20480
  ds_read_b64_tr_b16 v[210:211], v120 offset:20736
  ds_read_b64_tr_b16 v[212:213], v120 offset:21504
  ds_read_b64_tr_b16 v[214:215], v120 offset:21760
  ds_read_b64_tr_b16 v[216:217], v121 offset:20480
  ds_read_b64_tr_b16 v[218:219], v121 offset:20736
  ds_read_b64_tr_b16 v[220:221], v121 offset:21504
  ds_read_b64_tr_b16 v[222:223], v121 offset:21760
  s_waitcnt lgkmcnt(0)
  s_lshl_b32 s61, s5, 17
  s_lshl_b32 s62, s3, 8
  s_add_u32 s61, s61, s62
  s_add_u32 s61, s61, 65536
  s_add_u32 m0, s60, 16384
  s_add_u32 s62, s61, 0
  buffer_load_dwordx4 v118, s[28:31], s62 offen lds
  s_add_u32 m0, s60, 17408
  s_add_u32 s62, s61, 4096
  buffer_load_dwordx4 v118, s[28:31], s62 offen lds
  s_add_u32 m0, s60, 18432
  s_add_u32 s62, s61, 8192
  buffer_load_dwordx4 v119, s[28:31], s62 offen lds
  s_add_u32 m0, s60, 19456
  s_add_u32 s62, s61, 12288
  buffer_load_dwordx4 v119, s[28:31], s62 offen lds
  s_add_u32 m0, s60, 20480
  s_add_u32 s62, s61, 16384
  buffer_load_dwordx4 v118, s[28:31], s62 offen lds
  s_add_u32 m0, s60, 21504
  s_add_u32 s62, s61, 20480
  buffer_load_dwordx4 v118, s[28:31], s62 offen lds
  s_add_u32 m0, s60, 22528
  s_add_u32 s62, s61, 24576
  buffer_load_dwordx4 v119, s[28:31], s62 offen lds
  s_add_u32 m0, s60, 23552
  s_add_u32 s62, s61, 28672
  buffer_load_dwordx4 v119, s[28:31], s62 offen lds
  s_waitcnt vmcnt(24)
  ds_read_b64_tr_b16 v[224:225], v120 offset:24576
  ds_read_b64_tr_b16 v[226:227], v120 offset:24832
  ds_read_b64_tr_b16 v[228:229], v120 offset:25600
  ds_read_b64_tr_b16 v[230:231], v120 offset:25856
  ds_read_b64_tr_b16 v[232:233], v121 offset:24576
  ds_read_b64_tr_b16 v[234:235], v121 offset:24832
  ds_read_b64_tr_b16 v[236:237], v121 offset:25600
  ds_read_b64_tr_b16 v[238:239], v121 offset:25856
  ds_read_b64_tr_b16 v[240:241], v120 offset:28672
  ds_read_b64_tr_b16 v[242:243], v120 offset:28928
  ds_read_b64_tr_b16 v[244:245], v120 offset:29696
  ds_read_b64_tr_b16 v[246:247], v120 offset:29952
  ds_read_b64_tr_b16 v[248:249], v121 offset:28672
  ds_read_b64_tr_b16 v[250:251], v121 offset:28928
  ds_read_b64_tr_b16 v[252:253], v121 offset:29696
  ds_read_b64_tr_b16 v[254:255], v121 offset:29952
  s_waitcnt lgkmcnt(0)
  s_lshl_b32 s61, s5, 17
  s_lshl_b32 s62, s3, 8
  s_add_u32 s61, s61, s62
  s_add_u32 s61, s61, 98304
  s_add_u32 m0, s60, 24576
  s_add_u32 s62, s61, 0
  buffer_load_dwordx4 v118, s[28:31], s62 offen lds
  s_add_u32 m0, s60, 25600
  s_add_u32 s62, s61, 4096
  buffer_load_dwordx4 v118, s[28:31], s62 offen lds
  s_add_u32 m0, s60, 26624
  s_add_u32 s62, s61, 8192
  buffer_load_dwordx4 v119, s[28:31], s62 offen lds
  s_add_u32 m0, s60, 27648
  s_add_u32 s62, s61, 12288
  buffer_load_dwordx4 v119, s[28:31], s62 offen lds
  s_add_u32 m0, s60, 28672
  s_add_u32 s62, s61, 16384
  buffer_load_dwordx4 v118, s[28:31], s62 offen lds
  s_add_u32 m0, s60, 29696
  s_add_u32 s62, s61, 20480
  buffer_load_dwordx4 v118, s[28:31], s62 offen lds
  s_add_u32 m0, s60, 30720
  s_add_u32 s62, s61, 24576
  buffer_load_dwordx4 v119, s[28:31], s62 offen lds
  s_add_u32 m0, s60, 31744
  s_add_u32 s62, s61, 28672
  buffer_load_dwordx4 v119, s[28:31], s62 offen lds
  s_waitcnt vmcnt(24)
  v_xor_b32 v123, 0, v122
  ds_read_b64_tr_b16 v[20:21], v123 offset:0
  ds_read_b64_tr_b16 v[22:23], v123 offset:1024
  v_xor_b32 v123, 32, v122
  ds_read_b64_tr_b16 v[24:25], v123 offset:0
  ds_read_b64_tr_b16 v[26:27], v123 offset:1024
  v_xor_b32 v123, 64, v122
  ds_read_b64_tr_b16 v[28:29], v123 offset:0
  ds_read_b64_tr_b16 v[30:31], v123 offset:1024
  v_xor_b32 v123, 96, v122
  ds_read_b64_tr_b16 v[32:33], v123 offset:0
  ds_read_b64_tr_b16 v[34:35], v123 offset:1024
  v_xor_b32 v123, 128, v122
  ds_read_b64_tr_b16 v[36:37], v123 offset:0
  ds_read_b64_tr_b16 v[38:39], v123 offset:1024
  v_xor_b32 v123, 160, v122
  ds_read_b64_tr_b16 v[40:41], v123 offset:0
  ds_read_b64_tr_b16 v[42:43], v123 offset:1024
  v_xor_b32 v123, 192, v122
  ds_read_b64_tr_b16 v[44:45], v123 offset:0
  ds_read_b64_tr_b16 v[46:47], v123 offset:1024
  v_xor_b32 v123, 224, v122
  ds_read_b64_tr_b16 v[48:49], v123 offset:0
  ds_read_b64_tr_b16 v[50:51], v123 offset:1024
  s_waitcnt lgkmcnt(0)
  ds_write_b128 v7, v[20:23] offset:0
  ds_write_b128 v7, v[24:27] offset:1024
  ds_write_b128 v7, v[28:31] offset:2048
  ds_write_b128 v7, v[32:35] offset:3072
  ds_write_b128 v7, v[36:39] offset:4096
  ds_write_b128 v7, v[40:43] offset:5120
  ds_write_b128 v7, v[44:47] offset:6144
  ds_write_b128 v7, v[48:51] offset:7168
  s_waitcnt lgkmcnt(0)
  s_waitcnt vmcnt(16)
  v_xor_b32 v123, 0, v122
  ds_read_b64_tr_b16 v[20:21], v123 offset:8192
  ds_read_b64_tr_b16 v[22:23], v123 offset:9216
  v_xor_b32 v123, 32, v122
  ds_read_b64_tr_b16 v[24:25], v123 offset:8192
  ds_read_b64_tr_b16 v[26:27], v123 offset:9216
  v_xor_b32 v123, 64, v122
  ds_read_b64_tr_b16 v[28:29], v123 offset:8192
  ds_read_b64_tr_b16 v[30:31], v123 offset:9216
  v_xor_b32 v123, 96, v122
  ds_read_b64_tr_b16 v[32:33], v123 offset:8192
  ds_read_b64_tr_b16 v[34:35], v123 offset:9216
  v_xor_b32 v123, 128, v122
  ds_read_b64_tr_b16 v[36:37], v123 offset:8192
  ds_read_b64_tr_b16 v[38:39], v123 offset:9216
  v_xor_b32 v123, 160, v122
  ds_read_b64_tr_b16 v[40:41], v123 offset:8192
  ds_read_b64_tr_b16 v[42:43], v123 offset:9216
  v_xor_b32 v123, 192, v122
  ds_read_b64_tr_b16 v[44:45], v123 offset:8192
  ds_read_b64_tr_b16 v[46:47], v123 offset:9216
  v_xor_b32 v123, 224, v122
  ds_read_b64_tr_b16 v[48:49], v123 offset:8192
  ds_read_b64_tr_b16 v[50:51], v123 offset:9216
  s_waitcnt lgkmcnt(0)
  ds_write_b128 v7, v[20:23] offset:8192
  ds_write_b128 v7, v[24:27] offset:9216
  ds_write_b128 v7, v[28:31] offset:10240
  ds_write_b128 v7, v[32:35] offset:11264
  ds_write_b128 v7, v[36:39] offset:12288
  ds_write_b128 v7, v[40:43] offset:13312
  ds_write_b128 v7, v[44:47] offset:14336
  ds_write_b128 v7, v[48:51] offset:15360
  s_waitcnt lgkmcnt(0)
  s_waitcnt vmcnt(8)
  v_xor_b32 v123, 0, v122
  ds_read_b64_tr_b16 v[20:21], v123 offset:16384
  ds_read_b64_tr_b16 v[22:23], v123 offset:17408
  v_xor_b32 v123, 32, v122
  ds_read_b64_tr_b16 v[24:25], v123 offset:16384
  ds_read_b64_tr_b16 v[26:27], v123 offset:17408
  v_xor_b32 v123, 64, v122
  ds_read_b64_tr_b16 v[28:29], v123 offset:16384
  ds_read_b64_tr_b16 v[30:31], v123 offset:17408
  v_xor_b32 v123, 96, v122
  ds_read_b64_tr_b16 v[32:33], v123 offset:16384
  ds_read_b64_tr_b16 v[34:35], v123 offset:17408
  v_xor_b32 v123, 128, v122
  ds_read_b64_tr_b16 v[36:37], v123 offset:16384
  ds_read_b64_tr_b16 v[38:39], v123 offset:17408
  v_xor_b32 v123, 160, v122
  ds_read_b64_tr_b16 v[40:41], v123 offset:16384
  ds_read_b64_tr_b16 v[42:43], v123 offset:17408
  v_xor_b32 v123, 192, v122
  ds_read_b64_tr_b16 v[44:45], v123 offset:16384
  ds_read_b64_tr_b16 v[46:47], v123 offset:17408
  v_xor_b32 v123, 224, v122
  ds_read_b64_tr_b16 v[48:49], v123 offset:16384
  ds_read_b64_tr_b16 v[50:51], v123 offset:17408
  s_waitcnt lgkmcnt(0)
  ds_write_b128 v7, v[20:23] offset:16384
  ds_write_b128 v7, v[24:27] offset:17408
  ds_write_b128 v7, v[28:31] offset:18432
  ds_write_b128 v7, v[32:35] offset:19456
  ds_write_b128 v7, v[36:39] offset:20480
  ds_write_b128 v7, v[40:43] offset:21504
  ds_write_b128 v7, v[44:47] offset:22528
  ds_write_b128 v7, v[48:51] offset:23552
  s_waitcnt lgkmcnt(0)
  s_waitcnt vmcnt(0)
  v_xor_b32 v123, 0, v122
  ds_read_b64_tr_b16 v[20:21], v123 offset:24576
  ds_read_b64_tr_b16 v[22:23], v123 offset:25600
  v_xor_b32 v123, 32, v122
  ds_read_b64_tr_b16 v[24:25], v123 offset:24576
  ds_read_b64_tr_b16 v[26:27], v123 offset:25600
  v_xor_b32 v123, 64, v122
  ds_read_b64_tr_b16 v[28:29], v123 offset:24576
  ds_read_b64_tr_b16 v[30:31], v123 offset:25600
  v_xor_b32 v123, 96, v122
  ds_read_b64_tr_b16 v[32:33], v123 offset:24576
  ds_read_b64_tr_b16 v[34:35], v123 offset:25600
  v_xor_b32 v123, 128, v122
  ds_read_b64_tr_b16 v[36:37], v123 offset:24576
  ds_read_b64_tr_b16 v[38:39], v123 offset:25600
  v_xor_b32 v123, 160, v122
  ds_read_b64_tr_b16 v[40:41], v123 offset:24576
  ds_read_b64_tr_b16 v[42:43], v123 offset:25600
  v_xor_b32 v123, 192, v122
  ds_read_b64_tr_b16 v[44:45], v123 offset:24576
  ds_read_b64_tr_b16 v[46:47], v123 offset:25600
  v_xor_b32 v123, 224, v122
  ds_read_b64_tr_b16 v[48:49], v123 offset:24576
  ds_read_b64_tr_b16 v[50:51], v123 offset:25600
  s_waitcnt lgkmcnt(0)
  ds_write_b128 v7, v[20:23] offset:24576
  ds_write_b128 v7, v[24:27] offset:25600
  ds_write_b128 v7, v[28:31] offset:26624
  ds_write_b128 v7, v[32:35] offset:27648
  ds_write_b128 v7, v[36:39] offset:28672
  ds_write_b128 v7, v[40:43] offset:29696
  ds_write_b128 v7, v[44:47] offset:30720
  ds_write_b128 v7, v[48:51] offset:31744
  s_waitcnt lgkmcnt(0)
  s_mov_b32 s16, s80
  s_mov_b32 s17, s81
  s_mov_b32 s18, 0x2000
  s_mov_b32 s19, 0x20000
  v_and_b32 v16, 15, v0
  v_lshrrev_b32 v17, 1, v16
  v_lshlrev_b32 v17, 10, v17
  v_and_b32 v18, 1, v0
  v_lshl_or_b32 v17, v18, 6, v17
  v_lshrrev_b32 v19, 4, v0
  v_lshl_or_b32 v17, v19, 3, v17
  s_lshl_b32 s6, s3, 8
  buffer_load_dwordx2 v[20:21], v17, s[16:19], s6 offen offset:0
  buffer_load_dwordx2 v[22:23], v17, s[16:19], s6 offen offset:32
  buffer_load_dwordx2 v[24:25], v17, s[16:19], s6 offen offset:128
  buffer_load_dwordx2 v[26:27], v17, s[16:19], s6 offen offset:160
  v_mov_b32 v19, 0x4444
  v_mov_b32 v16, 0xeeee
  v_cmp_eq_u32 vcc, 0, v18
  s_nop 1
  v_cndmask_b32 v0, v16, v19, vcc
  s_mov_b32 s7, 0
  v_mov_b32 v16, 128
L_wd_17:
  buffer_load_dword v17, v16, s[12:15], 0 offen sc1
  s_waitcnt vmcnt(0)
  v_cmp_ne_u32 vcc, 0x100, v17
  s_cbranch_vccz L_wdo_18
  s_add_u32 s7, s7, 1
  s_cmp_lt_u32 s7, 131072
  s_cbranch_scc1 L_wd_17
  s_mov_b32 s6, 10
  s_branch L_err
L_wdo_18:
  s_mov_b32 s32, 0
  s_mov_b32 s49, 1
  s_mov_b32 s33, 1
  s_sub_u32 s6, s49, 1
  s_and_b32 s7, s6, 1
  s_lshl_b32 s7, s7, 12
  s_add_u32 s51, s38, s7
  s_and_b32 s6, s6, 3
  s_lshl_b32 s6, s6, 19
  s_add_u32 s50, s35, s6
  s_mov_b32 s7, 0
L_pl_19:
  buffer_load_dwordx4 v[120:123], v13, s[8:11], s51 offen offset:0 sc1
  s_waitcnt vmcnt(0)
  v_min_u32 v120, v120, v121
  v_min3_u32 v120, v120, v122, v123
  v_cmp_gt_u32 vcc, s49, v120
  s_cbranch_vccz L_plo_20
  s_add_u32 s7, s7, 1
  s_cmp_lt_u32 s7, 131072
  s_cbranch_scc1 L_pl_19
  s_mov_b32 s6, 11
  s_branch L_err
L_plo_20:
  s_mov_b32 m0, s53
  s_add_u32 s6, s50, 0x2000
  buffer_load_dwordx4 v1, s[8:11], s50 offen sc1 lds
  buffer_load_dwordx4 v1, s[8:11], s50 offen offset:1024 sc1 lds
  s_mov_b32 m0, s37
  s_nop 0
  buffer_load_dwordx4 v1, s[8:11], s6 offen sc1 lds
  buffer_load_dwordx4 v1, s[8:11], s6 offen offset:1024 sc1 lds
  s_mov_b32 s49, 2
  s_sub_u32 s6, s49, 1
  s_and_b32 s7, s6, 1
  s_lshl_b32 s7, s7, 12
  s_add_u32 s51, s38, s7
  s_and_b32 s6, s6, 3
  s_lshl_b32 s6, s6, 19
  s_add_u32 s50, s35, s6
  v_add_u32 v116, s48, v1
  v_add_u32 v117, s45, v1
  v_add_u32 v118, s46, v1
  v_add_u32 v119, s47, v1
  v_mov_b64 v[84:85], 0
  v_mov_b64 v[86:87], 0
  v_mov_b64 v[88:89], 0
  v_mov_b64 v[90:91], 0
  v_mov_b64 v[92:93], 0
  v_mov_b64 v[94:95], 0
  v_mov_b64 v[96:97], 0
  v_mov_b64 v[98:99], 0
  v_mov_b64 v[100:101], 0
  v_mov_b64 v[102:103], 0
  v_mov_b64 v[104:105], 0
  v_mov_b64 v[106:107], 0
  s_waitcnt vmcnt(0)
  s_branch L_rec_step
L_rec_loop:
  buffer_load_dwordx4 v[20:23], v1, s[8:11], s44 offen sc1
  buffer_load_dwordx4 v[24:27], v1, s[8:11], s44 offen offset:1024 sc1
  s_mov_b32 s7, 0
  v_add_u32 v116, s48, v1
  v_add_u32 v117, s45, v1
  v_add_u32 v118, s46, v1
  v_add_u32 v119, s47, v1
  v_mov_b64 v[84:85], 0
  v_mov_b64 v[86:87], 0
  v_mov_b64 v[88:89], 0
  v_mov_b64 v[90:91], 0
  v_mov_b64 v[92:93], 0
  v_mov_b64 v[94:95], 0
  v_mov_b64 v[96:97], 0
  v_mov_b64 v[98:99], 0
  v_mov_b64 v[100:101], 0
  v_mov_b64 v[102:103], 0
  v_mov_b64 v[104:105], 0
  v_mov_b64 v[106:107], 0
L_rec_gather:
  buffer_load_dwordx4 v[52:55], v1, s[8:11], s44 offen sc1
  buffer_load_dwordx4 v[56:59], v1, s[8:11], s44 offen offset:1024 sc1
  s_waitcnt vmcnt(2)
  v_bitop3_b32 v16, v20, v22, s33 bitop3:0x7e
  v_bitop3_b32 v17, v24, v26, s33 bitop3:0x7e
  v_bitop3_b32 v16, v16, v17, 1 bitop3:0xa8
  v_cmp_ne_u32 vcc, 0, v16
  s_cbranch_vccz L_rec_got
  buffer_load_dwordx4 v[20:23], v1, s[8:11], s44 offen sc1
  buffer_load_dwordx4 v[24:27], v1, s[8:11], s44 offen offset:1024 sc1
  s_waitcnt vmcnt(2)
  v_bitop3_b32 v16, v52, v54, s33 bitop3:0x7e
  v_bitop3_b32 v17, v56, v58, s33 bitop3:0x7e
  v_bitop3_b32 v16, v16, v17, 1 bitop3:0xa8
  v_cmp_ne_u32 vcc, 0, v16
  s_cbranch_vccz L_rec_gotB
  s_and_b32 s6, s7, 31
  s_cmp_lg_u32 s6, 31
  s_cbranch_scc1 L_tf_21
  buffer_wbl2 sc1
  s_waitcnt vmcnt(0)
  buffer_inv sc1
  s_waitcnt vmcnt(0)
L_tf_21:
  s_add_u32 s7, s7, 1
  s_cmp_lt_u32 s7, 131072
  s_cbranch_scc1 L_rec_gather
  s_mov_b32 s6, 12
  s_branch L_err
L_rec_gotB:
  v_mov_b64 v[20:21], v[52:53]
  v_mov_b64 v[22:23], v[54:55]
  v_mov_b64 v[24:25], v[56:57]
  v_mov_b64 v[26:27], v[58:59]
L_rec_got:
  s_mov_b32 s63, s7
  s_xor_b32 s33, s33, 1
L_rec_step:
  ds_write_b128 v116, v[20:23]
  ds_write_b128 v116, v[24:27] offset:1024
  buffer_load_dwordx4 v[120:123], v13, s[8:11], s51 offen sc1
  v_smfmac_f32_16x16x64_bf16 v[84:87], v[20:23], a[0:7], v0
  v_smfmac_f32_16x16x64_bf16 v[88:91], v[20:23], a[8:15], v0
  v_smfmac_f32_16x16x64_bf16 v[84:87], v[24:27], a[16:23], v0
  v_smfmac_f32_16x16x64_bf16 v[88:91], v[24:27], a[24:31], v0
  s_waitcnt lgkmcnt(0)
  s_barrier
  ds_read_b128 v[28:31], v117 offset:0
  ds_read_b128 v[32:35], v117 offset:1024
  v_smfmac_f32_16x16x64_bf16 v[92:95], v[20:23], a[128:135], v0
  ds_read_b128 v[36:39], v118 offset:0
  ds_read_b128 v[40:43], v118 offset:1024
  v_smfmac_f32_16x16x64_bf16 v[96:99], v[20:23], a[136:143], v0
  ds_read_b128 v[44:47], v119 offset:0
  ds_read_b128 v[48:51], v119 offset:1024
  v_smfmac_f32_16x16x64_bf16 v[92:95], v[24:27], a[144:151], v0
  s_and_b32 s6, s32, 3
  v_smfmac_f32_16x16x64_bf16 v[96:99], v[24:27], a[152:159], v0
  s_lshl_b32 s6, s6, 17
  v_smfmac_f32_16x16x64_bf16 v[100:103], v[20:23], v[128:135], v0
  s_add_u32 s52, s36, s6
  v_smfmac_f32_16x16x64_bf16 v[104:107], v[20:23], v[136:143], v0
  s_lshr_b32 s6, s32, 2
  v_smfmac_f32_16x16x64_bf16 v[100:103], v[24:27], v[144:151], v0
  s_andn2_b32 s59, 1, s6
  v_smfmac_f32_16x16x64_bf16 v[104:107], v[24:27], v[152:159], v0
  s_waitcnt lgkmcnt(5)
  v_smfmac_f32_16x16x64_bf16 v[84:87], v[28:31], a[32:39], v0
  v_smfmac_f32_16x16x64_bf16 v[88:91], v[28:31], a[40:47], v0
  s_waitcnt lgkmcnt(4)
  v_smfmac_f32_16x16x64_bf16 v[84:87], v[32:35], a[48:55], v0
  v_smfmac_f32_16x16x64_bf16 v[88:91], v[32:35], a[56:63], v0
  s_waitcnt lgkmcnt(3)
  v_smfmac_f32_16x16x64_bf16 v[84:87], v[36:39], a[64:71], v0
  v_smfmac_f32_16x16x64_bf16 v[88:91], v[36:39], a[72:79], v0
  s_waitcnt lgkmcnt(2)
  v_smfmac_f32_16x16x64_bf16 v[84:87], v[40:43], a[80:87], v0
  v_smfmac_f32_16x16x64_bf16 v[88:91], v[40:43], a[88:95], v0
  s_waitcnt lgkmcnt(1)
  v_smfmac_f32_16x16x64_bf16 v[84:87], v[44:47], a[96:103], v0
  v_smfmac_f32_16x16x64_bf16 v[88:91], v[44:47], a[104:111], v0
  s_waitcnt lgkmcnt(0)
  v_smfmac_f32_16x16x64_bf16 v[84:87], v[48:51], a[112:119], v0
  v_smfmac_f32_16x16x64_bf16 v[88:91], v[48:51], a[120:127], v0
  s_waitcnt vmcnt(1)
  v_smfmac_f32_16x16x64_bf16 v[92:95], v[28:31], a[160:167], v0
  ds_read_b128 v[52:55], v4 offset:0
  ds_read_b128 v[68:71], v4 offset:128
  v_smfmac_f32_16x16x64_bf16 v[92:95], v[32:35], a[176:183], v0
  ds_read_b128 v[56:59], v4 offset:2048
  ds_read_b128 v[72:75], v4 offset:2176
  v_smfmac_f32_16x16x64_bf16 v[92:95], v[36:39], a[192:199], v0
  ds_read_b128 v[60:63], v4 offset:4096
  ds_read_b128 v[76:79], v4 offset:4224
  v_add_f32 v84, v84, v85
  v_smfmac_f32_16x16x64_bf16 v[92:95], v[40:43], a[208:215], v0
  ds_read_b128 v[64:67], v4 offset:6144
  ds_read_b128 v[80:83], v4 offset:6272
  v_add_f32 v86, v86, v87
  v_smfmac_f32_16x16x64_bf16 v[92:95], v[44:47], a[224:231], v0
  v_cvt_pk_bf16_f32 v16, v84, v86
  v_smfmac_f32_16x16x64_bf16 v[92:95], v[48:51], a[240:247], v0
  v_add_f32 v88, v88, v89
  v_smfmac_f32_16x16x64_bf16 v[96:99], v[28:31], a[168:175], v0
  v_add_f32 v90, v90, v91
  ds_read_b128 v[108:111], v9
  ds_read_b128 v[112:115], v9 offset:256
  v_smfmac_f32_16x16x64_bf16 v[96:99], v[32:35], a[184:191], v0
  v_cvt_pk_bf16_f32 v18, v88, v90
  v_smfmac_f32_16x16x64_bf16 v[96:99], v[36:39], a[200:207], v0
  v_add_f32 v92, v92, v93
  v_smfmac_f32_16x16x64_bf16 v[96:99], v[40:43], a[216:223], v0
  v_add_f32 v94, v94, v95
  v_smfmac_f32_16x16x64_bf16 v[96:99], v[44:47], a[232:239], v0
  v_cvt_pk_bf16_f32 v17, v92, v94
  v_smfmac_f32_16x16x64_bf16 v[96:99], v[48:51], a[248:255], v0
  ds_write_b64 v2, v[16:17]
  v_smfmac_f32_16x16x64_bf16 v[100:103], v[28:31], v[160:167], v0
  v_smfmac_f32_16x16x64_bf16 v[104:107], v[28:31], v[168:175], v0
  s_nop 4
  v_add_f32 v96, v96, v97
  v_add_f32 v98, v98, v99
  v_cvt_pk_bf16_f32 v19, v96, v98
  ds_write_b64 v2, v[18:19] offset:128
  v_smfmac_f32_16x16x64_bf16 v[100:103], v[32:35], v[176:183], v0
  v_smfmac_f32_16x16x64_bf16 v[104:107], v[32:35], v[184:191], v0
  s_waitcnt lgkmcnt(0)
  s_barrier
  ds_read_b64_tr_b16 v[84:85], v3 offset:0
  ds_read_b64_tr_b16 v[86:87], v3 offset:64
  v_smfmac_f32_16x16x64_bf16 v[100:103], v[36:39], v[192:199], v0
  ds_read_b64_tr_b16 v[88:89], v3 offset:256
  ds_read_b64_tr_b16 v[90:91], v3 offset:320
  v_smfmac_f32_16x16x64_bf16 v[104:107], v[36:39], v[200:207], v0
  ds_read_b64_tr_b16 v[92:93], v3 offset:512
  ds_read_b64_tr_b16 v[94:95], v3 offset:576
  v_smfmac_f32_16x16x64_bf16 v[100:103], v[40:43], v[208:215], v0
  ds_read_b64_tr_b16 v[96:97], v3 offset:768
  ds_read_b64_tr_b16 v[98:99], v3 offset:832
  v_smfmac_f32_16x16x64_bf16 v[104:107], v[40:43], v[216:223], v0
  s_cmp_eq_u32 s32, 63
  s_waitcnt vmcnt(0)
  s_cbranch_scc1 L_rec_nokv
  v_min_u32 v120, v120, v121
  v_min3_u32 v120, v120, v122, v123
  v_cmp_gt_u32 vcc, s49, v120
  s_cbranch_vccnz L_rec_kvwait
L_rec_kvok:
  s_mov_b32 m0, s53
  s_add_u32 s6, s50, 0x2000
  buffer_load_dwordx4 v1, s[8:11], s50 offen sc1 lds
  buffer_load_dwordx4 v1, s[8:11], s50 offen offset:1024 sc1 lds
  s_mov_b32 m0, s37
  s_nop 0
  buffer_load_dwordx4 v1, s[8:11], s6 offen sc1 lds
  buffer_load_dwordx4 v1, s[8:11], s6 offen offset:1024 sc1 lds
L_rec_nokv:
  v_smfmac_f32_16x16x64_bf16 v[100:103], v[44:47], v[224:231], v0
  s_waitcnt lgkmcnt(6)
  v_mfma_f32_16x16x32_bf16 v[116:119], v[52:55], v[84:87], 0
  v_mfma_f32_16x16x32_bf16 v[120:123], v[68:71], v[84:87], 0
  v_mfma_f32_16x16x32_bf16 v[124:127], v[84:87], v[84:87], 0
  s_waitcnt lgkmcnt(4)
  v_mfma_f32_16x16x32_bf16 v[116:119], v[56:59], v[88:91], v[116:119]
  v_mfma_f32_16x16x32_bf16 v[120:123], v[72:75], v[88:91], v[120:123]
  v_mfma_f32_16x16x32_bf16 v[124:127], v[88:91], v[88:91], v[124:127]
  s_waitcnt lgkmcnt(2)
  v_mfma_f32_16x16x32_bf16 v[116:119], v[60:63], v[92:95], v[116:119]
  v_mfma_f32_16x16x32_bf16 v[120:123], v[76:79], v[92:95], v[120:123]
  v_mfma_f32_16x16x32_bf16 v[124:127], v[92:95], v[92:95], v[124:127]
  s_waitcnt lgkmcnt(0)
  v_mfma_f32_16x16x32_bf16 v[116:119], v[64:67], v[96:99], v[116:119]
  v_mfma_f32_16x16x32_bf16 v[120:123], v[80:83], v[96:99], v[120:123]
  v_mfma_f32_16x16x32_bf16 v[124:127], v[96:99], v[96:99], v[124:127]
  v_smfmac_f32_16x16x64_bf16 v[104:107], v[44:47], v[232:239], v0
  ds_read_b128 v[52:55], v7 offset:0
  ds_read_b128 v[56:59], v7 offset:8192
  s_nop 2
  v_max3_f32 v88, v116, v117, v118
  v_max3_f32 v89, v120, v121, v122
  v_max3_f32 v88, v88, v119, v123
  v_max3_f32 v89, v89, v126, v127
  v_max_f32 v88, v88, v89
  v_max_f32 v89, v88, v89
  v_smfmac_f32_16x16x64_bf16 v[100:103], v[48:51], v[240:247], v0
  ds_read_b128 v[60:63], v7 offset:1024
  v_permlane32_swap_b32 v88, v89
  v_max_f32 v88, v88, v89
  v_max_f32 v89, v88, v89
  v_smfmac_f32_16x16x64_bf16 v[104:107], v[48:51], v[248:255], v0
  ds_read_b128 v[64:67], v7 offset:9216
  v_permlane16_swap_b32 v88, v89
  v_max_f32 v88, v88, v89
  v_mul_f32 v88, s34, v88
  v_fma_f32 v126, v126, s34, -v88
  v_fma_f32 v127, v127, s34, -v88
  v_exp_f32 v126, v126
  ds_read_b128 v[68:71], v7 offset:16384
  v_exp_f32 v127, v127
  ds_read_b128 v[72:75], v7 offset:24576
  v_fma_f32 v116, v116, s34, -v88
  v_fma_f32 v117, v117, s34, -v88
  v_fma_f32 v118, v118, s34, -v88
  v_fma_f32 v119, v119, s34, -v88
  v_cvt_pk_bf16_f32 v12, v126, v127
  v_exp_f32 v116, v116
  ds_read_b128 v[76:79], v7 offset:17408
  v_exp_f32 v117, v117
  ds_read_b128 v[80:83], v7 offset:25600
  v_mfma_f32_16x16x16_bf16 v[124:127], v[10:11], v[12:13], 0
  v_exp_f32 v118, v118
  ds_read_b128 v[20:23], v7 offset:2048
  v_exp_f32 v119, v119
  ds_read_b128 v[24:27], v7 offset:10240
  v_add_f32 v100, v100, v101
  v_add_f32 v102, v102, v103
  v_cvt_pk_bf16_f32 v16, v100, v102
  v_cvt_pk_bf16_f32 v92, v116, v117
  v_cvt_pk_bf16_f32 v93, v118, v119
  v_add_f32 v104, v104, v105
  v_add_f32 v106, v106, v107
  v_cvt_pk_bf16_f32 v18, v104, v106
  v_mfma_f32_16x16x16_bf16 v[124:127], v[10:11], v[92:93], v[124:127]
  v_bfi_b32 v16, 1, s59, v16
  v_fma_f32 v120, v120, s34, -v88
  v_fma_f32 v121, v121, s34, -v88
  buffer_store_dwordx4 v[16:19], v1, s[8:11], s52 offen sc1
  v_mfma_f32_16x16x16_bf16 v[100:103], v[16:17], v[12:13], 0
  v_fma_f32 v122, v122, s34, -v88
  v_fma_f32 v123, v123, s34, -v88
  v_mfma_f32_16x16x16_bf16 v[104:107], v[18:19], v[12:13], 0
  v_exp_f32 v120, v120
  ds_read_b128 v[28:31], v7 offset:3072
  v_exp_f32 v121, v121
  ds_read_b128 v[32:35], v7 offset:11264
  v_exp_f32 v122, v122
  ds_read_b128 v[36:39], v7 offset:18432
  v_exp_f32 v123, v123
  ds_read_b128 v[40:43], v7 offset:26624
  s_cmp_eq_u32 s32, 63
  v_cvt_pk_bf16_f32 v94, v120, v121
  v_cvt_pk_bf16_f32 v95, v122, v123
  s_cbranch_scc1 L_rec_last
  s_nop 0
  v_mfma_f32_16x16x16_bf16 v[124:127], v[10:11], v[94:95], v[124:127]
  v_mfma_f32_16x16x32_bf16 v[100:103], v[108:111], v[92:95], v[100:103]
  v_mfma_f32_16x16x32_bf16 v[104:107], v[112:115], v[92:95], v[104:107]
  ds_read_b128 v[44:47], v7 offset:19456
  ds_read_b128 v[48:51], v7 offset:27648
  s_nop 3
  v_rcp_f32 v124, v124
  s_nop 0
  v_mul_f32 v100, v124, v100
  v_mul_f32 v101, v124, v101
  v_mul_f32 v102, v124, v102
  v_mul_f32 v103, v124, v103
  v_cvt_pk_bf16_f32 v116, v100, v101
  v_cvt_pk_bf16_f32 v117, v102, v103
  v_mul_f32 v104, v124, v104
  v_mul_f32 v105, v124, v105
  v_mul_f32 v106, v124, v106
  v_mul_f32 v107, v124, v107
  v_cvt_pk_bf16_f32 v118, v104, v105
  v_cvt_pk_bf16_f32 v119, v106, v107
  s_mov_b64 exec, s[56:57]
  ds_write2_b32 v5, v116, v117 offset0:0 offset1:4
  ds_write2_b32 v5, v118, v119 offset0:8 offset1:12
  s_mov_b64 exec, -1
  v_mfma_f32_32x32x8_bf16 v[84:99], v[12:13], v[14:15], 0
  v_mfma_f32_32x32x8_bf16 v[100:115], v[12:13], v[14:15], 0
  s_waitcnt lgkmcnt(0)
  s_barrier
  ds_read_b128 v[116:119], v6
  ds_read_b128 v[120:123], v6 offset:128
  s_waitcnt lgkmcnt(1)
  s_nop 3
  v_smfmac_f32_16x16x64_bf16 v[84:87], v[116:119], v[52:59], v0
  ds_read_b128 v[52:55], v7 offset:4096
  ds_read_b128 v[56:59], v7 offset:12288
  v_smfmac_f32_16x16x64_bf16 v[88:91], v[116:119], v[60:67], v0
  ds_read_b128 v[60:63], v7 offset:5120
  ds_read_b128 v[64:67], v7 offset:13312
  s_waitcnt lgkmcnt(4)
  v_smfmac_f32_16x16x64_bf16 v[84:87], v[120:123], v[68:75], v0
  ds_read_b128 v[68:71], v7 offset:20480
  ds_read_b128 v[72:75], v7 offset:28672
  v_smfmac_f32_16x16x64_bf16 v[88:91], v[120:123], v[76:83], v0
  ds_read_b128 v[76:79], v7 offset:21504
  ds_read_b128 v[80:83], v7 offset:29696
  v_smfmac_f32_16x16x64_bf16 v[92:95], v[116:119], v[20:27], v0
  ds_read_b128 v[20:23], v7 offset:6144
  ds_read_b128 v[24:27], v7 offset:14336
  v_smfmac_f32_16x16x64_bf16 v[96:99], v[116:119], v[28:35], v0
  ds_read_b128 v[28:31], v7 offset:7168
  ds_read_b128 v[32:35], v7 offset:15360
  v_add_f32 v84, v84, v85
  v_smfmac_f32_16x16x64_bf16 v[92:95], v[120:123], v[36:43], v0
  ds_read_b128 v[36:39], v7 offset:22528
  ds_read_b128 v[40:43], v7 offset:30720
  v_add_f32 v86, v86, v87
  v_smfmac_f32_16x16x64_bf16 v[96:99], v[120:123], v[44:51], v0
  ds_read_b128 v[44:47], v7 offset:23552
  ds_read_b128 v[48:51], v7 offset:31744
  v_cvt_pk_bf16_f32 v124, v84, v86
  s_waitcnt lgkmcnt(14)
  v_smfmac_f32_16x16x64_bf16 v[100:103], v[116:119], v[52:59], v0
  v_add_f32 v88, v88, v89
  v_add_f32 v90, v90, v91
  s_waitcnt lgkmcnt(12)
  v_smfmac_f32_16x16x64_bf16 v[104:107], v[116:119], v[60:67], v0
  v_cvt_pk_bf16_f32 v125, v88, v90
  v_add_f32 v92, v92, v93
  s_waitcnt lgkmcnt(10)
  v_smfmac_f32_16x16x64_bf16 v[100:103], v[120:123], v[68:75], v0
  v_add_f32 v94, v94, v95
  v_cvt_pk_bf16_f32 v126, v92, v94
  s_waitcnt lgkmcnt(8)
  v_smfmac_f32_16x16x64_bf16 v[104:107], v[120:123], v[76:83], v0
  v_add_f32 v96, v96, v97
  v_add_f32 v98, v98, v99
  s_waitcnt lgkmcnt(6)
  v_smfmac_f32_16x16x64_bf16 v[108:111], v[116:119], v[20:27], v0
  v_cvt_pk_bf16_f32 v127, v96, v98
  v_bfi_b32 v124, 1, s33, v124
  s_waitcnt lgkmcnt(4)
  v_smfmac_f32_16x16x64_bf16 v[112:115], v[116:119], v[28:35], v0
  buffer_store_dwordx4 v[124:127], v8, s[8:11], s39 offen
  v_add_f32 v100, v100, v101
  s_waitcnt lgkmcnt(2)
  v_smfmac_f32_16x16x64_bf16 v[108:111], v[120:123], v[36:43], v0
  v_add_f32 v102, v102, v103
  v_cvt_pk_bf16_f32 v16, v100, v102
  s_waitcnt lgkmcnt(0)
  v_smfmac_f32_16x16x64_bf16 v[112:115], v[120:123], v[44:51], v0
  v_add_f32 v104, v104, v105
  v_add_f32 v106, v106, v107
  v_cvt_pk_bf16_f32 v17, v104, v106
  s_nop 0
  v_add_f32 v108, v108, v109
  v_add_f32 v110, v110, v111
  v_cvt_pk_bf16_f32 v18, v108, v110
  s_nop 0
  v_add_f32 v112, v112, v113
  v_add_f32 v114, v114, v115
  v_cvt_pk_bf16_f32 v19, v112, v114
  v_bfi_b32 v16, 1, s33, v16
  buffer_store_dwordx4 v[16:19], v8, s[8:11], s40 offen
  s_add_u32 s32, s32, 1
  s_add_u32 s49, s32, 2
  s_cmp_lg_u32 s3, 0
  s_cbranch_scc1 L_rec_nored
  v_bfe_u32 v108, v1, 4, 4
  v_and_b32 v109, 1, v108
  v_lshlrev_b32 v110, 4, v109
  v_mov_b32 v111, 0x3f80
  v_lshlrev_b32 v110, v110, v111
  v_lshrrev_b32 v111, 1, v108
  v_cmp_eq_u32 vcc, 0, v111
  s_nop 1
  v_cndmask_b32 v120, 0, v110, vcc
  v_cmp_eq_u32 vcc, 1, v111
  s_nop 1
  v_cndmask_b32 v121, 0, v110, vcc
  v_cmp_eq_u32 vcc, 2, v111
  s_nop 1
  v_cndmask_b32 v122, 0, v110, vcc
  v_cmp_eq_u32 vcc, 3, v111
  s_nop 1
  v_cndmask_b32 v123, 0, v110, vcc
  buffer_load_dwordx4 v[20:23], v1, s[8:11], s41 offen offset:0 sc1
  buffer_load_dwordx4 v[24:27], v1, s[8:11], s41 offen offset:1024 sc1
  buffer_load_dwordx4 v[28:31], v1, s[8:11], s41 offen offset:2048 sc1
  buffer_load_dwordx4 v[32:35], v1, s[8:11], s41 offen offset:3072 sc1
  buffer_load_dwordx4 v[36:39], v1, s[8:11], s42 offen offset:0 sc1
  buffer_load_dwordx4 v[40:43], v1, s[8:11], s42 offen offset:1024 sc1
  buffer_load_dwordx4 v[44:47], v1, s[8:11], s42 offen offset:2048 sc1
  buffer_load_dwordx4 v[48:51], v1, s[8:11], s42 offen offset:3072 sc1
  v_lshlrev_b32 v109, 5, v109
  v_bfe_u32 v110, v108, 2, 1
  v_lshl_or_b32 v109, v110, 4, v109
  v_bfe_u32 v110, v108, 1, 1
  v_lshl_or_b32 v109, v110, 3, v109
  v_lshrrev_b32 v110, 8, v1
  v_lshl_or_b32 v108, v110, 6, v109
  s_sub_u32 s6, s49, 1
  s_and_b32 s7, s6, 1
  s_lshl_b32 s7, s7, 12
  s_add_u32 s51, s38, s7
  s_and_b32 s6, s6, 3
  s_lshl_b32 s6, s6, 19
  s_add_u32 s50, s35, s6
  s_mov_b32 s7, 0
L_rec_rr:
  buffer_load_dwordx4 v[52:55], v1, s[8:11], s41 offen offset:0 sc1
  buffer_load_dwordx4 v[56:59], v1, s[8:11], s41 offen offset:1024 sc1
  buffer_load_dwordx4 v[60:63], v1, s[8:11], s41 offen offset:2048 sc1
  buffer_load_dwordx4 v[64:67], v1, s[8:11], s41 offen offset:3072 sc1
  buffer_load_dwordx4 v[68:71], v1, s[8:11], s42 offen offset:0 sc1
  buffer_load_dwordx4 v[72:75], v1, s[8:11], s42 offen offset:1024 sc1
  buffer_load_dwordx4 v[76:79], v1, s[8:11], s42 offen offset:2048 sc1
  buffer_load_dwordx4 v[80:83], v1, s[8:11], s42 offen offset:3072 sc1
  s_waitcnt vmcnt(15)
  v_mfma_f32_16x16x32_bf16 v[124:127], v[20:23], v[120:123], 0
  s_waitcnt vmcnt(14)
  v_mfma_f32_16x16x32_bf16 v[124:127], v[24:27], v[120:123], v[124:127]
  v_bitop3_b32 v109, v20, v24, s33 bitop3:0x7e
  s_waitcnt vmcnt(13)
  v_mfma_f32_16x16x32_bf16 v[124:127], v[28:31], v[120:123], v[124:127]
  s_waitcnt vmcnt(12)
  v_mfma_f32_16x16x32_bf16 v[124:127], v[32:35], v[120:123], v[124:127]
  v_bitop3_b32 v110, v28, v32, s33 bitop3:0x7e
  s_waitcnt vmcnt(11)
  v_mfma_f32_16x16x32_bf16 v[124:127], v[36:39], v[120:123], v[124:127]
  s_waitcnt vmcnt(10)
  v_mfma_f32_16x16x32_bf16 v[124:127], v[40:43], v[120:123], v[124:127]
  v_bitop3_b32 v111, v36, v40, s33 bitop3:0x7e
  s_waitcnt vmcnt(9)
  v_mfma_f32_16x16x32_bf16 v[124:127], v[44:47], v[120:123], v[124:127]
  s_waitcnt vmcnt(8)
  v_mfma_f32_16x16x32_bf16 v[124:127], v[48:51], v[120:123], v[124:127]
  v_bitop3_b32 v112, v44, v48, s33 bitop3:0x7e
  v_or3_b32 v109, v109, v110, v111
  v_bitop3_b32 v109, v109, v112, 1 bitop3:0xa8
  v_cmp_ne_u32 vcc, 0, v109
  s_cbranch_vccz L_rec_red
  buffer_load_dwordx4 v[20:23], v1, s[8:11], s41 offen offset:0 sc1
  buffer_load_dwordx4 v[24:27], v1, s[8:11], s41 offen offset:1024 sc1
  buffer_load_dwordx4 v[28:31], v1, s[8:11], s41 offen offset:2048 sc1
  buffer_load_dwordx4 v[32:35], v1, s[8:11], s41 offen offset:3072 sc1
  buffer_load_dwordx4 v[36:39], v1, s[8:11], s42 offen offset:0 sc1
  buffer_load_dwordx4 v[40:43], v1, s[8:11], s42 offen offset:1024 sc1
  buffer_load_dwordx4 v[44:47], v1, s[8:11], s42 offen offset:2048 sc1
  buffer_load_dwordx4 v[48:51], v1, s[8:11], s42 offen offset:3072 sc1
  s_waitcnt vmcnt(15)
  v_mfma_f32_16x16x32_bf16 v[124:127], v[52:55], v[120:123], 0
  s_waitcnt vmcnt(14)
  v_mfma_f32_16x16x32_bf16 v[124:127], v[56:59], v[120:123], v[124:127]
  v_bitop3_b32 v109, v52, v56, s33 bitop3:0x7e
  s_waitcnt vmcnt(13)
  v_mfma_f32_16x16x32_bf16 v[124:127], v[60:63], v[120:123], v[124:127]
  s_waitcnt vmcnt(12)
  v_mfma_f32_16x16x32_bf16 v[124:127], v[64:67], v[120:123], v[124:127]
  v_bitop3_b32 v110, v60, v64, s33 bitop3:0x7e
  s_waitcnt vmcnt(11)
  v_mfma_f32_16x16x32_bf16 v[124:127], v[68:71], v[120:123], v[124:127]
  s_waitcnt vmcnt(10)
  v_mfma_f32_16x16x32_bf16 v[124:127], v[72:75], v[120:123], v[124:127]
  v_bitop3_b32 v111, v68, v72, s33 bitop3:0x7e
  s_waitcnt vmcnt(9)
  v_mfma_f32_16x16x32_bf16 v[124:127], v[76:79], v[120:123], v[124:127]
  s_waitcnt vmcnt(8)
  v_mfma_f32_16x16x32_bf16 v[124:127], v[80:83], v[120:123], v[124:127]
  v_bitop3_b32 v112, v76, v80, s33 bitop3:0x7e
  v_or3_b32 v109, v109, v110, v111
  v_bitop3_b32 v109, v109, v112, 1 bitop3:0xa8
  v_cmp_ne_u32 vcc, 0, v109
  s_cbranch_vccz L_rec_red
  s_and_b32 s6, s7, 31
  s_cmp_lg_u32 s6, 31
  s_cbranch_scc1 L_tf_22
  buffer_wbl2 sc1
  s_waitcnt vmcnt(0)
  buffer_inv sc1
  s_waitcnt vmcnt(0)
L_tf_22:
  s_add_u32 s7, s7, 1
  s_cmp_lt_u32 s7, 131072
  s_cbranch_scc1 L_rec_rr
  s_mov_b32 s6, 14
  s_branch L_err
L_rec_red:
  s_nop 2
  v_cvt_pk_bf16_f32 v124, v124, v125
  v_cvt_pk_bf16_f32 v125, v126, v127
  v_bfi_b32 v124, 1, s33, v124
  s_mov_b64 exec, s[54:55]
  buffer_store_dwordx2 v[124:125], v108, s[8:11], s43 offen
  s_mov_b64 exec, -1
  s_barrier
  s_branch L_rec_loop
L_rec_nored:
  s_sub_u32 s6, s49, 1
  s_and_b32 s7, s6, 1
  s_lshl_b32 s7, s7, 12
  s_add_u32 s51, s38, s7
  s_and_b32 s6, s6, 3
  s_lshl_b32 s6, s6, 19
  s_add_u32 s50, s35, s6
  s_barrier
  s_branch L_rec_loop
L_rec_kvwait:
  s_mov_b32 s7, 0
L_pl_23:
  buffer_load_dwordx4 v[120:123], v13, s[8:11], s51 offen offset:0 sc1
  s_waitcnt vmcnt(0)
  v_min_u32 v120, v120, v121
  v_min3_u32 v120, v120, v122, v123
  v_cmp_gt_u32 vcc, s49, v120
  s_cbranch_vccz L_plo_24
  s_add_u32 s7, s7, 1
  s_cmp_lt_u32 s7, 131072
  s_cbranch_scc1 L_pl_23
  s_mov_b32 s6, 13
  s_branch L_err
L_plo_24:
  s_branch L_rec_kvok
L_rec_last:
  buffer_wbl2 sc1
  s_waitcnt vmcnt(0)
  s_endpgm
L_p:
  s_sub_u32 s35, s4, 2
  s_lshr_b32 s35, s35, 1
  s_and_b32 s6, s4, 1
  s_lshl_b32 s6, s6, 4
  s_and_b32 s36, s5, 15
  s_add_u32 s36, s36, s6
  s_lshr_b32 s37, s5, 4
  s_mul_i32 s38, s35, 0x200000
  s_add_u32 s38, s38, 0x0
  s_mul_i32 s39, s35, 0x2000000
  s_add_u32 s39, s39, 0x800000
  s_mul_i32 s40, s35, 0x1000000
  s_add_u32 s40, s40, 0x4800000
  s_mul_i32 s41, s35, 0x1000000
  s_add_u32 s41, s41, 0x6800000
  s_mul_i32 s44, s35, 0x800
  s_add_u32 s44, s44, 0x710000
  s_lshl_b32 s6, s3, 13
  s_add_u32 s38, s38, s6
  s_add_u32 s53, s6, 0
  s_lshl_b32 s6, s36, 14
  s_lshl_b32 s7, s3, 11
  s_add_u32 s39, s39, s6
  s_add_u32 s39, s39, s7
  s_lshl_b32 s6, s36, 12
  s_lshl_b32 s7, s3, 10
  s_add_u32 s40, s40, s6
  s_add_u32 s40, s40, s7
  s_lshl_b32 s6, s36, 13
  s_lshr_b32 s7, s3, 1
  s_lshl_b32 s7, s7, 12
  s_add_u32 s41, s41, s6
  s_add_u32 s41, s41, s7
  s_lshl_b32 s6, s35, 13
  s_lshl_b32 s7, s37, 12
  s_add_u32 s6, s6, s7
  s_lshl_b32 s7, s36, 7
  s_add_u32 s6, s6, s7
  s_lshl_b32 s7, s3, 2
  s_add_u32 s6, s6, s7
  s_add_u32 s42, s6, 0x714000
  s_add_u32 s43, s6, 0x718000
  s_mov_b32 s34, 0x3e0293ee
  v_mov_b32 v12, 0
  v_mov_b32 v13, 0
  s_mov_b64 exec, 1
  buffer_store_dword v12, v12, s[8:11], s42 offen sc1
  buffer_store_dword v12, v12, s[8:11], s43 offen sc1
  s_mov_b64 exec, -1
  s_cmp_ge_u32 s4, 4
  s_cbranch_scc1 L_pro
L_p2:
  v_mov_b32 v12, 0
  v_mov_b32 v13, 0
  v_lshlrev_b32 v0, 4, v0
  s_mov_b32 s16, s82
  s_mov_b32 s17, s83
  s_mov_b32 s18, 0x400000
  s_mov_b32 s19, 0x20000
  s_mov_b32 s20, s84
  s_mov_b32 s21, s85
  s_mov_b32 s22, 0x400000
  s_mov_b32 s23, 0x20000
  s_mov_b32 s24, s86
  s_mov_b32 s25, s87
  s_mov_b32 s26, 0x400000
  s_mov_b32 s27, 0x20000
  v_lshrrev_b32 v104, 4, v0
  v_lshrrev_b32 v100, 8, v0
  v_lshlrev_b32 v105, 2, v100
  v_and_b32 v104, 15, v104
  v_xor_b32 v104, v104, v105
  v_mul_u32_u24 v100, 8192, v100
  v_lshl_add_u32 v100, v104, 4, v100
  v_bfe_u32 v104, v0, 6, 2
  v_lshlrev_b32 v105, 2, v104
  v_bfe_u32 v106, v0, 8, 1
  v_lshlrev_b32 v106, 1, v106
  v_bfe_u32 v107, v0, 5, 1
  v_or_b32 v106, v106, v107
  s_lshl_b32 s6, s3, 2
  v_or_b32 v106, s6, v106
  v_xor_b32 v106, v106, v105
  v_lshlrev_b32 v106, 4, v106
  v_bfe_u32 v107, v0, 4, 1
  v_lshl_or_b32 v106, v107, 3, v106
  v_bfe_u32 v107, v0, 9, 1
  v_lshl_or_b32 v104, v107, 3, v104
  v_lshl_or_b32 v104, v104, 8, v106
  v_add_u32 v105, 0x10000, v104
  s_lshl_b32 s60, s3, 13
  s_mul_i32 s63, s3, 262144
  s_lshl_b32 s61, s36, 8
  s_add_u32 s61, s61, 0
  s_add_u32 s61, s61, s63
  s_add_u32 m0, s60, 0
  s_add_u32 s62, s61, 0
  buffer_load_dwordx4 v100, s[16:19], s62 offen lds
  s_add_u32 m0, s60, 1024
  s_add_u32 s62, s61, 32768
  buffer_load_dwordx4 v100, s[16:19], s62 offen lds
  s_add_u32 m0, s60, 2048
  s_add_u32 s62, s61, 65536
  buffer_load_dwordx4 v100, s[16:19], s62 offen lds
  s_add_u32 m0, s60, 3072
  s_add_u32 s62, s61, 98304
  buffer_load_dwordx4 v100, s[16:19], s62 offen lds
  s_add_u32 m0, s60, 4096
  s_add_u32 s62, s61, 131072
  buffer_load_dwordx4 v100, s[16:19], s62 offen lds
  s_add_u32 m0, s60, 5120
  s_add_u32 s62, s61, 163840
  buffer_load_dwordx4 v100, s[16:19], s62 offen lds
  s_add_u32 m0, s60, 6144
  s_add_u32 s62, s61, 196608
  buffer_load_dwordx4 v100, s[16:19], s62 offen lds
  s_add_u32 m0, s60, 7168
  s_add_u32 s62, s61, 229376
  buffer_load_dwordx4 v100, s[16:19], s62 offen lds
  s_lshl_b32 s61, s36, 8
  s_add_u32 s61, s61, 1048576
  s_add_u32 s61, s61, s63
  s_add_u32 m0, s60, 32768
  s_add_u32 s62, s61, 0
  buffer_load_dwordx4 v100, s[16:19], s62 offen lds
  s_add_u32 m0, s60, 33792
  s_add_u32 s62, s61, 32768
  buffer_load_dwordx4 v100, s[16:19], s62 offen lds
  s_add_u32 m0, s60, 34816
  s_add_u32 s62, s61, 65536
  buffer_load_dwordx4 v100, s[16:19], s62 offen lds
  s_add_u32 m0, s60, 35840
  s_add_u32 s62, s61, 98304
  buffer_load_dwordx4 v100, s[16:19], s62 offen lds
  s_add_u32 m0, s60, 36864
  s_add_u32 s62, s61, 131072
  buffer_load_dwordx4 v100, s[16:19], s62 offen lds
  s_add_u32 m0, s60, 37888
  s_add_u32 s62, s61, 163840
  buffer_load_dwordx4 v100, s[16:19], s62 offen lds
  s_add_u32 m0, s60, 38912
  s_add_u32 s62, s61, 196608
  buffer_load_dwordx4 v100, s[16:19], s62 offen lds
  s_add_u32 m0, s60, 39936
  s_add_u32 s62, s61, 229376
  buffer_load_dwordx4 v100, s[16:19], s62 offen lds
  s_lshl_b32 s61, s36, 8
  s_add_u32 s61, s61, 2097152
  s_add_u32 s61, s61, s63
  s_add_u32 m0, s60, 65536
  s_add_u32 s62, s61, 0
  buffer_load_dwordx4 v100, s[16:19], s62 offen lds
  s_add_u32 m0, s60, 66560
  s_add_u32 s62, s61, 32768
  buffer_load_dwordx4 v100, s[16:19], s62 offen lds
  s_add_u32 m0, s60, 67584
  s_add_u32 s62, s61, 65536
  buffer_load_dwordx4 v100, s[16:19], s62 offen lds
  s_add_u32 m0, s60, 68608
  s_add_u32 s62, s61, 98304
  buffer_load_dwordx4 v100, s[16:19], s62 offen lds
  s_add_u32 m0, s60, 69632
  s_add_u32 s62, s61, 131072
  buffer_load_dwordx4 v100, s[16:19], s62 offen lds
  s_add_u32 m0, s60, 70656
  s_add_u32 s62, s61, 163840
  buffer_load_dwordx4 v100, s[16:19], s62 offen lds
  s_add_u32 m0, s60, 71680
  s_add_u32 s62, s61, 196608
  buffer_load_dwordx4 v100, s[16:19], s62 offen lds
  s_add_u32 m0, s60, 72704
  s_add_u32 s62, s61, 229376
  buffer_load_dwordx4 v100, s[16:19], s62 offen lds
  s_lshr_b32 s6, 0x72, s4
  s_bitcmp1_b32 s6, 0
  s_cbranch_scc1 L_rdn_25
  s_waitcnt vmcnt(24)
  s_barrier
  s_cmp_lg_u32 s3, 0
  s_cbranch_scc1 L_sd_26
  s_mov_b64 exec, 1
  v_mov_b32 v18, 128
  v_mov_b32 v19, 1
  buffer_atomic_add v19, v18, s[12:15], 0 offen sc1
  s_mov_b64 exec, -1
L_sd_26:
L_rdn_25:
  s_waitcnt vmcnt(16)
  s_barrier
  s_lshl_b32 s61, s36, 8
  s_add_u32 s61, s61, 3145728
  s_add_u32 s61, s61, s63
  s_add_u32 m0, s60, 98304
  s_add_u32 s62, s61, 0
  buffer_load_dwordx4 v100, s[16:19], s62 offen lds
  s_add_u32 m0, s60, 99328
  s_add_u32 s62, s61, 32768
  buffer_load_dwordx4 v100, s[16:19], s62 offen lds
  s_add_u32 m0, s60, 100352
  s_add_u32 s62, s61, 65536
  buffer_load_dwordx4 v100, s[16:19], s62 offen lds
  s_add_u32 m0, s60, 101376
  s_add_u32 s62, s61, 98304
  buffer_load_dwordx4 v100, s[16:19], s62 offen lds
  s_add_u32 m0, s60, 102400
  s_add_u32 s62, s61, 131072
  buffer_load_dwordx4 v100, s[16:19], s62 offen lds
  s_add_u32 m0, s60, 103424
  s_add_u32 s62, s61, 163840
  buffer_load_dwordx4 v100, s[16:19], s62 offen lds
  s_add_u32 m0, s60, 104448
  s_add_u32 s62, s61, 196608
  buffer_load_dwordx4 v100, s[16:19], s62 offen lds
  s_add_u32 m0, s60, 105472
  s_add_u32 s62, s61, 229376
  buffer_load_dwordx4 v100, s[16:19], s62 offen lds
  ds_read_b64_tr_b16 a[0:1], v104 offset:0
  ds_read_b64_tr_b16 a[2:3], v104 offset:1024
  ds_read_b64_tr_b16 a[4:5], v104 offset:4096
  ds_read_b64_tr_b16 a[6:7], v104 offset:5120
  ds_read_b64_tr_b16 a[8:9], v104 offset:8192
  ds_read_b64_tr_b16 a[10:11], v104 offset:9216
  ds_read_b64_tr_b16 a[12:13], v104 offset:12288
  ds_read_b64_tr_b16 a[14:15], v104 offset:13312
  ds_read_b64_tr_b16 a[16:17], v104 offset:16384
  ds_read_b64_tr_b16 a[18:19], v104 offset:17408
  ds_read_b64_tr_b16 a[20:21], v104 offset:20480
  ds_read_b64_tr_b16 a[22:23], v104 offset:21504
  ds_read_b64_tr_b16 a[24:25], v104 offset:24576
  ds_read_b64_tr_b16 a[26:27], v104 offset:25600
  ds_read_b64_tr_b16 a[28:29], v104 offset:28672
  ds_read_b64_tr_b16 a[30:31], v104 offset:29696
  s_waitcnt lgkmcnt(0)
  s_waitcnt vmcnt(16)
  s_barrier
  s_lshl_b32 s61, s36, 8
  s_add_u32 s61, s61, 0
  s_add_u32 s61, s61, s63
  s_add_u32 m0, s60, 0
  s_add_u32 s62, s61, 0
  buffer_load_dwordx4 v100, s[20:23], s62 offen lds
  s_add_u32 m0, s60, 1024
  s_add_u32 s62, s61, 32768
  buffer_load_dwordx4 v100, s[20:23], s62 offen lds
  s_add_u32 m0, s60, 2048
  s_add_u32 s62, s61, 65536
  buffer_load_dwordx4 v100, s[20:23], s62 offen lds
  s_add_u32 m0, s60, 3072
  s_add_u32 s62, s61, 98304
  buffer_load_dwordx4 v100, s[20:23], s62 offen lds
  s_add_u32 m0, s60, 4096
  s_add_u32 s62, s61, 131072
  buffer_load_dwordx4 v100, s[20:23], s62 offen lds
  s_add_u32 m0, s60, 5120
  s_add_u32 s62, s61, 163840
  buffer_load_dwordx4 v100, s[20:23], s62 offen lds
  s_add_u32 m0, s60, 6144
  s_add_u32 s62, s61, 196608
  buffer_load_dwordx4 v100, s[20:23], s62 offen lds
  s_add_u32 m0, s60, 7168
  s_add_u32 s62, s61, 229376
  buffer_load_dwordx4 v100, s[20:23], s62 offen lds
  ds_read_b64_tr_b16 a[32:33], v104 offset:32768
  ds_read_b64_tr_b16 a[34:35], v104 offset:33792
  ds_read_b64_tr_b16 a[36:37], v104 offset:36864
  ds_read_b64_tr_b16 a[38:39], v104 offset:37888
  ds_read_b64_tr_b16 a[40:41], v104 offset:40960
  ds_read_b64_tr_b16 a[42:43], v104 offset:41984
  ds_read_b64_tr_b16 a[44:45], v104 offset:45056
  ds_read_b64_tr_b16 a[46:47], v104 offset:46080
  ds_read_b64_tr_b16 a[48:49], v104 offset:49152
  ds_read_b64_tr_b16 a[50:51], v104 offset:50176
  ds_read_b64_tr_b16 a[52:53], v104 offset:53248
  ds_read_b64_tr_b16 a[54:55], v104 offset:54272
  ds_read_b64_tr_b16 a[56:57], v104 offset:57344
  ds_read_b64_tr_b16 a[58:59], v104 offset:58368
  ds_read_b64_tr_b16 a[60:61], v104 offset:61440
  ds_read_b64_tr_b16 a[62:63], v104 offset:62464
  s_waitcnt lgkmcnt(0)
  s_waitcnt vmcnt(16)
  s_barrier
  s_lshl_b32 s61, s36, 8
  s_add_u32 s61, s61, 1048576
  s_add_u32 s61, s61, s63
  s_add_u32 m0, s60, 32768
  s_add_u32 s62, s61, 0
  buffer_load_dwordx4 v100, s[20:23], s62 offen lds
  s_add_u32 m0, s60, 33792
  s_add_u32 s62, s61, 32768
  buffer_load_dwordx4 v100, s[20:23], s62 offen lds
  s_add_u32 m0, s60, 34816
  s_add_u32 s62, s61, 65536
  buffer_load_dwordx4 v100, s[20:23], s62 offen lds
  s_add_u32 m0, s60, 35840
  s_add_u32 s62, s61, 98304
  buffer_load_dwordx4 v100, s[20:23], s62 offen lds
  s_add_u32 m0, s60, 36864
  s_add_u32 s62, s61, 131072
  buffer_load_dwordx4 v100, s[20:23], s62 offen lds
  s_add_u32 m0, s60, 37888
  s_add_u32 s62, s61, 163840
  buffer_load_dwordx4 v100, s[20:23], s62 offen lds
  s_add_u32 m0, s60, 38912
  s_add_u32 s62, s61, 196608
  buffer_load_dwordx4 v100, s[20:23], s62 offen lds
  s_add_u32 m0, s60, 39936
  s_add_u32 s62, s61, 229376
  buffer_load_dwordx4 v100, s[20:23], s62 offen lds
  ds_read_b64_tr_b16 a[64:65], v105 offset:0
  ds_read_b64_tr_b16 a[66:67], v105 offset:1024
  ds_read_b64_tr_b16 a[68:69], v105 offset:4096
  ds_read_b64_tr_b16 a[70:71], v105 offset:5120
  ds_read_b64_tr_b16 a[72:73], v105 offset:8192
  ds_read_b64_tr_b16 a[74:75], v105 offset:9216
  ds_read_b64_tr_b16 a[76:77], v105 offset:12288
  ds_read_b64_tr_b16 a[78:79], v105 offset:13312
  ds_read_b64_tr_b16 a[80:81], v105 offset:16384
  ds_read_b64_tr_b16 a[82:83], v105 offset:17408
  ds_read_b64_tr_b16 a[84:85], v105 offset:20480
  ds_read_b64_tr_b16 a[86:87], v105 offset:21504
  ds_read_b64_tr_b16 a[88:89], v105 offset:24576
  ds_read_b64_tr_b16 a[90:91], v105 offset:25600
  ds_read_b64_tr_b16 a[92:93], v105 offset:28672
  ds_read_b64_tr_b16 a[94:95], v105 offset:29696
  s_waitcnt lgkmcnt(0)
  s_waitcnt vmcnt(16)
  s_barrier
  s_lshl_b32 s61, s36, 8
  s_add_u32 s61, s61, 2097152
  s_add_u32 s61, s61, s63
  s_add_u32 m0, s60, 65536
  s_add_u32 s62, s61, 0
  buffer_load_dwordx4 v100, s[20:23], s62 offen lds
  s_add_u32 m0, s60, 66560
  s_add_u32 s62, s61, 32768
  buffer_load_dwordx4 v100, s[20:23], s62 offen lds
  s_add_u32 m0, s60, 67584
  s_add_u32 s62, s61, 65536
  buffer_load_dwordx4 v100, s[20:23], s62 offen lds
  s_add_u32 m0, s60, 68608
  s_add_u32 s62, s61, 98304
  buffer_load_dwordx4 v100, s[20:23], s62 offen lds
  s_add_u32 m0, s60, 69632
  s_add_u32 s62, s61, 131072
  buffer_load_dwordx4 v100, s[20:23], s62 offen lds
  s_add_u32 m0, s60, 70656
  s_add_u32 s62, s61, 163840
  buffer_load_dwordx4 v100, s[20:23], s62 offen lds
  s_add_u32 m0, s60, 71680
  s_add_u32 s62, s61, 196608
  buffer_load_dwordx4 v100, s[20:23], s62 offen lds
  s_add_u32 m0, s60, 72704
  s_add_u32 s62, s61, 229376
  buffer_load_dwordx4 v100, s[20:23], s62 offen lds
  ds_read_b64_tr_b16 a[96:97], v105 offset:32768
  ds_read_b64_tr_b16 a[98:99], v105 offset:33792
  ds_read_b64_tr_b16 a[100:101], v105 offset:36864
  ds_read_b64_tr_b16 a[102:103], v105 offset:37888
  ds_read_b64_tr_b16 a[104:105], v105 offset:40960
  ds_read_b64_tr_b16 a[106:107], v105 offset:41984
  ds_read_b64_tr_b16 a[108:109], v105 offset:45056
  ds_read_b64_tr_b16 a[110:111], v105 offset:46080
  ds_read_b64_tr_b16 a[112:113], v105 offset:49152
  ds_read_b64_tr_b16 a[114:115], v105 offset:50176
  ds_read_b64_tr_b16 a[116:117], v105 offset:53248
  ds_read_b64_tr_b16 a[118:119], v105 offset:54272
  ds_read_b64_tr_b16 a[120:121], v105 offset:57344
  ds_read_b64_tr_b16 a[122:123], v105 offset:58368
  ds_read_b64_tr_b16 a[124:125], v105 offset:61440
  ds_read_b64_tr_b16 a[126:127], v105 offset:62464
  s_waitcnt lgkmcnt(0)
  s_waitcnt vmcnt(16)
  s_barrier
  s_lshl_b32 s61, s36, 8
  s_add_u32 s61, s61, 3145728
  s_add_u32 s61, s61, s63
  s_add_u32 m0, s60, 98304
  s_add_u32 s62, s61, 0
  buffer_load_dwordx4 v100, s[20:23], s62 offen lds
  s_add_u32 m0, s60, 99328
  s_add_u32 s62, s61, 32768
  buffer_load_dwordx4 v100, s[20:23], s62 offen lds
  s_add_u32 m0, s60, 100352
  s_add_u32 s62, s61, 65536
  buffer_load_dwordx4 v100, s[20:23], s62 offen lds
  s_add_u32 m0, s60, 101376
  s_add_u32 s62, s61, 98304
  buffer_load_dwordx4 v100, s[20:23], s62 offen lds
  s_add_u32 m0, s60, 102400
  s_add_u32 s62, s61, 131072
  buffer_load_dwordx4 v100, s[20:23], s62 offen lds
  s_add_u32 m0, s60, 103424
  s_add_u32 s62, s61, 163840
  buffer_load_dwordx4 v100, s[20:23], s62 offen lds
  s_add_u32 m0, s60, 104448
  s_add_u32 s62, s61, 196608
  buffer_load_dwordx4 v100, s[20:23], s62 offen lds
  s_add_u32 m0, s60, 105472
  s_add_u32 s62, s61, 229376
  buffer_load_dwordx4 v100, s[20:23], s62 offen lds
  ds_read_b64_tr_b16 a[128:129], v104 offset:0
  ds_read_b64_tr_b16 a[130:131], v104 offset:1024
  ds_read_b64_tr_b16 a[132:133], v104 offset:4096
  ds_read_b64_tr_b16 a[134:135], v104 offset:5120
  ds_read_b64_tr_b16 a[136:137], v104 offset:8192
  ds_read_b64_tr_b16 a[138:139], v104 offset:9216
  ds_read_b64_tr_b16 a[140:141], v104 offset:12288
  ds_read_b64_tr_b16 a[142:143], v104 offset:13312
  ds_read_b64_tr_b16 a[144:145], v104 offset:16384
  ds_read_b64_tr_b16 a[146:147], v104 offset:17408
  ds_read_b64_tr_b16 a[148:149], v104 offset:20480
  ds_read_b64_tr_b16 a[150:151], v104 offset:21504
  ds_read_b64_tr_b16 a[152:153], v104 offset:24576
  ds_read_b64_tr_b16 a[154:155], v104 offset:25600
  ds_read_b64_tr_b16 a[156:157], v104 offset:28672
  ds_read_b64_tr_b16 a[158:159], v104 offset:29696
  s_waitcnt lgkmcnt(0)
  s_waitcnt vmcnt(16)
  s_barrier
  s_lshl_b32 s61, s36, 8
  s_add_u32 s61, s61, 0
  s_add_u32 s61, s61, s63
  s_add_u32 m0, s60, 0
  s_add_u32 s62, s61, 0
  buffer_load_dwordx4 v100, s[24:27], s62 offen lds
  s_add_u32 m0, s60, 1024
  s_add_u32 s62, s61, 32768
  buffer_load_dwordx4 v100, s[24:27], s62 offen lds
  s_add_u32 m0, s60, 2048
  s_add_u32 s62, s61, 65536
  buffer_load_dwordx4 v100, s[24:27], s62 offen lds
  s_add_u32 m0, s60, 3072
  s_add_u32 s62, s61, 98304
  buffer_load_dwordx4 v100, s[24:27], s62 offen lds
  s_add_u32 m0, s60, 4096
  s_add_u32 s62, s61, 131072
  buffer_load_dwordx4 v100, s[24:27], s62 offen lds
  s_add_u32 m0, s60, 5120
  s_add_u32 s62, s61, 163840
  buffer_load_dwordx4 v100, s[24:27], s62 offen lds
  s_add_u32 m0, s60, 6144
  s_add_u32 s62, s61, 196608
  buffer_load_dwordx4 v100, s[24:27], s62 offen lds
  s_add_u32 m0, s60, 7168
  s_add_u32 s62, s61, 229376
  buffer_load_dwordx4 v100, s[24:27], s62 offen lds
  ds_read_b64_tr_b16 a[160:161], v104 offset:32768
  ds_read_b64_tr_b16 a[162:163], v104 offset:33792
  ds_read_b64_tr_b16 a[164:165], v104 offset:36864
  ds_read_b64_tr_b16 a[166:167], v104 offset:37888
  ds_read_b64_tr_b16 a[168:169], v104 offset:40960
  ds_read_b64_tr_b16 a[170:171], v104 offset:41984
  ds_read_b64_tr_b16 a[172:173], v104 offset:45056
  ds_read_b64_tr_b16 a[174:175], v104 offset:46080
  ds_read_b64_tr_b16 a[176:177], v104 offset:49152
  ds_read_b64_tr_b16 a[178:179], v104 offset:50176
  ds_read_b64_tr_b16 a[180:181], v104 offset:53248
  ds_read_b64_tr_b16 a[182:183], v104 offset:54272
  ds_read_b64_tr_b16 a[184:185], v104 offset:57344
  ds_read_b64_tr_b16 a[186:187], v104 offset:58368
  ds_read_b64_tr_b16 a[188:189], v104 offset:61440
  ds_read_b64_tr_b16 a[190:191], v104 offset:62464
  s_waitcnt lgkmcnt(0)
  s_waitcnt vmcnt(16)
  s_barrier
  s_lshl_b32 s61, s36, 8
  s_add_u32 s61, s61, 1048576
  s_add_u32 s61, s61, s63
  s_add_u32 m0, s60, 32768
  s_add_u32 s62, s61, 0
  buffer_load_dwordx4 v100, s[24:27], s62 offen lds
  s_add_u32 m0, s60, 33792
  s_add_u32 s62, s61, 32768
  buffer_load_dwordx4 v100, s[24:27], s62 offen lds
  s_add_u32 m0, s60, 34816
  s_add_u32 s62, s61, 65536
  buffer_load_dwordx4 v100, s[24:27], s62 offen lds
  s_add_u32 m0, s60, 35840
  s_add_u32 s62, s61, 98304
  buffer_load_dwordx4 v100, s[24:27], s62 offen lds
  s_add_u32 m0, s60, 36864
  s_add_u32 s62, s61, 131072
  buffer_load_dwordx4 v100, s[24:27], s62 offen lds
  s_add_u32 m0, s60, 37888
  s_add_u32 s62, s61, 163840
  buffer_load_dwordx4 v100, s[24:27], s62 offen lds
  s_add_u32 m0, s60, 38912
  s_add_u32 s62, s61, 196608
  buffer_load_dwordx4 v100, s[24:27], s62 offen lds
  s_add_u32 m0, s60, 39936
  s_add_u32 s62, s61, 229376
  buffer_load_dwordx4 v100, s[24:27], s62 offen lds
  ds_read_b64_tr_b16 a[192:193], v105 offset:0
  ds_read_b64_tr_b16 a[194:195], v105 offset:1024
  ds_read_b64_tr_b16 a[196:197], v105 offset:4096
  ds_read_b64_tr_b16 a[198:199], v105 offset:5120
  ds_read_b64_tr_b16 a[200:201], v105 offset:8192
  ds_read_b64_tr_b16 a[202:203], v105 offset:9216
  ds_read_b64_tr_b16 a[204:205], v105 offset:12288
  ds_read_b64_tr_b16 a[206:207], v105 offset:13312
  ds_read_b64_tr_b16 a[208:209], v105 offset:16384
  ds_read_b64_tr_b16 a[210:211], v105 offset:17408
  ds_read_b64_tr_b16 a[212:213], v105 offset:20480
  ds_read_b64_tr_b16 a[214:215], v105 offset:21504
  ds_read_b64_tr_b16 a[216:217], v105 offset:24576
  ds_read_b64_tr_b16 a[218:219], v105 offset:25600
  ds_read_b64_tr_b16 a[220:221], v105 offset:28672
  ds_read_b64_tr_b16 a[222:223], v105 offset:29696
  s_waitcnt lgkmcnt(0)
  s_waitcnt vmcnt(16)
  s_barrier
  s_lshl_b32 s61, s36, 8
  s_add_u32 s61, s61, 2097152
  s_add_u32 s61, s61, s63
  s_add_u32 m0, s60, 65536
  s_add_u32 s62, s61, 0
  buffer_load_dwordx4 v100, s[24:27], s62 offen lds
  s_add_u32 m0, s60, 66560
  s_add_u32 s62, s61, 32768
  buffer_load_dwordx4 v100, s[24:27], s62 offen lds
  s_add_u32 m0, s60, 67584
  s_add_u32 s62, s61, 65536
  buffer_load_dwordx4 v100, s[24:27], s62 offen lds
  s_add_u32 m0, s60, 68608
  s_add_u32 s62, s61, 98304
  buffer_load_dwordx4 v100, s[24:27], s62 offen lds
  s_add_u32 m0, s60, 69632
  s_add_u32 s62, s61, 131072
  buffer_load_dwordx4 v100, s[24:27], s62 offen lds
  s_add_u32 m0, s60, 70656
  s_add_u32 s62, s61, 163840
  buffer_load_dwordx4 v100, s[24:27], s62 offen lds
  s_add_u32 m0, s60, 71680
  s_add_u32 s62, s61, 196608
  buffer_load_dwordx4 v100, s[24:27], s62 offen lds
  s_add_u32 m0, s60, 72704
  s_add_u32 s62, s61, 229376
  buffer_load_dwordx4 v100, s[24:27], s62 offen lds
  ds_read_b64_tr_b16 a[224:225], v105 offset:32768
  ds_read_b64_tr_b16 a[226:227], v105 offset:33792
  ds_read_b64_tr_b16 a[228:229], v105 offset:36864
  ds_read_b64_tr_b16 a[230:231], v105 offset:37888
  ds_read_b64_tr_b16 a[232:233], v105 offset:40960
  ds_read_b64_tr_b16 a[234:235], v105 offset:41984
  ds_read_b64_tr_b16 a[236:237], v105 offset:45056
  ds_read_b64_tr_b16 a[238:239], v105 offset:46080
  ds_read_b64_tr_b16 a[240:241], v105 offset:49152
  ds_read_b64_tr_b16 a[242:243], v105 offset:50176
  ds_read_b64_tr_b16 a[244:245], v105 offset:53248
  ds_read_b64_tr_b16 a[246:247], v105 offset:54272
  ds_read_b64_tr_b16 a[248:249], v105 offset:57344
  ds_read_b64_tr_b16 a[250:251], v105 offset:58368
  ds_read_b64_tr_b16 a[252:253], v105 offset:61440
  ds_read_b64_tr_b16 a[254:255], v105 offset:62464
  s_waitcnt lgkmcnt(0)
  s_waitcnt vmcnt(16)
  s_barrier
  s_lshl_b32 s61, s36, 8
  s_add_u32 s61, s61, 3145728
  s_add_u32 s61, s61, s63
  s_add_u32 m0, s60, 98304
  s_add_u32 s62, s61, 0
  buffer_load_dwordx4 v100, s[24:27], s62 offen lds
  s_add_u32 m0, s60, 99328
  s_add_u32 s62, s61, 32768
  buffer_load_dwordx4 v100, s[24:27], s62 offen lds
  s_add_u32 m0, s60, 100352
  s_add_u32 s62, s61, 65536
  buffer_load_dwordx4 v100, s[24:27], s62 offen lds
  s_add_u32 m0, s60, 101376
  s_add_u32 s62, s61, 98304
  buffer_load_dwordx4 v100, s[24:27], s62 offen lds
  s_add_u32 m0, s60, 102400
  s_add_u32 s62, s61, 131072
  buffer_load_dwordx4 v100, s[24:27], s62 offen lds
  s_add_u32 m0, s60, 103424
  s_add_u32 s62, s61, 163840
  buffer_load_dwordx4 v100, s[24:27], s62 offen lds
  s_add_u32 m0, s60, 104448
  s_add_u32 s62, s61, 196608
  buffer_load_dwordx4 v100, s[24:27], s62 offen lds
  s_add_u32 m0, s60, 105472
  s_add_u32 s62, s61, 229376
  buffer_load_dwordx4 v100, s[24:27], s62 offen lds
  ds_read_b64_tr_b16 v[128:129], v104 offset:0
  ds_read_b64_tr_b16 v[130:131], v104 offset:1024
  ds_read_b64_tr_b16 v[132:133], v104 offset:4096
  ds_read_b64_tr_b16 v[134:135], v104 offset:5120
  ds_read_b64_tr_b16 v[136:137], v104 offset:8192
  ds_read_b64_tr_b16 v[138:139], v104 offset:9216
  ds_read_b64_tr_b16 v[140:141], v104 offset:12288
  ds_read_b64_tr_b16 v[142:143], v104 offset:13312
  ds_read_b64_tr_b16 v[144:145], v104 offset:16384
  ds_read_b64_tr_b16 v[146:147], v104 offset:17408
  ds_read_b64_tr_b16 v[148:149], v104 offset:20480
  ds_read_b64_tr_b16 v[150:151], v104 offset:21504
  ds_read_b64_tr_b16 v[152:153], v104 offset:24576
  ds_read_b64_tr_b16 v[154:155], v104 offset:25600
  ds_read_b64_tr_b16 v[156:157], v104 offset:28672
  ds_read_b64_tr_b16 v[158:159], v104 offset:29696
  s_waitcnt lgkmcnt(0)
  s_waitcnt vmcnt(16)
  s_barrier
  ds_read_b64_tr_b16 v[160:161], v104 offset:32768
  ds_read_b64_tr_b16 v[162:163], v104 offset:33792
  ds_read_b64_tr_b16 v[164:165], v104 offset:36864
  ds_read_b64_tr_b16 v[166:167], v104 offset:37888
  ds_read_b64_tr_b16 v[168:169], v104 offset:40960
  ds_read_b64_tr_b16 v[170:171], v104 offset:41984
  ds_read_b64_tr_b16 v[172:173], v104 offset:45056
  ds_read_b64_tr_b16 v[174:175], v104 offset:46080
  ds_read_b64_tr_b16 v[176:177], v104 offset:49152
  ds_read_b64_tr_b16 v[178:179], v104 offset:50176
  ds_read_b64_tr_b16 v[180:181], v104 offset:53248
  ds_read_b64_tr_b16 v[182:183], v104 offset:54272
  ds_read_b64_tr_b16 v[184:185], v104 offset:57344
  ds_read_b64_tr_b16 v[186:187], v104 offset:58368
  ds_read_b64_tr_b16 v[188:189], v104 offset:61440
  ds_read_b64_tr_b16 v[190:191], v104 offset:62464
  s_waitcnt lgkmcnt(0)
  s_waitcnt vmcnt(8)
  s_barrier
  ds_read_b64_tr_b16 v[192:193], v105 offset:0
  ds_read_b64_tr_b16 v[194:195], v105 offset:1024
  ds_read_b64_tr_b16 v[196:197], v105 offset:4096
  ds_read_b64_tr_b16 v[198:199], v105 offset:5120
  ds_read_b64_tr_b16 v[200:201], v105 offset:8192
  ds_read_b64_tr_b16 v[202:203], v105 offset:9216
  ds_read_b64_tr_b16 v[204:205], v105 offset:12288
  ds_read_b64_tr_b16 v[206:207], v105 offset:13312
  ds_read_b64_tr_b16 v[208:209], v105 offset:16384
  ds_read_b64_tr_b16 v[210:211], v105 offset:17408
  ds_read_b64_tr_b16 v[212:213], v105 offset:20480
  ds_read_b64_tr_b16 v[214:215], v105 offset:21504
  ds_read_b64_tr_b16 v[216:217], v105 offset:24576
  ds_read_b64_tr_b16 v[218:219], v105 offset:25600
  ds_read_b64_tr_b16 v[220:221], v105 offset:28672
  ds_read_b64_tr_b16 v[222:223], v105 offset:29696
  s_waitcnt lgkmcnt(0)
  s_waitcnt vmcnt(0)
  s_barrier
  ds_read_b64_tr_b16 v[224:225], v105 offset:32768
  ds_read_b64_tr_b16 v[226:227], v105 offset:33792
  ds_read_b64_tr_b16 v[228:229], v105 offset:36864
  ds_read_b64_tr_b16 v[230:231], v105 offset:37888
  ds_read_b64_tr_b16 v[232:233], v105 offset:40960
  ds_read_b64_tr_b16 v[234:235], v105 offset:41984
  ds_read_b64_tr_b16 v[236:237], v105 offset:45056
  ds_read_b64_tr_b16 v[238:239], v105 offset:46080
  ds_read_b64_tr_b16 v[240:241], v105 offset:49152
  ds_read_b64_tr_b16 v[242:243], v105 offset:50176
  ds_read_b64_tr_b16 v[244:245], v105 offset:53248
  ds_read_b64_tr_b16 v[246:247], v105 offset:54272
  ds_read_b64_tr_b16 v[248:249], v105 offset:57344
  ds_read_b64_tr_b16 v[250:251], v105 offset:58368
  ds_read_b64_tr_b16 v[252:253], v105 offset:61440
  ds_read_b64_tr_b16 v[254:255], v105 offset:62464
  s_waitcnt lgkmcnt(0)
  s_barrier
  v_bfe_u32 v16, v0, 4, 4
  v_lshrrev_b32 v17, 8, v0
  v_lshrrev_b32 v114, 2, v0
  v_bfe_u32 v18, v0, 6, 2
  v_lshrrev_b32 v19, 9, v0
  v_lshl_or_b32 v18, v19, 3, v18
  v_lshlrev_b32 v18, 6, v18
  v_and_b32 v20, 1, v17
  v_lshl_or_b32 v18, v20, 5, v18
  v_and_b32 v20, 3, v16
  v_lshl_or_b32 v1, v20, 3, v18
  v_and_b32 v18, 7, v16
  v_lshrrev_b32 v20, 3, v16
  v_lshl_or_b32 v18, v20, 4, v18
  v_lshlrev_b32 v18, 4, v18
  v_lshl_add_u32 v18, v17, 9, v18
  v_add_u32 v2, 73728, v18
  s_and_b32 s6, s3, 1
  s_lshl_b32 s6, s6, 8
  v_lshlrev_b32 v18, 4, v16
  v_lshl_or_b32 v18, v17, 9, v18
  v_add_u32 v113, s6, v18
  v_add_u32 v3, 65536, v113
  s_lshr_b32 s7, s3, 1
  s_lshl_b32 s6, s7, 12
  s_add_u32 s6, s6, 81920
  v_add_u32 v4, s6, v18
  s_lshl_b32 s6, s3, 11
  s_add_u32 s6, s6, 32768
  v_add_u32 v112, s6, v0
  v_mul_u32_u24 v18, 1088, v17
  v_lshl_add_u32 v18, v16, 3, v18
  s_lshl_b32 s6, s3, 8
  s_add_u32 s6, s6, 57344
  v_add_u32 v5, s6, v18
  s_lshl_b32 s6, s7, 9
  s_add_u32 s6, s6, 57344
  v_add_u32 v7, s6, v18
  v_and_b32 v18, 3, v16
  v_mul_u32_u24 v18, 1088, v18
  v_bfe_u32 v20, v0, 6, 3
  v_lshl_add_u32 v18, v20, 3, v18
  v_lshl_add_u32 v18, v19, 7, v18
  v_add_u32 v6, 57344, v18
  s_lshl_b32 s6, s3, 7
  s_add_u32 s6, s6, 61952
  v_lshlrev_b32 v18, 4, v19
  v_add_u32 v8, s6, v18
  v_and_b32 v18, 0x7c, v114
  v_add_u32 v9, s6, v18
  v_lshlrev_b32 v18, 1, v18
  v_add_u32 v15, 62464, v18
  s_lshl_b32 s6, s3, 13
  v_add_u32 v14, s6, v1
  v_mov_b32 v10, 0x3f803f80
  v_mov_b32 v11, 0x3f803f80
  s_and_b32 s6, s3, 1
  s_lshl_b32 s6, s6, 4
  v_add_u32 v16, s6, v16
  v_lshlrev_b32 v18, 4, v19
  v_and_b32 v20, 1, v17
  v_lshl_or_b32 v18, v20, 2, v18
  v_sub_u32 v16, v16, v18
  v_mov_b32 v17, 0xf149f2ca
  v_cmp_gt_i32 vcc, 0, v16
  s_nop 1
  v_cndmask_b32 v24, 0, v17, vcc
  v_cmp_gt_i32 vcc, 1, v16
  s_nop 1
  v_cndmask_b32 v25, 0, v17, vcc
  v_cmp_gt_i32 vcc, 2, v16
  s_nop 1
  v_cndmask_b32 v26, 0, v17, vcc
  v_cmp_gt_i32 vcc, 3, v16
  s_nop 1
  v_cndmask_b32 v27, 0, v17, vcc
  v_cmp_gt_i32 vcc, 8, v16
  s_nop 1
  v_cndmask_b32 v28, 0, v17, vcc
  v_cmp_gt_i32 vcc, 9, v16
  s_nop 1
  v_cndmask_b32 v29, 0, v17, vcc
  v_cmp_gt_i32 vcc, 10, v16
  s_nop 1
  v_cndmask_b32 v30, 0, v17, vcc
  v_cmp_gt_i32 vcc, 11, v16
  s_nop 1
  v_cndmask_b32 v31, 0, v17, vcc
  v_mov_b32 v80, 0x3f803f80
  v_mov_b32 v81, 0x3f803f80
  v_mov_b32 v82, 0x3f803f80
  v_mov_b32 v83, 0x3f803f80
  s_nop 1
  v_mfma_f32_32x32x16_bf16 v[32:47], v[80:83], a[0:3], 0
  v_mfma_f32_32x32x16_bf16 v[48:63], v[80:83], a[128:131], 0
  v_mfma_f32_32x32x16_bf16 v[64:79], v[80:83], v[128:131], 0
  v_mfma_f32_32x32x16_bf16 v[32:47], v[80:83], a[4:7], v[32:47]
  v_mfma_f32_32x32x16_bf16 v[48:63], v[80:83], a[132:135], v[48:63]
  v_mfma_f32_32x32x16_bf16 v[64:79], v[80:83], v[132:135], v[64:79]
  v_mfma_f32_32x32x16_bf16 v[32:47], v[80:83], a[8:11], v[32:47]
  v_mfma_f32_32x32x16_bf16 v[48:63], v[80:83], a[136:139], v[48:63]
  v_mfma_f32_32x32x16_bf16 v[64:79], v[80:83], v[136:139], v[64:79]
  v_mfma_f32_32x32x16_bf16 v[32:47], v[80:83], a[12:15], v[32:47]
  v_mfma_f32_32x32x16_bf16 v[48:63], v[80:83], a[140:143], v[48:63]
  v_mfma_f32_32x32x16_bf16 v[64:79], v[80:83], v[140:143], v[64:79]
  v_mfma_f32_32x32x16_bf16 v[32:47], v[80:83], a[16:19], v[32:47]
  v_mfma_f32_32x32x16_bf16 v[48:63], v[80:83], a[144:147], v[48:63]
  v_mfma_f32_32x32x16_bf16 v[64:79], v[80:83], v[144:147], v[64:79]
  v_mfma_f32_32x32x16_bf16 v[32:47], v[80:83], a[20:23], v[32:47]
  v_mfma_f32_32x32x16_bf16 v[48:63], v[80:83], a[148:151], v[48:63]
  v_mfma_f32_32x32x16_bf16 v[64:79], v[80:83], v[148:151], v[64:79]
  v_mfma_f32_32x32x16_bf16 v[32:47], v[80:83], a[24:27], v[32:47]
  v_mfma_f32_32x32x16_bf16 v[48:63], v[80:83], a[152:155], v[48:63]
  v_mfma_f32_32x32x16_bf16 v[64:79], v[80:83], v[152:155], v[64:79]
  v_mfma_f32_32x32x16_bf16 v[32:47], v[80:83], a[28:31], v[32:47]
  v_mfma_f32_32x32x16_bf16 v[48:63], v[80:83], a[156:159], v[48:63]
  v_mfma_f32_32x32x16_bf16 v[64:79], v[80:83], v[156:159], v[64:79]
  v_mfma_f32_32x32x16_bf16 v[32:47], v[80:83], a[32:35], v[32:47]
  v_mfma_f32_32x32x16_bf16 v[48:63], v[80:83], a[160:163], v[48:63]
  v_mfma_f32_32x32x16_bf16 v[64:79], v[80:83], v[160:163], v[64:79]
  v_mfma_f32_32x32x16_bf16 v[32:47], v[80:83], a[36:39], v[32:47]
  v_mfma_f32_32x32x16_bf16 v[48:63], v[80:83], a[164:167], v[48:63]
  v_mfma_f32_32x32x16_bf16 v[64:79], v[80:83], v[164:167], v[64:79]
  v_mfma_f32_32x32x16_bf16 v[32:47], v[80:83], a[40:43], v[32:47]
  v_mfma_f32_32x32x16_bf16 v[48:63], v[80:83], a[168:171], v[48:63]
  v_mfma_f32_32x32x16_bf16 v[64:79], v[80:83], v[168:171], v[64:79]
  v_mfma_f32_32x32x16_bf16 v[32:47], v[80:83], a[44:47], v[32:47]
  v_mfma_f32_32x32x16_bf16 v[48:63], v[80:83], a[172:175], v[48:63]
  v_mfma_f32_32x32x16_bf16 v[64:79], v[80:83], v[172:175], v[64:79]
  v_mfma_f32_32x32x16_bf16 v[32:47], v[80:83], a[48:51], v[32:47]
  v_mfma_f32_32x32x16_bf16 v[48:63], v[80:83], a[176:179], v[48:63]
  v_mfma_f32_32x32x16_bf16 v[64:79], v[80:83], v[176:179], v[64:79]
  v_mfma_f32_32x32x16_bf16 v[32:47], v[80:83], a[52:55], v[32:47]
  v_mfma_f32_32x32x16_bf16 v[48:63], v[80:83], a[180:183], v[48:63]
  v_mfma_f32_32x32x16_bf16 v[64:79], v[80:83], v[180:183], v[64:79]
  v_mfma_f32_32x32x16_bf16 v[32:47], v[80:83], a[56:59], v[32:47]
  v_mfma_f32_32x32x16_bf16 v[48:63], v[80:83], a[184:187], v[48:63]
  v_mfma_f32_32x32x16_bf16 v[64:79], v[80:83], v[184:187], v[64:79]
  v_mfma_f32_32x32x16_bf16 v[32:47], v[80:83], a[60:63], v[32:47]
  v_mfma_f32_32x32x16_bf16 v[48:63], v[80:83], a[188:191], v[48:63]
  v_mfma_f32_32x32x16_bf16 v[64:79], v[80:83], v[188:191], v[64:79]
  v_mfma_f32_32x32x16_bf16 v[32:47], v[80:83], a[64:67], v[32:47]
  v_mfma_f32_32x32x16_bf16 v[48:63], v[80:83], a[192:195], v[48:63]
  v_mfma_f32_32x32x16_bf16 v[64:79], v[80:83], v[192:195], v[64:79]
  v_mfma_f32_32x32x16_bf16 v[32:47], v[80:83], a[68:71], v[32:47]
  v_mfma_f32_32x32x16_bf16 v[48:63], v[80:83], a[196:199], v[48:63]
  v_mfma_f32_32x32x16_bf16 v[64:79], v[80:83], v[196:199], v[64:79]
  v_mfma_f32_32x32x16_bf16 v[32:47], v[80:83], a[72:75], v[32:47]
  v_mfma_f32_32x32x16_bf16 v[48:63], v[80:83], a[200:203], v[48:63]
  v_mfma_f32_32x32x16_bf16 v[64:79], v[80:83], v[200:203], v[64:79]
  v_mfma_f32_32x32x16_bf16 v[32:47], v[80:83], a[76:79], v[32:47]
  v_mfma_f32_32x32x16_bf16 v[48:63], v[80:83], a[204:207], v[48:63]
  v_mfma_f32_32x32x16_bf16 v[64:79], v[80:83], v[204:207], v[64:79]
  v_mfma_f32_32x32x16_bf16 v[32:47], v[80:83], a[80:83], v[32:47]
  v_mfma_f32_32x32x16_bf16 v[48:63], v[80:83], a[208:211], v[48:63]
  v_mfma_f32_32x32x16_bf16 v[64:79], v[80:83], v[208:211], v[64:79]
  v_mfma_f32_32x32x16_bf16 v[32:47], v[80:83], a[84:87], v[32:47]
  v_mfma_f32_32x32x16_bf16 v[48:63], v[80:83], a[212:215], v[48:63]
  v_mfma_f32_32x32x16_bf16 v[64:79], v[80:83], v[212:215], v[64:79]
  v_mfma_f32_32x32x16_bf16 v[32:47], v[80:83], a[88:91], v[32:47]
  v_mfma_f32_32x32x16_bf16 v[48:63], v[80:83], a[216:219], v[48:63]
  v_mfma_f32_32x32x16_bf16 v[64:79], v[80:83], v[216:219], v[64:79]
  v_mfma_f32_32x32x16_bf16 v[32:47], v[80:83], a[92:95], v[32:47]
  v_mfma_f32_32x32x16_bf16 v[48:63], v[80:83], a[220:223], v[48:63]
  v_mfma_f32_32x32x16_bf16 v[64:79], v[80:83], v[220:223], v[64:79]
  v_mfma_f32_32x32x16_bf16 v[32:47], v[80:83], a[96:99], v[32:47]
  v_mfma_f32_32x32x16_bf16 v[48:63], v[80:83], a[224:227], v[48:63]
  v_mfma_f32_32x32x16_bf16 v[64:79], v[80:83], v[224:227], v[64:79]
  v_mfma_f32_32x32x16_bf16 v[32:47], v[80:83], a[100:103], v[32:47]
  v_mfma_f32_32x32x16_bf16 v[48:63], v[80:83], a[228:231], v[48:63]
  v_mfma_f32_32x32x16_bf16 v[64:79], v[80:83], v[228:231], v[64:79]
  v_mfma_f32_32x32x16_bf16 v[32:47], v[80:83], a[104:107], v[32:47]
  v_mfma_f32_32x32x16_bf16 v[48:63], v[80:83], a[232:235], v[48:63]
  v_mfma_f32_32x32x16_bf16 v[64:79], v[80:83], v[232:235], v[64:79]
  v_mfma_f32_32x32x16_bf16 v[32:47], v[80:83], a[108:111], v[32:47]
  v_mfma_f32_32x32x16_bf16 v[48:63], v[80:83], a[236:239], v[48:63]
  v_mfma_f32_32x32x16_bf16 v[64:79], v[80:83], v[236:239], v[64:79]
  v_mfma_f32_32x32x16_bf16 v[32:47], v[80:83], a[112:115], v[32:47]
  v_mfma_f32_32x32x16_bf16 v[48:63], v[80:83], a[240:243], v[48:63]
  v_mfma_f32_32x32x16_bf16 v[64:79], v[80:83], v[240:243], v[64:79]
  v_mfma_f32_32x32x16_bf16 v[32:47], v[80:83], a[116:119], v[32:47]
  v_mfma_f32_32x32x16_bf16 v[48:63], v[80:83], a[244:247], v[48:63]
  v_mfma_f32_32x32x16_bf16 v[64:79], v[80:83], v[244:247], v[64:79]
  v_mfma_f32_32x32x16_bf16 v[32:47], v[80:83], a[120:123], v[32:47]
  v_mfma_f32_32x32x16_bf16 v[48:63], v[80:83], a[248:251], v[48:63]
  v_mfma_f32_32x32x16_bf16 v[64:79], v[80:83], v[248:251], v[64:79]
  v_mfma_f32_32x32x16_bf16 v[32:47], v[80:83], a[124:127], v[32:47]
  v_mfma_f32_32x32x16_bf16 v[48:63], v[80:83], a[252:255], v[48:63]
  v_mfma_f32_32x32x16_bf16 v[64:79], v[80:83], v[252:255], v[64:79]
  v_cmp_gt_u32 vcc, 512, v0
  s_nop 8
  v_cvt_pk_bf16_f32 v33, v32, v32
  v_and_b32 v33, 0xffff0000, v33
  v_sub_f32 v32, v32, v33
  v_cvt_pk_bf16_f32 v32, v32, v33
  v_cndmask_b32 v16, 0, v32, vcc
  v_cvt_pk_bf16_f32 v49, v48, v48
  v_and_b32 v49, 0xffff0000, v49
  v_sub_f32 v48, v48, v49
  v_cvt_pk_bf16_f32 v48, v48, v49
  v_cndmask_b32 v17, 0, v48, vcc
  v_cvt_pk_bf16_f32 v65, v64, v64
  v_and_b32 v65, 0xffff0000, v65
  v_sub_f32 v64, v64, v65
  v_cvt_pk_bf16_f32 v64, v64, v65
  v_cndmask_b32 v18, 0, v64, vcc
  v_mov_b32 v19, 0
  v_mov_b32 v21, 0
  v_mov_b32 v22, 0
  s_mov_b32 s7, 0
  v_mov_b32 v92, 128
L_wd_27:
  buffer_load_dword v93, v92, s[12:15], 0 offen sc1
  s_waitcnt vmcnt(0)
  v_cmp_ne_u32 vcc, 0x100, v93
  s_cbranch_vccz L_wdo_28
  s_add_u32 s7, s7, 1
  s_cmp_lt_u32 s7, 131072
  s_cbranch_scc1 L_wd_27
  s_mov_b32 s6, 20
  s_branch L_err
L_wdo_28:
  s_mov_b32 s32, 0
  s_mov_b32 s33, s37
  s_add_u32 s49, s33, 1
  s_cmp_lg_u32 s35, 0
  s_cbranch_scc1 L_p1_29
  s_mov_b32 s7, 0
L_pl_30:
  buffer_load_dwordx4 v[92:95], v0, s[8:11], s44 offen offset:0 sc1
  s_waitcnt vmcnt(0)
  v_min_u32 v92, v92, v93
  v_min3_u32 v92, v92, v94, v95
  v_cmp_gt_u32 vcc, s49, v92
  s_cbranch_vccz L_plo_31
  s_add_u32 s7, s7, 1
  s_cmp_lt_u32 s7, 131072
  s_cbranch_scc1 L_pl_30
  s_mov_b32 s6, 21
  s_branch L_err
L_plo_31:
  s_mov_b32 s7, 0
L_pl_32:
  buffer_load_dwordx4 v[92:95], v0, s[8:11], s44 offen offset:1024 sc1
  s_waitcnt vmcnt(0)
  v_min_u32 v92, v92, v93
  v_min3_u32 v92, v92, v94, v95
  v_cmp_gt_u32 vcc, s49, v92
  s_cbranch_vccz L_plo_33
  s_add_u32 s7, s7, 1
  s_cmp_lt_u32 s7, 131072
  s_cbranch_scc1 L_pl_32
  s_mov_b32 s6, 21
  s_branch L_err
L_plo_33:
L_p1_29:
L_p_xwait:
  s_mov_b32 s7, 0
L_pl_34:
  buffer_load_dword v92, v114, s[8:11], s44 offen offset:0 sc1
  s_waitcnt vmcnt(0)
  v_cmp_gt_u32 vcc, s49, v92
  s_cbranch_vccz L_plo_35
  s_add_u32 s7, s7, 1
  s_cmp_lt_u32 s7, 131072
  s_cbranch_scc1 L_pl_34
  s_mov_b32 s6, 22
  s_branch L_err
L_plo_35:
  s_sub_u32 s6, s49, 1
  s_lshl_b32 s6, s6, 15
  s_add_u32 s45, s38, s6
  s_mov_b32 m0, s53
  s_add_u32 s6, s45, 4096
  buffer_load_dwordx4 v0, s[8:11], s45 offen offset:0 lds
  buffer_load_dwordx4 v0, s[8:11], s45 offen offset:1024 lds
  buffer_load_dwordx4 v0, s[8:11], s45 offen offset:2048 lds
  buffer_load_dwordx4 v0, s[8:11], s45 offen offset:3072 lds
  s_add_u32 m0, s53, 4096
  s_nop 0
  buffer_load_dwordx4 v0, s[8:11], s6 offen offset:0 lds
  buffer_load_dwordx4 v0, s[8:11], s6 offen offset:1024 lds
  buffer_load_dwordx4 v0, s[8:11], s6 offen offset:2048 lds
  buffer_load_dwordx4 v0, s[8:11], s6 offen offset:3072 lds
  s_waitcnt vmcnt(0)
L_p_loop:
  s_barrier
  s_and_b32 s6, s33, 3
  s_lshl_b32 s6, s6, 19
  s_add_u32 s46, s39, s6
  s_add_u32 s51, s33, 1
  s_add_u32 s49, s33, 3
  s_lshl_b32 s7, s3, 8
  ds_read_b64_tr_b16 v[80:81], v1 offset:0
  ds_read_b64_tr_b16 v[82:83], v1 offset:256
  ds_read_b64_tr_b16 v[84:85], v1 offset:1024
  ds_read_b64_tr_b16 v[86:87], v1 offset:1280
  ds_read_b64_tr_b16 v[96:97], v14 offset:0
  ds_read_b64_tr_b16 v[98:99], v14 offset:256
  v_mov_b32 v92, 0
  v_mov_b32 v93, 0
  v_add_u32 v108, s7, v15
  s_waitcnt lgkmcnt(4)
  v_mfma_f32_32x32x16_bf16 v[48:63], a[128:131], v[80:83], 0
  ds_read_b64_tr_b16 v[88:89], v1 offset:2048
  ds_read_b64_tr_b16 v[90:91], v1 offset:2304
  s_waitcnt lgkmcnt(2)
  ds_read_b64_tr_b16 v[100:101], v14 offset:1024
  ds_read_b64_tr_b16 v[102:103], v14 offset:1280
  v_lshlrev_b32 v104, 16, v96
  v_mfma_f32_32x32x16_bf16 v[64:79], v[80:83], v[128:131], 0
  v_and_b32 v105, 0xffff0000, v96
  v_add_f32 v92, v92, v104
  v_fmac_f32 v93, v104, v104
  v_add_f32 v92, v92, v105
  v_mfma_f32_32x32x16_bf16 v[32:47], a[0:3], v[80:83], 0
  v_fmac_f32 v93, v105, v105
  v_lshlrev_b32 v106, 16, v97
  v_and_b32 v107, 0xffff0000, v97
  v_mfma_f32_32x32x16_bf16 v[48:63], a[132:135], v[84:87], v[48:63]
  ds_read_b64_tr_b16 v[80:81], v1 offset:3072
  ds_read_b64_tr_b16 v[82:83], v1 offset:3328
  v_add_f32 v92, v92, v106
  v_mfma_f32_32x32x16_bf16 v[64:79], v[84:87], v[132:135], v[64:79]
  v_fmac_f32 v93, v106, v106
  v_add_f32 v92, v92, v107
  v_fmac_f32 v93, v107, v107
  v_lshlrev_b32 v104, 16, v98
  v_mfma_f32_32x32x16_bf16 v[32:47], a[4:7], v[84:87], v[32:47]
  v_and_b32 v105, 0xffff0000, v98
  v_add_f32 v92, v92, v104
  v_fmac_f32 v93, v104, v104
  s_waitcnt lgkmcnt(4)
  v_mfma_f32_32x32x16_bf16 v[48:63], a[136:139], v[88:91], v[48:63]
  ds_read_b64_tr_b16 v[84:85], v1 offset:4096
  ds_read_b64_tr_b16 v[86:87], v1 offset:4352
  v_add_f32 v92, v92, v105
  v_mfma_f32_32x32x16_bf16 v[64:79], v[88:91], v[136:139], v[64:79]
  v_fmac_f32 v93, v105, v105
  v_lshlrev_b32 v106, 16, v99
  v_and_b32 v107, 0xffff0000, v99
  v_add_f32 v92, v92, v106
  v_mfma_f32_32x32x16_bf16 v[32:47], a[8:11], v[88:91], v[32:47]
  v_fmac_f32 v93, v106, v106
  v_add_f32 v92, v92, v107
  v_fmac_f32 v93, v107, v107
  s_waitcnt lgkmcnt(2)
  v_mfma_f32_32x32x16_bf16 v[48:63], a[140:143], v[80:83], v[48:63]
  ds_read_b64_tr_b16 v[88:89], v1 offset:5120
  ds_read_b64_tr_b16 v[90:91], v1 offset:5376
  ds_read_b64_tr_b16 v[96:97], v14 offset:2048
  ds_read_b64_tr_b16 v[98:99], v14 offset:2304
  v_lshlrev_b32 v104, 16, v100
  v_mfma_f32_32x32x16_bf16 v[64:79], v[80:83], v[140:143], v[64:79]
  v_and_b32 v105, 0xffff0000, v100
  v_add_f32 v92, v92, v104
  v_fmac_f32 v93, v104, v104
  v_add_f32 v92, v92, v105
  v_mfma_f32_32x32x16_bf16 v[32:47], a[12:15], v[80:83], v[32:47]
  v_fmac_f32 v93, v105, v105
  v_lshlrev_b32 v106, 16, v101
  v_and_b32 v107, 0xffff0000, v101
  s_waitcnt lgkmcnt(4)
  v_mfma_f32_32x32x16_bf16 v[48:63], a[144:147], v[84:87], v[48:63]
  ds_read_b64_tr_b16 v[80:81], v1 offset:6144
  ds_read_b64_tr_b16 v[82:83], v1 offset:6400
  v_add_f32 v92, v92, v106
  v_mfma_f32_32x32x16_bf16 v[64:79], v[84:87], v[144:147], v[64:79]
  v_fmac_f32 v93, v106, v106
  v_add_f32 v92, v92, v107
  v_fmac_f32 v93, v107, v107
  v_lshlrev_b32 v104, 16, v102
  v_mfma_f32_32x32x16_bf16 v[32:47], a[16:19], v[84:87], v[32:47]
  v_and_b32 v105, 0xffff0000, v102
  v_add_f32 v92, v92, v104
  v_fmac_f32 v93, v104, v104
  s_waitcnt lgkmcnt(4)
  v_mfma_f32_32x32x16_bf16 v[48:63], a[148:151], v[88:91], v[48:63]
  ds_read_b64_tr_b16 v[84:85], v1 offset:7168
  ds_read_b64_tr_b16 v[86:87], v1 offset:7424
  v_add_f32 v92, v92, v105
  v_mfma_f32_32x32x16_bf16 v[64:79], v[88:91], v[148:151], v[64:79]
  v_fmac_f32 v93, v105, v105
  v_lshlrev_b32 v106, 16, v103
  v_and_b32 v107, 0xffff0000, v103
  v_add_f32 v92, v92, v106
  v_mfma_f32_32x32x16_bf16 v[32:47], a[20:23], v[88:91], v[32:47]
  v_fmac_f32 v93, v106, v106
  v_add_f32 v92, v92, v107
  v_fmac_f32 v93, v107, v107
  s_waitcnt lgkmcnt(2)
  v_mfma_f32_32x32x16_bf16 v[48:63], a[152:155], v[80:83], v[48:63]
  ds_read_b64_tr_b16 v[88:89], v1 offset:8192
  ds_read_b64_tr_b16 v[90:91], v1 offset:8448
  ds_read_b64_tr_b16 v[100:101], v14 offset:3072
  ds_read_b64_tr_b16 v[102:103], v14 offset:3328
  v_lshlrev_b32 v104, 16, v96
  v_mfma_f32_32x32x16_bf16 v[64:79], v[80:83], v[152:155], v[64:79]
  v_and_b32 v105, 0xffff0000, v96
  v_add_f32 v92, v92, v104
  v_fmac_f32 v93, v104, v104
  v_add_f32 v92, v92, v105
  v_mfma_f32_32x32x16_bf16 v[32:47], a[24:27], v[80:83], v[32:47]
  v_fmac_f32 v93, v105, v105
  v_lshlrev_b32 v106, 16, v97
  v_and_b32 v107, 0xffff0000, v97
  s_waitcnt lgkmcnt(4)
  v_mfma_f32_32x32x16_bf16 v[48:63], a[156:159], v[84:87], v[48:63]
  ds_read_b64_tr_b16 v[80:81], v1 offset:9216
  ds_read_b64_tr_b16 v[82:83], v1 offset:9472
  v_add_f32 v92, v92, v106
  v_mfma_f32_32x32x16_bf16 v[64:79], v[84:87], v[156:159], v[64:79]
  v_fmac_f32 v93, v106, v106
  v_add_f32 v92, v92, v107
  v_fmac_f32 v93, v107, v107
  v_lshlrev_b32 v104, 16, v98
  v_mfma_f32_32x32x16_bf16 v[32:47], a[28:31], v[84:87], v[32:47]
  v_and_b32 v105, 0xffff0000, v98
  v_add_f32 v92, v92, v104
  v_fmac_f32 v93, v104, v104
  s_waitcnt lgkmcnt(4)
  v_mfma_f32_32x32x16_bf16 v[48:63], a[160:163], v[88:91], v[48:63]
  ds_read_b64_tr_b16 v[84:85], v1 offset:10240
  ds_read_b64_tr_b16 v[86:87], v1 offset:10496
  v_add_f32 v92, v92, v105
  v_mfma_f32_32x32x16_bf16 v[64:79], v[88:91], v[160:163], v[64:79]
  v_fmac_f32 v93, v105, v105
  v_lshlrev_b32 v106, 16, v99
  v_and_b32 v107, 0xffff0000, v99
  v_add_f32 v92, v92, v106
  v_mfma_f32_32x32x16_bf16 v[32:47], a[32:35], v[88:91], v[32:47]
  v_fmac_f32 v93, v106, v106
  v_add_f32 v92, v92, v107
  v_fmac_f32 v93, v107, v107
  s_waitcnt lgkmcnt(2)
  v_mfma_f32_32x32x16_bf16 v[48:63], a[164:167], v[80:83], v[48:63]
  ds_read_b64_tr_b16 v[88:89], v1 offset:11264
  ds_read_b64_tr_b16 v[90:91], v1 offset:11520
  ds_read_b64_tr_b16 v[96:97], v14 offset:4096
  ds_read_b64_tr_b16 v[98:99], v14 offset:4352
  v_lshlrev_b32 v104, 16, v100
  v_mfma_f32_32x32x16_bf16 v[64:79], v[80:83], v[164:167], v[64:79]
  v_and_b32 v105, 0xffff0000, v100
  v_add_f32 v92, v92, v104
  v_fmac_f32 v93, v104, v104
  v_add_f32 v92, v92, v105
  v_mfma_f32_32x32x16_bf16 v[32:47], a[36:39], v[80:83], v[32:47]
  v_fmac_f32 v93, v105, v105
  v_lshlrev_b32 v106, 16, v101
  v_and_b32 v107, 0xffff0000, v101
  s_waitcnt lgkmcnt(4)
  v_mfma_f32_32x32x16_bf16 v[48:63], a[168:171], v[84:87], v[48:63]
  ds_read_b64_tr_b16 v[80:81], v1 offset:12288
  ds_read_b64_tr_b16 v[82:83], v1 offset:12544
  v_add_f32 v92, v92, v106
  v_mfma_f32_32x32x16_bf16 v[64:79], v[84:87], v[168:171], v[64:79]
  v_fmac_f32 v93, v106, v106
  v_add_f32 v92, v92, v107
  v_fmac_f32 v93, v107, v107
  v_lshlrev_b32 v104, 16, v102
  v_mfma_f32_32x32x16_bf16 v[32:47], a[40:43], v[84:87], v[32:47]
  v_and_b32 v105, 0xffff0000, v102
  v_add_f32 v92, v92, v104
  v_fmac_f32 v93, v104, v104
  s_waitcnt lgkmcnt(4)
  v_mfma_f32_32x32x16_bf16 v[48:63], a[172:175], v[88:91], v[48:63]
  ds_read_b64_tr_b16 v[84:85], v1 offset:13312
  ds_read_b64_tr_b16 v[86:87], v1 offset:13568
  v_add_f32 v92, v92, v105
  v_mfma_f32_32x32x16_bf16 v[64:79], v[88:91], v[172:175], v[64:79]
  v_fmac_f32 v93, v105, v105
  v_lshlrev_b32 v106, 16, v103
  v_and_b32 v107, 0xffff0000, v103
  v_add_f32 v92, v92, v106
  v_mfma_f32_32x32x16_bf16 v[32:47], a[44:47], v[88:91], v[32:47]
  v_fmac_f32 v93, v106, v106
  v_add_f32 v92, v92, v107
  v_fmac_f32 v93, v107, v107
  s_waitcnt lgkmcnt(2)
  v_mfma_f32_32x32x16_bf16 v[48:63], a[176:179], v[80:83], v[48:63]
  ds_read_b64_tr_b16 v[88:89], v1 offset:14336
  ds_read_b64_tr_b16 v[90:91], v1 offset:14592
  ds_read_b64_tr_b16 v[100:101], v14 offset:5120
  ds_read_b64_tr_b16 v[102:103], v14 offset:5376
  v_lshlrev_b32 v104, 16, v96
  v_mfma_f32_32x32x16_bf16 v[64:79], v[80:83], v[176:179], v[64:79]
  v_and_b32 v105, 0xffff0000, v96
  v_add_f32 v92, v92, v104
  v_fmac_f32 v93, v104, v104
  v_add_f32 v92, v92, v105
  v_mfma_f32_32x32x16_bf16 v[32:47], a[48:51], v[80:83], v[32:47]
  v_fmac_f32 v93, v105, v105
  v_lshlrev_b32 v106, 16, v97
  v_and_b32 v107, 0xffff0000, v97
  s_waitcnt lgkmcnt(4)
  v_mfma_f32_32x32x16_bf16 v[48:63], a[180:183], v[84:87], v[48:63]
  ds_read_b64_tr_b16 v[80:81], v1 offset:15360
  ds_read_b64_tr_b16 v[82:83], v1 offset:15616
  v_add_f32 v92, v92, v106
  v_mfma_f32_32x32x16_bf16 v[64:79], v[84:87], v[180:183], v[64:79]
  v_fmac_f32 v93, v106, v106
  v_add_f32 v92, v92, v107
  v_fmac_f32 v93, v107, v107
  v_lshlrev_b32 v104, 16, v98
  v_mfma_f32_32x32x16_bf16 v[32:47], a[52:55], v[84:87], v[32:47]
  v_and_b32 v105, 0xffff0000, v98
  v_add_f32 v92, v92, v104
  v_fmac_f32 v93, v104, v104
  s_waitcnt lgkmcnt(4)
  v_mfma_f32_32x32x16_bf16 v[48:63], a[184:187], v[88:91], v[48:63]
  ds_read_b64_tr_b16 v[84:85], v1 offset:16384
  ds_read_b64_tr_b16 v[86:87], v1 offset:16640
  v_add_f32 v92, v92, v105
  v_mfma_f32_32x32x16_bf16 v[64:79], v[88:91], v[184:187], v[64:79]
  v_fmac_f32 v93, v105, v105
  v_lshlrev_b32 v106, 16, v99
  v_and_b32 v107, 0xffff0000, v99
  v_add_f32 v92, v92, v106
  v_mfma_f32_32x32x16_bf16 v[32:47], a[56:59], v[88:91], v[32:47]
  v_fmac_f32 v93, v106, v106
  v_add_f32 v92, v92, v107
  v_fmac_f32 v93, v107, v107
  s_waitcnt lgkmcnt(2)
  v_mfma_f32_32x32x16_bf16 v[48:63], a[188:191], v[80:83], v[48:63]
  ds_read_b64_tr_b16 v[88:89], v1 offset:17408
  ds_read_b64_tr_b16 v[90:91], v1 offset:17664
  ds_read_b64_tr_b16 v[96:97], v14 offset:6144
  ds_read_b64_tr_b16 v[98:99], v14 offset:6400
  v_lshlrev_b32 v104, 16, v100
  v_mfma_f32_32x32x16_bf16 v[64:79], v[80:83], v[188:191], v[64:79]
  v_and_b32 v105, 0xffff0000, v100
  v_add_f32 v92, v92, v104
  v_fmac_f32 v93, v104, v104
  v_add_f32 v92, v92, v105
  v_mfma_f32_32x32x16_bf16 v[32:47], a[60:63], v[80:83], v[32:47]
  v_fmac_f32 v93, v105, v105
  v_lshlrev_b32 v106, 16, v101
  v_and_b32 v107, 0xffff0000, v101
  s_waitcnt lgkmcnt(4)
  v_mfma_f32_32x32x16_bf16 v[48:63], a[192:195], v[84:87], v[48:63]
  ds_read_b64_tr_b16 v[80:81], v1 offset:18432
  ds_read_b64_tr_b16 v[82:83], v1 offset:18688
  v_add_f32 v92, v92, v106
  v_mfma_f32_32x32x16_bf16 v[64:79], v[84:87], v[192:195], v[64:79]
  v_fmac_f32 v93, v106, v106
  v_add_f32 v92, v92, v107
  v_fmac_f32 v93, v107, v107
  v_lshlrev_b32 v104, 16, v102
  v_mfma_f32_32x32x16_bf16 v[32:47], a[64:67], v[84:87], v[32:47]
  v_and_b32 v105, 0xffff0000, v102
  v_add_f32 v92, v92, v104
  v_fmac_f32 v93, v104, v104
  s_waitcnt lgkmcnt(4)
  v_mfma_f32_32x32x16_bf16 v[48:63], a[196:199], v[88:91], v[48:63]
  ds_read_b64_tr_b16 v[84:85], v1 offset:19456
  ds_read_b64_tr_b16 v[86:87], v1 offset:19712
  v_add_f32 v92, v92, v105
  v_mfma_f32_32x32x16_bf16 v[64:79], v[88:91], v[196:199], v[64:79]
  v_fmac_f32 v93, v105, v105
  v_lshlrev_b32 v106, 16, v103
  v_and_b32 v107, 0xffff0000, v103
  v_add_f32 v92, v92, v106
  v_mfma_f32_32x32x16_bf16 v[32:47], a[68:71], v[88:91], v[32:47]
  v_fmac_f32 v93, v106, v106
  v_add_f32 v92, v92, v107
  v_fmac_f32 v93, v107, v107
  s_waitcnt lgkmcnt(2)
  v_mfma_f32_32x32x16_bf16 v[48:63], a[200:203], v[80:83], v[48:63]
  ds_read_b64_tr_b16 v[88:89], v1 offset:20480
  ds_read_b64_tr_b16 v[90:91], v1 offset:20736
  ds_read_b64_tr_b16 v[100:101], v14 offset:7168
  ds_read_b64_tr_b16 v[102:103], v14 offset:7424
  v_lshlrev_b32 v104, 16, v96
  v_mfma_f32_32x32x16_bf16 v[64:79], v[80:83], v[200:203], v[64:79]
  v_and_b32 v105, 0xffff0000, v96
  v_add_f32 v92, v92, v104
  v_fmac_f32 v93, v104, v104
  v_add_f32 v92, v92, v105
  v_mfma_f32_32x32x16_bf16 v[32:47], a[72:75], v[80:83], v[32:47]
  v_fmac_f32 v93, v105, v105
  v_lshlrev_b32 v106, 16, v97
  v_and_b32 v107, 0xffff0000, v97
  s_waitcnt lgkmcnt(4)
  v_mfma_f32_32x32x16_bf16 v[48:63], a[204:207], v[84:87], v[48:63]
  ds_read_b64_tr_b16 v[80:81], v1 offset:21504
  ds_read_b64_tr_b16 v[82:83], v1 offset:21760
  v_add_f32 v92, v92, v106
  v_mfma_f32_32x32x16_bf16 v[64:79], v[84:87], v[204:207], v[64:79]
  v_fmac_f32 v93, v106, v106
  v_add_f32 v92, v92, v107
  v_fmac_f32 v93, v107, v107
  v_lshlrev_b32 v104, 16, v98
  v_mfma_f32_32x32x16_bf16 v[32:47], a[76:79], v[84:87], v[32:47]
  v_and_b32 v105, 0xffff0000, v98
  v_add_f32 v92, v92, v104
  v_fmac_f32 v93, v104, v104
  s_waitcnt lgkmcnt(4)
  v_mfma_f32_32x32x16_bf16 v[48:63], a[208:211], v[88:91], v[48:63]
  ds_read_b64_tr_b16 v[84:85], v1 offset:22528
  ds_read_b64_tr_b16 v[86:87], v1 offset:22784
  v_add_f32 v92, v92, v105
  v_mfma_f32_32x32x16_bf16 v[64:79], v[88:91], v[208:211], v[64:79]
  v_fmac_f32 v93, v105, v105
  v_lshlrev_b32 v106, 16, v99
  v_and_b32 v107, 0xffff0000, v99
  v_add_f32 v92, v92, v106
  v_mfma_f32_32x32x16_bf16 v[32:47], a[80:83], v[88:91], v[32:47]
  v_fmac_f32 v93, v106, v106
  v_add_f32 v92, v92, v107
  v_fmac_f32 v93, v107, v107
  s_waitcnt lgkmcnt(2)
  v_mfma_f32_32x32x16_bf16 v[48:63], a[212:215], v[80:83], v[48:63]
  ds_read_b64_tr_b16 v[88:89], v1 offset:23552
  ds_read_b64_tr_b16 v[90:91], v1 offset:23808
  v_mfma_f32_32x32x16_bf16 v[64:79], v[80:83], v[212:215], v[64:79]
  v_lshlrev_b32 v104, 16, v100
  v_and_b32 v105, 0xffff0000, v100
  v_add_f32 v92, v92, v104
  v_fmac_f32 v93, v104, v104
  v_mfma_f32_32x32x16_bf16 v[32:47], a[84:87], v[80:83], v[32:47]
  v_add_f32 v92, v92, v105
  v_fmac_f32 v93, v105, v105
  v_lshlrev_b32 v106, 16, v101
  v_and_b32 v107, 0xffff0000, v101
  s_waitcnt lgkmcnt(2)
  v_mfma_f32_32x32x16_bf16 v[48:63], a[216:219], v[84:87], v[48:63]
  ds_read_b64_tr_b16 v[80:81], v1 offset:24576
  ds_read_b64_tr_b16 v[82:83], v1 offset:24832
  v_add_f32 v92, v92, v106
  v_mfma_f32_32x32x16_bf16 v[64:79], v[84:87], v[216:219], v[64:79]
  v_fmac_f32 v93, v106, v106
  v_add_f32 v92, v92, v107
  v_fmac_f32 v93, v107, v107
  v_lshlrev_b32 v104, 16, v102
  v_mfma_f32_32x32x16_bf16 v[32:47], a[88:91], v[84:87], v[32:47]
  v_and_b32 v105, 0xffff0000, v102
  v_add_f32 v92, v92, v104
  v_fmac_f32 v93, v104, v104
  s_waitcnt lgkmcnt(2)
  v_mfma_f32_32x32x16_bf16 v[48:63], a[220:223], v[88:91], v[48:63]
  ds_read_b64_tr_b16 v[84:85], v1 offset:25600
  ds_read_b64_tr_b16 v[86:87], v1 offset:25856
  v_add_f32 v92, v92, v105
  v_mfma_f32_32x32x16_bf16 v[64:79], v[88:91], v[220:223], v[64:79]
  v_fmac_f32 v93, v105, v105
  v_lshlrev_b32 v106, 16, v103
  v_and_b32 v107, 0xffff0000, v103
  v_add_f32 v92, v92, v106
  v_mfma_f32_32x32x16_bf16 v[32:47], a[92:95], v[88:91], v[32:47]
  v_fmac_f32 v93, v106, v106
  v_add_f32 v92, v92, v107
  v_fmac_f32 v93, v107, v107
  s_waitcnt lgkmcnt(2)
  v_mfma_f32_32x32x16_bf16 v[48:63], a[224:227], v[80:83], v[48:63]
  ds_read_b64_tr_b16 v[88:89], v1 offset:26624
  ds_read_b64_tr_b16 v[90:91], v1 offset:26880
  v_mov_b32 v94, v92
  v_mfma_f32_32x32x16_bf16 v[64:79], v[80:83], v[224:227], v[64:79]
  v_mov_b32 v95, v93
  v_permlane32_swap_b32 v92, v94
  s_nop 0
  v_permlane32_swap_b32 v93, v95
  v_add_f32 v92, v92, v94
  v_mfma_f32_32x32x16_bf16 v[32:47], a[96:99], v[80:83], v[32:47]
  v_add_f32 v93, v93, v95
  ds_write_b64 v108, v[92:93]
  s_waitcnt lgkmcnt(3)
  v_mfma_f32_32x32x16_bf16 v[48:63], a[228:231], v[84:87], v[48:63]
  ds_read_b64_tr_b16 v[80:81], v1 offset:27648
  ds_read_b64_tr_b16 v[82:83], v1 offset:27904
  v_mfma_f32_32x32x16_bf16 v[64:79], v[84:87], v[228:231], v[64:79]
  s_waitcnt lgkmcnt(2)
  s_barrier
  ds_read_b64 v[96:97], v15 offset:0
  ds_read_b64 v[98:99], v15 offset:256
  v_mfma_f32_32x32x16_bf16 v[32:47], a[100:103], v[84:87], v[32:47]
  ds_read_b64 v[100:101], v15 offset:512
  ds_read_b64 v[102:103], v15 offset:768
  v_mfma_f32_32x32x16_bf16 v[48:63], a[232:235], v[88:91], v[48:63]
  ds_read_b64_tr_b16 v[84:85], v1 offset:28672
  ds_read_b64_tr_b16 v[86:87], v1 offset:28928
  v_mfma_f32_32x32x16_bf16 v[64:79], v[88:91], v[232:235], v[64:79]
  v_mfma_f32_32x32x16_bf16 v[32:47], a[104:107], v[88:91], v[32:47]
  s_waitcnt lgkmcnt(6)
  v_mfma_f32_32x32x16_bf16 v[48:63], a[236:239], v[80:83], v[48:63]
  ds_read_b64_tr_b16 v[88:89], v1 offset:29696
  ds_read_b64_tr_b16 v[90:91], v1 offset:29952
  s_waitcnt lgkmcnt(4)
  v_mfma_f32_32x32x16_bf16 v[64:79], v[80:83], v[236:239], v[64:79]
  v_add_f32 v92, v96, v98
  v_add_f32 v93, v97, v99
  v_add_f32 v94, v100, v102
  v_add_f32 v95, v101, v103
  v_mfma_f32_32x32x16_bf16 v[32:47], a[108:111], v[80:83], v[32:47]
  v_add_f32 v92, v92, v94
  v_add_f32 v93, v93, v95
  v_mul_f32 v92, 0x3b000000, v92
  s_waitcnt lgkmcnt(2)
  v_mfma_f32_32x32x16_bf16 v[48:63], a[240:243], v[84:87], v[48:63]
  ds_read_b64_tr_b16 v[80:81], v1 offset:30720
  ds_read_b64_tr_b16 v[82:83], v1 offset:30976
  v_mul_f32 v94, v92, v92
  v_mfma_f32_32x32x16_bf16 v[64:79], v[84:87], v[240:243], v[64:79]
  v_mul_f32 v93, 0x3b000000, v93
  v_sub_f32 v93, v93, v94
  v_max_f32 v93, 0, v93
  v_cvt_pk_bf16_f32 v93, v93, v93
  v_mfma_f32_32x32x16_bf16 v[32:47], a[112:115], v[84:87], v[32:47]
  v_and_b32 v93, 0xffff0000, v93
  v_add_f32 v93, 0x3727c5ac, v93
  v_cvt_pk_bf16_f32 v93, v93, v93
  s_waitcnt lgkmcnt(2)
  v_mfma_f32_32x32x16_bf16 v[48:63], a[244:247], v[88:91], v[48:63]
  ds_read_b64_tr_b16 v[84:85], v1 offset:31744
  ds_read_b64_tr_b16 v[86:87], v1 offset:32000
  v_and_b32 v93, 0xffff0000, v93
  v_mfma_f32_32x32x16_bf16 v[64:79], v[88:91], v[244:247], v[64:79]
  v_sqrt_f32 v93, v93
  v_cvt_pk_bf16_f32 v92, v92, v92
  v_and_b32 v92, 0xffff0000, v92
  v_cvt_pk_bf16_f32 v93, v93, v93
  v_mfma_f32_32x32x16_bf16 v[32:47], a[116:119], v[88:91], v[32:47]
  v_and_b32 v93, 0xffff0000, v93
  v_rcp_f32 v93, v93
  v_xor_b32 v92, 0x80000000, v92
  s_waitcnt lgkmcnt(2)
  v_mfma_f32_32x32x16_bf16 v[48:63], a[248:251], v[80:83], v[48:63]
  v_lshrrev_b32 v94, 16, v92
  v_mfma_f32_32x32x16_bf16 v[64:79], v[80:83], v[248:251], v[64:79]
  v_or_b32 v20, v92, v94
  v_or_b32 v23, v92, v94
  v_mov_b32 v92, v93
  ds_write_b32 v9, v93
  v_mfma_f32_32x32x16_bf16 v[32:47], a[120:123], v[80:83], v[32:47]
  s_waitcnt lgkmcnt(1)
  v_mfma_f32_32x32x16_bf16 v[48:63], a[252:255], v[84:87], v[48:63]
  ds_read_b128 v[96:99], v8 offset:0
  v_mfma_f32_32x32x16_bf16 v[64:79], v[84:87], v[252:255], v[64:79]
  ds_read_b128 v[100:103], v8 offset:32
  ds_read_b128 v[104:107], v8 offset:64
  ds_read_b128 v[108:111], v8 offset:96
  v_mfma_f32_32x32x16_bf16 v[32:47], a[124:127], v[84:87], v[32:47]
  v_mfma_f32_32x32x8_bf16 v[48:63], v[16:17], v[22:23], v[48:63]
  v_mfma_f32_32x32x8_bf16 v[64:79], v[20:21], v[18:19], v[64:79]
  v_mfma_f32_32x32x8_bf16 v[32:47], v[16:17], v[20:21], v[32:47]
  s_add_u32 s7, s46, 0x2000
  s_nop 8
  v_pk_mul_f32 v[48:49], v[48:49], v[92:93]
  v_pk_mul_f32 v[50:51], v[50:51], v[92:93]
  v_pk_mul_f32 v[52:53], v[52:53], v[92:93]
  v_pk_mul_f32 v[54:55], v[54:55], v[92:93]
  v_pk_mul_f32 v[56:57], v[56:57], v[92:93]
  v_pk_mul_f32 v[58:59], v[58:59], v[92:93]
  v_pk_mul_f32 v[60:61], v[60:61], v[92:93]
  v_pk_mul_f32 v[62:63], v[62:63], v[92:93]
  v_cvt_pk_bf16_f32 v48, v48, v49
  v_cvt_pk_bf16_f32 v49, v50, v51
  v_cvt_pk_bf16_f32 v50, v52, v53
  v_cvt_pk_bf16_f32 v51, v54, v55
  v_cvt_pk_bf16_f32 v52, v56, v57
  v_cvt_pk_bf16_f32 v53, v58, v59
  v_cvt_pk_bf16_f32 v54, v60, v61
  v_cvt_pk_bf16_f32 v55, v62, v63
  buffer_store_dwordx4 v[48:51], v0, s[8:11], s46 offen offset:0 sc1
  ds_write_b128 v112, v[48:51] offset:8192
  buffer_store_dwordx4 v[52:55], v0, s[8:11], s46 offen offset:1024 sc1
  ds_write_b128 v112, v[52:55] offset:9216
  s_waitcnt lgkmcnt(2)
  v_pk_mul_f32 v[64:65], v[64:65], v[96:97]
  v_pk_mul_f32 v[66:67], v[66:67], v[98:99]
  v_pk_mul_f32 v[68:69], v[68:69], v[100:101]
  v_pk_mul_f32 v[70:71], v[70:71], v[102:103]
  v_pk_mul_f32 v[72:73], v[72:73], v[104:105]
  v_pk_mul_f32 v[74:75], v[74:75], v[106:107]
  v_pk_mul_f32 v[76:77], v[76:77], v[108:109]
  v_pk_mul_f32 v[78:79], v[78:79], v[110:111]
  v_cvt_pk_bf16_f32 v64, v64, v65
  v_cvt_pk_bf16_f32 v65, v66, v67
  v_cvt_pk_bf16_f32 v66, v68, v69
  v_cvt_pk_bf16_f32 v67, v70, v71
  v_cvt_pk_bf16_f32 v68, v72, v73
  v_cvt_pk_bf16_f32 v69, v74, v75
  v_cvt_pk_bf16_f32 v70, v76, v77
  v_cvt_pk_bf16_f32 v71, v78, v79
  buffer_store_dwordx4 v[64:67], v0, s[8:11], s7 offen offset:0 sc1
  ds_write_b128 v112, v[64:67] offset:16384
  buffer_store_dwordx4 v[68:71], v0, s[8:11], s7 offen offset:1024 sc1
  ds_write_b128 v112, v[68:71] offset:17408
  buffer_load_dword v115, v114, s[8:11], s44 offen sc1
  v_pk_mul_f32 v[32:33], v[32:33], v[92:93]
  v_pk_mul_f32 v[34:35], v[34:35], v[92:93]
  v_pk_mul_f32 v[36:37], v[36:37], v[92:93]
  v_pk_mul_f32 v[38:39], v[38:39], v[92:93]
  v_pk_mul_f32 v[40:41], v[40:41], v[92:93]
  v_pk_mul_f32 v[42:43], v[42:43], v[92:93]
  v_pk_mul_f32 v[44:45], v[44:45], v[92:93]
  v_pk_mul_f32 v[46:47], v[46:47], v[92:93]
  v_cvt_pk_bf16_f32 v32, v32, v33
  v_cvt_pk_bf16_f32 v33, v34, v35
  v_cvt_pk_bf16_f32 v34, v36, v37
  v_cvt_pk_bf16_f32 v35, v38, v39
  v_cvt_pk_bf16_f32 v36, v40, v41
  v_cvt_pk_bf16_f32 v37, v42, v43
  v_cvt_pk_bf16_f32 v38, v44, v45
  v_cvt_pk_bf16_f32 v39, v46, v47
  ds_write_b128 v112, v[32:35] offset:0
  ds_write_b128 v112, v[36:39] offset:1024
  v_mov_b32 v127, s51
  s_cmp_eq_u32 s32, 0
  s_cbranch_scc1 L_p_first
L_p_att:
  s_sub_u32 s51, s33, 2
  s_and_b32 s6, s51, 3
  s_lshl_b32 s6, s6, 17
  s_add_u32 s47, s40, s6
  s_lshr_b32 s6, s51, 2
  s_andn2_b32 s50, 1, s6
  s_lshl_b32 s6, s51, 18
  s_add_u32 s48, s41, s6
  s_add_u32 s51, s51, 1
  buffer_load_dwordx4 v[116:119], v0, s[8:11], s47 offen sc1
  ds_read_b128 v[64:67], v3 offset:0
  ds_read_b128 v[32:35], v2 offset:0
  ds_read_b128 v[48:51], v2 offset:128
  ds_read_b128 v[68:71], v3 offset:2048
  ds_read_b128 v[36:39], v2 offset:2048
  ds_read_b128 v[52:55], v2 offset:2176
  ds_read_b128 v[72:75], v3 offset:4096
  ds_read_b128 v[40:43], v2 offset:4096
  ds_read_b128 v[56:59], v2 offset:4224
  ds_read_b128 v[76:79], v3 offset:6144
  ds_read_b128 v[44:47], v2 offset:6144
  ds_read_b128 v[60:63], v2 offset:6272
  s_waitcnt lgkmcnt(9)
  v_mfma_f32_16x16x32_bf16 v[96:99], v[32:35], v[64:67], v[24:27]
  v_mfma_f32_16x16x32_bf16 v[100:103], v[48:51], v[64:67], v[28:31]
  s_waitcnt lgkmcnt(6)
  v_mfma_f32_16x16x32_bf16 v[96:99], v[36:39], v[68:71], v[96:99]
  v_mfma_f32_16x16x32_bf16 v[100:103], v[52:55], v[68:71], v[100:103]
  s_waitcnt lgkmcnt(3)
  v_mfma_f32_16x16x32_bf16 v[96:99], v[40:43], v[72:75], v[96:99]
  v_mfma_f32_16x16x32_bf16 v[100:103], v[56:59], v[72:75], v[100:103]
  s_waitcnt lgkmcnt(0)
  v_mfma_f32_16x16x32_bf16 v[96:99], v[44:47], v[76:79], v[96:99]
  v_mfma_f32_16x16x32_bf16 v[100:103], v[60:63], v[76:79], v[100:103]
  ds_read_b128 v[80:83], v4 offset:0
  ds_read_b128 v[84:87], v4 offset:256
  ds_read_b128 v[88:91], v4 offset:2048
  ds_read_b128 v[92:95], v4 offset:2304
  s_waitcnt vmcnt(2)
  s_mov_b64 exec, 1
  buffer_store_dword v127, v13, s[8:11], s42 offen sc1
  s_mov_b64 exec, -1
  s_mov_b32 s7, 0
  s_waitcnt vmcnt(1)
  s_branch L_p_km1
L_p_km:
  s_waitcnt vmcnt(0)
L_p_km1:
  v_bitop3_b32 v126, v116, s50, 1 bitop3:0x28
  v_cmp_ne_u32 vcc, 0, v126
  s_cbranch_vccz L_p_kmok
  buffer_load_dwordx4 v[116:119], v0, s[8:11], s47 offen sc1
  s_add_u32 s7, s7, 1
  s_cmp_lt_u32 s7, 131072
  s_cbranch_scc1 L_p_km
  s_mov_b32 s6, 23
  s_branch L_err
L_p_kmok:
  ds_write_b64 v5, v[116:117]
  ds_write_b64 v5, v[118:119] offset:128
  v_max3_f32 v124, v96, v97, v98
  v_max3_f32 v125, v100, v101, v102
  v_max3_f32 v124, v124, v99, v103
  s_waitcnt lgkmcnt(0)
  s_barrier
  ds_read_b64_tr_b16 v[32:33], v6 offset:0
  ds_read_b64_tr_b16 v[34:35], v6 offset:64
  ds_read_b64_tr_b16 v[36:37], v6 offset:256
  ds_read_b64_tr_b16 v[38:39], v6 offset:320
  ds_read_b64_tr_b16 v[40:41], v6 offset:512
  ds_read_b64_tr_b16 v[42:43], v6 offset:576
  ds_read_b64_tr_b16 v[44:45], v6 offset:768
  ds_read_b64_tr_b16 v[46:47], v6 offset:832
  ds_read_b64 v[48:49], v7 offset:0
  ds_read_b64 v[50:51], v7 offset:128
  ds_read_b64 v[52:53], v7 offset:256
  ds_read_b64 v[54:55], v7 offset:384
  s_mov_b32 s52, 0
  s_cmp_ge_u32 s32, 31
  s_cbranch_scc1 L_nx_36
  v_cmp_gt_u32 vcc, s49, v115
  s_cbranch_vccnz L_nx_36
  s_mov_b32 s52, 1
  s_sub_u32 s6, s49, 1
  s_lshl_b32 s6, s6, 15
  s_add_u32 s45, s38, s6
  s_mov_b32 m0, s53
  s_add_u32 s6, s45, 4096
  buffer_load_dwordx4 v0, s[8:11], s45 offen offset:0 lds
  buffer_load_dwordx4 v0, s[8:11], s45 offen offset:1024 lds
  buffer_load_dwordx4 v0, s[8:11], s45 offen offset:2048 lds
  buffer_load_dwordx4 v0, s[8:11], s45 offen offset:3072 lds
  s_add_u32 m0, s53, 4096
  s_nop 0
  buffer_load_dwordx4 v0, s[8:11], s6 offen offset:0 lds
  buffer_load_dwordx4 v0, s[8:11], s6 offen offset:1024 lds
  buffer_load_dwordx4 v0, s[8:11], s6 offen offset:2048 lds
  buffer_load_dwordx4 v0, s[8:11], s6 offen offset:3072 lds
L_nx_36:
  s_waitcnt lgkmcnt(10)
  v_mfma_f32_16x16x32_bf16 v[104:107], v[32:35], v[64:67], 0
  s_waitcnt lgkmcnt(8)
  v_mfma_f32_16x16x32_bf16 v[104:107], v[36:39], v[68:71], v[104:107]
  s_waitcnt lgkmcnt(6)
  v_mfma_f32_16x16x32_bf16 v[104:107], v[40:43], v[72:75], v[104:107]
  s_waitcnt lgkmcnt(4)
  v_mfma_f32_16x16x32_bf16 v[104:107], v[44:47], v[76:79], v[104:107]
  v_max_f32 v124, v124, v125
  s_nop 6
  v_max3_f32 v124, v124, v106, v107
  v_mov_b32 v125, v124
  s_nop 1
  v_permlane32_swap_b32 v124, v125
  v_max_f32 v124, v124, v125
  v_max_f32 v125, v124, v125
  s_nop 1
  v_permlane16_swap_b32 v124, v125
  v_max_f32 v124, v124, v125
  v_mul_f32 v124, s34, v124
  v_fma_f32 v106, v106, s34, -v124
  v_fma_f32 v107, v107, s34, -v124
  v_fma_f32 v96, v96, s34, -v124
  v_fma_f32 v97, v97, s34, -v124
  v_fma_f32 v98, v98, s34, -v124
  v_fma_f32 v99, v99, s34, -v124
  v_fma_f32 v100, v100, s34, -v124
  v_fma_f32 v101, v101, s34, -v124
  v_fma_f32 v102, v102, s34, -v124
  v_fma_f32 v103, v103, s34, -v124
  v_exp_f32 v106, v106
  v_exp_f32 v107, v107
  v_exp_f32 v96, v96
  v_cvt_pk_bf16_f32 v12, v106, v107
  v_exp_f32 v97, v97
  s_waitcnt lgkmcnt(0)
  v_mfma_f32_16x16x16_bf16 v[108:111], v[10:11], v[12:13], 0
  v_mfma_f32_16x16x16_bf16 v[56:59], v[48:49], v[12:13], 0
  v_exp_f32 v98, v98
  v_exp_f32 v99, v99
  v_mfma_f32_16x16x16_bf16 v[60:63], v[50:51], v[12:13], 0
  v_exp_f32 v100, v100
  v_exp_f32 v101, v101
  v_mfma_f32_16x16x16_bf16 v[64:67], v[52:53], v[12:13], 0
  v_exp_f32 v102, v102
  v_exp_f32 v103, v103
  v_mfma_f32_16x16x16_bf16 v[68:71], v[54:55], v[12:13], 0
  v_cvt_pk_bf16_f32 v120, v96, v97
  v_cvt_pk_bf16_f32 v121, v98, v99
  v_cvt_pk_bf16_f32 v122, v100, v101
  v_cvt_pk_bf16_f32 v123, v102, v103
  v_mfma_f32_16x16x16_bf16 v[108:111], v[10:11], v[120:121], v[108:111]
  s_nop 0
  v_mfma_f32_16x16x16_bf16 v[108:111], v[10:11], v[122:123], v[108:111]
  v_mfma_f32_16x16x32_bf16 v[56:59], v[80:83], v[120:123], v[56:59]
  v_mfma_f32_16x16x32_bf16 v[60:63], v[84:87], v[120:123], v[60:63]
  v_mfma_f32_16x16x32_bf16 v[64:67], v[88:91], v[120:123], v[64:67]
  v_mfma_f32_16x16x32_bf16 v[68:71], v[92:95], v[120:123], v[68:71]
  s_nop 3
  v_rcp_f32 v108, v108
  v_mov_b32 v126, s51
  v_pk_mul_f32 v[56:57], v[56:57], v[108:109] op_sel_hi:[1,0]
  v_pk_mul_f32 v[58:59], v[58:59], v[108:109] op_sel_hi:[1,0]
  v_pk_mul_f32 v[60:61], v[60:61], v[108:109] op_sel_hi:[1,0]
  v_pk_mul_f32 v[62:63], v[62:63], v[108:109] op_sel_hi:[1,0]
  v_cvt_pk_bf16_f32 v56, v56, v57
  v_cvt_pk_bf16_f32 v57, v58, v59
  v_cvt_pk_bf16_f32 v58, v60, v61
  v_cvt_pk_bf16_f32 v59, v62, v63
  buffer_store_dwordx4 v[56:59], v113, s[8:11], s48 offen offset:0 sc1
  v_pk_mul_f32 v[64:65], v[64:65], v[108:109] op_sel_hi:[1,0]
  v_pk_mul_f32 v[66:67], v[66:67], v[108:109] op_sel_hi:[1,0]
  v_pk_mul_f32 v[68:69], v[68:69], v[108:109] op_sel_hi:[1,0]
  v_pk_mul_f32 v[70:71], v[70:71], v[108:109] op_sel_hi:[1,0]
  v_cvt_pk_bf16_f32 v64, v64, v65
  v_cvt_pk_bf16_f32 v65, v66, v67
  v_cvt_pk_bf16_f32 v66, v68, v69
  v_cvt_pk_bf16_f32 v67, v70, v71
  buffer_store_dwordx4 v[64:67], v113, s[8:11], s48 offen offset:2048 sc1
  s_waitcnt vmcnt(0)
  s_mov_b64 exec, 1
  buffer_store_dword v126, v13, s[8:11], s43 offen sc1
  s_mov_b64 exec, -1
L_p_next:
  v_xor_b32 v2, 0x18000, v2
  v_xor_b32 v3, 0x18000, v3
  v_xor_b32 v4, 0x18000, v4
  v_xor_b32 v112, 0x18000, v112
  s_add_u32 s32, s32, 1
  s_add_u32 s33, s33, 2
  s_cmp_gt_u32 s32, 32
  s_cbranch_scc1 L_p_end
  s_cmp_eq_u32 s32, 32
  s_cbranch_scc1 L_p_tail
  s_cmp_eq_u32 s52, 0
  s_cbranch_scc1 L_p_xwait
  s_branch L_p_loop
L_p_tail:
  s_waitcnt lgkmcnt(0)
  s_barrier
  s_branch L_p_att
L_p_first:
  s_waitcnt vmcnt(1)
  s_mov_b64 exec, 1
  buffer_store_dword v127, v13, s[8:11], s42 offen sc1
  s_mov_b64 exec, -1
  s_waitcnt vmcnt(1) lgkmcnt(0)
  s_barrier
  s_mov_b32 s52, 0
  s_cmp_ge_u32 s32, 31
  s_cbranch_scc1 L_nx_37
  v_cmp_gt_u32 vcc, s49, v115
  s_cbranch_vccnz L_nx_37
  s_mov_b32 s52, 1
  s_sub_u32 s6, s49, 1
  s_lshl_b32 s6, s6, 15
  s_add_u32 s45, s38, s6
  s_mov_b32 m0, s53
  s_add_u32 s6, s45, 4096
  buffer_load_dwordx4 v0, s[8:11], s45 offen offset:0 lds
  buffer_load_dwordx4 v0, s[8:11], s45 offen offset:1024 lds
  buffer_load_dwordx4 v0, s[8:11], s45 offen offset:2048 lds
  buffer_load_dwordx4 v0, s[8:11], s45 offen offset:3072 lds
  s_add_u32 m0, s53, 4096
  s_nop 0
  buffer_load_dwordx4 v0, s[8:11], s6 offen offset:0 lds
  buffer_load_dwordx4 v0, s[8:11], s6 offen offset:1024 lds
  buffer_load_dwordx4 v0, s[8:11], s6 offen offset:2048 lds
  buffer_load_dwordx4 v0, s[8:11], s6 offen offset:3072 lds
L_nx_37:
  s_waitcnt vmcnt(0)
  s_branch L_p_next
L_p_end:
  s_waitcnt vmcnt(0)
  s_endpgm
L_o:
  s_lshr_b32 s33, s5, 4
  s_bfe_u32 s34, s5, 0x20002
  s_and_b32 s35, s5, 3
  s_mul_i32 s36, s33, 0x1000000
  s_add_u32 s36, s36, 0x6800000
  s_lshl_b32 s6, s34, 3
  s_lshl_b32 s7, s3, 1
  s_add_u32 s6, s6, s7
  s_lshl_b32 s7, s6, 13
  s_add_u32 s36, s36, s7
  s_lshl_b32 s6, s6, 7
  s_lshl_b32 s7, s33, 13
  s_add_u32 s6, s6, s7
  s_add_u32 s38, s6, 0x718000
  s_mul_i32 s37, s33, 0x800000
  s_add_u32 s37, s37, 0x8800000
  s_lshl_b32 s6, s34, 15
  s_add_u32 s37, s37, s6
  s_lshl_b32 s6, s35, 13
  s_add_u32 s37, s37, s6
  s_lshl_b32 s6, s3, 11
  s_add_u32 s37, s37, s6
  s_lshl_b32 s6, s5, 7
  s_lshl_b32 s7, s3, 2
  s_add_u32 s6, s6, s7
  s_add_u32 s39, s6, 0x711000
  s_lshl_b32 s42, s3, 14
  v_mov_b32 v3, 0
  s_mov_b64 exec, 1
  buffer_store_dword v3, v3, s[8:11], s39 offen sc1
  s_mov_b64 exec, -1
  s_branch L_pro
L_o2:
  v_lshlrev_b32 v0, 4, v0
  s_mov_b32 s16, s88
  s_mov_b32 s17, s89
  s_mov_b32 s18, 0x400000
  s_mov_b32 s19, 0x20000
  v_lshrrev_b32 v104, 4, v0
  v_lshrrev_b32 v100, 8, v0
  v_lshlrev_b32 v105, 2, v100
  v_and_b32 v104, 15, v104
  v_xor_b32 v104, v104, v105
  v_mul_u32_u24 v100, 1024, v100
  v_lshl_add_u32 v100, v104, 4, v100
  v_bfe_u32 v104, v0, 6, 2
  v_lshlrev_b32 v105, 2, v104
  v_bfe_u32 v106, v0, 8, 1
  v_lshlrev_b32 v106, 1, v106
  v_bfe_u32 v107, v0, 5, 1
  v_or_b32 v106, v106, v107
  s_lshl_b32 s6, s3, 2
  v_or_b32 v106, s6, v106
  v_xor_b32 v106, v106, v105
  v_lshlrev_b32 v106, 4, v106
  v_bfe_u32 v107, v0, 4, 1
  v_lshl_or_b32 v106, v107, 3, v106
  v_bfe_u32 v107, v0, 9, 1
  v_lshl_or_b32 v104, v107, 2, v104
  v_lshl_or_b32 v104, v104, 8, v106
  v_add_u32 v105, 0x10000, v104
  s_lshl_b32 s60, s3, 13
  s_mul_i32 s63, s3, 32768
  s_lshl_b32 s61, s34, 20
  s_lshl_b32 s62, s35, 8
  s_add_u32 s61, s61, s62
  s_add_u32 s61, s61, 0
  s_add_u32 s61, s61, s63
  s_add_u32 m0, s60, 0
  s_add_u32 s62, s61, 0
  buffer_load_dwordx4 v100, s[16:19], s62 offen lds
  s_add_u32 m0, s60, 1024
  s_add_u32 s62, s61, 4096
  buffer_load_dwordx4 v100, s[16:19], s62 offen lds
  s_add_u32 m0, s60, 2048
  s_add_u32 s62, s61, 8192
  buffer_load_dwordx4 v100, s[16:19], s62 offen lds
  s_add_u32 m0, s60, 3072
  s_add_u32 s62, s61, 12288
  buffer_load_dwordx4 v100, s[16:19], s62 offen lds
  s_add_u32 m0, s60, 4096
  s_add_u32 s62, s61, 16384
  buffer_load_dwordx4 v100, s[16:19], s62 offen lds
  s_add_u32 m0, s60, 5120
  s_add_u32 s62, s61, 20480
  buffer_load_dwordx4 v100, s[16:19], s62 offen lds
  s_add_u32 m0, s60, 6144
  s_add_u32 s62, s61, 24576
  buffer_load_dwordx4 v100, s[16:19], s62 offen lds
  s_add_u32 m0, s60, 7168
  s_add_u32 s62, s61, 28672
  buffer_load_dwordx4 v100, s[16:19], s62 offen lds
  s_lshl_b32 s61, s34, 20
  s_lshl_b32 s62, s35, 8
  s_add_u32 s61, s61, s62
  s_add_u32 s61, s61, 131072
  s_add_u32 s61, s61, s63
  s_add_u32 m0, s60, 32768
  s_add_u32 s62, s61, 0
  buffer_load_dwordx4 v100, s[16:19], s62 offen lds
  s_add_u32 m0, s60, 33792
  s_add_u32 s62, s61, 4096
  buffer_load_dwordx4 v100, s[16:19], s62 offen lds
  s_add_u32 m0, s60, 34816
  s_add_u32 s62, s61, 8192
  buffer_load_dwordx4 v100, s[16:19], s62 offen lds
  s_add_u32 m0, s60, 35840
  s_add_u32 s62, s61, 12288
  buffer_load_dwordx4 v100, s[16:19], s62 offen lds
  s_add_u32 m0, s60, 36864
  s_add_u32 s62, s61, 16384
  buffer_load_dwordx4 v100, s[16:19], s62 offen lds
  s_add_u32 m0, s60, 37888
  s_add_u32 s62, s61, 20480
  buffer_load_dwordx4 v100, s[16:19], s62 offen lds
  s_add_u32 m0, s60, 38912
  s_add_u32 s62, s61, 24576
  buffer_load_dwordx4 v100, s[16:19], s62 offen lds
  s_add_u32 m0, s60, 39936
  s_add_u32 s62, s61, 28672
  buffer_load_dwordx4 v100, s[16:19], s62 offen lds
  s_lshl_b32 s61, s34, 20
  s_lshl_b32 s62, s35, 8
  s_add_u32 s61, s61, s62
  s_add_u32 s61, s61, 262144
  s_add_u32 s61, s61, s63
  s_add_u32 m0, s60, 65536
  s_add_u32 s62, s61, 0
  buffer_load_dwordx4 v100, s[16:19], s62 offen lds
  s_add_u32 m0, s60, 66560
  s_add_u32 s62, s61, 4096
  buffer_load_dwordx4 v100, s[16:19], s62 offen lds
  s_add_u32 m0, s60, 67584
  s_add_u32 s62, s61, 8192
  buffer_load_dwordx4 v100, s[16:19], s62 offen lds
  s_add_u32 m0, s60, 68608
  s_add_u32 s62, s61, 12288
  buffer_load_dwordx4 v100, s[16:19], s62 offen lds
  s_add_u32 m0, s60, 69632
  s_add_u32 s62, s61, 16384
  buffer_load_dwordx4 v100, s[16:19], s62 offen lds
  s_add_u32 m0, s60, 70656
  s_add_u32 s62, s61, 20480
  buffer_load_dwordx4 v100, s[16:19], s62 offen lds
  s_add_u32 m0, s60, 71680
  s_add_u32 s62, s61, 24576
  buffer_load_dwordx4 v100, s[16:19], s62 offen lds
  s_add_u32 m0, s60, 72704
  s_add_u32 s62, s61, 28672
  buffer_load_dwordx4 v100, s[16:19], s62 offen lds
  s_waitcnt vmcnt(16)
  s_barrier
  s_lshl_b32 s61, s34, 20
  s_lshl_b32 s62, s35, 8
  s_add_u32 s61, s61, s62
  s_add_u32 s61, s61, 393216
  s_add_u32 s61, s61, s63
  s_add_u32 m0, s60, 98304
  s_add_u32 s62, s61, 0
  buffer_load_dwordx4 v100, s[16:19], s62 offen lds
  s_add_u32 m0, s60, 99328
  s_add_u32 s62, s61, 4096
  buffer_load_dwordx4 v100, s[16:19], s62 offen lds
  s_add_u32 m0, s60, 100352
  s_add_u32 s62, s61, 8192
  buffer_load_dwordx4 v100, s[16:19], s62 offen lds
  s_add_u32 m0, s60, 101376
  s_add_u32 s62, s61, 12288
  buffer_load_dwordx4 v100, s[16:19], s62 offen lds
  s_add_u32 m0, s60, 102400
  s_add_u32 s62, s61, 16384
  buffer_load_dwordx4 v100, s[16:19], s62 offen lds
  s_add_u32 m0, s60, 103424
  s_add_u32 s62, s61, 20480
  buffer_load_dwordx4 v100, s[16:19], s62 offen lds
  s_add_u32 m0, s60, 104448
  s_add_u32 s62, s61, 24576
  buffer_load_dwordx4 v100, s[16:19], s62 offen lds
  s_add_u32 m0, s60, 105472
  s_add_u32 s62, s61, 28672
  buffer_load_dwordx4 v100, s[16:19], s62 offen lds
  ds_read_b64_tr_b16 a[0:1], v104 offset:0
  ds_read_b64_tr_b16 a[2:3], v104 offset:4096
  ds_read_b64_tr_b16 a[4:5], v104 offset:2048
  ds_read_b64_tr_b16 a[6:7], v104 offset:6144
  ds_read_b64_tr_b16 a[8:9], v104 offset:8192
  ds_read_b64_tr_b16 a[10:11], v104 offset:12288
  ds_read_b64_tr_b16 a[12:13], v104 offset:10240
  ds_read_b64_tr_b16 a[14:15], v104 offset:14336
  ds_read_b64_tr_b16 a[16:17], v104 offset:16384
  ds_read_b64_tr_b16 a[18:19], v104 offset:20480
  ds_read_b64_tr_b16 a[20:21], v104 offset:18432
  ds_read_b64_tr_b16 a[22:23], v104 offset:22528
  ds_read_b64_tr_b16 a[24:25], v104 offset:24576
  ds_read_b64_tr_b16 a[26:27], v104 offset:28672
  ds_read_b64_tr_b16 a[28:29], v104 offset:26624
  ds_read_b64_tr_b16 a[30:31], v104 offset:30720
  s_waitcnt lgkmcnt(0)
  s_waitcnt vmcnt(16)
  s_barrier
  s_lshl_b32 s61, s34, 20
  s_lshl_b32 s62, s35, 8
  s_add_u32 s61, s61, s62
  s_add_u32 s61, s61, 524288
  s_add_u32 s61, s61, s63
  s_add_u32 m0, s60, 0
  s_add_u32 s62, s61, 0
  buffer_load_dwordx4 v100, s[16:19], s62 offen lds
  s_add_u32 m0, s60, 1024
  s_add_u32 s62, s61, 4096
  buffer_load_dwordx4 v100, s[16:19], s62 offen lds
  s_add_u32 m0, s60, 2048
  s_add_u32 s62, s61, 8192
  buffer_load_dwordx4 v100, s[16:19], s62 offen lds
  s_add_u32 m0, s60, 3072
  s_add_u32 s62, s61, 12288
  buffer_load_dwordx4 v100, s[16:19], s62 offen lds
  s_add_u32 m0, s60, 4096
  s_add_u32 s62, s61, 16384
  buffer_load_dwordx4 v100, s[16:19], s62 offen lds
  s_add_u32 m0, s60, 5120
  s_add_u32 s62, s61, 20480
  buffer_load_dwordx4 v100, s[16:19], s62 offen lds
  s_add_u32 m0, s60, 6144
  s_add_u32 s62, s61, 24576
  buffer_load_dwordx4 v100, s[16:19], s62 offen lds
  s_add_u32 m0, s60, 7168
  s_add_u32 s62, s61, 28672
  buffer_load_dwordx4 v100, s[16:19], s62 offen lds
  ds_read_b64_tr_b16 a[32:33], v104 offset:32768
  ds_read_b64_tr_b16 a[34:35], v104 offset:36864
  ds_read_b64_tr_b16 a[36:37], v104 offset:34816
  ds_read_b64_tr_b16 a[38:39], v104 offset:38912
  ds_read_b64_tr_b16 a[40:41], v104 offset:40960
  ds_read_b64_tr_b16 a[42:43], v104 offset:45056
  ds_read_b64_tr_b16 a[44:45], v104 offset:43008
  ds_read_b64_tr_b16 a[46:47], v104 offset:47104
  ds_read_b64_tr_b16 a[48:49], v104 offset:49152
  ds_read_b64_tr_b16 a[50:51], v104 offset:53248
  ds_read_b64_tr_b16 a[52:53], v104 offset:51200
  ds_read_b64_tr_b16 a[54:55], v104 offset:55296
  ds_read_b64_tr_b16 a[56:57], v104 offset:57344
  ds_read_b64_tr_b16 a[58:59], v104 offset:61440
  ds_read_b64_tr_b16 a[60:61], v104 offset:59392
  ds_read_b64_tr_b16 a[62:63], v104 offset:63488
  s_waitcnt lgkmcnt(0)
  s_waitcnt vmcnt(16)
  s_barrier
  s_lshl_b32 s61, s34, 20
  s_lshl_b32 s62, s35, 8
  s_add_u32 s61, s61, s62
  s_add_u32 s61, s61, 655360
  s_add_u32 s61, s61, s63
  s_add_u32 m0, s60, 32768
  s_add_u32 s62, s61, 0
  buffer_load_dwordx4 v100, s[16:19], s62 offen lds
  s_add_u32 m0, s60, 33792
  s_add_u32 s62, s61, 4096
  buffer_load_dwordx4 v100, s[16:19], s62 offen lds
  s_add_u32 m0, s60, 34816
  s_add_u32 s62, s61, 8192
  buffer_load_dwordx4 v100, s[16:19], s62 offen lds
  s_add_u32 m0, s60, 35840
  s_add_u32 s62, s61, 12288
  buffer_load_dwordx4 v100, s[16:19], s62 offen lds
  s_add_u32 m0, s60, 36864
  s_add_u32 s62, s61, 16384
  buffer_load_dwordx4 v100, s[16:19], s62 offen lds
  s_add_u32 m0, s60, 37888
  s_add_u32 s62, s61, 20480
  buffer_load_dwordx4 v100, s[16:19], s62 offen lds
  s_add_u32 m0, s60, 38912
  s_add_u32 s62, s61, 24576
  buffer_load_dwordx4 v100, s[16:19], s62 offen lds
  s_add_u32 m0, s60, 39936
  s_add_u32 s62, s61, 28672
  buffer_load_dwordx4 v100, s[16:19], s62 offen lds
  ds_read_b64_tr_b16 a[64:65], v105 offset:0
  ds_read_b64_tr_b16 a[66:67], v105 offset:4096
  ds_read_b64_tr_b16 a[68:69], v105 offset:2048
  ds_read_b64_tr_b16 a[70:71], v105 offset:6144
  ds_read_b64_tr_b16 a[72:73], v105 offset:8192
  ds_read_b64_tr_b16 a[74:75], v105 offset:12288
  ds_read_b64_tr_b16 a[76:77], v105 offset:10240
  ds_read_b64_tr_b16 a[78:79], v105 offset:14336
  ds_read_b64_tr_b16 a[80:81], v105 offset:16384
  ds_read_b64_tr_b16 a[82:83], v105 offset:20480
  ds_read_b64_tr_b16 a[84:85], v105 offset:18432
  ds_read_b64_tr_b16 a[86:87], v105 offset:22528
  ds_read_b64_tr_b16 a[88:89], v105 offset:24576
  ds_read_b64_tr_b16 a[90:91], v105 offset:28672
  ds_read_b64_tr_b16 a[92:93], v105 offset:26624
  ds_read_b64_tr_b16 a[94:95], v105 offset:30720
  s_waitcnt lgkmcnt(0)
  s_waitcnt vmcnt(16)
  s_barrier
  s_lshl_b32 s61, s34, 20
  s_lshl_b32 s62, s35, 8
  s_add_u32 s61, s61, s62
  s_add_u32 s61, s61, 786432
  s_add_u32 s61, s61, s63
  s_add_u32 m0, s60, 65536
  s_add_u32 s62, s61, 0
  buffer_load_dwordx4 v100, s[16:19], s62 offen lds
  s_add_u32 m0, s60, 66560
  s_add_u32 s62, s61, 4096
  buffer_load_dwordx4 v100, s[16:19], s62 offen lds
  s_add_u32 m0, s60, 67584
  s_add_u32 s62, s61, 8192
  buffer_load_dwordx4 v100, s[16:19], s62 offen lds
  s_add_u32 m0, s60, 68608
  s_add_u32 s62, s61, 12288
  buffer_load_dwordx4 v100, s[16:19], s62 offen lds
  s_add_u32 m0, s60, 69632
  s_add_u32 s62, s61, 16384
  buffer_load_dwordx4 v100, s[16:19], s62 offen lds
  s_add_u32 m0, s60, 70656
  s_add_u32 s62, s61, 20480
  buffer_load_dwordx4 v100, s[16:19], s62 offen lds
  s_add_u32 m0, s60, 71680
  s_add_u32 s62, s61, 24576
  buffer_load_dwordx4 v100, s[16:19], s62 offen lds
  s_add_u32 m0, s60, 72704
  s_add_u32 s62, s61, 28672
  buffer_load_dwordx4 v100, s[16:19], s62 offen lds
  ds_read_b64_tr_b16 a[96:97], v105 offset:32768
  ds_read_b64_tr_b16 a[98:99], v105 offset:36864
  ds_read_b64_tr_b16 a[100:101], v105 offset:34816
  ds_read_b64_tr_b16 a[102:103], v105 offset:38912
  ds_read_b64_tr_b16 a[104:105], v105 offset:40960
  ds_read_b64_tr_b16 a[106:107], v105 offset:45056
  ds_read_b64_tr_b16 a[108:109], v105 offset:43008
  ds_read_b64_tr_b16 a[110:111], v105 offset:47104
  ds_read_b64_tr_b16 a[112:113], v105 offset:49152
  ds_read_b64_tr_b16 a[114:115], v105 offset:53248
  ds_read_b64_tr_b16 a[116:117], v105 offset:51200
  ds_read_b64_tr_b16 a[118:119], v105 offset:55296
  ds_read_b64_tr_b16 a[120:121], v105 offset:57344
  ds_read_b64_tr_b16 a[122:123], v105 offset:61440
  ds_read_b64_tr_b16 a[124:125], v105 offset:59392
  ds_read_b64_tr_b16 a[126:127], v105 offset:63488
  s_waitcnt lgkmcnt(0)
  s_waitcnt vmcnt(16)
  s_barrier
  s_lshl_b32 s61, s34, 20
  s_lshl_b32 s62, s35, 8
  s_add_u32 s61, s61, s62
  s_add_u32 s61, s61, 917504
  s_add_u32 s61, s61, s63
  s_add_u32 m0, s60, 98304
  s_add_u32 s62, s61, 0
  buffer_load_dwordx4 v100, s[16:19], s62 offen lds
  s_add_u32 m0, s60, 99328
  s_add_u32 s62, s61, 4096
  buffer_load_dwordx4 v100, s[16:19], s62 offen lds
  s_add_u32 m0, s60, 100352
  s_add_u32 s62, s61, 8192
  buffer_load_dwordx4 v100, s[16:19], s62 offen lds
  s_add_u32 m0, s60, 101376
  s_add_u32 s62, s61, 12288
  buffer_load_dwordx4 v100, s[16:19], s62 offen lds
  s_add_u32 m0, s60, 102400
  s_add_u32 s62, s61, 16384
  buffer_load_dwordx4 v100, s[16:19], s62 offen lds
  s_add_u32 m0, s60, 103424
  s_add_u32 s62, s61, 20480
  buffer_load_dwordx4 v100, s[16:19], s62 offen lds
  s_add_u32 m0, s60, 104448
  s_add_u32 s62, s61, 24576
  buffer_load_dwordx4 v100, s[16:19], s62 offen lds
  s_add_u32 m0, s60, 105472
  s_add_u32 s62, s61, 28672
  buffer_load_dwordx4 v100, s[16:19], s62 offen lds
  ds_read_b64_tr_b16 a[128:129], v104 offset:0
  ds_read_b64_tr_b16 a[130:131], v104 offset:4096
  ds_read_b64_tr_b16 a[132:133], v104 offset:2048
  ds_read_b64_tr_b16 a[134:135], v104 offset:6144
  ds_read_b64_tr_b16 a[136:137], v104 offset:8192
  ds_read_b64_tr_b16 a[138:139], v104 offset:12288
  ds_read_b64_tr_b16 a[140:141], v104 offset:10240
  ds_read_b64_tr_b16 a[142:143], v104 offset:14336
  ds_read_b64_tr_b16 a[144:145], v104 offset:16384
  ds_read_b64_tr_b16 a[146:147], v104 offset:20480
  ds_read_b64_tr_b16 a[148:149], v104 offset:18432
  ds_read_b64_tr_b16 a[150:151], v104 offset:22528
  ds_read_b64_tr_b16 a[152:153], v104 offset:24576
  ds_read_b64_tr_b16 a[154:155], v104 offset:28672
  ds_read_b64_tr_b16 a[156:157], v104 offset:26624
  ds_read_b64_tr_b16 a[158:159], v104 offset:30720
  s_waitcnt lgkmcnt(0)
  s_waitcnt vmcnt(16)
  s_barrier
  ds_read_b64_tr_b16 a[160:161], v104 offset:32768
  ds_read_b64_tr_b16 a[162:163], v104 offset:36864
  ds_read_b64_tr_b16 a[164:165], v104 offset:34816
  ds_read_b64_tr_b16 a[166:167], v104 offset:38912
  ds_read_b64_tr_b16 a[168:169], v104 offset:40960
  ds_read_b64_tr_b16 a[170:171], v104 offset:45056
  ds_read_b64_tr_b16 a[172:173], v104 offset:43008
  ds_read_b64_tr_b16 a[174:175], v104 offset:47104
  ds_read_b64_tr_b16 a[176:177], v104 offset:49152
  ds_read_b64_tr_b16 a[178:179], v104 offset:53248
  ds_read_b64_tr_b16 a[180:181], v104 offset:51200
  ds_read_b64_tr_b16 a[182:183], v104 offset:55296
  ds_read_b64_tr_b16 a[184:185], v104 offset:57344
  ds_read_b64_tr_b16 a[186:187], v104 offset:61440
  ds_read_b64_tr_b16 a[188:189], v104 offset:59392
  ds_read_b64_tr_b16 a[190:191], v104 offset:63488
  s_waitcnt lgkmcnt(0)
  s_waitcnt vmcnt(8)
  s_barrier
  ds_read_b64_tr_b16 a[192:193], v105 offset:0
  ds_read_b64_tr_b16 a[194:195], v105 offset:4096
  ds_read_b64_tr_b16 a[196:197], v105 offset:2048
  ds_read_b64_tr_b16 a[198:199], v105 offset:6144
  ds_read_b64_tr_b16 a[200:201], v105 offset:8192
  ds_read_b64_tr_b16 a[202:203], v105 offset:12288
  ds_read_b64_tr_b16 a[204:205], v105 offset:10240
  ds_read_b64_tr_b16 a[206:207], v105 offset:14336
  ds_read_b64_tr_b16 a[208:209], v105 offset:16384
  ds_read_b64_tr_b16 a[210:211], v105 offset:20480
  ds_read_b64_tr_b16 a[212:213], v105 offset:18432
  ds_read_b64_tr_b16 a[214:215], v105 offset:22528
  ds_read_b64_tr_b16 a[216:217], v105 offset:24576
  ds_read_b64_tr_b16 a[218:219], v105 offset:28672
  ds_read_b64_tr_b16 a[220:221], v105 offset:26624
  ds_read_b64_tr_b16 a[222:223], v105 offset:30720
  s_waitcnt lgkmcnt(0)
  s_waitcnt vmcnt(0)
  s_barrier
  ds_read_b64_tr_b16 a[224:225], v105 offset:32768
  ds_read_b64_tr_b16 a[226:227], v105 offset:36864
  ds_read_b64_tr_b16 a[228:229], v105 offset:34816
  ds_read_b64_tr_b16 a[230:231], v105 offset:38912
  ds_read_b64_tr_b16 a[232:233], v105 offset:40960
  ds_read_b64_tr_b16 a[234:235], v105 offset:45056
  ds_read_b64_tr_b16 a[236:237], v105 offset:43008
  ds_read_b64_tr_b16 a[238:239], v105 offset:47104
  ds_read_b64_tr_b16 a[240:241], v105 offset:49152
  ds_read_b64_tr_b16 a[242:243], v105 offset:53248
  ds_read_b64_tr_b16 a[244:245], v105 offset:51200
  ds_read_b64_tr_b16 a[246:247], v105 offset:55296
  ds_read_b64_tr_b16 a[248:249], v105 offset:57344
  ds_read_b64_tr_b16 a[250:251], v105 offset:61440
  ds_read_b64_tr_b16 a[252:253], v105 offset:59392
  ds_read_b64_tr_b16 a[254:255], v105 offset:63488
  s_waitcnt lgkmcnt(0)
  s_barrier
  v_mov_b32 v3, 0
  v_mov_b32 v1, v0
  v_bfe_u32 v2, v0, 6, 1
  v_lshlrev_b32 v2, 7, v2
  v_bfe_u32 v4, v0, 2, 4
  v_or_b32 v2, v2, v4
  s_mov_b32 s7, 0
  v_mov_b32 v16, 128
L_wd_38:
  buffer_load_dword v17, v16, s[12:15], 0 offen sc1
  s_waitcnt vmcnt(0)
  v_cmp_ne_u32 vcc, 0x100, v17
  s_cbranch_vccz L_wdo_39
  s_add_u32 s7, s7, 1
  s_cmp_lt_u32 s7, 131072
  s_cbranch_scc1 L_wd_38
  s_mov_b32 s6, 30
  s_branch L_err
L_wdo_39:
  s_mov_b32 s32, 0
  s_mov_b32 s41, 1
  s_mov_b32 s40, s38
L_o_wait:
  s_mov_b32 s7, 0
L_pl_40:
  buffer_load_dword v4, v2, s[8:11], s40 offen offset:0 sc1
  s_waitcnt vmcnt(0)
  v_cmp_gt_u32 vcc, s41, v4
  s_cbranch_vccz L_plo_41
  s_add_u32 s7, s7, 1
  s_cmp_lt_u32 s7, 131072
  s_cbranch_scc1 L_pl_40
  s_mov_b32 s6, 31
  s_branch L_err
L_plo_41:
  s_sub_u32 s6, s41, 1
  s_lshl_b32 s6, s6, 18
  s_add_u32 s44, s36, s6
  s_add_u32 m0, s42, 0
  s_add_u32 s45, s44, 0
  buffer_load_dwordx4 v0, s[8:11], s45 offen offset:0 lds
  buffer_load_dwordx4 v0, s[8:11], s45 offen offset:1024 lds
  buffer_load_dwordx4 v0, s[8:11], s45 offen offset:2048 lds
  buffer_load_dwordx4 v0, s[8:11], s45 offen offset:3072 lds
  s_add_u32 m0, s42, 4096
  s_add_u32 s45, s44, 4096
  buffer_load_dwordx4 v0, s[8:11], s45 offen offset:0 lds
  buffer_load_dwordx4 v0, s[8:11], s45 offen offset:1024 lds
  buffer_load_dwordx4 v0, s[8:11], s45 offen offset:2048 lds
  buffer_load_dwordx4 v0, s[8:11], s45 offen offset:3072 lds
  s_add_u32 m0, s42, 8192
  s_add_u32 s45, s44, 8192
  buffer_load_dwordx4 v0, s[8:11], s45 offen offset:0 lds
  buffer_load_dwordx4 v0, s[8:11], s45 offen offset:1024 lds
  buffer_load_dwordx4 v0, s[8:11], s45 offen offset:2048 lds
  buffer_load_dwordx4 v0, s[8:11], s45 offen offset:3072 lds
  s_add_u32 m0, s42, 12288
  s_add_u32 s45, s44, 12288
  buffer_load_dwordx4 v0, s[8:11], s45 offen offset:0 lds
  buffer_load_dwordx4 v0, s[8:11], s45 offen offset:1024 lds
  buffer_load_dwordx4 v0, s[8:11], s45 offen offset:2048 lds
  buffer_load_dwordx4 v0, s[8:11], s45 offen offset:3072 lds
  s_xor_b32 s42, s42, 0x10000
  s_mov_b32 s43, 0
  s_waitcnt vmcnt(8)
L_o_loop:
  s_barrier
  ds_read_b128 v[32:35], v1 offset:0
  ds_read_b128 v[36:39], v1 offset:1024
  ds_read_b128 v[40:43], v1 offset:2048
  s_add_u32 s41, s32, 2
  s_xor_b32 s40, s40, 0x1000
  buffer_load_dword v4, v2, s[8:11], s40 offen sc1
  s_waitcnt lgkmcnt(2)
  v_mfma_f32_32x32x16_bf16 v[16:31], a[0:3], v[32:35], 0
  ds_read_b128 v[44:47], v1 offset:3072
  s_waitcnt lgkmcnt(2)
  v_mfma_f32_32x32x16_bf16 v[16:31], a[4:7], v[36:39], v[16:31]
  ds_read_b128 v[32:35], v1 offset:4096
  s_waitcnt lgkmcnt(2)
  v_mfma_f32_32x32x16_bf16 v[16:31], a[8:11], v[40:43], v[16:31]
  ds_read_b128 v[36:39], v1 offset:5120
  s_waitcnt lgkmcnt(2)
  v_mfma_f32_32x32x16_bf16 v[16:31], a[12:15], v[44:47], v[16:31]
  ds_read_b128 v[40:43], v1 offset:6144
  s_waitcnt lgkmcnt(2)
  v_mfma_f32_32x32x16_bf16 v[16:31], a[16:19], v[32:35], v[16:31]
  ds_read_b128 v[44:47], v1 offset:7168
  s_waitcnt lgkmcnt(2)
  v_mfma_f32_32x32x16_bf16 v[16:31], a[20:23], v[36:39], v[16:31]
  ds_read_b128 v[32:35], v1 offset:16384
  s_waitcnt lgkmcnt(2)
  v_mfma_f32_32x32x16_bf16 v[16:31], a[24:27], v[40:43], v[16:31]
  ds_read_b128 v[36:39], v1 offset:17408
  s_waitcnt lgkmcnt(2)
  v_mfma_f32_32x32x16_bf16 v[16:31], a[28:31], v[44:47], v[16:31]
  ds_read_b128 v[40:43], v1 offset:18432
  s_waitcnt lgkmcnt(2)
  v_mfma_f32_32x32x16_bf16 v[16:31], a[64:67], v[32:35], v[16:31]
  ds_read_b128 v[44:47], v1 offset:19456
  s_waitcnt lgkmcnt(2)
  v_mfma_f32_32x32x16_bf16 v[16:31], a[68:71], v[36:39], v[16:31]
  ds_read_b128 v[32:35], v1 offset:20480
  s_waitcnt lgkmcnt(2)
  v_mfma_f32_32x32x16_bf16 v[16:31], a[72:75], v[40:43], v[16:31]
  ds_read_b128 v[36:39], v1 offset:21504
  s_waitcnt lgkmcnt(2)
  v_mfma_f32_32x32x16_bf16 v[16:31], a[76:79], v[44:47], v[16:31]
  ds_read_b128 v[40:43], v1 offset:22528
  s_waitcnt lgkmcnt(2)
  v_mfma_f32_32x32x16_bf16 v[16:31], a[80:83], v[32:35], v[16:31]
  ds_read_b128 v[44:47], v1 offset:23552
  s_waitcnt lgkmcnt(2)
  v_mfma_f32_32x32x16_bf16 v[16:31], a[84:87], v[36:39], v[16:31]
  ds_read_b128 v[32:35], v1 offset:32768
  s_waitcnt lgkmcnt(2)
  v_mfma_f32_32x32x16_bf16 v[16:31], a[88:91], v[40:43], v[16:31]
  ds_read_b128 v[36:39], v1 offset:33792
  s_waitcnt lgkmcnt(2)
  v_mfma_f32_32x32x16_bf16 v[16:31], a[92:95], v[44:47], v[16:31]
  ds_read_b128 v[40:43], v1 offset:34816
  s_waitcnt lgkmcnt(2)
  v_mfma_f32_32x32x16_bf16 v[16:31], a[128:131], v[32:35], v[16:31]
  ds_read_b128 v[44:47], v1 offset:35840
  s_waitcnt lgkmcnt(2)
  v_mfma_f32_32x32x16_bf16 v[16:31], a[132:135], v[36:39], v[16:31]
  ds_read_b128 v[32:35], v1 offset:36864
  s_waitcnt lgkmcnt(2)
  v_mfma_f32_32x32x16_bf16 v[16:31], a[136:139], v[40:43], v[16:31]
  ds_read_b128 v[36:39], v1 offset:37888
  s_waitcnt lgkmcnt(2)
  v_mfma_f32_32x32x16_bf16 v[16:31], a[140:143], v[44:47], v[16:31]
  ds_read_b128 v[40:43], v1 offset:38912
  s_waitcnt lgkmcnt(2)
  v_mfma_f32_32x32x16_bf16 v[16:31], a[144:147], v[32:35], v[16:31]
  ds_read_b128 v[44:47], v1 offset:39936
  s_waitcnt lgkmcnt(2)
  v_mfma_f32_32x32x16_bf16 v[16:31], a[148:151], v[36:39], v[16:31]
  ds_read_b128 v[32:35], v1 offset:49152
  s_waitcnt lgkmcnt(2)
  v_mfma_f32_32x32x16_bf16 v[16:31], a[152:155], v[40:43], v[16:31]
  ds_read_b128 v[36:39], v1 offset:50176
  s_waitcnt lgkmcnt(2)
  v_mfma_f32_32x32x16_bf16 v[16:31], a[156:159], v[44:47], v[16:31]
  ds_read_b128 v[40:43], v1 offset:51200
  s_waitcnt lgkmcnt(2)
  v_mfma_f32_32x32x16_bf16 v[16:31], a[192:195], v[32:35], v[16:31]
  ds_read_b128 v[44:47], v1 offset:52224
  s_waitcnt lgkmcnt(2)
  v_mfma_f32_32x32x16_bf16 v[16:31], a[196:199], v[36:39], v[16:31]
  ds_read_b128 v[32:35], v1 offset:53248
  s_waitcnt lgkmcnt(2)
  v_mfma_f32_32x32x16_bf16 v[16:31], a[200:203], v[40:43], v[16:31]
  ds_read_b128 v[36:39], v1 offset:54272
  s_waitcnt lgkmcnt(2)
  v_mfma_f32_32x32x16_bf16 v[16:31], a[204:207], v[44:47], v[16:31]
  ds_read_b128 v[40:43], v1 offset:55296
  s_waitcnt lgkmcnt(2)
  v_mfma_f32_32x32x16_bf16 v[16:31], a[208:211], v[32:35], v[16:31]
  ds_read_b128 v[44:47], v1 offset:56320
  s_waitcnt lgkmcnt(2)
  v_mfma_f32_32x32x16_bf16 v[16:31], a[212:215], v[36:39], v[16:31]
  s_waitcnt lgkmcnt(1)
  v_mfma_f32_32x32x16_bf16 v[16:31], a[216:219], v[40:43], v[16:31]
  s_waitcnt lgkmcnt(0)
  v_mfma_f32_32x32x16_bf16 v[16:31], a[220:223], v[44:47], v[16:31]
  s_waitcnt vmcnt(0)
  s_barrier
  ds_read_b128 v[32:35], v1 offset:8192
  ds_read_b128 v[36:39], v1 offset:9216
  ds_read_b128 v[40:43], v1 offset:10240
  s_cmp_eq_u32 s43, 0
  s_cbranch_scc1 L_op_42
  s_mov_b64 exec, 1
  buffer_store_dword v5, v3, s[8:11], s39 offen sc1
  s_mov_b64 exec, -1
L_op_42:
  s_mov_b32 s43, 0
  s_cmp_eq_u32 s32, 63
  s_cbranch_scc1 L_on_43
  v_cmp_gt_u32 vcc, s41, v4
  s_cbranch_vccnz L_on_43
  s_mov_b32 s43, 1
  s_waitcnt lgkmcnt(2)
  v_mfma_f32_32x32x16_bf16 v[16:31], a[32:35], v[32:35], v[16:31]
  ds_read_b128 v[44:47], v1 offset:11264
  s_sub_u32 s6, s41, 1
  s_lshl_b32 s6, s6, 18
  s_add_u32 s44, s36, s6
  s_waitcnt lgkmcnt(2)
  v_mfma_f32_32x32x16_bf16 v[16:31], a[36:39], v[36:39], v[16:31]
  ds_read_b128 v[32:35], v1 offset:12288
  s_add_u32 m0, s42, 0
  s_add_u32 s45, s44, 0
  buffer_load_dwordx4 v0, s[8:11], s45 offen offset:0 lds
  s_waitcnt lgkmcnt(2)
  v_mfma_f32_32x32x16_bf16 v[16:31], a[40:43], v[40:43], v[16:31]
  ds_read_b128 v[36:39], v1 offset:13312
  buffer_load_dwordx4 v0, s[8:11], s45 offen offset:1024 lds
  s_waitcnt lgkmcnt(2)
  v_mfma_f32_32x32x16_bf16 v[16:31], a[44:47], v[44:47], v[16:31]
  ds_read_b128 v[40:43], v1 offset:14336
  buffer_load_dwordx4 v0, s[8:11], s45 offen offset:2048 lds
  s_waitcnt lgkmcnt(2)
  v_mfma_f32_32x32x16_bf16 v[16:31], a[48:51], v[32:35], v[16:31]
  ds_read_b128 v[44:47], v1 offset:15360
  buffer_load_dwordx4 v0, s[8:11], s45 offen offset:3072 lds
  s_waitcnt lgkmcnt(2)
  v_mfma_f32_32x32x16_bf16 v[16:31], a[52:55], v[36:39], v[16:31]
  ds_read_b128 v[32:35], v1 offset:24576
  s_waitcnt lgkmcnt(2)
  v_mfma_f32_32x32x16_bf16 v[16:31], a[56:59], v[40:43], v[16:31]
  ds_read_b128 v[36:39], v1 offset:25600
  s_add_u32 m0, s42, 4096
  s_add_u32 s45, s44, 4096
  buffer_load_dwordx4 v0, s[8:11], s45 offen offset:0 lds
  s_waitcnt lgkmcnt(2)
  v_mfma_f32_32x32x16_bf16 v[16:31], a[60:63], v[44:47], v[16:31]
  ds_read_b128 v[40:43], v1 offset:26624
  s_waitcnt lgkmcnt(2)
  v_mfma_f32_32x32x16_bf16 v[16:31], a[96:99], v[32:35], v[16:31]
  ds_read_b128 v[44:47], v1 offset:27648
  buffer_load_dwordx4 v0, s[8:11], s45 offen offset:1024 lds
  s_waitcnt lgkmcnt(2)
  v_mfma_f32_32x32x16_bf16 v[16:31], a[100:103], v[36:39], v[16:31]
  ds_read_b128 v[32:35], v1 offset:28672
  s_waitcnt lgkmcnt(2)
  v_mfma_f32_32x32x16_bf16 v[16:31], a[104:107], v[40:43], v[16:31]
  ds_read_b128 v[36:39], v1 offset:29696
  buffer_load_dwordx4 v0, s[8:11], s45 offen offset:2048 lds
  s_waitcnt lgkmcnt(2)
  v_mfma_f32_32x32x16_bf16 v[16:31], a[108:111], v[44:47], v[16:31]
  ds_read_b128 v[40:43], v1 offset:30720
  s_waitcnt lgkmcnt(2)
  v_mfma_f32_32x32x16_bf16 v[16:31], a[112:115], v[32:35], v[16:31]
  ds_read_b128 v[44:47], v1 offset:31744
  buffer_load_dwordx4 v0, s[8:11], s45 offen offset:3072 lds
  s_waitcnt lgkmcnt(2)
  v_mfma_f32_32x32x16_bf16 v[16:31], a[116:119], v[36:39], v[16:31]
  ds_read_b128 v[32:35], v1 offset:40960
  s_waitcnt lgkmcnt(2)
  v_mfma_f32_32x32x16_bf16 v[16:31], a[120:123], v[40:43], v[16:31]
  ds_read_b128 v[36:39], v1 offset:41984
  s_add_u32 m0, s42, 8192
  s_add_u32 s45, s44, 8192
  buffer_load_dwordx4 v0, s[8:11], s45 offen offset:0 lds
  s_waitcnt lgkmcnt(2)
  v_mfma_f32_32x32x16_bf16 v[16:31], a[124:127], v[44:47], v[16:31]
  ds_read_b128 v[40:43], v1 offset:43008
  s_waitcnt lgkmcnt(2)
  v_mfma_f32_32x32x16_bf16 v[16:31], a[160:163], v[32:35], v[16:31]
  ds_read_b128 v[44:47], v1 offset:44032
  buffer_load_dwordx4 v0, s[8:11], s45 offen offset:1024 lds
  s_waitcnt lgkmcnt(2)
  v_mfma_f32_32x32x16_bf16 v[16:31], a[164:167], v[36:39], v[16:31]
  ds_read_b128 v[32:35], v1 offset:45056
  s_waitcnt lgkmcnt(2)
  v_mfma_f32_32x32x16_bf16 v[16:31], a[168:171], v[40:43], v[16:31]
  ds_read_b128 v[36:39], v1 offset:46080
  buffer_load_dwordx4 v0, s[8:11], s45 offen offset:2048 lds
  s_waitcnt lgkmcnt(2)
  v_mfma_f32_32x32x16_bf16 v[16:31], a[172:175], v[44:47], v[16:31]
  ds_read_b128 v[40:43], v1 offset:47104
  s_waitcnt lgkmcnt(2)
  v_mfma_f32_32x32x16_bf16 v[16:31], a[176:179], v[32:35], v[16:31]
  ds_read_b128 v[44:47], v1 offset:48128
  buffer_load_dwordx4 v0, s[8:11], s45 offen offset:3072 lds
  s_waitcnt lgkmcnt(2)
  v_mfma_f32_32x32x16_bf16 v[16:31], a[180:183], v[36:39], v[16:31]
  ds_read_b128 v[32:35], v1 offset:57344
  s_waitcnt lgkmcnt(2)
  v_mfma_f32_32x32x16_bf16 v[16:31], a[184:187], v[40:43], v[16:31]
  ds_read_b128 v[36:39], v1 offset:58368
  s_add_u32 m0, s42, 12288
  s_add_u32 s45, s44, 12288
  buffer_load_dwordx4 v0, s[8:11], s45 offen offset:0 lds
  s_waitcnt lgkmcnt(2)
  v_mfma_f32_32x32x16_bf16 v[16:31], a[188:191], v[44:47], v[16:31]
  ds_read_b128 v[40:43], v1 offset:59392
  s_waitcnt lgkmcnt(2)
  v_mfma_f32_32x32x16_bf16 v[16:31], a[224:227], v[32:35], v[16:31]
  ds_read_b128 v[44:47], v1 offset:60416
  buffer_load_dwordx4 v0, s[8:11], s45 offen offset:1024 lds
  s_waitcnt lgkmcnt(2)
  v_mfma_f32_32x32x16_bf16 v[16:31], a[228:231], v[36:39], v[16:31]
  ds_read_b128 v[32:35], v1 offset:61440
  s_waitcnt lgkmcnt(2)
  v_mfma_f32_32x32x16_bf16 v[16:31], a[232:235], v[40:43], v[16:31]
  ds_read_b128 v[36:39], v1 offset:62464
  buffer_load_dwordx4 v0, s[8:11], s45 offen offset:2048 lds
  s_waitcnt lgkmcnt(2)
  v_mfma_f32_32x32x16_bf16 v[16:31], a[236:239], v[44:47], v[16:31]
  ds_read_b128 v[40:43], v1 offset:63488
  s_waitcnt lgkmcnt(2)
  v_mfma_f32_32x32x16_bf16 v[16:31], a[240:243], v[32:35], v[16:31]
  ds_read_b128 v[44:47], v1 offset:64512
  buffer_load_dwordx4 v0, s[8:11], s45 offen offset:3072 lds
  s_waitcnt lgkmcnt(2)
  v_mfma_f32_32x32x16_bf16 v[16:31], a[244:247], v[36:39], v[16:31]
  s_waitcnt lgkmcnt(1)
  v_mfma_f32_32x32x16_bf16 v[16:31], a[248:251], v[40:43], v[16:31]
  s_xor_b32 s42, s42, 0x10000
  s_waitcnt lgkmcnt(0)
  v_mfma_f32_32x32x16_bf16 v[16:31], a[252:255], v[44:47], v[16:31]
  s_branch L_o_h2
L_on_43:
  s_waitcnt lgkmcnt(2)
  v_mfma_f32_32x32x16_bf16 v[16:31], a[32:35], v[32:35], v[16:31]
  ds_read_b128 v[44:47], v1 offset:11264
  s_waitcnt lgkmcnt(2)
  v_mfma_f32_32x32x16_bf16 v[16:31], a[36:39], v[36:39], v[16:31]
  ds_read_b128 v[32:35], v1 offset:12288
  s_waitcnt lgkmcnt(2)
  v_mfma_f32_32x32x16_bf16 v[16:31], a[40:43], v[40:43], v[16:31]
  ds_read_b128 v[36:39], v1 offset:13312
  s_waitcnt lgkmcnt(2)
  v_mfma_f32_32x32x16_bf16 v[16:31], a[44:47], v[44:47], v[16:31]
  ds_read_b128 v[40:43], v1 offset:14336
  s_waitcnt lgkmcnt(2)
  v_mfma_f32_32x32x16_bf16 v[16:31], a[48:51], v[32:35], v[16:31]
  ds_read_b128 v[44:47], v1 offset:15360
  s_waitcnt lgkmcnt(2)
  v_mfma_f32_32x32x16_bf16 v[16:31], a[52:55], v[36:39], v[16:31]
  ds_read_b128 v[32:35], v1 offset:24576
  s_waitcnt lgkmcnt(2)
  v_mfma_f32_32x32x16_bf16 v[16:31], a[56:59], v[40:43], v[16:31]
  ds_read_b128 v[36:39], v1 offset:25600
  s_waitcnt lgkmcnt(2)
  v_mfma_f32_32x32x16_bf16 v[16:31], a[60:63], v[44:47], v[16:31]
  ds_read_b128 v[40:43], v1 offset:26624
  s_waitcnt lgkmcnt(2)
  v_mfma_f32_32x32x16_bf16 v[16:31], a[96:99], v[32:35], v[16:31]
  ds_read_b128 v[44:47], v1 offset:27648
  s_waitcnt lgkmcnt(2)
  v_mfma_f32_32x32x16_bf16 v[16:31], a[100:103], v[36:39], v[16:31]
  ds_read_b128 v[32:35], v1 offset:28672
  s_waitcnt lgkmcnt(2)
  v_mfma_f32_32x32x16_bf16 v[16:31], a[104:107], v[40:43], v[16:31]
  ds_read_b128 v[36:39], v1 offset:29696
  s_waitcnt lgkmcnt(2)
  v_mfma_f32_32x32x16_bf16 v[16:31], a[108:111], v[44:47], v[16:31]
  ds_read_b128 v[40:43], v1 offset:30720
  s_waitcnt lgkmcnt(2)
  v_mfma_f32_32x32x16_bf16 v[16:31], a[112:115], v[32:35], v[16:31]
  ds_read_b128 v[44:47], v1 offset:31744
  s_waitcnt lgkmcnt(2)
  v_mfma_f32_32x32x16_bf16 v[16:31], a[116:119], v[36:39], v[16:31]
  ds_read_b128 v[32:35], v1 offset:40960
  s_waitcnt lgkmcnt(2)
  v_mfma_f32_32x32x16_bf16 v[16:31], a[120:123], v[40:43], v[16:31]
  ds_read_b128 v[36:39], v1 offset:41984
  s_waitcnt lgkmcnt(2)
  v_mfma_f32_32x32x16_bf16 v[16:31], a[124:127], v[44:47], v[16:31]
  ds_read_b128 v[40:43], v1 offset:43008
  s_waitcnt lgkmcnt(2)
  v_mfma_f32_32x32x16_bf16 v[16:31], a[160:163], v[32:35], v[16:31]
  ds_read_b128 v[44:47], v1 offset:44032
  s_waitcnt lgkmcnt(2)
  v_mfma_f32_32x32x16_bf16 v[16:31], a[164:167], v[36:39], v[16:31]
  ds_read_b128 v[32:35], v1 offset:45056
  s_waitcnt lgkmcnt(2)
  v_mfma_f32_32x32x16_bf16 v[16:31], a[168:171], v[40:43], v[16:31]
  ds_read_b128 v[36:39], v1 offset:46080
  s_waitcnt lgkmcnt(2)
  v_mfma_f32_32x32x16_bf16 v[16:31], a[172:175], v[44:47], v[16:31]
  ds_read_b128 v[40:43], v1 offset:47104
  s_waitcnt lgkmcnt(2)
  v_mfma_f32_32x32x16_bf16 v[16:31], a[176:179], v[32:35], v[16:31]
  ds_read_b128 v[44:47], v1 offset:48128
  s_waitcnt lgkmcnt(2)
  v_mfma_f32_32x32x16_bf16 v[16:31], a[180:183], v[36:39], v[16:31]
  ds_read_b128 v[32:35], v1 offset:57344
  s_waitcnt lgkmcnt(2)
  v_mfma_f32_32x32x16_bf16 v[16:31], a[184:187], v[40:43], v[16:31]
  ds_read_b128 v[36:39], v1 offset:58368
  s_waitcnt lgkmcnt(2)
  v_mfma_f32_32x32x16_bf16 v[16:31], a[188:191], v[44:47], v[16:31]
  ds_read_b128 v[40:43], v1 offset:59392
  s_waitcnt lgkmcnt(2)
  v_mfma_f32_32x32x16_bf16 v[16:31], a[224:227], v[32:35], v[16:31]
  ds_read_b128 v[44:47], v1 offset:60416
  s_waitcnt lgkmcnt(2)
  v_mfma_f32_32x32x16_bf16 v[16:31], a[228:231], v[36:39], v[16:31]
  ds_read_b128 v[32:35], v1 offset:61440
  s_waitcnt lgkmcnt(2)
  v_mfma_f32_32x32x16_bf16 v[16:31], a[232:235], v[40:43], v[16:31]
  ds_read_b128 v[36:39], v1 offset:62464
  s_waitcnt lgkmcnt(2)
  v_mfma_f32_32x32x16_bf16 v[16:31], a[236:239], v[44:47], v[16:31]
  ds_read_b128 v[40:43], v1 offset:63488
  s_waitcnt lgkmcnt(2)
  v_mfma_f32_32x32x16_bf16 v[16:31], a[240:243], v[32:35], v[16:31]
  ds_read_b128 v[44:47], v1 offset:64512
  s_waitcnt lgkmcnt(2)
  v_mfma_f32_32x32x16_bf16 v[16:31], a[244:247], v[36:39], v[16:31]
  s_waitcnt lgkmcnt(1)
  v_mfma_f32_32x32x16_bf16 v[16:31], a[248:251], v[40:43], v[16:31]
  s_waitcnt lgkmcnt(0)
  v_mfma_f32_32x32x16_bf16 v[16:31], a[252:255], v[44:47], v[16:31]
L_o_h2:
  s_lshl_b32 s6, s32, 17
  s_add_u32 s44, s37, s6
  s_add_u32 s32, s32, 1
  v_xor_b32 v1, 0x10000, v1
  v_mov_b32 v5, s32
  s_nop 6
  v_cvt_pk_bf16_f32 v48, v16, v17
  v_cvt_pk_bf16_f32 v49, v18, v19
  v_cvt_pk_bf16_f32 v50, v20, v21
  v_cvt_pk_bf16_f32 v51, v22, v23
  buffer_store_dwordx4 v[48:51], v0, s[8:11], s44 offen offset:0 sc1
  v_cvt_pk_bf16_f32 v52, v24, v25
  v_cvt_pk_bf16_f32 v53, v26, v27
  v_cvt_pk_bf16_f32 v54, v28, v29
  v_cvt_pk_bf16_f32 v55, v30, v31
  buffer_store_dwordx4 v[52:55], v0, s[8:11], s44 offen offset:1024 sc1
  s_cmp_eq_u32 s43, 0
  s_waitcnt vmcnt(2)
  s_cbranch_scc0 L_o_loop
  s_waitcnt vmcnt(0)
  s_mov_b64 exec, 1
  buffer_store_dword v5, v3, s[8:11], s39 offen sc1
  s_mov_b64 exec, -1
  s_cmp_lt_u32 s32, 64
  s_cbranch_scc1 L_o_wait
  s_waitcnt vmcnt(0)
  s_endpgm
L_pro:
  s_max_u32 s6, s4, 3
  s_sub_u32 s6, s6, 3
  s_lshl_b32 s6, s6, 5
  s_add_u32 s6, s6, s5
  s_lshl_b32 s62, s6, 15
  s_lshl_b32 s6, s6, 2
  s_add_u32 s60, s6, s3
  s_lshl_b32 s6, s60, 2
  s_add_u32 s6, s6, 0x710000
  v_mov_b32 v1, 0
  v_lshlrev_b32 v2, 4, v0
  s_mov_b64 exec, 1
  buffer_store_dword v1, v1, s[8:11], s6 offen sc1
  s_mov_b64 exec, -1
  v_lshlrev_b32 v16, 2, v0
  s_lshl_b32 s6, s60, 8
  s_lshl_b32 s7, s60, 1
  s_mov_b32 s16, s66
  s_mov_b32 s17, s67
  s_mov_b32 s18, 0x20000
  s_mov_b32 s19, 0x20000
  buffer_load_dword v20, v16, s[16:19], s6 offen
  s_mov_b32 s20, s68
  s_mov_b32 s21, s69
  s_mov_b32 s22, 0x20000
  s_mov_b32 s23, 0x20000
  buffer_load_dword v21, v16, s[20:23], s6 offen
  s_mov_b32 s24, s70
  s_mov_b32 s25, s71
  s_mov_b32 s26, 0x20000
  s_mov_b32 s27, 0x20000
  buffer_load_dword v22, v16, s[24:27], s6 offen
  s_mov_b32 s28, s72
  s_mov_b32 s29, s73
  s_mov_b32 s30, 0x20000
  s_mov_b32 s31, 0x20000
  buffer_load_dword v23, v16, s[28:31], s6 offen
  s_mov_b32 s16, s74
  s_mov_b32 s17, s75
  s_mov_b32 s18, 0x400
  s_mov_b32 s19, 0x20000
  buffer_load_ushort v24, v1, s[16:19], s7 offen
  s_mov_b32 s20, s76
  s_mov_b32 s21, s77
  s_mov_b32 s22, 0x400
  s_mov_b32 s23, 0x20000
  buffer_load_ushort v232, v1, s[20:23], s7 offen
  s_waitcnt vmcnt(6)
  s_barrier
  s_cmp_lg_u32 s3, 0
  s_cbranch_scc1 L_sd_44
  s_mov_b64 exec, 1
  v_mov_b32 v18, 128
  v_mov_b32 v19, 1
  buffer_atomic_add v19, v18, s[12:15], 0 offen sc1
  s_mov_b64 exec, -1
L_sd_44:
  v_and_b32 v16, 15, v0
  v_and_b32 v17, 7, v16
  v_lshrrev_b32 v18, 3, v16
  v_lshl_add_u32 v19, v18, 7, v17
  v_add_u32 v19, 1, v19
  v_cvt_f32_u32 v4, v19
  v_and_b32 v19, 3, v16
  v_lshrrev_b32 v25, 2, v16
  v_lshlrev_b32 v25, 6, v25
  v_add_u32 v19, v19, v25
  v_lshlrev_b32 v19, 1, v19
  v_add_u32 v19, 258, v19
  v_cmp_gt_u32 vcc, 8, v16
  s_nop 1
  v_cndmask_b32 v19, 0, v19, vcc
  v_cvt_f32_u32 v5, v19
  v_and_b32 v19, 1, v16
  v_lshrrev_b32 v25, 1, v17
  v_lshlrev_b32 v25, 7, v25
  v_lshl_add_u32 v19, v19, 2, v25
  v_add_u32 v19, 516, v19
  v_lshlrev_b32 v25, 7, v17
  v_add_u32 v25, 1032, v25
  v_cndmask_b32 v19, v25, v19, vcc
  v_cvt_f32_u32 v6, v19
  v_lshlrev_b32 v19, 3, v16
  v_cvt_f32_u32 v7, v19
  v_lshrrev_b32 v19, 4, v0
  s_lshl_b32 s6, s3, 11
  v_lshl_add_u32 v3, v19, 6, s6
  v_lshlrev_b32 v16, 4, v0
  v_cvt_f32_u32 v16, v16
  s_mul_i32 s63, s3, 4352
  s_add_u32 s63, s63, 8192
  v_sub_f32 v17, 0x45800000, v16
  v_sub_f32 v18, 0x457fe000, v16
  v_cvt_pk_bf16_f32 v17, v17, v18
  v_lshlrev_b32 v160, 16, v17
  v_and_b32 v161, 0xffff0000, v17
  v_cvt_u32_f32 v160, v160
  v_cvt_u32_f32 v161, v161
  v_add_u32 v160, s63, v160
  v_add_u32 v161, s63, v161
  v_sub_f32 v17, 0x457fc000, v16
  v_sub_f32 v18, 0x457fa000, v16
  v_cvt_pk_bf16_f32 v17, v17, v18
  v_lshlrev_b32 v162, 16, v17
  v_and_b32 v163, 0xffff0000, v17
  v_cvt_u32_f32 v162, v162
  v_cvt_u32_f32 v163, v163
  v_add_u32 v162, s63, v162
  v_add_u32 v163, s63, v163
  v_sub_f32 v17, 0x457f8000, v16
  v_sub_f32 v18, 0x457f6000, v16
  v_cvt_pk_bf16_f32 v17, v17, v18
  v_lshlrev_b32 v164, 16, v17
  v_and_b32 v165, 0xffff0000, v17
  v_cvt_u32_f32 v164, v164
  v_cvt_u32_f32 v165, v165
  v_add_u32 v164, s63, v164
  v_add_u32 v165, s63, v165
  v_sub_f32 v17, 0x457f4000, v16
  v_sub_f32 v18, 0x457f2000, v16
  v_cvt_pk_bf16_f32 v17, v17, v18
  v_lshlrev_b32 v166, 16, v17
  v_and_b32 v167, 0xffff0000, v17
  v_cvt_u32_f32 v166, v166
  v_cvt_u32_f32 v167, v167
  v_add_u32 v166, s63, v166
  v_add_u32 v167, s63, v167
  v_sub_f32 v17, 0x45400000, v16
  v_sub_f32 v18, 0x453fe000, v16
  v_cvt_pk_bf16_f32 v17, v17, v18
  v_lshlrev_b32 v168, 16, v17
  v_and_b32 v169, 0xffff0000, v17
  v_cvt_u32_f32 v168, v168
  v_cvt_u32_f32 v169, v169
  v_add_u32 v168, s63, v168
  v_add_u32 v169, s63, v169
  v_sub_f32 v17, 0x453fc000, v16
  v_sub_f32 v18, 0x453fa000, v16
  v_cvt_pk_bf16_f32 v17, v17, v18
  v_lshlrev_b32 v170, 16, v17
  v_and_b32 v171, 0xffff0000, v17
  v_cvt_u32_f32 v170, v170
  v_cvt_u32_f32 v171, v171
  v_add_u32 v170, s63, v170
  v_add_u32 v171, s63, v171
  v_sub_f32 v17, 0x453f8000, v16
  v_sub_f32 v18, 0x453f6000, v16
  v_cvt_pk_bf16_f32 v17, v17, v18
  v_lshlrev_b32 v172, 16, v17
  v_and_b32 v173, 0xffff0000, v17
  v_cvt_u32_f32 v172, v172
  v_cvt_u32_f32 v173, v173
  v_add_u32 v172, s63, v172
  v_add_u32 v173, s63, v173
  v_sub_f32 v17, 0x453f4000, v16
  v_sub_f32 v18, 0x453f2000, v16
  v_cvt_pk_bf16_f32 v17, v17, v18
  v_lshlrev_b32 v174, 16, v17
  v_and_b32 v175, 0xffff0000, v17
  v_cvt_u32_f32 v174, v174
  v_cvt_u32_f32 v175, v175
  v_add_u32 v174, s63, v174
  v_add_u32 v175, s63, v175
  v_sub_f32 v17, 0x45000000, v16
  v_sub_f32 v18, 0x44ffc000, v16
  v_cvt_pk_bf16_f32 v17, v17, v18
  v_lshlrev_b32 v176, 16, v17
  v_and_b32 v177, 0xffff0000, v17
  v_cvt_u32_f32 v176, v176
  v_cvt_u32_f32 v177, v177
  v_add_u32 v176, s63, v176
  v_add_u32 v177, s63, v177
  v_sub_f32 v17, 0x44ff8000, v16
  v_sub_f32 v18, 0x44ff4000, v16
  v_cvt_pk_bf16_f32 v17, v17, v18
  v_lshlrev_b32 v178, 16, v17
  v_and_b32 v179, 0xffff0000, v17
  v_cvt_u32_f32 v178, v178
  v_cvt_u32_f32 v179, v179
  v_add_u32 v178, s63, v178
  v_add_u32 v179, s63, v179
  v_sub_f32 v17, 0x44ff0000, v16
  v_sub_f32 v18, 0x44fec000, v16
  v_cvt_pk_bf16_f32 v17, v17, v18
  v_lshlrev_b32 v180, 16, v17
  v_and_b32 v181, 0xffff0000, v17
  v_cvt_u32_f32 v180, v180
  v_cvt_u32_f32 v181, v181
  v_add_u32 v180, s63, v180
  v_add_u32 v181, s63, v181
  v_sub_f32 v17, 0x44fe8000, v16
  v_sub_f32 v18, 0x44fe4000, v16
  v_cvt_pk_bf16_f32 v17, v17, v18
  v_lshlrev_b32 v182, 16, v17
  v_and_b32 v183, 0xffff0000, v17
  v_cvt_u32_f32 v182, v182
  v_cvt_u32_f32 v183, v183
  v_add_u32 v182, s63, v182
  v_add_u32 v183, s63, v183
  v_sub_f32 v17, 0x44800000, v16
  v_sub_f32 v18, 0x447f8000, v16
  v_cvt_pk_bf16_f32 v17, v17, v18
  v_lshlrev_b32 v184, 16, v17
  v_and_b32 v185, 0xffff0000, v17
  v_cvt_u32_f32 v184, v184
  v_cvt_u32_f32 v185, v185
  v_add_u32 v184, s63, v184
  v_add_u32 v185, s63, v185
  v_sub_f32 v17, 0x447f0000, v16
  v_sub_f32 v18, 0x447e8000, v16
  v_cvt_pk_bf16_f32 v17, v17, v18
  v_lshlrev_b32 v186, 16, v17
  v_and_b32 v187, 0xffff0000, v17
  v_cvt_u32_f32 v186, v186
  v_cvt_u32_f32 v187, v187
  v_add_u32 v186, s63, v186
  v_add_u32 v187, s63, v187
  v_sub_f32 v17, 0x447e0000, v16
  v_sub_f32 v18, 0x447d8000, v16
  v_cvt_pk_bf16_f32 v17, v17, v18
  v_lshlrev_b32 v188, 16, v17
  v_and_b32 v189, 0xffff0000, v17
  v_cvt_u32_f32 v188, v188
  v_cvt_u32_f32 v189, v189
  v_add_u32 v188, s63, v188
  v_add_u32 v189, s63, v189
  v_sub_f32 v17, 0x447d0000, v16
  v_sub_f32 v18, 0x447c8000, v16
  v_cvt_pk_bf16_f32 v17, v17, v18
  v_lshlrev_b32 v190, 16, v17
  v_and_b32 v191, 0xffff0000, v17
  v_cvt_u32_f32 v190, v190
  v_cvt_u32_f32 v191, v191
  v_add_u32 v190, s63, v190
  v_add_u32 v191, s63, v191
  s_waitcnt vmcnt(1)
  v_lshlrev_b32 v24, 16, v24
  v_mul_f32 v26, 0x3fb8aa3b, v24
  v_mov_b32 v27, 0x3fb8aa3b
  v_fma_f32 v27, v24, v27, -v26
  v_fmac_f32 v27, 0x32a57060, v24
  v_exp_f32 v26, v26
  v_mul_f32 v27, 0x3f317218, v27
  v_fma_f32 v24, v26, v27, v26
  v_cvt_pk_bf16_f32 v24, v24, v24
  v_and_b32 v24, 0xffff0000, v24
  v_lshlrev_b32 v32, 16, v20
  v_and_b32 v36, 0xffff0000, v20
  v_lshlrev_b32 v33, 16, v21
  v_and_b32 v37, 0xffff0000, v21
  v_lshlrev_b32 v34, 16, v22
  v_and_b32 v38, 0xffff0000, v22
  v_lshlrev_b32 v35, 16, v23
  v_and_b32 v39, 0xffff0000, v23
  v_max3_f32 v28, |v34|, |v35|, |v38|
  v_max_f32 v28, |v39|, v28
  s_nop 1
  v_max_f32_dpp v28, v28, v28 quad_perm:[1,0,3,2] row_mask:0xf bank_mask:0xf
  s_nop 1
  v_max_f32_dpp v28, v28, v28 quad_perm:[2,3,0,1] row_mask:0xf bank_mask:0xf
  s_nop 1
  v_max_f32_dpp v28, v28, v28 row_half_mirror row_mask:0xf bank_mask:0xf
  s_nop 1
  v_max_f32_dpp v28, v28, v28 row_mirror row_mask:0xf bank_mask:0xf
  v_mov_b32 v29, v28
  s_nop 1
  v_permlane16_swap_b32 v28, v29
  v_max_f32 v28, v28, v29
  v_mov_b32 v29, v28
  s_nop 1
  v_permlane32_swap_b32 v28, v29
  v_max_f32 v28, v28, v29
  v_frexp_exp_i32_f32 v28, v28
  v_sub_u32 v29, 0, v28
  v_mul_f32 v26, 0x3fb8aa3b, v32
  v_mov_b32 v27, 0x3fb8aa3b
  v_fma_f32 v27, v32, v27, -v26
  v_fmac_f32 v27, 0x32a57060, v32
  v_exp_f32 v26, v26
  v_mul_f32 v27, 0x3f317218, v27
  v_fma_f32 v32, v26, v27, v26
  v_cvt_pk_bf16_f32 v32, v32, v32
  v_and_b32 v32, 0xffff0000, v32
  v_mul_f32 v32, v32, v24
  v_mul_f32 v33, v33, v24
  v_ldexp_f32 v34, v34, v29
  v_ldexp_f32 v35, v35, v29
  v_mul_f32 v32, 0xbfb8aa3b, v32
  v_mul_f32 v33, 0x3e22f983, v33
  v_mul_f32 v26, 0x3fb8aa3b, v36
  v_mov_b32 v27, 0x3fb8aa3b
  v_fma_f32 v27, v36, v27, -v26
  v_fmac_f32 v27, 0x32a57060, v36
  v_exp_f32 v26, v26
  v_mul_f32 v27, 0x3f317218, v27
  v_fma_f32 v36, v26, v27, v26
  v_cvt_pk_bf16_f32 v36, v36, v36
  v_and_b32 v36, 0xffff0000, v36
  v_mul_f32 v36, v36, v24
  v_mul_f32 v37, v37, v24
  v_ldexp_f32 v38, v38, v29
  v_ldexp_f32 v39, v39, v29
  v_mul_f32 v36, 0xbfb8aa3b, v36
  v_mul_f32 v37, 0x3e22f983, v37
  v_add_f32 v24, v24, v24
  v_ldexp_f32 v233, v24, v28
  s_lshl_b32 s6, s3, 11
  v_lshl_add_u32 v16, v0, 5, s6
  ds_write_b128 v16, v[32:35] offset:0
  ds_write_b128 v16, v[36:39] offset:16
  ds_read_b128 v[8:11], v3 offset:0
  v_mov_b32 v48, 0
  v_mov_b32 v49, 0
  v_mov_b32 v50, 0
  v_mov_b32 v51, 0
  v_mov_b32 v52, 0
  v_mov_b32 v53, 0
  v_mov_b32 v54, 0
  v_mov_b32 v55, 0
  v_mov_b32 v56, 0
  v_mov_b32 v57, 0
  v_mov_b32 v58, 0
  v_mov_b32 v59, 0
  v_mov_b32 v16, 0
  v_mov_b32 v17, 0
  v_mov_b32 v18, 0
  v_mov_b32 v19, 0
  v_mov_b32 v20, 0
  v_mov_b32 v21, 0
  v_mov_b32 v22, 0
  v_mov_b32 v23, 0
  v_mov_b32 v24, 0
  v_mov_b32 v25, 0
  v_mov_b32 v26, 0
  v_mov_b32 v27, 0
  v_mov_b32 v28, 0
  v_mov_b32 v29, 0
  v_mov_b32 v30, 0
  v_mov_b32 v31, 0
  s_mov_b32 s6, 2
L_kg_45:
  s_waitcnt lgkmcnt(0)
  ds_read_b128 v[12:15], v3 offset:16
  v_mfma_f32_16x16x32_f16 v[48:51], v[16:19], v[28:31], v[48:51]
  v_pk_mul_f32 v[38:39], v[8:9], v[6:7] op_sel:[0,1] op_sel_hi:[1,1]
  v_mfma_f32_16x16x32_f16 v[52:55], v[20:23], v[28:31], v[52:55]
  v_pk_mul_f32 v[32:33], v[8:9], v[4:5] op_sel:[0,0] op_sel_hi:[1,0]
  v_mfma_f32_16x16x32_f16 v[56:59], v[24:27], v[28:31], v[56:59]
  v_pk_mul_f32 v[34:35], v[8:9], v[4:5] op_sel:[0,1] op_sel_hi:[1,1]
  v_pk_mul_f32 v[36:37], v[8:9], v[6:7] op_sel:[0,0] op_sel_hi:[1,0]
  v_fract_f32 v39, v39
  v_fract_f32 v33, v33
  v_fract_f32 v35, v35
  v_fract_f32 v37, v37
  v_exp_f32 v38, v38
  v_cos_f32 v46, v39
  v_sin_f32 v47, v39
  v_exp_f32 v32, v32
  v_cos_f32 v40, v33
  v_sin_f32 v41, v33
  v_exp_f32 v34, v34
  v_cos_f32 v42, v35
  v_sin_f32 v43, v35
  v_exp_f32 v36, v36
  v_cos_f32 v44, v37
  v_sin_f32 v45, v37
  v_pk_mul_f32 v[46:47], v[46:47], v[38:39] op_sel_hi:[1,0]
  v_pk_mul_f32 v[40:41], v[40:41], v[32:33] op_sel_hi:[1,0]
  v_pk_mul_f32 v[42:43], v[42:43], v[34:35] op_sel_hi:[1,0]
  v_pk_mul_f32 v[44:45], v[44:45], v[36:37] op_sel_hi:[1,0]
  v_pk_mul_f32 v[32:33], v[46:47], v[10:11] op_sel_hi:[1,0] neg_hi:[1,0]
  v_cvt_pk_f16_f32 v16, v40, v41
  v_pk_fma_f32 v[32:33], v[46:47], v[10:11], v[32:33] op_sel:[1,1,0] op_sel_hi:[0,1,1] neg_lo:[1,0,0] neg_hi:[1,0,0]
  v_cvt_pk_f16_f32 v20, v42, v43
  v_cvt_pk_f16_f32 v24, v44, v45
  v_cvt_pk_f16_f32 v28, v32, v33
  s_waitcnt lgkmcnt(0)
  ds_read_b128 v[8:11], v3 offset:32
  v_pk_mul_f32 v[38:39], v[12:13], v[6:7] op_sel:[0,1] op_sel_hi:[1,1]
  v_pk_mul_f32 v[32:33], v[12:13], v[4:5] op_sel:[0,0] op_sel_hi:[1,0]
  v_pk_mul_f32 v[34:35], v[12:13], v[4:5] op_sel:[0,1] op_sel_hi:[1,1]
  v_pk_mul_f32 v[36:37], v[12:13], v[6:7] op_sel:[0,0] op_sel_hi:[1,0]
  v_fract_f32 v39, v39
  v_fract_f32 v33, v33
  v_fract_f32 v35, v35
  v_fract_f32 v37, v37
  v_exp_f32 v38, v38
  v_cos_f32 v46, v39
  v_sin_f32 v47, v39
  v_exp_f32 v32, v32
  v_cos_f32 v40, v33
  v_sin_f32 v41, v33
  v_exp_f32 v34, v34
  v_cos_f32 v42, v35
  v_sin_f32 v43, v35
  v_exp_f32 v36, v36
  v_cos_f32 v44, v37
  v_sin_f32 v45, v37
  v_pk_mul_f32 v[46:47], v[46:47], v[38:39] op_sel_hi:[1,0]
  v_pk_mul_f32 v[40:41], v[40:41], v[32:33] op_sel_hi:[1,0]
  v_pk_mul_f32 v[42:43], v[42:43], v[34:35] op_sel_hi:[1,0]
  v_pk_mul_f32 v[44:45], v[44:45], v[36:37] op_sel_hi:[1,0]
  v_pk_mul_f32 v[32:33], v[46:47], v[14:15] op_sel_hi:[1,0] neg_hi:[1,0]
  v_cvt_pk_f16_f32 v17, v40, v41
  v_pk_fma_f32 v[32:33], v[46:47], v[14:15], v[32:33] op_sel:[1,1,0] op_sel_hi:[0,1,1] neg_lo:[1,0,0] neg_hi:[1,0,0]
  v_cvt_pk_f16_f32 v21, v42, v43
  v_cvt_pk_f16_f32 v25, v44, v45
  v_cvt_pk_f16_f32 v29, v32, v33
  s_waitcnt lgkmcnt(0)
  ds_read_b128 v[12:15], v3 offset:48
  v_pk_mul_f32 v[38:39], v[8:9], v[6:7] op_sel:[0,1] op_sel_hi:[1,1]
  v_pk_mul_f32 v[32:33], v[8:9], v[4:5] op_sel:[0,0] op_sel_hi:[1,0]
  v_pk_mul_f32 v[34:35], v[8:9], v[4:5] op_sel:[0,1] op_sel_hi:[1,1]
  v_pk_mul_f32 v[36:37], v[8:9], v[6:7] op_sel:[0,0] op_sel_hi:[1,0]
  v_fract_f32 v39, v39
  v_fract_f32 v33, v33
  v_fract_f32 v35, v35
  v_fract_f32 v37, v37
  v_exp_f32 v38, v38
  v_cos_f32 v46, v39
  v_sin_f32 v47, v39
  v_exp_f32 v32, v32
  v_cos_f32 v40, v33
  v_sin_f32 v41, v33
  v_exp_f32 v34, v34
  v_cos_f32 v42, v35
  v_sin_f32 v43, v35
  v_exp_f32 v36, v36
  v_cos_f32 v44, v37
  v_sin_f32 v45, v37
  v_pk_mul_f32 v[46:47], v[46:47], v[38:39] op_sel_hi:[1,0]
  v_pk_mul_f32 v[40:41], v[40:41], v[32:33] op_sel_hi:[1,0]
  v_pk_mul_f32 v[42:43], v[42:43], v[34:35] op_sel_hi:[1,0]
  v_pk_mul_f32 v[44:45], v[44:45], v[36:37] op_sel_hi:[1,0]
  v_pk_mul_f32 v[32:33], v[46:47], v[10:11] op_sel_hi:[1,0] neg_hi:[1,0]
  v_cvt_pk_f16_f32 v18, v40, v41
  v_pk_fma_f32 v[32:33], v[46:47], v[10:11], v[32:33] op_sel:[1,1,0] op_sel_hi:[0,1,1] neg_lo:[1,0,0] neg_hi:[1,0,0]
  v_cvt_pk_f16_f32 v22, v42, v43
  v_cvt_pk_f16_f32 v26, v44, v45
  v_cvt_pk_f16_f32 v30, v32, v33
  s_waitcnt lgkmcnt(0)
  ds_read_b128 v[8:11], v3 offset:256
  v_pk_mul_f32 v[38:39], v[12:13], v[6:7] op_sel:[0,1] op_sel_hi:[1,1]
  v_pk_mul_f32 v[32:33], v[12:13], v[4:5] op_sel:[0,0] op_sel_hi:[1,0]
  v_pk_mul_f32 v[34:35], v[12:13], v[4:5] op_sel:[0,1] op_sel_hi:[1,1]
  v_pk_mul_f32 v[36:37], v[12:13], v[6:7] op_sel:[0,0] op_sel_hi:[1,0]
  v_fract_f32 v39, v39
  v_fract_f32 v33, v33
  v_fract_f32 v35, v35
  v_fract_f32 v37, v37
  v_exp_f32 v38, v38
  v_cos_f32 v46, v39
  v_sin_f32 v47, v39
  v_exp_f32 v32, v32
  v_cos_f32 v40, v33
  v_sin_f32 v41, v33
  v_exp_f32 v34, v34
  v_cos_f32 v42, v35
  v_sin_f32 v43, v35
  v_exp_f32 v36, v36
  v_cos_f32 v44, v37
  v_sin_f32 v45, v37
  v_pk_mul_f32 v[46:47], v[46:47], v[38:39] op_sel_hi:[1,0]
  v_pk_mul_f32 v[40:41], v[40:41], v[32:33] op_sel_hi:[1,0]
  v_pk_mul_f32 v[42:43], v[42:43], v[34:35] op_sel_hi:[1,0]
  v_pk_mul_f32 v[44:45], v[44:45], v[36:37] op_sel_hi:[1,0]
  v_pk_mul_f32 v[32:33], v[46:47], v[14:15] op_sel_hi:[1,0] neg_hi:[1,0]
  v_cvt_pk_f16_f32 v19, v40, v41
  v_pk_fma_f32 v[32:33], v[46:47], v[14:15], v[32:33] op_sel:[1,1,0] op_sel_hi:[0,1,1] neg_lo:[1,0,0] neg_hi:[1,0,0]
  v_cvt_pk_f16_f32 v23, v42, v43
  v_cvt_pk_f16_f32 v27, v44, v45
  v_cvt_pk_f16_f32 v31, v32, v33
  v_add_u32 v3, 256, v3
  s_sub_u32 s6, s6, 1
  s_cmp_lg_u32 s6, 0
  s_cbranch_scc1 L_kg_45
  v_mov_b32 v216, 128
  buffer_load_dword v217, v216, s[12:15], 0 offen sc1
  s_mov_b32 s6, 2
L_kg_46:
  s_waitcnt lgkmcnt(0)
  ds_read_b128 v[12:15], v3 offset:16
  v_mfma_f32_16x16x32_f16 v[48:51], v[16:19], v[28:31], v[48:51]
  v_pk_mul_f32 v[38:39], v[8:9], v[6:7] op_sel:[0,1] op_sel_hi:[1,1]
  v_mfma_f32_16x16x32_f16 v[52:55], v[20:23], v[28:31], v[52:55]
  v_pk_mul_f32 v[32:33], v[8:9], v[4:5] op_sel:[0,0] op_sel_hi:[1,0]
  v_mfma_f32_16x16x32_f16 v[56:59], v[24:27], v[28:31], v[56:59]
  v_pk_mul_f32 v[34:35], v[8:9], v[4:5] op_sel:[0,1] op_sel_hi:[1,1]
  v_pk_mul_f32 v[36:37], v[8:9], v[6:7] op_sel:[0,0] op_sel_hi:[1,0]
  v_fract_f32 v39, v39
  v_fract_f32 v33, v33
  v_fract_f32 v35, v35
  v_fract_f32 v37, v37
  v_exp_f32 v38, v38
  v_cos_f32 v46, v39
  v_sin_f32 v47, v39
  v_exp_f32 v32, v32
  v_cos_f32 v40, v33
  v_sin_f32 v41, v33
  v_exp_f32 v34, v34
  v_cos_f32 v42, v35
  v_sin_f32 v43, v35
  v_exp_f32 v36, v36
  v_cos_f32 v44, v37
  v_sin_f32 v45, v37
  v_pk_mul_f32 v[46:47], v[46:47], v[38:39] op_sel_hi:[1,0]
  v_pk_mul_f32 v[40:41], v[40:41], v[32:33] op_sel_hi:[1,0]
  v_pk_mul_f32 v[42:43], v[42:43], v[34:35] op_sel_hi:[1,0]
  v_pk_mul_f32 v[44:45], v[44:45], v[36:37] op_sel_hi:[1,0]
  v_pk_mul_f32 v[32:33], v[46:47], v[10:11] op_sel_hi:[1,0] neg_hi:[1,0]
  v_cvt_pk_f16_f32 v16, v40, v41
  v_pk_fma_f32 v[32:33], v[46:47], v[10:11], v[32:33] op_sel:[1,1,0] op_sel_hi:[0,1,1] neg_lo:[1,0,0] neg_hi:[1,0,0]
  v_cvt_pk_f16_f32 v20, v42, v43
  v_cvt_pk_f16_f32 v24, v44, v45
  v_cvt_pk_f16_f32 v28, v32, v33
  s_waitcnt lgkmcnt(0)
  ds_read_b128 v[8:11], v3 offset:32
  v_pk_mul_f32 v[38:39], v[12:13], v[6:7] op_sel:[0,1] op_sel_hi:[1,1]
  v_pk_mul_f32 v[32:33], v[12:13], v[4:5] op_sel:[0,0] op_sel_hi:[1,0]
  v_pk_mul_f32 v[34:35], v[12:13], v[4:5] op_sel:[0,1] op_sel_hi:[1,1]
  v_pk_mul_f32 v[36:37], v[12:13], v[6:7] op_sel:[0,0] op_sel_hi:[1,0]
  v_fract_f32 v39, v39
  v_fract_f32 v33, v33
  v_fract_f32 v35, v35
  v_fract_f32 v37, v37
  v_exp_f32 v38, v38
  v_cos_f32 v46, v39
  v_sin_f32 v47, v39
  v_exp_f32 v32, v32
  v_cos_f32 v40, v33
  v_sin_f32 v41, v33
  v_exp_f32 v34, v34
  v_cos_f32 v42, v35
  v_sin_f32 v43, v35
  v_exp_f32 v36, v36
  v_cos_f32 v44, v37
  v_sin_f32 v45, v37
  v_pk_mul_f32 v[46:47], v[46:47], v[38:39] op_sel_hi:[1,0]
  v_pk_mul_f32 v[40:41], v[40:41], v[32:33] op_sel_hi:[1,0]
  v_pk_mul_f32 v[42:43], v[42:43], v[34:35] op_sel_hi:[1,0]
  v_pk_mul_f32 v[44:45], v[44:45], v[36:37] op_sel_hi:[1,0]
  v_pk_mul_f32 v[32:33], v[46:47], v[14:15] op_sel_hi:[1,0] neg_hi:[1,0]
  v_cvt_pk_f16_f32 v17, v40, v41
  v_pk_fma_f32 v[32:33], v[46:47], v[14:15], v[32:33] op_sel:[1,1,0] op_sel_hi:[0,1,1] neg_lo:[1,0,0] neg_hi:[1,0,0]
  v_cvt_pk_f16_f32 v21, v42, v43
  v_cvt_pk_f16_f32 v25, v44, v45
  v_cvt_pk_f16_f32 v29, v32, v33
  s_waitcnt lgkmcnt(0)
  ds_read_b128 v[12:15], v3 offset:48
  v_pk_mul_f32 v[38:39], v[8:9], v[6:7] op_sel:[0,1] op_sel_hi:[1,1]
  v_pk_mul_f32 v[32:33], v[8:9], v[4:5] op_sel:[0,0] op_sel_hi:[1,0]
  v_pk_mul_f32 v[34:35], v[8:9], v[4:5] op_sel:[0,1] op_sel_hi:[1,1]
  v_pk_mul_f32 v[36:37], v[8:9], v[6:7] op_sel:[0,0] op_sel_hi:[1,0]
  v_fract_f32 v39, v39
  v_fract_f32 v33, v33
  v_fract_f32 v35, v35
  v_fract_f32 v37, v37
  v_exp_f32 v38, v38
  v_cos_f32 v46, v39
  v_sin_f32 v47, v39
  v_exp_f32 v32, v32
  v_cos_f32 v40, v33
  v_sin_f32 v41, v33
  v_exp_f32 v34, v34
  v_cos_f32 v42, v35
  v_sin_f32 v43, v35
  v_exp_f32 v36, v36
  v_cos_f32 v44, v37
  v_sin_f32 v45, v37
  v_pk_mul_f32 v[46:47], v[46:47], v[38:39] op_sel_hi:[1,0]
  v_pk_mul_f32 v[40:41], v[40:41], v[32:33] op_sel_hi:[1,0]
  v_pk_mul_f32 v[42:43], v[42:43], v[34:35] op_sel_hi:[1,0]
  v_pk_mul_f32 v[44:45], v[44:45], v[36:37] op_sel_hi:[1,0]
  v_pk_mul_f32 v[32:33], v[46:47], v[10:11] op_sel_hi:[1,0] neg_hi:[1,0]
  v_cvt_pk_f16_f32 v18, v40, v41
  v_pk_fma_f32 v[32:33], v[46:47], v[10:11], v[32:33] op_sel:[1,1,0] op_sel_hi:[0,1,1] neg_lo:[1,0,0] neg_hi:[1,0,0]
  v_cvt_pk_f16_f32 v22, v42, v43
  v_cvt_pk_f16_f32 v26, v44, v45
  v_cvt_pk_f16_f32 v30, v32, v33
  s_waitcnt lgkmcnt(0)
  ds_read_b128 v[8:11], v3 offset:256
  v_pk_mul_f32 v[38:39], v[12:13], v[6:7] op_sel:[0,1] op_sel_hi:[1,1]
  v_pk_mul_f32 v[32:33], v[12:13], v[4:5] op_sel:[0,0] op_sel_hi:[1,0]
  v_pk_mul_f32 v[34:35], v[12:13], v[4:5] op_sel:[0,1] op_sel_hi:[1,1]
  v_pk_mul_f32 v[36:37], v[12:13], v[6:7] op_sel:[0,0] op_sel_hi:[1,0]
  v_fract_f32 v39, v39
  v_fract_f32 v33, v33
  v_fract_f32 v35, v35
  v_fract_f32 v37, v37
  v_exp_f32 v38, v38
  v_cos_f32 v46, v39
  v_sin_f32 v47, v39
  v_exp_f32 v32, v32
  v_cos_f32 v40, v33
  v_sin_f32 v41, v33
  v_exp_f32 v34, v34
  v_cos_f32 v42, v35
  v_sin_f32 v43, v35
  v_exp_f32 v36, v36
  v_cos_f32 v44, v37
  v_sin_f32 v45, v37
  v_pk_mul_f32 v[46:47], v[46:47], v[38:39] op_sel_hi:[1,0]
  v_pk_mul_f32 v[40:41], v[40:41], v[32:33] op_sel_hi:[1,0]
  v_pk_mul_f32 v[42:43], v[42:43], v[34:35] op_sel_hi:[1,0]
  v_pk_mul_f32 v[44:45], v[44:45], v[36:37] op_sel_hi:[1,0]
  v_pk_mul_f32 v[32:33], v[46:47], v[14:15] op_sel_hi:[1,0] neg_hi:[1,0]
  v_cvt_pk_f16_f32 v19, v40, v41
  v_pk_fma_f32 v[32:33], v[46:47], v[14:15], v[32:33] op_sel:[1,1,0] op_sel_hi:[0,1,1] neg_lo:[1,0,0] neg_hi:[1,0,0]
  v_cvt_pk_f16_f32 v23, v42, v43
  v_cvt_pk_f16_f32 v27, v44, v45
  v_cvt_pk_f16_f32 v31, v32, v33
  v_add_u32 v3, 256, v3
  s_sub_u32 s6, s6, 1
  s_cmp_lg_u32 s6, 0
  s_cbranch_scc1 L_kg_46
  s_waitcnt vmcnt(0)
  v_cmp_ne_u32 vcc, 0x100, v217
  s_cbranch_vccz L_dn_47
  s_mov_b32 s7, 0
  v_mov_b32 v216, 128
L_wd_48:
  buffer_load_dword v217, v216, s[12:15], 0 offen sc1
  s_waitcnt vmcnt(0)
  v_cmp_ne_u32 vcc, 0x100, v217
  s_cbranch_vccz L_wdo_49
  s_add_u32 s7, s7, 1
  s_cmp_lt_u32 s7, 131072
  s_cbranch_scc1 L_wd_48
  s_mov_b32 s6, 50
  s_branch L_err
L_wdo_49:
L_dn_47:
  s_lshl_b32 s6, s3, 13
  s_add_u32 s6, s6, s62
  s_add_u32 s6, s6, 0xb000000
  s_lshl_b32 s7, s3, 10
  v_lshlrev_b32 v216, 7, v0
  s_add_u32 m0, s7, 44064
  s_nop 0
  buffer_load_dwordx4 v216, s[8:11], s6 offen lds
  s_add_u32 s6, s6, 16
  s_add_u32 m0, s7, 48192
  s_nop 0
  buffer_load_dwordx4 v216, s[8:11], s6 offen lds
  s_add_u32 s6, s6, 16
  s_add_u32 m0, s7, 52320
  s_nop 0
  buffer_load_dwordx4 v216, s[8:11], s6 offen lds
  s_add_u32 s6, s6, 16
  s_add_u32 m0, s7, 56448
  s_nop 0
  buffer_load_dwordx4 v216, s[8:11], s6 offen lds
  s_add_u32 s6, s6, 16
  s_add_u32 m0, s7, 60544
  s_nop 0
  buffer_load_dwordx4 v216, s[8:11], s6 offen lds
  s_add_u32 s6, s6, 16
  s_add_u32 m0, s7, 64640
  s_nop 0
  buffer_load_dwordx4 v216, s[8:11], s6 offen lds
  s_add_u32 s6, s6, 16
  s_add_u32 m0, s7, 68736
  s_nop 0
  buffer_load_dwordx4 v216, s[8:11], s6 offen lds
  s_add_u32 s6, s6, 16
  s_add_u32 m0, s7, 72832
  s_nop 0
  buffer_load_dwordx4 v216, s[8:11], s6 offen lds
  s_add_u32 s6, s6, 16
  s_mov_b32 s6, 2
L_kg_50:
  s_waitcnt lgkmcnt(0)
  ds_read_b128 v[12:15], v3 offset:16
  v_mfma_f32_16x16x32_f16 v[48:51], v[16:19], v[28:31], v[48:51]
  v_pk_mul_f32 v[38:39], v[8:9], v[6:7] op_sel:[0,1] op_sel_hi:[1,1]
  v_mfma_f32_16x16x32_f16 v[52:55], v[20:23], v[28:31], v[52:55]
  v_pk_mul_f32 v[32:33], v[8:9], v[4:5] op_sel:[0,0] op_sel_hi:[1,0]
  v_mfma_f32_16x16x32_f16 v[56:59], v[24:27], v[28:31], v[56:59]
  v_pk_mul_f32 v[34:35], v[8:9], v[4:5] op_sel:[0,1] op_sel_hi:[1,1]
  v_pk_mul_f32 v[36:37], v[8:9], v[6:7] op_sel:[0,0] op_sel_hi:[1,0]
  v_fract_f32 v39, v39
  v_fract_f32 v33, v33
  v_fract_f32 v35, v35
  v_fract_f32 v37, v37
  v_exp_f32 v38, v38
  v_cos_f32 v46, v39
  v_sin_f32 v47, v39
  v_exp_f32 v32, v32
  v_cos_f32 v40, v33
  v_sin_f32 v41, v33
  v_exp_f32 v34, v34
  v_cos_f32 v42, v35
  v_sin_f32 v43, v35
  v_exp_f32 v36, v36
  v_cos_f32 v44, v37
  v_sin_f32 v45, v37
  v_pk_mul_f32 v[46:47], v[46:47], v[38:39] op_sel_hi:[1,0]
  v_pk_mul_f32 v[40:41], v[40:41], v[32:33] op_sel_hi:[1,0]
  v_pk_mul_f32 v[42:43], v[42:43], v[34:35] op_sel_hi:[1,0]
  v_pk_mul_f32 v[44:45], v[44:45], v[36:37] op_sel_hi:[1,0]
  v_pk_mul_f32 v[32:33], v[46:47], v[10:11] op_sel_hi:[1,0] neg_hi:[1,0]
  v_cvt_pk_f16_f32 v16, v40, v41
  v_pk_fma_f32 v[32:33], v[46:47], v[10:11], v[32:33] op_sel:[1,1,0] op_sel_hi:[0,1,1] neg_lo:[1,0,0] neg_hi:[1,0,0]
  v_cvt_pk_f16_f32 v20, v42, v43
  v_cvt_pk_f16_f32 v24, v44, v45
  v_cvt_pk_f16_f32 v28, v32, v33
  s_waitcnt lgkmcnt(0)
  ds_read_b128 v[8:11], v3 offset:32
  v_pk_mul_f32 v[38:39], v[12:13], v[6:7] op_sel:[0,1] op_sel_hi:[1,1]
  v_pk_mul_f32 v[32:33], v[12:13], v[4:5] op_sel:[0,0] op_sel_hi:[1,0]
  v_pk_mul_f32 v[34:35], v[12:13], v[4:5] op_sel:[0,1] op_sel_hi:[1,1]
  v_pk_mul_f32 v[36:37], v[12:13], v[6:7] op_sel:[0,0] op_sel_hi:[1,0]
  v_fract_f32 v39, v39
  v_fract_f32 v33, v33
  v_fract_f32 v35, v35
  v_fract_f32 v37, v37
  v_exp_f32 v38, v38
  v_cos_f32 v46, v39
  v_sin_f32 v47, v39
  v_exp_f32 v32, v32
  v_cos_f32 v40, v33
  v_sin_f32 v41, v33
  v_exp_f32 v34, v34
  v_cos_f32 v42, v35
  v_sin_f32 v43, v35
  v_exp_f32 v36, v36
  v_cos_f32 v44, v37
  v_sin_f32 v45, v37
  v_pk_mul_f32 v[46:47], v[46:47], v[38:39] op_sel_hi:[1,0]
  v_pk_mul_f32 v[40:41], v[40:41], v[32:33] op_sel_hi:[1,0]
  v_pk_mul_f32 v[42:43], v[42:43], v[34:35] op_sel_hi:[1,0]
  v_pk_mul_f32 v[44:45], v[44:45], v[36:37] op_sel_hi:[1,0]
  v_pk_mul_f32 v[32:33], v[46:47], v[14:15] op_sel_hi:[1,0] neg_hi:[1,0]
  v_cvt_pk_f16_f32 v17, v40, v41
  v_pk_fma_f32 v[32:33], v[46:47], v[14:15], v[32:33] op_sel:[1,1,0] op_sel_hi:[0,1,1] neg_lo:[1,0,0] neg_hi:[1,0,0]
  v_cvt_pk_f16_f32 v21, v42, v43
  v_cvt_pk_f16_f32 v25, v44, v45
  v_cvt_pk_f16_f32 v29, v32, v33
  s_waitcnt lgkmcnt(0)
  ds_read_b128 v[12:15], v3 offset:48
  v_pk_mul_f32 v[38:39], v[8:9], v[6:7] op_sel:[0,1] op_sel_hi:[1,1]
  v_pk_mul_f32 v[32:33], v[8:9], v[4:5] op_sel:[0,0] op_sel_hi:[1,0]
  v_pk_mul_f32 v[34:35], v[8:9], v[4:5] op_sel:[0,1] op_sel_hi:[1,1]
  v_pk_mul_f32 v[36:37], v[8:9], v[6:7] op_sel:[0,0] op_sel_hi:[1,0]
  v_fract_f32 v39, v39
  v_fract_f32 v33, v33
  v_fract_f32 v35, v35
  v_fract_f32 v37, v37
  v_exp_f32 v38, v38
  v_cos_f32 v46, v39
  v_sin_f32 v47, v39
  v_exp_f32 v32, v32
  v_cos_f32 v40, v33
  v_sin_f32 v41, v33
  v_exp_f32 v34, v34
  v_cos_f32 v42, v35
  v_sin_f32 v43, v35
  v_exp_f32 v36, v36
  v_cos_f32 v44, v37
  v_sin_f32 v45, v37
  v_pk_mul_f32 v[46:47], v[46:47], v[38:39] op_sel_hi:[1,0]
  v_pk_mul_f32 v[40:41], v[40:41], v[32:33] op_sel_hi:[1,0]
  v_pk_mul_f32 v[42:43], v[42:43], v[34:35] op_sel_hi:[1,0]
  v_pk_mul_f32 v[44:45], v[44:45], v[36:37] op_sel_hi:[1,0]
  v_pk_mul_f32 v[32:33], v[46:47], v[10:11] op_sel_hi:[1,0] neg_hi:[1,0]
  v_cvt_pk_f16_f32 v18, v40, v41
  v_pk_fma_f32 v[32:33], v[46:47], v[10:11], v[32:33] op_sel:[1,1,0] op_sel_hi:[0,1,1] neg_lo:[1,0,0] neg_hi:[1,0,0]
  v_cvt_pk_f16_f32 v22, v42, v43
  v_cvt_pk_f16_f32 v26, v44, v45
  v_cvt_pk_f16_f32 v30, v32, v33
  s_waitcnt lgkmcnt(0)
  ds_read_b128 v[8:11], v3 offset:256
  v_pk_mul_f32 v[38:39], v[12:13], v[6:7] op_sel:[0,1] op_sel_hi:[1,1]
  v_pk_mul_f32 v[32:33], v[12:13], v[4:5] op_sel:[0,0] op_sel_hi:[1,0]
  v_pk_mul_f32 v[34:35], v[12:13], v[4:5] op_sel:[0,1] op_sel_hi:[1,1]
  v_pk_mul_f32 v[36:37], v[12:13], v[6:7] op_sel:[0,0] op_sel_hi:[1,0]
  v_fract_f32 v39, v39
  v_fract_f32 v33, v33
  v_fract_f32 v35, v35
  v_fract_f32 v37, v37
  v_exp_f32 v38, v38
  v_cos_f32 v46, v39
  v_sin_f32 v47, v39
  v_exp_f32 v32, v32
  v_cos_f32 v40, v33
  v_sin_f32 v41, v33
  v_exp_f32 v34, v34
  v_cos_f32 v42, v35
  v_sin_f32 v43, v35
  v_exp_f32 v36, v36
  v_cos_f32 v44, v37
  v_sin_f32 v45, v37
  v_pk_mul_f32 v[46:47], v[46:47], v[38:39] op_sel_hi:[1,0]
  v_pk_mul_f32 v[40:41], v[40:41], v[32:33] op_sel_hi:[1,0]
  v_pk_mul_f32 v[42:43], v[42:43], v[34:35] op_sel_hi:[1,0]
  v_pk_mul_f32 v[44:45], v[44:45], v[36:37] op_sel_hi:[1,0]
  v_pk_mul_f32 v[32:33], v[46:47], v[14:15] op_sel_hi:[1,0] neg_hi:[1,0]
  v_cvt_pk_f16_f32 v19, v40, v41
  v_pk_fma_f32 v[32:33], v[46:47], v[14:15], v[32:33] op_sel:[1,1,0] op_sel_hi:[0,1,1] neg_lo:[1,0,0] neg_hi:[1,0,0]
  v_cvt_pk_f16_f32 v23, v42, v43
  v_cvt_pk_f16_f32 v27, v44, v45
  v_cvt_pk_f16_f32 v31, v32, v33
  v_add_u32 v3, 256, v3
  s_sub_u32 s6, s6, 1
  s_cmp_lg_u32 s6, 0
  s_cbranch_scc1 L_kg_50
  s_mov_b32 s6, 2
L_kg_51:
  s_waitcnt lgkmcnt(0)
  ds_read_b128 v[12:15], v3 offset:16
  v_mfma_f32_16x16x32_f16 v[48:51], v[16:19], v[28:31], v[48:51]
  v_pk_mul_f32 v[38:39], v[8:9], v[6:7] op_sel:[0,1] op_sel_hi:[1,1]
  v_mfma_f32_16x16x32_f16 v[52:55], v[20:23], v[28:31], v[52:55]
  v_pk_mul_f32 v[32:33], v[8:9], v[4:5] op_sel:[0,0] op_sel_hi:[1,0]
  v_mfma_f32_16x16x32_f16 v[56:59], v[24:27], v[28:31], v[56:59]
  v_pk_mul_f32 v[34:35], v[8:9], v[4:5] op_sel:[0,1] op_sel_hi:[1,1]
  v_pk_mul_f32 v[36:37], v[8:9], v[6:7] op_sel:[0,0] op_sel_hi:[1,0]
  v_fract_f32 v39, v39
  v_fract_f32 v33, v33
  v_fract_f32 v35, v35
  v_fract_f32 v37, v37
  v_exp_f32 v38, v38
  v_cos_f32 v46, v39
  v_sin_f32 v47, v39
  v_exp_f32 v32, v32
  v_cos_f32 v40, v33
  v_sin_f32 v41, v33
  v_exp_f32 v34, v34
  v_cos_f32 v42, v35
  v_sin_f32 v43, v35
  v_exp_f32 v36, v36
  v_cos_f32 v44, v37
  v_sin_f32 v45, v37
  v_pk_mul_f32 v[46:47], v[46:47], v[38:39] op_sel_hi:[1,0]
  v_pk_mul_f32 v[40:41], v[40:41], v[32:33] op_sel_hi:[1,0]
  v_pk_mul_f32 v[42:43], v[42:43], v[34:35] op_sel_hi:[1,0]
  v_pk_mul_f32 v[44:45], v[44:45], v[36:37] op_sel_hi:[1,0]
  v_pk_mul_f32 v[32:33], v[46:47], v[10:11] op_sel_hi:[1,0] neg_hi:[1,0]
  v_cvt_pk_f16_f32 v16, v40, v41
  v_pk_fma_f32 v[32:33], v[46:47], v[10:11], v[32:33] op_sel:[1,1,0] op_sel_hi:[0,1,1] neg_lo:[1,0,0] neg_hi:[1,0,0]
  v_cvt_pk_f16_f32 v20, v42, v43
  v_cvt_pk_f16_f32 v24, v44, v45
  v_cvt_pk_f16_f32 v28, v32, v33
  s_waitcnt lgkmcnt(0)
  ds_read_b128 v[8:11], v3 offset:32
  v_pk_mul_f32 v[38:39], v[12:13], v[6:7] op_sel:[0,1] op_sel_hi:[1,1]
  v_pk_mul_f32 v[32:33], v[12:13], v[4:5] op_sel:[0,0] op_sel_hi:[1,0]
  v_pk_mul_f32 v[34:35], v[12:13], v[4:5] op_sel:[0,1] op_sel_hi:[1,1]
  v_pk_mul_f32 v[36:37], v[12:13], v[6:7] op_sel:[0,0] op_sel_hi:[1,0]
  v_fract_f32 v39, v39
  v_fract_f32 v33, v33
  v_fract_f32 v35, v35
  v_fract_f32 v37, v37
  v_exp_f32 v38, v38
  v_cos_f32 v46, v39
  v_sin_f32 v47, v39
  v_exp_f32 v32, v32
  v_cos_f32 v40, v33
  v_sin_f32 v41, v33
  v_exp_f32 v34, v34
  v_cos_f32 v42, v35
  v_sin_f32 v43, v35
  v_exp_f32 v36, v36
  v_cos_f32 v44, v37
  v_sin_f32 v45, v37
  v_pk_mul_f32 v[46:47], v[46:47], v[38:39] op_sel_hi:[1,0]
  v_pk_mul_f32 v[40:41], v[40:41], v[32:33] op_sel_hi:[1,0]
  v_pk_mul_f32 v[42:43], v[42:43], v[34:35] op_sel_hi:[1,0]
  v_pk_mul_f32 v[44:45], v[44:45], v[36:37] op_sel_hi:[1,0]
  v_pk_mul_f32 v[32:33], v[46:47], v[14:15] op_sel_hi:[1,0] neg_hi:[1,0]
  v_cvt_pk_f16_f32 v17, v40, v41
  v_pk_fma_f32 v[32:33], v[46:47], v[14:15], v[32:33] op_sel:[1,1,0] op_sel_hi:[0,1,1] neg_lo:[1,0,0] neg_hi:[1,0,0]
  v_cvt_pk_f16_f32 v21, v42, v43
  v_cvt_pk_f16_f32 v25, v44, v45
  v_cvt_pk_f16_f32 v29, v32, v33
  s_waitcnt lgkmcnt(0)
  ds_read_b128 v[12:15], v3 offset:48
  v_pk_mul_f32 v[38:39], v[8:9], v[6:7] op_sel:[0,1] op_sel_hi:[1,1]
  v_pk_mul_f32 v[32:33], v[8:9], v[4:5] op_sel:[0,0] op_sel_hi:[1,0]
  v_pk_mul_f32 v[34:35], v[8:9], v[4:5] op_sel:[0,1] op_sel_hi:[1,1]
  v_pk_mul_f32 v[36:37], v[8:9], v[6:7] op_sel:[0,0] op_sel_hi:[1,0]
  v_fract_f32 v39, v39
  v_fract_f32 v33, v33
  v_fract_f32 v35, v35
  v_fract_f32 v37, v37
  v_exp_f32 v38, v38
  v_cos_f32 v46, v39
  v_sin_f32 v47, v39
  v_exp_f32 v32, v32
  v_cos_f32 v40, v33
  v_sin_f32 v41, v33
  v_exp_f32 v34, v34
  v_cos_f32 v42, v35
  v_sin_f32 v43, v35
  v_exp_f32 v36, v36
  v_cos_f32 v44, v37
  v_sin_f32 v45, v37
  v_pk_mul_f32 v[46:47], v[46:47], v[38:39] op_sel_hi:[1,0]
  v_pk_mul_f32 v[40:41], v[40:41], v[32:33] op_sel_hi:[1,0]
  v_pk_mul_f32 v[42:43], v[42:43], v[34:35] op_sel_hi:[1,0]
  v_pk_mul_f32 v[44:45], v[44:45], v[36:37] op_sel_hi:[1,0]
  v_pk_mul_f32 v[32:33], v[46:47], v[10:11] op_sel_hi:[1,0] neg_hi:[1,0]
  v_cvt_pk_f16_f32 v18, v40, v41
  v_pk_fma_f32 v[32:33], v[46:47], v[10:11], v[32:33] op_sel:[1,1,0] op_sel_hi:[0,1,1] neg_lo:[1,0,0] neg_hi:[1,0,0]
  v_cvt_pk_f16_f32 v22, v42, v43
  v_cvt_pk_f16_f32 v26, v44, v45
  v_cvt_pk_f16_f32 v30, v32, v33
  s_waitcnt lgkmcnt(0)
  ds_read_b128 v[8:11], v3 offset:256
  v_pk_mul_f32 v[38:39], v[12:13], v[6:7] op_sel:[0,1] op_sel_hi:[1,1]
  v_pk_mul_f32 v[32:33], v[12:13], v[4:5] op_sel:[0,0] op_sel_hi:[1,0]
  v_pk_mul_f32 v[34:35], v[12:13], v[4:5] op_sel:[0,1] op_sel_hi:[1,1]
  v_pk_mul_f32 v[36:37], v[12:13], v[6:7] op_sel:[0,0] op_sel_hi:[1,0]
  v_fract_f32 v39, v39
  v_fract_f32 v33, v33
  v_fract_f32 v35, v35
  v_fract_f32 v37, v37
  v_exp_f32 v38, v38
  v_cos_f32 v46, v39
  v_sin_f32 v47, v39
  v_exp_f32 v32, v32
  v_cos_f32 v40, v33
  v_sin_f32 v41, v33
  v_exp_f32 v34, v34
  v_cos_f32 v42, v35
  v_sin_f32 v43, v35
  v_exp_f32 v36, v36
  v_cos_f32 v44, v37
  v_sin_f32 v45, v37
  v_pk_mul_f32 v[46:47], v[46:47], v[38:39] op_sel_hi:[1,0]
  v_pk_mul_f32 v[40:41], v[40:41], v[32:33] op_sel_hi:[1,0]
  v_pk_mul_f32 v[42:43], v[42:43], v[34:35] op_sel_hi:[1,0]
  v_pk_mul_f32 v[44:45], v[44:45], v[36:37] op_sel_hi:[1,0]
  v_pk_mul_f32 v[32:33], v[46:47], v[14:15] op_sel_hi:[1,0] neg_hi:[1,0]
  v_cvt_pk_f16_f32 v19, v40, v41
  v_pk_fma_f32 v[32:33], v[46:47], v[14:15], v[32:33] op_sel:[1,1,0] op_sel_hi:[0,1,1] neg_lo:[1,0,0] neg_hi:[1,0,0]
  v_cvt_pk_f16_f32 v23, v42, v43
  v_cvt_pk_f16_f32 v27, v44, v45
  v_cvt_pk_f16_f32 v31, v32, v33
  v_add_u32 v3, 256, v3
  s_sub_u32 s6, s6, 1
  s_cmp_lg_u32 s6, 0
  s_cbranch_scc1 L_kg_51
  v_mfma_f32_16x16x32_f16 v[48:51], v[16:19], v[28:31], v[48:51]
  v_mfma_f32_16x16x32_f16 v[52:55], v[20:23], v[28:31], v[52:55]
  v_mfma_f32_16x16x32_f16 v[56:59], v[24:27], v[28:31], v[56:59]
  s_waitcnt lgkmcnt(0)
  s_nop 4
  v_mul_f32 v48, v48, v233
  v_mul_f32 v49, v49, v233
  v_mul_f32 v50, v50, v233
  v_mul_f32 v51, v51, v233
  v_mul_f32 v52, v52, v233
  v_mul_f32 v53, v53, v233
  v_mul_f32 v54, v54, v233
  v_mul_f32 v55, v55, v233
  v_mul_f32 v56, v56, v233
  v_mul_f32 v57, v57, v233
  v_mul_f32 v58, v58, v233
  v_mul_f32 v59, v59, v233
  v_readlane_b32 s61, v52, 32
  v_lshrrev_b32 v16, 4, v0
  v_and_b32 v17, 15, v0
  v_lshlrev_b32 v17, 4, v17
  v_add_u32 v17, s63, v17
  v_lshrrev_b32 v18, 1, v16
  v_and_b32 v19, 1, v16
  v_lshlrev_b32 v20, 8, v18
  v_lshl_add_u32 v20, v19, 3, v20
  v_add3_u32 v20, v20, v17, 2
  v_lshlrev_b32 v21, 8, v19
  v_add_u32 v21, 516, v21
  v_cmp_eq_u32 vcc, 0, v18
  s_nop 1
  v_cndmask_b32 v21, 0, v21, vcc
  v_cndmask_b32 v22, 0, 4, vcc
  v_add_u32 v21, v21, v17
  v_lshlrev_b32 v23, 9, v19
  v_add_u32 v23, 1032, v23
  v_lshlrev_b32 v24, 10, v19
  v_add_u32 v24, 2064, v24
  v_cndmask_b32 v23, v24, v23, vcc
  v_add_u32 v23, v23, v17
  v_mov_b32 v24, 0x100
  v_cndmask_b32 v24, v24, 8, vcc
  v_mov_b32 v25, 0x200
  v_cndmask_b32 v25, v25, v24, vcc
  v_mov_b32 v26, 0x100
  v_cndmask_b32 v25, v25, v26, vcc
  v_cvt_pk_bf16_f32 v32, v48, v49
  v_cvt_pk_bf16_f32 v33, v50, v51
  v_cvt_pk_bf16_f32 v34, v52, v53
  v_cvt_pk_bf16_f32 v35, v54, v55
  v_cvt_pk_bf16_f32 v36, v56, v57
  v_cvt_pk_bf16_f32 v37, v58, v59
  ds_write_b16 v21, v34
  v_add_u32 v21, v21, v22
  ds_write_b16_d16_hi v21, v34
  v_add_u32 v21, v21, v22
  ds_write_b16 v21, v35
  v_add_u32 v21, v21, v22
  ds_write_b16_d16_hi v21, v35
  ds_write_b16 v20, v32 offset:0
  ds_write_b16_d16_hi v20, v32 offset:2
  ds_write_b16 v20, v33 offset:4
  ds_write_b16_d16_hi v20, v33 offset:6
  ds_write_b16 v23, v36
  v_add_u32 v26, v23, v24
  v_add_u32 v23, v23, v25
  ds_write_b16_d16_hi v26, v36
  ds_write_b16 v23, v37
  v_add_u32 v23, v23, v24
  ds_write_b16_d16_hi v23, v37
  ds_read_u16 v160, v160
  ds_read_u16 v161, v161
  ds_read_u16 v162, v162
  ds_read_u16 v163, v163
  ds_read_u16 v164, v164
  ds_read_u16 v165, v165
  ds_read_u16 v166, v166
  ds_read_u16 v167, v167
  ds_read_u16 v168, v168
  ds_read_u16 v169, v169
  ds_read_u16 v170, v170
  ds_read_u16 v171, v171
  ds_read_u16 v172, v172
  ds_read_u16 v173, v173
  ds_read_u16 v174, v174
  ds_read_u16 v175, v175
  ds_read_u16 v176, v176
  ds_read_u16 v177, v177
  ds_read_u16 v178, v178
  ds_read_u16 v179, v179
  ds_read_u16 v180, v180
  ds_read_u16 v181, v181
  ds_read_u16 v182, v182
  ds_read_u16 v183, v183
  ds_read_u16 v184, v184
  ds_read_u16 v185, v185
  ds_read_u16 v186, v186
  ds_read_u16 v187, v187
  ds_read_u16 v188, v188
  ds_read_u16 v189, v189
  ds_read_u16 v190, v190
  ds_read_u16 v191, v191
  s_mul_i32 s6, s3, 4608
  s_add_u32 s6, s6, 25600
  v_add_u32 v16, s6, v2
  s_mul_i32 s7, s60, 4608
  s_add_u32 s7, s7, 0x400000
  v_mov_b32 v21, 0
  v_mov_b32 v22, 0
  v_mov_b32 v23, 0
  v_mov_b32 v20, s61
  v_cmp_eq_u32 vcc, 30, v0
  s_nop 1
  v_cndmask_b32 v20, 0, v20, vcc
  s_mul_i32 s62, s3, 4128
  s_add_u32 s62, s62, 44032
  v_and_b32 v24, 16, v2
  v_add_u32 v24, s62, v24
  v_mov_b32 v28, 0
  v_mov_b32 v29, 0
  v_mov_b32 v30, 0
  v_mov_b32 v31, 0
  s_waitcnt lgkmcnt(15)
  v_lshl_or_b32 v160, v161, 16, v160
  v_lshl_or_b32 v161, v163, 16, v162
  v_lshl_or_b32 v162, v165, 16, v164
  v_lshl_or_b32 v163, v167, 16, v166
  ds_write_b128 v16, v[160:163] offset:0
  buffer_store_dwordx4 v[160:163], v2, s[8:11], s7 offen offset:0 sc1
  s_waitcnt lgkmcnt(15)
  s_waitcnt lgkmcnt(15)
  v_lshl_or_b32 v168, v169, 16, v168
  v_lshl_or_b32 v169, v171, 16, v170
  v_lshl_or_b32 v170, v173, 16, v172
  v_lshl_or_b32 v171, v175, 16, v174
  ds_write_b128 v16, v[168:171] offset:1024
  buffer_store_dwordx4 v[168:171], v2, s[8:11], s7 offen offset:1024 sc1
  s_waitcnt lgkmcnt(10)
  v_lshl_or_b32 v176, v177, 16, v176
  v_lshl_or_b32 v177, v179, 16, v178
  v_lshl_or_b32 v178, v181, 16, v180
  v_lshl_or_b32 v179, v183, 16, v182
  ds_write_b128 v16, v[176:179] offset:2048
  buffer_store_dwordx4 v[176:179], v2, s[8:11], s7 offen offset:2048 sc1
  s_waitcnt lgkmcnt(3)
  v_lshl_or_b32 v184, v185, 16, v184
  v_lshl_or_b32 v185, v187, 16, v186
  v_lshl_or_b32 v186, v189, 16, v188
  v_lshl_or_b32 v187, v191, 16, v190
  ds_write_b128 v16, v[184:187] offset:3072
  buffer_store_dwordx4 v[184:187], v2, s[8:11], s7 offen offset:3072 sc1
  s_add_u32 s7, s7, 4096
  ds_write_b128 v24, v[28:31]
  s_mov_b32 exec_hi, 0
  ds_write_b128 v16, v[20:23] offset:4096
  buffer_store_dwordx4 v[20:23], v2, s[8:11], s7 offen sc1
  s_mov_b32 exec_hi, -1
  v_and_b32 v16, 15, v0
  v_lshrrev_b32 v17, 4, v0
  v_lshlrev_b32 v18, 5, v16
  s_add_u32 s6, s6, 480
  v_sub_u32 v18, s6, v18
  v_lshl_add_u32 v4, v17, 4, v18
  v_lshlrev_b32 v18, 1, v16
  v_lshl_add_u32 v18, v17, 4, v18
  v_and_b32 v6, 2, v18
  v_and_b32 v18, -4, v18
  v_add_u32 v5, s62, v18
  v_lshlrev_b32 v18, 5, v16
  v_lshl_add_u32 v18, v17, 3, v18
  v_add3_u32 v7, v18, s62, 32
  s_lshl_b32 s7, s3, 12
  s_add_u32 s7, s7, 60544
  v_add_u32 v8, s7, v18
  v_lshrrev_b32 v18, 1, v16
  v_lshlrev_b32 v18, 15, v18
  v_and_b32 v19, 1, v16
  v_lshl_or_b32 v18, v19, 5, v18
  v_lshl_or_b32 v9, v17, 3, v18
  v_lshlrev_b32 v31, 16, v232
  v_add_u32 v60, 1024, v5
  v_add_u32 v61, 2048, v5
  v_add_u32 v62, 3072, v5
  s_lshl_b32 s62, s60, 6
  s_add_u32 s62, s62, 0x0
  s_waitcnt vmcnt(5) lgkmcnt(0)
  s_barrier
  ds_read_b128 a[32:35], v4 offset:4032
  ds_read_b128 a[36:39], v4 offset:3968
  ds_read_b128 a[40:43], v4 offset:3904
  ds_read2_b32 v[10:11], v62 offset0:240 offset1:241
  ds_read2_b32 v[12:13], v62 offset0:242 offset1:243
  ds_read_b32 v14, v62 offset:976
  ds_read2_b32 v[16:17], v62 offset0:112 offset1:113
  ds_read2_b32 v[18:19], v62 offset0:114 offset1:115
  ds_read_b32 v20, v62 offset:464
  ds_read2_b32 v[32:33], v61 offset0:240 offset1:241
  ds_read2_b32 v[34:35], v61 offset0:242 offset1:243
  ds_read_b32 v36, v61 offset:976
  ds_read2_b32 v[38:39], v61 offset0:112 offset1:113
  ds_read2_b32 v[40:41], v61 offset0:114 offset1:115
  ds_read_b32 v42, v61 offset:464
  ds_read2_b32 v[44:45], v60 offset0:240 offset1:241
  ds_read2_b32 v[46:47], v60 offset0:242 offset1:243
  ds_read_b32 v48, v60 offset:976
  s_waitcnt lgkmcnt(12)
  v_alignbyte_b32 v26, v11, v10, v6
  v_alignbyte_b32 v27, v12, v11, v6
  v_alignbyte_b32 v28, v13, v12, v6
  v_alignbyte_b32 v29, v14, v13, v6
  s_waitcnt lgkmcnt(9)
  v_alignbyte_b32 v56, v17, v16, v6
  v_alignbyte_b32 v57, v18, v17, v6
  v_alignbyte_b32 v58, v19, v18, v6
  v_alignbyte_b32 v59, v20, v19, v6
  v_accvgpr_write_b32 a92, v56
  v_accvgpr_write_b32 a93, v57
  v_accvgpr_write_b32 a94, v58
  v_accvgpr_write_b32 a95, v59
  v_mfma_f32_16x16x32_bf16 a[28:31], v[26:29], a[32:35], 0
  ds_read2_b32 v[10:11], v60 offset0:112 offset1:113
  ds_read2_b32 v[12:13], v60 offset0:114 offset1:115
  ds_read_b32 v14, v60 offset:464
  ds_read_b128 a[44:47], v4 offset:3840
  s_waitcnt lgkmcnt(10)
  v_alignbyte_b32 v252, v33, v32, v6
  v_alignbyte_b32 v253, v34, v33, v6
  v_alignbyte_b32 v254, v35, v34, v6
  v_alignbyte_b32 v255, v36, v35, v6
  v_mfma_f32_16x16x32_bf16 a[24:27], a[92:95], a[32:35], 0
  ds_read2_b32 v[16:17], v5 offset0:240 offset1:241
  ds_read2_b32 v[18:19], v5 offset0:242 offset1:243
  ds_read_b32 v20, v5 offset:976
  s_waitcnt lgkmcnt(10)
  v_alignbyte_b32 v220, v39, v38, v6
  v_alignbyte_b32 v221, v40, v39, v6
  v_alignbyte_b32 v222, v41, v40, v6
  v_alignbyte_b32 v223, v42, v41, v6
  v_mfma_f32_16x16x32_bf16 a[20:23], v[252:255], a[32:35], 0
  ds_read2_b32 v[32:33], v5 offset0:112 offset1:113
  ds_read2_b32 v[34:35], v5 offset0:114 offset1:115
  ds_read_b32 v36, v5 offset:464
  s_waitcnt lgkmcnt(10)
  v_alignbyte_b32 v188, v45, v44, v6
  v_alignbyte_b32 v189, v46, v45, v6
  v_alignbyte_b32 v190, v47, v46, v6
  v_alignbyte_b32 v191, v48, v47, v6
  v_mfma_f32_16x16x32_bf16 a[16:19], v[220:223], a[32:35], 0
  ds_read2_b32 v[38:39], v62 offset0:224 offset1:225
  ds_read2_b32 v[40:41], v62 offset0:226 offset1:227
  ds_read_b32 v42, v62 offset:912
  s_waitcnt lgkmcnt(10)
  v_alignbyte_b32 v156, v11, v10, v6
  v_alignbyte_b32 v157, v12, v11, v6
  v_alignbyte_b32 v158, v13, v12, v6
  v_alignbyte_b32 v159, v14, v13, v6
  v_mfma_f32_16x16x32_bf16 a[12:15], v[188:191], a[32:35], 0
  ds_read2_b32 v[44:45], v62 offset0:96 offset1:97
  ds_read2_b32 v[46:47], v62 offset0:98 offset1:99
  ds_read_b32 v48, v62 offset:400
  s_waitcnt lgkmcnt(9)
  v_alignbyte_b32 v124, v17, v16, v6
  v_alignbyte_b32 v125, v18, v17, v6
  v_alignbyte_b32 v126, v19, v18, v6
  v_alignbyte_b32 v127, v20, v19, v6
  v_mfma_f32_16x16x32_bf16 a[8:11], v[156:159], a[32:35], 0
  ds_read2_b32 v[10:11], v61 offset0:224 offset1:225
  ds_read2_b32 v[12:13], v61 offset0:226 offset1:227
  ds_read_b32 v14, v61 offset:912
  s_waitcnt lgkmcnt(9)
  v_alignbyte_b32 v92, v33, v32, v6
  v_alignbyte_b32 v93, v34, v33, v6
  v_alignbyte_b32 v94, v35, v34, v6
  v_alignbyte_b32 v95, v36, v35, v6
  v_mfma_f32_16x16x32_bf16 a[4:7], v[124:127], a[32:35], 0
  ds_read2_b32 v[16:17], v61 offset0:96 offset1:97
  ds_read2_b32 v[18:19], v61 offset0:98 offset1:99
  ds_read_b32 v20, v61 offset:400
  s_waitcnt lgkmcnt(9)
  v_alignbyte_b32 v22, v39, v38, v6
  v_alignbyte_b32 v23, v40, v39, v6
  v_alignbyte_b32 v24, v41, v40, v6
  v_alignbyte_b32 v25, v42, v41, v6
  v_mfma_f32_16x16x32_bf16 a[0:3], v[92:95], a[32:35], 0
  ds_read2_b32 v[32:33], v60 offset0:224 offset1:225
  ds_read2_b32 v[34:35], v60 offset0:226 offset1:227
  ds_read_b32 v36, v60 offset:912
  s_waitcnt lgkmcnt(9)
  v_alignbyte_b32 v56, v45, v44, v6
  v_alignbyte_b32 v57, v46, v45, v6
  v_alignbyte_b32 v58, v47, v46, v6
  v_alignbyte_b32 v59, v48, v47, v6
  v_accvgpr_write_b32 a88, v56
  v_accvgpr_write_b32 a89, v57
  v_accvgpr_write_b32 a90, v58
  v_accvgpr_write_b32 a91, v59
  v_mfma_f32_16x16x32_bf16 a[28:31], v[22:25], a[36:39], a[28:31]
  ds_read2_b32 v[38:39], v60 offset0:96 offset1:97
  ds_read2_b32 v[40:41], v60 offset0:98 offset1:99
  ds_read_b32 v42, v60 offset:400
  ds_read_b128 a[32:35], v4 offset:3776
  s_waitcnt lgkmcnt(10)
  v_alignbyte_b32 v248, v11, v10, v6
  v_alignbyte_b32 v249, v12, v11, v6
  v_alignbyte_b32 v250, v13, v12, v6
  v_alignbyte_b32 v251, v14, v13, v6
  v_mfma_f32_16x16x32_bf16 a[24:27], a[88:91], a[36:39], a[24:27]
  ds_read2_b32 v[44:45], v5 offset0:224 offset1:225
  ds_read2_b32 v[46:47], v5 offset0:226 offset1:227
  ds_read_b32 v48, v5 offset:912
  s_waitcnt lgkmcnt(10)
  v_alignbyte_b32 v216, v17, v16, v6
  v_alignbyte_b32 v217, v18, v17, v6
  v_alignbyte_b32 v218, v19, v18, v6
  v_alignbyte_b32 v219, v20, v19, v6
  v_mfma_f32_16x16x32_bf16 a[20:23], v[248:251], a[36:39], a[20:23]
  ds_read2_b32 v[10:11], v5 offset0:96 offset1:97
  ds_read2_b32 v[12:13], v5 offset0:98 offset1:99
  ds_read_b32 v14, v5 offset:400
  s_waitcnt lgkmcnt(10)
  v_alignbyte_b32 v184, v33, v32, v6
  v_alignbyte_b32 v185, v34, v33, v6
  v_alignbyte_b32 v186, v35, v34, v6
  v_alignbyte_b32 v187, v36, v35, v6
  v_mfma_f32_16x16x32_bf16 a[16:19], v[216:219], a[36:39], a[16:19]
  ds_read2_b32 v[16:17], v62 offset0:208 offset1:209
  ds_read2_b32 v[18:19], v62 offset0:210 offset1:211
  ds_read_b32 v20, v62 offset:848
  s_waitcnt lgkmcnt(10)
  v_alignbyte_b32 v152, v39, v38, v6
  v_alignbyte_b32 v153, v40, v39, v6
  v_alignbyte_b32 v154, v41, v40, v6
  v_alignbyte_b32 v155, v42, v41, v6
  v_mfma_f32_16x16x32_bf16 a[12:15], v[184:187], a[36:39], a[12:15]
  ds_read2_b32 v[32:33], v62 offset0:80 offset1:81
  ds_read2_b32 v[34:35], v62 offset0:82 offset1:83
  ds_read_b32 v36, v62 offset:336
  s_waitcnt lgkmcnt(9)
  v_alignbyte_b32 v120, v45, v44, v6
  v_alignbyte_b32 v121, v46, v45, v6
  v_alignbyte_b32 v122, v47, v46, v6
  v_alignbyte_b32 v123, v48, v47, v6
  v_mfma_f32_16x16x32_bf16 a[8:11], v[152:155], a[36:39], a[8:11]
  ds_read2_b32 v[38:39], v61 offset0:208 offset1:209
  ds_read2_b32 v[40:41], v61 offset0:210 offset1:211
  ds_read_b32 v42, v61 offset:848
  s_waitcnt lgkmcnt(9)
  v_alignbyte_b32 v88, v11, v10, v6
  v_alignbyte_b32 v89, v12, v11, v6
  v_alignbyte_b32 v90, v13, v12, v6
  v_alignbyte_b32 v91, v14, v13, v6
  v_mfma_f32_16x16x32_bf16 a[4:7], v[120:123], a[36:39], a[4:7]
  ds_read2_b32 v[44:45], v61 offset0:80 offset1:81
  ds_read2_b32 v[46:47], v61 offset0:82 offset1:83
  ds_read_b32 v48, v61 offset:336
  s_waitcnt lgkmcnt(9)
  v_alignbyte_b32 v26, v17, v16, v6
  v_alignbyte_b32 v27, v18, v17, v6
  v_alignbyte_b32 v28, v19, v18, v6
  v_alignbyte_b32 v29, v20, v19, v6
  v_mfma_f32_16x16x32_bf16 a[0:3], v[88:91], a[36:39], a[0:3]
  ds_read2_b32 v[10:11], v60 offset0:208 offset1:209
  ds_read2_b32 v[12:13], v60 offset0:210 offset1:211
  ds_read_b32 v14, v60 offset:848
  s_waitcnt lgkmcnt(9)
  v_alignbyte_b32 v56, v33, v32, v6
  v_alignbyte_b32 v57, v34, v33, v6
  v_alignbyte_b32 v58, v35, v34, v6
  v_alignbyte_b32 v59, v36, v35, v6
  v_accvgpr_write_b32 a84, v56
  v_accvgpr_write_b32 a85, v57
  v_accvgpr_write_b32 a86, v58
  v_accvgpr_write_b32 a87, v59
  v_mfma_f32_16x16x32_bf16 a[28:31], v[26:29], a[40:43], a[28:31]
  ds_read2_b32 v[16:17], v60 offset0:80 offset1:81
  ds_read2_b32 v[18:19], v60 offset0:82 offset1:83
  ds_read_b32 v20, v60 offset:336
  ds_read_b128 a[36:39], v4 offset:3712
  s_waitcnt lgkmcnt(10)
  v_alignbyte_b32 v244, v39, v38, v6
  v_alignbyte_b32 v245, v40, v39, v6
  v_alignbyte_b32 v246, v41, v40, v6
  v_alignbyte_b32 v247, v42, v41, v6
  v_mfma_f32_16x16x32_bf16 a[24:27], a[84:87], a[40:43], a[24:27]
  ds_read2_b32 v[32:33], v5 offset0:208 offset1:209
  ds_read2_b32 v[34:35], v5 offset0:210 offset1:211
  ds_read_b32 v36, v5 offset:848
  s_waitcnt lgkmcnt(10)
  v_alignbyte_b32 v212, v45, v44, v6
  v_alignbyte_b32 v213, v46, v45, v6
  v_alignbyte_b32 v214, v47, v46, v6
  v_alignbyte_b32 v215, v48, v47, v6
  v_mfma_f32_16x16x32_bf16 a[20:23], v[244:247], a[40:43], a[20:23]
  ds_read2_b32 v[38:39], v5 offset0:80 offset1:81
  ds_read2_b32 v[40:41], v5 offset0:82 offset1:83
  ds_read_b32 v42, v5 offset:336
  s_waitcnt lgkmcnt(10)
  v_alignbyte_b32 v180, v11, v10, v6
  v_alignbyte_b32 v181, v12, v11, v6
  v_alignbyte_b32 v182, v13, v12, v6
  v_alignbyte_b32 v183, v14, v13, v6
  v_mfma_f32_16x16x32_bf16 a[16:19], v[212:215], a[40:43], a[16:19]
  ds_read2_b32 v[44:45], v62 offset0:192 offset1:193
  ds_read2_b32 v[46:47], v62 offset0:194 offset1:195
  ds_read_b32 v48, v62 offset:784
  s_waitcnt lgkmcnt(10)
  v_alignbyte_b32 v148, v17, v16, v6
  v_alignbyte_b32 v149, v18, v17, v6
  v_alignbyte_b32 v150, v19, v18, v6
  v_alignbyte_b32 v151, v20, v19, v6
  v_mfma_f32_16x16x32_bf16 a[12:15], v[180:183], a[40:43], a[12:15]
  ds_read2_b32 v[10:11], v62 offset0:64 offset1:65
  ds_read2_b32 v[12:13], v62 offset0:66 offset1:67
  ds_read_b32 v14, v62 offset:272
  s_waitcnt lgkmcnt(9)
  v_alignbyte_b32 v116, v33, v32, v6
  v_alignbyte_b32 v117, v34, v33, v6
  v_alignbyte_b32 v118, v35, v34, v6
  v_alignbyte_b32 v119, v36, v35, v6
  v_mfma_f32_16x16x32_bf16 a[8:11], v[148:151], a[40:43], a[8:11]
  ds_read2_b32 v[16:17], v61 offset0:192 offset1:193
  ds_read2_b32 v[18:19], v61 offset0:194 offset1:195
  ds_read_b32 v20, v61 offset:784
  s_waitcnt lgkmcnt(9)
  v_alignbyte_b32 v84, v39, v38, v6
  v_alignbyte_b32 v85, v40, v39, v6
  v_alignbyte_b32 v86, v41, v40, v6
  v_alignbyte_b32 v87, v42, v41, v6
  v_mfma_f32_16x16x32_bf16 a[4:7], v[116:119], a[40:43], a[4:7]
  ds_read2_b32 v[32:33], v61 offset0:64 offset1:65
  ds_read2_b32 v[34:35], v61 offset0:66 offset1:67
  ds_read_b32 v36, v61 offset:272
  s_waitcnt lgkmcnt(9)
  v_alignbyte_b32 v22, v45, v44, v6
  v_alignbyte_b32 v23, v46, v45, v6
  v_alignbyte_b32 v24, v47, v46, v6
  v_alignbyte_b32 v25, v48, v47, v6
  v_mfma_f32_16x16x32_bf16 a[0:3], v[84:87], a[40:43], a[0:3]
  ds_read2_b32 v[38:39], v60 offset0:192 offset1:193
  ds_read2_b32 v[40:41], v60 offset0:194 offset1:195
  ds_read_b32 v42, v60 offset:784
  s_waitcnt lgkmcnt(9)
  v_alignbyte_b32 v56, v11, v10, v6
  v_alignbyte_b32 v57, v12, v11, v6
  v_alignbyte_b32 v58, v13, v12, v6
  v_alignbyte_b32 v59, v14, v13, v6
  v_accvgpr_write_b32 a80, v56
  v_accvgpr_write_b32 a81, v57
  v_accvgpr_write_b32 a82, v58
  v_accvgpr_write_b32 a83, v59
  v_mfma_f32_16x16x32_bf16 a[28:31], v[22:25], a[44:47], a[28:31]
  ds_read2_b32 v[44:45], v60 offset0:64 offset1:65
  ds_read2_b32 v[46:47], v60 offset0:66 offset1:67
  ds_read_b32 v48, v60 offset:272
  ds_read_b128 a[40:43], v4 offset:3648
  s_waitcnt lgkmcnt(10)
  v_alignbyte_b32 v240, v17, v16, v6
  v_alignbyte_b32 v241, v18, v17, v6
  v_alignbyte_b32 v242, v19, v18, v6
  v_alignbyte_b32 v243, v20, v19, v6
  v_mfma_f32_16x16x32_bf16 a[24:27], a[80:83], a[44:47], a[24:27]
  ds_read2_b32 v[10:11], v5 offset0:192 offset1:193
  ds_read2_b32 v[12:13], v5 offset0:194 offset1:195
  ds_read_b32 v14, v5 offset:784
  s_waitcnt lgkmcnt(10)
  v_alignbyte_b32 v208, v33, v32, v6
  v_alignbyte_b32 v209, v34, v33, v6
  v_alignbyte_b32 v210, v35, v34, v6
  v_alignbyte_b32 v211, v36, v35, v6
  v_mfma_f32_16x16x32_bf16 a[20:23], v[240:243], a[44:47], a[20:23]
  ds_read2_b32 v[16:17], v5 offset0:64 offset1:65
  ds_read2_b32 v[18:19], v5 offset0:66 offset1:67
  ds_read_b32 v20, v5 offset:272
  s_waitcnt lgkmcnt(10)
  v_alignbyte_b32 v176, v39, v38, v6
  v_alignbyte_b32 v177, v40, v39, v6
  v_alignbyte_b32 v178, v41, v40, v6
  v_alignbyte_b32 v179, v42, v41, v6
  v_mfma_f32_16x16x32_bf16 a[16:19], v[208:211], a[44:47], a[16:19]
  ds_read2_b32 v[32:33], v62 offset0:176 offset1:177
  ds_read2_b32 v[34:35], v62 offset0:178 offset1:179
  ds_read_b32 v36, v62 offset:720
  s_waitcnt lgkmcnt(10)
  v_alignbyte_b32 v144, v45, v44, v6
  v_alignbyte_b32 v145, v46, v45, v6
  v_alignbyte_b32 v146, v47, v46, v6
  v_alignbyte_b32 v147, v48, v47, v6
  v_mfma_f32_16x16x32_bf16 a[12:15], v[176:179], a[44:47], a[12:15]
  ds_read2_b32 v[38:39], v62 offset0:48 offset1:49
  ds_read2_b32 v[40:41], v62 offset0:50 offset1:51
  ds_read_b32 v42, v62 offset:208
  s_waitcnt lgkmcnt(9)
  v_alignbyte_b32 v112, v11, v10, v6
  v_alignbyte_b32 v113, v12, v11, v6
  v_alignbyte_b32 v114, v13, v12, v6
  v_alignbyte_b32 v115, v14, v13, v6
  v_mfma_f32_16x16x32_bf16 a[8:11], v[144:147], a[44:47], a[8:11]
  ds_read2_b32 v[44:45], v61 offset0:176 offset1:177
  ds_read2_b32 v[46:47], v61 offset0:178 offset1:179
  ds_read_b32 v48, v61 offset:720
  s_waitcnt lgkmcnt(9)
  v_alignbyte_b32 v80, v17, v16, v6
  v_alignbyte_b32 v81, v18, v17, v6
  v_alignbyte_b32 v82, v19, v18, v6
  v_alignbyte_b32 v83, v20, v19, v6
  v_mfma_f32_16x16x32_bf16 a[4:7], v[112:115], a[44:47], a[4:7]
  ds_read2_b32 v[10:11], v61 offset0:48 offset1:49
  ds_read2_b32 v[12:13], v61 offset0:50 offset1:51
  ds_read_b32 v14, v61 offset:208
  s_waitcnt lgkmcnt(9)
  v_alignbyte_b32 v26, v33, v32, v6
  v_alignbyte_b32 v27, v34, v33, v6
  v_alignbyte_b32 v28, v35, v34, v6
  v_alignbyte_b32 v29, v36, v35, v6
  v_mfma_f32_16x16x32_bf16 a[0:3], v[80:83], a[44:47], a[0:3]
  ds_read2_b32 v[16:17], v60 offset0:176 offset1:177
  ds_read2_b32 v[18:19], v60 offset0:178 offset1:179
  ds_read_b32 v20, v60 offset:720
  s_waitcnt lgkmcnt(9)
  v_alignbyte_b32 v56, v39, v38, v6
  v_alignbyte_b32 v57, v40, v39, v6
  v_alignbyte_b32 v58, v41, v40, v6
  v_alignbyte_b32 v59, v42, v41, v6
  v_accvgpr_write_b32 a76, v56
  v_accvgpr_write_b32 a77, v57
  v_accvgpr_write_b32 a78, v58
  v_accvgpr_write_b32 a79, v59
  v_mfma_f32_16x16x32_bf16 a[28:31], v[26:29], a[32:35], a[28:31]
  ds_read2_b32 v[32:33], v60 offset0:48 offset1:49
  ds_read2_b32 v[34:35], v60 offset0:50 offset1:51
  ds_read_b32 v36, v60 offset:208
  ds_read_b128 a[44:47], v4 offset:3584
  s_waitcnt lgkmcnt(10)
  v_alignbyte_b32 v236, v45, v44, v6
  v_alignbyte_b32 v237, v46, v45, v6
  v_alignbyte_b32 v238, v47, v46, v6
  v_alignbyte_b32 v239, v48, v47, v6
  v_mfma_f32_16x16x32_bf16 a[24:27], a[76:79], a[32:35], a[24:27]
  ds_read2_b32 v[38:39], v5 offset0:176 offset1:177
  ds_read2_b32 v[40:41], v5 offset0:178 offset1:179
  ds_read_b32 v42, v5 offset:720
  s_waitcnt lgkmcnt(10)
  v_alignbyte_b32 v204, v11, v10, v6
  v_alignbyte_b32 v205, v12, v11, v6
  v_alignbyte_b32 v206, v13, v12, v6
  v_alignbyte_b32 v207, v14, v13, v6
  v_mfma_f32_16x16x32_bf16 a[20:23], v[236:239], a[32:35], a[20:23]
  ds_read2_b32 v[44:45], v5 offset0:48 offset1:49
  ds_read2_b32 v[46:47], v5 offset0:50 offset1:51
  ds_read_b32 v48, v5 offset:208
  s_waitcnt lgkmcnt(10)
  v_alignbyte_b32 v172, v17, v16, v6
  v_alignbyte_b32 v173, v18, v17, v6
  v_alignbyte_b32 v174, v19, v18, v6
  v_alignbyte_b32 v175, v20, v19, v6
  v_mfma_f32_16x16x32_bf16 a[16:19], v[204:207], a[32:35], a[16:19]
  ds_read2_b32 v[10:11], v62 offset0:160 offset1:161
  ds_read2_b32 v[12:13], v62 offset0:162 offset1:163
  ds_read_b32 v14, v62 offset:656
  s_waitcnt lgkmcnt(10)
  v_alignbyte_b32 v140, v33, v32, v6
  v_alignbyte_b32 v141, v34, v33, v6
  v_alignbyte_b32 v142, v35, v34, v6
  v_alignbyte_b32 v143, v36, v35, v6
  v_mfma_f32_16x16x32_bf16 a[12:15], v[172:175], a[32:35], a[12:15]
  ds_read2_b32 v[16:17], v62 offset0:32 offset1:33
  ds_read2_b32 v[18:19], v62 offset0:34 offset1:35
  ds_read_b32 v20, v62 offset:144
  s_waitcnt lgkmcnt(9)
  v_alignbyte_b32 v108, v39, v38, v6
  v_alignbyte_b32 v109, v40, v39, v6
  v_alignbyte_b32 v110, v41, v40, v6
  v_alignbyte_b32 v111, v42, v41, v6
  v_mfma_f32_16x16x32_bf16 a[8:11], v[140:143], a[32:35], a[8:11]
  ds_read2_b32 v[32:33], v61 offset0:160 offset1:161
  ds_read2_b32 v[34:35], v61 offset0:162 offset1:163
  ds_read_b32 v36, v61 offset:656
  s_waitcnt lgkmcnt(9)
  v_alignbyte_b32 v76, v45, v44, v6
  v_alignbyte_b32 v77, v46, v45, v6
  v_alignbyte_b32 v78, v47, v46, v6
  v_alignbyte_b32 v79, v48, v47, v6
  v_mfma_f32_16x16x32_bf16 a[4:7], v[108:111], a[32:35], a[4:7]
  ds_read2_b32 v[38:39], v61 offset0:32 offset1:33
  ds_read2_b32 v[40:41], v61 offset0:34 offset1:35
  ds_read_b32 v42, v61 offset:144
  s_waitcnt lgkmcnt(9)
  v_alignbyte_b32 v22, v11, v10, v6
  v_alignbyte_b32 v23, v12, v11, v6
  v_alignbyte_b32 v24, v13, v12, v6
  v_alignbyte_b32 v25, v14, v13, v6
  v_mfma_f32_16x16x32_bf16 a[0:3], v[76:79], a[32:35], a[0:3]
  ds_read2_b32 v[44:45], v60 offset0:160 offset1:161
  ds_read2_b32 v[46:47], v60 offset0:162 offset1:163
  ds_read_b32 v48, v60 offset:656
  s_waitcnt lgkmcnt(9)
  v_alignbyte_b32 v56, v17, v16, v6
  v_alignbyte_b32 v57, v18, v17, v6
  v_alignbyte_b32 v58, v19, v18, v6
  v_alignbyte_b32 v59, v20, v19, v6
  v_accvgpr_write_b32 a72, v56
  v_accvgpr_write_b32 a73, v57
  v_accvgpr_write_b32 a74, v58
  v_accvgpr_write_b32 a75, v59
  v_mfma_f32_16x16x32_bf16 a[28:31], v[22:25], a[36:39], a[28:31]
  ds_read2_b32 v[10:11], v60 offset0:32 offset1:33
  ds_read2_b32 v[12:13], v60 offset0:34 offset1:35
  ds_read_b32 v14, v60 offset:144
  ds_read_b128 a[32:35], v4 offset:3520
  s_waitcnt lgkmcnt(10)
  v_alignbyte_b32 v232, v33, v32, v6
  v_alignbyte_b32 v233, v34, v33, v6
  v_alignbyte_b32 v234, v35, v34, v6
  v_alignbyte_b32 v235, v36, v35, v6
  v_mfma_f32_16x16x32_bf16 a[24:27], a[72:75], a[36:39], a[24:27]
  ds_read2_b32 v[16:17], v5 offset0:160 offset1:161
  ds_read2_b32 v[18:19], v5 offset0:162 offset1:163
  ds_read_b32 v20, v5 offset:656
  s_waitcnt lgkmcnt(10)
  v_alignbyte_b32 v200, v39, v38, v6
  v_alignbyte_b32 v201, v40, v39, v6
  v_alignbyte_b32 v202, v41, v40, v6
  v_alignbyte_b32 v203, v42, v41, v6
  v_mfma_f32_16x16x32_bf16 a[20:23], v[232:235], a[36:39], a[20:23]
  ds_read2_b32 v[32:33], v5 offset0:32 offset1:33
  ds_read2_b32 v[34:35], v5 offset0:34 offset1:35
  ds_read_b32 v36, v5 offset:144
  s_waitcnt lgkmcnt(10)
  v_alignbyte_b32 v168, v45, v44, v6
  v_alignbyte_b32 v169, v46, v45, v6
  v_alignbyte_b32 v170, v47, v46, v6
  v_alignbyte_b32 v171, v48, v47, v6
  v_mfma_f32_16x16x32_bf16 a[16:19], v[200:203], a[36:39], a[16:19]
  ds_read2_b32 v[38:39], v62 offset0:144 offset1:145
  ds_read2_b32 v[40:41], v62 offset0:146 offset1:147
  ds_read_b32 v42, v62 offset:592
  s_waitcnt lgkmcnt(10)
  v_alignbyte_b32 v136, v11, v10, v6
  v_alignbyte_b32 v137, v12, v11, v6
  v_alignbyte_b32 v138, v13, v12, v6
  v_alignbyte_b32 v139, v14, v13, v6
  v_mfma_f32_16x16x32_bf16 a[12:15], v[168:171], a[36:39], a[12:15]
  ds_read2_b32 v[44:45], v62 offset0:16 offset1:17
  ds_read2_b32 v[46:47], v62 offset0:18 offset1:19
  ds_read_b32 v48, v62 offset:80
  s_waitcnt lgkmcnt(9)
  v_alignbyte_b32 v104, v17, v16, v6
  v_alignbyte_b32 v105, v18, v17, v6
  v_alignbyte_b32 v106, v19, v18, v6
  v_alignbyte_b32 v107, v20, v19, v6
  v_mfma_f32_16x16x32_bf16 a[8:11], v[136:139], a[36:39], a[8:11]
  ds_read2_b32 v[10:11], v61 offset0:144 offset1:145
  ds_read2_b32 v[12:13], v61 offset0:146 offset1:147
  ds_read_b32 v14, v61 offset:592
  s_waitcnt lgkmcnt(9)
  v_alignbyte_b32 v72, v33, v32, v6
  v_alignbyte_b32 v73, v34, v33, v6
  v_alignbyte_b32 v74, v35, v34, v6
  v_alignbyte_b32 v75, v36, v35, v6
  v_mfma_f32_16x16x32_bf16 a[4:7], v[104:107], a[36:39], a[4:7]
  ds_read2_b32 v[16:17], v61 offset0:16 offset1:17
  ds_read2_b32 v[18:19], v61 offset0:18 offset1:19
  ds_read_b32 v20, v61 offset:80
  s_waitcnt lgkmcnt(9)
  v_alignbyte_b32 v26, v39, v38, v6
  v_alignbyte_b32 v27, v40, v39, v6
  v_alignbyte_b32 v28, v41, v40, v6
  v_alignbyte_b32 v29, v42, v41, v6
  v_mfma_f32_16x16x32_bf16 a[0:3], v[72:75], a[36:39], a[0:3]
  ds_read2_b32 v[32:33], v60 offset0:144 offset1:145
  ds_read2_b32 v[34:35], v60 offset0:146 offset1:147
  ds_read_b32 v36, v60 offset:592
  s_waitcnt lgkmcnt(9)
  v_alignbyte_b32 v56, v45, v44, v6
  v_alignbyte_b32 v57, v46, v45, v6
  v_alignbyte_b32 v58, v47, v46, v6
  v_alignbyte_b32 v59, v48, v47, v6
  v_accvgpr_write_b32 a68, v56
  v_accvgpr_write_b32 a69, v57
  v_accvgpr_write_b32 a70, v58
  v_accvgpr_write_b32 a71, v59
  v_mfma_f32_16x16x32_bf16 a[28:31], v[26:29], a[40:43], a[28:31]
  ds_read2_b32 v[38:39], v60 offset0:16 offset1:17
  ds_read2_b32 v[40:41], v60 offset0:18 offset1:19
  ds_read_b32 v42, v60 offset:80
  ds_read_b128 a[36:39], v4 offset:3456
  s_waitcnt lgkmcnt(10)
  v_alignbyte_b32 v228, v11, v10, v6
  v_alignbyte_b32 v229, v12, v11, v6
  v_alignbyte_b32 v230, v13, v12, v6
  v_alignbyte_b32 v231, v14, v13, v6
  v_mfma_f32_16x16x32_bf16 a[24:27], a[68:71], a[40:43], a[24:27]
  ds_read2_b32 v[44:45], v5 offset0:144 offset1:145
  ds_read2_b32 v[46:47], v5 offset0:146 offset1:147
  ds_read_b32 v48, v5 offset:592
  s_waitcnt lgkmcnt(10)
  v_alignbyte_b32 v196, v17, v16, v6
  v_alignbyte_b32 v197, v18, v17, v6
  v_alignbyte_b32 v198, v19, v18, v6
  v_alignbyte_b32 v199, v20, v19, v6
  v_mfma_f32_16x16x32_bf16 a[20:23], v[228:231], a[40:43], a[20:23]
  ds_read2_b32 v[10:11], v5 offset0:16 offset1:17
  ds_read2_b32 v[12:13], v5 offset0:18 offset1:19
  ds_read_b32 v14, v5 offset:80
  s_waitcnt lgkmcnt(10)
  v_alignbyte_b32 v164, v33, v32, v6
  v_alignbyte_b32 v165, v34, v33, v6
  v_alignbyte_b32 v166, v35, v34, v6
  v_alignbyte_b32 v167, v36, v35, v6
  v_mfma_f32_16x16x32_bf16 a[16:19], v[196:199], a[40:43], a[16:19]
  ds_read2_b32 v[16:17], v62 offset0:128 offset1:129
  ds_read2_b32 v[18:19], v62 offset0:130 offset1:131
  ds_read_b32 v20, v62 offset:528
  s_waitcnt lgkmcnt(10)
  v_alignbyte_b32 v132, v39, v38, v6
  v_alignbyte_b32 v133, v40, v39, v6
  v_alignbyte_b32 v134, v41, v40, v6
  v_alignbyte_b32 v135, v42, v41, v6
  v_mfma_f32_16x16x32_bf16 a[12:15], v[164:167], a[40:43], a[12:15]
  ds_read2_b32 v[32:33], v62 offset0:0 offset1:1
  ds_read2_b32 v[34:35], v62 offset0:2 offset1:3
  ds_read_b32 v36, v62 offset:16
  s_waitcnt lgkmcnt(9)
  v_alignbyte_b32 v100, v45, v44, v6
  v_alignbyte_b32 v101, v46, v45, v6
  v_alignbyte_b32 v102, v47, v46, v6
  v_alignbyte_b32 v103, v48, v47, v6
  v_mfma_f32_16x16x32_bf16 a[8:11], v[132:135], a[40:43], a[8:11]
  ds_read2_b32 v[38:39], v61 offset0:128 offset1:129
  ds_read2_b32 v[40:41], v61 offset0:130 offset1:131
  ds_read_b32 v42, v61 offset:528
  s_waitcnt lgkmcnt(9)
  v_alignbyte_b32 v68, v11, v10, v6
  v_alignbyte_b32 v69, v12, v11, v6
  v_alignbyte_b32 v70, v13, v12, v6
  v_alignbyte_b32 v71, v14, v13, v6
  v_mfma_f32_16x16x32_bf16 a[4:7], v[100:103], a[40:43], a[4:7]
  ds_read2_b32 v[44:45], v61 offset0:0 offset1:1
  ds_read2_b32 v[46:47], v61 offset0:2 offset1:3
  ds_read_b32 v48, v61 offset:16
  s_waitcnt lgkmcnt(9)
  v_alignbyte_b32 v22, v17, v16, v6
  v_alignbyte_b32 v23, v18, v17, v6
  v_alignbyte_b32 v24, v19, v18, v6
  v_alignbyte_b32 v25, v20, v19, v6
  v_mfma_f32_16x16x32_bf16 a[0:3], v[68:71], a[40:43], a[0:3]
  ds_read2_b32 v[10:11], v60 offset0:128 offset1:129
  ds_read2_b32 v[12:13], v60 offset0:130 offset1:131
  ds_read_b32 v14, v60 offset:528
  s_waitcnt lgkmcnt(9)
  v_alignbyte_b32 v56, v33, v32, v6
  v_alignbyte_b32 v57, v34, v33, v6
  v_alignbyte_b32 v58, v35, v34, v6
  v_alignbyte_b32 v59, v36, v35, v6
  v_accvgpr_write_b32 a64, v56
  v_accvgpr_write_b32 a65, v57
  v_accvgpr_write_b32 a66, v58
  v_accvgpr_write_b32 a67, v59
  v_mfma_f32_16x16x32_bf16 a[28:31], v[22:25], a[44:47], a[28:31]
  ds_read2_b32 v[16:17], v60 offset0:0 offset1:1
  ds_read2_b32 v[18:19], v60 offset0:2 offset1:3
  ds_read_b32 v20, v60 offset:16
  ds_read_b128 a[40:43], v4 offset:3392
  s_waitcnt lgkmcnt(10)
  v_alignbyte_b32 v224, v39, v38, v6
  v_alignbyte_b32 v225, v40, v39, v6
  v_alignbyte_b32 v226, v41, v40, v6
  v_alignbyte_b32 v227, v42, v41, v6
  v_mfma_f32_16x16x32_bf16 a[24:27], a[64:67], a[44:47], a[24:27]
  ds_read2_b32 v[32:33], v5 offset0:128 offset1:129
  ds_read2_b32 v[34:35], v5 offset0:130 offset1:131
  ds_read_b32 v36, v5 offset:528
  s_waitcnt lgkmcnt(10)
  v_alignbyte_b32 v192, v45, v44, v6
  v_alignbyte_b32 v193, v46, v45, v6
  v_alignbyte_b32 v194, v47, v46, v6
  v_alignbyte_b32 v195, v48, v47, v6
  v_mfma_f32_16x16x32_bf16 a[20:23], v[224:227], a[44:47], a[20:23]
  ds_read2_b32 v[38:39], v5 offset0:0 offset1:1
  ds_read2_b32 v[40:41], v5 offset0:2 offset1:3
  ds_read_b32 v42, v5 offset:16
  s_waitcnt lgkmcnt(10)
  v_alignbyte_b32 v160, v11, v10, v6
  v_alignbyte_b32 v161, v12, v11, v6
  v_alignbyte_b32 v162, v13, v12, v6
  v_alignbyte_b32 v163, v14, v13, v6
  v_mfma_f32_16x16x32_bf16 a[16:19], v[192:195], a[44:47], a[16:19]
  s_waitcnt lgkmcnt(7)
  v_alignbyte_b32 v128, v17, v16, v6
  v_alignbyte_b32 v129, v18, v17, v6
  v_alignbyte_b32 v130, v19, v18, v6
  v_alignbyte_b32 v131, v20, v19, v6
  v_mfma_f32_16x16x32_bf16 a[12:15], v[160:163], a[44:47], a[12:15]
  s_waitcnt lgkmcnt(3)
  v_alignbyte_b32 v96, v33, v32, v6
  v_alignbyte_b32 v97, v34, v33, v6
  v_alignbyte_b32 v98, v35, v34, v6
  v_alignbyte_b32 v99, v36, v35, v6
  v_mfma_f32_16x16x32_bf16 a[8:11], v[128:131], a[44:47], a[8:11]
  s_waitcnt lgkmcnt(0)
  v_alignbyte_b32 v64, v39, v38, v6
  v_alignbyte_b32 v65, v40, v39, v6
  v_alignbyte_b32 v66, v41, v40, v6
  v_alignbyte_b32 v67, v42, v41, v6
  v_mfma_f32_16x16x32_bf16 a[4:7], v[96:99], a[44:47], a[4:7]
  s_nop 0
  v_mfma_f32_16x16x32_bf16 a[0:3], v[64:67], a[44:47], a[0:3]
  v_mfma_f32_16x16x32_bf16 a[28:31], a[92:95], a[32:35], a[28:31]
  ds_read_b128 a[44:47], v4 offset:3328
  ds_read_b64 v[36:37], v7 offset:0
  ds_read_b64 v[38:39], v8 offset:0
  s_nop 3
  v_accvgpr_read_b32 v44, a0
  v_accvgpr_read_b32 v45, a1
  v_mfma_f32_16x16x32_bf16 a[24:27], v[252:255], a[32:35], a[24:27]
  v_accvgpr_read_b32 v46, a2
  v_accvgpr_read_b32 v47, a3
  v_mfma_f32_16x16x32_bf16 a[20:23], v[220:223], a[32:35], a[20:23]
  s_waitcnt lgkmcnt(0)
  v_lshlrev_b32 v48, 16, v36
  v_and_b32 v49, 0xffff0000, v36
  v_mfma_f32_16x16x32_bf16 a[16:19], v[188:191], a[32:35], a[16:19]
  v_lshlrev_b32 v50, 16, v37
  v_and_b32 v51, 0xffff0000, v37
  v_mfma_f32_16x16x32_bf16 a[12:15], v[156:159], a[32:35], a[12:15]
  v_lshlrev_b32 v32, 16, v38
  v_and_b32 v33, 0xffff0000, v38
  v_mfma_f32_16x16x32_bf16 a[8:11], v[124:127], a[32:35], a[8:11]
  v_lshlrev_b32 v34, 16, v39
  v_and_b32 v35, 0xffff0000, v39
  v_mfma_f32_16x16x32_bf16 a[4:7], v[92:95], a[32:35], a[4:7]
  v_mul_f32 v52, v48, v31
  v_mul_f32 v53, v49, v31
  v_mfma_f32_16x16x32_bf16 a[28:31], a[88:91], a[36:39], a[28:31]
  ds_read_b128 a[32:35], v4 offset:3264
  v_mul_f32 v54, v50, v31
  v_mul_f32 v55, v51, v31
  v_mfma_f32_16x16x32_bf16 a[24:27], v[248:251], a[36:39], a[24:27]
  v_fmac_f32 v44, s61, v48
  v_fmac_f32 v45, s61, v49
  v_mfma_f32_16x16x32_bf16 a[20:23], v[216:219], a[36:39], a[20:23]
  v_fmac_f32 v46, s61, v50
  v_fmac_f32 v47, s61, v51
  v_mfma_f32_16x16x32_bf16 a[16:19], v[184:187], a[36:39], a[16:19]
  v_cvt_pk_bf16_f32 v36, v52, v53
  v_cvt_pk_bf16_f32 v37, v54, v55
  v_mfma_f32_16x16x32_bf16 a[12:15], v[152:155], a[36:39], a[12:15]
  v_lshlrev_b32 v52, 16, v36
  v_and_b32 v53, 0xffff0000, v36
  v_mfma_f32_16x16x32_bf16 a[8:11], v[120:123], a[36:39], a[8:11]
  v_lshlrev_b32 v54, 16, v37
  v_and_b32 v55, 0xffff0000, v37
  v_mfma_f32_16x16x32_bf16 a[4:7], v[88:91], a[36:39], a[4:7]
  v_cvt_pk_bf16_f32 v36, v44, v45
  v_cvt_pk_bf16_f32 v37, v46, v47
  v_mfma_f32_16x16x32_bf16 a[28:31], a[84:87], a[40:43], a[28:31]
  ds_read_b128 a[36:39], v4 offset:3200
  v_lshlrev_b32 v44, 16, v36
  v_and_b32 v45, 0xffff0000, v36
  v_mfma_f32_16x16x32_bf16 a[24:27], v[244:247], a[40:43], a[24:27]
  v_lshlrev_b32 v46, 16, v37
  v_and_b32 v47, 0xffff0000, v37
  v_mfma_f32_16x16x32_bf16 a[20:23], v[212:215], a[40:43], a[20:23]
  v_add_f32 v44, v44, v52
  v_add_f32 v45, v45, v53
  v_mfma_f32_16x16x32_bf16 a[16:19], v[180:183], a[40:43], a[16:19]
  v_add_f32 v46, v46, v54
  v_add_f32 v47, v47, v55
  v_mfma_f32_16x16x32_bf16 a[12:15], v[148:151], a[40:43], a[12:15]
  v_cvt_pk_bf16_f32 v36, v44, v45
  v_cvt_pk_bf16_f32 v37, v46, v47
  v_mfma_f32_16x16x32_bf16 a[8:11], v[116:119], a[40:43], a[8:11]
  v_lshlrev_b32 v44, 16, v36
  v_and_b32 v45, 0xffff0000, v36
  v_mfma_f32_16x16x32_bf16 a[4:7], v[84:87], a[40:43], a[4:7]
  v_lshlrev_b32 v46, 16, v37
  v_and_b32 v47, 0xffff0000, v37
  v_mfma_f32_16x16x32_bf16 a[28:31], a[80:83], a[44:47], a[28:31]
  ds_read_b128 a[40:43], v4 offset:3136
  v_add_f32 v44, v44, v32
  v_add_f32 v45, v45, v33
  v_mfma_f32_16x16x32_bf16 a[24:27], v[240:243], a[44:47], a[24:27]
  v_add_f32 v46, v46, v34
  v_add_f32 v47, v47, v35
  v_mfma_f32_16x16x32_bf16 a[20:23], v[208:211], a[44:47], a[20:23]
  v_cvt_pk_bf16_f32 v36, v44, v45
  v_cvt_pk_bf16_f32 v37, v46, v47
  v_mfma_f32_16x16x32_bf16 a[16:19], v[176:179], a[44:47], a[16:19]
  s_add_u32 s6, s62, 0
  buffer_store_dwordx2 v[36:37], v9, s[8:11], s6 offen sc1
  v_mfma_f32_16x16x32_bf16 a[12:15], v[144:147], a[44:47], a[12:15]
  v_mfma_f32_16x16x32_bf16 a[8:11], v[112:115], a[44:47], a[8:11]
  v_mfma_f32_16x16x32_bf16 a[4:7], v[80:83], a[44:47], a[4:7]
  s_waitcnt lgkmcnt(2)
  v_mfma_f32_16x16x32_bf16 a[28:31], a[76:79], a[32:35], a[28:31]
  ds_read_b128 a[44:47], v4 offset:3072
  v_mfma_f32_16x16x32_bf16 a[24:27], v[236:239], a[32:35], a[24:27]
  v_mfma_f32_16x16x32_bf16 a[20:23], v[204:207], a[32:35], a[20:23]
  v_mfma_f32_16x16x32_bf16 a[16:19], v[172:175], a[32:35], a[16:19]
  v_mfma_f32_16x16x32_bf16 a[12:15], v[140:143], a[32:35], a[12:15]
  v_mfma_f32_16x16x32_bf16 a[8:11], v[108:111], a[32:35], a[8:11]
  v_mfma_f32_16x16x32_bf16 a[4:7], v[76:79], a[32:35], a[4:7]
  s_waitcnt lgkmcnt(2)
  v_mfma_f32_16x16x32_bf16 a[28:31], a[72:75], a[36:39], a[28:31]
  ds_read_b128 a[32:35], v4 offset:3008
  v_mfma_f32_16x16x32_bf16 a[24:27], v[232:235], a[36:39], a[24:27]
  v_mfma_f32_16x16x32_bf16 a[20:23], v[200:203], a[36:39], a[20:23]
  v_mfma_f32_16x16x32_bf16 a[16:19], v[168:171], a[36:39], a[16:19]
  v_mfma_f32_16x16x32_bf16 a[12:15], v[136:139], a[36:39], a[12:15]
  v_mfma_f32_16x16x32_bf16 a[8:11], v[104:107], a[36:39], a[8:11]
  v_mfma_f32_16x16x32_bf16 a[4:7], v[72:75], a[36:39], a[4:7]
  s_waitcnt lgkmcnt(2)
  v_mfma_f32_16x16x32_bf16 a[28:31], a[68:71], a[40:43], a[28:31]
  ds_read_b128 a[36:39], v4 offset:2944
  v_mfma_f32_16x16x32_bf16 a[24:27], v[228:231], a[40:43], a[24:27]
  v_mfma_f32_16x16x32_bf16 a[20:23], v[196:199], a[40:43], a[20:23]
  v_mfma_f32_16x16x32_bf16 a[16:19], v[164:167], a[40:43], a[16:19]
  v_mfma_f32_16x16x32_bf16 a[12:15], v[132:135], a[40:43], a[12:15]
  v_mfma_f32_16x16x32_bf16 a[8:11], v[100:103], a[40:43], a[8:11]
  v_mfma_f32_16x16x32_bf16 a[4:7], v[68:71], a[40:43], a[4:7]
  s_waitcnt lgkmcnt(2)
  v_mfma_f32_16x16x32_bf16 a[28:31], a[64:67], a[44:47], a[28:31]
  ds_read_b128 a[40:43], v4 offset:2880
  v_mfma_f32_16x16x32_bf16 a[24:27], v[224:227], a[44:47], a[24:27]
  v_mfma_f32_16x16x32_bf16 a[20:23], v[192:195], a[44:47], a[20:23]
  v_mfma_f32_16x16x32_bf16 a[16:19], v[160:163], a[44:47], a[16:19]
  v_mfma_f32_16x16x32_bf16 a[12:15], v[128:131], a[44:47], a[12:15]
  v_mfma_f32_16x16x32_bf16 a[8:11], v[96:99], a[44:47], a[8:11]
  v_mfma_f32_16x16x32_bf16 a[4:7], v[64:67], a[44:47], a[4:7]
  s_waitcnt lgkmcnt(2)
  v_mfma_f32_16x16x32_bf16 a[28:31], v[252:255], a[32:35], a[28:31]
  ds_read_b128 a[44:47], v4 offset:2816
  ds_read_b64 v[36:37], v7 offset:512
  ds_read_b64 v[38:39], v8 offset:512
  s_nop 2
  v_accvgpr_read_b32 v44, a4
  v_accvgpr_read_b32 v45, a5
  v_mfma_f32_16x16x32_bf16 a[24:27], v[220:223], a[32:35], a[24:27]
  v_accvgpr_read_b32 v46, a6
  v_accvgpr_read_b32 v47, a7
  v_mfma_f32_16x16x32_bf16 a[20:23], v[188:191], a[32:35], a[20:23]
  s_waitcnt lgkmcnt(0)
  v_lshlrev_b32 v48, 16, v36
  v_and_b32 v49, 0xffff0000, v36
  v_mfma_f32_16x16x32_bf16 a[16:19], v[156:159], a[32:35], a[16:19]
  v_lshlrev_b32 v50, 16, v37
  v_and_b32 v51, 0xffff0000, v37
  v_mfma_f32_16x16x32_bf16 a[12:15], v[124:127], a[32:35], a[12:15]
  v_lshlrev_b32 v32, 16, v38
  v_and_b32 v33, 0xffff0000, v38
  v_mfma_f32_16x16x32_bf16 a[8:11], v[92:95], a[32:35], a[8:11]
  v_lshlrev_b32 v34, 16, v39
  v_and_b32 v35, 0xffff0000, v39
  v_mfma_f32_16x16x32_bf16 a[28:31], v[248:251], a[36:39], a[28:31]
  ds_read_b128 a[32:35], v4 offset:2752
  v_mul_f32 v52, v48, v31
  v_mul_f32 v53, v49, v31
  v_mfma_f32_16x16x32_bf16 a[24:27], v[216:219], a[36:39], a[24:27]
  v_mul_f32 v54, v50, v31
  v_mul_f32 v55, v51, v31
  v_mfma_f32_16x16x32_bf16 a[20:23], v[184:187], a[36:39], a[20:23]
  v_fmac_f32 v44, s61, v48
  v_fmac_f32 v45, s61, v49
  v_mfma_f32_16x16x32_bf16 a[16:19], v[152:155], a[36:39], a[16:19]
  v_fmac_f32 v46, s61, v50
  v_fmac_f32 v47, s61, v51
  v_mfma_f32_16x16x32_bf16 a[12:15], v[120:123], a[36:39], a[12:15]
  v_cvt_pk_bf16_f32 v36, v52, v53
  v_cvt_pk_bf16_f32 v37, v54, v55
  v_mfma_f32_16x16x32_bf16 a[8:11], v[88:91], a[36:39], a[8:11]
  v_lshlrev_b32 v52, 16, v36
  v_and_b32 v53, 0xffff0000, v36
  v_mfma_f32_16x16x32_bf16 a[28:31], v[244:247], a[40:43], a[28:31]
  ds_read_b128 a[36:39], v4 offset:2688
  v_lshlrev_b32 v54, 16, v37
  v_and_b32 v55, 0xffff0000, v37
  v_mfma_f32_16x16x32_bf16 a[24:27], v[212:215], a[40:43], a[24:27]
  v_cvt_pk_bf16_f32 v36, v44, v45
  v_cvt_pk_bf16_f32 v37, v46, v47
  v_mfma_f32_16x16x32_bf16 a[20:23], v[180:183], a[40:43], a[20:23]
  v_lshlrev_b32 v44, 16, v36
  v_and_b32 v45, 0xffff0000, v36
  v_mfma_f32_16x16x32_bf16 a[16:19], v[148:151], a[40:43], a[16:19]
  v_lshlrev_b32 v46, 16, v37
  v_and_b32 v47, 0xffff0000, v37
  v_mfma_f32_16x16x32_bf16 a[12:15], v[116:119], a[40:43], a[12:15]
  v_add_f32 v44, v44, v52
  v_add_f32 v45, v45, v53
  v_mfma_f32_16x16x32_bf16 a[8:11], v[84:87], a[40:43], a[8:11]
  v_add_f32 v46, v46, v54
  v_add_f32 v47, v47, v55
  v_mfma_f32_16x16x32_bf16 a[28:31], v[240:243], a[44:47], a[28:31]
  ds_read_b128 a[40:43], v4 offset:2624
  v_cvt_pk_bf16_f32 v36, v44, v45
  v_cvt_pk_bf16_f32 v37, v46, v47
  v_mfma_f32_16x16x32_bf16 a[24:27], v[208:211], a[44:47], a[24:27]
  v_lshlrev_b32 v44, 16, v36
  v_and_b32 v45, 0xffff0000, v36
  v_mfma_f32_16x16x32_bf16 a[20:23], v[176:179], a[44:47], a[20:23]
  v_lshlrev_b32 v46, 16, v37
  v_and_b32 v47, 0xffff0000, v37
  v_mfma_f32_16x16x32_bf16 a[16:19], v[144:147], a[44:47], a[16:19]
  v_add_f32 v44, v44, v32
  v_add_f32 v45, v45, v33
  v_mfma_f32_16x16x32_bf16 a[12:15], v[112:115], a[44:47], a[12:15]
  v_add_f32 v46, v46, v34
  v_add_f32 v47, v47, v35
  v_mfma_f32_16x16x32_bf16 a[8:11], v[80:83], a[44:47], a[8:11]
  v_cvt_pk_bf16_f32 v36, v44, v45
  v_cvt_pk_bf16_f32 v37, v46, v47
  s_waitcnt lgkmcnt(2)
  v_mfma_f32_16x16x32_bf16 a[28:31], v[236:239], a[32:35], a[28:31]
  ds_read_b128 a[44:47], v4 offset:2560
  s_add_u32 s6, s62, 262144
  buffer_store_dwordx2 v[36:37], v9, s[8:11], s6 offen sc1
  v_mfma_f32_16x16x32_bf16 a[24:27], v[204:207], a[32:35], a[24:27]
  v_mfma_f32_16x16x32_bf16 a[20:23], v[172:175], a[32:35], a[20:23]
  v_mfma_f32_16x16x32_bf16 a[16:19], v[140:143], a[32:35], a[16:19]
  v_mfma_f32_16x16x32_bf16 a[12:15], v[108:111], a[32:35], a[12:15]
  v_mfma_f32_16x16x32_bf16 a[8:11], v[76:79], a[32:35], a[8:11]
  s_waitcnt lgkmcnt(2)
  v_mfma_f32_16x16x32_bf16 a[28:31], v[232:235], a[36:39], a[28:31]
  ds_read_b128 a[32:35], v4 offset:2496
  v_mfma_f32_16x16x32_bf16 a[24:27], v[200:203], a[36:39], a[24:27]
  v_mfma_f32_16x16x32_bf16 a[20:23], v[168:171], a[36:39], a[20:23]
  v_mfma_f32_16x16x32_bf16 a[16:19], v[136:139], a[36:39], a[16:19]
  v_mfma_f32_16x16x32_bf16 a[12:15], v[104:107], a[36:39], a[12:15]
  v_mfma_f32_16x16x32_bf16 a[8:11], v[72:75], a[36:39], a[8:11]
  s_waitcnt lgkmcnt(2)
  v_mfma_f32_16x16x32_bf16 a[28:31], v[228:231], a[40:43], a[28:31]
  ds_read_b128 a[36:39], v4 offset:2432
  v_mfma_f32_16x16x32_bf16 a[24:27], v[196:199], a[40:43], a[24:27]
  v_mfma_f32_16x16x32_bf16 a[20:23], v[164:167], a[40:43], a[20:23]
  v_mfma_f32_16x16x32_bf16 a[16:19], v[132:135], a[40:43], a[16:19]
  v_mfma_f32_16x16x32_bf16 a[12:15], v[100:103], a[40:43], a[12:15]
  v_mfma_f32_16x16x32_bf16 a[8:11], v[68:71], a[40:43], a[8:11]
  s_waitcnt lgkmcnt(2)
  v_mfma_f32_16x16x32_bf16 a[28:31], v[224:227], a[44:47], a[28:31]
  ds_read_b128 a[40:43], v4 offset:2368
  v_mfma_f32_16x16x32_bf16 a[24:27], v[192:195], a[44:47], a[24:27]
  v_mfma_f32_16x16x32_bf16 a[20:23], v[160:163], a[44:47], a[20:23]
  v_mfma_f32_16x16x32_bf16 a[16:19], v[128:131], a[44:47], a[16:19]
  v_mfma_f32_16x16x32_bf16 a[12:15], v[96:99], a[44:47], a[12:15]
  v_mfma_f32_16x16x32_bf16 a[8:11], v[64:67], a[44:47], a[8:11]
  s_waitcnt lgkmcnt(2)
  v_mfma_f32_16x16x32_bf16 a[28:31], v[220:223], a[32:35], a[28:31]
  ds_read_b128 a[44:47], v4 offset:2304
  ds_read_b64 v[36:37], v7 offset:1024
  ds_read_b64 v[38:39], v8 offset:1024
  s_nop 2
  v_accvgpr_read_b32 v44, a8
  v_accvgpr_read_b32 v45, a9
  v_mfma_f32_16x16x32_bf16 a[24:27], v[188:191], a[32:35], a[24:27]
  v_accvgpr_read_b32 v46, a10
  v_accvgpr_read_b32 v47, a11
  v_mfma_f32_16x16x32_bf16 a[20:23], v[156:159], a[32:35], a[20:23]
  s_waitcnt lgkmcnt(0)
  v_lshlrev_b32 v48, 16, v36
  v_and_b32 v49, 0xffff0000, v36
  v_mfma_f32_16x16x32_bf16 a[16:19], v[124:127], a[32:35], a[16:19]
  v_lshlrev_b32 v50, 16, v37
  v_and_b32 v51, 0xffff0000, v37
  v_mfma_f32_16x16x32_bf16 a[12:15], v[92:95], a[32:35], a[12:15]
  v_lshlrev_b32 v32, 16, v38
  v_and_b32 v33, 0xffff0000, v38
  v_mfma_f32_16x16x32_bf16 a[28:31], v[216:219], a[36:39], a[28:31]
  ds_read_b128 a[32:35], v4 offset:2240
  v_lshlrev_b32 v34, 16, v39
  v_and_b32 v35, 0xffff0000, v39
  v_mfma_f32_16x16x32_bf16 a[24:27], v[184:187], a[36:39], a[24:27]
  v_mul_f32 v52, v48, v31
  v_mul_f32 v53, v49, v31
  v_mfma_f32_16x16x32_bf16 a[20:23], v[152:155], a[36:39], a[20:23]
  v_mul_f32 v54, v50, v31
  v_mul_f32 v55, v51, v31
  v_mfma_f32_16x16x32_bf16 a[16:19], v[120:123], a[36:39], a[16:19]
  v_fmac_f32 v44, s61, v48
  v_fmac_f32 v45, s61, v49
  v_mfma_f32_16x16x32_bf16 a[12:15], v[88:91], a[36:39], a[12:15]
  v_fmac_f32 v46, s61, v50
  v_fmac_f32 v47, s61, v51
  v_mfma_f32_16x16x32_bf16 a[28:31], v[212:215], a[40:43], a[28:31]
  ds_read_b128 a[36:39], v4 offset:2176
  v_cvt_pk_bf16_f32 v36, v52, v53
  v_cvt_pk_bf16_f32 v37, v54, v55
  v_mfma_f32_16x16x32_bf16 a[24:27], v[180:183], a[40:43], a[24:27]
  v_lshlrev_b32 v52, 16, v36
  v_and_b32 v53, 0xffff0000, v36
  v_mfma_f32_16x16x32_bf16 a[20:23], v[148:151], a[40:43], a[20:23]
  v_lshlrev_b32 v54, 16, v37
  v_and_b32 v55, 0xffff0000, v37
  v_mfma_f32_16x16x32_bf16 a[16:19], v[116:119], a[40:43], a[16:19]
  v_cvt_pk_bf16_f32 v36, v44, v45
  v_cvt_pk_bf16_f32 v37, v46, v47
  v_mfma_f32_16x16x32_bf16 a[12:15], v[84:87], a[40:43], a[12:15]
  v_lshlrev_b32 v44, 16, v36
  v_and_b32 v45, 0xffff0000, v36
  v_mfma_f32_16x16x32_bf16 a[28:31], v[208:211], a[44:47], a[28:31]
  ds_read_b128 a[40:43], v4 offset:2112
  v_lshlrev_b32 v46, 16, v37
  v_and_b32 v47, 0xffff0000, v37
  v_mfma_f32_16x16x32_bf16 a[24:27], v[176:179], a[44:47], a[24:27]
  v_add_f32 v44, v44, v52
  v_add_f32 v45, v45, v53
  v_mfma_f32_16x16x32_bf16 a[20:23], v[144:147], a[44:47], a[20:23]
  v_add_f32 v46, v46, v54
  v_add_f32 v47, v47, v55
  v_mfma_f32_16x16x32_bf16 a[16:19], v[112:115], a[44:47], a[16:19]
  v_cvt_pk_bf16_f32 v36, v44, v45
  v_cvt_pk_bf16_f32 v37, v46, v47
  v_mfma_f32_16x16x32_bf16 a[12:15], v[80:83], a[44:47], a[12:15]
  v_lshlrev_b32 v44, 16, v36
  v_and_b32 v45, 0xffff0000, v36
  s_waitcnt lgkmcnt(2)
  v_mfma_f32_16x16x32_bf16 a[28:31], v[204:207], a[32:35], a[28:31]
  ds_read_b128 a[44:47], v4 offset:2048
  v_lshlrev_b32 v46, 16, v37
  v_and_b32 v47, 0xffff0000, v37
  v_mfma_f32_16x16x32_bf16 a[24:27], v[172:175], a[32:35], a[24:27]
  v_add_f32 v44, v44, v32
  v_add_f32 v45, v45, v33
  v_mfma_f32_16x16x32_bf16 a[20:23], v[140:143], a[32:35], a[20:23]
  v_add_f32 v46, v46, v34
  v_add_f32 v47, v47, v35
  v_mfma_f32_16x16x32_bf16 a[16:19], v[108:111], a[32:35], a[16:19]
  v_cvt_pk_bf16_f32 v36, v44, v45
  v_cvt_pk_bf16_f32 v37, v46, v47
  v_mfma_f32_16x16x32_bf16 a[12:15], v[76:79], a[32:35], a[12:15]
  s_add_u32 s6, s62, 524288
  buffer_store_dwordx2 v[36:37], v9, s[8:11], s6 offen sc1
  s_waitcnt lgkmcnt(2)
  v_mfma_f32_16x16x32_bf16 a[28:31], v[200:203], a[36:39], a[28:31]
  ds_read_b128 a[32:35], v4 offset:1984
  v_mfma_f32_16x16x32_bf16 a[24:27], v[168:171], a[36:39], a[24:27]
  v_mfma_f32_16x16x32_bf16 a[20:23], v[136:139], a[36:39], a[20:23]
  v_mfma_f32_16x16x32_bf16 a[16:19], v[104:107], a[36:39], a[16:19]
  v_mfma_f32_16x16x32_bf16 a[12:15], v[72:75], a[36:39], a[12:15]
  s_waitcnt lgkmcnt(2)
  v_mfma_f32_16x16x32_bf16 a[28:31], v[196:199], a[40:43], a[28:31]
  ds_read_b128 a[36:39], v4 offset:1920
  v_mfma_f32_16x16x32_bf16 a[24:27], v[164:167], a[40:43], a[24:27]
  v_mfma_f32_16x16x32_bf16 a[20:23], v[132:135], a[40:43], a[20:23]
  v_mfma_f32_16x16x32_bf16 a[16:19], v[100:103], a[40:43], a[16:19]
  v_mfma_f32_16x16x32_bf16 a[12:15], v[68:71], a[40:43], a[12:15]
  s_waitcnt lgkmcnt(2)
  v_mfma_f32_16x16x32_bf16 a[28:31], v[192:195], a[44:47], a[28:31]
  ds_read_b128 a[40:43], v4 offset:1856
  v_mfma_f32_16x16x32_bf16 a[24:27], v[160:163], a[44:47], a[24:27]
  v_mfma_f32_16x16x32_bf16 a[20:23], v[128:131], a[44:47], a[20:23]
  v_mfma_f32_16x16x32_bf16 a[16:19], v[96:99], a[44:47], a[16:19]
  v_mfma_f32_16x16x32_bf16 a[12:15], v[64:67], a[44:47], a[12:15]
  s_waitcnt lgkmcnt(2)
  v_mfma_f32_16x16x32_bf16 a[28:31], v[188:191], a[32:35], a[28:31]
  ds_read_b128 a[44:47], v4 offset:1792
  ds_read_b64 v[36:37], v7 offset:1536
  ds_read_b64 v[38:39], v8 offset:1536
  s_nop 2
  v_accvgpr_read_b32 v44, a12
  v_accvgpr_read_b32 v45, a13
  v_mfma_f32_16x16x32_bf16 a[24:27], v[156:159], a[32:35], a[24:27]
  v_accvgpr_read_b32 v46, a14
  v_accvgpr_read_b32 v47, a15
  v_mfma_f32_16x16x32_bf16 a[20:23], v[124:127], a[32:35], a[20:23]
  s_waitcnt lgkmcnt(0)
  v_lshlrev_b32 v48, 16, v36
  v_and_b32 v49, 0xffff0000, v36
  v_mfma_f32_16x16x32_bf16 a[16:19], v[92:95], a[32:35], a[16:19]
  v_lshlrev_b32 v50, 16, v37
  v_and_b32 v51, 0xffff0000, v37
  v_mfma_f32_16x16x32_bf16 a[28:31], v[184:187], a[36:39], a[28:31]
  ds_read_b128 a[32:35], v4 offset:1728
  v_lshlrev_b32 v32, 16, v38
  v_and_b32 v33, 0xffff0000, v38
  v_mfma_f32_16x16x32_bf16 a[24:27], v[152:155], a[36:39], a[24:27]
  v_lshlrev_b32 v34, 16, v39
  v_and_b32 v35, 0xffff0000, v39
  v_mfma_f32_16x16x32_bf16 a[20:23], v[120:123], a[36:39], a[20:23]
  v_mul_f32 v52, v48, v31
  v_mul_f32 v53, v49, v31
  v_mfma_f32_16x16x32_bf16 a[16:19], v[88:91], a[36:39], a[16:19]
  v_mul_f32 v54, v50, v31
  v_mul_f32 v55, v51, v31
  v_mfma_f32_16x16x32_bf16 a[28:31], v[180:183], a[40:43], a[28:31]
  ds_read_b128 a[36:39], v4 offset:1664
  v_fmac_f32 v44, s61, v48
  v_fmac_f32 v45, s61, v49
  v_mfma_f32_16x16x32_bf16 a[24:27], v[148:151], a[40:43], a[24:27]
  v_fmac_f32 v46, s61, v50
  v_fmac_f32 v47, s61, v51
  v_mfma_f32_16x16x32_bf16 a[20:23], v[116:119], a[40:43], a[20:23]
  v_cvt_pk_bf16_f32 v36, v52, v53
  v_cvt_pk_bf16_f32 v37, v54, v55
  v_mfma_f32_16x16x32_bf16 a[16:19], v[84:87], a[40:43], a[16:19]
  v_lshlrev_b32 v52, 16, v36
  v_and_b32 v53, 0xffff0000, v36
  v_mfma_f32_16x16x32_bf16 a[28:31], v[176:179], a[44:47], a[28:31]
  ds_read_b128 a[40:43], v4 offset:1600
  v_lshlrev_b32 v54, 16, v37
  v_and_b32 v55, 0xffff0000, v37
  v_mfma_f32_16x16x32_bf16 a[24:27], v[144:147], a[44:47], a[24:27]
  v_cvt_pk_bf16_f32 v36, v44, v45
  v_cvt_pk_bf16_f32 v37, v46, v47
  v_mfma_f32_16x16x32_bf16 a[20:23], v[112:115], a[44:47], a[20:23]
  v_lshlrev_b32 v44, 16, v36
  v_and_b32 v45, 0xffff0000, v36
  v_mfma_f32_16x16x32_bf16 a[16:19], v[80:83], a[44:47], a[16:19]
  v_lshlrev_b32 v46, 16, v37
  v_and_b32 v47, 0xffff0000, v37
  s_waitcnt lgkmcnt(2)
  v_mfma_f32_16x16x32_bf16 a[28:31], v[172:175], a[32:35], a[28:31]
  ds_read_b128 a[44:47], v4 offset:1536
  v_add_f32 v44, v44, v52
  v_add_f32 v45, v45, v53
  v_mfma_f32_16x16x32_bf16 a[24:27], v[140:143], a[32:35], a[24:27]
  v_add_f32 v46, v46, v54
  v_add_f32 v47, v47, v55
  v_mfma_f32_16x16x32_bf16 a[20:23], v[108:111], a[32:35], a[20:23]
  v_cvt_pk_bf16_f32 v36, v44, v45
  v_cvt_pk_bf16_f32 v37, v46, v47
  v_mfma_f32_16x16x32_bf16 a[16:19], v[76:79], a[32:35], a[16:19]
  v_lshlrev_b32 v44, 16, v36
  v_and_b32 v45, 0xffff0000, v36
  s_waitcnt lgkmcnt(2)
  v_mfma_f32_16x16x32_bf16 a[28:31], v[168:171], a[36:39], a[28:31]
  ds_read_b128 a[32:35], v4 offset:1472
  v_lshlrev_b32 v46, 16, v37
  v_and_b32 v47, 0xffff0000, v37
  v_mfma_f32_16x16x32_bf16 a[24:27], v[136:139], a[36:39], a[24:27]
  v_add_f32 v44, v44, v32
  v_add_f32 v45, v45, v33
  v_mfma_f32_16x16x32_bf16 a[20:23], v[104:107], a[36:39], a[20:23]
  v_add_f32 v46, v46, v34
  v_add_f32 v47, v47, v35
  v_mfma_f32_16x16x32_bf16 a[16:19], v[72:75], a[36:39], a[16:19]
  v_cvt_pk_bf16_f32 v36, v44, v45
  v_cvt_pk_bf16_f32 v37, v46, v47
  s_waitcnt lgkmcnt(2)
  v_mfma_f32_16x16x32_bf16 a[28:31], v[164:167], a[40:43], a[28:31]
  ds_read_b128 a[36:39], v4 offset:1408
  s_add_u32 s6, s62, 786432
  buffer_store_dwordx2 v[36:37], v9, s[8:11], s6 offen sc1
  v_mfma_f32_16x16x32_bf16 a[24:27], v[132:135], a[40:43], a[24:27]
  v_mfma_f32_16x16x32_bf16 a[20:23], v[100:103], a[40:43], a[20:23]
  v_mfma_f32_16x16x32_bf16 a[16:19], v[68:71], a[40:43], a[16:19]
  s_waitcnt lgkmcnt(2)
  v_mfma_f32_16x16x32_bf16 a[28:31], v[160:163], a[44:47], a[28:31]
  ds_read_b128 a[40:43], v4 offset:1344
  v_mfma_f32_16x16x32_bf16 a[24:27], v[128:131], a[44:47], a[24:27]
  v_mfma_f32_16x16x32_bf16 a[20:23], v[96:99], a[44:47], a[20:23]
  v_mfma_f32_16x16x32_bf16 a[16:19], v[64:67], a[44:47], a[16:19]
  s_waitcnt lgkmcnt(2)
  v_mfma_f32_16x16x32_bf16 a[28:31], v[156:159], a[32:35], a[28:31]
  ds_read_b128 a[44:47], v4 offset:1280
  ds_read_b64 v[36:37], v7 offset:2048
  ds_read_b64 v[38:39], v8 offset:2048
  s_nop 2
  v_accvgpr_read_b32 v44, a16
  v_accvgpr_read_b32 v45, a17
  v_mfma_f32_16x16x32_bf16 a[24:27], v[124:127], a[32:35], a[24:27]
  v_accvgpr_read_b32 v46, a18
  v_accvgpr_read_b32 v47, a19
  v_mfma_f32_16x16x32_bf16 a[20:23], v[92:95], a[32:35], a[20:23]
  s_waitcnt lgkmcnt(0)
  v_lshlrev_b32 v48, 16, v36
  v_and_b32 v49, 0xffff0000, v36
  v_mfma_f32_16x16x32_bf16 a[28:31], v[152:155], a[36:39], a[28:31]
  ds_read_b128 a[32:35], v4 offset:1216
  v_lshlrev_b32 v50, 16, v37
  v_and_b32 v51, 0xffff0000, v37
  v_mfma_f32_16x16x32_bf16 a[24:27], v[120:123], a[36:39], a[24:27]
  v_lshlrev_b32 v32, 16, v38
  v_and_b32 v33, 0xffff0000, v38
  v_mfma_f32_16x16x32_bf16 a[20:23], v[88:91], a[36:39], a[20:23]
  v_lshlrev_b32 v34, 16, v39
  v_and_b32 v35, 0xffff0000, v39
  v_mfma_f32_16x16x32_bf16 a[28:31], v[148:151], a[40:43], a[28:31]
  ds_read_b128 a[36:39], v4 offset:1152
  v_mul_f32 v52, v48, v31
  v_mul_f32 v53, v49, v31
  v_mfma_f32_16x16x32_bf16 a[24:27], v[116:119], a[40:43], a[24:27]
  v_mul_f32 v54, v50, v31
  v_mul_f32 v55, v51, v31
  v_mfma_f32_16x16x32_bf16 a[20:23], v[84:87], a[40:43], a[20:23]
  v_fmac_f32 v44, s61, v48
  v_fmac_f32 v45, s61, v49
  v_mfma_f32_16x16x32_bf16 a[28:31], v[144:147], a[44:47], a[28:31]
  ds_read_b128 a[40:43], v4 offset:1088
  v_fmac_f32 v46, s61, v50
  v_fmac_f32 v47, s61, v51
  v_mfma_f32_16x16x32_bf16 a[24:27], v[112:115], a[44:47], a[24:27]
  v_cvt_pk_bf16_f32 v36, v52, v53
  v_cvt_pk_bf16_f32 v37, v54, v55
  v_mfma_f32_16x16x32_bf16 a[20:23], v[80:83], a[44:47], a[20:23]
  v_lshlrev_b32 v52, 16, v36
  v_and_b32 v53, 0xffff0000, v36
  s_waitcnt lgkmcnt(2)
  v_mfma_f32_16x16x32_bf16 a[28:31], v[140:143], a[32:35], a[28:31]
  ds_read_b128 a[44:47], v4 offset:1024
  v_lshlrev_b32 v54, 16, v37
  v_and_b32 v55, 0xffff0000, v37
  v_mfma_f32_16x16x32_bf16 a[24:27], v[108:111], a[32:35], a[24:27]
  v_cvt_pk_bf16_f32 v36, v44, v45
  v_cvt_pk_bf16_f32 v37, v46, v47
  v_mfma_f32_16x16x32_bf16 a[20:23], v[76:79], a[32:35], a[20:23]
  v_lshlrev_b32 v44, 16, v36
  v_and_b32 v45, 0xffff0000, v36
  s_waitcnt lgkmcnt(2)
  v_mfma_f32_16x16x32_bf16 a[28:31], v[136:139], a[36:39], a[28:31]
  ds_read_b128 a[32:35], v4 offset:960
  v_lshlrev_b32 v46, 16, v37
  v_and_b32 v47, 0xffff0000, v37
  v_mfma_f32_16x16x32_bf16 a[24:27], v[104:107], a[36:39], a[24:27]
  v_add_f32 v44, v44, v52
  v_add_f32 v45, v45, v53
  v_mfma_f32_16x16x32_bf16 a[20:23], v[72:75], a[36:39], a[20:23]
  v_add_f32 v46, v46, v54
  v_add_f32 v47, v47, v55
  s_waitcnt lgkmcnt(2)
  v_mfma_f32_16x16x32_bf16 a[28:31], v[132:135], a[40:43], a[28:31]
  ds_read_b128 a[36:39], v4 offset:896
  v_cvt_pk_bf16_f32 v36, v44, v45
  v_cvt_pk_bf16_f32 v37, v46, v47
  v_mfma_f32_16x16x32_bf16 a[24:27], v[100:103], a[40:43], a[24:27]
  v_lshlrev_b32 v44, 16, v36
  v_and_b32 v45, 0xffff0000, v36
  v_mfma_f32_16x16x32_bf16 a[20:23], v[68:71], a[40:43], a[20:23]
  v_lshlrev_b32 v46, 16, v37
  v_and_b32 v47, 0xffff0000, v37
  s_waitcnt lgkmcnt(2)
  v_mfma_f32_16x16x32_bf16 a[28:31], v[128:131], a[44:47], a[28:31]
  ds_read_b128 a[40:43], v4 offset:832
  v_add_f32 v44, v44, v32
  v_add_f32 v45, v45, v33
  v_mfma_f32_16x16x32_bf16 a[24:27], v[96:99], a[44:47], a[24:27]
  v_add_f32 v46, v46, v34
  v_add_f32 v47, v47, v35
  v_mfma_f32_16x16x32_bf16 a[20:23], v[64:67], a[44:47], a[20:23]
  v_cvt_pk_bf16_f32 v36, v44, v45
  v_cvt_pk_bf16_f32 v37, v46, v47
  s_waitcnt lgkmcnt(2)
  v_mfma_f32_16x16x32_bf16 a[28:31], v[124:127], a[32:35], a[28:31]
  ds_read_b128 a[44:47], v4 offset:768
  s_add_u32 s6, s62, 1048576
  buffer_store_dwordx2 v[36:37], v9, s[8:11], s6 offen sc1
  v_mfma_f32_16x16x32_bf16 a[24:27], v[92:95], a[32:35], a[24:27]
  ds_read_b64 v[36:37], v7 offset:2560
  ds_read_b64 v[38:39], v8 offset:2560
  v_accvgpr_read_b32 v44, a20
  v_accvgpr_read_b32 v45, a21
  s_waitcnt lgkmcnt(4)
  v_mfma_f32_16x16x32_bf16 a[28:31], v[120:123], a[36:39], a[28:31]
  ds_read_b128 a[32:35], v4 offset:704
  v_accvgpr_read_b32 v46, a22
  v_accvgpr_read_b32 v47, a23
  v_mfma_f32_16x16x32_bf16 a[24:27], v[88:91], a[36:39], a[24:27]
  s_waitcnt lgkmcnt(1)
  v_lshlrev_b32 v48, 16, v36
  v_and_b32 v49, 0xffff0000, v36
  v_mfma_f32_16x16x32_bf16 a[28:31], v[116:119], a[40:43], a[28:31]
  ds_read_b128 a[36:39], v4 offset:640
  v_lshlrev_b32 v50, 16, v37
  v_and_b32 v51, 0xffff0000, v37
  v_mfma_f32_16x16x32_bf16 a[24:27], v[84:87], a[40:43], a[24:27]
  v_lshlrev_b32 v32, 16, v38
  v_and_b32 v33, 0xffff0000, v38
  v_mfma_f32_16x16x32_bf16 a[28:31], v[112:115], a[44:47], a[28:31]
  ds_read_b128 a[40:43], v4 offset:576
  v_lshlrev_b32 v34, 16, v39
  v_and_b32 v35, 0xffff0000, v39
  v_mfma_f32_16x16x32_bf16 a[24:27], v[80:83], a[44:47], a[24:27]
  v_mul_f32 v52, v48, v31
  v_mul_f32 v53, v49, v31
  s_waitcnt lgkmcnt(2)
  v_mfma_f32_16x16x32_bf16 a[28:31], v[108:111], a[32:35], a[28:31]
  ds_read_b128 a[44:47], v4 offset:512
  v_mul_f32 v54, v50, v31
  v_mul_f32 v55, v51, v31
  v_mfma_f32_16x16x32_bf16 a[24:27], v[76:79], a[32:35], a[24:27]
  v_fmac_f32 v44, s61, v48
  v_fmac_f32 v45, s61, v49
  s_waitcnt lgkmcnt(2)
  v_mfma_f32_16x16x32_bf16 a[28:31], v[104:107], a[36:39], a[28:31]
  ds_read_b128 a[32:35], v4 offset:448
  v_fmac_f32 v46, s61, v50
  v_fmac_f32 v47, s61, v51
  v_mfma_f32_16x16x32_bf16 a[24:27], v[72:75], a[36:39], a[24:27]
  v_cvt_pk_bf16_f32 v36, v52, v53
  v_cvt_pk_bf16_f32 v37, v54, v55
  s_waitcnt lgkmcnt(2)
  v_mfma_f32_16x16x32_bf16 a[28:31], v[100:103], a[40:43], a[28:31]
  ds_read_b128 a[36:39], v4 offset:384
  v_lshlrev_b32 v52, 16, v36
  v_and_b32 v53, 0xffff0000, v36
  v_mfma_f32_16x16x32_bf16 a[24:27], v[68:71], a[40:43], a[24:27]
  v_lshlrev_b32 v54, 16, v37
  v_and_b32 v55, 0xffff0000, v37
  s_waitcnt lgkmcnt(2)
  v_mfma_f32_16x16x32_bf16 a[28:31], v[96:99], a[44:47], a[28:31]
  ds_read_b128 a[40:43], v4 offset:320
  v_cvt_pk_bf16_f32 v36, v44, v45
  v_cvt_pk_bf16_f32 v37, v46, v47
  v_mfma_f32_16x16x32_bf16 a[24:27], v[64:67], a[44:47], a[24:27]
  v_lshlrev_b32 v44, 16, v36
  v_and_b32 v45, 0xffff0000, v36
  s_waitcnt lgkmcnt(2)
  v_mfma_f32_16x16x32_bf16 a[28:31], v[92:95], a[32:35], a[28:31]
  ds_read_b128 a[44:47], v4 offset:256
  v_lshlrev_b32 v46, 16, v37
  v_and_b32 v47, 0xffff0000, v37
  s_waitcnt lgkmcnt(2)
  v_mfma_f32_16x16x32_bf16 a[28:31], v[88:91], a[36:39], a[28:31]
  ds_read_b128 a[32:35], v4 offset:192
  v_add_f32 v44, v44, v52
  v_add_f32 v45, v45, v53
  s_waitcnt lgkmcnt(2)
  v_mfma_f32_16x16x32_bf16 a[28:31], v[84:87], a[40:43], a[28:31]
  ds_read_b128 a[36:39], v4 offset:128
  v_add_f32 v46, v46, v54
  v_add_f32 v47, v47, v55
  s_waitcnt lgkmcnt(2)
  v_mfma_f32_16x16x32_bf16 a[28:31], v[80:83], a[44:47], a[28:31]
  ds_read_b128 a[40:43], v4 offset:64
  v_cvt_pk_bf16_f32 v36, v44, v45
  v_cvt_pk_bf16_f32 v37, v46, v47
  s_waitcnt lgkmcnt(2)
  v_mfma_f32_16x16x32_bf16 a[28:31], v[76:79], a[32:35], a[28:31]
  ds_read_b128 a[44:47], v4 offset:0
  v_lshlrev_b32 v44, 16, v36
  v_and_b32 v45, 0xffff0000, v36
  s_waitcnt lgkmcnt(2)
  v_mfma_f32_16x16x32_bf16 a[28:31], v[72:75], a[36:39], a[28:31]
  v_lshlrev_b32 v46, 16, v37
  v_and_b32 v47, 0xffff0000, v37
  s_waitcnt lgkmcnt(1)
  v_mfma_f32_16x16x32_bf16 a[28:31], v[68:71], a[40:43], a[28:31]
  v_add_f32 v44, v44, v32
  v_add_f32 v45, v45, v33
  s_waitcnt lgkmcnt(0)
  v_mfma_f32_16x16x32_bf16 a[28:31], v[64:67], a[44:47], a[28:31]
  v_add_f32 v46, v46, v34
  v_add_f32 v47, v47, v35
  v_cvt_pk_bf16_f32 v36, v44, v45
  v_cvt_pk_bf16_f32 v37, v46, v47
  s_add_u32 s6, s62, 1310720
  buffer_store_dwordx2 v[36:37], v9, s[8:11], s6 offen sc1
  ds_read_b64 v[36:37], v7 offset:3072
  ds_read_b64 v[38:39], v8 offset:3072
  v_accvgpr_read_b32 v44, a24
  v_accvgpr_read_b32 v45, a25
  v_accvgpr_read_b32 v46, a26
  v_accvgpr_read_b32 v47, a27
  s_waitcnt lgkmcnt(0)
  v_lshlrev_b32 v48, 16, v36
  v_and_b32 v49, 0xffff0000, v36
  v_lshlrev_b32 v50, 16, v37
  v_and_b32 v51, 0xffff0000, v37
  v_lshlrev_b32 v32, 16, v38
  v_and_b32 v33, 0xffff0000, v38
  v_lshlrev_b32 v34, 16, v39
  v_and_b32 v35, 0xffff0000, v39
  v_mul_f32 v52, v48, v31
  v_mul_f32 v53, v49, v31
  v_mul_f32 v54, v50, v31
  v_mul_f32 v55, v51, v31
  v_fmac_f32 v44, s61, v48
  v_fmac_f32 v45, s61, v49
  v_fmac_f32 v46, s61, v50
  v_fmac_f32 v47, s61, v51
  v_cvt_pk_bf16_f32 v36, v52, v53
  v_cvt_pk_bf16_f32 v37, v54, v55
  v_lshlrev_b32 v52, 16, v36
  v_and_b32 v53, 0xffff0000, v36
  v_lshlrev_b32 v54, 16, v37
  v_and_b32 v55, 0xffff0000, v37
  v_cvt_pk_bf16_f32 v36, v44, v45
  v_cvt_pk_bf16_f32 v37, v46, v47
  v_lshlrev_b32 v44, 16, v36
  v_and_b32 v45, 0xffff0000, v36
  v_lshlrev_b32 v46, 16, v37
  v_and_b32 v47, 0xffff0000, v37
  v_add_f32 v44, v44, v52
  v_add_f32 v45, v45, v53
  v_add_f32 v46, v46, v54
  v_add_f32 v47, v47, v55
  v_cvt_pk_bf16_f32 v36, v44, v45
  v_cvt_pk_bf16_f32 v37, v46, v47
  v_lshlrev_b32 v44, 16, v36
  v_and_b32 v45, 0xffff0000, v36
  v_lshlrev_b32 v46, 16, v37
  v_and_b32 v47, 0xffff0000, v37
  v_add_f32 v44, v44, v32
  v_add_f32 v45, v45, v33
  v_add_f32 v46, v46, v34
  v_add_f32 v47, v47, v35
  v_cvt_pk_bf16_f32 v36, v44, v45
  v_cvt_pk_bf16_f32 v37, v46, v47
  s_add_u32 s6, s62, 1572864
  buffer_store_dwordx2 v[36:37], v9, s[8:11], s6 offen sc1
  ds_read_b64 v[36:37], v7 offset:3584
  ds_read_b64 v[38:39], v8 offset:3584
  v_accvgpr_read_b32 v44, a28
  v_accvgpr_read_b32 v45, a29
  v_accvgpr_read_b32 v46, a30
  v_accvgpr_read_b32 v47, a31
  s_waitcnt lgkmcnt(0)
  v_lshlrev_b32 v48, 16, v36
  v_and_b32 v49, 0xffff0000, v36
  v_lshlrev_b32 v50, 16, v37
  v_and_b32 v51, 0xffff0000, v37
  v_lshlrev_b32 v32, 16, v38
  v_and_b32 v33, 0xffff0000, v38
  v_lshlrev_b32 v34, 16, v39
  v_and_b32 v35, 0xffff0000, v39
  v_mul_f32 v52, v48, v31
  v_mul_f32 v53, v49, v31
  v_mul_f32 v54, v50, v31
  v_mul_f32 v55, v51, v31
  v_fmac_f32 v44, s61, v48
  v_fmac_f32 v45, s61, v49
  v_fmac_f32 v46, s61, v50
  v_fmac_f32 v47, s61, v51
  v_cvt_pk_bf16_f32 v36, v52, v53
  v_cvt_pk_bf16_f32 v37, v54, v55
  v_lshlrev_b32 v52, 16, v36
  v_and_b32 v53, 0xffff0000, v36
  v_lshlrev_b32 v54, 16, v37
  v_and_b32 v55, 0xffff0000, v37
  v_cvt_pk_bf16_f32 v36, v44, v45
  v_cvt_pk_bf16_f32 v37, v46, v47
  v_lshlrev_b32 v44, 16, v36
  v_and_b32 v45, 0xffff0000, v36
  v_lshlrev_b32 v46, 16, v37
  v_and_b32 v47, 0xffff0000, v37
  v_add_f32 v44, v44, v52
  v_add_f32 v45, v45, v53
  v_add_f32 v46, v46, v54
  v_add_f32 v47, v47, v55
  v_cvt_pk_bf16_f32 v36, v44, v45
  v_cvt_pk_bf16_f32 v37, v46, v47
  v_lshlrev_b32 v44, 16, v36
  v_and_b32 v45, 0xffff0000, v36
  v_lshlrev_b32 v46, 16, v37
  v_and_b32 v47, 0xffff0000, v37
  v_add_f32 v44, v44, v32
  v_add_f32 v45, v45, v33
  v_add_f32 v46, v46, v34
  v_add_f32 v47, v47, v35
  v_cvt_pk_bf16_f32 v36, v44, v45
  v_cvt_pk_bf16_f32 v37, v46, v47
  s_add_u32 s6, s62, 1835008
  buffer_store_dwordx2 v[36:37], v9, s[8:11], s6 offen sc1
  s_lshl_b32 s6, s60, 2
  s_add_u32 s6, s6, 0x710000
  v_mov_b32 v16, 127
  s_waitcnt vmcnt(0)
  s_mov_b64 exec, 1
  buffer_store_dword v16, v1, s[8:11], s6 offen sc1
  s_mov_b64 exec, -1
  s_barrier
  s_cmp_eq_u32 s4, 1
  s_cbranch_scc1 L_rec2
  s_cmp_eq_u32 s4, 6
  s_cbranch_scc1 L_o2
  s_branch L_p2
L_c:
  v_lshlrev_b32 v4, 2, v0
  v_lshlrev_b32 v0, 4, v0
  v_mov_b32 v1, 0
  v_mov_b32 v2, 150016
  s_lshl_b32 s6, s5, 8
  s_add_u32 s6, s6, 0x704000
  s_add_u32 s7, s6, 0x2000
  buffer_store_dword v1, v4, s[8:11], s6 offen sc1
  buffer_store_dword v1, v4, s[8:11], s7 offen sc1
  s_lshl_b32 s6, s5, 3
  s_add_u32 s6, s6, 0x710800
  s_mov_b64 exec, 3
  buffer_store_dword v1, v4, s[8:11], s6 offen sc1
  s_mov_b64 exec, -1
  s_waitcnt vmcnt(0)
  s_barrier
  s_cmp_lg_u32 s3, 0
  s_cbranch_scc1 L_sd_52
  s_mov_b64 exec, 1
  v_mov_b32 v6, 128
  v_mov_b32 v7, 1
  buffer_atomic_add v7, v6, s[12:15], 0 offen sc1
  s_mov_b64 exec, -1
L_sd_52:
  v_bfe_u32 v5, v0, 5, 4
  v_mul_u32_u24 v5, 4128, v5
  v_and_b32 v6, 16, v0
  v_add3_u32 v5, v5, v6, v1
  v_mov_b32 v8, 0
  v_mov_b32 v9, 0
  v_mov_b32 v10, 0
  v_mov_b32 v11, 0
  v_add_u32 v5, 73728, v5
  ds_write_b128 v5, v[8:11]
  ds_write_b128 v2, v[8:11]
  v_accvgpr_write_b32 a0, 0
  v_accvgpr_write_b32 a1, 0
  v_accvgpr_write_b32 a2, 0
  v_accvgpr_write_b32 a3, 0
  v_accvgpr_write_b32 a4, 0
  v_accvgpr_write_b32 a5, 0
  v_accvgpr_write_b32 a6, 0
  v_accvgpr_write_b32 a7, 0
  v_accvgpr_write_b32 a8, 0
  v_accvgpr_write_b32 a9, 0
  v_accvgpr_write_b32 a10, 0
  v_accvgpr_write_b32 a11, 0
  v_accvgpr_write_b32 a12, 0
  v_accvgpr_write_b32 a13, 0
  v_accvgpr_write_b32 a14, 0
  v_accvgpr_write_b32 a15, 0
  v_accvgpr_write_b32 a16, 0
  v_accvgpr_write_b32 a17, 0
  v_accvgpr_write_b32 a18, 0
  v_accvgpr_write_b32 a19, 0
  v_accvgpr_write_b32 a20, 0
  v_accvgpr_write_b32 a21, 0
  v_accvgpr_write_b32 a22, 0
  v_accvgpr_write_b32 a23, 0
  v_accvgpr_write_b32 a24, 0
  v_accvgpr_write_b32 a25, 0
  v_accvgpr_write_b32 a26, 0
  v_accvgpr_write_b32 a27, 0
  v_accvgpr_write_b32 a28, 0
  v_accvgpr_write_b32 a29, 0
  v_accvgpr_write_b32 a30, 0
  v_accvgpr_write_b32 a31, 0
  v_accvgpr_write_b32 a32, 0
  v_accvgpr_write_b32 a33, 0
  v_accvgpr_write_b32 a34, 0
  v_accvgpr_write_b32 a35, 0
  v_accvgpr_write_b32 a36, 0
  v_accvgpr_write_b32 a37, 0
  v_accvgpr_write_b32 a38, 0
  v_accvgpr_write_b32 a39, 0
  v_accvgpr_write_b32 a40, 0
  v_accvgpr_write_b32 a41, 0
  v_accvgpr_write_b32 a42, 0
  v_accvgpr_write_b32 a43, 0
  v_accvgpr_write_b32 a44, 0
  v_accvgpr_write_b32 a45, 0
  v_accvgpr_write_b32 a46, 0
  v_accvgpr_write_b32 a47, 0
  v_accvgpr_write_b32 a48, 0
  v_accvgpr_write_b32 a49, 0
  v_accvgpr_write_b32 a50, 0
  v_accvgpr_write_b32 a51, 0
  v_accvgpr_write_b32 a52, 0
  v_accvgpr_write_b32 a53, 0
  v_accvgpr_write_b32 a54, 0
  v_accvgpr_write_b32 a55, 0
  v_accvgpr_write_b32 a56, 0
  v_accvgpr_write_b32 a57, 0
  v_accvgpr_write_b32 a58, 0
  v_accvgpr_write_b32 a59, 0
  v_accvgpr_write_b32 a60, 0
  v_accvgpr_write_b32 a61, 0
  v_accvgpr_write_b32 a62, 0
  v_accvgpr_write_b32 a63, 0
  v_accvgpr_write_b32 a64, 0
  v_accvgpr_write_b32 a65, 0
  v_accvgpr_write_b32 a66, 0
  v_accvgpr_write_b32 a67, 0
  v_accvgpr_write_b32 a68, 0
  v_accvgpr_write_b32 a69, 0
  v_accvgpr_write_b32 a70, 0
  v_accvgpr_write_b32 a71, 0
  v_accvgpr_write_b32 a72, 0
  v_accvgpr_write_b32 a73, 0
  v_accvgpr_write_b32 a74, 0
  v_accvgpr_write_b32 a75, 0
  v_accvgpr_write_b32 a76, 0
  v_accvgpr_write_b32 a77, 0
  v_accvgpr_write_b32 a78, 0
  v_accvgpr_write_b32 a79, 0
  v_accvgpr_write_b32 a80, 0
  v_accvgpr_write_b32 a81, 0
  v_accvgpr_write_b32 a82, 0
  v_accvgpr_write_b32 a83, 0
  v_accvgpr_write_b32 a84, 0
  v_accvgpr_write_b32 a85, 0
  v_accvgpr_write_b32 a86, 0
  v_accvgpr_write_b32 a87, 0
  v_accvgpr_write_b32 a88, 0
  v_accvgpr_write_b32 a89, 0
  v_accvgpr_write_b32 a90, 0
  v_accvgpr_write_b32 a91, 0
  v_accvgpr_write_b32 a92, 0
  v_accvgpr_write_b32 a93, 0
  v_accvgpr_write_b32 a94, 0
  v_accvgpr_write_b32 a95, 0
  v_accvgpr_write_b32 a96, 0
  v_accvgpr_write_b32 a97, 0
  v_accvgpr_write_b32 a98, 0
  v_accvgpr_write_b32 a99, 0
  v_accvgpr_write_b32 a100, 0
  v_accvgpr_write_b32 a101, 0
  v_accvgpr_write_b32 a102, 0
  v_accvgpr_write_b32 a103, 0
  v_accvgpr_write_b32 a104, 0
  v_accvgpr_write_b32 a105, 0
  v_accvgpr_write_b32 a106, 0
  v_accvgpr_write_b32 a107, 0
  v_accvgpr_write_b32 a108, 0
  v_accvgpr_write_b32 a109, 0
  v_accvgpr_write_b32 a110, 0
  v_accvgpr_write_b32 a111, 0
  v_accvgpr_write_b32 a112, 0
  v_accvgpr_write_b32 a113, 0
  v_accvgpr_write_b32 a114, 0
  v_accvgpr_write_b32 a115, 0
  v_accvgpr_write_b32 a116, 0
  v_accvgpr_write_b32 a117, 0
  v_accvgpr_write_b32 a118, 0
  v_accvgpr_write_b32 a119, 0
  v_accvgpr_write_b32 a120, 0
  v_accvgpr_write_b32 a121, 0
  v_accvgpr_write_b32 a122, 0
  v_accvgpr_write_b32 a123, 0
  v_accvgpr_write_b32 a124, 0
  v_accvgpr_write_b32 a125, 0
  v_accvgpr_write_b32 a126, 0
  v_accvgpr_write_b32 a127, 0
  v_accvgpr_write_b32 a128, 0
  v_accvgpr_write_b32 a129, 0
  v_accvgpr_write_b32 a130, 0
  v_accvgpr_write_b32 a131, 0
  v_accvgpr_write_b32 a132, 0
  v_accvgpr_write_b32 a133, 0
  v_accvgpr_write_b32 a134, 0
  v_accvgpr_write_b32 a135, 0
  v_accvgpr_write_b32 a136, 0
  v_accvgpr_write_b32 a137, 0
  v_accvgpr_write_b32 a138, 0
  v_accvgpr_write_b32 a139, 0
  v_accvgpr_write_b32 a140, 0
  v_accvgpr_write_b32 a141, 0
  v_accvgpr_write_b32 a142, 0
  v_accvgpr_write_b32 a143, 0
  v_accvgpr_write_b32 a144, 0
  v_accvgpr_write_b32 a145, 0
  v_accvgpr_write_b32 a146, 0
  v_accvgpr_write_b32 a147, 0
  v_accvgpr_write_b32 a148, 0
  v_accvgpr_write_b32 a149, 0
  v_accvgpr_write_b32 a150, 0
  v_accvgpr_write_b32 a151, 0
  v_accvgpr_write_b32 a152, 0
  v_accvgpr_write_b32 a153, 0
  v_accvgpr_write_b32 a154, 0
  v_accvgpr_write_b32 a155, 0
  v_accvgpr_write_b32 a156, 0
  v_accvgpr_write_b32 a157, 0
  v_accvgpr_write_b32 a158, 0
  v_accvgpr_write_b32 a159, 0
  v_accvgpr_write_b32 a160, 0
  v_accvgpr_write_b32 a161, 0
  v_accvgpr_write_b32 a162, 0
  v_accvgpr_write_b32 a163, 0
  v_accvgpr_write_b32 a164, 0
  v_accvgpr_write_b32 a165, 0
  v_accvgpr_write_b32 a166, 0
  v_accvgpr_write_b32 a167, 0
  v_accvgpr_write_b32 a168, 0
  v_accvgpr_write_b32 a169, 0
  v_accvgpr_write_b32 a170, 0
  v_accvgpr_write_b32 a171, 0
  v_accvgpr_write_b32 a172, 0
  v_accvgpr_write_b32 a173, 0
  v_accvgpr_write_b32 a174, 0
  v_accvgpr_write_b32 a175, 0
  v_accvgpr_write_b32 a176, 0
  v_accvgpr_write_b32 a177, 0
  v_accvgpr_write_b32 a178, 0
  v_accvgpr_write_b32 a179, 0
  v_accvgpr_write_b32 a180, 0
  v_accvgpr_write_b32 a181, 0
  v_accvgpr_write_b32 a182, 0
  v_accvgpr_write_b32 a183, 0
  v_accvgpr_write_b32 a184, 0
  v_accvgpr_write_b32 a185, 0
  v_accvgpr_write_b32 a186, 0
  v_accvgpr_write_b32 a187, 0
  v_accvgpr_write_b32 a188, 0
  v_accvgpr_write_b32 a189, 0
  v_accvgpr_write_b32 a190, 0
  v_accvgpr_write_b32 a191, 0
  v_accvgpr_write_b32 a192, 0
  v_accvgpr_write_b32 a193, 0
  v_accvgpr_write_b32 a194, 0
  v_accvgpr_write_b32 a195, 0
  v_accvgpr_write_b32 a196, 0
  v_accvgpr_write_b32 a197, 0
  v_accvgpr_write_b32 a198, 0
  v_accvgpr_write_b32 a199, 0
  v_accvgpr_write_b32 a200, 0
  v_accvgpr_write_b32 a201, 0
  v_accvgpr_write_b32 a202, 0
  v_accvgpr_write_b32 a203, 0
  v_accvgpr_write_b32 a204, 0
  v_accvgpr_write_b32 a205, 0
  v_accvgpr_write_b32 a206, 0
  v_accvgpr_write_b32 a207, 0
  v_accvgpr_write_b32 a208, 0
  v_accvgpr_write_b32 a209, 0
  v_accvgpr_write_b32 a210, 0
  v_accvgpr_write_b32 a211, 0
  v_accvgpr_write_b32 a212, 0
  v_accvgpr_write_b32 a213, 0
  v_accvgpr_write_b32 a214, 0
  v_accvgpr_write_b32 a215, 0
  v_accvgpr_write_b32 a216, 0
  v_accvgpr_write_b32 a217, 0
  v_accvgpr_write_b32 a218, 0
  v_accvgpr_write_b32 a219, 0
  v_accvgpr_write_b32 a220, 0
  v_accvgpr_write_b32 a221, 0
  v_accvgpr_write_b32 a222, 0
  v_accvgpr_write_b32 a223, 0
  v_accvgpr_write_b32 a224, 0
  v_accvgpr_write_b32 a225, 0
  v_accvgpr_write_b32 a226, 0
  v_accvgpr_write_b32 a227, 0
  v_accvgpr_write_b32 a228, 0
  v_accvgpr_write_b32 a229, 0
  v_accvgpr_write_b32 a230, 0
  v_accvgpr_write_b32 a231, 0
  v_accvgpr_write_b32 a232, 0
  v_accvgpr_write_b32 a233, 0
  v_accvgpr_write_b32 a234, 0
  v_accvgpr_write_b32 a235, 0
  v_accvgpr_write_b32 a236, 0
  v_accvgpr_write_b32 a237, 0
  v_accvgpr_write_b32 a238, 0
  v_accvgpr_write_b32 a239, 0
  v_accvgpr_write_b32 a240, 0
  v_accvgpr_write_b32 a241, 0
  v_accvgpr_write_b32 a242, 0
  v_accvgpr_write_b32 a243, 0
  v_accvgpr_write_b32 a244, 0
  v_accvgpr_write_b32 a245, 0
  v_accvgpr_write_b32 a246, 0
  v_accvgpr_write_b32 a247, 0
  v_accvgpr_write_b32 a248, 0
  v_accvgpr_write_b32 a249, 0
  v_accvgpr_write_b32 a250, 0
  v_accvgpr_write_b32 a251, 0
  v_accvgpr_write_b32 a252, 0
  v_accvgpr_write_b32 a253, 0
  v_accvgpr_write_b32 a254, 0
  v_accvgpr_write_b32 a255, 0
  s_mov_b32 s7, 0
  v_mov_b32 v8, 128
L_wd_53:
  buffer_load_dword v9, v8, s[12:15], 0 offen sc1
  s_waitcnt vmcnt(0)
  v_cmp_ne_u32 vcc, 0x100, v9
  s_cbranch_vccz L_wdo_54
  s_add_u32 s7, s7, 1
  s_cmp_lt_u32 s7, 131072
  s_cbranch_scc1 L_wd_53
  s_mov_b32 s6, 40
  s_branch L_err
L_wdo_54:
  v_and_b32 v4, 60, v4
  s_lshl_b32 s6, s5, 6
  s_add_u32 s34, s6, 0x710000
  s_mov_b32 s33, 1
  s_mov_b32 s7, 0
L_pl_55:
  buffer_load_dword v8, v4, s[8:11], s34 offen offset:0 sc1
  s_waitcnt vmcnt(0)
  v_cmp_gt_u32 vcc, s33, v8
  s_cbranch_vccz L_plo_56
  s_add_u32 s7, s7, 1
  s_cmp_lt_u32 s7, 131072
  s_cbranch_scc1 L_pl_55
  s_mov_b32 s6, 41
  s_branch L_err
L_plo_56:
  s_mul_i32 s34, s5, 73728
  s_mul_i32 s35, s3, 18432
  s_add_u32 s34, s34, s35
  s_add_u32 s34, s34, 0x400000
  s_add_u32 m0, s35, 0
  s_add_u32 s6, s34, 0
  buffer_load_dwordx4 v0, s[8:11], s6 offen offset:0 lds
  buffer_load_dwordx4 v0, s[8:11], s6 offen offset:1024 lds
  buffer_load_dwordx4 v0, s[8:11], s6 offen offset:2048 lds
  buffer_load_dwordx4 v0, s[8:11], s6 offen offset:3072 lds
  s_add_u32 m0, s35, 4096
  s_add_u32 s6, s34, 4096
  buffer_load_dwordx4 v0, s[8:11], s6 offen offset:0 lds
  buffer_load_dwordx4 v0, s[8:11], s6 offen offset:1024 lds
  buffer_load_dwordx4 v0, s[8:11], s6 offen offset:2048 lds
  buffer_load_dwordx4 v0, s[8:11], s6 offen offset:3072 lds
  s_add_u32 m0, s35, 8192
  s_add_u32 s6, s34, 8192
  buffer_load_dwordx4 v0, s[8:11], s6 offen offset:0 lds
  buffer_load_dwordx4 v0, s[8:11], s6 offen offset:1024 lds
  buffer_load_dwordx4 v0, s[8:11], s6 offen offset:2048 lds
  buffer_load_dwordx4 v0, s[8:11], s6 offen offset:3072 lds
  s_add_u32 m0, s35, 12288
  s_add_u32 s6, s34, 12288
  buffer_load_dwordx4 v0, s[8:11], s6 offen offset:0 lds
  buffer_load_dwordx4 v0, s[8:11], s6 offen offset:1024 lds
  buffer_load_dwordx4 v0, s[8:11], s6 offen offset:2048 lds
  buffer_load_dwordx4 v0, s[8:11], s6 offen offset:3072 lds
  s_add_u32 m0, s35, 16384
  s_add_u32 s6, s34, 16384
  buffer_load_dwordx4 v0, s[8:11], s6 offen offset:0 lds
  buffer_load_dwordx4 v0, s[8:11], s6 offen offset:1024 lds
  s_mov_b32 s32, 0
  s_waitcnt vmcnt(0) lgkmcnt(0)
  s_barrier
  s_cmp_ge_u32 s3, 2
  s_cbranch_scc1 L_c_res
  s_mov_b32 s16, s76
  s_mov_b32 s17, s77
  s_mov_b32 s18, 0x400
  s_mov_b32 s19, 0x20000
  v_bfe_u32 v16, v0, 4, 4
  v_lshrrev_b32 v17, 8, v0
  v_lshrrev_b32 v18, 7, v0
  s_lshl_b32 s6, s5, 5
  s_lshl_b32 s7, s3, 4
  s_add_u32 s6, s6, s7
  v_lshlrev_b32 v19, 1, v18
  buffer_load_ushort v12, v19, s[16:19], s6 offen
  s_mul_i32 s6, s3, 36864
  v_mul_u32_u24 v19, 4608, v18
  v_add_u32 v19, s6, v19
  ds_read_b32 v11, v19 offset:4576
  s_add_u32 s6, s6, 480
  v_lshlrev_b32 v19, 5, v16
  v_sub_u32 v19, s6, v19
  v_lshl_add_u32 v4, v17, 4, v19
  s_mul_i32 s6, s3, 33024
  s_add_u32 s6, s6, 73728
  v_lshlrev_b32 v19, 1, v16
  v_lshl_add_u32 v19, v17, 4, v19
  v_add_u32 v5, s6, v19
  v_mul_u32_u24 v19, 4128, v18
  v_bfe_u32 v20, v0, 1, 6
  v_add3_u32 v19, v19, v20, s6
  v_add_u32 v8, 32, v19
  s_lshl_b32 s6, s3, 10
  s_add_u32 s6, s6, 147968
  v_add_u32 v7, s6, v0
  v_and_b32 v19, 1, v16
  v_lshlrev_b32 v19, 6, v19
  v_lshl_add_u32 v19, v17, 4, v19
  v_add_u32 v6, s6, v19
  v_lshrrev_b32 v10, 1, v0
  s_lshl_b32 s6, s3, 9
  s_add_u32 s35, s6, 139776
  s_lshl_b32 s7, s5, 10
  s_add_u32 s6, s6, s7
  s_add_u32 s40, s6, 0x200000
  s_lshl_b32 s6, s5, 3
  s_lshl_b32 s7, s3, 2
  s_add_u32 s6, s6, s7
  s_add_u32 s39, s6, 0x710800
  v_add_u32 v14, s7, v2
  s_waitcnt vmcnt(0) lgkmcnt(0)
  v_lshlrev_b32 v12, 16, v12
  v_and_b32 v15, 2, v5
  v_and_b32 v5, -4, v5
  v_add_u32 v104, 0, v5
  v_add_u32 v105, 4128, v5
  v_add_u32 v106, 8256, v5
  v_add_u32 v107, 12384, v5
  v_add_u32 v108, 16512, v5
  v_add_u32 v109, 20640, v5
  v_add_u32 v110, 24768, v5
  v_add_u32 v111, 28896, v5
L_c_conv0:
  s_add_u32 s33, s32, 1
  s_and_b32 s6, s32, 7
  s_lshl_b32 s7, s6, 10
  s_add_u32 s7, s7, s35
  v_add_u32 v9, s7, v10
  s_lshl_b32 s6, s6, 1
  s_lshl_b32 s42, 0x30003, s6
  v_mov_b32 v13, s33
  ds_read_b128 v[48:51], v4 offset:3584
  ds_read_b128 v[52:55], v4 offset:8192
  ds_read_b128 v[56:59], v4 offset:12800
  ds_read_b128 v[60:63], v4 offset:17408
  ds_read_b128 v[64:67], v4 offset:22016
  ds_read_b128 v[68:71], v4 offset:26624
  ds_read_b128 v[72:75], v4 offset:31232
  ds_read_b128 v[76:79], v4 offset:35840
  s_mov_b32 s7, 0
L_lw_57:
  ds_read_b32 v88, v2 offset:0
  s_waitcnt lgkmcnt(0)
  v_cmp_gt_i32 vcc, s33, v88
  s_cbranch_vccz L_lwo_58
  s_add_u32 s7, s7, 1
  s_cmp_lt_u32 s7, 131072
  s_cbranch_scc1 L_lw_57
  s_mov_b32 s6, 42
  s_branch L_err
L_lwo_58:
  ds_read2_b32 v[112:113], v104 offset0:0 offset1:1
  ds_read2_b32 v[114:115], v104 offset0:2 offset1:3
  ds_read_b32 v116, v104 offset:16
  ds_read2_b32 v[118:119], v105 offset0:0 offset1:1
  ds_read2_b32 v[120:121], v105 offset0:2 offset1:3
  ds_read_b32 v122, v105 offset:16
  ds_read2_b32 v[124:125], v106 offset0:0 offset1:1
  ds_read2_b32 v[126:127], v106 offset0:2 offset1:3
  ds_read_b32 v128, v106 offset:16
  ds_read2_b32 v[130:131], v107 offset0:0 offset1:1
  ds_read2_b32 v[132:133], v107 offset0:2 offset1:3
  ds_read_b32 v134, v107 offset:16
  s_waitcnt lgkmcnt(9)
  v_alignbyte_b32 v16, v113, v112, v15
  v_alignbyte_b32 v17, v114, v113, v15
  v_alignbyte_b32 v18, v115, v114, v15
  v_alignbyte_b32 v19, v116, v115, v15
  ds_read2_b32 v[112:113], v108 offset0:0 offset1:1
  ds_read2_b32 v[114:115], v108 offset0:2 offset1:3
  ds_read_b32 v116, v108 offset:16
  s_waitcnt lgkmcnt(9)
  v_alignbyte_b32 v20, v119, v118, v15
  v_alignbyte_b32 v21, v120, v119, v15
  v_alignbyte_b32 v22, v121, v120, v15
  v_alignbyte_b32 v23, v122, v121, v15
  ds_read2_b32 v[118:119], v109 offset0:0 offset1:1
  ds_read2_b32 v[120:121], v109 offset0:2 offset1:3
  ds_read_b32 v122, v109 offset:16
  v_mfma_f32_16x16x32_bf16 a[0:3], v[16:19], v[48:51], a[0:3]
  s_waitcnt lgkmcnt(9)
  v_alignbyte_b32 v24, v125, v124, v15
  v_alignbyte_b32 v25, v126, v125, v15
  v_alignbyte_b32 v26, v127, v126, v15
  v_alignbyte_b32 v27, v128, v127, v15
  ds_read2_b32 v[124:125], v110 offset0:0 offset1:1
  ds_read2_b32 v[126:127], v110 offset0:2 offset1:3
  ds_read_b32 v128, v110 offset:16
  v_mfma_f32_16x16x32_bf16 a[32:35], v[20:23], v[52:55], a[32:35]
  s_waitcnt lgkmcnt(9)
  v_alignbyte_b32 v28, v131, v130, v15
  v_alignbyte_b32 v29, v132, v131, v15
  v_alignbyte_b32 v30, v133, v132, v15
  v_alignbyte_b32 v31, v134, v133, v15
  ds_read2_b32 v[130:131], v111 offset0:0 offset1:1
  ds_read2_b32 v[132:133], v111 offset0:2 offset1:3
  ds_read_b32 v134, v111 offset:16
  v_mfma_f32_16x16x32_bf16 a[64:67], v[24:27], v[56:59], a[64:67]
  s_waitcnt lgkmcnt(9)
  v_alignbyte_b32 v32, v113, v112, v15
  v_alignbyte_b32 v33, v114, v113, v15
  v_alignbyte_b32 v34, v115, v114, v15
  v_alignbyte_b32 v35, v116, v115, v15
  ds_read_b64 v[84:85], v8
  ds_read_b64 v[86:87], v9
  v_mfma_f32_16x16x32_bf16 a[96:99], v[28:31], v[60:63], a[96:99]
  s_waitcnt lgkmcnt(8)
  v_alignbyte_b32 v36, v119, v118, v15
  v_alignbyte_b32 v37, v120, v119, v15
  v_alignbyte_b32 v38, v121, v120, v15
  v_alignbyte_b32 v39, v122, v121, v15
  v_mfma_f32_16x16x32_bf16 a[128:131], v[32:35], v[64:67], a[128:131]
  s_waitcnt lgkmcnt(5)
  v_alignbyte_b32 v40, v125, v124, v15
  v_alignbyte_b32 v41, v126, v125, v15
  v_alignbyte_b32 v42, v127, v126, v15
  v_alignbyte_b32 v43, v128, v127, v15
  v_mfma_f32_16x16x32_bf16 a[160:163], v[36:39], v[68:71], a[160:163]
  s_waitcnt lgkmcnt(2)
  v_alignbyte_b32 v44, v131, v130, v15
  v_alignbyte_b32 v45, v132, v131, v15
  v_alignbyte_b32 v46, v133, v132, v15
  v_alignbyte_b32 v47, v134, v133, v15
  v_mfma_f32_16x16x32_bf16 a[192:195], v[40:43], v[72:75], a[192:195]
  s_nop 0
  v_mfma_f32_16x16x32_bf16 a[224:227], v[44:47], v[76:79], a[224:227]
  s_waitcnt lgkmcnt(0)
  ds_read_b128 v[48:51], v4 offset:3072
  ds_read_b128 v[52:55], v4 offset:7680
  ds_read_b128 v[56:59], v4 offset:12288
  ds_read_b128 v[60:63], v4 offset:16896
  ds_read_b128 v[64:67], v4 offset:21504
  ds_read_b128 v[68:71], v4 offset:26112
  ds_read_b128 v[72:75], v4 offset:30720
  ds_read_b128 v[76:79], v4 offset:35328
  s_mov_b32 exec_lo, s42
  s_mov_b32 exec_hi, s42
  ds_write_b128 v6, a[0:3] offset:0
  ds_write_b128 v6, a[32:35] offset:128
  ds_write_b128 v6, a[64:67] offset:256
  ds_write_b128 v6, a[96:99] offset:384
  ds_write_b128 v6, a[128:131] offset:512
  ds_write_b128 v6, a[160:163] offset:640
  ds_write_b128 v6, a[192:195] offset:768
  ds_write_b128 v6, a[224:227] offset:896
  s_mov_b64 exec, -1
  ds_read_b128 v[80:83], v7
  ds_write_b32 v14, v13 offset:8
  v_lshlrev_b32 v88, 16, v84
  v_and_b32 v89, 0xffff0000, v84
  v_lshlrev_b32 v90, 16, v85
  v_and_b32 v91, 0xffff0000, v85
  v_lshlrev_b32 v96, 16, v86
  v_and_b32 v97, 0xffff0000, v86
  v_lshlrev_b32 v98, 16, v87
  v_and_b32 v99, 0xffff0000, v87
  v_mul_f32 v92, v88, v12
  v_mul_f32 v93, v89, v12
  v_mul_f32 v94, v90, v12
  v_mul_f32 v95, v91, v12
  v_cvt_pk_bf16_f32 v84, v92, v93
  v_cvt_pk_bf16_f32 v85, v94, v95
  v_lshlrev_b32 v92, 16, v84
  v_and_b32 v93, 0xffff0000, v84
  v_lshlrev_b32 v94, 16, v85
  v_and_b32 v95, 0xffff0000, v85
  s_waitcnt lgkmcnt(1)
  v_fmac_f32 v80, v88, v11
  v_fmac_f32 v81, v89, v11
  v_fmac_f32 v82, v90, v11
  v_fmac_f32 v83, v91, v11
  v_cvt_pk_bf16_f32 v84, v80, v81
  v_cvt_pk_bf16_f32 v85, v82, v83
  v_lshlrev_b32 v80, 16, v84
  v_and_b32 v81, 0xffff0000, v84
  v_lshlrev_b32 v82, 16, v85
  v_and_b32 v83, 0xffff0000, v85
  v_add_f32 v80, v80, v92
  v_add_f32 v81, v81, v93
  v_add_f32 v82, v82, v94
  v_add_f32 v83, v83, v95
  v_cvt_pk_bf16_f32 v84, v80, v81
  v_cvt_pk_bf16_f32 v85, v82, v83
  v_lshlrev_b32 v80, 16, v84
  v_and_b32 v81, 0xffff0000, v84
  v_lshlrev_b32 v82, 16, v85
  v_and_b32 v83, 0xffff0000, v85
  v_add_f32 v80, v80, v96
  v_add_f32 v81, v81, v97
  v_add_f32 v82, v82, v98
  v_add_f32 v83, v83, v99
  v_cvt_pk_bf16_f32 v84, v80, v81
  v_cvt_pk_bf16_f32 v85, v82, v83
  buffer_store_dwordx2 v[84:85], v10, s[8:11], s40 offen sc1
  v_mfma_f32_16x16x32_bf16 a[4:7], v[16:19], v[48:51], a[4:7]
  ds_read_b128 v[48:51], v4 offset:2560
  v_mfma_f32_16x16x32_bf16 a[36:39], v[20:23], v[52:55], a[36:39]
  ds_read_b128 v[52:55], v4 offset:7168
  v_mfma_f32_16x16x32_bf16 a[68:71], v[24:27], v[56:59], a[68:71]
  ds_read_b128 v[56:59], v4 offset:11776
  v_mfma_f32_16x16x32_bf16 a[100:103], v[28:31], v[60:63], a[100:103]
  ds_read_b128 v[60:63], v4 offset:16384
  v_mfma_f32_16x16x32_bf16 a[132:135], v[32:35], v[64:67], a[132:135]
  ds_read_b128 v[64:67], v4 offset:20992
  v_mfma_f32_16x16x32_bf16 a[164:167], v[36:39], v[68:71], a[164:167]
  ds_read_b128 v[68:71], v4 offset:25600
  v_mfma_f32_16x16x32_bf16 a[196:199], v[40:43], v[72:75], a[196:199]
  ds_read_b128 v[72:75], v4 offset:30208
  v_mfma_f32_16x16x32_bf16 a[228:231], v[44:47], v[76:79], a[228:231]
  ds_read_b128 v[76:79], v4 offset:34816
  s_waitcnt lgkmcnt(7)
  v_mfma_f32_16x16x32_bf16 a[8:11], v[16:19], v[48:51], a[8:11]
  ds_read_b128 v[48:51], v4 offset:2048
  s_waitcnt lgkmcnt(7)
  v_mfma_f32_16x16x32_bf16 a[40:43], v[20:23], v[52:55], a[40:43]
  ds_read_b128 v[52:55], v4 offset:6656
  s_waitcnt lgkmcnt(7)
  v_mfma_f32_16x16x32_bf16 a[72:75], v[24:27], v[56:59], a[72:75]
  ds_read_b128 v[56:59], v4 offset:11264
  s_waitcnt lgkmcnt(7)
  v_mfma_f32_16x16x32_bf16 a[104:107], v[28:31], v[60:63], a[104:107]
  ds_read_b128 v[60:63], v4 offset:15872
  s_waitcnt lgkmcnt(7)
  v_mfma_f32_16x16x32_bf16 a[136:139], v[32:35], v[64:67], a[136:139]
  ds_read_b128 v[64:67], v4 offset:20480
  s_waitcnt lgkmcnt(7)
  v_mfma_f32_16x16x32_bf16 a[168:171], v[36:39], v[68:71], a[168:171]
  ds_read_b128 v[68:71], v4 offset:25088
  s_waitcnt lgkmcnt(7)
  v_mfma_f32_16x16x32_bf16 a[200:203], v[40:43], v[72:75], a[200:203]
  ds_read_b128 v[72:75], v4 offset:29696
  s_waitcnt lgkmcnt(7)
  v_mfma_f32_16x16x32_bf16 a[232:235], v[44:47], v[76:79], a[232:235]
  ds_read_b128 v[76:79], v4 offset:34304
  s_waitcnt lgkmcnt(7)
  v_mfma_f32_16x16x32_bf16 a[12:15], v[16:19], v[48:51], a[12:15]
  ds_read_b128 v[48:51], v4 offset:1536
  s_waitcnt lgkmcnt(7)
  v_mfma_f32_16x16x32_bf16 a[44:47], v[20:23], v[52:55], a[44:47]
  ds_read_b128 v[52:55], v4 offset:6144
  s_waitcnt lgkmcnt(7)
  v_mfma_f32_16x16x32_bf16 a[76:79], v[24:27], v[56:59], a[76:79]
  ds_read_b128 v[56:59], v4 offset:10752
  s_waitcnt lgkmcnt(7)
  v_mfma_f32_16x16x32_bf16 a[108:111], v[28:31], v[60:63], a[108:111]
  ds_read_b128 v[60:63], v4 offset:15360
  s_waitcnt lgkmcnt(7)
  v_mfma_f32_16x16x32_bf16 a[140:143], v[32:35], v[64:67], a[140:143]
  ds_read_b128 v[64:67], v4 offset:19968
  s_waitcnt lgkmcnt(7)
  v_mfma_f32_16x16x32_bf16 a[172:175], v[36:39], v[68:71], a[172:175]
  ds_read_b128 v[68:71], v4 offset:24576
  s_waitcnt lgkmcnt(7)
  v_mfma_f32_16x16x32_bf16 a[204:207], v[40:43], v[72:75], a[204:207]
  ds_read_b128 v[72:75], v4 offset:29184
  s_waitcnt lgkmcnt(7)
  v_mfma_f32_16x16x32_bf16 a[236:239], v[44:47], v[76:79], a[236:239]
  ds_read_b128 v[76:79], v4 offset:33792
  s_waitcnt lgkmcnt(7)
  v_mfma_f32_16x16x32_bf16 a[16:19], v[16:19], v[48:51], a[16:19]
  ds_read_b128 v[48:51], v4 offset:1024
  s_waitcnt lgkmcnt(7)
  v_mfma_f32_16x16x32_bf16 a[48:51], v[20:23], v[52:55], a[48:51]
  ds_read_b128 v[52:55], v4 offset:5632
  s_waitcnt lgkmcnt(7)
  v_mfma_f32_16x16x32_bf16 a[80:83], v[24:27], v[56:59], a[80:83]
  ds_read_b128 v[56:59], v4 offset:10240
  s_waitcnt lgkmcnt(7)
  v_mfma_f32_16x16x32_bf16 a[112:115], v[28:31], v[60:63], a[112:115]
  ds_read_b128 v[60:63], v4 offset:14848
  s_waitcnt lgkmcnt(7)
  v_mfma_f32_16x16x32_bf16 a[144:147], v[32:35], v[64:67], a[144:147]
  ds_read_b128 v[64:67], v4 offset:19456
  s_waitcnt lgkmcnt(7)
  v_mfma_f32_16x16x32_bf16 a[176:179], v[36:39], v[68:71], a[176:179]
  ds_read_b128 v[68:71], v4 offset:24064
  s_waitcnt lgkmcnt(7)
  v_mfma_f32_16x16x32_bf16 a[208:211], v[40:43], v[72:75], a[208:211]
  ds_read_b128 v[72:75], v4 offset:28672
  s_waitcnt lgkmcnt(7)
  v_mfma_f32_16x16x32_bf16 a[240:243], v[44:47], v[76:79], a[240:243]
  ds_read_b128 v[76:79], v4 offset:33280
  s_waitcnt lgkmcnt(7)
  v_mfma_f32_16x16x32_bf16 a[20:23], v[16:19], v[48:51], a[20:23]
  ds_read_b128 v[48:51], v4 offset:512
  s_waitcnt lgkmcnt(7)
  v_mfma_f32_16x16x32_bf16 a[52:55], v[20:23], v[52:55], a[52:55]
  ds_read_b128 v[52:55], v4 offset:5120
  s_waitcnt lgkmcnt(7)
  v_mfma_f32_16x16x32_bf16 a[84:87], v[24:27], v[56:59], a[84:87]
  ds_read_b128 v[56:59], v4 offset:9728
  s_waitcnt lgkmcnt(7)
  v_mfma_f32_16x16x32_bf16 a[116:119], v[28:31], v[60:63], a[116:119]
  ds_read_b128 v[60:63], v4 offset:14336
  s_waitcnt lgkmcnt(7)
  v_mfma_f32_16x16x32_bf16 a[148:151], v[32:35], v[64:67], a[148:151]
  ds_read_b128 v[64:67], v4 offset:18944
  s_waitcnt lgkmcnt(7)
  v_mfma_f32_16x16x32_bf16 a[180:183], v[36:39], v[68:71], a[180:183]
  ds_read_b128 v[68:71], v4 offset:23552
  s_waitcnt lgkmcnt(7)
  v_mfma_f32_16x16x32_bf16 a[212:215], v[40:43], v[72:75], a[212:215]
  ds_read_b128 v[72:75], v4 offset:28160
  s_waitcnt lgkmcnt(7)
  v_mfma_f32_16x16x32_bf16 a[244:247], v[44:47], v[76:79], a[244:247]
  ds_read_b128 v[76:79], v4 offset:32768
  s_waitcnt lgkmcnt(7)
  v_mfma_f32_16x16x32_bf16 a[24:27], v[16:19], v[48:51], a[24:27]
  ds_read_b128 v[48:51], v4 offset:0
  s_waitcnt lgkmcnt(7)
  v_mfma_f32_16x16x32_bf16 a[56:59], v[20:23], v[52:55], a[56:59]
  ds_read_b128 v[52:55], v4 offset:4608
  s_waitcnt lgkmcnt(7)
  v_mfma_f32_16x16x32_bf16 a[88:91], v[24:27], v[56:59], a[88:91]
  ds_read_b128 v[56:59], v4 offset:9216
  s_waitcnt lgkmcnt(7)
  v_mfma_f32_16x16x32_bf16 a[120:123], v[28:31], v[60:63], a[120:123]
  ds_read_b128 v[60:63], v4 offset:13824
  s_waitcnt lgkmcnt(7)
  v_mfma_f32_16x16x32_bf16 a[152:155], v[32:35], v[64:67], a[152:155]
  ds_read_b128 v[64:67], v4 offset:18432
  s_waitcnt lgkmcnt(7)
  v_mfma_f32_16x16x32_bf16 a[184:187], v[36:39], v[68:71], a[184:187]
  ds_read_b128 v[68:71], v4 offset:23040
  s_waitcnt lgkmcnt(7)
  v_mfma_f32_16x16x32_bf16 a[216:219], v[40:43], v[72:75], a[216:219]
  ds_read_b128 v[72:75], v4 offset:27648
  s_waitcnt lgkmcnt(7)
  v_mfma_f32_16x16x32_bf16 a[248:251], v[44:47], v[76:79], a[248:251]
  ds_read_b128 v[76:79], v4 offset:32256
  s_waitcnt lgkmcnt(7)
  v_mfma_f32_16x16x32_bf16 a[28:31], v[16:19], v[48:51], a[28:31]
  s_waitcnt lgkmcnt(6)
  v_mfma_f32_16x16x32_bf16 a[60:63], v[20:23], v[52:55], a[60:63]
  s_waitcnt lgkmcnt(5)
  v_mfma_f32_16x16x32_bf16 a[92:95], v[24:27], v[56:59], a[92:95]
  s_waitcnt lgkmcnt(4)
  v_mfma_f32_16x16x32_bf16 a[124:127], v[28:31], v[60:63], a[124:127]
  s_waitcnt lgkmcnt(3)
  v_mfma_f32_16x16x32_bf16 a[156:159], v[32:35], v[64:67], a[156:159]
  s_waitcnt lgkmcnt(2)
  v_mfma_f32_16x16x32_bf16 a[188:191], v[36:39], v[68:71], a[188:191]
  s_waitcnt lgkmcnt(1)
  v_mfma_f32_16x16x32_bf16 a[220:223], v[40:43], v[72:75], a[220:223]
  s_waitcnt lgkmcnt(0)
  v_mfma_f32_16x16x32_bf16 a[252:255], v[44:47], v[76:79], a[252:255]
  v_add_u32 v104, 64, v104
  v_add_u32 v105, 64, v105
  v_add_u32 v106, 64, v106
  v_add_u32 v107, 64, v107
  v_add_u32 v108, 64, v108
  v_add_u32 v109, 64, v109
  v_add_u32 v110, 64, v110
  v_add_u32 v111, 64, v111
  v_add_u32 v4, 64, v4
  v_add_u32 v8, 64, v8
  s_add_u32 s40, s40, 0x8000
  s_waitcnt vmcnt(0)
  s_mov_b64 exec, 1
  buffer_store_dword v13, v1, s[8:11], s39 offen sc1
  s_mov_b64 exec, -1
  s_add_u32 s32, s32, 1
  s_and_b32 s6, s32, 7
  s_cbranch_scc1 L_c_conv0
L_c_conv1:
  s_add_u32 s33, s32, 1
  s_and_b32 s6, s32, 7
  s_lshl_b32 s7, s6, 10
  s_add_u32 s7, s7, s35
  v_add_u32 v9, s7, v10
  s_lshl_b32 s6, s6, 1
  s_lshl_b32 s42, 0x30003, s6
  v_mov_b32 v13, s33
  ds_read_b128 v[48:51], v4 offset:3072
  ds_read_b128 v[52:55], v4 offset:7680
  ds_read_b128 v[56:59], v4 offset:12288
  ds_read_b128 v[60:63], v4 offset:16896
  ds_read_b128 v[64:67], v4 offset:21504
  ds_read_b128 v[68:71], v4 offset:26112
  ds_read_b128 v[72:75], v4 offset:30720
  ds_read_b128 v[76:79], v4 offset:35328
  s_mov_b32 s7, 0
L_lw_59:
  ds_read_b32 v88, v2 offset:0
  s_waitcnt lgkmcnt(0)
  v_cmp_gt_i32 vcc, s33, v88
  s_cbranch_vccz L_lwo_60
  s_add_u32 s7, s7, 1
  s_cmp_lt_u32 s7, 131072
  s_cbranch_scc1 L_lw_59
  s_mov_b32 s6, 42
  s_branch L_err
L_lwo_60:
  ds_read2_b32 v[112:113], v104 offset0:0 offset1:1
  ds_read2_b32 v[114:115], v104 offset0:2 offset1:3
  ds_read_b32 v116, v104 offset:16
  ds_read2_b32 v[118:119], v105 offset0:0 offset1:1
  ds_read2_b32 v[120:121], v105 offset0:2 offset1:3
  ds_read_b32 v122, v105 offset:16
  ds_read2_b32 v[124:125], v106 offset0:0 offset1:1
  ds_read2_b32 v[126:127], v106 offset0:2 offset1:3
  ds_read_b32 v128, v106 offset:16
  ds_read2_b32 v[130:131], v107 offset0:0 offset1:1
  ds_read2_b32 v[132:133], v107 offset0:2 offset1:3
  ds_read_b32 v134, v107 offset:16
  s_waitcnt lgkmcnt(9)
  v_alignbyte_b32 v16, v113, v112, v15
  v_alignbyte_b32 v17, v114, v113, v15
  v_alignbyte_b32 v18, v115, v114, v15
  v_alignbyte_b32 v19, v116, v115, v15
  ds_read2_b32 v[112:113], v108 offset0:0 offset1:1
  ds_read2_b32 v[114:115], v108 offset0:2 offset1:3
  ds_read_b32 v116, v108 offset:16
  s_waitcnt lgkmcnt(9)
  v_alignbyte_b32 v20, v119, v118, v15
  v_alignbyte_b32 v21, v120, v119, v15
  v_alignbyte_b32 v22, v121, v120, v15
  v_alignbyte_b32 v23, v122, v121, v15
  ds_read2_b32 v[118:119], v109 offset0:0 offset1:1
  ds_read2_b32 v[120:121], v109 offset0:2 offset1:3
  ds_read_b32 v122, v109 offset:16
  v_mfma_f32_16x16x32_bf16 a[4:7], v[16:19], v[48:51], a[4:7]
  s_waitcnt lgkmcnt(9)
  v_alignbyte_b32 v24, v125, v124, v15
  v_alignbyte_b32 v25, v126, v125, v15
  v_alignbyte_b32 v26, v127, v126, v15
  v_alignbyte_b32 v27, v128, v127, v15
  ds_read2_b32 v[124:125], v110 offset0:0 offset1:1
  ds_read2_b32 v[126:127], v110 offset0:2 offset1:3
  ds_read_b32 v128, v110 offset:16
  v_mfma_f32_16x16x32_bf16 a[36:39], v[20:23], v[52:55], a[36:39]
  s_waitcnt lgkmcnt(9)
  v_alignbyte_b32 v28, v131, v130, v15
  v_alignbyte_b32 v29, v132, v131, v15
  v_alignbyte_b32 v30, v133, v132, v15
  v_alignbyte_b32 v31, v134, v133, v15
  ds_read2_b32 v[130:131], v111 offset0:0 offset1:1
  ds_read2_b32 v[132:133], v111 offset0:2 offset1:3
  ds_read_b32 v134, v111 offset:16
  v_mfma_f32_16x16x32_bf16 a[68:71], v[24:27], v[56:59], a[68:71]
  s_waitcnt lgkmcnt(9)
  v_alignbyte_b32 v32, v113, v112, v15
  v_alignbyte_b32 v33, v114, v113, v15
  v_alignbyte_b32 v34, v115, v114, v15
  v_alignbyte_b32 v35, v116, v115, v15
  ds_read_b64 v[84:85], v8
  ds_read_b64 v[86:87], v9
  v_mfma_f32_16x16x32_bf16 a[100:103], v[28:31], v[60:63], a[100:103]
  s_waitcnt lgkmcnt(8)
  v_alignbyte_b32 v36, v119, v118, v15
  v_alignbyte_b32 v37, v120, v119, v15
  v_alignbyte_b32 v38, v121, v120, v15
  v_alignbyte_b32 v39, v122, v121, v15
  v_mfma_f32_16x16x32_bf16 a[132:135], v[32:35], v[64:67], a[132:135]
  s_waitcnt lgkmcnt(5)
  v_alignbyte_b32 v40, v125, v124, v15
  v_alignbyte_b32 v41, v126, v125, v15
  v_alignbyte_b32 v42, v127, v126, v15
  v_alignbyte_b32 v43, v128, v127, v15
  v_mfma_f32_16x16x32_bf16 a[164:167], v[36:39], v[68:71], a[164:167]
  s_waitcnt lgkmcnt(2)
  v_alignbyte_b32 v44, v131, v130, v15
  v_alignbyte_b32 v45, v132, v131, v15
  v_alignbyte_b32 v46, v133, v132, v15
  v_alignbyte_b32 v47, v134, v133, v15
  v_mfma_f32_16x16x32_bf16 a[196:199], v[40:43], v[72:75], a[196:199]
  s_nop 0
  v_mfma_f32_16x16x32_bf16 a[228:231], v[44:47], v[76:79], a[228:231]
  s_waitcnt lgkmcnt(0)
  ds_read_b128 v[48:51], v4 offset:2560
  ds_read_b128 v[52:55], v4 offset:7168
  ds_read_b128 v[56:59], v4 offset:11776
  ds_read_b128 v[60:63], v4 offset:16384
  ds_read_b128 v[64:67], v4 offset:20992
  ds_read_b128 v[68:71], v4 offset:25600
  ds_read_b128 v[72:75], v4 offset:30208
  ds_read_b128 v[76:79], v4 offset:34816
  s_mov_b32 exec_lo, s42
  s_mov_b32 exec_hi, s42
  ds_write_b128 v6, a[4:7] offset:0
  ds_write_b128 v6, a[36:39] offset:128
  ds_write_b128 v6, a[68:71] offset:256
  ds_write_b128 v6, a[100:103] offset:384
  ds_write_b128 v6, a[132:135] offset:512
  ds_write_b128 v6, a[164:167] offset:640
  ds_write_b128 v6, a[196:199] offset:768
  ds_write_b128 v6, a[228:231] offset:896
  s_mov_b64 exec, -1
  ds_read_b128 v[80:83], v7
  ds_write_b32 v14, v13 offset:8
  v_lshlrev_b32 v88, 16, v84
  v_and_b32 v89, 0xffff0000, v84
  v_lshlrev_b32 v90, 16, v85
  v_and_b32 v91, 0xffff0000, v85
  v_lshlrev_b32 v96, 16, v86
  v_and_b32 v97, 0xffff0000, v86
  v_lshlrev_b32 v98, 16, v87
  v_and_b32 v99, 0xffff0000, v87
  v_mul_f32 v92, v88, v12
  v_mul_f32 v93, v89, v12
  v_mul_f32 v94, v90, v12
  v_mul_f32 v95, v91, v12
  v_cvt_pk_bf16_f32 v84, v92, v93
  v_cvt_pk_bf16_f32 v85, v94, v95
  v_lshlrev_b32 v92, 16, v84
  v_and_b32 v93, 0xffff0000, v84
  v_lshlrev_b32 v94, 16, v85
  v_and_b32 v95, 0xffff0000, v85
  s_waitcnt lgkmcnt(1)
  v_fmac_f32 v80, v88, v11
  v_fmac_f32 v81, v89, v11
  v_fmac_f32 v82, v90, v11
  v_fmac_f32 v83, v91, v11
  v_cvt_pk_bf16_f32 v84, v80, v81
  v_cvt_pk_bf16_f32 v85, v82, v83
  v_lshlrev_b32 v80, 16, v84
  v_and_b32 v81, 0xffff0000, v84
  v_lshlrev_b32 v82, 16, v85
  v_and_b32 v83, 0xffff0000, v85
  v_add_f32 v80, v80, v92
  v_add_f32 v81, v81, v93
  v_add_f32 v82, v82, v94
  v_add_f32 v83, v83, v95
  v_cvt_pk_bf16_f32 v84, v80, v81
  v_cvt_pk_bf16_f32 v85, v82, v83
  v_lshlrev_b32 v80, 16, v84
  v_and_b32 v81, 0xffff0000, v84
  v_lshlrev_b32 v82, 16, v85
  v_and_b32 v83, 0xffff0000, v85
  v_add_f32 v80, v80, v96
  v_add_f32 v81, v81, v97
  v_add_f32 v82, v82, v98
  v_add_f32 v83, v83, v99
  v_cvt_pk_bf16_f32 v84, v80, v81
  v_cvt_pk_bf16_f32 v85, v82, v83
  buffer_store_dwordx2 v[84:85], v10, s[8:11], s40 offen sc1
  v_mfma_f32_16x16x32_bf16 a[8:11], v[16:19], v[48:51], a[8:11]
  ds_read_b128 v[48:51], v4 offset:2048
  v_mfma_f32_16x16x32_bf16 a[40:43], v[20:23], v[52:55], a[40:43]
  ds_read_b128 v[52:55], v4 offset:6656
  v_mfma_f32_16x16x32_bf16 a[72:75], v[24:27], v[56:59], a[72:75]
  ds_read_b128 v[56:59], v4 offset:11264
  v_mfma_f32_16x16x32_bf16 a[104:107], v[28:31], v[60:63], a[104:107]
  ds_read_b128 v[60:63], v4 offset:15872
  v_mfma_f32_16x16x32_bf16 a[136:139], v[32:35], v[64:67], a[136:139]
  ds_read_b128 v[64:67], v4 offset:20480
  v_mfma_f32_16x16x32_bf16 a[168:171], v[36:39], v[68:71], a[168:171]
  ds_read_b128 v[68:71], v4 offset:25088
  v_mfma_f32_16x16x32_bf16 a[200:203], v[40:43], v[72:75], a[200:203]
  ds_read_b128 v[72:75], v4 offset:29696
  v_mfma_f32_16x16x32_bf16 a[232:235], v[44:47], v[76:79], a[232:235]
  ds_read_b128 v[76:79], v4 offset:34304
  s_waitcnt lgkmcnt(7)
  v_mfma_f32_16x16x32_bf16 a[12:15], v[16:19], v[48:51], a[12:15]
  ds_read_b128 v[48:51], v4 offset:1536
  s_waitcnt lgkmcnt(7)
  v_mfma_f32_16x16x32_bf16 a[44:47], v[20:23], v[52:55], a[44:47]
  ds_read_b128 v[52:55], v4 offset:6144
  s_waitcnt lgkmcnt(7)
  v_mfma_f32_16x16x32_bf16 a[76:79], v[24:27], v[56:59], a[76:79]
  ds_read_b128 v[56:59], v4 offset:10752
  s_waitcnt lgkmcnt(7)
  v_mfma_f32_16x16x32_bf16 a[108:111], v[28:31], v[60:63], a[108:111]
  ds_read_b128 v[60:63], v4 offset:15360
  s_waitcnt lgkmcnt(7)
  v_mfma_f32_16x16x32_bf16 a[140:143], v[32:35], v[64:67], a[140:143]
  ds_read_b128 v[64:67], v4 offset:19968
  s_waitcnt lgkmcnt(7)
  v_mfma_f32_16x16x32_bf16 a[172:175], v[36:39], v[68:71], a[172:175]
  ds_read_b128 v[68:71], v4 offset:24576
  s_waitcnt lgkmcnt(7)
  v_mfma_f32_16x16x32_bf16 a[204:207], v[40:43], v[72:75], a[204:207]
  ds_read_b128 v[72:75], v4 offset:29184
  s_waitcnt lgkmcnt(7)
  v_mfma_f32_16x16x32_bf16 a[236:239], v[44:47], v[76:79], a[236:239]
  ds_read_b128 v[76:79], v4 offset:33792
  s_waitcnt lgkmcnt(7)
  v_mfma_f32_16x16x32_bf16 a[16:19], v[16:19], v[48:51], a[16:19]
  ds_read_b128 v[48:51], v4 offset:1024
  s_waitcnt lgkmcnt(7)
  v_mfma_f32_16x16x32_bf16 a[48:51], v[20:23], v[52:55], a[48:51]
  ds_read_b128 v[52:55], v4 offset:5632
  s_waitcnt lgkmcnt(7)
  v_mfma_f32_16x16x32_bf16 a[80:83], v[24:27], v[56:59], a[80:83]
  ds_read_b128 v[56:59], v4 offset:10240
  s_waitcnt lgkmcnt(7)
  v_mfma_f32_16x16x32_bf16 a[112:115], v[28:31], v[60:63], a[112:115]
  ds_read_b128 v[60:63], v4 offset:14848
  s_waitcnt lgkmcnt(7)
  v_mfma_f32_16x16x32_bf16 a[144:147], v[32:35], v[64:67], a[144:147]
  ds_read_b128 v[64:67], v4 offset:19456
  s_waitcnt lgkmcnt(7)
  v_mfma_f32_16x16x32_bf16 a[176:179], v[36:39], v[68:71], a[176:179]
  ds_read_b128 v[68:71], v4 offset:24064
  s_waitcnt lgkmcnt(7)
  v_mfma_f32_16x16x32_bf16 a[208:211], v[40:43], v[72:75], a[208:211]
  ds_read_b128 v[72:75], v4 offset:28672
  s_waitcnt lgkmcnt(7)
  v_mfma_f32_16x16x32_bf16 a[240:243], v[44:47], v[76:79], a[240:243]
  ds_read_b128 v[76:79], v4 offset:33280
  s_waitcnt lgkmcnt(7)
  v_mfma_f32_16x16x32_bf16 a[20:23], v[16:19], v[48:51], a[20:23]
  ds_read_b128 v[48:51], v4 offset:512
  s_waitcnt lgkmcnt(7)
  v_mfma_f32_16x16x32_bf16 a[52:55], v[20:23], v[52:55], a[52:55]
  ds_read_b128 v[52:55], v4 offset:5120
  s_waitcnt lgkmcnt(7)
  v_mfma_f32_16x16x32_bf16 a[84:87], v[24:27], v[56:59], a[84:87]
  ds_read_b128 v[56:59], v4 offset:9728
  s_waitcnt lgkmcnt(7)
  v_mfma_f32_16x16x32_bf16 a[116:119], v[28:31], v[60:63], a[116:119]
  ds_read_b128 v[60:63], v4 offset:14336
  s_waitcnt lgkmcnt(7)
  v_mfma_f32_16x16x32_bf16 a[148:151], v[32:35], v[64:67], a[148:151]
  ds_read_b128 v[64:67], v4 offset:18944
  s_waitcnt lgkmcnt(7)
  v_mfma_f32_16x16x32_bf16 a[180:183], v[36:39], v[68:71], a[180:183]
  ds_read_b128 v[68:71], v4 offset:23552
  s_waitcnt lgkmcnt(7)
  v_mfma_f32_16x16x32_bf16 a[212:215], v[40:43], v[72:75], a[212:215]
  ds_read_b128 v[72:75], v4 offset:28160
  s_waitcnt lgkmcnt(7)
  v_mfma_f32_16x16x32_bf16 a[244:247], v[44:47], v[76:79], a[244:247]
  ds_read_b128 v[76:79], v4 offset:32768
  s_waitcnt lgkmcnt(7)
  v_mfma_f32_16x16x32_bf16 a[24:27], v[16:19], v[48:51], a[24:27]
  ds_read_b128 v[48:51], v4 offset:0
  s_waitcnt lgkmcnt(7)
  v_mfma_f32_16x16x32_bf16 a[56:59], v[20:23], v[52:55], a[56:59]
  ds_read_b128 v[52:55], v4 offset:4608
  s_waitcnt lgkmcnt(7)
  v_mfma_f32_16x16x32_bf16 a[88:91], v[24:27], v[56:59], a[88:91]
  ds_read_b128 v[56:59], v4 offset:9216
  s_waitcnt lgkmcnt(7)
  v_mfma_f32_16x16x32_bf16 a[120:123], v[28:31], v[60:63], a[120:123]
  ds_read_b128 v[60:63], v4 offset:13824
  s_waitcnt lgkmcnt(7)
  v_mfma_f32_16x16x32_bf16 a[152:155], v[32:35], v[64:67], a[152:155]
  ds_read_b128 v[64:67], v4 offset:18432
  s_waitcnt lgkmcnt(7)
  v_mfma_f32_16x16x32_bf16 a[184:187], v[36:39], v[68:71], a[184:187]
  ds_read_b128 v[68:71], v4 offset:23040
  s_waitcnt lgkmcnt(7)
  v_mfma_f32_16x16x32_bf16 a[216:219], v[40:43], v[72:75], a[216:219]
  ds_read_b128 v[72:75], v4 offset:27648
  s_waitcnt lgkmcnt(7)
  v_mfma_f32_16x16x32_bf16 a[248:251], v[44:47], v[76:79], a[248:251]
  ds_read_b128 v[76:79], v4 offset:32256
  s_waitcnt lgkmcnt(7)
  v_mfma_f32_16x16x32_bf16 a[28:31], v[16:19], v[48:51], a[28:31]
  s_waitcnt lgkmcnt(6)
  v_mfma_f32_16x16x32_bf16 a[60:63], v[20:23], v[52:55], a[60:63]
  s_waitcnt lgkmcnt(5)
  v_mfma_f32_16x16x32_bf16 a[92:95], v[24:27], v[56:59], a[92:95]
  s_waitcnt lgkmcnt(4)
  v_mfma_f32_16x16x32_bf16 a[124:127], v[28:31], v[60:63], a[124:127]
  s_waitcnt lgkmcnt(3)
  v_mfma_f32_16x16x32_bf16 a[156:159], v[32:35], v[64:67], a[156:159]
  s_waitcnt lgkmcnt(2)
  v_mfma_f32_16x16x32_bf16 a[188:191], v[36:39], v[68:71], a[188:191]
  s_waitcnt lgkmcnt(1)
  v_mfma_f32_16x16x32_bf16 a[220:223], v[40:43], v[72:75], a[220:223]
  s_waitcnt lgkmcnt(0)
  v_mfma_f32_16x16x32_bf16 a[252:255], v[44:47], v[76:79], a[252:255]
  v_add_u32 v104, 64, v104
  v_add_u32 v105, 64, v105
  v_add_u32 v106, 64, v106
  v_add_u32 v107, 64, v107
  v_add_u32 v108, 64, v108
  v_add_u32 v109, 64, v109
  v_add_u32 v110, 64, v110
  v_add_u32 v111, 64, v111
  v_add_u32 v4, 64, v4
  v_add_u32 v8, 64, v8
  s_add_u32 s40, s40, 0x8000
  s_waitcnt vmcnt(0)
  s_mov_b64 exec, 1
  buffer_store_dword v13, v1, s[8:11], s39 offen sc1
  s_mov_b64 exec, -1
  s_add_u32 s32, s32, 1
  s_and_b32 s6, s32, 7
  s_cbranch_scc1 L_c_conv1
L_c_conv2:
  s_add_u32 s33, s32, 1
  s_and_b32 s6, s32, 7
  s_lshl_b32 s7, s6, 10
  s_add_u32 s7, s7, s35
  v_add_u32 v9, s7, v10
  s_lshl_b32 s6, s6, 1
  s_lshl_b32 s42, 0x30003, s6
  v_mov_b32 v13, s33
  ds_read_b128 v[48:51], v4 offset:2560
  ds_read_b128 v[52:55], v4 offset:7168
  ds_read_b128 v[56:59], v4 offset:11776
  ds_read_b128 v[60:63], v4 offset:16384
  ds_read_b128 v[64:67], v4 offset:20992
  ds_read_b128 v[68:71], v4 offset:25600
  ds_read_b128 v[72:75], v4 offset:30208
  ds_read_b128 v[76:79], v4 offset:34816
  s_mov_b32 s7, 0
L_lw_61:
  ds_read_b32 v88, v2 offset:0
  s_waitcnt lgkmcnt(0)
  v_cmp_gt_i32 vcc, s33, v88
  s_cbranch_vccz L_lwo_62
  s_add_u32 s7, s7, 1
  s_cmp_lt_u32 s7, 131072
  s_cbranch_scc1 L_lw_61
  s_mov_b32 s6, 42
  s_branch L_err
L_lwo_62:
  ds_read2_b32 v[112:113], v104 offset0:0 offset1:1
  ds_read2_b32 v[114:115], v104 offset0:2 offset1:3
  ds_read_b32 v116, v104 offset:16
  ds_read2_b32 v[118:119], v105 offset0:0 offset1:1
  ds_read2_b32 v[120:121], v105 offset0:2 offset1:3
  ds_read_b32 v122, v105 offset:16
  ds_read2_b32 v[124:125], v106 offset0:0 offset1:1
  ds_read2_b32 v[126:127], v106 offset0:2 offset1:3
  ds_read_b32 v128, v106 offset:16
  ds_read2_b32 v[130:131], v107 offset0:0 offset1:1
  ds_read2_b32 v[132:133], v107 offset0:2 offset1:3
  ds_read_b32 v134, v107 offset:16
  s_waitcnt lgkmcnt(9)
  v_alignbyte_b32 v16, v113, v112, v15
  v_alignbyte_b32 v17, v114, v113, v15
  v_alignbyte_b32 v18, v115, v114, v15
  v_alignbyte_b32 v19, v116, v115, v15
  ds_read2_b32 v[112:113], v108 offset0:0 offset1:1
  ds_read2_b32 v[114:115], v108 offset0:2 offset1:3
  ds_read_b32 v116, v108 offset:16
  s_waitcnt lgkmcnt(9)
  v_alignbyte_b32 v20, v119, v118, v15
  v_alignbyte_b32 v21, v120, v119, v15
  v_alignbyte_b32 v22, v121, v120, v15
  v_alignbyte_b32 v23, v122, v121, v15
  ds_read2_b32 v[118:119], v109 offset0:0 offset1:1
  ds_read2_b32 v[120:121], v109 offset0:2 offset1:3
  ds_read_b32 v122, v109 offset:16
  v_mfma_f32_16x16x32_bf16 a[8:11], v[16:19], v[48:51], a[8:11]
  s_waitcnt lgkmcnt(9)
  v_alignbyte_b32 v24, v125, v124, v15
  v_alignbyte_b32 v25, v126, v125, v15
  v_alignbyte_b32 v26, v127, v126, v15
  v_alignbyte_b32 v27, v128, v127, v15
  ds_read2_b32 v[124:125], v110 offset0:0 offset1:1
  ds_read2_b32 v[126:127], v110 offset0:2 offset1:3
  ds_read_b32 v128, v110 offset:16
  v_mfma_f32_16x16x32_bf16 a[40:43], v[20:23], v[52:55], a[40:43]
  s_waitcnt lgkmcnt(9)
  v_alignbyte_b32 v28, v131, v130, v15
  v_alignbyte_b32 v29, v132, v131, v15
  v_alignbyte_b32 v30, v133, v132, v15
  v_alignbyte_b32 v31, v134, v133, v15
  ds_read2_b32 v[130:131], v111 offset0:0 offset1:1
  ds_read2_b32 v[132:133], v111 offset0:2 offset1:3
  ds_read_b32 v134, v111 offset:16
  v_mfma_f32_16x16x32_bf16 a[72:75], v[24:27], v[56:59], a[72:75]
  s_waitcnt lgkmcnt(9)
  v_alignbyte_b32 v32, v113, v112, v15
  v_alignbyte_b32 v33, v114, v113, v15
  v_alignbyte_b32 v34, v115, v114, v15
  v_alignbyte_b32 v35, v116, v115, v15
  ds_read_b64 v[84:85], v8
  ds_read_b64 v[86:87], v9
  v_mfma_f32_16x16x32_bf16 a[104:107], v[28:31], v[60:63], a[104:107]
  s_waitcnt lgkmcnt(8)
  v_alignbyte_b32 v36, v119, v118, v15
  v_alignbyte_b32 v37, v120, v119, v15
  v_alignbyte_b32 v38, v121, v120, v15
  v_alignbyte_b32 v39, v122, v121, v15
  v_mfma_f32_16x16x32_bf16 a[136:139], v[32:35], v[64:67], a[136:139]
  s_waitcnt lgkmcnt(5)
  v_alignbyte_b32 v40, v125, v124, v15
  v_alignbyte_b32 v41, v126, v125, v15
  v_alignbyte_b32 v42, v127, v126, v15
  v_alignbyte_b32 v43, v128, v127, v15
  v_mfma_f32_16x16x32_bf16 a[168:171], v[36:39], v[68:71], a[168:171]
  s_waitcnt lgkmcnt(2)
  v_alignbyte_b32 v44, v131, v130, v15
  v_alignbyte_b32 v45, v132, v131, v15
  v_alignbyte_b32 v46, v133, v132, v15
  v_alignbyte_b32 v47, v134, v133, v15
  v_mfma_f32_16x16x32_bf16 a[200:203], v[40:43], v[72:75], a[200:203]
  s_nop 0
  v_mfma_f32_16x16x32_bf16 a[232:235], v[44:47], v[76:79], a[232:235]
  s_waitcnt lgkmcnt(0)
  ds_read_b128 v[48:51], v4 offset:2048
  ds_read_b128 v[52:55], v4 offset:6656
  ds_read_b128 v[56:59], v4 offset:11264
  ds_read_b128 v[60:63], v4 offset:15872
  ds_read_b128 v[64:67], v4 offset:20480
  ds_read_b128 v[68:71], v4 offset:25088
  ds_read_b128 v[72:75], v4 offset:29696
  ds_read_b128 v[76:79], v4 offset:34304
  s_mov_b32 exec_lo, s42
  s_mov_b32 exec_hi, s42
  ds_write_b128 v6, a[8:11] offset:0
  ds_write_b128 v6, a[40:43] offset:128
  ds_write_b128 v6, a[72:75] offset:256
  ds_write_b128 v6, a[104:107] offset:384
  ds_write_b128 v6, a[136:139] offset:512
  ds_write_b128 v6, a[168:171] offset:640
  ds_write_b128 v6, a[200:203] offset:768
  ds_write_b128 v6, a[232:235] offset:896
  s_mov_b64 exec, -1
  ds_read_b128 v[80:83], v7
  ds_write_b32 v14, v13 offset:8
  v_lshlrev_b32 v88, 16, v84
  v_and_b32 v89, 0xffff0000, v84
  v_lshlrev_b32 v90, 16, v85
  v_and_b32 v91, 0xffff0000, v85
  v_lshlrev_b32 v96, 16, v86
  v_and_b32 v97, 0xffff0000, v86
  v_lshlrev_b32 v98, 16, v87
  v_and_b32 v99, 0xffff0000, v87
  v_mul_f32 v92, v88, v12
  v_mul_f32 v93, v89, v12
  v_mul_f32 v94, v90, v12
  v_mul_f32 v95, v91, v12
  v_cvt_pk_bf16_f32 v84, v92, v93
  v_cvt_pk_bf16_f32 v85, v94, v95
  v_lshlrev_b32 v92, 16, v84
  v_and_b32 v93, 0xffff0000, v84
  v_lshlrev_b32 v94, 16, v85
  v_and_b32 v95, 0xffff0000, v85
  s_waitcnt lgkmcnt(1)
  v_fmac_f32 v80, v88, v11
  v_fmac_f32 v81, v89, v11
  v_fmac_f32 v82, v90, v11
  v_fmac_f32 v83, v91, v11
  v_cvt_pk_bf16_f32 v84, v80, v81
  v_cvt_pk_bf16_f32 v85, v82, v83
  v_lshlrev_b32 v80, 16, v84
  v_and_b32 v81, 0xffff0000, v84
  v_lshlrev_b32 v82, 16, v85
  v_and_b32 v83, 0xffff0000, v85
  v_add_f32 v80, v80, v92
  v_add_f32 v81, v81, v93
  v_add_f32 v82, v82, v94
  v_add_f32 v83, v83, v95
  v_cvt_pk_bf16_f32 v84, v80, v81
  v_cvt_pk_bf16_f32 v85, v82, v83
  v_lshlrev_b32 v80, 16, v84
  v_and_b32 v81, 0xffff0000, v84
  v_lshlrev_b32 v82, 16, v85
  v_and_b32 v83, 0xffff0000, v85
  v_add_f32 v80, v80, v96
  v_add_f32 v81, v81, v97
  v_add_f32 v82, v82, v98
  v_add_f32 v83, v83, v99
  v_cvt_pk_bf16_f32 v84, v80, v81
  v_cvt_pk_bf16_f32 v85, v82, v83
  buffer_store_dwordx2 v[84:85], v10, s[8:11], s40 offen sc1
  v_mfma_f32_16x16x32_bf16 a[12:15], v[16:19], v[48:51], a[12:15]
  ds_read_b128 v[48:51], v4 offset:1536
  v_mfma_f32_16x16x32_bf16 a[44:47], v[20:23], v[52:55], a[44:47]
  ds_read_b128 v[52:55], v4 offset:6144
  v_mfma_f32_16x16x32_bf16 a[76:79], v[24:27], v[56:59], a[76:79]
  ds_read_b128 v[56:59], v4 offset:10752
  v_mfma_f32_16x16x32_bf16 a[108:111], v[28:31], v[60:63], a[108:111]
  ds_read_b128 v[60:63], v4 offset:15360
  v_mfma_f32_16x16x32_bf16 a[140:143], v[32:35], v[64:67], a[140:143]
  ds_read_b128 v[64:67], v4 offset:19968
  v_mfma_f32_16x16x32_bf16 a[172:175], v[36:39], v[68:71], a[172:175]
  ds_read_b128 v[68:71], v4 offset:24576
  v_mfma_f32_16x16x32_bf16 a[204:207], v[40:43], v[72:75], a[204:207]
  ds_read_b128 v[72:75], v4 offset:29184
  v_mfma_f32_16x16x32_bf16 a[236:239], v[44:47], v[76:79], a[236:239]
  ds_read_b128 v[76:79], v4 offset:33792
  s_waitcnt lgkmcnt(7)
  v_mfma_f32_16x16x32_bf16 a[16:19], v[16:19], v[48:51], a[16:19]
  ds_read_b128 v[48:51], v4 offset:1024
  s_waitcnt lgkmcnt(7)
  v_mfma_f32_16x16x32_bf16 a[48:51], v[20:23], v[52:55], a[48:51]
  ds_read_b128 v[52:55], v4 offset:5632
  s_waitcnt lgkmcnt(7)
  v_mfma_f32_16x16x32_bf16 a[80:83], v[24:27], v[56:59], a[80:83]
  ds_read_b128 v[56:59], v4 offset:10240
  s_waitcnt lgkmcnt(7)
  v_mfma_f32_16x16x32_bf16 a[112:115], v[28:31], v[60:63], a[112:115]
  ds_read_b128 v[60:63], v4 offset:14848
  s_waitcnt lgkmcnt(7)
  v_mfma_f32_16x16x32_bf16 a[144:147], v[32:35], v[64:67], a[144:147]
  ds_read_b128 v[64:67], v4 offset:19456
  s_waitcnt lgkmcnt(7)
  v_mfma_f32_16x16x32_bf16 a[176:179], v[36:39], v[68:71], a[176:179]
  ds_read_b128 v[68:71], v4 offset:24064
  s_waitcnt lgkmcnt(7)
  v_mfma_f32_16x16x32_bf16 a[208:211], v[40:43], v[72:75], a[208:211]
  ds_read_b128 v[72:75], v4 offset:28672
  s_waitcnt lgkmcnt(7)
  v_mfma_f32_16x16x32_bf16 a[240:243], v[44:47], v[76:79], a[240:243]
  ds_read_b128 v[76:79], v4 offset:33280
  s_waitcnt lgkmcnt(7)
  v_mfma_f32_16x16x32_bf16 a[20:23], v[16:19], v[48:51], a[20:23]
  ds_read_b128 v[48:51], v4 offset:512
  s_waitcnt lgkmcnt(7)
  v_mfma_f32_16x16x32_bf16 a[52:55], v[20:23], v[52:55], a[52:55]
  ds_read_b128 v[52:55], v4 offset:5120
  s_waitcnt lgkmcnt(7)
  v_mfma_f32_16x16x32_bf16 a[84:87], v[24:27], v[56:59], a[84:87]
  ds_read_b128 v[56:59], v4 offset:9728
  s_waitcnt lgkmcnt(7)
  v_mfma_f32_16x16x32_bf16 a[116:119], v[28:31], v[60:63], a[116:119]
  ds_read_b128 v[60:63], v4 offset:14336
  s_waitcnt lgkmcnt(7)
  v_mfma_f32_16x16x32_bf16 a[148:151], v[32:35], v[64:67], a[148:151]
  ds_read_b128 v[64:67], v4 offset:18944
  s_waitcnt lgkmcnt(7)
  v_mfma_f32_16x16x32_bf16 a[180:183], v[36:39], v[68:71], a[180:183]
  ds_read_b128 v[68:71], v4 offset:23552
  s_waitcnt lgkmcnt(7)
  v_mfma_f32_16x16x32_bf16 a[212:215], v[40:43], v[72:75], a[212:215]
  ds_read_b128 v[72:75], v4 offset:28160
  s_waitcnt lgkmcnt(7)
  v_mfma_f32_16x16x32_bf16 a[244:247], v[44:47], v[76:79], a[244:247]
  ds_read_b128 v[76:79], v4 offset:32768
  s_waitcnt lgkmcnt(7)
  v_mfma_f32_16x16x32_bf16 a[24:27], v[16:19], v[48:51], a[24:27]
  ds_read_b128 v[48:51], v4 offset:0
  s_waitcnt lgkmcnt(7)
  v_mfma_f32_16x16x32_bf16 a[56:59], v[20:23], v[52:55], a[56:59]
  ds_read_b128 v[52:55], v4 offset:4608
  s_waitcnt lgkmcnt(7)
  v_mfma_f32_16x16x32_bf16 a[88:91], v[24:27], v[56:59], a[88:91]
  ds_read_b128 v[56:59], v4 offset:9216
  s_waitcnt lgkmcnt(7)
  v_mfma_f32_16x16x32_bf16 a[120:123], v[28:31], v[60:63], a[120:123]
  ds_read_b128 v[60:63], v4 offset:13824
  s_waitcnt lgkmcnt(7)
  v_mfma_f32_16x16x32_bf16 a[152:155], v[32:35], v[64:67], a[152:155]
  ds_read_b128 v[64:67], v4 offset:18432
  s_waitcnt lgkmcnt(7)
  v_mfma_f32_16x16x32_bf16 a[184:187], v[36:39], v[68:71], a[184:187]
  ds_read_b128 v[68:71], v4 offset:23040
  s_waitcnt lgkmcnt(7)
  v_mfma_f32_16x16x32_bf16 a[216:219], v[40:43], v[72:75], a[216:219]
  ds_read_b128 v[72:75], v4 offset:27648
  s_waitcnt lgkmcnt(7)
  v_mfma_f32_16x16x32_bf16 a[248:251], v[44:47], v[76:79], a[248:251]
  ds_read_b128 v[76:79], v4 offset:32256
  s_waitcnt lgkmcnt(7)
  v_mfma_f32_16x16x32_bf16 a[28:31], v[16:19], v[48:51], a[28:31]
  s_waitcnt lgkmcnt(6)
  v_mfma_f32_16x16x32_bf16 a[60:63], v[20:23], v[52:55], a[60:63]
  s_waitcnt lgkmcnt(5)
  v_mfma_f32_16x16x32_bf16 a[92:95], v[24:27], v[56:59], a[92:95]
  s_waitcnt lgkmcnt(4)
  v_mfma_f32_16x16x32_bf16 a[124:127], v[28:31], v[60:63], a[124:127]
  s_waitcnt lgkmcnt(3)
  v_mfma_f32_16x16x32_bf16 a[156:159], v[32:35], v[64:67], a[156:159]
  s_waitcnt lgkmcnt(2)
  v_mfma_f32_16x16x32_bf16 a[188:191], v[36:39], v[68:71], a[188:191]
  s_waitcnt lgkmcnt(1)
  v_mfma_f32_16x16x32_bf16 a[220:223], v[40:43], v[72:75], a[220:223]
  s_waitcnt lgkmcnt(0)
  v_mfma_f32_16x16x32_bf16 a[252:255], v[44:47], v[76:79], a[252:255]
  v_add_u32 v104, 64, v104
  v_add_u32 v105, 64, v105
  v_add_u32 v106, 64, v106
  v_add_u32 v107, 64, v107
  v_add_u32 v108, 64, v108
  v_add_u32 v109, 64, v109
  v_add_u32 v110, 64, v110
  v_add_u32 v111, 64, v111
  v_add_u32 v4, 64, v4
  v_add_u32 v8, 64, v8
  s_add_u32 s40, s40, 0x8000
  s_waitcnt vmcnt(0)
  s_mov_b64 exec, 1
  buffer_store_dword v13, v1, s[8:11], s39 offen sc1
  s_mov_b64 exec, -1
  s_add_u32 s32, s32, 1
  s_and_b32 s6, s32, 7
  s_cbranch_scc1 L_c_conv2
L_c_conv3:
  s_add_u32 s33, s32, 1
  s_and_b32 s6, s32, 7
  s_lshl_b32 s7, s6, 10
  s_add_u32 s7, s7, s35
  v_add_u32 v9, s7, v10
  s_lshl_b32 s6, s6, 1
  s_lshl_b32 s42, 0x30003, s6
  v_mov_b32 v13, s33
  ds_read_b128 v[48:51], v4 offset:2048
  ds_read_b128 v[52:55], v4 offset:6656
  ds_read_b128 v[56:59], v4 offset:11264
  ds_read_b128 v[60:63], v4 offset:15872
  ds_read_b128 v[64:67], v4 offset:20480
  ds_read_b128 v[68:71], v4 offset:25088
  ds_read_b128 v[72:75], v4 offset:29696
  ds_read_b128 v[76:79], v4 offset:34304
  s_mov_b32 s7, 0
L_lw_63:
  ds_read_b32 v88, v2 offset:0
  s_waitcnt lgkmcnt(0)
  v_cmp_gt_i32 vcc, s33, v88
  s_cbranch_vccz L_lwo_64
  s_add_u32 s7, s7, 1
  s_cmp_lt_u32 s7, 131072
  s_cbranch_scc1 L_lw_63
  s_mov_b32 s6, 42
  s_branch L_err
L_lwo_64:
  ds_read2_b32 v[112:113], v104 offset0:0 offset1:1
  ds_read2_b32 v[114:115], v104 offset0:2 offset1:3
  ds_read_b32 v116, v104 offset:16
  ds_read2_b32 v[118:119], v105 offset0:0 offset1:1
  ds_read2_b32 v[120:121], v105 offset0:2 offset1:3
  ds_read_b32 v122, v105 offset:16
  ds_read2_b32 v[124:125], v106 offset0:0 offset1:1
  ds_read2_b32 v[126:127], v106 offset0:2 offset1:3
  ds_read_b32 v128, v106 offset:16
  ds_read2_b32 v[130:131], v107 offset0:0 offset1:1
  ds_read2_b32 v[132:133], v107 offset0:2 offset1:3
  ds_read_b32 v134, v107 offset:16
  s_waitcnt lgkmcnt(9)
  v_alignbyte_b32 v16, v113, v112, v15
  v_alignbyte_b32 v17, v114, v113, v15
  v_alignbyte_b32 v18, v115, v114, v15
  v_alignbyte_b32 v19, v116, v115, v15
  ds_read2_b32 v[112:113], v108 offset0:0 offset1:1
  ds_read2_b32 v[114:115], v108 offset0:2 offset1:3
  ds_read_b32 v116, v108 offset:16
  s_waitcnt lgkmcnt(9)
  v_alignbyte_b32 v20, v119, v118, v15
  v_alignbyte_b32 v21, v120, v119, v15
  v_alignbyte_b32 v22, v121, v120, v15
  v_alignbyte_b32 v23, v122, v121, v15
  ds_read2_b32 v[118:119], v109 offset0:0 offset1:1
  ds_read2_b32 v[120:121], v109 offset0:2 offset1:3
  ds_read_b32 v122, v109 offset:16
  v_mfma_f32_16x16x32_bf16 a[12:15], v[16:19], v[48:51], a[12:15]
  s_waitcnt lgkmcnt(9)
  v_alignbyte_b32 v24, v125, v124, v15
  v_alignbyte_b32 v25, v126, v125, v15
  v_alignbyte_b32 v26, v127, v126, v15
  v_alignbyte_b32 v27, v128, v127, v15
  ds_read2_b32 v[124:125], v110 offset0:0 offset1:1
  ds_read2_b32 v[126:127], v110 offset0:2 offset1:3
  ds_read_b32 v128, v110 offset:16
  v_mfma_f32_16x16x32_bf16 a[44:47], v[20:23], v[52:55], a[44:47]
  s_waitcnt lgkmcnt(9)
  v_alignbyte_b32 v28, v131, v130, v15
  v_alignbyte_b32 v29, v132, v131, v15
  v_alignbyte_b32 v30, v133, v132, v15
  v_alignbyte_b32 v31, v134, v133, v15
  ds_read2_b32 v[130:131], v111 offset0:0 offset1:1
  ds_read2_b32 v[132:133], v111 offset0:2 offset1:3
  ds_read_b32 v134, v111 offset:16
  v_mfma_f32_16x16x32_bf16 a[76:79], v[24:27], v[56:59], a[76:79]
  s_waitcnt lgkmcnt(9)
  v_alignbyte_b32 v32, v113, v112, v15
  v_alignbyte_b32 v33, v114, v113, v15
  v_alignbyte_b32 v34, v115, v114, v15
  v_alignbyte_b32 v35, v116, v115, v15
  ds_read_b64 v[84:85], v8
  ds_read_b64 v[86:87], v9
  v_mfma_f32_16x16x32_bf16 a[108:111], v[28:31], v[60:63], a[108:111]
  s_waitcnt lgkmcnt(8)
  v_alignbyte_b32 v36, v119, v118, v15
  v_alignbyte_b32 v37, v120, v119, v15
  v_alignbyte_b32 v38, v121, v120, v15
  v_alignbyte_b32 v39, v122, v121, v15
  v_mfma_f32_16x16x32_bf16 a[140:143], v[32:35], v[64:67], a[140:143]
  s_waitcnt lgkmcnt(5)
  v_alignbyte_b32 v40, v125, v124, v15
  v_alignbyte_b32 v41, v126, v125, v15
  v_alignbyte_b32 v42, v127, v126, v15
  v_alignbyte_b32 v43, v128, v127, v15
  v_mfma_f32_16x16x32_bf16 a[172:175], v[36:39], v[68:71], a[172:175]
  s_waitcnt lgkmcnt(2)
  v_alignbyte_b32 v44, v131, v130, v15
  v_alignbyte_b32 v45, v132, v131, v15
  v_alignbyte_b32 v46, v133, v132, v15
  v_alignbyte_b32 v47, v134, v133, v15
  v_mfma_f32_16x16x32_bf16 a[204:207], v[40:43], v[72:75], a[204:207]
  s_nop 0
  v_mfma_f32_16x16x32_bf16 a[236:239], v[44:47], v[76:79], a[236:239]
  s_waitcnt lgkmcnt(0)
  ds_read_b128 v[48:51], v4 offset:1536
  ds_read_b128 v[52:55], v4 offset:6144
  ds_read_b128 v[56:59], v4 offset:10752
  ds_read_b128 v[60:63], v4 offset:15360
  ds_read_b128 v[64:67], v4 offset:19968
  ds_read_b128 v[68:71], v4 offset:24576
  ds_read_b128 v[72:75], v4 offset:29184
  ds_read_b128 v[76:79], v4 offset:33792
  s_mov_b32 exec_lo, s42
  s_mov_b32 exec_hi, s42
  ds_write_b128 v6, a[12:15] offset:0
  ds_write_b128 v6, a[44:47] offset:128
  ds_write_b128 v6, a[76:79] offset:256
  ds_write_b128 v6, a[108:111] offset:384
  ds_write_b128 v6, a[140:143] offset:512
  ds_write_b128 v6, a[172:175] offset:640
  ds_write_b128 v6, a[204:207] offset:768
  ds_write_b128 v6, a[236:239] offset:896
  s_mov_b64 exec, -1
  ds_read_b128 v[80:83], v7
  ds_write_b32 v14, v13 offset:8
  v_lshlrev_b32 v88, 16, v84
  v_and_b32 v89, 0xffff0000, v84
  v_lshlrev_b32 v90, 16, v85
  v_and_b32 v91, 0xffff0000, v85
  v_lshlrev_b32 v96, 16, v86
  v_and_b32 v97, 0xffff0000, v86
  v_lshlrev_b32 v98, 16, v87
  v_and_b32 v99, 0xffff0000, v87
  v_mul_f32 v92, v88, v12
  v_mul_f32 v93, v89, v12
  v_mul_f32 v94, v90, v12
  v_mul_f32 v95, v91, v12
  v_cvt_pk_bf16_f32 v84, v92, v93
  v_cvt_pk_bf16_f32 v85, v94, v95
  v_lshlrev_b32 v92, 16, v84
  v_and_b32 v93, 0xffff0000, v84
  v_lshlrev_b32 v94, 16, v85
  v_and_b32 v95, 0xffff0000, v85
  s_waitcnt lgkmcnt(1)
  v_fmac_f32 v80, v88, v11
  v_fmac_f32 v81, v89, v11
  v_fmac_f32 v82, v90, v11
  v_fmac_f32 v83, v91, v11
  v_cvt_pk_bf16_f32 v84, v80, v81
  v_cvt_pk_bf16_f32 v85, v82, v83
  v_lshlrev_b32 v80, 16, v84
  v_and_b32 v81, 0xffff0000, v84
  v_lshlrev_b32 v82, 16, v85
  v_and_b32 v83, 0xffff0000, v85
  v_add_f32 v80, v80, v92
  v_add_f32 v81, v81, v93
  v_add_f32 v82, v82, v94
  v_add_f32 v83, v83, v95
  v_cvt_pk_bf16_f32 v84, v80, v81
  v_cvt_pk_bf16_f32 v85, v82, v83
  v_lshlrev_b32 v80, 16, v84
  v_and_b32 v81, 0xffff0000, v84
  v_lshlrev_b32 v82, 16, v85
  v_and_b32 v83, 0xffff0000, v85
  v_add_f32 v80, v80, v96
  v_add_f32 v81, v81, v97
  v_add_f32 v82, v82, v98
  v_add_f32 v83, v83, v99
  v_cvt_pk_bf16_f32 v84, v80, v81
  v_cvt_pk_bf16_f32 v85, v82, v83
  buffer_store_dwordx2 v[84:85], v10, s[8:11], s40 offen sc1
  v_mfma_f32_16x16x32_bf16 a[16:19], v[16:19], v[48:51], a[16:19]
  ds_read_b128 v[48:51], v4 offset:1024
  v_mfma_f32_16x16x32_bf16 a[48:51], v[20:23], v[52:55], a[48:51]
  ds_read_b128 v[52:55], v4 offset:5632
  v_mfma_f32_16x16x32_bf16 a[80:83], v[24:27], v[56:59], a[80:83]
  ds_read_b128 v[56:59], v4 offset:10240
  v_mfma_f32_16x16x32_bf16 a[112:115], v[28:31], v[60:63], a[112:115]
  ds_read_b128 v[60:63], v4 offset:14848
  v_mfma_f32_16x16x32_bf16 a[144:147], v[32:35], v[64:67], a[144:147]
  ds_read_b128 v[64:67], v4 offset:19456
  v_mfma_f32_16x16x32_bf16 a[176:179], v[36:39], v[68:71], a[176:179]
  ds_read_b128 v[68:71], v4 offset:24064
  v_mfma_f32_16x16x32_bf16 a[208:211], v[40:43], v[72:75], a[208:211]
  ds_read_b128 v[72:75], v4 offset:28672
  v_mfma_f32_16x16x32_bf16 a[240:243], v[44:47], v[76:79], a[240:243]
  ds_read_b128 v[76:79], v4 offset:33280
  s_waitcnt lgkmcnt(7)
  v_mfma_f32_16x16x32_bf16 a[20:23], v[16:19], v[48:51], a[20:23]
  ds_read_b128 v[48:51], v4 offset:512
  s_waitcnt lgkmcnt(7)
  v_mfma_f32_16x16x32_bf16 a[52:55], v[20:23], v[52:55], a[52:55]
  ds_read_b128 v[52:55], v4 offset:5120
  s_waitcnt lgkmcnt(7)
  v_mfma_f32_16x16x32_bf16 a[84:87], v[24:27], v[56:59], a[84:87]
  ds_read_b128 v[56:59], v4 offset:9728
  s_waitcnt lgkmcnt(7)
  v_mfma_f32_16x16x32_bf16 a[116:119], v[28:31], v[60:63], a[116:119]
  ds_read_b128 v[60:63], v4 offset:14336
  s_waitcnt lgkmcnt(7)
  v_mfma_f32_16x16x32_bf16 a[148:151], v[32:35], v[64:67], a[148:151]
  ds_read_b128 v[64:67], v4 offset:18944
  s_waitcnt lgkmcnt(7)
  v_mfma_f32_16x16x32_bf16 a[180:183], v[36:39], v[68:71], a[180:183]
  ds_read_b128 v[68:71], v4 offset:23552
  s_waitcnt lgkmcnt(7)
  v_mfma_f32_16x16x32_bf16 a[212:215], v[40:43], v[72:75], a[212:215]
  ds_read_b128 v[72:75], v4 offset:28160
  s_waitcnt lgkmcnt(7)
  v_mfma_f32_16x16x32_bf16 a[244:247], v[44:47], v[76:79], a[244:247]
  ds_read_b128 v[76:79], v4 offset:32768
  s_waitcnt lgkmcnt(7)
  v_mfma_f32_16x16x32_bf16 a[24:27], v[16:19], v[48:51], a[24:27]
  ds_read_b128 v[48:51], v4 offset:0
  s_waitcnt lgkmcnt(7)
  v_mfma_f32_16x16x32_bf16 a[56:59], v[20:23], v[52:55], a[56:59]
  ds_read_b128 v[52:55], v4 offset:4608
  s_waitcnt lgkmcnt(7)
  v_mfma_f32_16x16x32_bf16 a[88:91], v[24:27], v[56:59], a[88:91]
  ds_read_b128 v[56:59], v4 offset:9216
  s_waitcnt lgkmcnt(7)
  v_mfma_f32_16x16x32_bf16 a[120:123], v[28:31], v[60:63], a[120:123]
  ds_read_b128 v[60:63], v4 offset:13824
  s_waitcnt lgkmcnt(7)
  v_mfma_f32_16x16x32_bf16 a[152:155], v[32:35], v[64:67], a[152:155]
  ds_read_b128 v[64:67], v4 offset:18432
  s_waitcnt lgkmcnt(7)
  v_mfma_f32_16x16x32_bf16 a[184:187], v[36:39], v[68:71], a[184:187]
  ds_read_b128 v[68:71], v4 offset:23040
  s_waitcnt lgkmcnt(7)
  v_mfma_f32_16x16x32_bf16 a[216:219], v[40:43], v[72:75], a[216:219]
  ds_read_b128 v[72:75], v4 offset:27648
  s_waitcnt lgkmcnt(7)
  v_mfma_f32_16x16x32_bf16 a[248:251], v[44:47], v[76:79], a[248:251]
  ds_read_b128 v[76:79], v4 offset:32256
  s_waitcnt lgkmcnt(7)
  v_mfma_f32_16x16x32_bf16 a[28:31], v[16:19], v[48:51], a[28:31]
  s_waitcnt lgkmcnt(6)
  v_mfma_f32_16x16x32_bf16 a[60:63], v[20:23], v[52:55], a[60:63]
  s_waitcnt lgkmcnt(5)
  v_mfma_f32_16x16x32_bf16 a[92:95], v[24:27], v[56:59], a[92:95]
  s_waitcnt lgkmcnt(4)
  v_mfma_f32_16x16x32_bf16 a[124:127], v[28:31], v[60:63], a[124:127]
  s_waitcnt lgkmcnt(3)
  v_mfma_f32_16x16x32_bf16 a[156:159], v[32:35], v[64:67], a[156:159]
  s_waitcnt lgkmcnt(2)
  v_mfma_f32_16x16x32_bf16 a[188:191], v[36:39], v[68:71], a[188:191]
  s_waitcnt lgkmcnt(1)
  v_mfma_f32_16x16x32_bf16 a[220:223], v[40:43], v[72:75], a[220:223]
  s_waitcnt lgkmcnt(0)
  v_mfma_f32_16x16x32_bf16 a[252:255], v[44:47], v[76:79], a[252:255]
  v_add_u32 v104, 64, v104
  v_add_u32 v105, 64, v105
  v_add_u32 v106, 64, v106
  v_add_u32 v107, 64, v107
  v_add_u32 v108, 64, v108
  v_add_u32 v109, 64, v109
  v_add_u32 v110, 64, v110
  v_add_u32 v111, 64, v111
  v_add_u32 v4, 64, v4
  v_add_u32 v8, 64, v8
  s_add_u32 s40, s40, 0x8000
  s_waitcnt vmcnt(0)
  s_mov_b64 exec, 1
  buffer_store_dword v13, v1, s[8:11], s39 offen sc1
  s_mov_b64 exec, -1
  s_add_u32 s32, s32, 1
  s_and_b32 s6, s32, 7
  s_cbranch_scc1 L_c_conv3
L_c_conv4:
  s_add_u32 s33, s32, 1
  s_and_b32 s6, s32, 7
  s_lshl_b32 s7, s6, 10
  s_add_u32 s7, s7, s35
  v_add_u32 v9, s7, v10
  s_lshl_b32 s6, s6, 1
  s_lshl_b32 s42, 0x30003, s6
  v_mov_b32 v13, s33
  ds_read_b128 v[48:51], v4 offset:1536
  ds_read_b128 v[52:55], v4 offset:6144
  ds_read_b128 v[56:59], v4 offset:10752
  ds_read_b128 v[60:63], v4 offset:15360
  ds_read_b128 v[64:67], v4 offset:19968
  ds_read_b128 v[68:71], v4 offset:24576
  ds_read_b128 v[72:75], v4 offset:29184
  ds_read_b128 v[76:79], v4 offset:33792
  s_mov_b32 s7, 0
L_lw_65:
  ds_read_b32 v88, v2 offset:0
  s_waitcnt lgkmcnt(0)
  v_cmp_gt_i32 vcc, s33, v88
  s_cbranch_vccz L_lwo_66
  s_add_u32 s7, s7, 1
  s_cmp_lt_u32 s7, 131072
  s_cbranch_scc1 L_lw_65
  s_mov_b32 s6, 42
  s_branch L_err
L_lwo_66:
  ds_read2_b32 v[112:113], v104 offset0:0 offset1:1
  ds_read2_b32 v[114:115], v104 offset0:2 offset1:3
  ds_read_b32 v116, v104 offset:16
  ds_read2_b32 v[118:119], v105 offset0:0 offset1:1
  ds_read2_b32 v[120:121], v105 offset0:2 offset1:3
  ds_read_b32 v122, v105 offset:16
  ds_read2_b32 v[124:125], v106 offset0:0 offset1:1
  ds_read2_b32 v[126:127], v106 offset0:2 offset1:3
  ds_read_b32 v128, v106 offset:16
  ds_read2_b32 v[130:131], v107 offset0:0 offset1:1
  ds_read2_b32 v[132:133], v107 offset0:2 offset1:3
  ds_read_b32 v134, v107 offset:16
  s_waitcnt lgkmcnt(9)
  v_alignbyte_b32 v16, v113, v112, v15
  v_alignbyte_b32 v17, v114, v113, v15
  v_alignbyte_b32 v18, v115, v114, v15
  v_alignbyte_b32 v19, v116, v115, v15
  ds_read2_b32 v[112:113], v108 offset0:0 offset1:1
  ds_read2_b32 v[114:115], v108 offset0:2 offset1:3
  ds_read_b32 v116, v108 offset:16
  s_waitcnt lgkmcnt(9)
  v_alignbyte_b32 v20, v119, v118, v15
  v_alignbyte_b32 v21, v120, v119, v15
  v_alignbyte_b32 v22, v121, v120, v15
  v_alignbyte_b32 v23, v122, v121, v15
  ds_read2_b32 v[118:119], v109 offset0:0 offset1:1
  ds_read2_b32 v[120:121], v109 offset0:2 offset1:3
  ds_read_b32 v122, v109 offset:16
  v_mfma_f32_16x16x32_bf16 a[16:19], v[16:19], v[48:51], a[16:19]
  s_waitcnt lgkmcnt(9)
  v_alignbyte_b32 v24, v125, v124, v15
  v_alignbyte_b32 v25, v126, v125, v15
  v_alignbyte_b32 v26, v127, v126, v15
  v_alignbyte_b32 v27, v128, v127, v15
  ds_read2_b32 v[124:125], v110 offset0:0 offset1:1
  ds_read2_b32 v[126:127], v110 offset0:2 offset1:3
  ds_read_b32 v128, v110 offset:16
  v_mfma_f32_16x16x32_bf16 a[48:51], v[20:23], v[52:55], a[48:51]
  s_waitcnt lgkmcnt(9)
  v_alignbyte_b32 v28, v131, v130, v15
  v_alignbyte_b32 v29, v132, v131, v15
  v_alignbyte_b32 v30, v133, v132, v15
  v_alignbyte_b32 v31, v134, v133, v15
  ds_read2_b32 v[130:131], v111 offset0:0 offset1:1
  ds_read2_b32 v[132:133], v111 offset0:2 offset1:3
  ds_read_b32 v134, v111 offset:16
  v_mfma_f32_16x16x32_bf16 a[80:83], v[24:27], v[56:59], a[80:83]
  s_waitcnt lgkmcnt(9)
  v_alignbyte_b32 v32, v113, v112, v15
  v_alignbyte_b32 v33, v114, v113, v15
  v_alignbyte_b32 v34, v115, v114, v15
  v_alignbyte_b32 v35, v116, v115, v15
  ds_read_b64 v[84:85], v8
  ds_read_b64 v[86:87], v9
  v_mfma_f32_16x16x32_bf16 a[112:115], v[28:31], v[60:63], a[112:115]
  s_waitcnt lgkmcnt(8)
  v_alignbyte_b32 v36, v119, v118, v15
  v_alignbyte_b32 v37, v120, v119, v15
  v_alignbyte_b32 v38, v121, v120, v15
  v_alignbyte_b32 v39, v122, v121, v15
  v_mfma_f32_16x16x32_bf16 a[144:147], v[32:35], v[64:67], a[144:147]
  s_waitcnt lgkmcnt(5)
  v_alignbyte_b32 v40, v125, v124, v15
  v_alignbyte_b32 v41, v126, v125, v15
  v_alignbyte_b32 v42, v127, v126, v15
  v_alignbyte_b32 v43, v128, v127, v15
  v_mfma_f32_16x16x32_bf16 a[176:179], v[36:39], v[68:71], a[176:179]
  s_waitcnt lgkmcnt(2)
  v_alignbyte_b32 v44, v131, v130, v15
  v_alignbyte_b32 v45, v132, v131, v15
  v_alignbyte_b32 v46, v133, v132, v15
  v_alignbyte_b32 v47, v134, v133, v15
  v_mfma_f32_16x16x32_bf16 a[208:211], v[40:43], v[72:75], a[208:211]
  s_nop 0
  v_mfma_f32_16x16x32_bf16 a[240:243], v[44:47], v[76:79], a[240:243]
  s_waitcnt lgkmcnt(0)
  ds_read_b128 v[48:51], v4 offset:1024
  ds_read_b128 v[52:55], v4 offset:5632
  ds_read_b128 v[56:59], v4 offset:10240
  ds_read_b128 v[60:63], v4 offset:14848
  ds_read_b128 v[64:67], v4 offset:19456
  ds_read_b128 v[68:71], v4 offset:24064
  ds_read_b128 v[72:75], v4 offset:28672
  ds_read_b128 v[76:79], v4 offset:33280
  s_mov_b32 exec_lo, s42
  s_mov_b32 exec_hi, s42
  ds_write_b128 v6, a[16:19] offset:0
  ds_write_b128 v6, a[48:51] offset:128
  ds_write_b128 v6, a[80:83] offset:256
  ds_write_b128 v6, a[112:115] offset:384
  ds_write_b128 v6, a[144:147] offset:512
  ds_write_b128 v6, a[176:179] offset:640
  ds_write_b128 v6, a[208:211] offset:768
  ds_write_b128 v6, a[240:243] offset:896
  s_mov_b64 exec, -1
  ds_read_b128 v[80:83], v7
  ds_write_b32 v14, v13 offset:8
  v_lshlrev_b32 v88, 16, v84
  v_and_b32 v89, 0xffff0000, v84
  v_lshlrev_b32 v90, 16, v85
  v_and_b32 v91, 0xffff0000, v85
  v_lshlrev_b32 v96, 16, v86
  v_and_b32 v97, 0xffff0000, v86
  v_lshlrev_b32 v98, 16, v87
  v_and_b32 v99, 0xffff0000, v87
  v_mul_f32 v92, v88, v12
  v_mul_f32 v93, v89, v12
  v_mul_f32 v94, v90, v12
  v_mul_f32 v95, v91, v12
  v_cvt_pk_bf16_f32 v84, v92, v93
  v_cvt_pk_bf16_f32 v85, v94, v95
  v_lshlrev_b32 v92, 16, v84
  v_and_b32 v93, 0xffff0000, v84
  v_lshlrev_b32 v94, 16, v85
  v_and_b32 v95, 0xffff0000, v85
  s_waitcnt lgkmcnt(1)
  v_fmac_f32 v80, v88, v11
  v_fmac_f32 v81, v89, v11
  v_fmac_f32 v82, v90, v11
  v_fmac_f32 v83, v91, v11
  v_cvt_pk_bf16_f32 v84, v80, v81
  v_cvt_pk_bf16_f32 v85, v82, v83
  v_lshlrev_b32 v80, 16, v84
  v_and_b32 v81, 0xffff0000, v84
  v_lshlrev_b32 v82, 16, v85
  v_and_b32 v83, 0xffff0000, v85
  v_add_f32 v80, v80, v92
  v_add_f32 v81, v81, v93
  v_add_f32 v82, v82, v94
  v_add_f32 v83, v83, v95
  v_cvt_pk_bf16_f32 v84, v80, v81
  v_cvt_pk_bf16_f32 v85, v82, v83
  v_lshlrev_b32 v80, 16, v84
  v_and_b32 v81, 0xffff0000, v84
  v_lshlrev_b32 v82, 16, v85
  v_and_b32 v83, 0xffff0000, v85
  v_add_f32 v80, v80, v96
  v_add_f32 v81, v81, v97
  v_add_f32 v82, v82, v98
  v_add_f32 v83, v83, v99
  v_cvt_pk_bf16_f32 v84, v80, v81
  v_cvt_pk_bf16_f32 v85, v82, v83
  buffer_store_dwordx2 v[84:85], v10, s[8:11], s40 offen sc1
  v_mfma_f32_16x16x32_bf16 a[20:23], v[16:19], v[48:51], a[20:23]
  ds_read_b128 v[48:51], v4 offset:512
  v_mfma_f32_16x16x32_bf16 a[52:55], v[20:23], v[52:55], a[52:55]
  ds_read_b128 v[52:55], v4 offset:5120
  v_mfma_f32_16x16x32_bf16 a[84:87], v[24:27], v[56:59], a[84:87]
  ds_read_b128 v[56:59], v4 offset:9728
  v_mfma_f32_16x16x32_bf16 a[116:119], v[28:31], v[60:63], a[116:119]
  ds_read_b128 v[60:63], v4 offset:14336
  v_mfma_f32_16x16x32_bf16 a[148:151], v[32:35], v[64:67], a[148:151]
  ds_read_b128 v[64:67], v4 offset:18944
  v_mfma_f32_16x16x32_bf16 a[180:183], v[36:39], v[68:71], a[180:183]
  ds_read_b128 v[68:71], v4 offset:23552
  v_mfma_f32_16x16x32_bf16 a[212:215], v[40:43], v[72:75], a[212:215]
  ds_read_b128 v[72:75], v4 offset:28160
  v_mfma_f32_16x16x32_bf16 a[244:247], v[44:47], v[76:79], a[244:247]
  ds_read_b128 v[76:79], v4 offset:32768
  s_waitcnt lgkmcnt(7)
  v_mfma_f32_16x16x32_bf16 a[24:27], v[16:19], v[48:51], a[24:27]
  ds_read_b128 v[48:51], v4 offset:0
  s_waitcnt lgkmcnt(7)
  v_mfma_f32_16x16x32_bf16 a[56:59], v[20:23], v[52:55], a[56:59]
  ds_read_b128 v[52:55], v4 offset:4608
  s_waitcnt lgkmcnt(7)
  v_mfma_f32_16x16x32_bf16 a[88:91], v[24:27], v[56:59], a[88:91]
  ds_read_b128 v[56:59], v4 offset:9216
  s_waitcnt lgkmcnt(7)
  v_mfma_f32_16x16x32_bf16 a[120:123], v[28:31], v[60:63], a[120:123]
  ds_read_b128 v[60:63], v4 offset:13824
  s_waitcnt lgkmcnt(7)
  v_mfma_f32_16x16x32_bf16 a[152:155], v[32:35], v[64:67], a[152:155]
  ds_read_b128 v[64:67], v4 offset:18432
  s_waitcnt lgkmcnt(7)
  v_mfma_f32_16x16x32_bf16 a[184:187], v[36:39], v[68:71], a[184:187]
  ds_read_b128 v[68:71], v4 offset:23040
  s_waitcnt lgkmcnt(7)
  v_mfma_f32_16x16x32_bf16 a[216:219], v[40:43], v[72:75], a[216:219]
  ds_read_b128 v[72:75], v4 offset:27648
  s_waitcnt lgkmcnt(7)
  v_mfma_f32_16x16x32_bf16 a[248:251], v[44:47], v[76:79], a[248:251]
  ds_read_b128 v[76:79], v4 offset:32256
  s_waitcnt lgkmcnt(7)
  v_mfma_f32_16x16x32_bf16 a[28:31], v[16:19], v[48:51], a[28:31]
  s_waitcnt lgkmcnt(6)
  v_mfma_f32_16x16x32_bf16 a[60:63], v[20:23], v[52:55], a[60:63]
  s_waitcnt lgkmcnt(5)
  v_mfma_f32_16x16x32_bf16 a[92:95], v[24:27], v[56:59], a[92:95]
  s_waitcnt lgkmcnt(4)
  v_mfma_f32_16x16x32_bf16 a[124:127], v[28:31], v[60:63], a[124:127]
  s_waitcnt lgkmcnt(3)
  v_mfma_f32_16x16x32_bf16 a[156:159], v[32:35], v[64:67], a[156:159]
  s_waitcnt lgkmcnt(2)
  v_mfma_f32_16x16x32_bf16 a[188:191], v[36:39], v[68:71], a[188:191]
  s_waitcnt lgkmcnt(1)
  v_mfma_f32_16x16x32_bf16 a[220:223], v[40:43], v[72:75], a[220:223]
  s_waitcnt lgkmcnt(0)
  v_mfma_f32_16x16x32_bf16 a[252:255], v[44:47], v[76:79], a[252:255]
  v_add_u32 v104, 64, v104
  v_add_u32 v105, 64, v105
  v_add_u32 v106, 64, v106
  v_add_u32 v107, 64, v107
  v_add_u32 v108, 64, v108
  v_add_u32 v109, 64, v109
  v_add_u32 v110, 64, v110
  v_add_u32 v111, 64, v111
  v_add_u32 v4, 64, v4
  v_add_u32 v8, 64, v8
  s_add_u32 s40, s40, 0x8000
  s_waitcnt vmcnt(0)
  s_mov_b64 exec, 1
  buffer_store_dword v13, v1, s[8:11], s39 offen sc1
  s_mov_b64 exec, -1
  s_add_u32 s32, s32, 1
  s_and_b32 s6, s32, 7
  s_cbranch_scc1 L_c_conv4
L_c_conv5:
  s_add_u32 s33, s32, 1
  s_and_b32 s6, s32, 7
  s_lshl_b32 s7, s6, 10
  s_add_u32 s7, s7, s35
  v_add_u32 v9, s7, v10
  s_lshl_b32 s6, s6, 1
  s_lshl_b32 s42, 0x30003, s6
  v_mov_b32 v13, s33
  ds_read_b128 v[48:51], v4 offset:1024
  ds_read_b128 v[52:55], v4 offset:5632
  ds_read_b128 v[56:59], v4 offset:10240
  ds_read_b128 v[60:63], v4 offset:14848
  ds_read_b128 v[64:67], v4 offset:19456
  ds_read_b128 v[68:71], v4 offset:24064
  ds_read_b128 v[72:75], v4 offset:28672
  ds_read_b128 v[76:79], v4 offset:33280
  s_mov_b32 s7, 0
L_lw_67:
  ds_read_b32 v88, v2 offset:0
  s_waitcnt lgkmcnt(0)
  v_cmp_gt_i32 vcc, s33, v88
  s_cbranch_vccz L_lwo_68
  s_add_u32 s7, s7, 1
  s_cmp_lt_u32 s7, 131072
  s_cbranch_scc1 L_lw_67
  s_mov_b32 s6, 42
  s_branch L_err
L_lwo_68:
  ds_read2_b32 v[112:113], v104 offset0:0 offset1:1
  ds_read2_b32 v[114:115], v104 offset0:2 offset1:3
  ds_read_b32 v116, v104 offset:16
  ds_read2_b32 v[118:119], v105 offset0:0 offset1:1
  ds_read2_b32 v[120:121], v105 offset0:2 offset1:3
  ds_read_b32 v122, v105 offset:16
  ds_read2_b32 v[124:125], v106 offset0:0 offset1:1
  ds_read2_b32 v[126:127], v106 offset0:2 offset1:3
  ds_read_b32 v128, v106 offset:16
  ds_read2_b32 v[130:131], v107 offset0:0 offset1:1
  ds_read2_b32 v[132:133], v107 offset0:2 offset1:3
  ds_read_b32 v134, v107 offset:16
  s_waitcnt lgkmcnt(9)
  v_alignbyte_b32 v16, v113, v112, v15
  v_alignbyte_b32 v17, v114, v113, v15
  v_alignbyte_b32 v18, v115, v114, v15
  v_alignbyte_b32 v19, v116, v115, v15
  ds_read2_b32 v[112:113], v108 offset0:0 offset1:1
  ds_read2_b32 v[114:115], v108 offset0:2 offset1:3
  ds_read_b32 v116, v108 offset:16
  s_waitcnt lgkmcnt(9)
  v_alignbyte_b32 v20, v119, v118, v15
  v_alignbyte_b32 v21, v120, v119, v15
  v_alignbyte_b32 v22, v121, v120, v15
  v_alignbyte_b32 v23, v122, v121, v15
  ds_read2_b32 v[118:119], v109 offset0:0 offset1:1
  ds_read2_b32 v[120:121], v109 offset0:2 offset1:3
  ds_read_b32 v122, v109 offset:16
  v_mfma_f32_16x16x32_bf16 a[20:23], v[16:19], v[48:51], a[20:23]
  s_waitcnt lgkmcnt(9)
  v_alignbyte_b32 v24, v125, v124, v15
  v_alignbyte_b32 v25, v126, v125, v15
  v_alignbyte_b32 v26, v127, v126, v15
  v_alignbyte_b32 v27, v128, v127, v15
  ds_read2_b32 v[124:125], v110 offset0:0 offset1:1
  ds_read2_b32 v[126:127], v110 offset0:2 offset1:3
  ds_read_b32 v128, v110 offset:16
  v_mfma_f32_16x16x32_bf16 a[52:55], v[20:23], v[52:55], a[52:55]
  s_waitcnt lgkmcnt(9)
  v_alignbyte_b32 v28, v131, v130, v15
  v_alignbyte_b32 v29, v132, v131, v15
  v_alignbyte_b32 v30, v133, v132, v15
  v_alignbyte_b32 v31, v134, v133, v15
  ds_read2_b32 v[130:131], v111 offset0:0 offset1:1
  ds_read2_b32 v[132:133], v111 offset0:2 offset1:3
  ds_read_b32 v134, v111 offset:16
  v_mfma_f32_16x16x32_bf16 a[84:87], v[24:27], v[56:59], a[84:87]
  s_waitcnt lgkmcnt(9)
  v_alignbyte_b32 v32, v113, v112, v15
  v_alignbyte_b32 v33, v114, v113, v15
  v_alignbyte_b32 v34, v115, v114, v15
  v_alignbyte_b32 v35, v116, v115, v15
  ds_read_b64 v[84:85], v8
  ds_read_b64 v[86:87], v9
  v_mfma_f32_16x16x32_bf16 a[116:119], v[28:31], v[60:63], a[116:119]
  s_waitcnt lgkmcnt(8)
  v_alignbyte_b32 v36, v119, v118, v15
  v_alignbyte_b32 v37, v120, v119, v15
  v_alignbyte_b32 v38, v121, v120, v15
  v_alignbyte_b32 v39, v122, v121, v15
  v_mfma_f32_16x16x32_bf16 a[148:151], v[32:35], v[64:67], a[148:151]
  s_waitcnt lgkmcnt(5)
  v_alignbyte_b32 v40, v125, v124, v15
  v_alignbyte_b32 v41, v126, v125, v15
  v_alignbyte_b32 v42, v127, v126, v15
  v_alignbyte_b32 v43, v128, v127, v15
  v_mfma_f32_16x16x32_bf16 a[180:183], v[36:39], v[68:71], a[180:183]
  s_waitcnt lgkmcnt(2)
  v_alignbyte_b32 v44, v131, v130, v15
  v_alignbyte_b32 v45, v132, v131, v15
  v_alignbyte_b32 v46, v133, v132, v15
  v_alignbyte_b32 v47, v134, v133, v15
  v_mfma_f32_16x16x32_bf16 a[212:215], v[40:43], v[72:75], a[212:215]
  s_nop 0
  v_mfma_f32_16x16x32_bf16 a[244:247], v[44:47], v[76:79], a[244:247]
  s_waitcnt lgkmcnt(0)
  ds_read_b128 v[48:51], v4 offset:512
  ds_read_b128 v[52:55], v4 offset:5120
  ds_read_b128 v[56:59], v4 offset:9728
  ds_read_b128 v[60:63], v4 offset:14336
  ds_read_b128 v[64:67], v4 offset:18944
  ds_read_b128 v[68:71], v4 offset:23552
  ds_read_b128 v[72:75], v4 offset:28160
  ds_read_b128 v[76:79], v4 offset:32768
  s_mov_b32 exec_lo, s42
  s_mov_b32 exec_hi, s42
  ds_write_b128 v6, a[20:23] offset:0
  ds_write_b128 v6, a[52:55] offset:128
  ds_write_b128 v6, a[84:87] offset:256
  ds_write_b128 v6, a[116:119] offset:384
  ds_write_b128 v6, a[148:151] offset:512
  ds_write_b128 v6, a[180:183] offset:640
  ds_write_b128 v6, a[212:215] offset:768
  ds_write_b128 v6, a[244:247] offset:896
  s_mov_b64 exec, -1
  ds_read_b128 v[80:83], v7
  ds_write_b32 v14, v13 offset:8
  v_lshlrev_b32 v88, 16, v84
  v_and_b32 v89, 0xffff0000, v84
  v_lshlrev_b32 v90, 16, v85
  v_and_b32 v91, 0xffff0000, v85
  v_lshlrev_b32 v96, 16, v86
  v_and_b32 v97, 0xffff0000, v86
  v_lshlrev_b32 v98, 16, v87
  v_and_b32 v99, 0xffff0000, v87
  v_mul_f32 v92, v88, v12
  v_mul_f32 v93, v89, v12
  v_mul_f32 v94, v90, v12
  v_mul_f32 v95, v91, v12
  v_cvt_pk_bf16_f32 v84, v92, v93
  v_cvt_pk_bf16_f32 v85, v94, v95
  v_lshlrev_b32 v92, 16, v84
  v_and_b32 v93, 0xffff0000, v84
  v_lshlrev_b32 v94, 16, v85
  v_and_b32 v95, 0xffff0000, v85
  s_waitcnt lgkmcnt(1)
  v_fmac_f32 v80, v88, v11
  v_fmac_f32 v81, v89, v11
  v_fmac_f32 v82, v90, v11
  v_fmac_f32 v83, v91, v11
  v_cvt_pk_bf16_f32 v84, v80, v81
  v_cvt_pk_bf16_f32 v85, v82, v83
  v_lshlrev_b32 v80, 16, v84
  v_and_b32 v81, 0xffff0000, v84
  v_lshlrev_b32 v82, 16, v85
  v_and_b32 v83, 0xffff0000, v85
  v_add_f32 v80, v80, v92
  v_add_f32 v81, v81, v93
  v_add_f32 v82, v82, v94
  v_add_f32 v83, v83, v95
  v_cvt_pk_bf16_f32 v84, v80, v81
  v_cvt_pk_bf16_f32 v85, v82, v83
  v_lshlrev_b32 v80, 16, v84
  v_and_b32 v81, 0xffff0000, v84
  v_lshlrev_b32 v82, 16, v85
  v_and_b32 v83, 0xffff0000, v85
  v_add_f32 v80, v80, v96
  v_add_f32 v81, v81, v97
  v_add_f32 v82, v82, v98
  v_add_f32 v83, v83, v99
  v_cvt_pk_bf16_f32 v84, v80, v81
  v_cvt_pk_bf16_f32 v85, v82, v83
  buffer_store_dwordx2 v[84:85], v10, s[8:11], s40 offen sc1
  v_mfma_f32_16x16x32_bf16 a[24:27], v[16:19], v[48:51], a[24:27]
  ds_read_b128 v[48:51], v4 offset:0
  v_mfma_f32_16x16x32_bf16 a[56:59], v[20:23], v[52:55], a[56:59]
  ds_read_b128 v[52:55], v4 offset:4608
  v_mfma_f32_16x16x32_bf16 a[88:91], v[24:27], v[56:59], a[88:91]
  ds_read_b128 v[56:59], v4 offset:9216
  v_mfma_f32_16x16x32_bf16 a[120:123], v[28:31], v[60:63], a[120:123]
  ds_read_b128 v[60:63], v4 offset:13824
  v_mfma_f32_16x16x32_bf16 a[152:155], v[32:35], v[64:67], a[152:155]
  ds_read_b128 v[64:67], v4 offset:18432
  v_mfma_f32_16x16x32_bf16 a[184:187], v[36:39], v[68:71], a[184:187]
  ds_read_b128 v[68:71], v4 offset:23040
  v_mfma_f32_16x16x32_bf16 a[216:219], v[40:43], v[72:75], a[216:219]
  ds_read_b128 v[72:75], v4 offset:27648
  v_mfma_f32_16x16x32_bf16 a[248:251], v[44:47], v[76:79], a[248:251]
  ds_read_b128 v[76:79], v4 offset:32256
  s_waitcnt lgkmcnt(7)
  v_mfma_f32_16x16x32_bf16 a[28:31], v[16:19], v[48:51], a[28:31]
  s_waitcnt lgkmcnt(6)
  v_mfma_f32_16x16x32_bf16 a[60:63], v[20:23], v[52:55], a[60:63]
  s_waitcnt lgkmcnt(5)
  v_mfma_f32_16x16x32_bf16 a[92:95], v[24:27], v[56:59], a[92:95]
  s_waitcnt lgkmcnt(4)
  v_mfma_f32_16x16x32_bf16 a[124:127], v[28:31], v[60:63], a[124:127]
  s_waitcnt lgkmcnt(3)
  v_mfma_f32_16x16x32_bf16 a[156:159], v[32:35], v[64:67], a[156:159]
  s_waitcnt lgkmcnt(2)
  v_mfma_f32_16x16x32_bf16 a[188:191], v[36:39], v[68:71], a[188:191]
  s_waitcnt lgkmcnt(1)
  v_mfma_f32_16x16x32_bf16 a[220:223], v[40:43], v[72:75], a[220:223]
  s_waitcnt lgkmcnt(0)
  v_mfma_f32_16x16x32_bf16 a[252:255], v[44:47], v[76:79], a[252:255]
  v_add_u32 v104, 64, v104
  v_add_u32 v105, 64, v105
  v_add_u32 v106, 64, v106
  v_add_u32 v107, 64, v107
  v_add_u32 v108, 64, v108
  v_add_u32 v109, 64, v109
  v_add_u32 v110, 64, v110
  v_add_u32 v111, 64, v111
  v_add_u32 v4, 64, v4
  v_add_u32 v8, 64, v8
  s_add_u32 s40, s40, 0x8000
  s_waitcnt vmcnt(0)
  s_mov_b64 exec, 1
  buffer_store_dword v13, v1, s[8:11], s39 offen sc1
  s_mov_b64 exec, -1
  s_add_u32 s32, s32, 1
  s_and_b32 s6, s32, 7
  s_cbranch_scc1 L_c_conv5
L_c_conv6:
  s_add_u32 s33, s32, 1
  s_and_b32 s6, s32, 7
  s_lshl_b32 s7, s6, 10
  s_add_u32 s7, s7, s35
  v_add_u32 v9, s7, v10
  s_lshl_b32 s6, s6, 1
  s_lshl_b32 s42, 0x30003, s6
  v_mov_b32 v13, s33
  ds_read_b128 v[48:51], v4 offset:512
  ds_read_b128 v[52:55], v4 offset:5120
  ds_read_b128 v[56:59], v4 offset:9728
  ds_read_b128 v[60:63], v4 offset:14336
  ds_read_b128 v[64:67], v4 offset:18944
  ds_read_b128 v[68:71], v4 offset:23552
  ds_read_b128 v[72:75], v4 offset:28160
  ds_read_b128 v[76:79], v4 offset:32768
  s_mov_b32 s7, 0
L_lw_69:
  ds_read_b32 v88, v2 offset:0
  s_waitcnt lgkmcnt(0)
  v_cmp_gt_i32 vcc, s33, v88
  s_cbranch_vccz L_lwo_70
  s_add_u32 s7, s7, 1
  s_cmp_lt_u32 s7, 131072
  s_cbranch_scc1 L_lw_69
  s_mov_b32 s6, 42
  s_branch L_err
L_lwo_70:
  ds_read2_b32 v[112:113], v104 offset0:0 offset1:1
  ds_read2_b32 v[114:115], v104 offset0:2 offset1:3
  ds_read_b32 v116, v104 offset:16
  ds_read2_b32 v[118:119], v105 offset0:0 offset1:1
  ds_read2_b32 v[120:121], v105 offset0:2 offset1:3
  ds_read_b32 v122, v105 offset:16
  ds_read2_b32 v[124:125], v106 offset0:0 offset1:1
  ds_read2_b32 v[126:127], v106 offset0:2 offset1:3
  ds_read_b32 v128, v106 offset:16
  ds_read2_b32 v[130:131], v107 offset0:0 offset1:1
  ds_read2_b32 v[132:133], v107 offset0:2 offset1:3
  ds_read_b32 v134, v107 offset:16
  s_waitcnt lgkmcnt(9)
  v_alignbyte_b32 v16, v113, v112, v15
  v_alignbyte_b32 v17, v114, v113, v15
  v_alignbyte_b32 v18, v115, v114, v15
  v_alignbyte_b32 v19, v116, v115, v15
  ds_read2_b32 v[112:113], v108 offset0:0 offset1:1
  ds_read2_b32 v[114:115], v108 offset0:2 offset1:3
  ds_read_b32 v116, v108 offset:16
  s_waitcnt lgkmcnt(9)
  v_alignbyte_b32 v20, v119, v118, v15
  v_alignbyte_b32 v21, v120, v119, v15
  v_alignbyte_b32 v22, v121, v120, v15
  v_alignbyte_b32 v23, v122, v121, v15
  ds_read2_b32 v[118:119], v109 offset0:0 offset1:1
  ds_read2_b32 v[120:121], v109 offset0:2 offset1:3
  ds_read_b32 v122, v109 offset:16
  v_mfma_f32_16x16x32_bf16 a[24:27], v[16:19], v[48:51], a[24:27]
  s_waitcnt lgkmcnt(9)
  v_alignbyte_b32 v24, v125, v124, v15
  v_alignbyte_b32 v25, v126, v125, v15
  v_alignbyte_b32 v26, v127, v126, v15
  v_alignbyte_b32 v27, v128, v127, v15
  ds_read2_b32 v[124:125], v110 offset0:0 offset1:1
  ds_read2_b32 v[126:127], v110 offset0:2 offset1:3
  ds_read_b32 v128, v110 offset:16
  v_mfma_f32_16x16x32_bf16 a[56:59], v[20:23], v[52:55], a[56:59]
  s_waitcnt lgkmcnt(9)
  v_alignbyte_b32 v28, v131, v130, v15
  v_alignbyte_b32 v29, v132, v131, v15
  v_alignbyte_b32 v30, v133, v132, v15
  v_alignbyte_b32 v31, v134, v133, v15
  ds_read2_b32 v[130:131], v111 offset0:0 offset1:1
  ds_read2_b32 v[132:133], v111 offset0:2 offset1:3
  ds_read_b32 v134, v111 offset:16
  v_mfma_f32_16x16x32_bf16 a[88:91], v[24:27], v[56:59], a[88:91]
  s_waitcnt lgkmcnt(9)
  v_alignbyte_b32 v32, v113, v112, v15
  v_alignbyte_b32 v33, v114, v113, v15
  v_alignbyte_b32 v34, v115, v114, v15
  v_alignbyte_b32 v35, v116, v115, v15
  ds_read_b64 v[84:85], v8
  ds_read_b64 v[86:87], v9
  v_mfma_f32_16x16x32_bf16 a[120:123], v[28:31], v[60:63], a[120:123]
  s_waitcnt lgkmcnt(8)
  v_alignbyte_b32 v36, v119, v118, v15
  v_alignbyte_b32 v37, v120, v119, v15
  v_alignbyte_b32 v38, v121, v120, v15
  v_alignbyte_b32 v39, v122, v121, v15
  v_mfma_f32_16x16x32_bf16 a[152:155], v[32:35], v[64:67], a[152:155]
  s_waitcnt lgkmcnt(5)
  v_alignbyte_b32 v40, v125, v124, v15
  v_alignbyte_b32 v41, v126, v125, v15
  v_alignbyte_b32 v42, v127, v126, v15
  v_alignbyte_b32 v43, v128, v127, v15
  v_mfma_f32_16x16x32_bf16 a[184:187], v[36:39], v[68:71], a[184:187]
  s_waitcnt lgkmcnt(2)
  v_alignbyte_b32 v44, v131, v130, v15
  v_alignbyte_b32 v45, v132, v131, v15
  v_alignbyte_b32 v46, v133, v132, v15
  v_alignbyte_b32 v47, v134, v133, v15
  v_mfma_f32_16x16x32_bf16 a[216:219], v[40:43], v[72:75], a[216:219]
  s_nop 0
  v_mfma_f32_16x16x32_bf16 a[248:251], v[44:47], v[76:79], a[248:251]
  s_waitcnt lgkmcnt(0)
  ds_read_b128 v[48:51], v4 offset:0
  ds_read_b128 v[52:55], v4 offset:4608
  ds_read_b128 v[56:59], v4 offset:9216
  ds_read_b128 v[60:63], v4 offset:13824
  ds_read_b128 v[64:67], v4 offset:18432
  ds_read_b128 v[68:71], v4 offset:23040
  ds_read_b128 v[72:75], v4 offset:27648
  ds_read_b128 v[76:79], v4 offset:32256
  s_mov_b32 exec_lo, s42
  s_mov_b32 exec_hi, s42
  ds_write_b128 v6, a[24:27] offset:0
  ds_write_b128 v6, a[56:59] offset:128
  ds_write_b128 v6, a[88:91] offset:256
  ds_write_b128 v6, a[120:123] offset:384
  ds_write_b128 v6, a[152:155] offset:512
  ds_write_b128 v6, a[184:187] offset:640
  ds_write_b128 v6, a[216:219] offset:768
  ds_write_b128 v6, a[248:251] offset:896
  s_mov_b64 exec, -1
  ds_read_b128 v[80:83], v7
  ds_write_b32 v14, v13 offset:8
  v_lshlrev_b32 v88, 16, v84
  v_and_b32 v89, 0xffff0000, v84
  v_lshlrev_b32 v90, 16, v85
  v_and_b32 v91, 0xffff0000, v85
  v_lshlrev_b32 v96, 16, v86
  v_and_b32 v97, 0xffff0000, v86
  v_lshlrev_b32 v98, 16, v87
  v_and_b32 v99, 0xffff0000, v87
  v_mul_f32 v92, v88, v12
  v_mul_f32 v93, v89, v12
  v_mul_f32 v94, v90, v12
  v_mul_f32 v95, v91, v12
  v_cvt_pk_bf16_f32 v84, v92, v93
  v_cvt_pk_bf16_f32 v85, v94, v95
  v_lshlrev_b32 v92, 16, v84
  v_and_b32 v93, 0xffff0000, v84
  v_lshlrev_b32 v94, 16, v85
  v_and_b32 v95, 0xffff0000, v85
  s_waitcnt lgkmcnt(1)
  v_fmac_f32 v80, v88, v11
  v_fmac_f32 v81, v89, v11
  v_fmac_f32 v82, v90, v11
  v_fmac_f32 v83, v91, v11
  v_cvt_pk_bf16_f32 v84, v80, v81
  v_cvt_pk_bf16_f32 v85, v82, v83
  v_lshlrev_b32 v80, 16, v84
  v_and_b32 v81, 0xffff0000, v84
  v_lshlrev_b32 v82, 16, v85
  v_and_b32 v83, 0xffff0000, v85
  v_add_f32 v80, v80, v92
  v_add_f32 v81, v81, v93
  v_add_f32 v82, v82, v94
  v_add_f32 v83, v83, v95
  v_cvt_pk_bf16_f32 v84, v80, v81
  v_cvt_pk_bf16_f32 v85, v82, v83
  v_lshlrev_b32 v80, 16, v84
  v_and_b32 v81, 0xffff0000, v84
  v_lshlrev_b32 v82, 16, v85
  v_and_b32 v83, 0xffff0000, v85
  v_add_f32 v80, v80, v96
  v_add_f32 v81, v81, v97
  v_add_f32 v82, v82, v98
  v_add_f32 v83, v83, v99
  v_cvt_pk_bf16_f32 v84, v80, v81
  v_cvt_pk_bf16_f32 v85, v82, v83
  buffer_store_dwordx2 v[84:85], v10, s[8:11], s40 offen sc1
  v_mfma_f32_16x16x32_bf16 a[28:31], v[16:19], v[48:51], a[28:31]
  v_mfma_f32_16x16x32_bf16 a[60:63], v[20:23], v[52:55], a[60:63]
  v_mfma_f32_16x16x32_bf16 a[92:95], v[24:27], v[56:59], a[92:95]
  v_mfma_f32_16x16x32_bf16 a[124:127], v[28:31], v[60:63], a[124:127]
  v_mfma_f32_16x16x32_bf16 a[156:159], v[32:35], v[64:67], a[156:159]
  v_mfma_f32_16x16x32_bf16 a[188:191], v[36:39], v[68:71], a[188:191]
  v_mfma_f32_16x16x32_bf16 a[220:223], v[40:43], v[72:75], a[220:223]
  v_mfma_f32_16x16x32_bf16 a[252:255], v[44:47], v[76:79], a[252:255]
  v_add_u32 v104, 64, v104
  v_add_u32 v105, 64, v105
  v_add_u32 v106, 64, v106
  v_add_u32 v107, 64, v107
  v_add_u32 v108, 64, v108
  v_add_u32 v109, 64, v109
  v_add_u32 v110, 64, v110
  v_add_u32 v111, 64, v111
  v_add_u32 v4, 64, v4
  v_add_u32 v8, 64, v8
  s_add_u32 s40, s40, 0x8000
  s_waitcnt vmcnt(0)
  s_mov_b64 exec, 1
  buffer_store_dword v13, v1, s[8:11], s39 offen sc1
  s_mov_b64 exec, -1
  s_add_u32 s32, s32, 1
  s_and_b32 s6, s32, 7
  s_cbranch_scc1 L_c_conv6
L_c_conv7:
  s_add_u32 s33, s32, 1
  s_and_b32 s6, s32, 7
  s_lshl_b32 s7, s6, 10
  s_add_u32 s7, s7, s35
  v_add_u32 v9, s7, v10
  s_lshl_b32 s6, s6, 1
  s_lshl_b32 s42, 0x30003, s6
  v_mov_b32 v13, s33
  ds_read_b128 v[48:51], v4 offset:0
  ds_read_b128 v[52:55], v4 offset:4608
  ds_read_b128 v[56:59], v4 offset:9216
  ds_read_b128 v[60:63], v4 offset:13824
  ds_read_b128 v[64:67], v4 offset:18432
  ds_read_b128 v[68:71], v4 offset:23040
  ds_read_b128 v[72:75], v4 offset:27648
  ds_read_b128 v[76:79], v4 offset:32256
  s_mov_b32 s7, 0
L_lw_71:
  ds_read_b32 v88, v2 offset:0
  s_waitcnt lgkmcnt(0)
  v_cmp_gt_i32 vcc, s33, v88
  s_cbranch_vccz L_lwo_72
  s_add_u32 s7, s7, 1
  s_cmp_lt_u32 s7, 131072
  s_cbranch_scc1 L_lw_71
  s_mov_b32 s6, 42
  s_branch L_err
L_lwo_72:
  ds_read2_b32 v[112:113], v104 offset0:0 offset1:1
  ds_read2_b32 v[114:115], v104 offset0:2 offset1:3
  ds_read_b32 v116, v104 offset:16
  ds_read2_b32 v[118:119], v105 offset0:0 offset1:1
  ds_read2_b32 v[120:121], v105 offset0:2 offset1:3
  ds_read_b32 v122, v105 offset:16
  ds_read2_b32 v[124:125], v106 offset0:0 offset1:1
  ds_read2_b32 v[126:127], v106 offset0:2 offset1:3
  ds_read_b32 v128, v106 offset:16
  ds_read2_b32 v[130:131], v107 offset0:0 offset1:1
  ds_read2_b32 v[132:133], v107 offset0:2 offset1:3
  ds_read_b32 v134, v107 offset:16
  s_waitcnt lgkmcnt(9)
  v_alignbyte_b32 v16, v113, v112, v15
  v_alignbyte_b32 v17, v114, v113, v15
  v_alignbyte_b32 v18, v115, v114, v15
  v_alignbyte_b32 v19, v116, v115, v15
  ds_read2_b32 v[112:113], v108 offset0:0 offset1:1
  ds_read2_b32 v[114:115], v108 offset0:2 offset1:3
  ds_read_b32 v116, v108 offset:16
  s_waitcnt lgkmcnt(9)
  v_alignbyte_b32 v20, v119, v118, v15
  v_alignbyte_b32 v21, v120, v119, v15
  v_alignbyte_b32 v22, v121, v120, v15
  v_alignbyte_b32 v23, v122, v121, v15
  ds_read2_b32 v[118:119], v109 offset0:0 offset1:1
  ds_read2_b32 v[120:121], v109 offset0:2 offset1:3
  ds_read_b32 v122, v109 offset:16
  v_mfma_f32_16x16x32_bf16 a[28:31], v[16:19], v[48:51], a[28:31]
  s_waitcnt lgkmcnt(9)
  v_alignbyte_b32 v24, v125, v124, v15
  v_alignbyte_b32 v25, v126, v125, v15
  v_alignbyte_b32 v26, v127, v126, v15
  v_alignbyte_b32 v27, v128, v127, v15
  ds_read2_b32 v[124:125], v110 offset0:0 offset1:1
  ds_read2_b32 v[126:127], v110 offset0:2 offset1:3
  ds_read_b32 v128, v110 offset:16
  v_mfma_f32_16x16x32_bf16 a[60:63], v[20:23], v[52:55], a[60:63]
  s_waitcnt lgkmcnt(9)
  v_alignbyte_b32 v28, v131, v130, v15
  v_alignbyte_b32 v29, v132, v131, v15
  v_alignbyte_b32 v30, v133, v132, v15
  v_alignbyte_b32 v31, v134, v133, v15
  ds_read2_b32 v[130:131], v111 offset0:0 offset1:1
  ds_read2_b32 v[132:133], v111 offset0:2 offset1:3
  ds_read_b32 v134, v111 offset:16
  v_mfma_f32_16x16x32_bf16 a[92:95], v[24:27], v[56:59], a[92:95]
  s_waitcnt lgkmcnt(9)
  v_alignbyte_b32 v32, v113, v112, v15
  v_alignbyte_b32 v33, v114, v113, v15
  v_alignbyte_b32 v34, v115, v114, v15
  v_alignbyte_b32 v35, v116, v115, v15
  ds_read_b64 v[84:85], v8
  ds_read_b64 v[86:87], v9
  v_mfma_f32_16x16x32_bf16 a[124:127], v[28:31], v[60:63], a[124:127]
  s_waitcnt lgkmcnt(8)
  v_alignbyte_b32 v36, v119, v118, v15
  v_alignbyte_b32 v37, v120, v119, v15
  v_alignbyte_b32 v38, v121, v120, v15
  v_alignbyte_b32 v39, v122, v121, v15
  v_mfma_f32_16x16x32_bf16 a[156:159], v[32:35], v[64:67], a[156:159]
  s_waitcnt lgkmcnt(5)
  v_alignbyte_b32 v40, v125, v124, v15
  v_alignbyte_b32 v41, v126, v125, v15
  v_alignbyte_b32 v42, v127, v126, v15
  v_alignbyte_b32 v43, v128, v127, v15
  v_mfma_f32_16x16x32_bf16 a[188:191], v[36:39], v[68:71], a[188:191]
  s_waitcnt lgkmcnt(2)
  v_alignbyte_b32 v44, v131, v130, v15
  v_alignbyte_b32 v45, v132, v131, v15
  v_alignbyte_b32 v46, v133, v132, v15
  v_alignbyte_b32 v47, v134, v133, v15
  v_mfma_f32_16x16x32_bf16 a[220:223], v[40:43], v[72:75], a[220:223]
  s_nop 0
  v_mfma_f32_16x16x32_bf16 a[252:255], v[44:47], v[76:79], a[252:255]
  s_waitcnt lgkmcnt(0)
  s_mov_b32 exec_lo, s42
  s_mov_b32 exec_hi, s42
  ds_write_b128 v6, a[28:31] offset:0
  ds_write_b128 v6, a[60:63] offset:128
  ds_write_b128 v6, a[92:95] offset:256
  ds_write_b128 v6, a[124:127] offset:384
  ds_write_b128 v6, a[156:159] offset:512
  ds_write_b128 v6, a[188:191] offset:640
  ds_write_b128 v6, a[220:223] offset:768
  ds_write_b128 v6, a[252:255] offset:896
  s_mov_b64 exec, -1
  ds_read_b128 v[80:83], v7
  ds_write_b32 v14, v13 offset:8
  v_lshlrev_b32 v88, 16, v84
  v_and_b32 v89, 0xffff0000, v84
  v_lshlrev_b32 v90, 16, v85
  v_and_b32 v91, 0xffff0000, v85
  v_lshlrev_b32 v96, 16, v86
  v_and_b32 v97, 0xffff0000, v86
  v_lshlrev_b32 v98, 16, v87
  v_and_b32 v99, 0xffff0000, v87
  v_mul_f32 v92, v88, v12
  v_mul_f32 v93, v89, v12
  v_mul_f32 v94, v90, v12
  v_mul_f32 v95, v91, v12
  v_cvt_pk_bf16_f32 v84, v92, v93
  v_cvt_pk_bf16_f32 v85, v94, v95
  v_lshlrev_b32 v92, 16, v84
  v_and_b32 v93, 0xffff0000, v84
  v_lshlrev_b32 v94, 16, v85
  v_and_b32 v95, 0xffff0000, v85
  s_waitcnt lgkmcnt(1)
  v_fmac_f32 v80, v88, v11
  v_fmac_f32 v81, v89, v11
  v_fmac_f32 v82, v90, v11
  v_fmac_f32 v83, v91, v11
  v_cvt_pk_bf16_f32 v84, v80, v81
  v_cvt_pk_bf16_f32 v85, v82, v83
  v_lshlrev_b32 v80, 16, v84
  v_and_b32 v81, 0xffff0000, v84
  v_lshlrev_b32 v82, 16, v85
  v_and_b32 v83, 0xffff0000, v85
  v_add_f32 v80, v80, v92
  v_add_f32 v81, v81, v93
  v_add_f32 v82, v82, v94
  v_add_f32 v83, v83, v95
  v_cvt_pk_bf16_f32 v84, v80, v81
  v_cvt_pk_bf16_f32 v85, v82, v83
  v_lshlrev_b32 v80, 16, v84
  v_and_b32 v81, 0xffff0000, v84
  v_lshlrev_b32 v82, 16, v85
  v_and_b32 v83, 0xffff0000, v85
  v_add_f32 v80, v80, v96
  v_add_f32 v81, v81, v97
  v_add_f32 v82, v82, v98
  v_add_f32 v83, v83, v99
  v_cvt_pk_bf16_f32 v84, v80, v81
  v_cvt_pk_bf16_f32 v85, v82, v83
  buffer_store_dwordx2 v[84:85], v10, s[8:11], s40 offen sc1
  v_add_u32 v104, 64, v104
  v_add_u32 v105, 64, v105
  v_add_u32 v106, 64, v106
  v_add_u32 v107, 64, v107
  v_add_u32 v108, 64, v108
  v_add_u32 v109, 64, v109
  v_add_u32 v110, 64, v110
  v_add_u32 v111, 64, v111
  v_add_u32 v4, 64, v4
  v_add_u32 v8, 64, v8
  s_add_u32 s40, s40, 0x8000
  s_waitcnt vmcnt(0)
  s_mov_b64 exec, 1
  buffer_store_dword v13, v1, s[8:11], s39 offen sc1
  s_mov_b64 exec, -1
  s_add_u32 s32, s32, 1
  s_and_b32 s6, s32, 7
  s_cbranch_scc1 L_c_conv7
  s_waitcnt vmcnt(0)
  s_endpgm
L_c_res:
  s_mov_b32 s16, s92
  s_mov_b32 s17, s93
  s_mov_b32 s18, 0x200000
  s_mov_b32 s19, 0x20000
  s_and_b32 s6, s3, 1
  s_mul_i32 s37, s6, 0x200000
  s_mul_i32 s38, s6, 0x800000
  s_lshl_b32 s39, s6, 11
  s_lshl_b32 s7, s5, 10
  s_add_u32 s37, s37, s7
  s_add_u32 s37, s37, 0x0
  s_add_u32 s38, s38, s7
  s_add_u32 s38, s38, 0x8800000
  s_lshr_b32 s6, s5, 3
  s_lshl_b32 s6, s6, 7
  s_add_u32 s39, s39, s6
  s_and_b32 s6, s5, 6
  s_lshl_b32 s6, s6, 1
  s_add_u32 s39, s39, s6
  s_add_u32 s39, s39, 0x711000
  s_lshl_b32 s41, s5, 5
  v_bfe_u32 v16, v0, 4, 5
  v_lshrrev_b32 v17, 9, v0
  v_lshlrev_b32 v18, 1, v16
  v_lshl_or_b32 v4, v17, 8, v18
  v_add_u32 v8, 139776, v4
  v_mul_u32_u24 v19, 16512, v17
  v_add_u32 v19, v19, v18
  v_add_u32 v7, 73760, v19
  v_bfe_u32 v19, v0, 4, 2
  v_lshlrev_b32 v5, 9, v19
  v_lshrrev_b32 v6, 1, v0
  v_lshlrev_b32 v19, 10, v16
  v_lshl_or_b32 v9, v17, 3, v19
L_c_rloop:
  s_add_u32 s33, s32, 1
  s_mov_b32 s7, 0
L_pl_73:
  buffer_load_dword v16, v5, s[8:11], s39 offen offset:0 sc1
  s_waitcnt vmcnt(0)
  v_cmp_gt_u32 vcc, s33, v16
  s_cbranch_vccz L_plo_74
  s_add_u32 s7, s7, 1
  s_cmp_lt_u32 s7, 131072
  s_cbranch_scc1 L_pl_73
  s_mov_b32 s6, 43
  s_branch L_err
L_plo_74:
  s_add_u32 s6, s38, 0
  buffer_load_dwordx4 v[16:19], v0, s[8:11], s6 offen
  s_add_u32 s6, s38, 32768
  buffer_load_dwordx4 v[20:23], v0, s[8:11], s6 offen
  s_add_u32 s6, s38, 65536
  buffer_load_dwordx4 v[24:27], v0, s[8:11], s6 offen
  s_add_u32 s6, s38, 98304
  buffer_load_dwordx4 v[28:31], v0, s[8:11], s6 offen
  buffer_load_ushort v32, v4, s[8:11], s37 offen offset:0
  buffer_load_ushort v33, v4, s[8:11], s37 offen offset:64
  buffer_load_ushort v34, v4, s[8:11], s37 offen offset:128
  buffer_load_ushort v35, v4, s[8:11], s37 offen offset:192
  buffer_load_ushort v36, v4, s[8:11], s37 offen offset:512
  buffer_load_ushort v37, v4, s[8:11], s37 offen offset:576
  buffer_load_ushort v38, v4, s[8:11], s37 offen offset:640
  buffer_load_ushort v39, v4, s[8:11], s37 offen offset:704
  s_add_u32 s38, s38, 0x20000
  s_add_u32 s37, s37, 0x8000
  s_waitcnt vmcnt(11)
  v_lshlrev_b32 v40, 16, v16
  v_and_b32 v41, 0xffff0000, v16
  v_lshlrev_b32 v42, 16, v17
  v_and_b32 v43, 0xffff0000, v17
  v_lshlrev_b32 v44, 16, v18
  v_and_b32 v45, 0xffff0000, v18
  v_lshlrev_b32 v46, 16, v19
  v_and_b32 v47, 0xffff0000, v19
  s_waitcnt vmcnt(10)
  v_lshlrev_b32 v52, 16, v20
  v_and_b32 v53, 0xffff0000, v20
  v_add_f32 v40, v40, v52
  v_add_f32 v41, v41, v53
  v_lshlrev_b32 v52, 16, v21
  v_and_b32 v53, 0xffff0000, v21
  v_add_f32 v42, v42, v52
  v_add_f32 v43, v43, v53
  v_lshlrev_b32 v52, 16, v22
  v_and_b32 v53, 0xffff0000, v22
  v_add_f32 v44, v44, v52
  v_add_f32 v45, v45, v53
  v_lshlrev_b32 v52, 16, v23
  v_and_b32 v53, 0xffff0000, v23
  v_add_f32 v46, v46, v52
  v_add_f32 v47, v47, v53
  s_waitcnt vmcnt(9)
  v_lshlrev_b32 v52, 16, v24
  v_and_b32 v53, 0xffff0000, v24
  v_add_f32 v40, v40, v52
  v_add_f32 v41, v41, v53
  v_lshlrev_b32 v52, 16, v25
  v_and_b32 v53, 0xffff0000, v25
  v_add_f32 v42, v42, v52
  v_add_f32 v43, v43, v53
  v_lshlrev_b32 v52, 16, v26
  v_and_b32 v53, 0xffff0000, v26
  v_add_f32 v44, v44, v52
  v_add_f32 v45, v45, v53
  v_lshlrev_b32 v52, 16, v27
  v_and_b32 v53, 0xffff0000, v27
  v_add_f32 v46, v46, v52
  v_add_f32 v47, v47, v53
  s_waitcnt vmcnt(8)
  v_lshlrev_b32 v52, 16, v28
  v_and_b32 v53, 0xffff0000, v28
  v_add_f32 v40, v40, v52
  v_add_f32 v41, v41, v53
  v_lshlrev_b32 v52, 16, v29
  v_and_b32 v53, 0xffff0000, v29
  v_add_f32 v42, v42, v52
  v_add_f32 v43, v43, v53
  v_lshlrev_b32 v52, 16, v30
  v_and_b32 v53, 0xffff0000, v30
  v_add_f32 v44, v44, v52
  v_add_f32 v45, v45, v53
  v_lshlrev_b32 v52, 16, v31
  v_and_b32 v53, 0xffff0000, v31
  v_add_f32 v46, v46, v52
  v_add_f32 v47, v47, v53
  v_cvt_pk_bf16_f32 v48, v40, v41
  v_cvt_pk_bf16_f32 v49, v42, v43
  v_cvt_pk_bf16_f32 v50, v44, v45
  v_cvt_pk_bf16_f32 v51, v46, v47
  v_lshlrev_b32 v40, 16, v48
  v_and_b32 v41, 0xffff0000, v48
  v_lshlrev_b32 v42, 16, v49
  v_and_b32 v43, 0xffff0000, v49
  v_lshlrev_b32 v44, 16, v50
  v_and_b32 v45, 0xffff0000, v50
  v_lshlrev_b32 v46, 16, v51
  v_and_b32 v47, 0xffff0000, v51
  s_waitcnt vmcnt(0)
  v_lshlrev_b32 v32, 16, v32
  v_lshlrev_b32 v33, 16, v33
  v_lshlrev_b32 v34, 16, v34
  v_lshlrev_b32 v35, 16, v35
  v_lshlrev_b32 v36, 16, v36
  v_lshlrev_b32 v37, 16, v37
  v_lshlrev_b32 v38, 16, v38
  v_lshlrev_b32 v39, 16, v39
  v_add_f32 v40, v40, v32
  v_add_f32 v41, v41, v33
  v_add_f32 v42, v42, v34
  v_add_f32 v43, v43, v35
  v_add_f32 v44, v44, v36
  v_add_f32 v45, v45, v37
  v_add_f32 v46, v46, v38
  v_add_f32 v47, v47, v39
  v_cvt_pk_bf16_f32 v48, v40, v41
  v_cvt_pk_bf16_f32 v49, v42, v43
  v_cvt_pk_bf16_f32 v50, v44, v45
  v_cvt_pk_bf16_f32 v51, v46, v47
  s_cmp_eq_u32 s3, 2
  s_cbranch_scc1 L_c_ln
  buffer_store_dwordx2 v[48:49], v9, s[16:19], s41 offen
  buffer_store_dwordx2 v[50:51], v9, s[16:19], s41 offen offset:16
  s_add_u32 s41, s41, 0x8000
  s_branch L_c_rnext
L_c_ln:
  v_lshlrev_b32 v40, 16, v48
  v_and_b32 v41, 0xffff0000, v48
  v_lshlrev_b32 v42, 16, v49
  v_and_b32 v43, 0xffff0000, v49
  v_lshlrev_b32 v44, 16, v50
  v_and_b32 v45, 0xffff0000, v50
  v_lshlrev_b32 v46, 16, v51
  v_and_b32 v47, 0xffff0000, v51
  v_add_f32 v52, v40, v41
  v_mul_f32 v53, v40, v40
  v_fmac_f32 v53, v41, v41
  v_add_f32 v52, v52, v42
  v_fmac_f32 v53, v42, v42
  v_add_f32 v52, v52, v43
  v_fmac_f32 v53, v43, v43
  v_add_f32 v52, v52, v44
  v_fmac_f32 v53, v44, v44
  v_add_f32 v52, v52, v45
  v_fmac_f32 v53, v45, v45
  v_add_f32 v52, v52, v46
  v_fmac_f32 v53, v46, v46
  v_add_f32 v52, v52, v47
  v_fmac_f32 v53, v47, v47
  s_lshr_b32 s6, s32, 1
  s_andn2_b32 s36, 1, s6
  s_and_b32 s6, s32, 1
  s_lshl_b32 s6, s6, 13
  s_add_u32 s34, s6, 0x704000
  s_add_u32 s35, s34, 4096
  s_lshl_b32 s6, s5, 8
  s_add_u32 s6, s6, s34
  v_mov_b32 v54, v52
  v_mov_b32 v55, v53
  s_nop 0
  v_permlane32_swap_b32 v52, v54
  v_permlane32_swap_b32 v53, v55
  v_add_f32 v52, v52, v54
  v_add_f32 v53, v53, v55
  v_bfi_b32 v53, 1, s36, v53
  s_mov_b32 exec_hi, 0
  buffer_store_dwordx2 v[52:53], v6, s[8:11], s6 offen
  s_mov_b32 exec_hi, -1
  buffer_load_dwordx2 v[64:65], v6, s[8:11], s34 offen offset:0 sc1
  buffer_load_dwordx2 v[66:67], v6, s[8:11], s34 offen offset:512 sc1
  buffer_load_dwordx2 v[68:69], v6, s[8:11], s34 offen offset:1024 sc1
  buffer_load_dwordx2 v[70:71], v6, s[8:11], s34 offen offset:1536 sc1
  buffer_load_dwordx2 v[72:73], v6, s[8:11], s34 offen offset:2048 sc1
  buffer_load_dwordx2 v[74:75], v6, s[8:11], s34 offen offset:2560 sc1
  buffer_load_dwordx2 v[76:77], v6, s[8:11], s34 offen offset:3072 sc1
  buffer_load_dwordx2 v[78:79], v6, s[8:11], s34 offen offset:3584 sc1
  buffer_load_dwordx2 v[80:81], v6, s[8:11], s35 offen offset:0 sc1
  buffer_load_dwordx2 v[82:83], v6, s[8:11], s35 offen offset:512 sc1
  buffer_load_dwordx2 v[84:85], v6, s[8:11], s35 offen offset:1024 sc1
  buffer_load_dwordx2 v[86:87], v6, s[8:11], s35 offen offset:1536 sc1
  buffer_load_dwordx2 v[88:89], v6, s[8:11], s35 offen offset:2048 sc1
  buffer_load_dwordx2 v[90:91], v6, s[8:11], s35 offen offset:2560 sc1
  buffer_load_dwordx2 v[92:93], v6, s[8:11], s35 offen offset:3072 sc1
  buffer_load_dwordx2 v[94:95], v6, s[8:11], s35 offen offset:3584 sc1
  s_sub_u32 s33, s32, 7
  s_mov_b32 s7, 0
L_lw_75:
  ds_read_b64 v[52:53], v2 offset:8
  s_waitcnt lgkmcnt(0)
  v_min_i32 v52, v52, v53
  v_cmp_gt_i32 vcc, s33, v52
  s_cbranch_vccz L_lwo_76
  s_add_u32 s7, s7, 1
  s_cmp_lt_u32 s7, 131072
  s_cbranch_scc1 L_lw_75
  s_mov_b32 s6, 44
  s_branch L_err
L_lwo_76:
  s_and_b32 s6, s32, 7
  s_lshl_b32 s6, s6, 10
  v_add_u32 v52, s6, v8
  ds_write_b16 v52, v48 offset:0
  ds_write_b16_d16_hi v52, v48 offset:64
  ds_write_b16 v52, v49 offset:128
  ds_write_b16_d16_hi v52, v49 offset:192
  ds_write_b16 v52, v50 offset:512
  ds_write_b16_d16_hi v52, v50 offset:576
  ds_write_b16 v52, v51 offset:640
  ds_write_b16_d16_hi v52, v51 offset:704
  s_mov_b32 s7, 0
L_c_g:
  s_waitcnt vmcnt(0)
  v_bitop3_b32 v16, v65, v67, s36 bitop3:0x7e
  v_bitop3_b32 v17, v69, v71, s36 bitop3:0x7e
  v_bitop3_b32 v18, v73, v75, s36 bitop3:0x7e
  v_bitop3_b32 v19, v77, v79, s36 bitop3:0x7e
  v_bitop3_b32 v20, v81, v83, s36 bitop3:0x7e
  v_bitop3_b32 v21, v85, v87, s36 bitop3:0x7e
  v_bitop3_b32 v22, v89, v91, s36 bitop3:0x7e
  v_bitop3_b32 v23, v93, v95, s36 bitop3:0x7e
  v_or3_b32 v16, v16, v17, v18
  v_or3_b32 v19, v19, v20, v21
  v_or3_b32 v16, v16, v22, v23
  v_bitop3_b32 v16, v16, v19, 1 bitop3:0xa8
  v_cmp_ne_u32 vcc, 0, v16
  s_cbranch_vccz L_c_gok
  buffer_load_dwordx2 v[64:65], v6, s[8:11], s34 offen offset:0 sc1
  buffer_load_dwordx2 v[66:67], v6, s[8:11], s34 offen offset:512 sc1
  buffer_load_dwordx2 v[68:69], v6, s[8:11], s34 offen offset:1024 sc1
  buffer_load_dwordx2 v[70:71], v6, s[8:11], s34 offen offset:1536 sc1
  buffer_load_dwordx2 v[72:73], v6, s[8:11], s34 offen offset:2048 sc1
  buffer_load_dwordx2 v[74:75], v6, s[8:11], s34 offen offset:2560 sc1
  buffer_load_dwordx2 v[76:77], v6, s[8:11], s34 offen offset:3072 sc1
  buffer_load_dwordx2 v[78:79], v6, s[8:11], s34 offen offset:3584 sc1
  buffer_load_dwordx2 v[80:81], v6, s[8:11], s35 offen offset:0 sc1
  buffer_load_dwordx2 v[82:83], v6, s[8:11], s35 offen offset:512 sc1
  buffer_load_dwordx2 v[84:85], v6, s[8:11], s35 offen offset:1024 sc1
  buffer_load_dwordx2 v[86:87], v6, s[8:11], s35 offen offset:1536 sc1
  buffer_load_dwordx2 v[88:89], v6, s[8:11], s35 offen offset:2048 sc1
  buffer_load_dwordx2 v[90:91], v6, s[8:11], s35 offen offset:2560 sc1
  buffer_load_dwordx2 v[92:93], v6, s[8:11], s35 offen offset:3072 sc1
  buffer_load_dwordx2 v[94:95], v6, s[8:11], s35 offen offset:3584 sc1
  s_and_b32 s6, s7, 31
  s_cmp_lg_u32 s6, 31
  s_cbranch_scc1 L_tf_77
  buffer_wbl2 sc1
  s_waitcnt vmcnt(0)
  buffer_inv sc1
  s_waitcnt vmcnt(0)
L_tf_77:
  s_add_u32 s7, s7, 1
  s_cmp_lt_u32 s7, 131072
  s_cbranch_scc1 L_c_g
  s_mov_b32 s6, 45
  s_branch L_err
L_c_gok:
  v_add_f32 v64, v64, v80
  v_add_f32 v65, v65, v81
  v_add_f32 v66, v66, v82
  v_add_f32 v67, v67, v83
  v_add_f32 v68, v68, v84
  v_add_f32 v69, v69, v85
  v_add_f32 v70, v70, v86
  v_add_f32 v71, v71, v87
  v_add_f32 v72, v72, v88
  v_add_f32 v73, v73, v89
  v_add_f32 v74, v74, v90
  v_add_f32 v75, v75, v91
  v_add_f32 v76, v76, v92
  v_add_f32 v77, v77, v93
  v_add_f32 v78, v78, v94
  v_add_f32 v79, v79, v95
  v_add_f32 v64, v64, v72
  v_add_f32 v65, v65, v73
  v_add_f32 v66, v66, v74
  v_add_f32 v67, v67, v75
  v_add_f32 v68, v68, v76
  v_add_f32 v69, v69, v77
  v_add_f32 v70, v70, v78
  v_add_f32 v71, v71, v79
  v_add_f32 v64, v64, v68
  v_add_f32 v65, v65, v69
  v_add_f32 v66, v66, v70
  v_add_f32 v67, v67, v71
  v_add_f32 v52, v64, v66
  v_add_f32 v53, v65, v67
  v_mov_b32 v54, v52
  v_mov_b32 v55, v53
  s_nop 0
  v_permlane32_swap_b32 v52, v54
  v_permlane32_swap_b32 v53, v55
  v_add_f32 v52, v52, v54
  v_add_f32 v53, v53, v55
  v_mul_f32 v52, 0x3b000000, v52
  v_mul_f32 v54, v52, v52
  v_mul_f32 v53, 0x3b000000, v53
  v_sub_f32 v53, v53, v54
  v_max_f32 v53, 0, v53
  v_cvt_pk_bf16_f32 v53, v53, v53
  v_and_b32 v53, 0xffff0000, v53
  v_add_f32 v53, 0x3727c5ac, v53
  v_cvt_pk_bf16_f32 v53, v53, v53
  v_and_b32 v53, 0xffff0000, v53
  v_sqrt_f32 v53, v53
  v_cvt_pk_bf16_f32 v52, v52, v52
  v_and_b32 v52, 0xffff0000, v52
  v_cvt_pk_bf16_f32 v53, v53, v53
  v_and_b32 v53, 0xffff0000, v53
  v_rcp_f32 v53, v53
  v_sub_f32 v40, v40, v52
  v_sub_f32 v41, v41, v52
  v_sub_f32 v42, v42, v52
  v_sub_f32 v43, v43, v52
  v_sub_f32 v44, v44, v52
  v_sub_f32 v45, v45, v52
  v_sub_f32 v46, v46, v52
  v_sub_f32 v47, v47, v52
  v_cvt_pk_bf16_f32 v48, v40, v41
  v_cvt_pk_bf16_f32 v49, v42, v43
  v_cvt_pk_bf16_f32 v50, v44, v45
  v_cvt_pk_bf16_f32 v51, v46, v47
  v_lshlrev_b32 v40, 16, v48
  v_and_b32 v41, 0xffff0000, v48
  v_lshlrev_b32 v42, 16, v49
  v_and_b32 v43, 0xffff0000, v49
  v_lshlrev_b32 v44, 16, v50
  v_and_b32 v45, 0xffff0000, v50
  v_lshlrev_b32 v46, 16, v51
  v_and_b32 v47, 0xffff0000, v51
  v_mul_f32 v40, v40, v53
  v_mul_f32 v41, v41, v53
  v_mul_f32 v42, v42, v53
  v_mul_f32 v43, v43, v53
  v_mul_f32 v44, v44, v53
  v_mul_f32 v45, v45, v53
  v_mul_f32 v46, v46, v53
  v_mul_f32 v47, v47, v53
  v_cvt_pk_bf16_f32 v48, v40, v41
  v_cvt_pk_bf16_f32 v49, v42, v43
  v_cvt_pk_bf16_f32 v50, v44, v45
  v_cvt_pk_bf16_f32 v51, v46, v47
  s_add_u32 s6, s32, 1
  v_mov_b32 v52, s6
  ds_write_b16 v7, v48 offset:0
  ds_write_b16_d16_hi v7, v48 offset:4128
  ds_write_b16 v7, v49 offset:8256
  ds_write_b16_d16_hi v7, v49 offset:12384
  ds_write_b16 v7, v50 offset:33024
  ds_write_b16_d16_hi v7, v50 offset:37152
  ds_write_b16 v7, v51 offset:41280
  ds_write_b16_d16_hi v7, v51 offset:45408
  ds_write_b32 v2, v52
  v_add_u32 v7, 64, v7
L_c_rnext:
  s_add_u32 s32, s32, 1
  s_cmp_lt_u32 s32, 64
  s_cbranch_scc1 L_c_rloop
  buffer_wbl2 sc1
  s_waitcnt vmcnt(0)
  s_endpgm
.section .rodata,"a"
.p2align 6
.amdhsa_kernel interleave_layers__ssm_conv_s4d__memory_aug_recurrent_mem_tr__prompt_kernel
  .amdhsa_next_free_vgpr 512
  .amdhsa_next_free_sgpr 102
  .amdhsa_accum_offset 256
  .amdhsa_group_segment_fixed_size 0
  .amdhsa_kernarg_size 136
  .amdhsa_user_sgpr_count 2
  .amdhsa_user_sgpr_kernarg_segment_ptr 1
  .amdhsa_system_sgpr_workgroup_id_x 1
.end_amdhsa_kernel
```

```asm
; @launch grid=(256,1,1) block=(256,1,1) lds=163840
.amdgcn_target "amdgcn-amd-amdhsa--gfx950"
.text
.globl interleave_layers__ssm_conv_s4d__memory_aug_recurrent_mem_tr__prompt_kernel
.p2align 8
.type interleave_layers__ssm_conv_s4d__memory_aug_recurrent_mem_tr__prompt_kernel,@function
interleave_layers__ssm_conv_s4d__memory_aug_recurrent_mem_tr__prompt_kernel:
  s_cmp_ge_u32 s2, 256
  s_cbranch_scc1 L_end
  s_load_dwordx16 s[64:79], s[0:1], 0
  s_load_dwordx16 s[80:95], s[0:1], 64
  s_load_dwordx2 s[96:97], s[0:1], 128
  s_getreg_b32 s4, hwreg(HW_REG_XCC_ID,0,4)
  v_lshrrev_b32 v1, 6, v0
  v_and_b32 v0, 63, v0
  s_and_b32 s4, s4, 7
  v_readfirstlane_b32 s3, v1
  s_waitcnt lgkmcnt(0)
  s_mov_b32 s12, s94
  s_mov_b32 s13, s95
  s_mov_b32 s14, 0x100
  s_mov_b32 s15, 0x20000
  s_mov_b32 s8, s96
  s_mov_b32 s9, s97
  s_mov_b32 s10, 0x10000000
  s_mov_b32 s11, 0x20000
  s_mov_b32 s16, s64
  s_mov_b32 s17, s65
  s_mov_b32 s18, 0x200000
  s_mov_b32 s19, 0x20000
  s_lshl_b32 s6, s2, 3
  s_lshl_b32 s7, s3, 1
  s_add_u32 s32, s6, s7
  s_lshl_b32 s6, s32, 10
  v_lshlrev_b32 v4, 5, v0
  buffer_load_dwordx4 v[40:43], v4, s[16:19], s6 offen
  buffer_load_dwordx4 v[44:47], v4, s[16:19], s6 offen offset:16
  s_cmp_lg_u32 s3, 0
  s_cbranch_scc1 L_tk_1
  s_and_b32 s6, s4, 3
  s_lshl_b32 s6, s6, 6
  s_and_b32 s7, s4, 4
  s_add_u32 s6, s6, s7
  s_mov_b64 exec, 1
  v_mov_b32 v2, s6
  v_mov_b32 v3, 1
  buffer_atomic_add v3, v2, s[12:15], 0 offen sc0 sc1
  s_mov_b64 exec, -1
L_tk_1:
  s_cmp_lg_u32 s3, 0
  s_waitcnt vmcnt(1)
  s_cbranch_scc0 L_xw_2
  s_waitcnt vmcnt(0)
L_xw_2:
  v_mov_b32 v5, 0
  v_mov_b32 v6, 0
  v_mov_b32 v7, 0x3f803f80
  v_dot2c_f32_bf16 v5, v40, v7
  v_dot2c_f32_bf16 v6, v40, v40
  v_dot2c_f32_bf16 v5, v41, v7
  v_dot2c_f32_bf16 v6, v41, v41
  v_dot2c_f32_bf16 v5, v42, v7
  v_dot2c_f32_bf16 v6, v42, v42
  v_dot2c_f32_bf16 v5, v43, v7
  v_dot2c_f32_bf16 v6, v43, v43
  v_dot2c_f32_bf16 v5, v44, v7
  v_dot2c_f32_bf16 v6, v44, v44
  v_dot2c_f32_bf16 v5, v45, v7
  v_dot2c_f32_bf16 v6, v45, v45
  v_dot2c_f32_bf16 v5, v46, v7
  v_dot2c_f32_bf16 v6, v46, v46
  v_dot2c_f32_bf16 v5, v47, v7
  v_dot2c_f32_bf16 v6, v47, v47
  s_nop 1
  v_add_f32_dpp v5, v5, v5 quad_perm:[1,0,3,2] row_mask:0xf bank_mask:0xf
  v_add_f32_dpp v6, v6, v6 quad_perm:[1,0,3,2] row_mask:0xf bank_mask:0xf
  s_nop 0
  v_add_f32_dpp v5, v5, v5 quad_perm:[2,3,0,1] row_mask:0xf bank_mask:0xf
  v_add_f32_dpp v6, v6, v6 quad_perm:[2,3,0,1] row_mask:0xf bank_mask:0xf
  s_nop 0
  v_add_f32_dpp v5, v5, v5 row_half_mirror row_mask:0xf bank_mask:0xf
  v_add_f32_dpp v6, v6, v6 row_half_mirror row_mask:0xf bank_mask:0xf
  s_nop 0
  v_add_f32_dpp v5, v5, v5 row_mirror row_mask:0xf bank_mask:0xf
  v_add_f32_dpp v6, v6, v6 row_mirror row_mask:0xf bank_mask:0xf
  v_mov_b32 v8, v5
  v_mov_b32 v9, v6
  s_nop 0
  v_permlane16_swap_b32 v5, v8
  v_permlane16_swap_b32 v6, v9
  v_add_f32 v8, v5, v8
  v_add_f32 v9, v6, v9
  v_mul_f32 v8, 0x3b000000, v8
  v_mul_f32 v10, v8, v8
  v_mul_f32 v9, 0x3b000000, v9
  v_sub_f32 v9, v9, v10
  v_max_f32 v9, 0, v9
  v_cvt_pk_bf16_f32 v9, v9, v9
  v_and_b32 v9, 0xffff0000, v9
  v_add_f32 v9, 0x3727c5ac, v9
  v_cvt_pk_bf16_f32 v9, v9, v9
  v_and_b32 v9, 0xffff0000, v9
  v_sqrt_f32 v9, v9
  v_cvt_pk_bf16_f32 v8, v8, v8
  v_and_b32 v8, 0xffff0000, v8
  v_cvt_pk_bf16_f32 v9, v9, v9
  v_and_b32 v9, 0xffff0000, v9
  v_rcp_f32 v9, v9
  v_lshlrev_b32 v16, 16, v40
  v_and_b32 v17, 0xffff0000, v40
  v_lshlrev_b32 v18, 16, v41
  v_and_b32 v19, 0xffff0000, v41
  v_lshlrev_b32 v20, 16, v42
  v_and_b32 v21, 0xffff0000, v42
  v_lshlrev_b32 v22, 16, v43
  v_and_b32 v23, 0xffff0000, v43
  v_lshlrev_b32 v24, 16, v44
  v_and_b32 v25, 0xffff0000, v44
  v_lshlrev_b32 v26, 16, v45
  v_and_b32 v27, 0xffff0000, v45
  v_lshlrev_b32 v28, 16, v46
  v_and_b32 v29, 0xffff0000, v46
  v_lshlrev_b32 v30, 16, v47
  v_and_b32 v31, 0xffff0000, v47
  v_sub_f32 v16, v16, v8
  v_sub_f32 v17, v17, v8
  v_sub_f32 v18, v18, v8
  v_sub_f32 v19, v19, v8
  v_sub_f32 v20, v20, v8
  v_sub_f32 v21, v21, v8
  v_sub_f32 v22, v22, v8
  v_sub_f32 v23, v23, v8
  v_sub_f32 v24, v24, v8
  v_sub_f32 v25, v25, v8
  v_sub_f32 v26, v26, v8
  v_sub_f32 v27, v27, v8
  v_sub_f32 v28, v28, v8
  v_sub_f32 v29, v29, v8
  v_sub_f32 v30, v30, v8
  v_sub_f32 v31, v31, v8
  v_cvt_pk_bf16_f32 v32, v16, v17
  v_cvt_pk_bf16_f32 v33, v18, v19
  v_cvt_pk_bf16_f32 v34, v20, v21
  v_cvt_pk_bf16_f32 v35, v22, v23
  v_cvt_pk_bf16_f32 v36, v24, v25
  v_cvt_pk_bf16_f32 v37, v26, v27
  v_cvt_pk_bf16_f32 v38, v28, v29
  v_cvt_pk_bf16_f32 v39, v30, v31
  v_lshlrev_b32 v16, 16, v32
  v_and_b32 v17, 0xffff0000, v32
  v_lshlrev_b32 v18, 16, v33
  v_and_b32 v19, 0xffff0000, v33
  v_lshlrev_b32 v20, 16, v34
  v_and_b32 v21, 0xffff0000, v34
  v_lshlrev_b32 v22, 16, v35
  v_and_b32 v23, 0xffff0000, v35
  v_lshlrev_b32 v24, 16, v36
  v_and_b32 v25, 0xffff0000, v36
  v_lshlrev_b32 v26, 16, v37
  v_and_b32 v27, 0xffff0000, v37
  v_lshlrev_b32 v28, 16, v38
  v_and_b32 v29, 0xffff0000, v38
  v_lshlrev_b32 v30, 16, v39
  v_and_b32 v31, 0xffff0000, v39
  v_mul_f32 v16, v16, v9
  v_mul_f32 v17, v17, v9
  v_mul_f32 v18, v18, v9
  v_mul_f32 v19, v19, v9
  v_mul_f32 v20, v20, v9
  v_mul_f32 v21, v21, v9
  v_mul_f32 v22, v22, v9
  v_mul_f32 v23, v23, v9
  v_mul_f32 v24, v24, v9
  v_mul_f32 v25, v25, v9
  v_mul_f32 v26, v26, v9
  v_mul_f32 v27, v27, v9
  v_mul_f32 v28, v28, v9
  v_mul_f32 v29, v29, v9
  v_mul_f32 v30, v30, v9
  v_mul_f32 v31, v31, v9
  v_cvt_pk_bf16_f32 v32, v16, v17
  v_cvt_pk_bf16_f32 v33, v18, v19
  v_cvt_pk_bf16_f32 v34, v20, v21
  v_cvt_pk_bf16_f32 v35, v22, v23
  v_cvt_pk_bf16_f32 v36, v24, v25
  v_cvt_pk_bf16_f32 v37, v26, v27
  v_cvt_pk_bf16_f32 v38, v28, v29
  v_cvt_pk_bf16_f32 v39, v30, v31
  s_mov_b32 s6, 0x05040100
  s_mov_b32 s7, 0x07060302
  v_and_b32 v4, 31, v0
  v_mul_u32_u24 v4, 528, v4
  v_lshrrev_b32 v5, 5, v0
  v_lshl_add_u32 v4, v5, 8, v4
  s_lshl_b32 s34, s3, 2
  s_add_u32 s34, s34, 64
  v_add_u32 v4, s34, v4
  v_permlane32_swap_b32 v32, v36
  v_permlane32_swap_b32 v33, v37
  v_permlane32_swap_b32 v34, v38
  v_permlane32_swap_b32 v35, v39
  v_perm_b32 v16, v36, v32, s6
  ds_write_b32 v4, v16 offset:0
  v_perm_b32 v17, v36, v32, s7
  ds_write_b32 v4, v17 offset:16
  v_perm_b32 v18, v37, v33, s6
  ds_write_b32 v4, v18 offset:32
  v_perm_b32 v19, v37, v33, s7
  ds_write_b32 v4, v19 offset:48
  v_perm_b32 v20, v38, v34, s6
  ds_write_b32 v4, v20 offset:128
  v_perm_b32 v21, v38, v34, s7
  ds_write_b32 v4, v21 offset:144
  v_perm_b32 v22, v39, v35, s6
  ds_write_b32 v4, v22 offset:160
  v_perm_b32 v23, v39, v35, s7
  ds_write_b32 v4, v23 offset:176
  v_permlane32_swap_b32 v40, v44
  v_permlane32_swap_b32 v41, v45
  v_permlane32_swap_b32 v42, v46
  v_permlane32_swap_b32 v43, v47
  v_perm_b32 v24, v44, v40, s6
  ds_write_b32 v4, v24 offset:64
  v_perm_b32 v25, v44, v40, s7
  ds_write_b32 v4, v25 offset:80
  v_perm_b32 v26, v45, v41, s6
  ds_write_b32 v4, v26 offset:96
  v_perm_b32 v27, v45, v41, s7
  ds_write_b32 v4, v27 offset:112
  v_perm_b32 v28, v46, v42, s6
  ds_write_b32 v4, v28 offset:192
  v_perm_b32 v29, v46, v42, s7
  ds_write_b32 v4, v29 offset:208
  v_perm_b32 v30, v47, v43, s6
  ds_write_b32 v4, v30 offset:224
  v_perm_b32 v31, v47, v43, s7
  ds_write_b32 v4, v31 offset:240
  s_cmp_lg_u32 s3, 0
  s_cbranch_scc1 L_rl_3
  s_waitcnt vmcnt(0)
  v_readfirstlane_b32 s5, v3
  s_cmp_lt_u32 s5, 32
  s_cbranch_scc1 L_rok_4
  s_mov_b64 exec, 1
  v_mov_b32 v2, 32
  v_mov_b32 v3, 1
  buffer_atomic_add v3, v2, s[12:15], 0 offen sc0 sc1
  s_waitcnt vmcnt(0)
  v_readfirstlane_b32 s33, v3
  s_mov_b64 exec, -1
  s_mov_b32 s7, 0
  v_lshlrev_b32 v2, 2, v0
L_row_5:
  buffer_load_dword v3, v2, s[12:15], 0 offen sc1
  s_waitcnt vmcnt(0)
  s_mov_b32 s34, 0
  v_readlane_b32 s40, v3, 0
  v_readlane_b32 s41, v3, 16
  v_readlane_b32 s42, v3, 32
  v_readlane_b32 s43, v3, 48
  v_readlane_b32 s44, v3, 1
  v_readlane_b32 s45, v3, 17
  v_readlane_b32 s46, v3, 33
  v_readlane_b32 s47, v3, 49
  s_add_u32 s34, s34, s40
  s_add_u32 s34, s34, s41
  s_add_u32 s34, s34, s42
  s_add_u32 s34, s34, s43
  s_add_u32 s34, s34, s44
  s_add_u32 s34, s34, s45
  s_add_u32 s34, s34, s46
  s_add_u32 s34, s34, s47
  s_cmp_eq_u32 s34, 256
  s_cbranch_scc1 L_row2_6
  s_add_u32 s7, s7, 1
  s_cmp_lt_u32 s7, 131072
  s_cbranch_scc1 L_row_5
  s_mov_b32 s6, 1
  s_branch L_err
L_row2_6:
  s_min_u32 s5, s40, 32
  s_sub_u32 s35, 32, s5
  s_cmp_ge_u32 s33, s35
  s_cbranch_scc1 L_ovn_7
  s_add_u32 s5, s5, s33
  s_mov_b32 s4, 0
  s_branch L_rok_4
L_ovn_7:
  s_sub_u32 s33, s33, s35
  s_min_u32 s5, s41, 32
  s_sub_u32 s35, 32, s5
  s_cmp_ge_u32 s33, s35
  s_cbranch_scc1 L_ovn_8
  s_add_u32 s5, s5, s33
  s_mov_b32 s4, 1
  s_branch L_rok_4
L_ovn_8:
  s_sub_u32 s33, s33, s35
  s_min_u32 s5, s42, 32
  s_sub_u32 s35, 32, s5
  s_cmp_ge_u32 s33, s35
  s_cbranch_scc1 L_ovn_9
  s_add_u32 s5, s5, s33
  s_mov_b32 s4, 2
  s_branch L_rok_4
L_ovn_9:
  s_sub_u32 s33, s33, s35
  s_min_u32 s5, s43, 32
  s_sub_u32 s35, 32, s5
  s_cmp_ge_u32 s33, s35
  s_cbranch_scc1 L_ovn_10
  s_add_u32 s5, s5, s33
  s_mov_b32 s4, 3
  s_branch L_rok_4
L_ovn_10:
  s_sub_u32 s33, s33, s35
  s_min_u32 s5, s44, 32
  s_sub_u32 s35, 32, s5
  s_cmp_ge_u32 s33, s35
  s_cbranch_scc1 L_ovn_11
  s_add_u32 s5, s5, s33
  s_mov_b32 s4, 4
  s_branch L_rok_4
L_ovn_11:
  s_sub_u32 s33, s33, s35
  s_min_u32 s5, s45, 32
  s_sub_u32 s35, 32, s5
  s_cmp_ge_u32 s33, s35
  s_cbranch_scc1 L_ovn_12
  s_add_u32 s5, s5, s33
  s_mov_b32 s4, 5
  s_branch L_rok_4
L_ovn_12:
  s_sub_u32 s33, s33, s35
  s_min_u32 s5, s46, 32
  s_sub_u32 s35, 32, s5
  s_cmp_ge_u32 s33, s35
  s_cbranch_scc1 L_ovn_13
  s_add_u32 s5, s5, s33
  s_mov_b32 s4, 6
  s_branch L_rok_4
L_ovn_13:
  s_sub_u32 s33, s33, s35
  s_min_u32 s5, s47, 32
  s_sub_u32 s35, 32, s5
  s_cmp_ge_u32 s33, s35
  s_cbranch_scc1 L_ovn_14
  s_add_u32 s5, s5, s33
  s_mov_b32 s4, 7
  s_branch L_rok_4
L_ovn_14:
  s_sub_u32 s33, s33, s35
  s_mov_b32 s6, 2
  s_branch L_err
L_rok_4:
  s_lshl_b32 s6, s4, 5
  s_add_u32 s6, s6, s5
  v_mov_b32 v2, 0
  v_mov_b32 v3, s6
  ds_write_b32 v2, v3
L_rl_3:
  v_lshrrev_b32 v4, 5, v0
  s_lshl_b32 s6, s3, 1
  v_add_u32 v4, s6, v4
  v_mul_u32_u24 v4, 528, v4
  v_and_b32 v5, 31, v0
  v_lshl_add_u32 v4, v5, 4, v4
  v_lshrrev_b32 v5, 3, v0
  v_lshlrev_b32 v5, 15, v5
  v_and_b32 v6, 7, v0
  v_lshl_or_b32 v5, v6, 4, v5
  s_lshl_b32 s6, s3, 18
  s_lshl_b32 s7, s2, 7
  s_add_u32 s6, s6, s7
  s_add_u32 s6, s6, 0xb000000
  s_waitcnt lgkmcnt(0)
  s_barrier
  ds_read_b128 v[16:19], v4 offset:64
  ds_read_b128 v[20:23], v4 offset:4288
  ds_read_b128 v[24:27], v4 offset:8512
  ds_read_b128 v[28:31], v4 offset:12736
  s_waitcnt lgkmcnt(3)
  buffer_store_dwordx4 v[16:19], v5, s[8:11], s6 offen sc1
  s_add_u32 s6, s6, 1048576
  s_waitcnt lgkmcnt(2)
  buffer_store_dwordx4 v[20:23], v5, s[8:11], s6 offen sc1
  s_add_u32 s6, s6, 1048576
  s_waitcnt lgkmcnt(1)
  buffer_store_dwordx4 v[24:27], v5, s[8:11], s6 offen sc1
  s_add_u32 s6, s6, 1048576
  s_waitcnt lgkmcnt(0)
  buffer_store_dwordx4 v[28:31], v5, s[8:11], s6 offen sc1
  s_add_u32 s6, s6, 1048576
  v_mov_b32 v2, 0
  ds_read_b32 v3, v2
  s_waitcnt lgkmcnt(0)
  v_readfirstlane_b32 s6, v3
  s_barrier
  s_lshr_b32 s4, s6, 5
  s_and_b32 s4, s4, 7
  s_and_b32 s5, s6, 31
  s_cmp_eq_u32 s4, 0
  s_cbranch_scc1 L_rec
  s_cmp_eq_u32 s4, 1
  s_cbranch_scc1 L_rec
  s_cmp_eq_u32 s4, 2
  s_cbranch_scc1 L_p
  s_cmp_eq_u32 s4, 3
  s_cbranch_scc1 L_p
  s_cmp_eq_u32 s4, 4
  s_cbranch_scc1 L_p
  s_cmp_eq_u32 s4, 5
  s_cbranch_scc1 L_p
  s_cmp_eq_u32 s4, 6
  s_cbranch_scc1 L_o
  s_cmp_eq_u32 s4, 7
  s_cbranch_scc1 L_c
  s_waitcnt vmcnt(0)
  s_barrier
  s_cmp_lg_u32 s3, 0
  s_cbranch_scc1 L_sd_15
  s_mov_b64 exec, 1
  s_and_b32 s6, s4, 3
  s_lshl_b32 s6, s6, 6
  v_mov_b32 v2, 16
  v_mov_b32 v3, 1
  buffer_atomic_add v3, v2, s[12:15], s6 offen sc1
  s_mov_b64 exec, -1
L_sd_15:
  s_waitcnt vmcnt(0)
  s_endpgm
L_err:
  s_mov_b64 exec, 1
  s_lshl_b32 s7, s4, 2
  s_add_u32 s7, s7, 160
  v_mov_b32 v2, s7
  v_mov_b32 v3, s6
  buffer_store_dword v3, v2, s[12:15], 0 offen sc1
  s_waitcnt vmcnt(0)
L_end:
  s_endpgm
L_rec:
  s_and_b32 s58, s4, 1
  s_mul_i32 s35, s58, 0x2000000
  s_add_u32 s35, s35, 0x800000
  s_mul_i32 s36, s58, 0x1000000
  s_add_u32 s36, s36, 0x4800000
  s_mul_i32 s39, s58, 0x40000
  s_add_u32 s39, s39, 0x740000
  s_mul_i32 s44, s58, 0x2000
  s_add_u32 s44, s44, 0x708000
  s_lshl_b32 s6, s5, 14
  s_lshl_b32 s7, s3, 11
  s_add_u32 s35, s35, s6
  s_add_u32 s35, s35, s7
  s_mov_b32 s48, s7
  s_lshl_b32 s6, s5, 8
  s_add_u32 s43, s44, s6
  s_add_u32 s44, s44, s7
  s_lshl_b32 s7, s5, 13
  s_add_u32 s41, s39, s7
  s_add_u32 s42, s41, 4096
  s_add_u32 s39, s39, s6
  s_add_u32 s40, s39, 32768
  s_lshl_b32 s7, s5, 12
  s_add_u32 s36, s36, s7
  s_lshl_b32 s7, s3, 10
  s_add_u32 s36, s36, s7
  s_add_u32 s53, s48, 8192
  s_add_u32 s37, s48, 16384
  s_lshl_b32 s6, s58, 13
  s_lshl_b32 s7, s5, 7
  s_add_u32 s38, s6, s7
  s_add_u32 s38, s38, 0x714000
  s_mov_b32 s54, 0x00ff00ff
  s_mov_b32 s55, 0x00ff00ff
  s_mov_b32 s56, 0x33333333
  s_mov_b32 s57, 0x33333333
  s_mov_b32 s34, 0x3e0293ee
  s_add_u32 s6, s3, 1
  s_and_b32 s6, s6, 3
  s_lshl_b32 s45, s6, 11
  s_add_u32 s6, s3, 2
  s_and_b32 s6, s6, 3
  s_lshl_b32 s46, s6, 11
  s_add_u32 s6, s3, 3
  s_and_b32 s6, s6, 3
  s_lshl_b32 s47, s6, 11
  v_and_b32 v16, 15, v0
  v_lshrrev_b32 v17, 4, v0
  v_lshlrev_b32 v1, 4, v0
  s_lshl_b32 s6, s3, 8
  s_add_u32 s6, s6, 24576
  v_mul_u32_u24 v18, 1088, v17
  v_lshl_add_u32 v18, v16, 3, v18
  v_add_u32 v2, s6, v18
  v_and_b32 v18, 3, v0
  v_mul_u32_u24 v18, 1088, v18
  v_bfe_u32 v19, v0, 2, 3
  v_lshl_add_u32 v18, v19, 3, v18
  v_lshrrev_b32 v19, 5, v0
  v_lshl_add_u32 v18, v19, 7, v18
  v_add_u32 v3, 24576, v18
  v_and_b32 v18, 7, v0
  v_bfe_u32 v19, v0, 3, 1
  v_lshl_or_b32 v18, v19, 4, v18
  v_lshlrev_b32 v18, 4, v18
  v_lshl_add_u32 v18, v17, 9, v18
  v_add_u32 v4, 8192, v18
  v_lshrrev_b32 v18, 2, v16
  v_and_b32 v19, 1, v0
  v_lshl_or_b32 v18, v18, 1, v19
  v_mul_u32_u24 v18, 288, v18
  v_lshl_add_u32 v18, v17, 2, v18
  s_lshl_b32 s6, s3, 6
  s_add_u32 s6, s6, 28928
  v_add_u32 v5, s6, v18
  v_lshrrev_b32 v18, 1, v16
  v_mul_u32_u24 v18, 288, v18
  v_lshl_add_u32 v18, v17, 5, v18
  v_lshl_add_u32 v18, v19, 4, v18
  v_add_u32 v6, 28928, v18
  s_lshl_b32 s6, s3, 15
  s_add_u32 s6, s6, 32768
  v_add_u32 v7, s6, v1
  v_lshrrev_b32 v18, 2, v16
  v_lshlrev_b32 v18, 13, v18
  v_and_b32 v19, 3, v0
  v_lshl_or_b32 v19, v17, 2, v19
  v_lshl_or_b32 v18, v19, 4, v18
  s_lshl_b32 s6, s3, 16
  v_add_u32 v8, s6, v18
  v_lshlrev_b32 v18, 4, v16
  v_lshl_or_b32 v18, v17, 9, v18
  v_add_u32 v9, s37, v18
  v_mov_b32 v10, 0x3f803f80
  v_mov_b32 v11, 0x3f803f80
  v_mov_b32 v12, 0
  v_mov_b32 v13, 0
  v_mov_b32 v14, 0
  v_mov_b32 v15, 0
  buffer_store_dwordx4 v[12:15], v8, s[8:11], s39 offen sc1
  buffer_store_dwordx4 v[12:15], v8, s[8:11], s40 offen sc1
  s_add_u32 s6, s36, 0
  buffer_store_dwordx4 v[12:15], v1, s[8:11], s6 offen sc1
  s_add_u32 s6, s36, 131072
  buffer_store_dwordx4 v[12:15], v1, s[8:11], s6 offen sc1
  s_add_u32 s6, s36, 262144
  buffer_store_dwordx4 v[12:15], v1, s[8:11], s6 offen sc1
  s_add_u32 s6, s36, 393216
  buffer_store_dwordx4 v[12:15], v1, s[8:11], s6 offen sc1
  s_mov_b64 exec, 0xffff
  buffer_store_dwordx4 v[12:15], v1, s[8:11], s43 offen sc1
  s_mov_b64 exec, -1
  s_cmp_eq_u32 s4, 1
  s_cbranch_scc1 L_pro
  s_branch L_rec3
L_rec2:
  v_and_b32 v16, 15, v0
  v_lshrrev_b32 v17, 4, v0
  v_lshlrev_b32 v1, 4, v0
  s_lshl_b32 s6, s3, 8
  s_add_u32 s6, s6, 24576
  v_mul_u32_u24 v18, 1088, v17
  v_lshl_add_u32 v18, v16, 3, v18
  v_add_u32 v2, s6, v18
  v_and_b32 v18, 3, v0
  v_mul_u32_u24 v18, 1088, v18
  v_bfe_u32 v19, v0, 2, 3
  v_lshl_add_u32 v18, v19, 3, v18
  v_lshrrev_b32 v19, 5, v0
  v_lshl_add_u32 v18, v19, 7, v18
  v_add_u32 v3, 24576, v18
  v_and_b32 v18, 7, v0
  v_bfe_u32 v19, v0, 3, 1
  v_lshl_or_b32 v18, v19, 4, v18
  v_lshlrev_b32 v18, 4, v18
  v_lshl_add_u32 v18, v17, 9, v18
  v_add_u32 v4, 8192, v18
  v_lshrrev_b32 v18, 2, v16
  v_and_b32 v19, 1, v0
  v_lshl_or_b32 v18, v18, 1, v19
  v_mul_u32_u24 v18, 288, v18
  v_lshl_add_u32 v18, v17, 2, v18
  s_lshl_b32 s6, s3, 6
  s_add_u32 s6, s6, 28928
  v_add_u32 v5, s6, v18
  v_lshrrev_b32 v18, 1, v16
  v_mul_u32_u24 v18, 288, v18
  v_lshl_add_u32 v18, v17, 5, v18
  v_lshl_add_u32 v18, v19, 4, v18
  v_add_u32 v6, 28928, v18
  s_lshl_b32 s6, s3, 15
  s_add_u32 s6, s6, 32768
  v_add_u32 v7, s6, v1
  v_lshrrev_b32 v18, 2, v16
  v_lshlrev_b32 v18, 13, v18
  v_and_b32 v19, 3, v0
  v_lshl_or_b32 v19, v17, 2, v19
  v_lshl_or_b32 v18, v19, 4, v18
  s_lshl_b32 s6, s3, 16
  v_add_u32 v8, s6, v18
  v_lshlrev_b32 v18, 4, v16
  v_lshl_or_b32 v18, v17, 9, v18
  v_add_u32 v9, s37, v18
  v_mov_b32 v10, 0x3f803f80
  v_mov_b32 v11, 0x3f803f80
  v_mov_b32 v12, 0
  v_mov_b32 v13, 0
  v_mov_b32 v14, 0
  v_mov_b32 v15, 0
L_rec3:
  s_mov_b32 s16, s82
  s_mov_b32 s17, s83
  s_mov_b32 s18, 0x400000
  s_mov_b32 s19, 0x20000
  s_mov_b32 s20, s84
  s_mov_b32 s21, s85
  s_mov_b32 s22, 0x400000
  s_mov_b32 s23, 0x20000
  s_mov_b32 s24, s86
  s_mov_b32 s25, s87
  s_mov_b32 s26, 0x400000
  s_mov_b32 s27, 0x20000
  s_mov_b32 s28, s88
  s_mov_b32 s29, s89
  s_mov_b32 s30, 0x400000
  s_mov_b32 s31, 0x20000
  s_lshr_b32 s6, 0x72, s4
  s_bitcmp1_b32 s6, 0
  s_cbranch_scc1 L_rdn_16
  s_waitcnt vmcnt(0)
  s_barrier
  s_cmp_lg_u32 s3, 0
  s_cbranch_scc1 L_sd_17
  s_mov_b64 exec, 1
  s_and_b32 s6, s4, 3
  s_lshl_b32 s6, s6, 6
  v_mov_b32 v18, 16
  v_mov_b32 v19, 1
  buffer_atomic_add v19, v18, s[12:15], s6 offen sc1
  s_mov_b64 exec, -1
L_sd_17:
L_rdn_16:
  v_bfe_u32 v16, v0, 4, 1
  v_lshrrev_b32 v17, 5, v0
  v_lshl_or_b32 v18, v17, 5, v16
  s_and_b32 s6, s3, 1
  s_lshr_b32 s7, s3, 1
  s_lshl_b32 s60, s6, 4
  s_lshl_b32 s7, s7, 6
  s_add_u32 s7, s7, s60
  v_add_u32 v18, s7, v18
  v_lshlrev_b32 v18, 13, v18
  v_lshrrev_b32 v19, 4, v0
  s_lshl_b32 s6, s6, 2
  v_or_b32 v19, s6, v19
  v_lshlrev_b32 v19, 1, v19
  v_and_b32 v116, 15, v0
  v_xor_b32 v19, v19, v116
  v_lshl_or_b32 v116, v19, 4, v18
  v_bfe_u32 v18, v0, 2, 2
  v_lshl_or_b32 v19, v16, 2, v18
  v_lshl_or_b32 v18, v17, 3, v18
  v_lshl_or_b32 v18, v16, 5, v18
  v_lshlrev_b32 v18, 8, v18
  s_lshl_b32 s6, s3, 1
  v_xor_b32 v19, s6, v19
  v_lshl_or_b32 v18, v19, 5, v18
  v_and_b32 v19, 3, v0
  v_lshl_or_b32 v18, v19, 3, v18
  v_add_u32 v120, 32768, v18
  v_xor_b32 v121, 32, v120
  v_add_u32 v122, 0x10000, v120
  v_add_u32 v123, 0x10000, v121
  v_lshrrev_b32 v16, 4, v0
  v_and_b32 v17, 15, v0
  v_lshlrev_b32 v18, 1, v16
  v_xor_b32 v17, v17, v18
  v_lshlrev_b32 v17, 4, v17
  v_lshl_or_b32 v118, v16, 10, v17
  v_xor_b32 v119, 0x80, v118
  s_lshl_b32 s60, s3, 13
  s_add_u32 s60, s60, 32768
  v_bfe_u32 v17, v0, 2, 2
  v_bfe_u32 v18, v0, 4, 1
  v_lshl_or_b32 v18, v18, 2, v17
  v_lshl_or_b32 v17, v16, 3, v17
  v_lshlrev_b32 v17, 8, v17
  v_lshl_or_b32 v17, v18, 5, v17
  v_lshl_or_b32 v17, v19, 3, v17
  v_add_u32 v124, s60, v17
  v_add_u32 v127, s60, v1
  s_lshl_b32 s63, s5, 8
  s_add_u32 s61, s63, 0
  s_add_u32 m0, s60, 0
  s_add_u32 s62, s61, 0
  buffer_load_dwordx4 v116, s[16:19], s62 offen lds
  s_add_u32 m0, s60, 1024
  s_add_u32 s62, s61, 16384
  buffer_load_dwordx4 v116, s[16:19], s62 offen lds
  s_add_u32 m0, s60, 2048
  s_add_u32 s62, s61, 32768
  buffer_load_dwordx4 v116, s[16:19], s62 offen lds
  s_add_u32 m0, s60, 3072
  s_add_u32 s62, s61, 49152
  buffer_load_dwordx4 v116, s[16:19], s62 offen lds
  s_add_u32 m0, s60, 4096
  s_add_u32 s62, s61, 65536
  buffer_load_dwordx4 v116, s[16:19], s62 offen lds
  s_add_u32 m0, s60, 5120
  s_add_u32 s62, s61, 81920
  buffer_load_dwordx4 v116, s[16:19], s62 offen lds
  s_add_u32 m0, s60, 6144
  s_add_u32 s62, s61, 98304
  buffer_load_dwordx4 v116, s[16:19], s62 offen lds
  s_add_u32 m0, s60, 7168
  s_add_u32 s62, s61, 114688
  buffer_load_dwordx4 v116, s[16:19], s62 offen lds
  s_add_u32 s61, s63, 1048576
  s_add_u32 m0, s60, 32768
  s_add_u32 s62, s61, 0
  buffer_load_dwordx4 v116, s[16:19], s62 offen lds
  s_add_u32 m0, s60, 33792
  s_add_u32 s62, s61, 16384
  buffer_load_dwordx4 v116, s[16:19], s62 offen lds
  s_add_u32 m0, s60, 34816
  s_add_u32 s62, s61, 32768
  buffer_load_dwordx4 v116, s[16:19], s62 offen lds
  s_add_u32 m0, s60, 35840
  s_add_u32 s62, s61, 49152
  buffer_load_dwordx4 v116, s[16:19], s62 offen lds
  s_add_u32 m0, s60, 36864
  s_add_u32 s62, s61, 65536
  buffer_load_dwordx4 v116, s[16:19], s62 offen lds
  s_add_u32 m0, s60, 37888
  s_add_u32 s62, s61, 81920
  buffer_load_dwordx4 v116, s[16:19], s62 offen lds
  s_add_u32 m0, s60, 38912
  s_add_u32 s62, s61, 98304
  buffer_load_dwordx4 v116, s[16:19], s62 offen lds
  s_add_u32 m0, s60, 39936
  s_add_u32 s62, s61, 114688
  buffer_load_dwordx4 v116, s[16:19], s62 offen lds
  s_add_u32 s61, s63, 2097152
  s_add_u32 m0, s60, 65536
  s_add_u32 s62, s61, 0
  buffer_load_dwordx4 v116, s[16:19], s62 offen lds
  s_add_u32 m0, s60, 66560
  s_add_u32 s62, s61, 16384
  buffer_load_dwordx4 v116, s[16:19], s62 offen lds
  s_add_u32 m0, s60, 67584
  s_add_u32 s62, s61, 32768
  buffer_load_dwordx4 v116, s[16:19], s62 offen lds
  s_add_u32 m0, s60, 68608
  s_add_u32 s62, s61, 49152
  buffer_load_dwordx4 v116, s[16:19], s62 offen lds
  s_add_u32 m0, s60, 69632
  s_add_u32 s62, s61, 65536
  buffer_load_dwordx4 v116, s[16:19], s62 offen lds
  s_add_u32 m0, s60, 70656
  s_add_u32 s62, s61, 81920
  buffer_load_dwordx4 v116, s[16:19], s62 offen lds
  s_add_u32 m0, s60, 71680
  s_add_u32 s62, s61, 98304
  buffer_load_dwordx4 v116, s[16:19], s62 offen lds
  s_add_u32 m0, s60, 72704
  s_add_u32 s62, s61, 114688
  buffer_load_dwordx4 v116, s[16:19], s62 offen lds
  s_waitcnt vmcnt(16)
  s_barrier
  s_add_u32 s61, s63, 3145728
  s_add_u32 m0, s60, 98304
  s_add_u32 s62, s61, 0
  buffer_load_dwordx4 v116, s[16:19], s62 offen lds
  s_add_u32 m0, s60, 99328
  s_add_u32 s62, s61, 16384
  buffer_load_dwordx4 v116, s[16:19], s62 offen lds
  s_add_u32 m0, s60, 100352
  s_add_u32 s62, s61, 32768
  buffer_load_dwordx4 v116, s[16:19], s62 offen lds
  s_add_u32 m0, s60, 101376
  s_add_u32 s62, s61, 49152
  buffer_load_dwordx4 v116, s[16:19], s62 offen lds
  s_add_u32 m0, s60, 102400
  s_add_u32 s62, s61, 65536
  buffer_load_dwordx4 v116, s[16:19], s62 offen lds
  s_add_u32 m0, s60, 103424
  s_add_u32 s62, s61, 81920
  buffer_load_dwordx4 v116, s[16:19], s62 offen lds
  s_add_u32 m0, s60, 104448
  s_add_u32 s62, s61, 98304
  buffer_load_dwordx4 v116, s[16:19], s62 offen lds
  s_add_u32 m0, s60, 105472
  s_add_u32 s62, s61, 114688
  buffer_load_dwordx4 v116, s[16:19], s62 offen lds
  s_cmp_eq_u32 s3, 1
  s_cbranch_scc1 L_lv_20
  s_cmp_eq_u32 s3, 2
  s_cbranch_scc1 L_lv_21
  s_cmp_eq_u32 s3, 3
  s_cbranch_scc1 L_lv_22
L_lv_19:
  ds_read_b64_tr_b16 a[0:1], v120 offset:0
  ds_read_b64_tr_b16 a[2:3], v120 offset:1024
  ds_read_b64_tr_b16 a[4:5], v120 offset:4096
  ds_read_b64_tr_b16 a[6:7], v120 offset:5120
  ds_read_b64_tr_b16 a[8:9], v121 offset:0
  ds_read_b64_tr_b16 a[10:11], v121 offset:1024
  ds_read_b64_tr_b16 a[12:13], v121 offset:4096
  ds_read_b64_tr_b16 a[14:15], v121 offset:5120
  ds_read_b64_tr_b16 a[16:17], v120 offset:16384
  ds_read_b64_tr_b16 a[18:19], v120 offset:17408
  ds_read_b64_tr_b16 a[20:21], v120 offset:20480
  ds_read_b64_tr_b16 a[22:23], v120 offset:21504
  ds_read_b64_tr_b16 a[24:25], v121 offset:16384
  ds_read_b64_tr_b16 a[26:27], v121 offset:17408
  ds_read_b64_tr_b16 a[28:29], v121 offset:20480
  ds_read_b64_tr_b16 a[30:31], v121 offset:21504
  s_branch L_lw_18
L_lv_20:
  ds_read_b64_tr_b16 a[96:97], v120 offset:0
  ds_read_b64_tr_b16 a[98:99], v120 offset:1024
  ds_read_b64_tr_b16 a[100:101], v120 offset:4096
  ds_read_b64_tr_b16 a[102:103], v120 offset:5120
  ds_read_b64_tr_b16 a[104:105], v121 offset:0
  ds_read_b64_tr_b16 a[106:107], v121 offset:1024
  ds_read_b64_tr_b16 a[108:109], v121 offset:4096
  ds_read_b64_tr_b16 a[110:111], v121 offset:5120
  ds_read_b64_tr_b16 a[112:113], v120 offset:16384
  ds_read_b64_tr_b16 a[114:115], v120 offset:17408
  ds_read_b64_tr_b16 a[116:117], v120 offset:20480
  ds_read_b64_tr_b16 a[118:119], v120 offset:21504
  ds_read_b64_tr_b16 a[120:121], v121 offset:16384
  ds_read_b64_tr_b16 a[122:123], v121 offset:17408
  ds_read_b64_tr_b16 a[124:125], v121 offset:20480
  ds_read_b64_tr_b16 a[126:127], v121 offset:21504
  s_branch L_lw_18
L_lv_21:
  ds_read_b64_tr_b16 a[64:65], v120 offset:0
  ds_read_b64_tr_b16 a[66:67], v120 offset:1024
  ds_read_b64_tr_b16 a[68:69], v120 offset:4096
  ds_read_b64_tr_b16 a[70:71], v120 offset:5120
  ds_read_b64_tr_b16 a[72:73], v121 offset:0
  ds_read_b64_tr_b16 a[74:75], v121 offset:1024
  ds_read_b64_tr_b16 a[76:77], v121 offset:4096
  ds_read_b64_tr_b16 a[78:79], v121 offset:5120
  ds_read_b64_tr_b16 a[80:81], v120 offset:16384
  ds_read_b64_tr_b16 a[82:83], v120 offset:17408
  ds_read_b64_tr_b16 a[84:85], v120 offset:20480
  ds_read_b64_tr_b16 a[86:87], v120 offset:21504
  ds_read_b64_tr_b16 a[88:89], v121 offset:16384
  ds_read_b64_tr_b16 a[90:91], v121 offset:17408
  ds_read_b64_tr_b16 a[92:93], v121 offset:20480
  ds_read_b64_tr_b16 a[94:95], v121 offset:21504
  s_branch L_lw_18
L_lv_22:
  ds_read_b64_tr_b16 a[32:33], v120 offset:0
  ds_read_b64_tr_b16 a[34:35], v120 offset:1024
  ds_read_b64_tr_b16 a[36:37], v120 offset:4096
  ds_read_b64_tr_b16 a[38:39], v120 offset:5120
  ds_read_b64_tr_b16 a[40:41], v121 offset:0
  ds_read_b64_tr_b16 a[42:43], v121 offset:1024
  ds_read_b64_tr_b16 a[44:45], v121 offset:4096
  ds_read_b64_tr_b16 a[46:47], v121 offset:5120
  ds_read_b64_tr_b16 a[48:49], v120 offset:16384
  ds_read_b64_tr_b16 a[50:51], v120 offset:17408
  ds_read_b64_tr_b16 a[52:53], v120 offset:20480
  ds_read_b64_tr_b16 a[54:55], v120 offset:21504
  ds_read_b64_tr_b16 a[56:57], v121 offset:16384
  ds_read_b64_tr_b16 a[58:59], v121 offset:17408
  ds_read_b64_tr_b16 a[60:61], v121 offset:20480
  ds_read_b64_tr_b16 a[62:63], v121 offset:21504
L_lw_18:
  s_waitcnt lgkmcnt(0)
  s_waitcnt vmcnt(16)
  s_barrier
  s_add_u32 s61, s63, 0
  s_add_u32 m0, s60, 0
  s_add_u32 s62, s61, 0
  buffer_load_dwordx4 v116, s[20:23], s62 offen lds
  s_add_u32 m0, s60, 1024
  s_add_u32 s62, s61, 16384
  buffer_load_dwordx4 v116, s[20:23], s62 offen lds
  s_add_u32 m0, s60, 2048
  s_add_u32 s62, s61, 32768
  buffer_load_dwordx4 v116, s[20:23], s62 offen lds
  s_add_u32 m0, s60, 3072
  s_add_u32 s62, s61, 49152
  buffer_load_dwordx4 v116, s[20:23], s62 offen lds
  s_add_u32 m0, s60, 4096
  s_add_u32 s62, s61, 65536
  buffer_load_dwordx4 v116, s[20:23], s62 offen lds
  s_add_u32 m0, s60, 5120
  s_add_u32 s62, s61, 81920
  buffer_load_dwordx4 v116, s[20:23], s62 offen lds
  s_add_u32 m0, s60, 6144
  s_add_u32 s62, s61, 98304
  buffer_load_dwordx4 v116, s[20:23], s62 offen lds
  s_add_u32 m0, s60, 7168
  s_add_u32 s62, s61, 114688
  buffer_load_dwordx4 v116, s[20:23], s62 offen lds
  s_cmp_eq_u32 s3, 1
  s_cbranch_scc1 L_lv_25
  s_cmp_eq_u32 s3, 2
  s_cbranch_scc1 L_lv_26
  s_cmp_eq_u32 s3, 3
  s_cbranch_scc1 L_lv_27
L_lv_24:
  ds_read_b64_tr_b16 a[32:33], v120 offset:32768
  ds_read_b64_tr_b16 a[34:35], v120 offset:33792
  ds_read_b64_tr_b16 a[36:37], v120 offset:36864
  ds_read_b64_tr_b16 a[38:39], v120 offset:37888
  ds_read_b64_tr_b16 a[40:41], v121 offset:32768
  ds_read_b64_tr_b16 a[42:43], v121 offset:33792
  ds_read_b64_tr_b16 a[44:45], v121 offset:36864
  ds_read_b64_tr_b16 a[46:47], v121 offset:37888
  ds_read_b64_tr_b16 a[48:49], v120 offset:49152
  ds_read_b64_tr_b16 a[50:51], v120 offset:50176
  ds_read_b64_tr_b16 a[52:53], v120 offset:53248
  ds_read_b64_tr_b16 a[54:55], v120 offset:54272
  ds_read_b64_tr_b16 a[56:57], v121 offset:49152
  ds_read_b64_tr_b16 a[58:59], v121 offset:50176
  ds_read_b64_tr_b16 a[60:61], v121 offset:53248
  ds_read_b64_tr_b16 a[62:63], v121 offset:54272
  s_branch L_lw_23
L_lv_25:
  ds_read_b64_tr_b16 a[0:1], v120 offset:32768
  ds_read_b64_tr_b16 a[2:3], v120 offset:33792
  ds_read_b64_tr_b16 a[4:5], v120 offset:36864
  ds_read_b64_tr_b16 a[6:7], v120 offset:37888
  ds_read_b64_tr_b16 a[8:9], v121 offset:32768
  ds_read_b64_tr_b16 a[10:11], v121 offset:33792
  ds_read_b64_tr_b16 a[12:13], v121 offset:36864
  ds_read_b64_tr_b16 a[14:15], v121 offset:37888
  ds_read_b64_tr_b16 a[16:17], v120 offset:49152
  ds_read_b64_tr_b16 a[18:19], v120 offset:50176
  ds_read_b64_tr_b16 a[20:21], v120 offset:53248
  ds_read_b64_tr_b16 a[22:23], v120 offset:54272
  ds_read_b64_tr_b16 a[24:25], v121 offset:49152
  ds_read_b64_tr_b16 a[26:27], v121 offset:50176
  ds_read_b64_tr_b16 a[28:29], v121 offset:53248
  ds_read_b64_tr_b16 a[30:31], v121 offset:54272
  s_branch L_lw_23
L_lv_26:
  ds_read_b64_tr_b16 a[96:97], v120 offset:32768
  ds_read_b64_tr_b16 a[98:99], v120 offset:33792
  ds_read_b64_tr_b16 a[100:101], v120 offset:36864
  ds_read_b64_tr_b16 a[102:103], v120 offset:37888
  ds_read_b64_tr_b16 a[104:105], v121 offset:32768
  ds_read_b64_tr_b16 a[106:107], v121 offset:33792
  ds_read_b64_tr_b16 a[108:109], v121 offset:36864
  ds_read_b64_tr_b16 a[110:111], v121 offset:37888
  ds_read_b64_tr_b16 a[112:113], v120 offset:49152
  ds_read_b64_tr_b16 a[114:115], v120 offset:50176
  ds_read_b64_tr_b16 a[116:117], v120 offset:53248
  ds_read_b64_tr_b16 a[118:119], v120 offset:54272
  ds_read_b64_tr_b16 a[120:121], v121 offset:49152
  ds_read_b64_tr_b16 a[122:123], v121 offset:50176
  ds_read_b64_tr_b16 a[124:125], v121 offset:53248
  ds_read_b64_tr_b16 a[126:127], v121 offset:54272
  s_branch L_lw_23
L_lv_27:
  ds_read_b64_tr_b16 a[64:65], v120 offset:32768
  ds_read_b64_tr_b16 a[66:67], v120 offset:33792
  ds_read_b64_tr_b16 a[68:69], v120 offset:36864
  ds_read_b64_tr_b16 a[70:71], v120 offset:37888
  ds_read_b64_tr_b16 a[72:73], v121 offset:32768
  ds_read_b64_tr_b16 a[74:75], v121 offset:33792
  ds_read_b64_tr_b16 a[76:77], v121 offset:36864
  ds_read_b64_tr_b16 a[78:79], v121 offset:37888
  ds_read_b64_tr_b16 a[80:81], v120 offset:49152
  ds_read_b64_tr_b16 a[82:83], v120 offset:50176
  ds_read_b64_tr_b16 a[84:85], v120 offset:53248
  ds_read_b64_tr_b16 a[86:87], v120 offset:54272
  ds_read_b64_tr_b16 a[88:89], v121 offset:49152
  ds_read_b64_tr_b16 a[90:91], v121 offset:50176
  ds_read_b64_tr_b16 a[92:93], v121 offset:53248
  ds_read_b64_tr_b16 a[94:95], v121 offset:54272
L_lw_23:
  s_waitcnt lgkmcnt(0)
  s_waitcnt vmcnt(16)
  s_barrier
  s_add_u32 s61, s63, 1048576
  s_add_u32 m0, s60, 32768
  s_add_u32 s62, s61, 0
  buffer_load_dwordx4 v116, s[20:23], s62 offen lds
  s_add_u32 m0, s60, 33792
  s_add_u32 s62, s61, 16384
  buffer_load_dwordx4 v116, s[20:23], s62 offen lds
  s_add_u32 m0, s60, 34816
  s_add_u32 s62, s61, 32768
  buffer_load_dwordx4 v116, s[20:23], s62 offen lds
  s_add_u32 m0, s60, 35840
  s_add_u32 s62, s61, 49152
  buffer_load_dwordx4 v116, s[20:23], s62 offen lds
  s_add_u32 m0, s60, 36864
  s_add_u32 s62, s61, 65536
  buffer_load_dwordx4 v116, s[20:23], s62 offen lds
  s_add_u32 m0, s60, 37888
  s_add_u32 s62, s61, 81920
  buffer_load_dwordx4 v116, s[20:23], s62 offen lds
  s_add_u32 m0, s60, 38912
  s_add_u32 s62, s61, 98304
  buffer_load_dwordx4 v116, s[20:23], s62 offen lds
  s_add_u32 m0, s60, 39936
  s_add_u32 s62, s61, 114688
  buffer_load_dwordx4 v116, s[20:23], s62 offen lds
  s_cmp_eq_u32 s3, 1
  s_cbranch_scc1 L_lv_30
  s_cmp_eq_u32 s3, 2
  s_cbranch_scc1 L_lv_31
  s_cmp_eq_u32 s3, 3
  s_cbranch_scc1 L_lv_32
L_lv_29:
  ds_read_b64_tr_b16 a[64:65], v122 offset:0
  ds_read_b64_tr_b16 a[66:67], v122 offset:1024
  ds_read_b64_tr_b16 a[68:69], v122 offset:4096
  ds_read_b64_tr_b16 a[70:71], v122 offset:5120
  ds_read_b64_tr_b16 a[72:73], v123 offset:0
  ds_read_b64_tr_b16 a[74:75], v123 offset:1024
  ds_read_b64_tr_b16 a[76:77], v123 offset:4096
  ds_read_b64_tr_b16 a[78:79], v123 offset:5120
  ds_read_b64_tr_b16 a[80:81], v122 offset:16384
  ds_read_b64_tr_b16 a[82:83], v122 offset:17408
  ds_read_b64_tr_b16 a[84:85], v122 offset:20480
  ds_read_b64_tr_b16 a[86:87], v122 offset:21504
  ds_read_b64_tr_b16 a[88:89], v123 offset:16384
  ds_read_b64_tr_b16 a[90:91], v123 offset:17408
  ds_read_b64_tr_b16 a[92:93], v123 offset:20480
  ds_read_b64_tr_b16 a[94:95], v123 offset:21504
  s_branch L_lw_28
L_lv_30:
  ds_read_b64_tr_b16 a[32:33], v122 offset:0
  ds_read_b64_tr_b16 a[34:35], v122 offset:1024
  ds_read_b64_tr_b16 a[36:37], v122 offset:4096
  ds_read_b64_tr_b16 a[38:39], v122 offset:5120
  ds_read_b64_tr_b16 a[40:41], v123 offset:0
  ds_read_b64_tr_b16 a[42:43], v123 offset:1024
  ds_read_b64_tr_b16 a[44:45], v123 offset:4096
  ds_read_b64_tr_b16 a[46:47], v123 offset:5120
  ds_read_b64_tr_b16 a[48:49], v122 offset:16384
  ds_read_b64_tr_b16 a[50:51], v122 offset:17408
  ds_read_b64_tr_b16 a[52:53], v122 offset:20480
  ds_read_b64_tr_b16 a[54:55], v122 offset:21504
  ds_read_b64_tr_b16 a[56:57], v123 offset:16384
  ds_read_b64_tr_b16 a[58:59], v123 offset:17408
  ds_read_b64_tr_b16 a[60:61], v123 offset:20480
  ds_read_b64_tr_b16 a[62:63], v123 offset:21504
  s_branch L_lw_28
L_lv_31:
  ds_read_b64_tr_b16 a[0:1], v122 offset:0
  ds_read_b64_tr_b16 a[2:3], v122 offset:1024
  ds_read_b64_tr_b16 a[4:5], v122 offset:4096
  ds_read_b64_tr_b16 a[6:7], v122 offset:5120
  ds_read_b64_tr_b16 a[8:9], v123 offset:0
  ds_read_b64_tr_b16 a[10:11], v123 offset:1024
  ds_read_b64_tr_b16 a[12:13], v123 offset:4096
  ds_read_b64_tr_b16 a[14:15], v123 offset:5120
  ds_read_b64_tr_b16 a[16:17], v122 offset:16384
  ds_read_b64_tr_b16 a[18:19], v122 offset:17408
  ds_read_b64_tr_b16 a[20:21], v122 offset:20480
  ds_read_b64_tr_b16 a[22:23], v122 offset:21504
  ds_read_b64_tr_b16 a[24:25], v123 offset:16384
  ds_read_b64_tr_b16 a[26:27], v123 offset:17408
  ds_read_b64_tr_b16 a[28:29], v123 offset:20480
  ds_read_b64_tr_b16 a[30:31], v123 offset:21504
  s_branch L_lw_28
L_lv_32:
  ds_read_b64_tr_b16 a[96:97], v122 offset:0
  ds_read_b64_tr_b16 a[98:99], v122 offset:1024
  ds_read_b64_tr_b16 a[100:101], v122 offset:4096
  ds_read_b64_tr_b16 a[102:103], v122 offset:5120
  ds_read_b64_tr_b16 a[104:105], v123 offset:0
  ds_read_b64_tr_b16 a[106:107], v123 offset:1024
  ds_read_b64_tr_b16 a[108:109], v123 offset:4096
  ds_read_b64_tr_b16 a[110:111], v123 offset:5120
  ds_read_b64_tr_b16 a[112:113], v122 offset:16384
  ds_read_b64_tr_b16 a[114:115], v122 offset:17408
  ds_read_b64_tr_b16 a[116:117], v122 offset:20480
  ds_read_b64_tr_b16 a[118:119], v122 offset:21504
  ds_read_b64_tr_b16 a[120:121], v123 offset:16384
  ds_read_b64_tr_b16 a[122:123], v123 offset:17408
  ds_read_b64_tr_b16 a[124:125], v123 offset:20480
  ds_read_b64_tr_b16 a[126:127], v123 offset:21504
L_lw_28:
  s_waitcnt lgkmcnt(0)
  s_waitcnt vmcnt(16)
  s_barrier
  s_add_u32 s61, s63, 2097152
  s_add_u32 m0, s60, 65536
  s_add_u32 s62, s61, 0
  buffer_load_dwordx4 v116, s[20:23], s62 offen lds
  s_add_u32 m0, s60, 66560
  s_add_u32 s62, s61, 16384
  buffer_load_dwordx4 v116, s[20:23], s62 offen lds
  s_add_u32 m0, s60, 67584
  s_add_u32 s62, s61, 32768
  buffer_load_dwordx4 v116, s[20:23], s62 offen lds
  s_add_u32 m0, s60, 68608
  s_add_u32 s62, s61, 49152
  buffer_load_dwordx4 v116, s[20:23], s62 offen lds
  s_add_u32 m0, s60, 69632
  s_add_u32 s62, s61, 65536
  buffer_load_dwordx4 v116, s[20:23], s62 offen lds
  s_add_u32 m0, s60, 70656
  s_add_u32 s62, s61, 81920
  buffer_load_dwordx4 v116, s[20:23], s62 offen lds
  s_add_u32 m0, s60, 71680
  s_add_u32 s62, s61, 98304
  buffer_load_dwordx4 v116, s[20:23], s62 offen lds
  s_add_u32 m0, s60, 72704
  s_add_u32 s62, s61, 114688
  buffer_load_dwordx4 v116, s[20:23], s62 offen lds
  s_cmp_eq_u32 s3, 1
  s_cbranch_scc1 L_lv_35
  s_cmp_eq_u32 s3, 2
  s_cbranch_scc1 L_lv_36
  s_cmp_eq_u32 s3, 3
  s_cbranch_scc1 L_lv_37
L_lv_34:
  ds_read_b64_tr_b16 a[96:97], v122 offset:32768
  ds_read_b64_tr_b16 a[98:99], v122 offset:33792
  ds_read_b64_tr_b16 a[100:101], v122 offset:36864
  ds_read_b64_tr_b16 a[102:103], v122 offset:37888
  ds_read_b64_tr_b16 a[104:105], v123 offset:32768
  ds_read_b64_tr_b16 a[106:107], v123 offset:33792
  ds_read_b64_tr_b16 a[108:109], v123 offset:36864
  ds_read_b64_tr_b16 a[110:111], v123 offset:37888
  ds_read_b64_tr_b16 a[112:113], v122 offset:49152
  ds_read_b64_tr_b16 a[114:115], v122 offset:50176
  ds_read_b64_tr_b16 a[116:117], v122 offset:53248
  ds_read_b64_tr_b16 a[118:119], v122 offset:54272
  ds_read_b64_tr_b16 a[120:121], v123 offset:49152
  ds_read_b64_tr_b16 a[122:123], v123 offset:50176
  ds_read_b64_tr_b16 a[124:125], v123 offset:53248
  ds_read_b64_tr_b16 a[126:127], v123 offset:54272
  s_branch L_lw_33
L_lv_35:
  ds_read_b64_tr_b16 a[64:65], v122 offset:32768
  ds_read_b64_tr_b16 a[66:67], v122 offset:33792
  ds_read_b64_tr_b16 a[68:69], v122 offset:36864
  ds_read_b64_tr_b16 a[70:71], v122 offset:37888
  ds_read_b64_tr_b16 a[72:73], v123 offset:32768
  ds_read_b64_tr_b16 a[74:75], v123 offset:33792
  ds_read_b64_tr_b16 a[76:77], v123 offset:36864
  ds_read_b64_tr_b16 a[78:79], v123 offset:37888
  ds_read_b64_tr_b16 a[80:81], v122 offset:49152
  ds_read_b64_tr_b16 a[82:83], v122 offset:50176
  ds_read_b64_tr_b16 a[84:85], v122 offset:53248
  ds_read_b64_tr_b16 a[86:87], v122 offset:54272
  ds_read_b64_tr_b16 a[88:89], v123 offset:49152
  ds_read_b64_tr_b16 a[90:91], v123 offset:50176
  ds_read_b64_tr_b16 a[92:93], v123 offset:53248
  ds_read_b64_tr_b16 a[94:95], v123 offset:54272
  s_branch L_lw_33
L_lv_36:
  ds_read_b64_tr_b16 a[32:33], v122 offset:32768
  ds_read_b64_tr_b16 a[34:35], v122 offset:33792
  ds_read_b64_tr_b16 a[36:37], v122 offset:36864
  ds_read_b64_tr_b16 a[38:39], v122 offset:37888
  ds_read_b64_tr_b16 a[40:41], v123 offset:32768
  ds_read_b64_tr_b16 a[42:43], v123 offset:33792
  ds_read_b64_tr_b16 a[44:45], v123 offset:36864
  ds_read_b64_tr_b16 a[46:47], v123 offset:37888
  ds_read_b64_tr_b16 a[48:49], v122 offset:49152
  ds_read_b64_tr_b16 a[50:51], v122 offset:50176
  ds_read_b64_tr_b16 a[52:53], v122 offset:53248
  ds_read_b64_tr_b16 a[54:55], v122 offset:54272
  ds_read_b64_tr_b16 a[56:57], v123 offset:49152
  ds_read_b64_tr_b16 a[58:59], v123 offset:50176
  ds_read_b64_tr_b16 a[60:61], v123 offset:53248
  ds_read_b64_tr_b16 a[62:63], v123 offset:54272
  s_branch L_lw_33
L_lv_37:
  ds_read_b64_tr_b16 a[0:1], v122 offset:32768
  ds_read_b64_tr_b16 a[2:3], v122 offset:33792
  ds_read_b64_tr_b16 a[4:5], v122 offset:36864
  ds_read_b64_tr_b16 a[6:7], v122 offset:37888
  ds_read_b64_tr_b16 a[8:9], v123 offset:32768
  ds_read_b64_tr_b16 a[10:11], v123 offset:33792
  ds_read_b64_tr_b16 a[12:13], v123 offset:36864
  ds_read_b64_tr_b16 a[14:15], v123 offset:37888
  ds_read_b64_tr_b16 a[16:17], v122 offset:49152
  ds_read_b64_tr_b16 a[18:19], v122 offset:50176
  ds_read_b64_tr_b16 a[20:21], v122 offset:53248
  ds_read_b64_tr_b16 a[22:23], v122 offset:54272
  ds_read_b64_tr_b16 a[24:25], v123 offset:49152
  ds_read_b64_tr_b16 a[26:27], v123 offset:50176
  ds_read_b64_tr_b16 a[28:29], v123 offset:53248
  ds_read_b64_tr_b16 a[30:31], v123 offset:54272
L_lw_33:
  s_waitcnt lgkmcnt(0)
  s_waitcnt vmcnt(16)
  s_barrier
  s_add_u32 s61, s63, 3145728
  s_add_u32 m0, s60, 98304
  s_add_u32 s62, s61, 0
  buffer_load_dwordx4 v116, s[20:23], s62 offen lds
  s_add_u32 m0, s60, 99328
  s_add_u32 s62, s61, 16384
  buffer_load_dwordx4 v116, s[20:23], s62 offen lds
  s_add_u32 m0, s60, 100352
  s_add_u32 s62, s61, 32768
  buffer_load_dwordx4 v116, s[20:23], s62 offen lds
  s_add_u32 m0, s60, 101376
  s_add_u32 s62, s61, 49152
  buffer_load_dwordx4 v116, s[20:23], s62 offen lds
  s_add_u32 m0, s60, 102400
  s_add_u32 s62, s61, 65536
  buffer_load_dwordx4 v116, s[20:23], s62 offen lds
  s_add_u32 m0, s60, 103424
  s_add_u32 s62, s61, 81920
  buffer_load_dwordx4 v116, s[20:23], s62 offen lds
  s_add_u32 m0, s60, 104448
  s_add_u32 s62, s61, 98304
  buffer_load_dwordx4 v116, s[20:23], s62 offen lds
  s_add_u32 m0, s60, 105472
  s_add_u32 s62, s61, 114688
  buffer_load_dwordx4 v116, s[20:23], s62 offen lds
  s_cmp_eq_u32 s3, 1
  s_cbranch_scc1 L_lv_40
  s_cmp_eq_u32 s3, 2
  s_cbranch_scc1 L_lv_41
  s_cmp_eq_u32 s3, 3
  s_cbranch_scc1 L_lv_42
L_lv_39:
  ds_read_b64_tr_b16 a[128:129], v120 offset:0
  ds_read_b64_tr_b16 a[130:131], v120 offset:1024
  ds_read_b64_tr_b16 a[132:133], v120 offset:4096
  ds_read_b64_tr_b16 a[134:135], v120 offset:5120
  ds_read_b64_tr_b16 a[136:137], v121 offset:0
  ds_read_b64_tr_b16 a[138:139], v121 offset:1024
  ds_read_b64_tr_b16 a[140:141], v121 offset:4096
  ds_read_b64_tr_b16 a[142:143], v121 offset:5120
  ds_read_b64_tr_b16 a[144:145], v120 offset:16384
  ds_read_b64_tr_b16 a[146:147], v120 offset:17408
  ds_read_b64_tr_b16 a[148:149], v120 offset:20480
  ds_read_b64_tr_b16 a[150:151], v120 offset:21504
  ds_read_b64_tr_b16 a[152:153], v121 offset:16384
  ds_read_b64_tr_b16 a[154:155], v121 offset:17408
  ds_read_b64_tr_b16 a[156:157], v121 offset:20480
  ds_read_b64_tr_b16 a[158:159], v121 offset:21504
  s_branch L_lw_38
L_lv_40:
  ds_read_b64_tr_b16 a[224:225], v120 offset:0
  ds_read_b64_tr_b16 a[226:227], v120 offset:1024
  ds_read_b64_tr_b16 a[228:229], v120 offset:4096
  ds_read_b64_tr_b16 a[230:231], v120 offset:5120
  ds_read_b64_tr_b16 a[232:233], v121 offset:0
  ds_read_b64_tr_b16 a[234:235], v121 offset:1024
  ds_read_b64_tr_b16 a[236:237], v121 offset:4096
  ds_read_b64_tr_b16 a[238:239], v121 offset:5120
  ds_read_b64_tr_b16 a[240:241], v120 offset:16384
  ds_read_b64_tr_b16 a[242:243], v120 offset:17408
  ds_read_b64_tr_b16 a[244:245], v120 offset:20480
  ds_read_b64_tr_b16 a[246:247], v120 offset:21504
  ds_read_b64_tr_b16 a[248:249], v121 offset:16384
  ds_read_b64_tr_b16 a[250:251], v121 offset:17408
  ds_read_b64_tr_b16 a[252:253], v121 offset:20480
  ds_read_b64_tr_b16 a[254:255], v121 offset:21504
  s_branch L_lw_38
L_lv_41:
  ds_read_b64_tr_b16 a[192:193], v120 offset:0
  ds_read_b64_tr_b16 a[194:195], v120 offset:1024
  ds_read_b64_tr_b16 a[196:197], v120 offset:4096
  ds_read_b64_tr_b16 a[198:199], v120 offset:5120
  ds_read_b64_tr_b16 a[200:201], v121 offset:0
  ds_read_b64_tr_b16 a[202:203], v121 offset:1024
  ds_read_b64_tr_b16 a[204:205], v121 offset:4096
  ds_read_b64_tr_b16 a[206:207], v121 offset:5120
  ds_read_b64_tr_b16 a[208:209], v120 offset:16384
  ds_read_b64_tr_b16 a[210:211], v120 offset:17408
  ds_read_b64_tr_b16 a[212:213], v120 offset:20480
  ds_read_b64_tr_b16 a[214:215], v120 offset:21504
  ds_read_b64_tr_b16 a[216:217], v121 offset:16384
  ds_read_b64_tr_b16 a[218:219], v121 offset:17408
  ds_read_b64_tr_b16 a[220:221], v121 offset:20480
  ds_read_b64_tr_b16 a[222:223], v121 offset:21504
  s_branch L_lw_38
L_lv_42:
  ds_read_b64_tr_b16 a[160:161], v120 offset:0
  ds_read_b64_tr_b16 a[162:163], v120 offset:1024
  ds_read_b64_tr_b16 a[164:165], v120 offset:4096
  ds_read_b64_tr_b16 a[166:167], v120 offset:5120
  ds_read_b64_tr_b16 a[168:169], v121 offset:0
  ds_read_b64_tr_b16 a[170:171], v121 offset:1024
  ds_read_b64_tr_b16 a[172:173], v121 offset:4096
  ds_read_b64_tr_b16 a[174:175], v121 offset:5120
  ds_read_b64_tr_b16 a[176:177], v120 offset:16384
  ds_read_b64_tr_b16 a[178:179], v120 offset:17408
  ds_read_b64_tr_b16 a[180:181], v120 offset:20480
  ds_read_b64_tr_b16 a[182:183], v120 offset:21504
  ds_read_b64_tr_b16 a[184:185], v121 offset:16384
  ds_read_b64_tr_b16 a[186:187], v121 offset:17408
  ds_read_b64_tr_b16 a[188:189], v121 offset:20480
  ds_read_b64_tr_b16 a[190:191], v121 offset:21504
L_lw_38:
  s_waitcnt lgkmcnt(0)
  s_waitcnt vmcnt(16)
  s_barrier
  s_add_u32 s61, s63, 0
  s_add_u32 m0, s60, 0
  s_add_u32 s62, s61, 0
  buffer_load_dwordx4 v116, s[24:27], s62 offen lds
  s_add_u32 m0, s60, 1024
  s_add_u32 s62, s61, 16384
  buffer_load_dwordx4 v116, s[24:27], s62 offen lds
  s_add_u32 m0, s60, 2048
  s_add_u32 s62, s61, 32768
  buffer_load_dwordx4 v116, s[24:27], s62 offen lds
  s_add_u32 m0, s60, 3072
  s_add_u32 s62, s61, 49152
  buffer_load_dwordx4 v116, s[24:27], s62 offen lds
  s_add_u32 m0, s60, 4096
  s_add_u32 s62, s61, 65536
  buffer_load_dwordx4 v116, s[24:27], s62 offen lds
  s_add_u32 m0, s60, 5120
  s_add_u32 s62, s61, 81920
  buffer_load_dwordx4 v116, s[24:27], s62 offen lds
  s_add_u32 m0, s60, 6144
  s_add_u32 s62, s61, 98304
  buffer_load_dwordx4 v116, s[24:27], s62 offen lds
  s_add_u32 m0, s60, 7168
  s_add_u32 s62, s61, 114688
  buffer_load_dwordx4 v116, s[24:27], s62 offen lds
  s_cmp_eq_u32 s3, 1
  s_cbranch_scc1 L_lv_45
  s_cmp_eq_u32 s3, 2
  s_cbranch_scc1 L_lv_46
  s_cmp_eq_u32 s3, 3
  s_cbranch_scc1 L_lv_47
L_lv_44:
  ds_read_b64_tr_b16 a[160:161], v120 offset:32768
  ds_read_b64_tr_b16 a[162:163], v120 offset:33792
  ds_read_b64_tr_b16 a[164:165], v120 offset:36864
  ds_read_b64_tr_b16 a[166:167], v120 offset:37888
  ds_read_b64_tr_b16 a[168:169], v121 offset:32768
  ds_read_b64_tr_b16 a[170:171], v121 offset:33792
  ds_read_b64_tr_b16 a[172:173], v121 offset:36864
  ds_read_b64_tr_b16 a[174:175], v121 offset:37888
  ds_read_b64_tr_b16 a[176:177], v120 offset:49152
  ds_read_b64_tr_b16 a[178:179], v120 offset:50176
  ds_read_b64_tr_b16 a[180:181], v120 offset:53248
  ds_read_b64_tr_b16 a[182:183], v120 offset:54272
  ds_read_b64_tr_b16 a[184:185], v121 offset:49152
  ds_read_b64_tr_b16 a[186:187], v121 offset:50176
  ds_read_b64_tr_b16 a[188:189], v121 offset:53248
  ds_read_b64_tr_b16 a[190:191], v121 offset:54272
  s_branch L_lw_43
L_lv_45:
  ds_read_b64_tr_b16 a[128:129], v120 offset:32768
  ds_read_b64_tr_b16 a[130:131], v120 offset:33792
  ds_read_b64_tr_b16 a[132:133], v120 offset:36864
  ds_read_b64_tr_b16 a[134:135], v120 offset:37888
  ds_read_b64_tr_b16 a[136:137], v121 offset:32768
  ds_read_b64_tr_b16 a[138:139], v121 offset:33792
  ds_read_b64_tr_b16 a[140:141], v121 offset:36864
  ds_read_b64_tr_b16 a[142:143], v121 offset:37888
  ds_read_b64_tr_b16 a[144:145], v120 offset:49152
  ds_read_b64_tr_b16 a[146:147], v120 offset:50176
  ds_read_b64_tr_b16 a[148:149], v120 offset:53248
  ds_read_b64_tr_b16 a[150:151], v120 offset:54272
  ds_read_b64_tr_b16 a[152:153], v121 offset:49152
  ds_read_b64_tr_b16 a[154:155], v121 offset:50176
  ds_read_b64_tr_b16 a[156:157], v121 offset:53248
  ds_read_b64_tr_b16 a[158:159], v121 offset:54272
  s_branch L_lw_43
L_lv_46:
  ds_read_b64_tr_b16 a[224:225], v120 offset:32768
  ds_read_b64_tr_b16 a[226:227], v120 offset:33792
  ds_read_b64_tr_b16 a[228:229], v120 offset:36864
  ds_read_b64_tr_b16 a[230:231], v120 offset:37888
  ds_read_b64_tr_b16 a[232:233], v121 offset:32768
  ds_read_b64_tr_b16 a[234:235], v121 offset:33792
  ds_read_b64_tr_b16 a[236:237], v121 offset:36864
  ds_read_b64_tr_b16 a[238:239], v121 offset:37888
  ds_read_b64_tr_b16 a[240:241], v120 offset:49152
  ds_read_b64_tr_b16 a[242:243], v120 offset:50176
  ds_read_b64_tr_b16 a[244:245], v120 offset:53248
  ds_read_b64_tr_b16 a[246:247], v120 offset:54272
  ds_read_b64_tr_b16 a[248:249], v121 offset:49152
  ds_read_b64_tr_b16 a[250:251], v121 offset:50176
  ds_read_b64_tr_b16 a[252:253], v121 offset:53248
  ds_read_b64_tr_b16 a[254:255], v121 offset:54272
  s_branch L_lw_43
L_lv_47:
  ds_read_b64_tr_b16 a[192:193], v120 offset:32768
  ds_read_b64_tr_b16 a[194:195], v120 offset:33792
  ds_read_b64_tr_b16 a[196:197], v120 offset:36864
  ds_read_b64_tr_b16 a[198:199], v120 offset:37888
  ds_read_b64_tr_b16 a[200:201], v121 offset:32768
  ds_read_b64_tr_b16 a[202:203], v121 offset:33792
  ds_read_b64_tr_b16 a[204:205], v121 offset:36864
  ds_read_b64_tr_b16 a[206:207], v121 offset:37888
  ds_read_b64_tr_b16 a[208:209], v120 offset:49152
  ds_read_b64_tr_b16 a[210:211], v120 offset:50176
  ds_read_b64_tr_b16 a[212:213], v120 offset:53248
  ds_read_b64_tr_b16 a[214:215], v120 offset:54272
  ds_read_b64_tr_b16 a[216:217], v121 offset:49152
  ds_read_b64_tr_b16 a[218:219], v121 offset:50176
  ds_read_b64_tr_b16 a[220:221], v121 offset:53248
  ds_read_b64_tr_b16 a[222:223], v121 offset:54272
L_lw_43:
  s_waitcnt lgkmcnt(0)
  s_waitcnt vmcnt(16)
  s_barrier
  s_add_u32 s61, s63, 1048576
  s_add_u32 m0, s60, 32768
  s_add_u32 s62, s61, 0
  buffer_load_dwordx4 v116, s[24:27], s62 offen lds
  s_add_u32 m0, s60, 33792
  s_add_u32 s62, s61, 16384
  buffer_load_dwordx4 v116, s[24:27], s62 offen lds
  s_add_u32 m0, s60, 34816
  s_add_u32 s62, s61, 32768
  buffer_load_dwordx4 v116, s[24:27], s62 offen lds
  s_add_u32 m0, s60, 35840
  s_add_u32 s62, s61, 49152
  buffer_load_dwordx4 v116, s[24:27], s62 offen lds
  s_add_u32 m0, s60, 36864
  s_add_u32 s62, s61, 65536
  buffer_load_dwordx4 v116, s[24:27], s62 offen lds
  s_add_u32 m0, s60, 37888
  s_add_u32 s62, s61, 81920
  buffer_load_dwordx4 v116, s[24:27], s62 offen lds
  s_add_u32 m0, s60, 38912
  s_add_u32 s62, s61, 98304
  buffer_load_dwordx4 v116, s[24:27], s62 offen lds
  s_add_u32 m0, s60, 39936
  s_add_u32 s62, s61, 114688
  buffer_load_dwordx4 v116, s[24:27], s62 offen lds
  s_cmp_eq_u32 s3, 1
  s_cbranch_scc1 L_lv_50
  s_cmp_eq_u32 s3, 2
  s_cbranch_scc1 L_lv_51
  s_cmp_eq_u32 s3, 3
  s_cbranch_scc1 L_lv_52
L_lv_49:
  ds_read_b64_tr_b16 a[192:193], v122 offset:0
  ds_read_b64_tr_b16 a[194:195], v122 offset:1024
  ds_read_b64_tr_b16 a[196:197], v122 offset:4096
  ds_read_b64_tr_b16 a[198:199], v122 offset:5120
  ds_read_b64_tr_b16 a[200:201], v123 offset:0
  ds_read_b64_tr_b16 a[202:203], v123 offset:1024
  ds_read_b64_tr_b16 a[204:205], v123 offset:4096
  ds_read_b64_tr_b16 a[206:207], v123 offset:5120
  ds_read_b64_tr_b16 a[208:209], v122 offset:16384
  ds_read_b64_tr_b16 a[210:211], v122 offset:17408
  ds_read_b64_tr_b16 a[212:213], v122 offset:20480
  ds_read_b64_tr_b16 a[214:215], v122 offset:21504
  ds_read_b64_tr_b16 a[216:217], v123 offset:16384
  ds_read_b64_tr_b16 a[218:219], v123 offset:17408
  ds_read_b64_tr_b16 a[220:221], v123 offset:20480
  ds_read_b64_tr_b16 a[222:223], v123 offset:21504
  s_branch L_lw_48
L_lv_50:
  ds_read_b64_tr_b16 a[160:161], v122 offset:0
  ds_read_b64_tr_b16 a[162:163], v122 offset:1024
  ds_read_b64_tr_b16 a[164:165], v122 offset:4096
  ds_read_b64_tr_b16 a[166:167], v122 offset:5120
  ds_read_b64_tr_b16 a[168:169], v123 offset:0
  ds_read_b64_tr_b16 a[170:171], v123 offset:1024
  ds_read_b64_tr_b16 a[172:173], v123 offset:4096
  ds_read_b64_tr_b16 a[174:175], v123 offset:5120
  ds_read_b64_tr_b16 a[176:177], v122 offset:16384
  ds_read_b64_tr_b16 a[178:179], v122 offset:17408
  ds_read_b64_tr_b16 a[180:181], v122 offset:20480
  ds_read_b64_tr_b16 a[182:183], v122 offset:21504
  ds_read_b64_tr_b16 a[184:185], v123 offset:16384
  ds_read_b64_tr_b16 a[186:187], v123 offset:17408
  ds_read_b64_tr_b16 a[188:189], v123 offset:20480
  ds_read_b64_tr_b16 a[190:191], v123 offset:21504
  s_branch L_lw_48
L_lv_51:
  ds_read_b64_tr_b16 a[128:129], v122 offset:0
  ds_read_b64_tr_b16 a[130:131], v122 offset:1024
  ds_read_b64_tr_b16 a[132:133], v122 offset:4096
  ds_read_b64_tr_b16 a[134:135], v122 offset:5120
  ds_read_b64_tr_b16 a[136:137], v123 offset:0
  ds_read_b64_tr_b16 a[138:139], v123 offset:1024
  ds_read_b64_tr_b16 a[140:141], v123 offset:4096
  ds_read_b64_tr_b16 a[142:143], v123 offset:5120
  ds_read_b64_tr_b16 a[144:145], v122 offset:16384
  ds_read_b64_tr_b16 a[146:147], v122 offset:17408
  ds_read_b64_tr_b16 a[148:149], v122 offset:20480
  ds_read_b64_tr_b16 a[150:151], v122 offset:21504
  ds_read_b64_tr_b16 a[152:153], v123 offset:16384
  ds_read_b64_tr_b16 a[154:155], v123 offset:17408
  ds_read_b64_tr_b16 a[156:157], v123 offset:20480
  ds_read_b64_tr_b16 a[158:159], v123 offset:21504
  s_branch L_lw_48
L_lv_52:
  ds_read_b64_tr_b16 a[224:225], v122 offset:0
  ds_read_b64_tr_b16 a[226:227], v122 offset:1024
  ds_read_b64_tr_b16 a[228:229], v122 offset:4096
  ds_read_b64_tr_b16 a[230:231], v122 offset:5120
  ds_read_b64_tr_b16 a[232:233], v123 offset:0
  ds_read_b64_tr_b16 a[234:235], v123 offset:1024
  ds_read_b64_tr_b16 a[236:237], v123 offset:4096
  ds_read_b64_tr_b16 a[238:239], v123 offset:5120
  ds_read_b64_tr_b16 a[240:241], v122 offset:16384
  ds_read_b64_tr_b16 a[242:243], v122 offset:17408
  ds_read_b64_tr_b16 a[244:245], v122 offset:20480
  ds_read_b64_tr_b16 a[246:247], v122 offset:21504
  ds_read_b64_tr_b16 a[248:249], v123 offset:16384
  ds_read_b64_tr_b16 a[250:251], v123 offset:17408
  ds_read_b64_tr_b16 a[252:253], v123 offset:20480
  ds_read_b64_tr_b16 a[254:255], v123 offset:21504
L_lw_48:
  s_waitcnt lgkmcnt(0)
  s_waitcnt vmcnt(16)
  s_barrier
  s_add_u32 s61, s63, 2097152
  s_add_u32 m0, s60, 65536
  s_add_u32 s62, s61, 0
  buffer_load_dwordx4 v116, s[24:27], s62 offen lds
  s_add_u32 m0, s60, 66560
  s_add_u32 s62, s61, 16384
  buffer_load_dwordx4 v116, s[24:27], s62 offen lds
  s_add_u32 m0, s60, 67584
  s_add_u32 s62, s61, 32768
  buffer_load_dwordx4 v116, s[24:27], s62 offen lds
  s_add_u32 m0, s60, 68608
  s_add_u32 s62, s61, 49152
  buffer_load_dwordx4 v116, s[24:27], s62 offen lds
  s_add_u32 m0, s60, 69632
  s_add_u32 s62, s61, 65536
  buffer_load_dwordx4 v116, s[24:27], s62 offen lds
  s_add_u32 m0, s60, 70656
  s_add_u32 s62, s61, 81920
  buffer_load_dwordx4 v116, s[24:27], s62 offen lds
  s_add_u32 m0, s60, 71680
  s_add_u32 s62, s61, 98304
  buffer_load_dwordx4 v116, s[24:27], s62 offen lds
  s_add_u32 m0, s60, 72704
  s_add_u32 s62, s61, 114688
  buffer_load_dwordx4 v116, s[24:27], s62 offen lds
  s_cmp_eq_u32 s3, 1
  s_cbranch_scc1 L_lv_55
  s_cmp_eq_u32 s3, 2
  s_cbranch_scc1 L_lv_56
  s_cmp_eq_u32 s3, 3
  s_cbranch_scc1 L_lv_57
L_lv_54:
  ds_read_b64_tr_b16 a[224:225], v122 offset:32768
  ds_read_b64_tr_b16 a[226:227], v122 offset:33792
  ds_read_b64_tr_b16 a[228:229], v122 offset:36864
  ds_read_b64_tr_b16 a[230:231], v122 offset:37888
  ds_read_b64_tr_b16 a[232:233], v123 offset:32768
  ds_read_b64_tr_b16 a[234:235], v123 offset:33792
  ds_read_b64_tr_b16 a[236:237], v123 offset:36864
  ds_read_b64_tr_b16 a[238:239], v123 offset:37888
  ds_read_b64_tr_b16 a[240:241], v122 offset:49152
  ds_read_b64_tr_b16 a[242:243], v122 offset:50176
  ds_read_b64_tr_b16 a[244:245], v122 offset:53248
  ds_read_b64_tr_b16 a[246:247], v122 offset:54272
  ds_read_b64_tr_b16 a[248:249], v123 offset:49152
  ds_read_b64_tr_b16 a[250:251], v123 offset:50176
  ds_read_b64_tr_b16 a[252:253], v123 offset:53248
  ds_read_b64_tr_b16 a[254:255], v123 offset:54272
  s_branch L_lw_53
L_lv_55:
  ds_read_b64_tr_b16 a[192:193], v122 offset:32768
  ds_read_b64_tr_b16 a[194:195], v122 offset:33792
  ds_read_b64_tr_b16 a[196:197], v122 offset:36864
  ds_read_b64_tr_b16 a[198:199], v122 offset:37888
  ds_read_b64_tr_b16 a[200:201], v123 offset:32768
  ds_read_b64_tr_b16 a[202:203], v123 offset:33792
  ds_read_b64_tr_b16 a[204:205], v123 offset:36864
  ds_read_b64_tr_b16 a[206:207], v123 offset:37888
  ds_read_b64_tr_b16 a[208:209], v122 offset:49152
  ds_read_b64_tr_b16 a[210:211], v122 offset:50176
  ds_read_b64_tr_b16 a[212:213], v122 offset:53248
  ds_read_b64_tr_b16 a[214:215], v122 offset:54272
  ds_read_b64_tr_b16 a[216:217], v123 offset:49152
  ds_read_b64_tr_b16 a[218:219], v123 offset:50176
  ds_read_b64_tr_b16 a[220:221], v123 offset:53248
  ds_read_b64_tr_b16 a[222:223], v123 offset:54272
  s_branch L_lw_53
L_lv_56:
  ds_read_b64_tr_b16 a[160:161], v122 offset:32768
  ds_read_b64_tr_b16 a[162:163], v122 offset:33792
  ds_read_b64_tr_b16 a[164:165], v122 offset:36864
  ds_read_b64_tr_b16 a[166:167], v122 offset:37888
  ds_read_b64_tr_b16 a[168:169], v123 offset:32768
  ds_read_b64_tr_b16 a[170:171], v123 offset:33792
  ds_read_b64_tr_b16 a[172:173], v123 offset:36864
  ds_read_b64_tr_b16 a[174:175], v123 offset:37888
  ds_read_b64_tr_b16 a[176:177], v122 offset:49152
  ds_read_b64_tr_b16 a[178:179], v122 offset:50176
  ds_read_b64_tr_b16 a[180:181], v122 offset:53248
  ds_read_b64_tr_b16 a[182:183], v122 offset:54272
  ds_read_b64_tr_b16 a[184:185], v123 offset:49152
  ds_read_b64_tr_b16 a[186:187], v123 offset:50176
  ds_read_b64_tr_b16 a[188:189], v123 offset:53248
  ds_read_b64_tr_b16 a[190:191], v123 offset:54272
  s_branch L_lw_53
L_lv_57:
  ds_read_b64_tr_b16 a[128:129], v122 offset:32768
  ds_read_b64_tr_b16 a[130:131], v122 offset:33792
  ds_read_b64_tr_b16 a[132:133], v122 offset:36864
  ds_read_b64_tr_b16 a[134:135], v122 offset:37888
  ds_read_b64_tr_b16 a[136:137], v123 offset:32768
  ds_read_b64_tr_b16 a[138:139], v123 offset:33792
  ds_read_b64_tr_b16 a[140:141], v123 offset:36864
  ds_read_b64_tr_b16 a[142:143], v123 offset:37888
  ds_read_b64_tr_b16 a[144:145], v122 offset:49152
  ds_read_b64_tr_b16 a[146:147], v122 offset:50176
  ds_read_b64_tr_b16 a[148:149], v122 offset:53248
  ds_read_b64_tr_b16 a[150:151], v122 offset:54272
  ds_read_b64_tr_b16 a[152:153], v123 offset:49152
  ds_read_b64_tr_b16 a[154:155], v123 offset:50176
  ds_read_b64_tr_b16 a[156:157], v123 offset:53248
  ds_read_b64_tr_b16 a[158:159], v123 offset:54272
L_lw_53:
  s_waitcnt lgkmcnt(0)
  s_waitcnt vmcnt(16)
  s_barrier
  s_add_u32 s61, s63, 3145728
  s_add_u32 m0, s60, 98304
  s_add_u32 s62, s61, 0
  buffer_load_dwordx4 v116, s[24:27], s62 offen lds
  s_add_u32 m0, s60, 99328
  s_add_u32 s62, s61, 16384
  buffer_load_dwordx4 v116, s[24:27], s62 offen lds
  s_add_u32 m0, s60, 100352
  s_add_u32 s62, s61, 32768
  buffer_load_dwordx4 v116, s[24:27], s62 offen lds
  s_add_u32 m0, s60, 101376
  s_add_u32 s62, s61, 49152
  buffer_load_dwordx4 v116, s[24:27], s62 offen lds
  s_add_u32 m0, s60, 102400
  s_add_u32 s62, s61, 65536
  buffer_load_dwordx4 v116, s[24:27], s62 offen lds
  s_add_u32 m0, s60, 103424
  s_add_u32 s62, s61, 81920
  buffer_load_dwordx4 v116, s[24:27], s62 offen lds
  s_add_u32 m0, s60, 104448
  s_add_u32 s62, s61, 98304
  buffer_load_dwordx4 v116, s[24:27], s62 offen lds
  s_add_u32 m0, s60, 105472
  s_add_u32 s62, s61, 114688
  buffer_load_dwordx4 v116, s[24:27], s62 offen lds
  s_cmp_eq_u32 s3, 1
  s_cbranch_scc1 L_lv_60
  s_cmp_eq_u32 s3, 2
  s_cbranch_scc1 L_lv_61
  s_cmp_eq_u32 s3, 3
  s_cbranch_scc1 L_lv_62
L_lv_59:
  ds_read_b64_tr_b16 v[128:129], v120 offset:0
  ds_read_b64_tr_b16 v[130:131], v120 offset:1024
  ds_read_b64_tr_b16 v[132:133], v120 offset:4096
  ds_read_b64_tr_b16 v[134:135], v120 offset:5120
  ds_read_b64_tr_b16 v[136:137], v121 offset:0
  ds_read_b64_tr_b16 v[138:139], v121 offset:1024
  ds_read_b64_tr_b16 v[140:141], v121 offset:4096
  ds_read_b64_tr_b16 v[142:143], v121 offset:5120
  ds_read_b64_tr_b16 v[144:145], v120 offset:16384
  ds_read_b64_tr_b16 v[146:147], v120 offset:17408
  ds_read_b64_tr_b16 v[148:149], v120 offset:20480
  ds_read_b64_tr_b16 v[150:151], v120 offset:21504
  ds_read_b64_tr_b16 v[152:153], v121 offset:16384
  ds_read_b64_tr_b16 v[154:155], v121 offset:17408
  ds_read_b64_tr_b16 v[156:157], v121 offset:20480
  ds_read_b64_tr_b16 v[158:159], v121 offset:21504
  s_branch L_lw_58
L_lv_60:
  ds_read_b64_tr_b16 v[224:225], v120 offset:0
  ds_read_b64_tr_b16 v[226:227], v120 offset:1024
  ds_read_b64_tr_b16 v[228:229], v120 offset:4096
  ds_read_b64_tr_b16 v[230:231], v120 offset:5120
  ds_read_b64_tr_b16 v[232:233], v121 offset:0
  ds_read_b64_tr_b16 v[234:235], v121 offset:1024
  ds_read_b64_tr_b16 v[236:237], v121 offset:4096
  ds_read_b64_tr_b16 v[238:239], v121 offset:5120
  ds_read_b64_tr_b16 v[240:241], v120 offset:16384
  ds_read_b64_tr_b16 v[242:243], v120 offset:17408
  ds_read_b64_tr_b16 v[244:245], v120 offset:20480
  ds_read_b64_tr_b16 v[246:247], v120 offset:21504
  ds_read_b64_tr_b16 v[248:249], v121 offset:16384
  ds_read_b64_tr_b16 v[250:251], v121 offset:17408
  ds_read_b64_tr_b16 v[252:253], v121 offset:20480
  ds_read_b64_tr_b16 v[254:255], v121 offset:21504
  s_branch L_lw_58
L_lv_61:
  ds_read_b64_tr_b16 v[192:193], v120 offset:0
  ds_read_b64_tr_b16 v[194:195], v120 offset:1024
  ds_read_b64_tr_b16 v[196:197], v120 offset:4096
  ds_read_b64_tr_b16 v[198:199], v120 offset:5120
  ds_read_b64_tr_b16 v[200:201], v121 offset:0
  ds_read_b64_tr_b16 v[202:203], v121 offset:1024
  ds_read_b64_tr_b16 v[204:205], v121 offset:4096
  ds_read_b64_tr_b16 v[206:207], v121 offset:5120
  ds_read_b64_tr_b16 v[208:209], v120 offset:16384
  ds_read_b64_tr_b16 v[210:211], v120 offset:17408
  ds_read_b64_tr_b16 v[212:213], v120 offset:20480
  ds_read_b64_tr_b16 v[214:215], v120 offset:21504
  ds_read_b64_tr_b16 v[216:217], v121 offset:16384
  ds_read_b64_tr_b16 v[218:219], v121 offset:17408
  ds_read_b64_tr_b16 v[220:221], v121 offset:20480
  ds_read_b64_tr_b16 v[222:223], v121 offset:21504
  s_branch L_lw_58
L_lv_62:
  ds_read_b64_tr_b16 v[160:161], v120 offset:0
  ds_read_b64_tr_b16 v[162:163], v120 offset:1024
  ds_read_b64_tr_b16 v[164:165], v120 offset:4096
  ds_read_b64_tr_b16 v[166:167], v120 offset:5120
  ds_read_b64_tr_b16 v[168:169], v121 offset:0
  ds_read_b64_tr_b16 v[170:171], v121 offset:1024
  ds_read_b64_tr_b16 v[172:173], v121 offset:4096
  ds_read_b64_tr_b16 v[174:175], v121 offset:5120
  ds_read_b64_tr_b16 v[176:177], v120 offset:16384
  ds_read_b64_tr_b16 v[178:179], v120 offset:17408
  ds_read_b64_tr_b16 v[180:181], v120 offset:20480
  ds_read_b64_tr_b16 v[182:183], v120 offset:21504
  ds_read_b64_tr_b16 v[184:185], v121 offset:16384
  ds_read_b64_tr_b16 v[186:187], v121 offset:17408
  ds_read_b64_tr_b16 v[188:189], v121 offset:20480
  ds_read_b64_tr_b16 v[190:191], v121 offset:21504
L_lw_58:
  s_waitcnt lgkmcnt(0)
  s_waitcnt vmcnt(16)
  s_barrier
  s_lshl_b32 s61, s5, 17
  s_lshl_b32 s62, s3, 15
  s_add_u32 s61, s61, s62
  s_add_u32 s61, s61, 0
  s_add_u32 m0, s60, 0
  s_add_u32 s62, s61, 0
  buffer_load_dwordx4 v118, s[28:31], s62 offen lds
  s_add_u32 m0, s60, 1024
  s_add_u32 s62, s61, 4096
  buffer_load_dwordx4 v118, s[28:31], s62 offen lds
  s_add_u32 m0, s60, 2048
  s_add_u32 s62, s61, 8192
  buffer_load_dwordx4 v119, s[28:31], s62 offen lds
  s_add_u32 m0, s60, 3072
  s_add_u32 s62, s61, 12288
  buffer_load_dwordx4 v119, s[28:31], s62 offen lds
  s_add_u32 m0, s60, 4096
  s_add_u32 s62, s61, 16384
  buffer_load_dwordx4 v118, s[28:31], s62 offen lds
  s_add_u32 m0, s60, 5120
  s_add_u32 s62, s61, 20480
  buffer_load_dwordx4 v118, s[28:31], s62 offen lds
  s_add_u32 m0, s60, 6144
  s_add_u32 s62, s61, 24576
  buffer_load_dwordx4 v119, s[28:31], s62 offen lds
  s_add_u32 m0, s60, 7168
  s_add_u32 s62, s61, 28672
  buffer_load_dwordx4 v119, s[28:31], s62 offen lds
  s_cmp_eq_u32 s3, 1
  s_cbranch_scc1 L_lv_65
  s_cmp_eq_u32 s3, 2
  s_cbranch_scc1 L_lv_66
  s_cmp_eq_u32 s3, 3
  s_cbranch_scc1 L_lv_67
L_lv_64:
  ds_read_b64_tr_b16 v[160:161], v120 offset:32768
  ds_read_b64_tr_b16 v[162:163], v120 offset:33792
  ds_read_b64_tr_b16 v[164:165], v120 offset:36864
  ds_read_b64_tr_b16 v[166:167], v120 offset:37888
  ds_read_b64_tr_b16 v[168:169], v121 offset:32768
  ds_read_b64_tr_b16 v[170:171], v121 offset:33792
  ds_read_b64_tr_b16 v[172:173], v121 offset:36864
  ds_read_b64_tr_b16 v[174:175], v121 offset:37888
  ds_read_b64_tr_b16 v[176:177], v120 offset:49152
  ds_read_b64_tr_b16 v[178:179], v120 offset:50176
  ds_read_b64_tr_b16 v[180:181], v120 offset:53248
  ds_read_b64_tr_b16 v[182:183], v120 offset:54272
  ds_read_b64_tr_b16 v[184:185], v121 offset:49152
  ds_read_b64_tr_b16 v[186:187], v121 offset:50176
  ds_read_b64_tr_b16 v[188:189], v121 offset:53248
  ds_read_b64_tr_b16 v[190:191], v121 offset:54272
  s_branch L_lw_63
L_lv_65:
  ds_read_b64_tr_b16 v[128:129], v120 offset:32768
  ds_read_b64_tr_b16 v[130:131], v120 offset:33792
  ds_read_b64_tr_b16 v[132:133], v120 offset:36864
  ds_read_b64_tr_b16 v[134:135], v120 offset:37888
  ds_read_b64_tr_b16 v[136:137], v121 offset:32768
  ds_read_b64_tr_b16 v[138:139], v121 offset:33792
  ds_read_b64_tr_b16 v[140:141], v121 offset:36864
  ds_read_b64_tr_b16 v[142:143], v121 offset:37888
  ds_read_b64_tr_b16 v[144:145], v120 offset:49152
  ds_read_b64_tr_b16 v[146:147], v120 offset:50176
  ds_read_b64_tr_b16 v[148:149], v120 offset:53248
  ds_read_b64_tr_b16 v[150:151], v120 offset:54272
  ds_read_b64_tr_b16 v[152:153], v121 offset:49152
  ds_read_b64_tr_b16 v[154:155], v121 offset:50176
  ds_read_b64_tr_b16 v[156:157], v121 offset:53248
  ds_read_b64_tr_b16 v[158:159], v121 offset:54272
  s_branch L_lw_63
L_lv_66:
  ds_read_b64_tr_b16 v[224:225], v120 offset:32768
  ds_read_b64_tr_b16 v[226:227], v120 offset:33792
  ds_read_b64_tr_b16 v[228:229], v120 offset:36864
  ds_read_b64_tr_b16 v[230:231], v120 offset:37888
  ds_read_b64_tr_b16 v[232:233], v121 offset:32768
  ds_read_b64_tr_b16 v[234:235], v121 offset:33792
  ds_read_b64_tr_b16 v[236:237], v121 offset:36864
  ds_read_b64_tr_b16 v[238:239], v121 offset:37888
  ds_read_b64_tr_b16 v[240:241], v120 offset:49152
  ds_read_b64_tr_b16 v[242:243], v120 offset:50176
  ds_read_b64_tr_b16 v[244:245], v120 offset:53248
  ds_read_b64_tr_b16 v[246:247], v120 offset:54272
  ds_read_b64_tr_b16 v[248:249], v121 offset:49152
  ds_read_b64_tr_b16 v[250:251], v121 offset:50176
  ds_read_b64_tr_b16 v[252:253], v121 offset:53248
  ds_read_b64_tr_b16 v[254:255], v121 offset:54272
  s_branch L_lw_63
L_lv_67:
  ds_read_b64_tr_b16 v[192:193], v120 offset:32768
  ds_read_b64_tr_b16 v[194:195], v120 offset:33792
  ds_read_b64_tr_b16 v[196:197], v120 offset:36864
  ds_read_b64_tr_b16 v[198:199], v120 offset:37888
  ds_read_b64_tr_b16 v[200:201], v121 offset:32768
  ds_read_b64_tr_b16 v[202:203], v121 offset:33792
  ds_read_b64_tr_b16 v[204:205], v121 offset:36864
  ds_read_b64_tr_b16 v[206:207], v121 offset:37888
  ds_read_b64_tr_b16 v[208:209], v120 offset:49152
  ds_read_b64_tr_b16 v[210:211], v120 offset:50176
  ds_read_b64_tr_b16 v[212:213], v120 offset:53248
  ds_read_b64_tr_b16 v[214:215], v120 offset:54272
  ds_read_b64_tr_b16 v[216:217], v121 offset:49152
  ds_read_b64_tr_b16 v[218:219], v121 offset:50176
  ds_read_b64_tr_b16 v[220:221], v121 offset:53248
  ds_read_b64_tr_b16 v[222:223], v121 offset:54272
L_lw_63:
  s_waitcnt lgkmcnt(0)
  s_waitcnt vmcnt(16)
  s_barrier
  s_lshl_b32 s61, s5, 17
  s_lshl_b32 s62, s3, 15
  s_add_u32 s61, s61, s62
  s_add_u32 s61, s61, 256
  s_add_u32 m0, s60, 32768
  s_add_u32 s62, s61, 0
  buffer_load_dwordx4 v118, s[28:31], s62 offen lds
  s_add_u32 m0, s60, 33792
  s_add_u32 s62, s61, 4096
  buffer_load_dwordx4 v118, s[28:31], s62 offen lds
  s_add_u32 m0, s60, 34816
  s_add_u32 s62, s61, 8192
  buffer_load_dwordx4 v119, s[28:31], s62 offen lds
  s_add_u32 m0, s60, 35840
  s_add_u32 s62, s61, 12288
  buffer_load_dwordx4 v119, s[28:31], s62 offen lds
  s_add_u32 m0, s60, 36864
  s_add_u32 s62, s61, 16384
  buffer_load_dwordx4 v118, s[28:31], s62 offen lds
  s_add_u32 m0, s60, 37888
  s_add_u32 s62, s61, 20480
  buffer_load_dwordx4 v118, s[28:31], s62 offen lds
  s_add_u32 m0, s60, 38912
  s_add_u32 s62, s61, 24576
  buffer_load_dwordx4 v119, s[28:31], s62 offen lds
  s_add_u32 m0, s60, 39936
  s_add_u32 s62, s61, 28672
  buffer_load_dwordx4 v119, s[28:31], s62 offen lds
  s_cmp_eq_u32 s3, 1
  s_cbranch_scc1 L_lv_70
  s_cmp_eq_u32 s3, 2
  s_cbranch_scc1 L_lv_71
  s_cmp_eq_u32 s3, 3
  s_cbranch_scc1 L_lv_72
L_lv_69:
  ds_read_b64_tr_b16 v[192:193], v122 offset:0
  ds_read_b64_tr_b16 v[194:195], v122 offset:1024
  ds_read_b64_tr_b16 v[196:197], v122 offset:4096
  ds_read_b64_tr_b16 v[198:199], v122 offset:5120
  ds_read_b64_tr_b16 v[200:201], v123 offset:0
  ds_read_b64_tr_b16 v[202:203], v123 offset:1024
  ds_read_b64_tr_b16 v[204:205], v123 offset:4096
  ds_read_b64_tr_b16 v[206:207], v123 offset:5120
  ds_read_b64_tr_b16 v[208:209], v122 offset:16384
  ds_read_b64_tr_b16 v[210:211], v122 offset:17408
  ds_read_b64_tr_b16 v[212:213], v122 offset:20480
  ds_read_b64_tr_b16 v[214:215], v122 offset:21504
  ds_read_b64_tr_b16 v[216:217], v123 offset:16384
  ds_read_b64_tr_b16 v[218:219], v123 offset:17408
  ds_read_b64_tr_b16 v[220:221], v123 offset:20480
  ds_read_b64_tr_b16 v[222:223], v123 offset:21504
  s_branch L_lw_68
L_lv_70:
  ds_read_b64_tr_b16 v[160:161], v122 offset:0
  ds_read_b64_tr_b16 v[162:163], v122 offset:1024
  ds_read_b64_tr_b16 v[164:165], v122 offset:4096
  ds_read_b64_tr_b16 v[166:167], v122 offset:5120
  ds_read_b64_tr_b16 v[168:169], v123 offset:0
  ds_read_b64_tr_b16 v[170:171], v123 offset:1024
  ds_read_b64_tr_b16 v[172:173], v123 offset:4096
  ds_read_b64_tr_b16 v[174:175], v123 offset:5120
  ds_read_b64_tr_b16 v[176:177], v122 offset:16384
  ds_read_b64_tr_b16 v[178:179], v122 offset:17408
  ds_read_b64_tr_b16 v[180:181], v122 offset:20480
  ds_read_b64_tr_b16 v[182:183], v122 offset:21504
  ds_read_b64_tr_b16 v[184:185], v123 offset:16384
  ds_read_b64_tr_b16 v[186:187], v123 offset:17408
  ds_read_b64_tr_b16 v[188:189], v123 offset:20480
  ds_read_b64_tr_b16 v[190:191], v123 offset:21504
  s_branch L_lw_68
L_lv_71:
  ds_read_b64_tr_b16 v[128:129], v122 offset:0
  ds_read_b64_tr_b16 v[130:131], v122 offset:1024
  ds_read_b64_tr_b16 v[132:133], v122 offset:4096
  ds_read_b64_tr_b16 v[134:135], v122 offset:5120
  ds_read_b64_tr_b16 v[136:137], v123 offset:0
  ds_read_b64_tr_b16 v[138:139], v123 offset:1024
  ds_read_b64_tr_b16 v[140:141], v123 offset:4096
  ds_read_b64_tr_b16 v[142:143], v123 offset:5120
  ds_read_b64_tr_b16 v[144:145], v122 offset:16384
  ds_read_b64_tr_b16 v[146:147], v122 offset:17408
  ds_read_b64_tr_b16 v[148:149], v122 offset:20480
  ds_read_b64_tr_b16 v[150:151], v122 offset:21504
  ds_read_b64_tr_b16 v[152:153], v123 offset:16384
  ds_read_b64_tr_b16 v[154:155], v123 offset:17408
  ds_read_b64_tr_b16 v[156:157], v123 offset:20480
  ds_read_b64_tr_b16 v[158:159], v123 offset:21504
  s_branch L_lw_68
L_lv_72:
  ds_read_b64_tr_b16 v[224:225], v122 offset:0
  ds_read_b64_tr_b16 v[226:227], v122 offset:1024
  ds_read_b64_tr_b16 v[228:229], v122 offset:4096
  ds_read_b64_tr_b16 v[230:231], v122 offset:5120
  ds_read_b64_tr_b16 v[232:233], v123 offset:0
  ds_read_b64_tr_b16 v[234:235], v123 offset:1024
  ds_read_b64_tr_b16 v[236:237], v123 offset:4096
  ds_read_b64_tr_b16 v[238:239], v123 offset:5120
  ds_read_b64_tr_b16 v[240:241], v122 offset:16384
  ds_read_b64_tr_b16 v[242:243], v122 offset:17408
  ds_read_b64_tr_b16 v[244:245], v122 offset:20480
  ds_read_b64_tr_b16 v[246:247], v122 offset:21504
  ds_read_b64_tr_b16 v[248:249], v123 offset:16384
  ds_read_b64_tr_b16 v[250:251], v123 offset:17408
  ds_read_b64_tr_b16 v[252:253], v123 offset:20480
  ds_read_b64_tr_b16 v[254:255], v123 offset:21504
L_lw_68:
  s_waitcnt lgkmcnt(0)
  s_waitcnt vmcnt(16)
  s_barrier
  s_lshl_b32 s61, s5, 17
  s_lshl_b32 s62, s3, 15
  s_add_u32 s61, s61, s62
  s_add_u32 s61, s61, 512
  s_add_u32 m0, s60, 65536
  s_add_u32 s62, s61, 0
  buffer_load_dwordx4 v118, s[28:31], s62 offen lds
  s_add_u32 m0, s60, 66560
  s_add_u32 s62, s61, 4096
  buffer_load_dwordx4 v118, s[28:31], s62 offen lds
  s_add_u32 m0, s60, 67584
  s_add_u32 s62, s61, 8192
  buffer_load_dwordx4 v119, s[28:31], s62 offen lds
  s_add_u32 m0, s60, 68608
  s_add_u32 s62, s61, 12288
  buffer_load_dwordx4 v119, s[28:31], s62 offen lds
  s_add_u32 m0, s60, 69632
  s_add_u32 s62, s61, 16384
  buffer_load_dwordx4 v118, s[28:31], s62 offen lds
  s_add_u32 m0, s60, 70656
  s_add_u32 s62, s61, 20480
  buffer_load_dwordx4 v118, s[28:31], s62 offen lds
  s_add_u32 m0, s60, 71680
  s_add_u32 s62, s61, 24576
  buffer_load_dwordx4 v119, s[28:31], s62 offen lds
  s_add_u32 m0, s60, 72704
  s_add_u32 s62, s61, 28672
  buffer_load_dwordx4 v119, s[28:31], s62 offen lds
  s_cmp_eq_u32 s3, 1
  s_cbranch_scc1 L_lv_75
  s_cmp_eq_u32 s3, 2
  s_cbranch_scc1 L_lv_76
  s_cmp_eq_u32 s3, 3
  s_cbranch_scc1 L_lv_77
L_lv_74:
  ds_read_b64_tr_b16 v[224:225], v122 offset:32768
  ds_read_b64_tr_b16 v[226:227], v122 offset:33792
  ds_read_b64_tr_b16 v[228:229], v122 offset:36864
  ds_read_b64_tr_b16 v[230:231], v122 offset:37888
  ds_read_b64_tr_b16 v[232:233], v123 offset:32768
  ds_read_b64_tr_b16 v[234:235], v123 offset:33792
  ds_read_b64_tr_b16 v[236:237], v123 offset:36864
  ds_read_b64_tr_b16 v[238:239], v123 offset:37888
  ds_read_b64_tr_b16 v[240:241], v122 offset:49152
  ds_read_b64_tr_b16 v[242:243], v122 offset:50176
  ds_read_b64_tr_b16 v[244:245], v122 offset:53248
  ds_read_b64_tr_b16 v[246:247], v122 offset:54272
  ds_read_b64_tr_b16 v[248:249], v123 offset:49152
  ds_read_b64_tr_b16 v[250:251], v123 offset:50176
  ds_read_b64_tr_b16 v[252:253], v123 offset:53248
  ds_read_b64_tr_b16 v[254:255], v123 offset:54272
  s_branch L_lw_73
L_lv_75:
  ds_read_b64_tr_b16 v[192:193], v122 offset:32768
  ds_read_b64_tr_b16 v[194:195], v122 offset:33792
  ds_read_b64_tr_b16 v[196:197], v122 offset:36864
  ds_read_b64_tr_b16 v[198:199], v122 offset:37888
  ds_read_b64_tr_b16 v[200:201], v123 offset:32768
  ds_read_b64_tr_b16 v[202:203], v123 offset:33792
  ds_read_b64_tr_b16 v[204:205], v123 offset:36864
  ds_read_b64_tr_b16 v[206:207], v123 offset:37888
  ds_read_b64_tr_b16 v[208:209], v122 offset:49152
  ds_read_b64_tr_b16 v[210:211], v122 offset:50176
  ds_read_b64_tr_b16 v[212:213], v122 offset:53248
  ds_read_b64_tr_b16 v[214:215], v122 offset:54272
  ds_read_b64_tr_b16 v[216:217], v123 offset:49152
  ds_read_b64_tr_b16 v[218:219], v123 offset:50176
  ds_read_b64_tr_b16 v[220:221], v123 offset:53248
  ds_read_b64_tr_b16 v[222:223], v123 offset:54272
  s_branch L_lw_73
L_lv_76:
  ds_read_b64_tr_b16 v[160:161], v122 offset:32768
  ds_read_b64_tr_b16 v[162:163], v122 offset:33792
  ds_read_b64_tr_b16 v[164:165], v122 offset:36864
  ds_read_b64_tr_b16 v[166:167], v122 offset:37888
  ds_read_b64_tr_b16 v[168:169], v123 offset:32768
  ds_read_b64_tr_b16 v[170:171], v123 offset:33792
  ds_read_b64_tr_b16 v[172:173], v123 offset:36864
  ds_read_b64_tr_b16 v[174:175], v123 offset:37888
  ds_read_b64_tr_b16 v[176:177], v122 offset:49152
  ds_read_b64_tr_b16 v[178:179], v122 offset:50176
  ds_read_b64_tr_b16 v[180:181], v122 offset:53248
  ds_read_b64_tr_b16 v[182:183], v122 offset:54272
  ds_read_b64_tr_b16 v[184:185], v123 offset:49152
  ds_read_b64_tr_b16 v[186:187], v123 offset:50176
  ds_read_b64_tr_b16 v[188:189], v123 offset:53248
  ds_read_b64_tr_b16 v[190:191], v123 offset:54272
  s_branch L_lw_73
L_lv_77:
  ds_read_b64_tr_b16 v[128:129], v122 offset:32768
  ds_read_b64_tr_b16 v[130:131], v122 offset:33792
  ds_read_b64_tr_b16 v[132:133], v122 offset:36864
  ds_read_b64_tr_b16 v[134:135], v122 offset:37888
  ds_read_b64_tr_b16 v[136:137], v123 offset:32768
  ds_read_b64_tr_b16 v[138:139], v123 offset:33792
  ds_read_b64_tr_b16 v[140:141], v123 offset:36864
  ds_read_b64_tr_b16 v[142:143], v123 offset:37888
  ds_read_b64_tr_b16 v[144:145], v122 offset:49152
  ds_read_b64_tr_b16 v[146:147], v122 offset:50176
  ds_read_b64_tr_b16 v[148:149], v122 offset:53248
  ds_read_b64_tr_b16 v[150:151], v122 offset:54272
  ds_read_b64_tr_b16 v[152:153], v123 offset:49152
  ds_read_b64_tr_b16 v[154:155], v123 offset:50176
  ds_read_b64_tr_b16 v[156:157], v123 offset:53248
  ds_read_b64_tr_b16 v[158:159], v123 offset:54272
L_lw_73:
  s_waitcnt lgkmcnt(0)
  s_waitcnt vmcnt(16)
  s_barrier
  s_lshl_b32 s61, s5, 17
  s_lshl_b32 s62, s3, 15
  s_add_u32 s61, s61, s62
  s_add_u32 s61, s61, 768
  s_add_u32 m0, s60, 98304
  s_add_u32 s62, s61, 0
  buffer_load_dwordx4 v118, s[28:31], s62 offen lds
  s_add_u32 m0, s60, 99328
  s_add_u32 s62, s61, 4096
  buffer_load_dwordx4 v118, s[28:31], s62 offen lds
  s_add_u32 m0, s60, 100352
  s_add_u32 s62, s61, 8192
  buffer_load_dwordx4 v119, s[28:31], s62 offen lds
  s_add_u32 m0, s60, 101376
  s_add_u32 s62, s61, 12288
  buffer_load_dwordx4 v119, s[28:31], s62 offen lds
  s_add_u32 m0, s60, 102400
  s_add_u32 s62, s61, 16384
  buffer_load_dwordx4 v118, s[28:31], s62 offen lds
  s_add_u32 m0, s60, 103424
  s_add_u32 s62, s61, 20480
  buffer_load_dwordx4 v118, s[28:31], s62 offen lds
  s_add_u32 m0, s60, 104448
  s_add_u32 s62, s61, 24576
  buffer_load_dwordx4 v119, s[28:31], s62 offen lds
  s_add_u32 m0, s60, 105472
  s_add_u32 s62, s61, 28672
  buffer_load_dwordx4 v119, s[28:31], s62 offen lds
  v_xor_b32 v126, 0, v124
  ds_read_b64_tr_b16 v[20:21], v126 offset:0
  ds_read_b64_tr_b16 v[22:23], v126 offset:1024
  v_xor_b32 v126, 32, v124
  ds_read_b64_tr_b16 v[24:25], v126 offset:0
  ds_read_b64_tr_b16 v[26:27], v126 offset:1024
  v_xor_b32 v126, 64, v124
  ds_read_b64_tr_b16 v[28:29], v126 offset:0
  ds_read_b64_tr_b16 v[30:31], v126 offset:1024
  v_xor_b32 v126, 96, v124
  ds_read_b64_tr_b16 v[32:33], v126 offset:0
  ds_read_b64_tr_b16 v[34:35], v126 offset:1024
  v_xor_b32 v126, 128, v124
  ds_read_b64_tr_b16 v[36:37], v126 offset:0
  ds_read_b64_tr_b16 v[38:39], v126 offset:1024
  v_xor_b32 v126, 160, v124
  ds_read_b64_tr_b16 v[40:41], v126 offset:0
  ds_read_b64_tr_b16 v[42:43], v126 offset:1024
  v_xor_b32 v126, 192, v124
  ds_read_b64_tr_b16 v[44:45], v126 offset:0
  ds_read_b64_tr_b16 v[46:47], v126 offset:1024
  v_xor_b32 v126, 224, v124
  ds_read_b64_tr_b16 v[48:49], v126 offset:0
  ds_read_b64_tr_b16 v[50:51], v126 offset:1024
  s_waitcnt lgkmcnt(0)
  ds_write_b128 v127, v[20:23] offset:0
  ds_write_b128 v127, v[24:27] offset:1024
  ds_write_b128 v127, v[28:31] offset:2048
  ds_write_b128 v127, v[32:35] offset:3072
  ds_write_b128 v127, v[36:39] offset:4096
  ds_write_b128 v127, v[40:43] offset:5120
  ds_write_b128 v127, v[44:47] offset:6144
  ds_write_b128 v127, v[48:51] offset:7168
  s_waitcnt lgkmcnt(0)
  v_add_u32 v124, 0x8000, v124
  v_add_u32 v127, 0x8000, v127
  s_waitcnt vmcnt(16)
  v_xor_b32 v126, 0, v124
  ds_read_b64_tr_b16 v[20:21], v126 offset:0
  ds_read_b64_tr_b16 v[22:23], v126 offset:1024
  v_xor_b32 v126, 32, v124
  ds_read_b64_tr_b16 v[24:25], v126 offset:0
  ds_read_b64_tr_b16 v[26:27], v126 offset:1024
  v_xor_b32 v126, 64, v124
  ds_read_b64_tr_b16 v[28:29], v126 offset:0
  ds_read_b64_tr_b16 v[30:31], v126 offset:1024
  v_xor_b32 v126, 96, v124
  ds_read_b64_tr_b16 v[32:33], v126 offset:0
  ds_read_b64_tr_b16 v[34:35], v126 offset:1024
  v_xor_b32 v126, 128, v124
  ds_read_b64_tr_b16 v[36:37], v126 offset:0
  ds_read_b64_tr_b16 v[38:39], v126 offset:1024
  v_xor_b32 v126, 160, v124
  ds_read_b64_tr_b16 v[40:41], v126 offset:0
  ds_read_b64_tr_b16 v[42:43], v126 offset:1024
  v_xor_b32 v126, 192, v124
  ds_read_b64_tr_b16 v[44:45], v126 offset:0
  ds_read_b64_tr_b16 v[46:47], v126 offset:1024
  v_xor_b32 v126, 224, v124
  ds_read_b64_tr_b16 v[48:49], v126 offset:0
  ds_read_b64_tr_b16 v[50:51], v126 offset:1024
  s_waitcnt lgkmcnt(0)
  ds_write_b128 v127, v[20:23] offset:0
  ds_write_b128 v127, v[24:27] offset:1024
  ds_write_b128 v127, v[28:31] offset:2048
  ds_write_b128 v127, v[32:35] offset:3072
  ds_write_b128 v127, v[36:39] offset:4096
  ds_write_b128 v127, v[40:43] offset:5120
  ds_write_b128 v127, v[44:47] offset:6144
  ds_write_b128 v127, v[48:51] offset:7168
  s_waitcnt lgkmcnt(0)
  v_add_u32 v124, 0x8000, v124
  v_add_u32 v127, 0x8000, v127
  s_waitcnt vmcnt(8)
  v_xor_b32 v126, 0, v124
  ds_read_b64_tr_b16 v[20:21], v126 offset:0
  ds_read_b64_tr_b16 v[22:23], v126 offset:1024
  v_xor_b32 v126, 32, v124
  ds_read_b64_tr_b16 v[24:25], v126 offset:0
  ds_read_b64_tr_b16 v[26:27], v126 offset:1024
  v_xor_b32 v126, 64, v124
  ds_read_b64_tr_b16 v[28:29], v126 offset:0
  ds_read_b64_tr_b16 v[30:31], v126 offset:1024
  v_xor_b32 v126, 96, v124
  ds_read_b64_tr_b16 v[32:33], v126 offset:0
  ds_read_b64_tr_b16 v[34:35], v126 offset:1024
  v_xor_b32 v126, 128, v124
  ds_read_b64_tr_b16 v[36:37], v126 offset:0
  ds_read_b64_tr_b16 v[38:39], v126 offset:1024
  v_xor_b32 v126, 160, v124
  ds_read_b64_tr_b16 v[40:41], v126 offset:0
  ds_read_b64_tr_b16 v[42:43], v126 offset:1024
  v_xor_b32 v126, 192, v124
  ds_read_b64_tr_b16 v[44:45], v126 offset:0
  ds_read_b64_tr_b16 v[46:47], v126 offset:1024
  v_xor_b32 v126, 224, v124
  ds_read_b64_tr_b16 v[48:49], v126 offset:0
  ds_read_b64_tr_b16 v[50:51], v126 offset:1024
  s_waitcnt lgkmcnt(0)
  ds_write_b128 v127, v[20:23] offset:0
  ds_write_b128 v127, v[24:27] offset:1024
  ds_write_b128 v127, v[28:31] offset:2048
  ds_write_b128 v127, v[32:35] offset:3072
  ds_write_b128 v127, v[36:39] offset:4096
  ds_write_b128 v127, v[40:43] offset:5120
  ds_write_b128 v127, v[44:47] offset:6144
  ds_write_b128 v127, v[48:51] offset:7168
  s_waitcnt lgkmcnt(0)
  v_add_u32 v124, 0x8000, v124
  v_add_u32 v127, 0x8000, v127
  s_waitcnt vmcnt(0)
  v_xor_b32 v126, 0, v124
  ds_read_b64_tr_b16 v[20:21], v126 offset:0
  ds_read_b64_tr_b16 v[22:23], v126 offset:1024
  v_xor_b32 v126, 32, v124
  ds_read_b64_tr_b16 v[24:25], v126 offset:0
  ds_read_b64_tr_b16 v[26:27], v126 offset:1024
  v_xor_b32 v126, 64, v124
  ds_read_b64_tr_b16 v[28:29], v126 offset:0
  ds_read_b64_tr_b16 v[30:31], v126 offset:1024
  v_xor_b32 v126, 96, v124
  ds_read_b64_tr_b16 v[32:33], v126 offset:0
  ds_read_b64_tr_b16 v[34:35], v126 offset:1024
  v_xor_b32 v126, 128, v124
  ds_read_b64_tr_b16 v[36:37], v126 offset:0
  ds_read_b64_tr_b16 v[38:39], v126 offset:1024
  v_xor_b32 v126, 160, v124
  ds_read_b64_tr_b16 v[40:41], v126 offset:0
  ds_read_b64_tr_b16 v[42:43], v126 offset:1024
  v_xor_b32 v126, 192, v124
  ds_read_b64_tr_b16 v[44:45], v126 offset:0
  ds_read_b64_tr_b16 v[46:47], v126 offset:1024
  v_xor_b32 v126, 224, v124
  ds_read_b64_tr_b16 v[48:49], v126 offset:0
  ds_read_b64_tr_b16 v[50:51], v126 offset:1024
  s_waitcnt lgkmcnt(0)
  ds_write_b128 v127, v[20:23] offset:0
  ds_write_b128 v127, v[24:27] offset:1024
  ds_write_b128 v127, v[28:31] offset:2048
  ds_write_b128 v127, v[32:35] offset:3072
  ds_write_b128 v127, v[36:39] offset:4096
  ds_write_b128 v127, v[40:43] offset:5120
  ds_write_b128 v127, v[44:47] offset:6144
  ds_write_b128 v127, v[48:51] offset:7168
  s_waitcnt lgkmcnt(0)
  v_add_u32 v124, 0x8000, v124
  v_add_u32 v127, 0x8000, v127
  s_mov_b32 s16, s80
  s_mov_b32 s17, s81
  s_mov_b32 s18, 0x2000
  s_mov_b32 s19, 0x20000
  v_and_b32 v16, 15, v0
  v_lshrrev_b32 v17, 1, v16
  v_lshlrev_b32 v17, 10, v17
  v_and_b32 v18, 1, v0
  v_lshl_or_b32 v17, v18, 6, v17
  v_lshrrev_b32 v19, 4, v0
  v_lshl_or_b32 v17, v19, 3, v17
  s_lshl_b32 s6, s3, 8
  buffer_load_dwordx2 v[20:21], v17, s[16:19], s6 offen offset:0
  buffer_load_dwordx2 v[22:23], v17, s[16:19], s6 offen offset:32
  buffer_load_dwordx2 v[24:25], v17, s[16:19], s6 offen offset:128
  buffer_load_dwordx2 v[26:27], v17, s[16:19], s6 offen offset:160
  v_mov_b32 v19, 0x4444
  v_mov_b32 v16, 0xeeee
  v_cmp_eq_u32 vcc, 0, v18
  s_nop 1
  v_cndmask_b32 v0, v16, v19, vcc
  s_mov_b32 s7, 0
  v_mbcnt_lo_u32_b32 v16, -1, 0
  v_and_b32 v16, 3, v16
  v_lshlrev_b32 v16, 6, v16
L_wd_78:
  buffer_load_dword v17, v16, s[12:15], 0 offen offset:16 sc1
  s_waitcnt vmcnt(0)
  v_cmp_ne_u32 vcc, 64, v17
  s_cbranch_vccz L_wdo_79
  s_add_u32 s7, s7, 1
  s_cmp_lt_u32 s7, 131072
  s_cbranch_scc1 L_wd_78
  s_mov_b32 s6, 10
  s_branch L_err
L_wdo_79:
  s_mov_b32 s32, 0
  s_mov_b32 s49, 1
  s_mov_b32 s33, 1
  s_sub_u32 s6, s49, 1
  s_and_b32 s7, s6, 1
  s_lshl_b32 s7, s7, 12
  s_add_u32 s51, s38, s7
  s_and_b32 s6, s6, 3
  s_lshl_b32 s6, s6, 19
  s_add_u32 s50, s35, s6
  s_mov_b32 s7, 0
L_pl_80:
  buffer_load_dwordx4 v[120:123], v13, s[8:11], s51 offen offset:0 sc1
  s_waitcnt vmcnt(0)
  v_min_u32 v120, v120, v121
  v_min3_u32 v120, v120, v122, v123
  v_cmp_gt_u32 vcc, s49, v120
  s_cbranch_vccz L_plo_81
  s_add_u32 s7, s7, 1
  s_cmp_lt_u32 s7, 131072
  s_cbranch_scc1 L_pl_80
  s_mov_b32 s6, 11
  s_branch L_err
L_plo_81:
  s_mov_b32 m0, s53
  s_add_u32 s6, s50, 0x2000
  buffer_load_dwordx4 v1, s[8:11], s50 offen sc1 lds
  buffer_load_dwordx4 v1, s[8:11], s50 offen offset:1024 sc1 lds
  s_mov_b32 m0, s37
  s_nop 0
  buffer_load_dwordx4 v1, s[8:11], s6 offen sc1 lds
  buffer_load_dwordx4 v1, s[8:11], s6 offen offset:1024 sc1 lds
  s_mov_b32 s49, 2
  s_sub_u32 s6, s49, 1
  s_and_b32 s7, s6, 1
  s_lshl_b32 s7, s7, 12
  s_add_u32 s51, s38, s7
  s_and_b32 s6, s6, 3
  s_lshl_b32 s6, s6, 19
  s_add_u32 s50, s35, s6
  v_add_u32 v116, s48, v1
  v_add_u32 v117, s45, v1
  v_add_u32 v118, s46, v1
  v_add_u32 v119, s47, v1
  v_mov_b64 v[84:85], 0
  v_mov_b64 v[86:87], 0
  v_mov_b64 v[88:89], 0
  v_mov_b64 v[90:91], 0
  v_mov_b64 v[92:93], 0
  v_mov_b64 v[94:95], 0
  v_mov_b64 v[96:97], 0
  v_mov_b64 v[98:99], 0
  v_mov_b64 v[100:101], 0
  v_mov_b64 v[102:103], 0
  v_mov_b64 v[104:105], 0
  v_mov_b64 v[106:107], 0
  s_waitcnt vmcnt(0)
  s_branch L_rec_step
L_rec_loop:
  buffer_load_dwordx4 v[20:23], v1, s[8:11], s44 offen sc1
  buffer_load_dwordx4 v[24:27], v1, s[8:11], s44 offen offset:1024 sc1
  s_mov_b32 s7, 0
  v_add_u32 v116, s48, v1
  v_add_u32 v117, s45, v1
  v_add_u32 v118, s46, v1
  v_add_u32 v119, s47, v1
  v_mov_b64 v[84:85], 0
  v_mov_b64 v[86:87], 0
  v_mov_b64 v[88:89], 0
  v_mov_b64 v[90:91], 0
  v_mov_b64 v[92:93], 0
  v_mov_b64 v[94:95], 0
  v_mov_b64 v[96:97], 0
  v_mov_b64 v[98:99], 0
  v_mov_b64 v[100:101], 0
  v_mov_b64 v[102:103], 0
  v_mov_b64 v[104:105], 0
  v_mov_b64 v[106:107], 0
L_rec_gather:
  buffer_load_dwordx4 v[52:55], v1, s[8:11], s44 offen sc1
  buffer_load_dwordx4 v[56:59], v1, s[8:11], s44 offen offset:1024 sc1
  s_waitcnt vmcnt(2)
  v_bitop3_b32 v16, v20, v22, s33 bitop3:0x7e
  v_bitop3_b32 v17, v24, v26, s33 bitop3:0x7e
  v_bitop3_b32 v16, v16, v17, 1 bitop3:0xa8
  v_cmp_ne_u32 vcc, 0, v16
  s_cbranch_vccz L_rec_got
  buffer_load_dwordx4 v[20:23], v1, s[8:11], s44 offen sc1
  buffer_load_dwordx4 v[24:27], v1, s[8:11], s44 offen offset:1024 sc1
  s_waitcnt vmcnt(2)
  v_bitop3_b32 v16, v52, v54, s33 bitop3:0x7e
  v_bitop3_b32 v17, v56, v58, s33 bitop3:0x7e
  v_bitop3_b32 v16, v16, v17, 1 bitop3:0xa8
  v_cmp_ne_u32 vcc, 0, v16
  s_cbranch_vccz L_rec_gotB
  s_and_b32 s6, s7, 31
  s_cmp_lg_u32 s6, 31
  s_cbranch_scc1 L_tf_82
  buffer_wbl2 sc1
  s_waitcnt vmcnt(0)
  buffer_inv sc1
  s_waitcnt vmcnt(0)
L_tf_82:
  s_add_u32 s7, s7, 1
  s_cmp_lt_u32 s7, 131072
  s_cbranch_scc1 L_rec_gather
  s_mov_b32 s6, 12
  s_branch L_err
L_rec_gotB:
  v_mov_b64 v[20:21], v[52:53]
  v_mov_b64 v[22:23], v[54:55]
  v_mov_b64 v[24:25], v[56:57]
  v_mov_b64 v[26:27], v[58:59]
L_rec_got:
  s_mov_b32 s63, s7
  s_xor_b32 s33, s33, 1
L_rec_step:
  ds_write_b128 v116, v[20:23]
  ds_write_b128 v116, v[24:27] offset:1024
  buffer_load_dwordx4 v[120:123], v13, s[8:11], s51 offen sc1
  v_smfmac_f32_16x16x64_bf16 v[84:87], v[20:23], a[0:7], v0
  v_smfmac_f32_16x16x64_bf16 v[88:91], v[20:23], a[8:15], v0
  v_smfmac_f32_16x16x64_bf16 v[84:87], v[24:27], a[16:23], v0
  v_smfmac_f32_16x16x64_bf16 v[88:91], v[24:27], a[24:31], v0
  s_waitcnt lgkmcnt(0)
  s_barrier
  ds_read_b128 v[28:31], v117 offset:0
  ds_read_b128 v[32:35], v117 offset:1024
  v_smfmac_f32_16x16x64_bf16 v[92:95], v[20:23], a[128:135], v0
  ds_read_b128 v[36:39], v118 offset:0
  ds_read_b128 v[40:43], v118 offset:1024
  v_smfmac_f32_16x16x64_bf16 v[96:99], v[20:23], a[136:143], v0
  ds_read_b128 v[44:47], v119 offset:0
  ds_read_b128 v[48:51], v119 offset:1024
  v_smfmac_f32_16x16x64_bf16 v[92:95], v[24:27], a[144:151], v0
  s_and_b32 s6, s32, 3
  v_smfmac_f32_16x16x64_bf16 v[96:99], v[24:27], a[152:159], v0
  s_lshl_b32 s6, s6, 17
  v_smfmac_f32_16x16x64_bf16 v[100:103], v[20:23], v[128:135], v0
  s_add_u32 s52, s36, s6
  v_smfmac_f32_16x16x64_bf16 v[104:107], v[20:23], v[136:143], v0
  s_lshr_b32 s6, s32, 2
  v_smfmac_f32_16x16x64_bf16 v[100:103], v[24:27], v[144:151], v0
  s_andn2_b32 s59, 1, s6
  v_smfmac_f32_16x16x64_bf16 v[104:107], v[24:27], v[152:159], v0
  s_waitcnt lgkmcnt(5)
  v_smfmac_f32_16x16x64_bf16 v[84:87], v[28:31], a[32:39], v0
  v_smfmac_f32_16x16x64_bf16 v[88:91], v[28:31], a[40:47], v0
  s_waitcnt lgkmcnt(4)
  v_smfmac_f32_16x16x64_bf16 v[84:87], v[32:35], a[48:55], v0
  v_smfmac_f32_16x16x64_bf16 v[88:91], v[32:35], a[56:63], v0
  s_waitcnt lgkmcnt(3)
  v_smfmac_f32_16x16x64_bf16 v[84:87], v[36:39], a[64:71], v0
  v_smfmac_f32_16x16x64_bf16 v[88:91], v[36:39], a[72:79], v0
  s_waitcnt lgkmcnt(2)
  v_smfmac_f32_16x16x64_bf16 v[84:87], v[40:43], a[80:87], v0
  v_smfmac_f32_16x16x64_bf16 v[88:91], v[40:43], a[88:95], v0
  s_waitcnt lgkmcnt(1)
  v_smfmac_f32_16x16x64_bf16 v[84:87], v[44:47], a[96:103], v0
  v_smfmac_f32_16x16x64_bf16 v[88:91], v[44:47], a[104:111], v0
  s_waitcnt lgkmcnt(0)
  v_smfmac_f32_16x16x64_bf16 v[84:87], v[48:51], a[112:119], v0
  v_smfmac_f32_16x16x64_bf16 v[88:91], v[48:51], a[120:127], v0
  s_waitcnt vmcnt(1)
  v_smfmac_f32_16x16x64_bf16 v[92:95], v[28:31], a[160:167], v0
  ds_read_b128 v[52:55], v4 offset:0
  ds_read_b128 v[68:71], v4 offset:128
  v_smfmac_f32_16x16x64_bf16 v[92:95], v[32:35], a[176:183], v0
  ds_read_b128 v[56:59], v4 offset:2048
  ds_read_b128 v[72:75], v4 offset:2176
  v_smfmac_f32_16x16x64_bf16 v[92:95], v[36:39], a[192:199], v0
  ds_read_b128 v[60:63], v4 offset:4096
  ds_read_b128 v[76:79], v4 offset:4224
  v_add_f32 v84, v84, v85
  v_smfmac_f32_16x16x64_bf16 v[92:95], v[40:43], a[208:215], v0
  ds_read_b128 v[64:67], v4 offset:6144
  ds_read_b128 v[80:83], v4 offset:6272
  v_add_f32 v86, v86, v87
  v_smfmac_f32_16x16x64_bf16 v[92:95], v[44:47], a[224:231], v0
  v_cvt_pk_bf16_f32 v16, v84, v86
  v_smfmac_f32_16x16x64_bf16 v[92:95], v[48:51], a[240:247], v0
  v_add_f32 v88, v88, v89
  v_smfmac_f32_16x16x64_bf16 v[96:99], v[28:31], a[168:175], v0
  v_add_f32 v90, v90, v91
  ds_read_b128 v[108:111], v9
  ds_read_b128 v[112:115], v9 offset:256
  v_smfmac_f32_16x16x64_bf16 v[96:99], v[32:35], a[184:191], v0
  v_cvt_pk_bf16_f32 v18, v88, v90
  v_smfmac_f32_16x16x64_bf16 v[96:99], v[36:39], a[200:207], v0
  v_add_f32 v92, v92, v93
  v_smfmac_f32_16x16x64_bf16 v[96:99], v[40:43], a[216:223], v0
  v_add_f32 v94, v94, v95
  v_smfmac_f32_16x16x64_bf16 v[96:99], v[44:47], a[232:239], v0
  v_cvt_pk_bf16_f32 v17, v92, v94
  v_smfmac_f32_16x16x64_bf16 v[96:99], v[48:51], a[248:255], v0
  ds_write_b64 v2, v[16:17]
  v_smfmac_f32_16x16x64_bf16 v[100:103], v[28:31], v[160:167], v0
  v_smfmac_f32_16x16x64_bf16 v[104:107], v[28:31], v[168:175], v0
  s_nop 4
  v_add_f32 v96, v96, v97
  v_add_f32 v98, v98, v99
  v_cvt_pk_bf16_f32 v19, v96, v98
  ds_write_b64 v2, v[18:19] offset:128
  v_smfmac_f32_16x16x64_bf16 v[100:103], v[32:35], v[176:183], v0
  v_smfmac_f32_16x16x64_bf16 v[104:107], v[32:35], v[184:191], v0
  s_waitcnt lgkmcnt(0)
  s_barrier
  ds_read_b64_tr_b16 v[84:85], v3 offset:0
  ds_read_b64_tr_b16 v[86:87], v3 offset:64
  v_smfmac_f32_16x16x64_bf16 v[100:103], v[36:39], v[192:199], v0
  ds_read_b64_tr_b16 v[88:89], v3 offset:256
  ds_read_b64_tr_b16 v[90:91], v3 offset:320
  v_smfmac_f32_16x16x64_bf16 v[104:107], v[36:39], v[200:207], v0
  ds_read_b64_tr_b16 v[92:93], v3 offset:512
  ds_read_b64_tr_b16 v[94:95], v3 offset:576
  v_smfmac_f32_16x16x64_bf16 v[100:103], v[40:43], v[208:215], v0
  ds_read_b64_tr_b16 v[96:97], v3 offset:768
  ds_read_b64_tr_b16 v[98:99], v3 offset:832
  v_smfmac_f32_16x16x64_bf16 v[104:107], v[40:43], v[216:223], v0
  s_cmp_eq_u32 s32, 63
  s_waitcnt vmcnt(0)
  s_cbranch_scc1 L_rec_nokv
  v_min_u32 v120, v120, v121
  v_min3_u32 v120, v120, v122, v123
  v_cmp_gt_u32 vcc, s49, v120
  s_cbranch_vccnz L_rec_kvwait
L_rec_kvok:
  s_mov_b32 m0, s53
  s_add_u32 s6, s50, 0x2000
  buffer_load_dwordx4 v1, s[8:11], s50 offen sc1 lds
  buffer_load_dwordx4 v1, s[8:11], s50 offen offset:1024 sc1 lds
  s_mov_b32 m0, s37
  s_nop 0
  buffer_load_dwordx4 v1, s[8:11], s6 offen sc1 lds
  buffer_load_dwordx4 v1, s[8:11], s6 offen offset:1024 sc1 lds
L_rec_nokv:
  v_smfmac_f32_16x16x64_bf16 v[100:103], v[44:47], v[224:231], v0
  s_waitcnt lgkmcnt(6)
  v_mfma_f32_16x16x32_bf16 v[116:119], v[52:55], v[84:87], 0
  v_mfma_f32_16x16x32_bf16 v[120:123], v[68:71], v[84:87], 0
  v_mfma_f32_16x16x32_bf16 v[124:127], v[84:87], v[84:87], 0
  s_waitcnt lgkmcnt(4)
  v_mfma_f32_16x16x32_bf16 v[116:119], v[56:59], v[88:91], v[116:119]
  v_mfma_f32_16x16x32_bf16 v[120:123], v[72:75], v[88:91], v[120:123]
  v_mfma_f32_16x16x32_bf16 v[124:127], v[88:91], v[88:91], v[124:127]
  s_waitcnt lgkmcnt(2)
  v_mfma_f32_16x16x32_bf16 v[116:119], v[60:63], v[92:95], v[116:119]
  v_mfma_f32_16x16x32_bf16 v[120:123], v[76:79], v[92:95], v[120:123]
  v_mfma_f32_16x16x32_bf16 v[124:127], v[92:95], v[92:95], v[124:127]
  s_waitcnt lgkmcnt(0)
  v_mfma_f32_16x16x32_bf16 v[116:119], v[64:67], v[96:99], v[116:119]
  v_mfma_f32_16x16x32_bf16 v[120:123], v[80:83], v[96:99], v[120:123]
  v_mfma_f32_16x16x32_bf16 v[124:127], v[96:99], v[96:99], v[124:127]
  v_smfmac_f32_16x16x64_bf16 v[104:107], v[44:47], v[232:239], v0
  ds_read_b128 v[52:55], v7 offset:0
  ds_read_b128 v[56:59], v7 offset:8192
  s_nop 2
  v_max3_f32 v88, v116, v117, v118
  v_max3_f32 v89, v120, v121, v122
  v_max3_f32 v88, v88, v119, v123
  v_max3_f32 v89, v89, v126, v127
  v_max_f32 v88, v88, v89
  v_max_f32 v89, v88, v89
  v_smfmac_f32_16x16x64_bf16 v[100:103], v[48:51], v[240:247], v0
  ds_read_b128 v[60:63], v7 offset:1024
  v_permlane32_swap_b32 v88, v89
  v_max_f32 v88, v88, v89
  v_max_f32 v89, v88, v89
  v_smfmac_f32_16x16x64_bf16 v[104:107], v[48:51], v[248:255], v0
  ds_read_b128 v[64:67], v7 offset:9216
  v_permlane16_swap_b32 v88, v89
  v_max_f32 v88, v88, v89
  v_mul_f32 v88, s34, v88
  v_fma_f32 v126, v126, s34, -v88
  v_fma_f32 v127, v127, s34, -v88
  v_exp_f32 v126, v126
  ds_read_b128 v[68:71], v7 offset:16384
  v_exp_f32 v127, v127
  ds_read_b128 v[72:75], v7 offset:24576
  v_fma_f32 v116, v116, s34, -v88
  v_fma_f32 v117, v117, s34, -v88
  v_fma_f32 v118, v118, s34, -v88
  v_fma_f32 v119, v119, s34, -v88
  v_cvt_pk_bf16_f32 v12, v126, v127
  v_exp_f32 v116, v116
  ds_read_b128 v[76:79], v7 offset:17408
  v_exp_f32 v117, v117
  ds_read_b128 v[80:83], v7 offset:25600
  v_mfma_f32_16x16x16_bf16 v[124:127], v[10:11], v[12:13], 0
  v_exp_f32 v118, v118
  ds_read_b128 v[20:23], v7 offset:2048
  v_exp_f32 v119, v119
  ds_read_b128 v[24:27], v7 offset:10240
  v_add_f32 v100, v100, v101
  v_add_f32 v102, v102, v103
  v_cvt_pk_bf16_f32 v16, v100, v102
  v_cvt_pk_bf16_f32 v92, v116, v117
  v_cvt_pk_bf16_f32 v93, v118, v119
  v_add_f32 v104, v104, v105
  v_add_f32 v106, v106, v107
  v_cvt_pk_bf16_f32 v18, v104, v106
  v_mfma_f32_16x16x16_bf16 v[124:127], v[10:11], v[92:93], v[124:127]
  v_bfi_b32 v16, 1, s59, v16
  v_fma_f32 v120, v120, s34, -v88
  v_fma_f32 v121, v121, s34, -v88
  buffer_store_dwordx4 v[16:19], v1, s[8:11], s52 offen sc1
  v_mfma_f32_16x16x16_bf16 v[100:103], v[16:17], v[12:13], 0
  v_fma_f32 v122, v122, s34, -v88
  v_fma_f32 v123, v123, s34, -v88
  v_mfma_f32_16x16x16_bf16 v[104:107], v[18:19], v[12:13], 0
  v_exp_f32 v120, v120
  ds_read_b128 v[28:31], v7 offset:3072
  v_exp_f32 v121, v121
  ds_read_b128 v[32:35], v7 offset:11264
  v_exp_f32 v122, v122
  ds_read_b128 v[36:39], v7 offset:18432
  v_exp_f32 v123, v123
  ds_read_b128 v[40:43], v7 offset:26624
  s_cmp_eq_u32 s32, 63
  v_cvt_pk_bf16_f32 v94, v120, v121
  v_cvt_pk_bf16_f32 v95, v122, v123
  s_cbranch_scc1 L_rec_last
  s_nop 0
  v_mfma_f32_16x16x16_bf16 v[124:127], v[10:11], v[94:95], v[124:127]
  v_mfma_f32_16x16x32_bf16 v[100:103], v[108:111], v[92:95], v[100:103]
  v_mfma_f32_16x16x32_bf16 v[104:107], v[112:115], v[92:95], v[104:107]
  ds_read_b128 v[44:47], v7 offset:19456
  ds_read_b128 v[48:51], v7 offset:27648
  s_nop 3
  v_rcp_f32 v124, v124
  s_nop 0
  v_mul_f32 v100, v124, v100
  v_mul_f32 v101, v124, v101
  v_mul_f32 v102, v124, v102
  v_mul_f32 v103, v124, v103
  v_cvt_pk_bf16_f32 v116, v100, v101
  v_cvt_pk_bf16_f32 v117, v102, v103
  v_mul_f32 v104, v124, v104
  v_mul_f32 v105, v124, v105
  v_mul_f32 v106, v124, v106
  v_mul_f32 v107, v124, v107
  v_cvt_pk_bf16_f32 v118, v104, v105
  v_cvt_pk_bf16_f32 v119, v106, v107
  s_mov_b64 exec, s[56:57]
  ds_write2_b32 v5, v116, v117 offset0:0 offset1:4
  ds_write2_b32 v5, v118, v119 offset0:8 offset1:12
  s_mov_b64 exec, -1
  v_mfma_f32_32x32x8_bf16 v[84:99], v[12:13], v[14:15], 0
  v_mfma_f32_32x32x8_bf16 v[100:115], v[12:13], v[14:15], 0
  s_waitcnt lgkmcnt(0)
  s_barrier
  ds_read_b128 v[116:119], v6
  ds_read_b128 v[120:123], v6 offset:128
  s_waitcnt lgkmcnt(1)
  s_nop 3
  v_smfmac_f32_16x16x64_bf16 v[84:87], v[116:119], v[52:59], v0
  ds_read_b128 v[52:55], v7 offset:4096
  ds_read_b128 v[56:59], v7 offset:12288
  v_smfmac_f32_16x16x64_bf16 v[88:91], v[116:119], v[60:67], v0
  ds_read_b128 v[60:63], v7 offset:5120
  ds_read_b128 v[64:67], v7 offset:13312
  s_waitcnt lgkmcnt(4)
  v_smfmac_f32_16x16x64_bf16 v[84:87], v[120:123], v[68:75], v0
  ds_read_b128 v[68:71], v7 offset:20480
  ds_read_b128 v[72:75], v7 offset:28672
  v_smfmac_f32_16x16x64_bf16 v[88:91], v[120:123], v[76:83], v0
  ds_read_b128 v[76:79], v7 offset:21504
  ds_read_b128 v[80:83], v7 offset:29696
  v_smfmac_f32_16x16x64_bf16 v[92:95], v[116:119], v[20:27], v0
  ds_read_b128 v[20:23], v7 offset:6144
  ds_read_b128 v[24:27], v7 offset:14336
  v_smfmac_f32_16x16x64_bf16 v[96:99], v[116:119], v[28:35], v0
  ds_read_b128 v[28:31], v7 offset:7168
  ds_read_b128 v[32:35], v7 offset:15360
  v_add_f32 v84, v84, v85
  v_smfmac_f32_16x16x64_bf16 v[92:95], v[120:123], v[36:43], v0
  ds_read_b128 v[36:39], v7 offset:22528
  ds_read_b128 v[40:43], v7 offset:30720
  v_add_f32 v86, v86, v87
  v_smfmac_f32_16x16x64_bf16 v[96:99], v[120:123], v[44:51], v0
  ds_read_b128 v[44:47], v7 offset:23552
  ds_read_b128 v[48:51], v7 offset:31744
  v_cvt_pk_bf16_f32 v124, v84, v86
  s_waitcnt lgkmcnt(14)
  v_smfmac_f32_16x16x64_bf16 v[100:103], v[116:119], v[52:59], v0
  v_add_f32 v88, v88, v89
  v_add_f32 v90, v90, v91
  s_waitcnt lgkmcnt(12)
  v_smfmac_f32_16x16x64_bf16 v[104:107], v[116:119], v[60:67], v0
  v_cvt_pk_bf16_f32 v125, v88, v90
  v_add_f32 v92, v92, v93
  s_waitcnt lgkmcnt(10)
  v_smfmac_f32_16x16x64_bf16 v[100:103], v[120:123], v[68:75], v0
  v_add_f32 v94, v94, v95
  v_cvt_pk_bf16_f32 v126, v92, v94
  s_waitcnt lgkmcnt(8)
  v_smfmac_f32_16x16x64_bf16 v[104:107], v[120:123], v[76:83], v0
  v_add_f32 v96, v96, v97
  v_add_f32 v98, v98, v99
  s_waitcnt lgkmcnt(6)
  v_smfmac_f32_16x16x64_bf16 v[108:111], v[116:119], v[20:27], v0
  v_cvt_pk_bf16_f32 v127, v96, v98
  v_bfi_b32 v124, 1, s33, v124
  s_waitcnt lgkmcnt(4)
  v_smfmac_f32_16x16x64_bf16 v[112:115], v[116:119], v[28:35], v0
  buffer_store_dwordx4 v[124:127], v8, s[8:11], s39 offen
  v_add_f32 v100, v100, v101
  s_waitcnt lgkmcnt(2)
  v_smfmac_f32_16x16x64_bf16 v[108:111], v[120:123], v[36:43], v0
  v_add_f32 v102, v102, v103
  v_cvt_pk_bf16_f32 v16, v100, v102
  s_waitcnt lgkmcnt(0)
  v_smfmac_f32_16x16x64_bf16 v[112:115], v[120:123], v[44:51], v0
  v_add_f32 v104, v104, v105
  v_add_f32 v106, v106, v107
  v_cvt_pk_bf16_f32 v17, v104, v106
  s_nop 0
  v_add_f32 v108, v108, v109
  v_add_f32 v110, v110, v111
  v_cvt_pk_bf16_f32 v18, v108, v110
  s_nop 0
  v_add_f32 v112, v112, v113
  v_add_f32 v114, v114, v115
  v_cvt_pk_bf16_f32 v19, v112, v114
  v_bfi_b32 v16, 1, s33, v16
  buffer_store_dwordx4 v[16:19], v8, s[8:11], s40 offen
  s_add_u32 s32, s32, 1
  s_add_u32 s49, s32, 2
  s_cmp_lg_u32 s3, 0
  s_cbranch_scc1 L_rec_nored
  v_bfe_u32 v108, v1, 4, 4
  v_and_b32 v109, 1, v108
  v_lshlrev_b32 v110, 4, v109
  v_mov_b32 v111, 0x3f80
  v_lshlrev_b32 v110, v110, v111
  v_lshrrev_b32 v111, 1, v108
  v_cmp_eq_u32 vcc, 0, v111
  s_nop 1
  v_cndmask_b32 v120, 0, v110, vcc
  v_cmp_eq_u32 vcc, 1, v111
  s_nop 1
  v_cndmask_b32 v121, 0, v110, vcc
  v_cmp_eq_u32 vcc, 2, v111
  s_nop 1
  v_cndmask_b32 v122, 0, v110, vcc
  v_cmp_eq_u32 vcc, 3, v111
  s_nop 1
  v_cndmask_b32 v123, 0, v110, vcc
  buffer_load_dwordx4 v[20:23], v1, s[8:11], s41 offen offset:0 sc1
  buffer_load_dwordx4 v[24:27], v1, s[8:11], s41 offen offset:1024 sc1
  buffer_load_dwordx4 v[28:31], v1, s[8:11], s41 offen offset:2048 sc1
  buffer_load_dwordx4 v[32:35], v1, s[8:11], s41 offen offset:3072 sc1
  buffer_load_dwordx4 v[36:39], v1, s[8:11], s42 offen offset:0 sc1
  buffer_load_dwordx4 v[40:43], v1, s[8:11], s42 offen offset:1024 sc1
  buffer_load_dwordx4 v[44:47], v1, s[8:11], s42 offen offset:2048 sc1
  buffer_load_dwordx4 v[48:51], v1, s[8:11], s42 offen offset:3072 sc1
  v_lshlrev_b32 v109, 5, v109
  v_bfe_u32 v110, v108, 2, 1
  v_lshl_or_b32 v109, v110, 4, v109
  v_bfe_u32 v110, v108, 1, 1
  v_lshl_or_b32 v109, v110, 3, v109
  v_lshrrev_b32 v110, 8, v1
  v_lshl_or_b32 v108, v110, 6, v109
  s_sub_u32 s6, s49, 1
  s_and_b32 s7, s6, 1
  s_lshl_b32 s7, s7, 12
  s_add_u32 s51, s38, s7
  s_and_b32 s6, s6, 3
  s_lshl_b32 s6, s6, 19
  s_add_u32 s50, s35, s6
  s_mov_b32 s7, 0
L_rec_rr:
  buffer_load_dwordx4 v[52:55], v1, s[8:11], s41 offen offset:0 sc1
  buffer_load_dwordx4 v[56:59], v1, s[8:11], s41 offen offset:1024 sc1
  buffer_load_dwordx4 v[60:63], v1, s[8:11], s41 offen offset:2048 sc1
  buffer_load_dwordx4 v[64:67], v1, s[8:11], s41 offen offset:3072 sc1
  buffer_load_dwordx4 v[68:71], v1, s[8:11], s42 offen offset:0 sc1
  buffer_load_dwordx4 v[72:75], v1, s[8:11], s42 offen offset:1024 sc1
  buffer_load_dwordx4 v[76:79], v1, s[8:11], s42 offen offset:2048 sc1
  buffer_load_dwordx4 v[80:83], v1, s[8:11], s42 offen offset:3072 sc1
  s_waitcnt vmcnt(15)
  v_mfma_f32_16x16x32_bf16 v[124:127], v[20:23], v[120:123], 0
  s_waitcnt vmcnt(14)
  v_mfma_f32_16x16x32_bf16 v[124:127], v[24:27], v[120:123], v[124:127]
  v_bitop3_b32 v109, v20, v24, s33 bitop3:0x7e
  s_waitcnt vmcnt(13)
  v_mfma_f32_16x16x32_bf16 v[124:127], v[28:31], v[120:123], v[124:127]
  s_waitcnt vmcnt(12)
  v_mfma_f32_16x16x32_bf16 v[124:127], v[32:35], v[120:123], v[124:127]
  v_bitop3_b32 v110, v28, v32, s33 bitop3:0x7e
  s_waitcnt vmcnt(11)
  v_mfma_f32_16x16x32_bf16 v[124:127], v[36:39], v[120:123], v[124:127]
  s_waitcnt vmcnt(10)
  v_mfma_f32_16x16x32_bf16 v[124:127], v[40:43], v[120:123], v[124:127]
  v_bitop3_b32 v111, v36, v40, s33 bitop3:0x7e
  s_waitcnt vmcnt(9)
  v_mfma_f32_16x16x32_bf16 v[124:127], v[44:47], v[120:123], v[124:127]
  s_waitcnt vmcnt(8)
  v_mfma_f32_16x16x32_bf16 v[124:127], v[48:51], v[120:123], v[124:127]
  v_bitop3_b32 v112, v44, v48, s33 bitop3:0x7e
  v_or3_b32 v109, v109, v110, v111
  v_bitop3_b32 v109, v109, v112, 1 bitop3:0xa8
  v_cmp_ne_u32 vcc, 0, v109
  s_cbranch_vccz L_rec_red
  buffer_load_dwordx4 v[20:23], v1, s[8:11], s41 offen offset:0 sc1
  buffer_load_dwordx4 v[24:27], v1, s[8:11], s41 offen offset:1024 sc1
  buffer_load_dwordx4 v[28:31], v1, s[8:11], s41 offen offset:2048 sc1
  buffer_load_dwordx4 v[32:35], v1, s[8:11], s41 offen offset:3072 sc1
  buffer_load_dwordx4 v[36:39], v1, s[8:11], s42 offen offset:0 sc1
  buffer_load_dwordx4 v[40:43], v1, s[8:11], s42 offen offset:1024 sc1
  buffer_load_dwordx4 v[44:47], v1, s[8:11], s42 offen offset:2048 sc1
  buffer_load_dwordx4 v[48:51], v1, s[8:11], s42 offen offset:3072 sc1
  s_waitcnt vmcnt(15)
  v_mfma_f32_16x16x32_bf16 v[124:127], v[52:55], v[120:123], 0
  s_waitcnt vmcnt(14)
  v_mfma_f32_16x16x32_bf16 v[124:127], v[56:59], v[120:123], v[124:127]
  v_bitop3_b32 v109, v52, v56, s33 bitop3:0x7e
  s_waitcnt vmcnt(13)
  v_mfma_f32_16x16x32_bf16 v[124:127], v[60:63], v[120:123], v[124:127]
  s_waitcnt vmcnt(12)
  v_mfma_f32_16x16x32_bf16 v[124:127], v[64:67], v[120:123], v[124:127]
  v_bitop3_b32 v110, v60, v64, s33 bitop3:0x7e
  s_waitcnt vmcnt(11)
  v_mfma_f32_16x16x32_bf16 v[124:127], v[68:71], v[120:123], v[124:127]
  s_waitcnt vmcnt(10)
  v_mfma_f32_16x16x32_bf16 v[124:127], v[72:75], v[120:123], v[124:127]
  v_bitop3_b32 v111, v68, v72, s33 bitop3:0x7e
  s_waitcnt vmcnt(9)
  v_mfma_f32_16x16x32_bf16 v[124:127], v[76:79], v[120:123], v[124:127]
  s_waitcnt vmcnt(8)
  v_mfma_f32_16x16x32_bf16 v[124:127], v[80:83], v[120:123], v[124:127]
  v_bitop3_b32 v112, v76, v80, s33 bitop3:0x7e
  v_or3_b32 v109, v109, v110, v111
  v_bitop3_b32 v109, v109, v112, 1 bitop3:0xa8
  v_cmp_ne_u32 vcc, 0, v109
  s_cbranch_vccz L_rec_red
  s_and_b32 s6, s7, 31
  s_cmp_lg_u32 s6, 31
  s_cbranch_scc1 L_tf_83
  buffer_wbl2 sc1
  s_waitcnt vmcnt(0)
  buffer_inv sc1
  s_waitcnt vmcnt(0)
L_tf_83:
  s_add_u32 s7, s7, 1
  s_cmp_lt_u32 s7, 131072
  s_cbranch_scc1 L_rec_rr
  s_mov_b32 s6, 14
  s_branch L_err
L_rec_red:
  s_nop 2
  v_cvt_pk_bf16_f32 v124, v124, v125
  v_cvt_pk_bf16_f32 v125, v126, v127
  v_bfi_b32 v124, 1, s33, v124
  s_mov_b64 exec, s[54:55]
  buffer_store_dwordx2 v[124:125], v108, s[8:11], s43 offen
  s_cmp_lg_u32 s32, 63
  s_cbranch_scc1 L_rec_nl
  buffer_store_dwordx2 v[124:125], v108, s[8:11], s43 offen sc1
L_rec_nl:
  s_mov_b64 exec, -1
  s_barrier
  s_branch L_rec_loop
L_rec_nored:
  s_sub_u32 s6, s49, 1
  s_and_b32 s7, s6, 1
  s_lshl_b32 s7, s7, 12
  s_add_u32 s51, s38, s7
  s_and_b32 s6, s6, 3
  s_lshl_b32 s6, s6, 19
  s_add_u32 s50, s35, s6
  s_barrier
  s_branch L_rec_loop
L_rec_kvwait:
  s_mov_b32 s7, 0
L_pl_84:
  buffer_load_dwordx4 v[120:123], v13, s[8:11], s51 offen offset:0 sc1
  s_waitcnt vmcnt(0)
  v_min_u32 v120, v120, v121
  v_min3_u32 v120, v120, v122, v123
  v_cmp_gt_u32 vcc, s49, v120
  s_cbranch_vccz L_plo_85
  s_add_u32 s7, s7, 1
  s_cmp_lt_u32 s7, 131072
  s_cbranch_scc1 L_pl_84
  s_mov_b32 s6, 13
  s_branch L_err
L_plo_85:
  s_branch L_rec_kvok
L_rec_last:
  s_waitcnt vmcnt(0)
  s_endpgm
L_p:
  s_sub_u32 s35, s4, 2
  s_lshr_b32 s35, s35, 1
  s_and_b32 s6, s4, 1
  s_lshl_b32 s6, s6, 4
  s_and_b32 s36, s5, 15
  s_add_u32 s36, s36, s6
  s_lshr_b32 s37, s5, 4
  s_mul_i32 s38, s35, 0x200000
  s_add_u32 s38, s38, 0x0
  s_mul_i32 s39, s35, 0x2000000
  s_add_u32 s39, s39, 0x800000
  s_mul_i32 s40, s35, 0x1000000
  s_add_u32 s40, s40, 0x4800000
  s_mul_i32 s41, s35, 0x1000000
  s_add_u32 s41, s41, 0x6800000
  s_mul_i32 s44, s35, 0x800
  s_add_u32 s44, s44, 0x710000
  s_lshl_b32 s6, s3, 13
  s_add_u32 s38, s38, s6
  s_add_u32 s53, s6, 0
  s_lshl_b32 s6, s36, 14
  s_lshl_b32 s7, s3, 11
  s_add_u32 s39, s39, s6
  s_add_u32 s39, s39, s7
  s_lshl_b32 s6, s36, 12
  s_lshl_b32 s7, s3, 10
  s_add_u32 s40, s40, s6
  s_add_u32 s40, s40, s7
  s_lshl_b32 s6, s36, 13
  s_lshr_b32 s7, s3, 1
  s_lshl_b32 s7, s7, 12
  s_add_u32 s41, s41, s6
  s_add_u32 s41, s41, s7
  s_lshl_b32 s6, s35, 13
  s_lshl_b32 s7, s37, 12
  s_add_u32 s6, s6, s7
  s_lshl_b32 s7, s36, 7
  s_add_u32 s6, s6, s7
  s_lshl_b32 s7, s3, 2
  s_add_u32 s6, s6, s7
  s_add_u32 s42, s6, 0x714000
  s_add_u32 s43, s6, 0x718000
  s_mov_b32 s34, 0x3e0293ee
  v_mov_b32 v12, 0
  v_mov_b32 v13, 0
  s_mov_b64 exec, 1
  buffer_store_dword v12, v12, s[8:11], s42 offen sc1
  buffer_store_dword v12, v12, s[8:11], s43 offen sc1
  s_mov_b64 exec, -1
  s_cmp_ge_u32 s4, 4
  s_cbranch_scc1 L_pro
L_p2:
  v_mov_b32 v12, 0
  v_mov_b32 v13, 0
  v_lshlrev_b32 v0, 4, v0
  s_mov_b32 s16, s82
  s_mov_b32 s17, s83
  s_mov_b32 s18, 0x400000
  s_mov_b32 s19, 0x20000
  s_mov_b32 s20, s84
  s_mov_b32 s21, s85
  s_mov_b32 s22, 0x400000
  s_mov_b32 s23, 0x20000
  s_mov_b32 s24, s86
  s_mov_b32 s25, s87
  s_mov_b32 s26, 0x400000
  s_mov_b32 s27, 0x20000
  v_lshrrev_b32 v104, 4, v0
  v_lshrrev_b32 v100, 8, v0
  v_lshlrev_b32 v105, 2, v100
  v_and_b32 v104, 15, v104
  v_xor_b32 v104, v104, v105
  v_mul_u32_u24 v100, 8192, v100
  v_lshl_add_u32 v100, v104, 4, v100
  v_bfe_u32 v104, v0, 6, 2
  v_lshlrev_b32 v105, 2, v104
  v_bfe_u32 v106, v0, 8, 1
  v_lshlrev_b32 v106, 1, v106
  v_bfe_u32 v107, v0, 5, 1
  v_or_b32 v106, v106, v107
  s_lshl_b32 s6, s3, 2
  v_or_b32 v106, s6, v106
  v_xor_b32 v106, v106, v105
  v_lshlrev_b32 v106, 4, v106
  v_bfe_u32 v107, v0, 4, 1
  v_lshl_or_b32 v106, v107, 3, v106
  v_bfe_u32 v107, v0, 9, 1
  v_lshl_or_b32 v104, v107, 3, v104
  v_lshl_or_b32 v104, v104, 8, v106
  v_add_u32 v105, 0x10000, v104
  s_lshl_b32 s60, s3, 13
  s_mul_i32 s63, s3, 262144
  s_lshr_b32 s6, 0x72, s4
  s_bitcmp1_b32 s6, 0
  s_cbranch_scc1 L_rdn_86
  s_waitcnt vmcnt(0)
  s_barrier
  s_cmp_lg_u32 s3, 0
  s_cbranch_scc1 L_sd_87
  s_mov_b64 exec, 1
  s_and_b32 s6, s4, 3
  s_lshl_b32 s6, s6, 6
  v_mov_b32 v18, 16
  v_mov_b32 v19, 1
  buffer_atomic_add v19, v18, s[12:15], s6 offen sc1
  s_mov_b64 exec, -1
L_sd_87:
L_rdn_86:
  s_lshl_b32 s61, s36, 8
  s_add_u32 s61, s61, 0
  s_add_u32 s61, s61, s63
  s_add_u32 m0, s60, 0
  s_add_u32 s62, s61, 0
  buffer_load_dwordx4 v100, s[16:19], s62 offen lds
  s_add_u32 m0, s60, 1024
  s_add_u32 s62, s61, 32768
  buffer_load_dwordx4 v100, s[16:19], s62 offen lds
  s_add_u32 m0, s60, 2048
  s_add_u32 s62, s61, 65536
  buffer_load_dwordx4 v100, s[16:19], s62 offen lds
  s_add_u32 m0, s60, 3072
  s_add_u32 s62, s61, 98304
  buffer_load_dwordx4 v100, s[16:19], s62 offen lds
  s_add_u32 m0, s60, 4096
  s_add_u32 s62, s61, 131072
  buffer_load_dwordx4 v100, s[16:19], s62 offen lds
  s_add_u32 m0, s60, 5120
  s_add_u32 s62, s61, 163840
  buffer_load_dwordx4 v100, s[16:19], s62 offen lds
  s_add_u32 m0, s60, 6144
  s_add_u32 s62, s61, 196608
  buffer_load_dwordx4 v100, s[16:19], s62 offen lds
  s_add_u32 m0, s60, 7168
  s_add_u32 s62, s61, 229376
  buffer_load_dwordx4 v100, s[16:19], s62 offen lds
  s_lshl_b32 s61, s36, 8
  s_add_u32 s61, s61, 1048576
  s_add_u32 s61, s61, s63
  s_add_u32 m0, s60, 32768
  s_add_u32 s62, s61, 0
  buffer_load_dwordx4 v100, s[16:19], s62 offen lds
  s_add_u32 m0, s60, 33792
  s_add_u32 s62, s61, 32768
  buffer_load_dwordx4 v100, s[16:19], s62 offen lds
  s_add_u32 m0, s60, 34816
  s_add_u32 s62, s61, 65536
  buffer_load_dwordx4 v100, s[16:19], s62 offen lds
  s_add_u32 m0, s60, 35840
  s_add_u32 s62, s61, 98304
  buffer_load_dwordx4 v100, s[16:19], s62 offen lds
  s_add_u32 m0, s60, 36864
  s_add_u32 s62, s61, 131072
  buffer_load_dwordx4 v100, s[16:19], s62 offen lds
  s_add_u32 m0, s60, 37888
  s_add_u32 s62, s61, 163840
  buffer_load_dwordx4 v100, s[16:19], s62 offen lds
  s_add_u32 m0, s60, 38912
  s_add_u32 s62, s61, 196608
  buffer_load_dwordx4 v100, s[16:19], s62 offen lds
  s_add_u32 m0, s60, 39936
  s_add_u32 s62, s61, 229376
  buffer_load_dwordx4 v100, s[16:19], s62 offen lds
  s_lshl_b32 s61, s36, 8
  s_add_u32 s61, s61, 2097152
  s_add_u32 s61, s61, s63
  s_add_u32 m0, s60, 65536
  s_add_u32 s62, s61, 0
  buffer_load_dwordx4 v100, s[16:19], s62 offen lds
  s_add_u32 m0, s60, 66560
  s_add_u32 s62, s61, 32768
  buffer_load_dwordx4 v100, s[16:19], s62 offen lds
  s_add_u32 m0, s60, 67584
  s_add_u32 s62, s61, 65536
  buffer_load_dwordx4 v100, s[16:19], s62 offen lds
  s_add_u32 m0, s60, 68608
  s_add_u32 s62, s61, 98304
  buffer_load_dwordx4 v100, s[16:19], s62 offen lds
  s_add_u32 m0, s60, 69632
  s_add_u32 s62, s61, 131072
  buffer_load_dwordx4 v100, s[16:19], s62 offen lds
  s_add_u32 m0, s60, 70656
  s_add_u32 s62, s61, 163840
  buffer_load_dwordx4 v100, s[16:19], s62 offen lds
  s_add_u32 m0, s60, 71680
  s_add_u32 s62, s61, 196608
  buffer_load_dwordx4 v100, s[16:19], s62 offen lds
  s_add_u32 m0, s60, 72704
  s_add_u32 s62, s61, 229376
  buffer_load_dwordx4 v100, s[16:19], s62 offen lds
  s_waitcnt vmcnt(16)
  s_barrier
  s_lshl_b32 s61, s36, 8
  s_add_u32 s61, s61, 3145728
  s_add_u32 s61, s61, s63
  s_add_u32 m0, s60, 98304
  s_add_u32 s62, s61, 0
  buffer_load_dwordx4 v100, s[16:19], s62 offen lds
  s_add_u32 m0, s60, 99328
  s_add_u32 s62, s61, 32768
  buffer_load_dwordx4 v100, s[16:19], s62 offen lds
  s_add_u32 m0, s60, 100352
  s_add_u32 s62, s61, 65536
  buffer_load_dwordx4 v100, s[16:19], s62 offen lds
  s_add_u32 m0, s60, 101376
  s_add_u32 s62, s61, 98304
  buffer_load_dwordx4 v100, s[16:19], s62 offen lds
  s_add_u32 m0, s60, 102400
  s_add_u32 s62, s61, 131072
  buffer_load_dwordx4 v100, s[16:19], s62 offen lds
  s_add_u32 m0, s60, 103424
  s_add_u32 s62, s61, 163840
  buffer_load_dwordx4 v100, s[16:19], s62 offen lds
  s_add_u32 m0, s60, 104448
  s_add_u32 s62, s61, 196608
  buffer_load_dwordx4 v100, s[16:19], s62 offen lds
  s_add_u32 m0, s60, 105472
  s_add_u32 s62, s61, 229376
  buffer_load_dwordx4 v100, s[16:19], s62 offen lds
  ds_read_b64_tr_b16 a[0:1], v104 offset:0
  ds_read_b64_tr_b16 a[2:3], v104 offset:1024
  ds_read_b64_tr_b16 a[4:5], v104 offset:4096
  ds_read_b64_tr_b16 a[6:7], v104 offset:5120
  ds_read_b64_tr_b16 a[8:9], v104 offset:8192
  ds_read_b64_tr_b16 a[10:11], v104 offset:9216
  ds_read_b64_tr_b16 a[12:13], v104 offset:12288
  ds_read_b64_tr_b16 a[14:15], v104 offset:13312
  ds_read_b64_tr_b16 a[16:17], v104 offset:16384
  ds_read_b64_tr_b16 a[18:19], v104 offset:17408
  ds_read_b64_tr_b16 a[20:21], v104 offset:20480
  ds_read_b64_tr_b16 a[22:23], v104 offset:21504
  ds_read_b64_tr_b16 a[24:25], v104 offset:24576
  ds_read_b64_tr_b16 a[26:27], v104 offset:25600
  ds_read_b64_tr_b16 a[28:29], v104 offset:28672
  ds_read_b64_tr_b16 a[30:31], v104 offset:29696
  s_waitcnt lgkmcnt(0)
  s_waitcnt vmcnt(16)
  s_barrier
  s_lshl_b32 s61, s36, 8
  s_add_u32 s61, s61, 0
  s_add_u32 s61, s61, s63
  s_add_u32 m0, s60, 0
  s_add_u32 s62, s61, 0
  buffer_load_dwordx4 v100, s[20:23], s62 offen lds
  s_add_u32 m0, s60, 1024
  s_add_u32 s62, s61, 32768
  buffer_load_dwordx4 v100, s[20:23], s62 offen lds
  s_add_u32 m0, s60, 2048
  s_add_u32 s62, s61, 65536
  buffer_load_dwordx4 v100, s[20:23], s62 offen lds
  s_add_u32 m0, s60, 3072
  s_add_u32 s62, s61, 98304
  buffer_load_dwordx4 v100, s[20:23], s62 offen lds
  s_add_u32 m0, s60, 4096
  s_add_u32 s62, s61, 131072
  buffer_load_dwordx4 v100, s[20:23], s62 offen lds
  s_add_u32 m0, s60, 5120
  s_add_u32 s62, s61, 163840
  buffer_load_dwordx4 v100, s[20:23], s62 offen lds
  s_add_u32 m0, s60, 6144
  s_add_u32 s62, s61, 196608
  buffer_load_dwordx4 v100, s[20:23], s62 offen lds
  s_add_u32 m0, s60, 7168
  s_add_u32 s62, s61, 229376
  buffer_load_dwordx4 v100, s[20:23], s62 offen lds
  ds_read_b64_tr_b16 a[32:33], v104 offset:32768
  ds_read_b64_tr_b16 a[34:35], v104 offset:33792
  ds_read_b64_tr_b16 a[36:37], v104 offset:36864
  ds_read_b64_tr_b16 a[38:39], v104 offset:37888
  ds_read_b64_tr_b16 a[40:41], v104 offset:40960
  ds_read_b64_tr_b16 a[42:43], v104 offset:41984
  ds_read_b64_tr_b16 a[44:45], v104 offset:45056
  ds_read_b64_tr_b16 a[46:47], v104 offset:46080
  ds_read_b64_tr_b16 a[48:49], v104 offset:49152
  ds_read_b64_tr_b16 a[50:51], v104 offset:50176
  ds_read_b64_tr_b16 a[52:53], v104 offset:53248
  ds_read_b64_tr_b16 a[54:55], v104 offset:54272
  ds_read_b64_tr_b16 a[56:57], v104 offset:57344
  ds_read_b64_tr_b16 a[58:59], v104 offset:58368
  ds_read_b64_tr_b16 a[60:61], v104 offset:61440
  ds_read_b64_tr_b16 a[62:63], v104 offset:62464
  s_waitcnt lgkmcnt(0)
  s_waitcnt vmcnt(16)
  s_barrier
  s_lshl_b32 s61, s36, 8
  s_add_u32 s61, s61, 1048576
  s_add_u32 s61, s61, s63
  s_add_u32 m0, s60, 32768
  s_add_u32 s62, s61, 0
  buffer_load_dwordx4 v100, s[20:23], s62 offen lds
  s_add_u32 m0, s60, 33792
  s_add_u32 s62, s61, 32768
  buffer_load_dwordx4 v100, s[20:23], s62 offen lds
  s_add_u32 m0, s60, 34816
  s_add_u32 s62, s61, 65536
  buffer_load_dwordx4 v100, s[20:23], s62 offen lds
  s_add_u32 m0, s60, 35840
  s_add_u32 s62, s61, 98304
  buffer_load_dwordx4 v100, s[20:23], s62 offen lds
  s_add_u32 m0, s60, 36864
  s_add_u32 s62, s61, 131072
  buffer_load_dwordx4 v100, s[20:23], s62 offen lds
  s_add_u32 m0, s60, 37888
  s_add_u32 s62, s61, 163840
  buffer_load_dwordx4 v100, s[20:23], s62 offen lds
  s_add_u32 m0, s60, 38912
  s_add_u32 s62, s61, 196608
  buffer_load_dwordx4 v100, s[20:23], s62 offen lds
  s_add_u32 m0, s60, 39936
  s_add_u32 s62, s61, 229376
  buffer_load_dwordx4 v100, s[20:23], s62 offen lds
  ds_read_b64_tr_b16 a[64:65], v105 offset:0
  ds_read_b64_tr_b16 a[66:67], v105 offset:1024
  ds_read_b64_tr_b16 a[68:69], v105 offset:4096
  ds_read_b64_tr_b16 a[70:71], v105 offset:5120
  ds_read_b64_tr_b16 a[72:73], v105 offset:8192
  ds_read_b64_tr_b16 a[74:75], v105 offset:9216
  ds_read_b64_tr_b16 a[76:77], v105 offset:12288
  ds_read_b64_tr_b16 a[78:79], v105 offset:13312
  ds_read_b64_tr_b16 a[80:81], v105 offset:16384
  ds_read_b64_tr_b16 a[82:83], v105 offset:17408
  ds_read_b64_tr_b16 a[84:85], v105 offset:20480
  ds_read_b64_tr_b16 a[86:87], v105 offset:21504
  ds_read_b64_tr_b16 a[88:89], v105 offset:24576
  ds_read_b64_tr_b16 a[90:91], v105 offset:25600
  ds_read_b64_tr_b16 a[92:93], v105 offset:28672
  ds_read_b64_tr_b16 a[94:95], v105 offset:29696
  s_waitcnt lgkmcnt(0)
  s_waitcnt vmcnt(16)
  s_barrier
  s_lshl_b32 s61, s36, 8
  s_add_u32 s61, s61, 2097152
  s_add_u32 s61, s61, s63
  s_add_u32 m0, s60, 65536
  s_add_u32 s62, s61, 0
  buffer_load_dwordx4 v100, s[20:23], s62 offen lds
  s_add_u32 m0, s60, 66560
  s_add_u32 s62, s61, 32768
  buffer_load_dwordx4 v100, s[20:23], s62 offen lds
  s_add_u32 m0, s60, 67584
  s_add_u32 s62, s61, 65536
  buffer_load_dwordx4 v100, s[20:23], s62 offen lds
  s_add_u32 m0, s60, 68608
  s_add_u32 s62, s61, 98304
  buffer_load_dwordx4 v100, s[20:23], s62 offen lds
  s_add_u32 m0, s60, 69632
  s_add_u32 s62, s61, 131072
  buffer_load_dwordx4 v100, s[20:23], s62 offen lds
  s_add_u32 m0, s60, 70656
  s_add_u32 s62, s61, 163840
  buffer_load_dwordx4 v100, s[20:23], s62 offen lds
  s_add_u32 m0, s60, 71680
  s_add_u32 s62, s61, 196608
  buffer_load_dwordx4 v100, s[20:23], s62 offen lds
  s_add_u32 m0, s60, 72704
  s_add_u32 s62, s61, 229376
  buffer_load_dwordx4 v100, s[20:23], s62 offen lds
  ds_read_b64_tr_b16 a[96:97], v105 offset:32768
  ds_read_b64_tr_b16 a[98:99], v105 offset:33792
  ds_read_b64_tr_b16 a[100:101], v105 offset:36864
  ds_read_b64_tr_b16 a[102:103], v105 offset:37888
  ds_read_b64_tr_b16 a[104:105], v105 offset:40960
  ds_read_b64_tr_b16 a[106:107], v105 offset:41984
  ds_read_b64_tr_b16 a[108:109], v105 offset:45056
  ds_read_b64_tr_b16 a[110:111], v105 offset:46080
  ds_read_b64_tr_b16 a[112:113], v105 offset:49152
  ds_read_b64_tr_b16 a[114:115], v105 offset:50176
  ds_read_b64_tr_b16 a[116:117], v105 offset:53248
  ds_read_b64_tr_b16 a[118:119], v105 offset:54272
  ds_read_b64_tr_b16 a[120:121], v105 offset:57344
  ds_read_b64_tr_b16 a[122:123], v105 offset:58368
  ds_read_b64_tr_b16 a[124:125], v105 offset:61440
  ds_read_b64_tr_b16 a[126:127], v105 offset:62464
  s_waitcnt lgkmcnt(0)
  s_waitcnt vmcnt(16)
  s_barrier
  s_lshl_b32 s61, s36, 8
  s_add_u32 s61, s61, 3145728
  s_add_u32 s61, s61, s63
  s_add_u32 m0, s60, 98304
  s_add_u32 s62, s61, 0
  buffer_load_dwordx4 v100, s[20:23], s62 offen lds
  s_add_u32 m0, s60, 99328
  s_add_u32 s62, s61, 32768
  buffer_load_dwordx4 v100, s[20:23], s62 offen lds
  s_add_u32 m0, s60, 100352
  s_add_u32 s62, s61, 65536
  buffer_load_dwordx4 v100, s[20:23], s62 offen lds
  s_add_u32 m0, s60, 101376
  s_add_u32 s62, s61, 98304
  buffer_load_dwordx4 v100, s[20:23], s62 offen lds
  s_add_u32 m0, s60, 102400
  s_add_u32 s62, s61, 131072
  buffer_load_dwordx4 v100, s[20:23], s62 offen lds
  s_add_u32 m0, s60, 103424
  s_add_u32 s62, s61, 163840
  buffer_load_dwordx4 v100, s[20:23], s62 offen lds
  s_add_u32 m0, s60, 104448
  s_add_u32 s62, s61, 196608
  buffer_load_dwordx4 v100, s[20:23], s62 offen lds
  s_add_u32 m0, s60, 105472
  s_add_u32 s62, s61, 229376
  buffer_load_dwordx4 v100, s[20:23], s62 offen lds
  ds_read_b64_tr_b16 a[128:129], v104 offset:0
  ds_read_b64_tr_b16 a[130:131], v104 offset:1024
  ds_read_b64_tr_b16 a[132:133], v104 offset:4096
  ds_read_b64_tr_b16 a[134:135], v104 offset:5120
  ds_read_b64_tr_b16 a[136:137], v104 offset:8192
  ds_read_b64_tr_b16 a[138:139], v104 offset:9216
  ds_read_b64_tr_b16 a[140:141], v104 offset:12288
  ds_read_b64_tr_b16 a[142:143], v104 offset:13312
  ds_read_b64_tr_b16 a[144:145], v104 offset:16384
  ds_read_b64_tr_b16 a[146:147], v104 offset:17408
  ds_read_b64_tr_b16 a[148:149], v104 offset:20480
  ds_read_b64_tr_b16 a[150:151], v104 offset:21504
  ds_read_b64_tr_b16 a[152:153], v104 offset:24576
  ds_read_b64_tr_b16 a[154:155], v104 offset:25600
  ds_read_b64_tr_b16 a[156:157], v104 offset:28672
  ds_read_b64_tr_b16 a[158:159], v104 offset:29696
  s_waitcnt lgkmcnt(0)
  s_waitcnt vmcnt(16)
  s_barrier
  s_lshl_b32 s61, s36, 8
  s_add_u32 s61, s61, 0
  s_add_u32 s61, s61, s63
  s_add_u32 m0, s60, 0
  s_add_u32 s62, s61, 0
  buffer_load_dwordx4 v100, s[24:27], s62 offen lds
  s_add_u32 m0, s60, 1024
  s_add_u32 s62, s61, 32768
  buffer_load_dwordx4 v100, s[24:27], s62 offen lds
  s_add_u32 m0, s60, 2048
  s_add_u32 s62, s61, 65536
  buffer_load_dwordx4 v100, s[24:27], s62 offen lds
  s_add_u32 m0, s60, 3072
  s_add_u32 s62, s61, 98304
  buffer_load_dwordx4 v100, s[24:27], s62 offen lds
  s_add_u32 m0, s60, 4096
  s_add_u32 s62, s61, 131072
  buffer_load_dwordx4 v100, s[24:27], s62 offen lds
  s_add_u32 m0, s60, 5120
  s_add_u32 s62, s61, 163840
  buffer_load_dwordx4 v100, s[24:27], s62 offen lds
  s_add_u32 m0, s60, 6144
  s_add_u32 s62, s61, 196608
  buffer_load_dwordx4 v100, s[24:27], s62 offen lds
  s_add_u32 m0, s60, 7168
  s_add_u32 s62, s61, 229376
  buffer_load_dwordx4 v100, s[24:27], s62 offen lds
  ds_read_b64_tr_b16 a[160:161], v104 offset:32768
  ds_read_b64_tr_b16 a[162:163], v104 offset:33792
  ds_read_b64_tr_b16 a[164:165], v104 offset:36864
  ds_read_b64_tr_b16 a[166:167], v104 offset:37888
  ds_read_b64_tr_b16 a[168:169], v104 offset:40960
  ds_read_b64_tr_b16 a[170:171], v104 offset:41984
  ds_read_b64_tr_b16 a[172:173], v104 offset:45056
  ds_read_b64_tr_b16 a[174:175], v104 offset:46080
  ds_read_b64_tr_b16 a[176:177], v104 offset:49152
  ds_read_b64_tr_b16 a[178:179], v104 offset:50176
  ds_read_b64_tr_b16 a[180:181], v104 offset:53248
  ds_read_b64_tr_b16 a[182:183], v104 offset:54272
  ds_read_b64_tr_b16 a[184:185], v104 offset:57344
  ds_read_b64_tr_b16 a[186:187], v104 offset:58368
  ds_read_b64_tr_b16 a[188:189], v104 offset:61440
  ds_read_b64_tr_b16 a[190:191], v104 offset:62464
  s_waitcnt lgkmcnt(0)
  s_waitcnt vmcnt(16)
  s_barrier
  s_lshl_b32 s61, s36, 8
  s_add_u32 s61, s61, 1048576
  s_add_u32 s61, s61, s63
  s_add_u32 m0, s60, 32768
  s_add_u32 s62, s61, 0
  buffer_load_dwordx4 v100, s[24:27], s62 offen lds
  s_add_u32 m0, s60, 33792
  s_add_u32 s62, s61, 32768
  buffer_load_dwordx4 v100, s[24:27], s62 offen lds
  s_add_u32 m0, s60, 34816
  s_add_u32 s62, s61, 65536
  buffer_load_dwordx4 v100, s[24:27], s62 offen lds
  s_add_u32 m0, s60, 35840
  s_add_u32 s62, s61, 98304
  buffer_load_dwordx4 v100, s[24:27], s62 offen lds
  s_add_u32 m0, s60, 36864
  s_add_u32 s62, s61, 131072
  buffer_load_dwordx4 v100, s[24:27], s62 offen lds
  s_add_u32 m0, s60, 37888
  s_add_u32 s62, s61, 163840
  buffer_load_dwordx4 v100, s[24:27], s62 offen lds
  s_add_u32 m0, s60, 38912
  s_add_u32 s62, s61, 196608
  buffer_load_dwordx4 v100, s[24:27], s62 offen lds
  s_add_u32 m0, s60, 39936
  s_add_u32 s62, s61, 229376
  buffer_load_dwordx4 v100, s[24:27], s62 offen lds
  ds_read_b64_tr_b16 a[192:193], v105 offset:0
  ds_read_b64_tr_b16 a[194:195], v105 offset:1024
  ds_read_b64_tr_b16 a[196:197], v105 offset:4096
  ds_read_b64_tr_b16 a[198:199], v105 offset:5120
  ds_read_b64_tr_b16 a[200:201], v105 offset:8192
  ds_read_b64_tr_b16 a[202:203], v105 offset:9216
  ds_read_b64_tr_b16 a[204:205], v105 offset:12288
  ds_read_b64_tr_b16 a[206:207], v105 offset:13312
  ds_read_b64_tr_b16 a[208:209], v105 offset:16384
  ds_read_b64_tr_b16 a[210:211], v105 offset:17408
  ds_read_b64_tr_b16 a[212:213], v105 offset:20480
  ds_read_b64_tr_b16 a[214:215], v105 offset:21504
  ds_read_b64_tr_b16 a[216:217], v105 offset:24576
  ds_read_b64_tr_b16 a[218:219], v105 offset:25600
  ds_read_b64_tr_b16 a[220:221], v105 offset:28672
  ds_read_b64_tr_b16 a[222:223], v105 offset:29696
  s_waitcnt lgkmcnt(0)
  s_waitcnt vmcnt(16)
  s_barrier
  s_lshl_b32 s61, s36, 8
  s_add_u32 s61, s61, 2097152
  s_add_u32 s61, s61, s63
  s_add_u32 m0, s60, 65536
  s_add_u32 s62, s61, 0
  buffer_load_dwordx4 v100, s[24:27], s62 offen lds
  s_add_u32 m0, s60, 66560
  s_add_u32 s62, s61, 32768
  buffer_load_dwordx4 v100, s[24:27], s62 offen lds
  s_add_u32 m0, s60, 67584
  s_add_u32 s62, s61, 65536
  buffer_load_dwordx4 v100, s[24:27], s62 offen lds
  s_add_u32 m0, s60, 68608
  s_add_u32 s62, s61, 98304
  buffer_load_dwordx4 v100, s[24:27], s62 offen lds
  s_add_u32 m0, s60, 69632
  s_add_u32 s62, s61, 131072
  buffer_load_dwordx4 v100, s[24:27], s62 offen lds
  s_add_u32 m0, s60, 70656
  s_add_u32 s62, s61, 163840
  buffer_load_dwordx4 v100, s[24:27], s62 offen lds
  s_add_u32 m0, s60, 71680
  s_add_u32 s62, s61, 196608
  buffer_load_dwordx4 v100, s[24:27], s62 offen lds
  s_add_u32 m0, s60, 72704
  s_add_u32 s62, s61, 229376
  buffer_load_dwordx4 v100, s[24:27], s62 offen lds
  ds_read_b64_tr_b16 a[224:225], v105 offset:32768
  ds_read_b64_tr_b16 a[226:227], v105 offset:33792
  ds_read_b64_tr_b16 a[228:229], v105 offset:36864
  ds_read_b64_tr_b16 a[230:231], v105 offset:37888
  ds_read_b64_tr_b16 a[232:233], v105 offset:40960
  ds_read_b64_tr_b16 a[234:235], v105 offset:41984
  ds_read_b64_tr_b16 a[236:237], v105 offset:45056
  ds_read_b64_tr_b16 a[238:239], v105 offset:46080
  ds_read_b64_tr_b16 a[240:241], v105 offset:49152
  ds_read_b64_tr_b16 a[242:243], v105 offset:50176
  ds_read_b64_tr_b16 a[244:245], v105 offset:53248
  ds_read_b64_tr_b16 a[246:247], v105 offset:54272
  ds_read_b64_tr_b16 a[248:249], v105 offset:57344
  ds_read_b64_tr_b16 a[250:251], v105 offset:58368
  ds_read_b64_tr_b16 a[252:253], v105 offset:61440
  ds_read_b64_tr_b16 a[254:255], v105 offset:62464
  s_waitcnt lgkmcnt(0)
  s_waitcnt vmcnt(16)
  s_barrier
  s_lshl_b32 s61, s36, 8
  s_add_u32 s61, s61, 3145728
  s_add_u32 s61, s61, s63
  s_add_u32 m0, s60, 98304
  s_add_u32 s62, s61, 0
  buffer_load_dwordx4 v100, s[24:27], s62 offen lds
  s_add_u32 m0, s60, 99328
  s_add_u32 s62, s61, 32768
  buffer_load_dwordx4 v100, s[24:27], s62 offen lds
  s_add_u32 m0, s60, 100352
  s_add_u32 s62, s61, 65536
  buffer_load_dwordx4 v100, s[24:27], s62 offen lds
  s_add_u32 m0, s60, 101376
  s_add_u32 s62, s61, 98304
  buffer_load_dwordx4 v100, s[24:27], s62 offen lds
  s_add_u32 m0, s60, 102400
  s_add_u32 s62, s61, 131072
  buffer_load_dwordx4 v100, s[24:27], s62 offen lds
  s_add_u32 m0, s60, 103424
  s_add_u32 s62, s61, 163840
  buffer_load_dwordx4 v100, s[24:27], s62 offen lds
  s_add_u32 m0, s60, 104448
  s_add_u32 s62, s61, 196608
  buffer_load_dwordx4 v100, s[24:27], s62 offen lds
  s_add_u32 m0, s60, 105472
  s_add_u32 s62, s61, 229376
  buffer_load_dwordx4 v100, s[24:27], s62 offen lds
  ds_read_b64_tr_b16 v[128:129], v104 offset:0
  ds_read_b64_tr_b16 v[130:131], v104 offset:1024
  ds_read_b64_tr_b16 v[132:133], v104 offset:4096
  ds_read_b64_tr_b16 v[134:135], v104 offset:5120
  ds_read_b64_tr_b16 v[136:137], v104 offset:8192
  ds_read_b64_tr_b16 v[138:139], v104 offset:9216
  ds_read_b64_tr_b16 v[140:141], v104 offset:12288
  ds_read_b64_tr_b16 v[142:143], v104 offset:13312
  ds_read_b64_tr_b16 v[144:145], v104 offset:16384
  ds_read_b64_tr_b16 v[146:147], v104 offset:17408
  ds_read_b64_tr_b16 v[148:149], v104 offset:20480
  ds_read_b64_tr_b16 v[150:151], v104 offset:21504
  ds_read_b64_tr_b16 v[152:153], v104 offset:24576
  ds_read_b64_tr_b16 v[154:155], v104 offset:25600
  ds_read_b64_tr_b16 v[156:157], v104 offset:28672
  ds_read_b64_tr_b16 v[158:159], v104 offset:29696
  s_waitcnt lgkmcnt(0)
  s_waitcnt vmcnt(16)
  s_barrier
  ds_read_b64_tr_b16 v[160:161], v104 offset:32768
  ds_read_b64_tr_b16 v[162:163], v104 offset:33792
  ds_read_b64_tr_b16 v[164:165], v104 offset:36864
  ds_read_b64_tr_b16 v[166:167], v104 offset:37888
  ds_read_b64_tr_b16 v[168:169], v104 offset:40960
  ds_read_b64_tr_b16 v[170:171], v104 offset:41984
  ds_read_b64_tr_b16 v[172:173], v104 offset:45056
  ds_read_b64_tr_b16 v[174:175], v104 offset:46080
  ds_read_b64_tr_b16 v[176:177], v104 offset:49152
  ds_read_b64_tr_b16 v[178:179], v104 offset:50176
  ds_read_b64_tr_b16 v[180:181], v104 offset:53248
  ds_read_b64_tr_b16 v[182:183], v104 offset:54272
  ds_read_b64_tr_b16 v[184:185], v104 offset:57344
  ds_read_b64_tr_b16 v[186:187], v104 offset:58368
  ds_read_b64_tr_b16 v[188:189], v104 offset:61440
  ds_read_b64_tr_b16 v[190:191], v104 offset:62464
  s_waitcnt lgkmcnt(0)
  s_waitcnt vmcnt(8)
  s_barrier
  ds_read_b64_tr_b16 v[192:193], v105 offset:0
  ds_read_b64_tr_b16 v[194:195], v105 offset:1024
  ds_read_b64_tr_b16 v[196:197], v105 offset:4096
  ds_read_b64_tr_b16 v[198:199], v105 offset:5120
  ds_read_b64_tr_b16 v[200:201], v105 offset:8192
  ds_read_b64_tr_b16 v[202:203], v105 offset:9216
  ds_read_b64_tr_b16 v[204:205], v105 offset:12288
  ds_read_b64_tr_b16 v[206:207], v105 offset:13312
  ds_read_b64_tr_b16 v[208:209], v105 offset:16384
  ds_read_b64_tr_b16 v[210:211], v105 offset:17408
  ds_read_b64_tr_b16 v[212:213], v105 offset:20480
  ds_read_b64_tr_b16 v[214:215], v105 offset:21504
  ds_read_b64_tr_b16 v[216:217], v105 offset:24576
  ds_read_b64_tr_b16 v[218:219], v105 offset:25600
  ds_read_b64_tr_b16 v[220:221], v105 offset:28672
  ds_read_b64_tr_b16 v[222:223], v105 offset:29696
  s_waitcnt lgkmcnt(0)
  s_waitcnt vmcnt(0)
  s_barrier
  ds_read_b64_tr_b16 v[224:225], v105 offset:32768
  ds_read_b64_tr_b16 v[226:227], v105 offset:33792
  ds_read_b64_tr_b16 v[228:229], v105 offset:36864
  ds_read_b64_tr_b16 v[230:231], v105 offset:37888
  ds_read_b64_tr_b16 v[232:233], v105 offset:40960
  ds_read_b64_tr_b16 v[234:235], v105 offset:41984
  ds_read_b64_tr_b16 v[236:237], v105 offset:45056
  ds_read_b64_tr_b16 v[238:239], v105 offset:46080
  ds_read_b64_tr_b16 v[240:241], v105 offset:49152
  ds_read_b64_tr_b16 v[242:243], v105 offset:50176
  ds_read_b64_tr_b16 v[244:245], v105 offset:53248
  ds_read_b64_tr_b16 v[246:247], v105 offset:54272
  ds_read_b64_tr_b16 v[248:249], v105 offset:57344
  ds_read_b64_tr_b16 v[250:251], v105 offset:58368
  ds_read_b64_tr_b16 v[252:253], v105 offset:61440
  ds_read_b64_tr_b16 v[254:255], v105 offset:62464
  s_waitcnt lgkmcnt(0)
  s_barrier
  v_bfe_u32 v16, v0, 4, 4
  v_lshrrev_b32 v17, 8, v0
  v_lshrrev_b32 v114, 2, v0
  v_bfe_u32 v18, v0, 6, 2
  v_lshrrev_b32 v19, 9, v0
  v_lshl_or_b32 v18, v19, 3, v18
  v_lshlrev_b32 v18, 6, v18
  v_and_b32 v20, 1, v17
  v_lshl_or_b32 v18, v20, 5, v18
  v_and_b32 v20, 3, v16
  v_lshl_or_b32 v1, v20, 3, v18
  v_and_b32 v18, 7, v16
  v_lshrrev_b32 v20, 3, v16
  v_lshl_or_b32 v18, v20, 4, v18
  v_lshlrev_b32 v18, 4, v18
  v_lshl_add_u32 v18, v17, 9, v18
  v_add_u32 v2, 73728, v18
  s_and_b32 s6, s3, 1
  s_lshl_b32 s6, s6, 8
  v_lshlrev_b32 v18, 4, v16
  v_lshl_or_b32 v18, v17, 9, v18
  v_add_u32 v113, s6, v18
  v_add_u32 v3, 65536, v113
  s_lshr_b32 s7, s3, 1
  s_lshl_b32 s6, s7, 12
  s_add_u32 s6, s6, 81920
  v_add_u32 v4, s6, v18
  s_lshl_b32 s6, s3, 11
  s_add_u32 s6, s6, 32768
  v_add_u32 v112, s6, v0
  v_mul_u32_u24 v18, 1088, v17
  v_lshl_add_u32 v18, v16, 3, v18
  s_lshl_b32 s6, s3, 8
  s_add_u32 s6, s6, 57344
  v_add_u32 v5, s6, v18
  s_lshl_b32 s6, s7, 9
  s_add_u32 s6, s6, 57344
  v_add_u32 v7, s6, v18
  v_and_b32 v18, 3, v16
  v_mul_u32_u24 v18, 1088, v18
  v_bfe_u32 v20, v0, 6, 3
  v_lshl_add_u32 v18, v20, 3, v18
  v_lshl_add_u32 v18, v19, 7, v18
  v_add_u32 v6, 57344, v18
  s_lshl_b32 s6, s3, 7
  s_add_u32 s6, s6, 61952
  v_lshlrev_b32 v18, 4, v19
  v_add_u32 v8, s6, v18
  v_and_b32 v18, 0x7c, v114
  v_add_u32 v9, s6, v18
  v_lshlrev_b32 v18, 1, v18
  v_add_u32 v15, 62464, v18
  s_lshl_b32 s6, s3, 13
  v_add_u32 v14, s6, v1
  v_mov_b32 v10, 0x3f803f80
  v_mov_b32 v11, 0x3f803f80
  s_and_b32 s6, s3, 1
  s_lshl_b32 s6, s6, 4
  v_add_u32 v16, s6, v16
  v_lshlrev_b32 v18, 4, v19
  v_and_b32 v20, 1, v17
  v_lshl_or_b32 v18, v20, 2, v18
  v_sub_u32 v16, v16, v18
  v_mov_b32 v17, 0xf149f2ca
  v_cmp_gt_i32 vcc, 0, v16
  s_nop 1
  v_cndmask_b32 v24, 0, v17, vcc
  v_cmp_gt_i32 vcc, 1, v16
  s_nop 1
  v_cndmask_b32 v25, 0, v17, vcc
  v_cmp_gt_i32 vcc, 2, v16
  s_nop 1
  v_cndmask_b32 v26, 0, v17, vcc
  v_cmp_gt_i32 vcc, 3, v16
  s_nop 1
  v_cndmask_b32 v27, 0, v17, vcc
  v_cmp_gt_i32 vcc, 8, v16
  s_nop 1
  v_cndmask_b32 v28, 0, v17, vcc
  v_cmp_gt_i32 vcc, 9, v16
  s_nop 1
  v_cndmask_b32 v29, 0, v17, vcc
  v_cmp_gt_i32 vcc, 10, v16
  s_nop 1
  v_cndmask_b32 v30, 0, v17, vcc
  v_cmp_gt_i32 vcc, 11, v16
  s_nop 1
  v_cndmask_b32 v31, 0, v17, vcc
  v_mov_b32 v80, 0x3f803f80
  v_mov_b32 v81, 0x3f803f80
  v_mov_b32 v82, 0x3f803f80
  v_mov_b32 v83, 0x3f803f80
  s_nop 1
  v_mfma_f32_32x32x16_bf16 v[32:47], v[80:83], a[0:3], 0
  v_mfma_f32_32x32x16_bf16 v[48:63], v[80:83], a[128:131], 0
  v_mfma_f32_32x32x16_bf16 v[64:79], v[80:83], v[128:131], 0
  v_mfma_f32_32x32x16_bf16 v[32:47], v[80:83], a[4:7], v[32:47]
  v_mfma_f32_32x32x16_bf16 v[48:63], v[80:83], a[132:135], v[48:63]
  v_mfma_f32_32x32x16_bf16 v[64:79], v[80:83], v[132:135], v[64:79]
  v_mfma_f32_32x32x16_bf16 v[32:47], v[80:83], a[8:11], v[32:47]
  v_mfma_f32_32x32x16_bf16 v[48:63], v[80:83], a[136:139], v[48:63]
  v_mfma_f32_32x32x16_bf16 v[64:79], v[80:83], v[136:139], v[64:79]
  v_mfma_f32_32x32x16_bf16 v[32:47], v[80:83], a[12:15], v[32:47]
  v_mfma_f32_32x32x16_bf16 v[48:63], v[80:83], a[140:143], v[48:63]
  v_mfma_f32_32x32x16_bf16 v[64:79], v[80:83], v[140:143], v[64:79]
  v_mfma_f32_32x32x16_bf16 v[32:47], v[80:83], a[16:19], v[32:47]
  v_mfma_f32_32x32x16_bf16 v[48:63], v[80:83], a[144:147], v[48:63]
  v_mfma_f32_32x32x16_bf16 v[64:79], v[80:83], v[144:147], v[64:79]
  v_mfma_f32_32x32x16_bf16 v[32:47], v[80:83], a[20:23], v[32:47]
  v_mfma_f32_32x32x16_bf16 v[48:63], v[80:83], a[148:151], v[48:63]
  v_mfma_f32_32x32x16_bf16 v[64:79], v[80:83], v[148:151], v[64:79]
  v_mfma_f32_32x32x16_bf16 v[32:47], v[80:83], a[24:27], v[32:47]
  v_mfma_f32_32x32x16_bf16 v[48:63], v[80:83], a[152:155], v[48:63]
  v_mfma_f32_32x32x16_bf16 v[64:79], v[80:83], v[152:155], v[64:79]
  v_mfma_f32_32x32x16_bf16 v[32:47], v[80:83], a[28:31], v[32:47]
  v_mfma_f32_32x32x16_bf16 v[48:63], v[80:83], a[156:159], v[48:63]
  v_mfma_f32_32x32x16_bf16 v[64:79], v[80:83], v[156:159], v[64:79]
  v_mfma_f32_32x32x16_bf16 v[32:47], v[80:83], a[32:35], v[32:47]
  v_mfma_f32_32x32x16_bf16 v[48:63], v[80:83], a[160:163], v[48:63]
  v_mfma_f32_32x32x16_bf16 v[64:79], v[80:83], v[160:163], v[64:79]
  v_mfma_f32_32x32x16_bf16 v[32:47], v[80:83], a[36:39], v[32:47]
  v_mfma_f32_32x32x16_bf16 v[48:63], v[80:83], a[164:167], v[48:63]
  v_mfma_f32_32x32x16_bf16 v[64:79], v[80:83], v[164:167], v[64:79]
  v_mfma_f32_32x32x16_bf16 v[32:47], v[80:83], a[40:43], v[32:47]
  v_mfma_f32_32x32x16_bf16 v[48:63], v[80:83], a[168:171], v[48:63]
  v_mfma_f32_32x32x16_bf16 v[64:79], v[80:83], v[168:171], v[64:79]
  v_mfma_f32_32x32x16_bf16 v[32:47], v[80:83], a[44:47], v[32:47]
  v_mfma_f32_32x32x16_bf16 v[48:63], v[80:83], a[172:175], v[48:63]
  v_mfma_f32_32x32x16_bf16 v[64:79], v[80:83], v[172:175], v[64:79]
  v_mfma_f32_32x32x16_bf16 v[32:47], v[80:83], a[48:51], v[32:47]
  v_mfma_f32_32x32x16_bf16 v[48:63], v[80:83], a[176:179], v[48:63]
  v_mfma_f32_32x32x16_bf16 v[64:79], v[80:83], v[176:179], v[64:79]
  v_mfma_f32_32x32x16_bf16 v[32:47], v[80:83], a[52:55], v[32:47]
  v_mfma_f32_32x32x16_bf16 v[48:63], v[80:83], a[180:183], v[48:63]
  v_mfma_f32_32x32x16_bf16 v[64:79], v[80:83], v[180:183], v[64:79]
  v_mfma_f32_32x32x16_bf16 v[32:47], v[80:83], a[56:59], v[32:47]
  v_mfma_f32_32x32x16_bf16 v[48:63], v[80:83], a[184:187], v[48:63]
  v_mfma_f32_32x32x16_bf16 v[64:79], v[80:83], v[184:187], v[64:79]
  v_mfma_f32_32x32x16_bf16 v[32:47], v[80:83], a[60:63], v[32:47]
  v_mfma_f32_32x32x16_bf16 v[48:63], v[80:83], a[188:191], v[48:63]
  v_mfma_f32_32x32x16_bf16 v[64:79], v[80:83], v[188:191], v[64:79]
  v_mfma_f32_32x32x16_bf16 v[32:47], v[80:83], a[64:67], v[32:47]
  v_mfma_f32_32x32x16_bf16 v[48:63], v[80:83], a[192:195], v[48:63]
  v_mfma_f32_32x32x16_bf16 v[64:79], v[80:83], v[192:195], v[64:79]
  v_mfma_f32_32x32x16_bf16 v[32:47], v[80:83], a[68:71], v[32:47]
  v_mfma_f32_32x32x16_bf16 v[48:63], v[80:83], a[196:199], v[48:63]
  v_mfma_f32_32x32x16_bf16 v[64:79], v[80:83], v[196:199], v[64:79]
  v_mfma_f32_32x32x16_bf16 v[32:47], v[80:83], a[72:75], v[32:47]
  v_mfma_f32_32x32x16_bf16 v[48:63], v[80:83], a[200:203], v[48:63]
  v_mfma_f32_32x32x16_bf16 v[64:79], v[80:83], v[200:203], v[64:79]
  v_mfma_f32_32x32x16_bf16 v[32:47], v[80:83], a[76:79], v[32:47]
  v_mfma_f32_32x32x16_bf16 v[48:63], v[80:83], a[204:207], v[48:63]
  v_mfma_f32_32x32x16_bf16 v[64:79], v[80:83], v[204:207], v[64:79]
  v_mfma_f32_32x32x16_bf16 v[32:47], v[80:83], a[80:83], v[32:47]
  v_mfma_f32_32x32x16_bf16 v[48:63], v[80:83], a[208:211], v[48:63]
  v_mfma_f32_32x32x16_bf16 v[64:79], v[80:83], v[208:211], v[64:79]
  v_mfma_f32_32x32x16_bf16 v[32:47], v[80:83], a[84:87], v[32:47]
  v_mfma_f32_32x32x16_bf16 v[48:63], v[80:83], a[212:215], v[48:63]
  v_mfma_f32_32x32x16_bf16 v[64:79], v[80:83], v[212:215], v[64:79]
  v_mfma_f32_32x32x16_bf16 v[32:47], v[80:83], a[88:91], v[32:47]
  v_mfma_f32_32x32x16_bf16 v[48:63], v[80:83], a[216:219], v[48:63]
  v_mfma_f32_32x32x16_bf16 v[64:79], v[80:83], v[216:219], v[64:79]
  v_mfma_f32_32x32x16_bf16 v[32:47], v[80:83], a[92:95], v[32:47]
  v_mfma_f32_32x32x16_bf16 v[48:63], v[80:83], a[220:223], v[48:63]
  v_mfma_f32_32x32x16_bf16 v[64:79], v[80:83], v[220:223], v[64:79]
  v_mfma_f32_32x32x16_bf16 v[32:47], v[80:83], a[96:99], v[32:47]
  v_mfma_f32_32x32x16_bf16 v[48:63], v[80:83], a[224:227], v[48:63]
  v_mfma_f32_32x32x16_bf16 v[64:79], v[80:83], v[224:227], v[64:79]
  v_mfma_f32_32x32x16_bf16 v[32:47], v[80:83], a[100:103], v[32:47]
  v_mfma_f32_32x32x16_bf16 v[48:63], v[80:83], a[228:231], v[48:63]
  v_mfma_f32_32x32x16_bf16 v[64:79], v[80:83], v[228:231], v[64:79]
  v_mfma_f32_32x32x16_bf16 v[32:47], v[80:83], a[104:107], v[32:47]
  v_mfma_f32_32x32x16_bf16 v[48:63], v[80:83], a[232:235], v[48:63]
  v_mfma_f32_32x32x16_bf16 v[64:79], v[80:83], v[232:235], v[64:79]
  v_mfma_f32_32x32x16_bf16 v[32:47], v[80:83], a[108:111], v[32:47]
  v_mfma_f32_32x32x16_bf16 v[48:63], v[80:83], a[236:239], v[48:63]
  v_mfma_f32_32x32x16_bf16 v[64:79], v[80:83], v[236:239], v[64:79]
  v_mfma_f32_32x32x16_bf16 v[32:47], v[80:83], a[112:115], v[32:47]
  v_mfma_f32_32x32x16_bf16 v[48:63], v[80:83], a[240:243], v[48:63]
  v_mfma_f32_32x32x16_bf16 v[64:79], v[80:83], v[240:243], v[64:79]
  v_mfma_f32_32x32x16_bf16 v[32:47], v[80:83], a[116:119], v[32:47]
  v_mfma_f32_32x32x16_bf16 v[48:63], v[80:83], a[244:247], v[48:63]
  v_mfma_f32_32x32x16_bf16 v[64:79], v[80:83], v[244:247], v[64:79]
  v_mfma_f32_32x32x16_bf16 v[32:47], v[80:83], a[120:123], v[32:47]
  v_mfma_f32_32x32x16_bf16 v[48:63], v[80:83], a[248:251], v[48:63]
  v_mfma_f32_32x32x16_bf16 v[64:79], v[80:83], v[248:251], v[64:79]
  v_mfma_f32_32x32x16_bf16 v[32:47], v[80:83], a[124:127], v[32:47]
  v_mfma_f32_32x32x16_bf16 v[48:63], v[80:83], a[252:255], v[48:63]
  v_mfma_f32_32x32x16_bf16 v[64:79], v[80:83], v[252:255], v[64:79]
  v_cmp_gt_u32 vcc, 512, v0
  s_nop 8
  v_cvt_pk_bf16_f32 v33, v32, v32
  v_and_b32 v33, 0xffff0000, v33
  v_sub_f32 v32, v32, v33
  v_cvt_pk_bf16_f32 v32, v32, v33
  v_cndmask_b32 v16, 0, v32, vcc
  v_cvt_pk_bf16_f32 v49, v48, v48
  v_and_b32 v49, 0xffff0000, v49
  v_sub_f32 v48, v48, v49
  v_cvt_pk_bf16_f32 v48, v48, v49
  v_cndmask_b32 v17, 0, v48, vcc
  v_cvt_pk_bf16_f32 v65, v64, v64
  v_and_b32 v65, 0xffff0000, v65
  v_sub_f32 v64, v64, v65
  v_cvt_pk_bf16_f32 v64, v64, v65
  v_cndmask_b32 v18, 0, v64, vcc
  v_mov_b32 v19, 0
  v_mov_b32 v21, 0
  v_mov_b32 v22, 0
  s_mov_b32 s7, 0
  v_mbcnt_lo_u32_b32 v92, -1, 0
  v_and_b32 v92, 3, v92
  v_lshlrev_b32 v92, 6, v92
L_wd_88:
  buffer_load_dword v93, v92, s[12:15], 0 offen offset:16 sc1
  s_waitcnt vmcnt(0)
  v_cmp_ne_u32 vcc, 64, v93
  s_cbranch_vccz L_wdo_89
  s_add_u32 s7, s7, 1
  s_cmp_lt_u32 s7, 131072
  s_cbranch_scc1 L_wd_88
  s_mov_b32 s6, 20
  s_branch L_err
L_wdo_89:
  s_mov_b32 s32, 0
  s_mov_b32 s33, s37
  s_add_u32 s49, s33, 1
  s_cmp_lg_u32 s35, 0
  s_cbranch_scc1 L_p1_90
  s_mov_b32 s7, 0
L_pl_91:
  buffer_load_dwordx4 v[92:95], v0, s[8:11], s44 offen offset:0 sc1
  s_waitcnt vmcnt(0)
  v_min_u32 v92, v92, v93
  v_min3_u32 v92, v92, v94, v95
  v_cmp_gt_u32 vcc, s49, v92
  s_cbranch_vccz L_plo_92
  s_add_u32 s7, s7, 1
  s_cmp_lt_u32 s7, 131072
  s_cbranch_scc1 L_pl_91
  s_mov_b32 s6, 21
  s_branch L_err
L_plo_92:
  s_mov_b32 s7, 0
L_pl_93:
  buffer_load_dwordx4 v[92:95], v0, s[8:11], s44 offen offset:1024 sc1
  s_waitcnt vmcnt(0)
  v_min_u32 v92, v92, v93
  v_min3_u32 v92, v92, v94, v95
  v_cmp_gt_u32 vcc, s49, v92
  s_cbranch_vccz L_plo_94
  s_add_u32 s7, s7, 1
  s_cmp_lt_u32 s7, 131072
  s_cbranch_scc1 L_pl_93
  s_mov_b32 s6, 21
  s_branch L_err
L_plo_94:
L_p1_90:
L_p_xwait:
  s_mov_b32 s7, 0
L_pl_95:
  buffer_load_dword v92, v114, s[8:11], s44 offen offset:0 sc1
  s_waitcnt vmcnt(0)
  v_cmp_gt_u32 vcc, s49, v92
  s_cbranch_vccz L_plo_96
  s_add_u32 s7, s7, 1
  s_cmp_lt_u32 s7, 131072
  s_cbranch_scc1 L_pl_95
  s_mov_b32 s6, 22
  s_branch L_err
L_plo_96:
  s_sub_u32 s6, s49, 1
  s_lshl_b32 s6, s6, 15
  s_add_u32 s45, s38, s6
  s_mov_b32 m0, s53
  s_add_u32 s6, s45, 4096
  buffer_load_dwordx4 v0, s[8:11], s45 offen offset:0 lds
  buffer_load_dwordx4 v0, s[8:11], s45 offen offset:1024 lds
  buffer_load_dwordx4 v0, s[8:11], s45 offen offset:2048 lds
  buffer_load_dwordx4 v0, s[8:11], s45 offen offset:3072 lds
  s_add_u32 m0, s53, 4096
  s_nop 0
  buffer_load_dwordx4 v0, s[8:11], s6 offen offset:0 lds
  buffer_load_dwordx4 v0, s[8:11], s6 offen offset:1024 lds
  buffer_load_dwordx4 v0, s[8:11], s6 offen offset:2048 lds
  buffer_load_dwordx4 v0, s[8:11], s6 offen offset:3072 lds
  s_waitcnt vmcnt(0)
L_p_loop:
  s_barrier
  s_and_b32 s6, s33, 3
  s_lshl_b32 s6, s6, 19
  s_add_u32 s46, s39, s6
  s_add_u32 s51, s33, 1
  s_add_u32 s49, s33, 3
  s_lshl_b32 s7, s3, 8
  ds_read_b64_tr_b16 v[80:81], v1 offset:0
  ds_read_b64_tr_b16 v[82:83], v1 offset:256
  ds_read_b64_tr_b16 v[84:85], v1 offset:1024
  ds_read_b64_tr_b16 v[86:87], v1 offset:1280
  ds_read_b64_tr_b16 v[96:97], v14 offset:0
  ds_read_b64_tr_b16 v[98:99], v14 offset:256
  v_mov_b32 v92, 0
  v_mov_b32 v93, 0
  v_add_u32 v108, s7, v15
  s_waitcnt lgkmcnt(4)
  v_mfma_f32_32x32x16_bf16 v[48:63], a[128:131], v[80:83], 0
  ds_read_b64_tr_b16 v[88:89], v1 offset:2048
  ds_read_b64_tr_b16 v[90:91], v1 offset:2304
  s_waitcnt lgkmcnt(2)
  ds_read_b64_tr_b16 v[100:101], v14 offset:1024
  ds_read_b64_tr_b16 v[102:103], v14 offset:1280
  v_lshlrev_b32 v104, 16, v96
  v_mfma_f32_32x32x16_bf16 v[64:79], v[80:83], v[128:131], 0
  v_and_b32 v105, 0xffff0000, v96
  v_add_f32 v92, v92, v104
  v_fmac_f32 v93, v104, v104
  v_add_f32 v92, v92, v105
  v_mfma_f32_32x32x16_bf16 v[32:47], a[0:3], v[80:83], 0
  v_fmac_f32 v93, v105, v105
  v_lshlrev_b32 v106, 16, v97
  v_and_b32 v107, 0xffff0000, v97
  v_mfma_f32_32x32x16_bf16 v[48:63], a[132:135], v[84:87], v[48:63]
  ds_read_b64_tr_b16 v[80:81], v1 offset:3072
  ds_read_b64_tr_b16 v[82:83], v1 offset:3328
  v_add_f32 v92, v92, v106
  v_mfma_f32_32x32x16_bf16 v[64:79], v[84:87], v[132:135], v[64:79]
  v_fmac_f32 v93, v106, v106
  v_add_f32 v92, v92, v107
  v_fmac_f32 v93, v107, v107
  v_lshlrev_b32 v104, 16, v98
  v_mfma_f32_32x32x16_bf16 v[32:47], a[4:7], v[84:87], v[32:47]
  v_and_b32 v105, 0xffff0000, v98
  v_add_f32 v92, v92, v104
  v_fmac_f32 v93, v104, v104
  s_waitcnt lgkmcnt(4)
  v_mfma_f32_32x32x16_bf16 v[48:63], a[136:139], v[88:91], v[48:63]
  ds_read_b64_tr_b16 v[84:85], v1 offset:4096
  ds_read_b64_tr_b16 v[86:87], v1 offset:4352
  v_add_f32 v92, v92, v105
  v_mfma_f32_32x32x16_bf16 v[64:79], v[88:91], v[136:139], v[64:79]
  v_fmac_f32 v93, v105, v105
  v_lshlrev_b32 v106, 16, v99
  v_and_b32 v107, 0xffff0000, v99
  v_add_f32 v92, v92, v106
  v_mfma_f32_32x32x16_bf16 v[32:47], a[8:11], v[88:91], v[32:47]
  v_fmac_f32 v93, v106, v106
  v_add_f32 v92, v92, v107
  v_fmac_f32 v93, v107, v107
  s_waitcnt lgkmcnt(2)
  v_mfma_f32_32x32x16_bf16 v[48:63], a[140:143], v[80:83], v[48:63]
  ds_read_b64_tr_b16 v[88:89], v1 offset:5120
  ds_read_b64_tr_b16 v[90:91], v1 offset:5376
  ds_read_b64_tr_b16 v[96:97], v14 offset:2048
  ds_read_b64_tr_b16 v[98:99], v14 offset:2304
  v_lshlrev_b32 v104, 16, v100
  v_mfma_f32_32x32x16_bf16 v[64:79], v[80:83], v[140:143], v[64:79]
  v_and_b32 v105, 0xffff0000, v100
  v_add_f32 v92, v92, v104
  v_fmac_f32 v93, v104, v104
  v_add_f32 v92, v92, v105
  v_mfma_f32_32x32x16_bf16 v[32:47], a[12:15], v[80:83], v[32:47]
  v_fmac_f32 v93, v105, v105
  v_lshlrev_b32 v106, 16, v101
  v_and_b32 v107, 0xffff0000, v101
  s_waitcnt lgkmcnt(4)
  v_mfma_f32_32x32x16_bf16 v[48:63], a[144:147], v[84:87], v[48:63]
  ds_read_b64_tr_b16 v[80:81], v1 offset:6144
  ds_read_b64_tr_b16 v[82:83], v1 offset:6400
  v_add_f32 v92, v92, v106
  v_mfma_f32_32x32x16_bf16 v[64:79], v[84:87], v[144:147], v[64:79]
  v_fmac_f32 v93, v106, v106
  v_add_f32 v92, v92, v107
  v_fmac_f32 v93, v107, v107
  v_lshlrev_b32 v104, 16, v102
  v_mfma_f32_32x32x16_bf16 v[32:47], a[16:19], v[84:87], v[32:47]
  v_and_b32 v105, 0xffff0000, v102
  v_add_f32 v92, v92, v104
  v_fmac_f32 v93, v104, v104
  s_waitcnt lgkmcnt(4)
  v_mfma_f32_32x32x16_bf16 v[48:63], a[148:151], v[88:91], v[48:63]
  ds_read_b64_tr_b16 v[84:85], v1 offset:7168
  ds_read_b64_tr_b16 v[86:87], v1 offset:7424
  v_add_f32 v92, v92, v105
  v_mfma_f32_32x32x16_bf16 v[64:79], v[88:91], v[148:151], v[64:79]
  v_fmac_f32 v93, v105, v105
  v_lshlrev_b32 v106, 16, v103
  v_and_b32 v107, 0xffff0000, v103
  v_add_f32 v92, v92, v106
  v_mfma_f32_32x32x16_bf16 v[32:47], a[20:23], v[88:91], v[32:47]
  v_fmac_f32 v93, v106, v106
  v_add_f32 v92, v92, v107
  v_fmac_f32 v93, v107, v107
  s_waitcnt lgkmcnt(2)
  v_mfma_f32_32x32x16_bf16 v[48:63], a[152:155], v[80:83], v[48:63]
  ds_read_b64_tr_b16 v[88:89], v1 offset:8192
  ds_read_b64_tr_b16 v[90:91], v1 offset:8448
  ds_read_b64_tr_b16 v[100:101], v14 offset:3072
  ds_read_b64_tr_b16 v[102:103], v14 offset:3328
  v_lshlrev_b32 v104, 16, v96
  v_mfma_f32_32x32x16_bf16 v[64:79], v[80:83], v[152:155], v[64:79]
  v_and_b32 v105, 0xffff0000, v96
  v_add_f32 v92, v92, v104
  v_fmac_f32 v93, v104, v104
  v_add_f32 v92, v92, v105
  v_mfma_f32_32x32x16_bf16 v[32:47], a[24:27], v[80:83], v[32:47]
  v_fmac_f32 v93, v105, v105
  v_lshlrev_b32 v106, 16, v97
  v_and_b32 v107, 0xffff0000, v97
  s_waitcnt lgkmcnt(4)
  v_mfma_f32_32x32x16_bf16 v[48:63], a[156:159], v[84:87], v[48:63]
  ds_read_b64_tr_b16 v[80:81], v1 offset:9216
  ds_read_b64_tr_b16 v[82:83], v1 offset:9472
  v_add_f32 v92, v92, v106
  v_mfma_f32_32x32x16_bf16 v[64:79], v[84:87], v[156:159], v[64:79]
  v_fmac_f32 v93, v106, v106
  v_add_f32 v92, v92, v107
  v_fmac_f32 v93, v107, v107
  v_lshlrev_b32 v104, 16, v98
  v_mfma_f32_32x32x16_bf16 v[32:47], a[28:31], v[84:87], v[32:47]
  v_and_b32 v105, 0xffff0000, v98
  v_add_f32 v92, v92, v104
  v_fmac_f32 v93, v104, v104
  s_waitcnt lgkmcnt(4)
  v_mfma_f32_32x32x16_bf16 v[48:63], a[160:163], v[88:91], v[48:63]
  ds_read_b64_tr_b16 v[84:85], v1 offset:10240
  ds_read_b64_tr_b16 v[86:87], v1 offset:10496
  v_add_f32 v92, v92, v105
  v_mfma_f32_32x32x16_bf16 v[64:79], v[88:91], v[160:163], v[64:79]
  v_fmac_f32 v93, v105, v105
  v_lshlrev_b32 v106, 16, v99
  v_and_b32 v107, 0xffff0000, v99
  v_add_f32 v92, v92, v106
  v_mfma_f32_32x32x16_bf16 v[32:47], a[32:35], v[88:91], v[32:47]
  v_fmac_f32 v93, v106, v106
  v_add_f32 v92, v92, v107
  v_fmac_f32 v93, v107, v107
  s_waitcnt lgkmcnt(2)
  v_mfma_f32_32x32x16_bf16 v[48:63], a[164:167], v[80:83], v[48:63]
  ds_read_b64_tr_b16 v[88:89], v1 offset:11264
  ds_read_b64_tr_b16 v[90:91], v1 offset:11520
  ds_read_b64_tr_b16 v[96:97], v14 offset:4096
  ds_read_b64_tr_b16 v[98:99], v14 offset:4352
  v_lshlrev_b32 v104, 16, v100
  v_mfma_f32_32x32x16_bf16 v[64:79], v[80:83], v[164:167], v[64:79]
  v_and_b32 v105, 0xffff0000, v100
  v_add_f32 v92, v92, v104
  v_fmac_f32 v93, v104, v104
  v_add_f32 v92, v92, v105
  v_mfma_f32_32x32x16_bf16 v[32:47], a[36:39], v[80:83], v[32:47]
  v_fmac_f32 v93, v105, v105
  v_lshlrev_b32 v106, 16, v101
  v_and_b32 v107, 0xffff0000, v101
  s_waitcnt lgkmcnt(4)
  v_mfma_f32_32x32x16_bf16 v[48:63], a[168:171], v[84:87], v[48:63]
  ds_read_b64_tr_b16 v[80:81], v1 offset:12288
  ds_read_b64_tr_b16 v[82:83], v1 offset:12544
  v_add_f32 v92, v92, v106
  v_mfma_f32_32x32x16_bf16 v[64:79], v[84:87], v[168:171], v[64:79]
  v_fmac_f32 v93, v106, v106
  v_add_f32 v92, v92, v107
  v_fmac_f32 v93, v107, v107
  v_lshlrev_b32 v104, 16, v102
  v_mfma_f32_32x32x16_bf16 v[32:47], a[40:43], v[84:87], v[32:47]
  v_and_b32 v105, 0xffff0000, v102
  v_add_f32 v92, v92, v104
  v_fmac_f32 v93, v104, v104
  s_waitcnt lgkmcnt(4)
  v_mfma_f32_32x32x16_bf16 v[48:63], a[172:175], v[88:91], v[48:63]
  ds_read_b64_tr_b16 v[84:85], v1 offset:13312
  ds_read_b64_tr_b16 v[86:87], v1 offset:13568
  v_add_f32 v92, v92, v105
  v_mfma_f32_32x32x16_bf16 v[64:79], v[88:91], v[172:175], v[64:79]
  v_fmac_f32 v93, v105, v105
  v_lshlrev_b32 v106, 16, v103
  v_and_b32 v107, 0xffff0000, v103
  v_add_f32 v92, v92, v106
  v_mfma_f32_32x32x16_bf16 v[32:47], a[44:47], v[88:91], v[32:47]
  v_fmac_f32 v93, v106, v106
  v_add_f32 v92, v92, v107
  v_fmac_f32 v93, v107, v107
  s_waitcnt lgkmcnt(2)
  v_mfma_f32_32x32x16_bf16 v[48:63], a[176:179], v[80:83], v[48:63]
  ds_read_b64_tr_b16 v[88:89], v1 offset:14336
  ds_read_b64_tr_b16 v[90:91], v1 offset:14592
  ds_read_b64_tr_b16 v[100:101], v14 offset:5120
  ds_read_b64_tr_b16 v[102:103], v14 offset:5376
  v_lshlrev_b32 v104, 16, v96
  v_mfma_f32_32x32x16_bf16 v[64:79], v[80:83], v[176:179], v[64:79]
  v_and_b32 v105, 0xffff0000, v96
  v_add_f32 v92, v92, v104
  v_fmac_f32 v93, v104, v104
  v_add_f32 v92, v92, v105
  v_mfma_f32_32x32x16_bf16 v[32:47], a[48:51], v[80:83], v[32:47]
  v_fmac_f32 v93, v105, v105
  v_lshlrev_b32 v106, 16, v97
  v_and_b32 v107, 0xffff0000, v97
  s_waitcnt lgkmcnt(4)
  v_mfma_f32_32x32x16_bf16 v[48:63], a[180:183], v[84:87], v[48:63]
  ds_read_b64_tr_b16 v[80:81], v1 offset:15360
  ds_read_b64_tr_b16 v[82:83], v1 offset:15616
  v_add_f32 v92, v92, v106
  v_mfma_f32_32x32x16_bf16 v[64:79], v[84:87], v[180:183], v[64:79]
  v_fmac_f32 v93, v106, v106
  v_add_f32 v92, v92, v107
  v_fmac_f32 v93, v107, v107
  v_lshlrev_b32 v104, 16, v98
  v_mfma_f32_32x32x16_bf16 v[32:47], a[52:55], v[84:87], v[32:47]
  v_and_b32 v105, 0xffff0000, v98
  v_add_f32 v92, v92, v104
  v_fmac_f32 v93, v104, v104
  s_waitcnt lgkmcnt(4)
  v_mfma_f32_32x32x16_bf16 v[48:63], a[184:187], v[88:91], v[48:63]
  ds_read_b64_tr_b16 v[84:85], v1 offset:16384
  ds_read_b64_tr_b16 v[86:87], v1 offset:16640
  v_add_f32 v92, v92, v105
  v_mfma_f32_32x32x16_bf16 v[64:79], v[88:91], v[184:187], v[64:79]
  v_fmac_f32 v93, v105, v105
  v_lshlrev_b32 v106, 16, v99
  v_and_b32 v107, 0xffff0000, v99
  v_add_f32 v92, v92, v106
  v_mfma_f32_32x32x16_bf16 v[32:47], a[56:59], v[88:91], v[32:47]
  v_fmac_f32 v93, v106, v106
  v_add_f32 v92, v92, v107
  v_fmac_f32 v93, v107, v107
  s_waitcnt lgkmcnt(2)
  v_mfma_f32_32x32x16_bf16 v[48:63], a[188:191], v[80:83], v[48:63]
  ds_read_b64_tr_b16 v[88:89], v1 offset:17408
  ds_read_b64_tr_b16 v[90:91], v1 offset:17664
  ds_read_b64_tr_b16 v[96:97], v14 offset:6144
  ds_read_b64_tr_b16 v[98:99], v14 offset:6400
  v_lshlrev_b32 v104, 16, v100
  v_mfma_f32_32x32x16_bf16 v[64:79], v[80:83], v[188:191], v[64:79]
  v_and_b32 v105, 0xffff0000, v100
  v_add_f32 v92, v92, v104
  v_fmac_f32 v93, v104, v104
  v_add_f32 v92, v92, v105
  v_mfma_f32_32x32x16_bf16 v[32:47], a[60:63], v[80:83], v[32:47]
  v_fmac_f32 v93, v105, v105
  v_lshlrev_b32 v106, 16, v101
  v_and_b32 v107, 0xffff0000, v101
  s_waitcnt lgkmcnt(4)
  v_mfma_f32_32x32x16_bf16 v[48:63], a[192:195], v[84:87], v[48:63]
  ds_read_b64_tr_b16 v[80:81], v1 offset:18432
  ds_read_b64_tr_b16 v[82:83], v1 offset:18688
  v_add_f32 v92, v92, v106
  v_mfma_f32_32x32x16_bf16 v[64:79], v[84:87], v[192:195], v[64:79]
  v_fmac_f32 v93, v106, v106
  v_add_f32 v92, v92, v107
  v_fmac_f32 v93, v107, v107
  v_lshlrev_b32 v104, 16, v102
  v_mfma_f32_32x32x16_bf16 v[32:47], a[64:67], v[84:87], v[32:47]
  v_and_b32 v105, 0xffff0000, v102
  v_add_f32 v92, v92, v104
  v_fmac_f32 v93, v104, v104
  s_waitcnt lgkmcnt(4)
  v_mfma_f32_32x32x16_bf16 v[48:63], a[196:199], v[88:91], v[48:63]
  ds_read_b64_tr_b16 v[84:85], v1 offset:19456
  ds_read_b64_tr_b16 v[86:87], v1 offset:19712
  v_add_f32 v92, v92, v105
  v_mfma_f32_32x32x16_bf16 v[64:79], v[88:91], v[196:199], v[64:79]
  v_fmac_f32 v93, v105, v105
  v_lshlrev_b32 v106, 16, v103
  v_and_b32 v107, 0xffff0000, v103
  v_add_f32 v92, v92, v106
  v_mfma_f32_32x32x16_bf16 v[32:47], a[68:71], v[88:91], v[32:47]
  v_fmac_f32 v93, v106, v106
  v_add_f32 v92, v92, v107
  v_fmac_f32 v93, v107, v107
  s_waitcnt lgkmcnt(2)
  v_mfma_f32_32x32x16_bf16 v[48:63], a[200:203], v[80:83], v[48:63]
  ds_read_b64_tr_b16 v[88:89], v1 offset:20480
  ds_read_b64_tr_b16 v[90:91], v1 offset:20736
  ds_read_b64_tr_b16 v[100:101], v14 offset:7168
  ds_read_b64_tr_b16 v[102:103], v14 offset:7424
  v_lshlrev_b32 v104, 16, v96
  v_mfma_f32_32x32x16_bf16 v[64:79], v[80:83], v[200:203], v[64:79]
  v_and_b32 v105, 0xffff0000, v96
  v_add_f32 v92, v92, v104
  v_fmac_f32 v93, v104, v104
  v_add_f32 v92, v92, v105
  v_mfma_f32_32x32x16_bf16 v[32:47], a[72:75], v[80:83], v[32:47]
  v_fmac_f32 v93, v105, v105
  v_lshlrev_b32 v106, 16, v97
  v_and_b32 v107, 0xffff0000, v97
  s_waitcnt lgkmcnt(4)
  v_mfma_f32_32x32x16_bf16 v[48:63], a[204:207], v[84:87], v[48:63]
  ds_read_b64_tr_b16 v[80:81], v1 offset:21504
  ds_read_b64_tr_b16 v[82:83], v1 offset:21760
  v_add_f32 v92, v92, v106
  v_mfma_f32_32x32x16_bf16 v[64:79], v[84:87], v[204:207], v[64:79]
  v_fmac_f32 v93, v106, v106
  v_add_f32 v92, v92, v107
  v_fmac_f32 v93, v107, v107
  v_lshlrev_b32 v104, 16, v98
  v_mfma_f32_32x32x16_bf16 v[32:47], a[76:79], v[84:87], v[32:47]
  v_and_b32 v105, 0xffff0000, v98
  v_add_f32 v92, v92, v104
  v_fmac_f32 v93, v104, v104
  s_waitcnt lgkmcnt(4)
  v_mfma_f32_32x32x16_bf16 v[48:63], a[208:211], v[88:91], v[48:63]
  ds_read_b64_tr_b16 v[84:85], v1 offset:22528
  ds_read_b64_tr_b16 v[86:87], v1 offset:22784
  v_add_f32 v92, v92, v105
  v_mfma_f32_32x32x16_bf16 v[64:79], v[88:91], v[208:211], v[64:79]
  v_fmac_f32 v93, v105, v105
  v_lshlrev_b32 v106, 16, v99
  v_and_b32 v107, 0xffff0000, v99
  v_add_f32 v92, v92, v106
  v_mfma_f32_32x32x16_bf16 v[32:47], a[80:83], v[88:91], v[32:47]
  v_fmac_f32 v93, v106, v106
  v_add_f32 v92, v92, v107
  v_fmac_f32 v93, v107, v107
  s_waitcnt lgkmcnt(2)
  v_mfma_f32_32x32x16_bf16 v[48:63], a[212:215], v[80:83], v[48:63]
  ds_read_b64_tr_b16 v[88:89], v1 offset:23552
  ds_read_b64_tr_b16 v[90:91], v1 offset:23808
  v_mfma_f32_32x32x16_bf16 v[64:79], v[80:83], v[212:215], v[64:79]
  v_lshlrev_b32 v104, 16, v100
  v_and_b32 v105, 0xffff0000, v100
  v_add_f32 v92, v92, v104
  v_fmac_f32 v93, v104, v104
  v_mfma_f32_32x32x16_bf16 v[32:47], a[84:87], v[80:83], v[32:47]
  v_add_f32 v92, v92, v105
  v_fmac_f32 v93, v105, v105
  v_lshlrev_b32 v106, 16, v101
  v_and_b32 v107, 0xffff0000, v101
  s_waitcnt lgkmcnt(2)
  v_mfma_f32_32x32x16_bf16 v[48:63], a[216:219], v[84:87], v[48:63]
  ds_read_b64_tr_b16 v[80:81], v1 offset:24576
  ds_read_b64_tr_b16 v[82:83], v1 offset:24832
  v_add_f32 v92, v92, v106
  v_mfma_f32_32x32x16_bf16 v[64:79], v[84:87], v[216:219], v[64:79]
  v_fmac_f32 v93, v106, v106
  v_add_f32 v92, v92, v107
  v_fmac_f32 v93, v107, v107
  v_lshlrev_b32 v104, 16, v102
  v_mfma_f32_32x32x16_bf16 v[32:47], a[88:91], v[84:87], v[32:47]
  v_and_b32 v105, 0xffff0000, v102
  v_add_f32 v92, v92, v104
  v_fmac_f32 v93, v104, v104
  s_waitcnt lgkmcnt(2)
  v_mfma_f32_32x32x16_bf16 v[48:63], a[220:223], v[88:91], v[48:63]
  ds_read_b64_tr_b16 v[84:85], v1 offset:25600
  ds_read_b64_tr_b16 v[86:87], v1 offset:25856
  v_add_f32 v92, v92, v105
  v_mfma_f32_32x32x16_bf16 v[64:79], v[88:91], v[220:223], v[64:79]
  v_fmac_f32 v93, v105, v105
  v_lshlrev_b32 v106, 16, v103
  v_and_b32 v107, 0xffff0000, v103
  v_add_f32 v92, v92, v106
  v_mfma_f32_32x32x16_bf16 v[32:47], a[92:95], v[88:91], v[32:47]
  v_fmac_f32 v93, v106, v106
  v_add_f32 v92, v92, v107
  v_fmac_f32 v93, v107, v107
  s_waitcnt lgkmcnt(2)
  v_mfma_f32_32x32x16_bf16 v[48:63], a[224:227], v[80:83], v[48:63]
  ds_read_b64_tr_b16 v[88:89], v1 offset:26624
  ds_read_b64_tr_b16 v[90:91], v1 offset:26880
  v_mov_b32 v94, v92
  v_mfma_f32_32x32x16_bf16 v[64:79], v[80:83], v[224:227], v[64:79]
  v_mov_b32 v95, v93
  v_permlane32_swap_b32 v92, v94
  s_nop 0
  v_permlane32_swap_b32 v93, v95
  v_add_f32 v92, v92, v94
  v_mfma_f32_32x32x16_bf16 v[32:47], a[96:99], v[80:83], v[32:47]
  v_add_f32 v93, v93, v95
  ds_write_b64 v108, v[92:93]
  s_waitcnt lgkmcnt(3)
  v_mfma_f32_32x32x16_bf16 v[48:63], a[228:231], v[84:87], v[48:63]
  ds_read_b64_tr_b16 v[80:81], v1 offset:27648
  ds_read_b64_tr_b16 v[82:83], v1 offset:27904
  v_mfma_f32_32x32x16_bf16 v[64:79], v[84:87], v[228:231], v[64:79]
  s_waitcnt lgkmcnt(2)
  s_barrier
  ds_read_b64 v[96:97], v15 offset:0
  ds_read_b64 v[98:99], v15 offset:256
  v_mfma_f32_32x32x16_bf16 v[32:47], a[100:103], v[84:87], v[32:47]
  ds_read_b64 v[100:101], v15 offset:512
  ds_read_b64 v[102:103], v15 offset:768
  v_mfma_f32_32x32x16_bf16 v[48:63], a[232:235], v[88:91], v[48:63]
  ds_read_b64_tr_b16 v[84:85], v1 offset:28672
  ds_read_b64_tr_b16 v[86:87], v1 offset:28928
  v_mfma_f32_32x32x16_bf16 v[64:79], v[88:91], v[232:235], v[64:79]
  v_mfma_f32_32x32x16_bf16 v[32:47], a[104:107], v[88:91], v[32:47]
  s_waitcnt lgkmcnt(6)
  v_mfma_f32_32x32x16_bf16 v[48:63], a[236:239], v[80:83], v[48:63]
  ds_read_b64_tr_b16 v[88:89], v1 offset:29696
  ds_read_b64_tr_b16 v[90:91], v1 offset:29952
  s_waitcnt lgkmcnt(4)
  v_mfma_f32_32x32x16_bf16 v[64:79], v[80:83], v[236:239], v[64:79]
  v_add_f32 v92, v96, v98
  v_add_f32 v93, v97, v99
  v_add_f32 v94, v100, v102
  v_add_f32 v95, v101, v103
  v_mfma_f32_32x32x16_bf16 v[32:47], a[108:111], v[80:83], v[32:47]
  v_add_f32 v92, v92, v94
  v_add_f32 v93, v93, v95
  v_mul_f32 v92, 0x3b000000, v92
  s_waitcnt lgkmcnt(2)
  v_mfma_f32_32x32x16_bf16 v[48:63], a[240:243], v[84:87], v[48:63]
  ds_read_b64_tr_b16 v[80:81], v1 offset:30720
  ds_read_b64_tr_b16 v[82:83], v1 offset:30976
  v_mul_f32 v94, v92, v92
  v_mfma_f32_32x32x16_bf16 v[64:79], v[84:87], v[240:243], v[64:79]
  v_mul_f32 v93, 0x3b000000, v93
  v_sub_f32 v93, v93, v94
  v_max_f32 v93, 0, v93
  v_cvt_pk_bf16_f32 v93, v93, v93
  v_mfma_f32_32x32x16_bf16 v[32:47], a[112:115], v[84:87], v[32:47]
  v_and_b32 v93, 0xffff0000, v93
  v_add_f32 v93, 0x3727c5ac, v93
  v_cvt_pk_bf16_f32 v93, v93, v93
  s_waitcnt lgkmcnt(2)
  v_mfma_f32_32x32x16_bf16 v[48:63], a[244:247], v[88:91], v[48:63]
  ds_read_b64_tr_b16 v[84:85], v1 offset:31744
  ds_read_b64_tr_b16 v[86:87], v1 offset:32000
  v_and_b32 v93, 0xffff0000, v93
  v_mfma_f32_32x32x16_bf16 v[64:79], v[88:91], v[244:247], v[64:79]
  v_sqrt_f32 v93, v93
  v_cvt_pk_bf16_f32 v92, v92, v92
  v_and_b32 v92, 0xffff0000, v92
  v_cvt_pk_bf16_f32 v93, v93, v93
  v_mfma_f32_32x32x16_bf16 v[32:47], a[116:119], v[88:91], v[32:47]
  v_and_b32 v93, 0xffff0000, v93
  v_rcp_f32 v93, v93
  v_xor_b32 v92, 0x80000000, v92
  s_waitcnt lgkmcnt(2)
  v_mfma_f32_32x32x16_bf16 v[48:63], a[248:251], v[80:83], v[48:63]
  v_lshrrev_b32 v94, 16, v92
  v_mfma_f32_32x32x16_bf16 v[64:79], v[80:83], v[248:251], v[64:79]
  v_or_b32 v20, v92, v94
  v_or_b32 v23, v92, v94
  v_mov_b32 v92, v93
  ds_write_b32 v9, v93
  v_mfma_f32_32x32x16_bf16 v[32:47], a[120:123], v[80:83], v[32:47]
  s_waitcnt lgkmcnt(1)
  v_mfma_f32_32x32x16_bf16 v[48:63], a[252:255], v[84:87], v[48:63]
  ds_read_b128 v[96:99], v8 offset:0
  v_mfma_f32_32x32x16_bf16 v[64:79], v[84:87], v[252:255], v[64:79]
  ds_read_b128 v[100:103], v8 offset:32
  ds_read_b128 v[104:107], v8 offset:64
  ds_read_b128 v[108:111], v8 offset:96
  v_mfma_f32_32x32x16_bf16 v[32:47], a[124:127], v[84:87], v[32:47]
  v_mfma_f32_32x32x8_bf16 v[48:63], v[16:17], v[22:23], v[48:63]
  v_mfma_f32_32x32x8_bf16 v[64:79], v[20:21], v[18:19], v[64:79]
  v_mfma_f32_32x32x8_bf16 v[32:47], v[16:17], v[20:21], v[32:47]
  s_add_u32 s7, s46, 0x2000
  s_nop 8
  v_pk_mul_f32 v[48:49], v[48:49], v[92:93]
  v_pk_mul_f32 v[50:51], v[50:51], v[92:93]
  v_pk_mul_f32 v[52:53], v[52:53], v[92:93]
  v_pk_mul_f32 v[54:55], v[54:55], v[92:93]
  v_pk_mul_f32 v[56:57], v[56:57], v[92:93]
  v_pk_mul_f32 v[58:59], v[58:59], v[92:93]
  v_pk_mul_f32 v[60:61], v[60:61], v[92:93]
  v_pk_mul_f32 v[62:63], v[62:63], v[92:93]
  v_cvt_pk_bf16_f32 v48, v48, v49
  v_cvt_pk_bf16_f32 v49, v50, v51
  v_cvt_pk_bf16_f32 v50, v52, v53
  v_cvt_pk_bf16_f32 v51, v54, v55
  v_cvt_pk_bf16_f32 v52, v56, v57
  v_cvt_pk_bf16_f32 v53, v58, v59
  v_cvt_pk_bf16_f32 v54, v60, v61
  v_cvt_pk_bf16_f32 v55, v62, v63
  buffer_store_dwordx4 v[48:51], v0, s[8:11], s46 offen offset:0 sc1
  ds_write_b128 v112, v[48:51] offset:8192
  buffer_store_dwordx4 v[52:55], v0, s[8:11], s46 offen offset:1024 sc1
  ds_write_b128 v112, v[52:55] offset:9216
  s_waitcnt lgkmcnt(2)
  v_pk_mul_f32 v[64:65], v[64:65], v[96:97]
  v_pk_mul_f32 v[66:67], v[66:67], v[98:99]
  v_pk_mul_f32 v[68:69], v[68:69], v[100:101]
  v_pk_mul_f32 v[70:71], v[70:71], v[102:103]
  v_pk_mul_f32 v[72:73], v[72:73], v[104:105]
  v_pk_mul_f32 v[74:75], v[74:75], v[106:107]
  v_pk_mul_f32 v[76:77], v[76:77], v[108:109]
  v_pk_mul_f32 v[78:79], v[78:79], v[110:111]
  v_cvt_pk_bf16_f32 v64, v64, v65
  v_cvt_pk_bf16_f32 v65, v66, v67
  v_cvt_pk_bf16_f32 v66, v68, v69
  v_cvt_pk_bf16_f32 v67, v70, v71
  v_cvt_pk_bf16_f32 v68, v72, v73
  v_cvt_pk_bf16_f32 v69, v74, v75
  v_cvt_pk_bf16_f32 v70, v76, v77
  v_cvt_pk_bf16_f32 v71, v78, v79
  buffer_store_dwordx4 v[64:67], v0, s[8:11], s7 offen offset:0 sc1
  ds_write_b128 v112, v[64:67] offset:16384
  buffer_store_dwordx4 v[68:71], v0, s[8:11], s7 offen offset:1024 sc1
  ds_write_b128 v112, v[68:71] offset:17408
  buffer_load_dword v115, v114, s[8:11], s44 offen sc1
  v_pk_mul_f32 v[32:33], v[32:33], v[92:93]
  v_pk_mul_f32 v[34:35], v[34:35], v[92:93]
  v_pk_mul_f32 v[36:37], v[36:37], v[92:93]
  v_pk_mul_f32 v[38:39], v[38:39], v[92:93]
  v_pk_mul_f32 v[40:41], v[40:41], v[92:93]
  v_pk_mul_f32 v[42:43], v[42:43], v[92:93]
  v_pk_mul_f32 v[44:45], v[44:45], v[92:93]
  v_pk_mul_f32 v[46:47], v[46:47], v[92:93]
  v_cvt_pk_bf16_f32 v32, v32, v33
  v_cvt_pk_bf16_f32 v33, v34, v35
  v_cvt_pk_bf16_f32 v34, v36, v37
  v_cvt_pk_bf16_f32 v35, v38, v39
  v_cvt_pk_bf16_f32 v36, v40, v41
  v_cvt_pk_bf16_f32 v37, v42, v43
  v_cvt_pk_bf16_f32 v38, v44, v45
  v_cvt_pk_bf16_f32 v39, v46, v47
  ds_write_b128 v112, v[32:35] offset:0
  ds_write_b128 v112, v[36:39] offset:1024
  v_mov_b32 v127, s51
  s_cmp_eq_u32 s32, 0
  s_cbranch_scc1 L_p_first
L_p_att:
  s_sub_u32 s51, s33, 2
  s_and_b32 s6, s51, 3
  s_lshl_b32 s6, s6, 17
  s_add_u32 s47, s40, s6
  s_lshr_b32 s6, s51, 2
  s_andn2_b32 s50, 1, s6
  s_lshl_b32 s6, s51, 18
  s_add_u32 s48, s41, s6
  s_add_u32 s51, s51, 1
  buffer_load_dwordx4 v[116:119], v0, s[8:11], s47 offen sc1
  ds_read_b128 v[64:67], v3 offset:0
  ds_read_b128 v[32:35], v2 offset:0
  ds_read_b128 v[48:51], v2 offset:128
  ds_read_b128 v[68:71], v3 offset:2048
  ds_read_b128 v[36:39], v2 offset:2048
  ds_read_b128 v[52:55], v2 offset:2176
  ds_read_b128 v[72:75], v3 offset:4096
  ds_read_b128 v[40:43], v2 offset:4096
  ds_read_b128 v[56:59], v2 offset:4224
  ds_read_b128 v[76:79], v3 offset:6144
  ds_read_b128 v[44:47], v2 offset:6144
  ds_read_b128 v[60:63], v2 offset:6272
  s_waitcnt lgkmcnt(9)
  v_mfma_f32_16x16x32_bf16 v[96:99], v[32:35], v[64:67], v[24:27]
  v_mfma_f32_16x16x32_bf16 v[100:103], v[48:51], v[64:67], v[28:31]
  s_waitcnt lgkmcnt(6)
  v_mfma_f32_16x16x32_bf16 v[96:99], v[36:39], v[68:71], v[96:99]
  v_mfma_f32_16x16x32_bf16 v[100:103], v[52:55], v[68:71], v[100:103]
  s_waitcnt lgkmcnt(3)
  v_mfma_f32_16x16x32_bf16 v[96:99], v[40:43], v[72:75], v[96:99]
  v_mfma_f32_16x16x32_bf16 v[100:103], v[56:59], v[72:75], v[100:103]
  s_waitcnt lgkmcnt(0)
  v_mfma_f32_16x16x32_bf16 v[96:99], v[44:47], v[76:79], v[96:99]
  v_mfma_f32_16x16x32_bf16 v[100:103], v[60:63], v[76:79], v[100:103]
  ds_read_b128 v[80:83], v4 offset:0
  ds_read_b128 v[84:87], v4 offset:256
  ds_read_b128 v[88:91], v4 offset:2048
  ds_read_b128 v[92:95], v4 offset:2304
  s_waitcnt vmcnt(2)
  s_mov_b64 exec, 1
  buffer_store_dword v127, v13, s[8:11], s42 offen sc1
  s_mov_b64 exec, -1
  s_mov_b32 s7, 0
  s_waitcnt vmcnt(1)
  s_branch L_p_km1
L_p_km:
  s_waitcnt vmcnt(0)
L_p_km1:
  v_bitop3_b32 v126, v116, s50, 1 bitop3:0x28
  v_cmp_ne_u32 vcc, 0, v126
  s_cbranch_vccz L_p_kmok
  buffer_load_dwordx4 v[116:119], v0, s[8:11], s47 offen sc1
  s_add_u32 s7, s7, 1
  s_cmp_lt_u32 s7, 131072
  s_cbranch_scc1 L_p_km
  s_mov_b32 s6, 23
  s_branch L_err
L_p_kmok:
  ds_write_b64 v5, v[116:117]
  ds_write_b64 v5, v[118:119] offset:128
  v_max3_f32 v124, v96, v97, v98
  v_max3_f32 v125, v100, v101, v102
  v_max3_f32 v124, v124, v99, v103
  s_waitcnt lgkmcnt(0)
  s_barrier
  ds_read_b64_tr_b16 v[32:33], v6 offset:0
  ds_read_b64_tr_b16 v[34:35], v6 offset:64
  ds_read_b64_tr_b16 v[36:37], v6 offset:256
  ds_read_b64_tr_b16 v[38:39], v6 offset:320
  ds_read_b64_tr_b16 v[40:41], v6 offset:512
  ds_read_b64_tr_b16 v[42:43], v6 offset:576
  ds_read_b64_tr_b16 v[44:45], v6 offset:768
  ds_read_b64_tr_b16 v[46:47], v6 offset:832
  ds_read_b64 v[48:49], v7 offset:0
  ds_read_b64 v[50:51], v7 offset:128
  ds_read_b64 v[52:53], v7 offset:256
  ds_read_b64 v[54:55], v7 offset:384
  s_mov_b32 s52, 0
  s_cmp_ge_u32 s32, 31
  s_cbranch_scc1 L_nx_97
  v_cmp_gt_u32 vcc, s49, v115
  s_cbranch_vccnz L_nx_97
  s_mov_b32 s52, 1
  s_sub_u32 s6, s49, 1
  s_lshl_b32 s6, s6, 15
  s_add_u32 s45, s38, s6
  s_mov_b32 m0, s53
  s_add_u32 s6, s45, 4096
  buffer_load_dwordx4 v0, s[8:11], s45 offen offset:0 lds
  buffer_load_dwordx4 v0, s[8:11], s45 offen offset:1024 lds
  buffer_load_dwordx4 v0, s[8:11], s45 offen offset:2048 lds
  buffer_load_dwordx4 v0, s[8:11], s45 offen offset:3072 lds
  s_add_u32 m0, s53, 4096
  s_nop 0
  buffer_load_dwordx4 v0, s[8:11], s6 offen offset:0 lds
  buffer_load_dwordx4 v0, s[8:11], s6 offen offset:1024 lds
  buffer_load_dwordx4 v0, s[8:11], s6 offen offset:2048 lds
  buffer_load_dwordx4 v0, s[8:11], s6 offen offset:3072 lds
L_nx_97:
  s_waitcnt lgkmcnt(10)
  v_mfma_f32_16x16x32_bf16 v[104:107], v[32:35], v[64:67], 0
  s_waitcnt lgkmcnt(8)
  v_mfma_f32_16x16x32_bf16 v[104:107], v[36:39], v[68:71], v[104:107]
  s_waitcnt lgkmcnt(6)
  v_mfma_f32_16x16x32_bf16 v[104:107], v[40:43], v[72:75], v[104:107]
  s_waitcnt lgkmcnt(4)
  v_mfma_f32_16x16x32_bf16 v[104:107], v[44:47], v[76:79], v[104:107]
  v_max_f32 v124, v124, v125
  s_nop 6
  v_max3_f32 v124, v124, v106, v107
  v_mov_b32 v125, v124
  s_nop 1
  v_permlane32_swap_b32 v124, v125
  v_max_f32 v124, v124, v125
  v_max_f32 v125, v124, v125
  s_nop 1
  v_permlane16_swap_b32 v124, v125
  v_max_f32 v124, v124, v125
  v_mul_f32 v124, s34, v124
  v_fma_f32 v106, v106, s34, -v124
  v_fma_f32 v107, v107, s34, -v124
  v_fma_f32 v96, v96, s34, -v124
  v_fma_f32 v97, v97, s34, -v124
  v_fma_f32 v98, v98, s34, -v124
  v_fma_f32 v99, v99, s34, -v124
  v_fma_f32 v100, v100, s34, -v124
  v_fma_f32 v101, v101, s34, -v124
  v_fma_f32 v102, v102, s34, -v124
  v_fma_f32 v103, v103, s34, -v124
  v_exp_f32 v106, v106
  v_exp_f32 v107, v107
  v_exp_f32 v96, v96
  v_cvt_pk_bf16_f32 v12, v106, v107
  v_exp_f32 v97, v97
  s_waitcnt lgkmcnt(0)
  v_mfma_f32_16x16x16_bf16 v[108:111], v[10:11], v[12:13], 0
  v_mfma_f32_16x16x16_bf16 v[56:59], v[48:49], v[12:13], 0
  v_exp_f32 v98, v98
  v_exp_f32 v99, v99
  v_mfma_f32_16x16x16_bf16 v[60:63], v[50:51], v[12:13], 0
  v_exp_f32 v100, v100
  v_exp_f32 v101, v101
  v_mfma_f32_16x16x16_bf16 v[64:67], v[52:53], v[12:13], 0
  v_exp_f32 v102, v102
  v_exp_f32 v103, v103
  v_mfma_f32_16x16x16_bf16 v[68:71], v[54:55], v[12:13], 0
  v_cvt_pk_bf16_f32 v120, v96, v97
  v_cvt_pk_bf16_f32 v121, v98, v99
  v_cvt_pk_bf16_f32 v122, v100, v101
  v_cvt_pk_bf16_f32 v123, v102, v103
  v_mfma_f32_16x16x16_bf16 v[108:111], v[10:11], v[120:121], v[108:111]
  s_nop 0
  v_mfma_f32_16x16x16_bf16 v[108:111], v[10:11], v[122:123], v[108:111]
  v_mfma_f32_16x16x32_bf16 v[56:59], v[80:83], v[120:123], v[56:59]
  v_mfma_f32_16x16x32_bf16 v[60:63], v[84:87], v[120:123], v[60:63]
  v_mfma_f32_16x16x32_bf16 v[64:67], v[88:91], v[120:123], v[64:67]
  v_mfma_f32_16x16x32_bf16 v[68:71], v[92:95], v[120:123], v[68:71]
  s_nop 3
  v_rcp_f32 v108, v108
  v_mov_b32 v126, s51
  v_pk_mul_f32 v[56:57], v[56:57], v[108:109] op_sel_hi:[1,0]
  v_pk_mul_f32 v[58:59], v[58:59], v[108:109] op_sel_hi:[1,0]
  v_pk_mul_f32 v[60:61], v[60:61], v[108:109] op_sel_hi:[1,0]
  v_pk_mul_f32 v[62:63], v[62:63], v[108:109] op_sel_hi:[1,0]
  v_cvt_pk_bf16_f32 v56, v56, v57
  v_cvt_pk_bf16_f32 v57, v58, v59
  v_cvt_pk_bf16_f32 v58, v60, v61
  v_cvt_pk_bf16_f32 v59, v62, v63
  buffer_store_dwordx4 v[56:59], v113, s[8:11], s48 offen offset:0 sc1
  v_pk_mul_f32 v[64:65], v[64:65], v[108:109] op_sel_hi:[1,0]
  v_pk_mul_f32 v[66:67], v[66:67], v[108:109] op_sel_hi:[1,0]
  v_pk_mul_f32 v[68:69], v[68:69], v[108:109] op_sel_hi:[1,0]
  v_pk_mul_f32 v[70:71], v[70:71], v[108:109] op_sel_hi:[1,0]
  v_cvt_pk_bf16_f32 v64, v64, v65
  v_cvt_pk_bf16_f32 v65, v66, v67
  v_cvt_pk_bf16_f32 v66, v68, v69
  v_cvt_pk_bf16_f32 v67, v70, v71
  buffer_store_dwordx4 v[64:67], v113, s[8:11], s48 offen offset:2048 sc1
  s_waitcnt vmcnt(0)
  s_mov_b64 exec, 1
  buffer_store_dword v126, v13, s[8:11], s43 offen sc1
  s_mov_b64 exec, -1
L_p_next:
  v_xor_b32 v2, 0x18000, v2
  v_xor_b32 v3, 0x18000, v3
  v_xor_b32 v4, 0x18000, v4
  v_xor_b32 v112, 0x18000, v112
  s_add_u32 s32, s32, 1
  s_add_u32 s33, s33, 2
  s_cmp_gt_u32 s32, 32
  s_cbranch_scc1 L_p_end
  s_cmp_eq_u32 s32, 32
  s_cbranch_scc1 L_p_tail
  s_cmp_eq_u32 s52, 0
  s_cbranch_scc1 L_p_xwait
  s_branch L_p_loop
L_p_tail:
  s_waitcnt lgkmcnt(0)
  s_barrier
  s_branch L_p_att
L_p_first:
  s_waitcnt vmcnt(1)
  s_mov_b64 exec, 1
  buffer_store_dword v127, v13, s[8:11], s42 offen sc1
  s_mov_b64 exec, -1
  s_waitcnt vmcnt(1) lgkmcnt(0)
  s_barrier
  s_mov_b32 s52, 0
  s_cmp_ge_u32 s32, 31
  s_cbranch_scc1 L_nx_98
  v_cmp_gt_u32 vcc, s49, v115
  s_cbranch_vccnz L_nx_98
  s_mov_b32 s52, 1
  s_sub_u32 s6, s49, 1
  s_lshl_b32 s6, s6, 15
  s_add_u32 s45, s38, s6
  s_mov_b32 m0, s53
  s_add_u32 s6, s45, 4096
  buffer_load_dwordx4 v0, s[8:11], s45 offen offset:0 lds
  buffer_load_dwordx4 v0, s[8:11], s45 offen offset:1024 lds
  buffer_load_dwordx4 v0, s[8:11], s45 offen offset:2048 lds
  buffer_load_dwordx4 v0, s[8:11], s45 offen offset:3072 lds
  s_add_u32 m0, s53, 4096
  s_nop 0
  buffer_load_dwordx4 v0, s[8:11], s6 offen offset:0 lds
  buffer_load_dwordx4 v0, s[8:11], s6 offen offset:1024 lds
  buffer_load_dwordx4 v0, s[8:11], s6 offen offset:2048 lds
  buffer_load_dwordx4 v0, s[8:11], s6 offen offset:3072 lds
L_nx_98:
  s_waitcnt vmcnt(0)
  s_branch L_p_next
L_p_end:
  s_waitcnt vmcnt(0)
  s_endpgm
L_o:
  s_lshr_b32 s33, s5, 4
  s_bfe_u32 s34, s5, 0x20002
  s_and_b32 s35, s5, 3
  s_mul_i32 s36, s33, 0x1000000
  s_add_u32 s36, s36, 0x6800000
  s_lshl_b32 s6, s34, 3
  s_lshl_b32 s7, s3, 1
  s_add_u32 s6, s6, s7
  s_lshl_b32 s7, s6, 13
  s_add_u32 s36, s36, s7
  s_lshl_b32 s6, s6, 7
  s_lshl_b32 s7, s33, 13
  s_add_u32 s6, s6, s7
  s_add_u32 s38, s6, 0x718000
  s_mul_i32 s37, s33, 0x800000
  s_add_u32 s37, s37, 0x8800000
  s_lshl_b32 s6, s34, 15
  s_add_u32 s37, s37, s6
  s_lshl_b32 s6, s35, 13
  s_add_u32 s37, s37, s6
  s_lshl_b32 s6, s3, 11
  s_add_u32 s37, s37, s6
  s_lshl_b32 s6, s5, 7
  s_lshl_b32 s7, s3, 2
  s_add_u32 s6, s6, s7
  s_add_u32 s39, s6, 0x711000
  s_lshl_b32 s42, s3, 14
  v_mov_b32 v3, 0
  s_mov_b64 exec, 1
  buffer_store_dword v3, v3, s[8:11], s39 offen sc1
  s_mov_b64 exec, -1
  s_branch L_pro
L_o2:
  v_lshlrev_b32 v0, 4, v0
  s_mov_b32 s16, s88
  s_mov_b32 s17, s89
  s_mov_b32 s18, 0x400000
  s_mov_b32 s19, 0x20000
  v_lshrrev_b32 v104, 4, v0
  v_lshrrev_b32 v100, 8, v0
  v_lshlrev_b32 v105, 2, v100
  v_and_b32 v104, 15, v104
  v_xor_b32 v104, v104, v105
  v_mul_u32_u24 v100, 1024, v100
  v_lshl_add_u32 v100, v104, 4, v100
  v_bfe_u32 v104, v0, 6, 2
  v_lshlrev_b32 v105, 2, v104
  v_bfe_u32 v106, v0, 8, 1
  v_lshlrev_b32 v106, 1, v106
  v_bfe_u32 v107, v0, 5, 1
  v_or_b32 v106, v106, v107
  s_lshl_b32 s6, s3, 2
  v_or_b32 v106, s6, v106
  v_xor_b32 v106, v106, v105
  v_lshlrev_b32 v106, 4, v106
  v_bfe_u32 v107, v0, 4, 1
  v_lshl_or_b32 v106, v107, 3, v106
  v_bfe_u32 v107, v0, 9, 1
  v_lshl_or_b32 v104, v107, 2, v104
  v_lshl_or_b32 v104, v104, 8, v106
  v_add_u32 v105, 0x10000, v104
  s_lshl_b32 s60, s3, 13
  s_mul_i32 s63, s3, 32768
  s_lshl_b32 s61, s34, 20
  s_lshl_b32 s62, s35, 8
  s_add_u32 s61, s61, s62
  s_add_u32 s61, s61, 0
  s_add_u32 s61, s61, s63
  s_add_u32 m0, s60, 0
  s_add_u32 s62, s61, 0
  buffer_load_dwordx4 v100, s[16:19], s62 offen lds
  s_add_u32 m0, s60, 1024
  s_add_u32 s62, s61, 4096
  buffer_load_dwordx4 v100, s[16:19], s62 offen lds
  s_add_u32 m0, s60, 2048
  s_add_u32 s62, s61, 8192
  buffer_load_dwordx4 v100, s[16:19], s62 offen lds
  s_add_u32 m0, s60, 3072
  s_add_u32 s62, s61, 12288
  buffer_load_dwordx4 v100, s[16:19], s62 offen lds
  s_add_u32 m0, s60, 4096
  s_add_u32 s62, s61, 16384
  buffer_load_dwordx4 v100, s[16:19], s62 offen lds
  s_add_u32 m0, s60, 5120
  s_add_u32 s62, s61, 20480
  buffer_load_dwordx4 v100, s[16:19], s62 offen lds
  s_add_u32 m0, s60, 6144
  s_add_u32 s62, s61, 24576
  buffer_load_dwordx4 v100, s[16:19], s62 offen lds
  s_add_u32 m0, s60, 7168
  s_add_u32 s62, s61, 28672
  buffer_load_dwordx4 v100, s[16:19], s62 offen lds
  s_lshl_b32 s61, s34, 20
  s_lshl_b32 s62, s35, 8
  s_add_u32 s61, s61, s62
  s_add_u32 s61, s61, 131072
  s_add_u32 s61, s61, s63
  s_add_u32 m0, s60, 32768
  s_add_u32 s62, s61, 0
  buffer_load_dwordx4 v100, s[16:19], s62 offen lds
  s_add_u32 m0, s60, 33792
  s_add_u32 s62, s61, 4096
  buffer_load_dwordx4 v100, s[16:19], s62 offen lds
  s_add_u32 m0, s60, 34816
  s_add_u32 s62, s61, 8192
  buffer_load_dwordx4 v100, s[16:19], s62 offen lds
  s_add_u32 m0, s60, 35840
  s_add_u32 s62, s61, 12288
  buffer_load_dwordx4 v100, s[16:19], s62 offen lds
  s_add_u32 m0, s60, 36864
  s_add_u32 s62, s61, 16384
  buffer_load_dwordx4 v100, s[16:19], s62 offen lds
  s_add_u32 m0, s60, 37888
  s_add_u32 s62, s61, 20480
  buffer_load_dwordx4 v100, s[16:19], s62 offen lds
  s_add_u32 m0, s60, 38912
  s_add_u32 s62, s61, 24576
  buffer_load_dwordx4 v100, s[16:19], s62 offen lds
  s_add_u32 m0, s60, 39936
  s_add_u32 s62, s61, 28672
  buffer_load_dwordx4 v100, s[16:19], s62 offen lds
  s_lshl_b32 s61, s34, 20
  s_lshl_b32 s62, s35, 8
  s_add_u32 s61, s61, s62
  s_add_u32 s61, s61, 262144
  s_add_u32 s61, s61, s63
  s_add_u32 m0, s60, 65536
  s_add_u32 s62, s61, 0
  buffer_load_dwordx4 v100, s[16:19], s62 offen lds
  s_add_u32 m0, s60, 66560
  s_add_u32 s62, s61, 4096
  buffer_load_dwordx4 v100, s[16:19], s62 offen lds
  s_add_u32 m0, s60, 67584
  s_add_u32 s62, s61, 8192
  buffer_load_dwordx4 v100, s[16:19], s62 offen lds
  s_add_u32 m0, s60, 68608
  s_add_u32 s62, s61, 12288
  buffer_load_dwordx4 v100, s[16:19], s62 offen lds
  s_add_u32 m0, s60, 69632
  s_add_u32 s62, s61, 16384
  buffer_load_dwordx4 v100, s[16:19], s62 offen lds
  s_add_u32 m0, s60, 70656
  s_add_u32 s62, s61, 20480
  buffer_load_dwordx4 v100, s[16:19], s62 offen lds
  s_add_u32 m0, s60, 71680
  s_add_u32 s62, s61, 24576
  buffer_load_dwordx4 v100, s[16:19], s62 offen lds
  s_add_u32 m0, s60, 72704
  s_add_u32 s62, s61, 28672
  buffer_load_dwordx4 v100, s[16:19], s62 offen lds
  s_waitcnt vmcnt(16)
  s_barrier
  s_lshl_b32 s61, s34, 20
  s_lshl_b32 s62, s35, 8
  s_add_u32 s61, s61, s62
  s_add_u32 s61, s61, 393216
  s_add_u32 s61, s61, s63
  s_add_u32 m0, s60, 98304
  s_add_u32 s62, s61, 0
  buffer_load_dwordx4 v100, s[16:19], s62 offen lds
  s_add_u32 m0, s60, 99328
  s_add_u32 s62, s61, 4096
  buffer_load_dwordx4 v100, s[16:19], s62 offen lds
  s_add_u32 m0, s60, 100352
  s_add_u32 s62, s61, 8192
  buffer_load_dwordx4 v100, s[16:19], s62 offen lds
  s_add_u32 m0, s60, 101376
  s_add_u32 s62, s61, 12288
  buffer_load_dwordx4 v100, s[16:19], s62 offen lds
  s_add_u32 m0, s60, 102400
  s_add_u32 s62, s61, 16384
  buffer_load_dwordx4 v100, s[16:19], s62 offen lds
  s_add_u32 m0, s60, 103424
  s_add_u32 s62, s61, 20480
  buffer_load_dwordx4 v100, s[16:19], s62 offen lds
  s_add_u32 m0, s60, 104448
  s_add_u32 s62, s61, 24576
  buffer_load_dwordx4 v100, s[16:19], s62 offen lds
  s_add_u32 m0, s60, 105472
  s_add_u32 s62, s61, 28672
  buffer_load_dwordx4 v100, s[16:19], s62 offen lds
  ds_read_b64_tr_b16 a[0:1], v104 offset:0
  ds_read_b64_tr_b16 a[2:3], v104 offset:4096
  ds_read_b64_tr_b16 a[4:5], v104 offset:2048
  ds_read_b64_tr_b16 a[6:7], v104 offset:6144
  ds_read_b64_tr_b16 a[8:9], v104 offset:8192
  ds_read_b64_tr_b16 a[10:11], v104 offset:12288
  ds_read_b64_tr_b16 a[12:13], v104 offset:10240
  ds_read_b64_tr_b16 a[14:15], v104 offset:14336
  ds_read_b64_tr_b16 a[16:17], v104 offset:16384
  ds_read_b64_tr_b16 a[18:19], v104 offset:20480
  ds_read_b64_tr_b16 a[20:21], v104 offset:18432
  ds_read_b64_tr_b16 a[22:23], v104 offset:22528
  ds_read_b64_tr_b16 a[24:25], v104 offset:24576
  ds_read_b64_tr_b16 a[26:27], v104 offset:28672
  ds_read_b64_tr_b16 a[28:29], v104 offset:26624
  ds_read_b64_tr_b16 a[30:31], v104 offset:30720
  s_waitcnt lgkmcnt(0)
  s_waitcnt vmcnt(16)
  s_barrier
  s_lshl_b32 s61, s34, 20
  s_lshl_b32 s62, s35, 8
  s_add_u32 s61, s61, s62
  s_add_u32 s61, s61, 524288
  s_add_u32 s61, s61, s63
  s_add_u32 m0, s60, 0
  s_add_u32 s62, s61, 0
  buffer_load_dwordx4 v100, s[16:19], s62 offen lds
  s_add_u32 m0, s60, 1024
  s_add_u32 s62, s61, 4096
  buffer_load_dwordx4 v100, s[16:19], s62 offen lds
  s_add_u32 m0, s60, 2048
  s_add_u32 s62, s61, 8192
  buffer_load_dwordx4 v100, s[16:19], s62 offen lds
  s_add_u32 m0, s60, 3072
  s_add_u32 s62, s61, 12288
  buffer_load_dwordx4 v100, s[16:19], s62 offen lds
  s_add_u32 m0, s60, 4096
  s_add_u32 s62, s61, 16384
  buffer_load_dwordx4 v100, s[16:19], s62 offen lds
  s_add_u32 m0, s60, 5120
  s_add_u32 s62, s61, 20480
  buffer_load_dwordx4 v100, s[16:19], s62 offen lds
  s_add_u32 m0, s60, 6144
  s_add_u32 s62, s61, 24576
  buffer_load_dwordx4 v100, s[16:19], s62 offen lds
  s_add_u32 m0, s60, 7168
  s_add_u32 s62, s61, 28672
  buffer_load_dwordx4 v100, s[16:19], s62 offen lds
  ds_read_b64_tr_b16 a[32:33], v104 offset:32768
  ds_read_b64_tr_b16 a[34:35], v104 offset:36864
  ds_read_b64_tr_b16 a[36:37], v104 offset:34816
  ds_read_b64_tr_b16 a[38:39], v104 offset:38912
  ds_read_b64_tr_b16 a[40:41], v104 offset:40960
  ds_read_b64_tr_b16 a[42:43], v104 offset:45056
  ds_read_b64_tr_b16 a[44:45], v104 offset:43008
  ds_read_b64_tr_b16 a[46:47], v104 offset:47104
  ds_read_b64_tr_b16 a[48:49], v104 offset:49152
  ds_read_b64_tr_b16 a[50:51], v104 offset:53248
  ds_read_b64_tr_b16 a[52:53], v104 offset:51200
  ds_read_b64_tr_b16 a[54:55], v104 offset:55296
  ds_read_b64_tr_b16 a[56:57], v104 offset:57344
  ds_read_b64_tr_b16 a[58:59], v104 offset:61440
  ds_read_b64_tr_b16 a[60:61], v104 offset:59392
  ds_read_b64_tr_b16 a[62:63], v104 offset:63488
  s_waitcnt lgkmcnt(0)
  s_waitcnt vmcnt(16)
  s_barrier
  s_lshl_b32 s61, s34, 20
  s_lshl_b32 s62, s35, 8
  s_add_u32 s61, s61, s62
  s_add_u32 s61, s61, 655360
  s_add_u32 s61, s61, s63
  s_add_u32 m0, s60, 32768
  s_add_u32 s62, s61, 0
  buffer_load_dwordx4 v100, s[16:19], s62 offen lds
  s_add_u32 m0, s60, 33792
  s_add_u32 s62, s61, 4096
  buffer_load_dwordx4 v100, s[16:19], s62 offen lds
  s_add_u32 m0, s60, 34816
  s_add_u32 s62, s61, 8192
  buffer_load_dwordx4 v100, s[16:19], s62 offen lds
  s_add_u32 m0, s60, 35840
  s_add_u32 s62, s61, 12288
  buffer_load_dwordx4 v100, s[16:19], s62 offen lds
  s_add_u32 m0, s60, 36864
  s_add_u32 s62, s61, 16384
  buffer_load_dwordx4 v100, s[16:19], s62 offen lds
  s_add_u32 m0, s60, 37888
  s_add_u32 s62, s61, 20480
  buffer_load_dwordx4 v100, s[16:19], s62 offen lds
  s_add_u32 m0, s60, 38912
  s_add_u32 s62, s61, 24576
  buffer_load_dwordx4 v100, s[16:19], s62 offen lds
  s_add_u32 m0, s60, 39936
  s_add_u32 s62, s61, 28672
  buffer_load_dwordx4 v100, s[16:19], s62 offen lds
  ds_read_b64_tr_b16 a[64:65], v105 offset:0
  ds_read_b64_tr_b16 a[66:67], v105 offset:4096
  ds_read_b64_tr_b16 a[68:69], v105 offset:2048
  ds_read_b64_tr_b16 a[70:71], v105 offset:6144
  ds_read_b64_tr_b16 a[72:73], v105 offset:8192
  ds_read_b64_tr_b16 a[74:75], v105 offset:12288
  ds_read_b64_tr_b16 a[76:77], v105 offset:10240
  ds_read_b64_tr_b16 a[78:79], v105 offset:14336
  ds_read_b64_tr_b16 a[80:81], v105 offset:16384
  ds_read_b64_tr_b16 a[82:83], v105 offset:20480
  ds_read_b64_tr_b16 a[84:85], v105 offset:18432
  ds_read_b64_tr_b16 a[86:87], v105 offset:22528
  ds_read_b64_tr_b16 a[88:89], v105 offset:24576
  ds_read_b64_tr_b16 a[90:91], v105 offset:28672
  ds_read_b64_tr_b16 a[92:93], v105 offset:26624
  ds_read_b64_tr_b16 a[94:95], v105 offset:30720
  s_waitcnt lgkmcnt(0)
  s_waitcnt vmcnt(16)
  s_barrier
  s_lshl_b32 s61, s34, 20
  s_lshl_b32 s62, s35, 8
  s_add_u32 s61, s61, s62
  s_add_u32 s61, s61, 786432
  s_add_u32 s61, s61, s63
  s_add_u32 m0, s60, 65536
  s_add_u32 s62, s61, 0
  buffer_load_dwordx4 v100, s[16:19], s62 offen lds
  s_add_u32 m0, s60, 66560
  s_add_u32 s62, s61, 4096
  buffer_load_dwordx4 v100, s[16:19], s62 offen lds
  s_add_u32 m0, s60, 67584
  s_add_u32 s62, s61, 8192
  buffer_load_dwordx4 v100, s[16:19], s62 offen lds
  s_add_u32 m0, s60, 68608
  s_add_u32 s62, s61, 12288
  buffer_load_dwordx4 v100, s[16:19], s62 offen lds
  s_add_u32 m0, s60, 69632
  s_add_u32 s62, s61, 16384
  buffer_load_dwordx4 v100, s[16:19], s62 offen lds
  s_add_u32 m0, s60, 70656
  s_add_u32 s62, s61, 20480
  buffer_load_dwordx4 v100, s[16:19], s62 offen lds
  s_add_u32 m0, s60, 71680
  s_add_u32 s62, s61, 24576
  buffer_load_dwordx4 v100, s[16:19], s62 offen lds
  s_add_u32 m0, s60, 72704
  s_add_u32 s62, s61, 28672
  buffer_load_dwordx4 v100, s[16:19], s62 offen lds
  ds_read_b64_tr_b16 a[96:97], v105 offset:32768
  ds_read_b64_tr_b16 a[98:99], v105 offset:36864
  ds_read_b64_tr_b16 a[100:101], v105 offset:34816
  ds_read_b64_tr_b16 a[102:103], v105 offset:38912
  ds_read_b64_tr_b16 a[104:105], v105 offset:40960
  ds_read_b64_tr_b16 a[106:107], v105 offset:45056
  ds_read_b64_tr_b16 a[108:109], v105 offset:43008
  ds_read_b64_tr_b16 a[110:111], v105 offset:47104
  ds_read_b64_tr_b16 a[112:113], v105 offset:49152
  ds_read_b64_tr_b16 a[114:115], v105 offset:53248
  ds_read_b64_tr_b16 a[116:117], v105 offset:51200
  ds_read_b64_tr_b16 a[118:119], v105 offset:55296
  ds_read_b64_tr_b16 a[120:121], v105 offset:57344
  ds_read_b64_tr_b16 a[122:123], v105 offset:61440
  ds_read_b64_tr_b16 a[124:125], v105 offset:59392
  ds_read_b64_tr_b16 a[126:127], v105 offset:63488
  s_waitcnt lgkmcnt(0)
  s_waitcnt vmcnt(16)
  s_barrier
  s_lshl_b32 s61, s34, 20
  s_lshl_b32 s62, s35, 8
  s_add_u32 s61, s61, s62
  s_add_u32 s61, s61, 917504
  s_add_u32 s61, s61, s63
  s_add_u32 m0, s60, 98304
  s_add_u32 s62, s61, 0
  buffer_load_dwordx4 v100, s[16:19], s62 offen lds
  s_add_u32 m0, s60, 99328
  s_add_u32 s62, s61, 4096
  buffer_load_dwordx4 v100, s[16:19], s62 offen lds
  s_add_u32 m0, s60, 100352
  s_add_u32 s62, s61, 8192
  buffer_load_dwordx4 v100, s[16:19], s62 offen lds
  s_add_u32 m0, s60, 101376
  s_add_u32 s62, s61, 12288
  buffer_load_dwordx4 v100, s[16:19], s62 offen lds
  s_add_u32 m0, s60, 102400
  s_add_u32 s62, s61, 16384
  buffer_load_dwordx4 v100, s[16:19], s62 offen lds
  s_add_u32 m0, s60, 103424
  s_add_u32 s62, s61, 20480
  buffer_load_dwordx4 v100, s[16:19], s62 offen lds
  s_add_u32 m0, s60, 104448
  s_add_u32 s62, s61, 24576
  buffer_load_dwordx4 v100, s[16:19], s62 offen lds
  s_add_u32 m0, s60, 105472
  s_add_u32 s62, s61, 28672
  buffer_load_dwordx4 v100, s[16:19], s62 offen lds
  ds_read_b64_tr_b16 a[128:129], v104 offset:0
  ds_read_b64_tr_b16 a[130:131], v104 offset:4096
  ds_read_b64_tr_b16 a[132:133], v104 offset:2048
  ds_read_b64_tr_b16 a[134:135], v104 offset:6144
  ds_read_b64_tr_b16 a[136:137], v104 offset:8192
  ds_read_b64_tr_b16 a[138:139], v104 offset:12288
  ds_read_b64_tr_b16 a[140:141], v104 offset:10240
  ds_read_b64_tr_b16 a[142:143], v104 offset:14336
  ds_read_b64_tr_b16 a[144:145], v104 offset:16384
  ds_read_b64_tr_b16 a[146:147], v104 offset:20480
  ds_read_b64_tr_b16 a[148:149], v104 offset:18432
  ds_read_b64_tr_b16 a[150:151], v104 offset:22528
  ds_read_b64_tr_b16 a[152:153], v104 offset:24576
  ds_read_b64_tr_b16 a[154:155], v104 offset:28672
  ds_read_b64_tr_b16 a[156:157], v104 offset:26624
  ds_read_b64_tr_b16 a[158:159], v104 offset:30720
  s_waitcnt lgkmcnt(0)
  s_waitcnt vmcnt(16)
  s_barrier
  ds_read_b64_tr_b16 a[160:161], v104 offset:32768
  ds_read_b64_tr_b16 a[162:163], v104 offset:36864
  ds_read_b64_tr_b16 a[164:165], v104 offset:34816
  ds_read_b64_tr_b16 a[166:167], v104 offset:38912
  ds_read_b64_tr_b16 a[168:169], v104 offset:40960
  ds_read_b64_tr_b16 a[170:171], v104 offset:45056
  ds_read_b64_tr_b16 a[172:173], v104 offset:43008
  ds_read_b64_tr_b16 a[174:175], v104 offset:47104
  ds_read_b64_tr_b16 a[176:177], v104 offset:49152
  ds_read_b64_tr_b16 a[178:179], v104 offset:53248
  ds_read_b64_tr_b16 a[180:181], v104 offset:51200
  ds_read_b64_tr_b16 a[182:183], v104 offset:55296
  ds_read_b64_tr_b16 a[184:185], v104 offset:57344
  ds_read_b64_tr_b16 a[186:187], v104 offset:61440
  ds_read_b64_tr_b16 a[188:189], v104 offset:59392
  ds_read_b64_tr_b16 a[190:191], v104 offset:63488
  s_waitcnt lgkmcnt(0)
  s_waitcnt vmcnt(8)
  s_barrier
  ds_read_b64_tr_b16 a[192:193], v105 offset:0
  ds_read_b64_tr_b16 a[194:195], v105 offset:4096
  ds_read_b64_tr_b16 a[196:197], v105 offset:2048
  ds_read_b64_tr_b16 a[198:199], v105 offset:6144
  ds_read_b64_tr_b16 a[200:201], v105 offset:8192
  ds_read_b64_tr_b16 a[202:203], v105 offset:12288
  ds_read_b64_tr_b16 a[204:205], v105 offset:10240
  ds_read_b64_tr_b16 a[206:207], v105 offset:14336
  ds_read_b64_tr_b16 a[208:209], v105 offset:16384
  ds_read_b64_tr_b16 a[210:211], v105 offset:20480
  ds_read_b64_tr_b16 a[212:213], v105 offset:18432
  ds_read_b64_tr_b16 a[214:215], v105 offset:22528
  ds_read_b64_tr_b16 a[216:217], v105 offset:24576
  ds_read_b64_tr_b16 a[218:219], v105 offset:28672
  ds_read_b64_tr_b16 a[220:221], v105 offset:26624
  ds_read_b64_tr_b16 a[222:223], v105 offset:30720
  s_waitcnt lgkmcnt(0)
  s_waitcnt vmcnt(0)
  s_barrier
  ds_read_b64_tr_b16 a[224:225], v105 offset:32768
  ds_read_b64_tr_b16 a[226:227], v105 offset:36864
  ds_read_b64_tr_b16 a[228:229], v105 offset:34816
  ds_read_b64_tr_b16 a[230:231], v105 offset:38912
  ds_read_b64_tr_b16 a[232:233], v105 offset:40960
  ds_read_b64_tr_b16 a[234:235], v105 offset:45056
  ds_read_b64_tr_b16 a[236:237], v105 offset:43008
  ds_read_b64_tr_b16 a[238:239], v105 offset:47104
  ds_read_b64_tr_b16 a[240:241], v105 offset:49152
  ds_read_b64_tr_b16 a[242:243], v105 offset:53248
  ds_read_b64_tr_b16 a[244:245], v105 offset:51200
  ds_read_b64_tr_b16 a[246:247], v105 offset:55296
  ds_read_b64_tr_b16 a[248:249], v105 offset:57344
  ds_read_b64_tr_b16 a[250:251], v105 offset:61440
  ds_read_b64_tr_b16 a[252:253], v105 offset:59392
  ds_read_b64_tr_b16 a[254:255], v105 offset:63488
  s_waitcnt lgkmcnt(0)
  s_barrier
  v_mov_b32 v3, 0
  v_mov_b32 v1, v0
  v_bfe_u32 v2, v0, 6, 1
  v_lshlrev_b32 v2, 7, v2
  v_bfe_u32 v4, v0, 2, 4
  v_or_b32 v2, v2, v4
  s_mov_b32 s7, 0
  v_mbcnt_lo_u32_b32 v16, -1, 0
  v_and_b32 v16, 3, v16
  v_lshlrev_b32 v16, 6, v16
L_wd_99:
  buffer_load_dword v17, v16, s[12:15], 0 offen offset:16 sc1
  s_waitcnt vmcnt(0)
  v_cmp_ne_u32 vcc, 64, v17
  s_cbranch_vccz L_wdo_100
  s_add_u32 s7, s7, 1
  s_cmp_lt_u32 s7, 131072
  s_cbranch_scc1 L_wd_99
  s_mov_b32 s6, 30
  s_branch L_err
L_wdo_100:
  s_mov_b32 s32, 0
  s_mov_b32 s41, 1
  s_mov_b32 s40, s38
L_o_wait:
  s_mov_b32 s7, 0
L_pl_101:
  buffer_load_dword v4, v2, s[8:11], s40 offen offset:0 sc1
  s_waitcnt vmcnt(0)
  v_cmp_gt_u32 vcc, s41, v4
  s_cbranch_vccz L_plo_102
  s_add_u32 s7, s7, 1
  s_cmp_lt_u32 s7, 131072
  s_cbranch_scc1 L_pl_101
  s_mov_b32 s6, 31
  s_branch L_err
L_plo_102:
  s_sub_u32 s6, s41, 1
  s_lshl_b32 s6, s6, 18
  s_add_u32 s44, s36, s6
  s_add_u32 m0, s42, 0
  s_add_u32 s45, s44, 0
  buffer_load_dwordx4 v0, s[8:11], s45 offen offset:0 lds
  buffer_load_dwordx4 v0, s[8:11], s45 offen offset:1024 lds
  buffer_load_dwordx4 v0, s[8:11], s45 offen offset:2048 lds
  buffer_load_dwordx4 v0, s[8:11], s45 offen offset:3072 lds
  s_add_u32 m0, s42, 4096
  s_add_u32 s45, s44, 4096
  buffer_load_dwordx4 v0, s[8:11], s45 offen offset:0 lds
  buffer_load_dwordx4 v0, s[8:11], s45 offen offset:1024 lds
  buffer_load_dwordx4 v0, s[8:11], s45 offen offset:2048 lds
  buffer_load_dwordx4 v0, s[8:11], s45 offen offset:3072 lds
  s_add_u32 m0, s42, 8192
  s_add_u32 s45, s44, 8192
  buffer_load_dwordx4 v0, s[8:11], s45 offen offset:0 lds
  buffer_load_dwordx4 v0, s[8:11], s45 offen offset:1024 lds
  buffer_load_dwordx4 v0, s[8:11], s45 offen offset:2048 lds
  buffer_load_dwordx4 v0, s[8:11], s45 offen offset:3072 lds
  s_add_u32 m0, s42, 12288
  s_add_u32 s45, s44, 12288
  buffer_load_dwordx4 v0, s[8:11], s45 offen offset:0 lds
  buffer_load_dwordx4 v0, s[8:11], s45 offen offset:1024 lds
  buffer_load_dwordx4 v0, s[8:11], s45 offen offset:2048 lds
  buffer_load_dwordx4 v0, s[8:11], s45 offen offset:3072 lds
  s_xor_b32 s42, s42, 0x10000
  s_mov_b32 s43, 0
  s_waitcnt vmcnt(8)
L_o_loop:
  s_barrier
  ds_read_b128 v[32:35], v1 offset:0
  ds_read_b128 v[36:39], v1 offset:1024
  ds_read_b128 v[40:43], v1 offset:2048
  s_add_u32 s41, s32, 2
  s_xor_b32 s40, s40, 0x1000
  buffer_load_dword v4, v2, s[8:11], s40 offen sc1
  s_waitcnt lgkmcnt(2)
  v_mfma_f32_32x32x16_bf16 v[16:31], a[0:3], v[32:35], 0
  ds_read_b128 v[44:47], v1 offset:3072
  s_waitcnt lgkmcnt(2)
  v_mfma_f32_32x32x16_bf16 v[16:31], a[4:7], v[36:39], v[16:31]
  ds_read_b128 v[32:35], v1 offset:4096
  s_waitcnt lgkmcnt(2)
  v_mfma_f32_32x32x16_bf16 v[16:31], a[8:11], v[40:43], v[16:31]
  ds_read_b128 v[36:39], v1 offset:5120
  s_waitcnt lgkmcnt(2)
  v_mfma_f32_32x32x16_bf16 v[16:31], a[12:15], v[44:47], v[16:31]
  ds_read_b128 v[40:43], v1 offset:6144
  s_waitcnt lgkmcnt(2)
  v_mfma_f32_32x32x16_bf16 v[16:31], a[16:19], v[32:35], v[16:31]
  ds_read_b128 v[44:47], v1 offset:7168
  s_waitcnt lgkmcnt(2)
  v_mfma_f32_32x32x16_bf16 v[16:31], a[20:23], v[36:39], v[16:31]
  ds_read_b128 v[32:35], v1 offset:16384
  s_waitcnt lgkmcnt(2)
  v_mfma_f32_32x32x16_bf16 v[16:31], a[24:27], v[40:43], v[16:31]
  ds_read_b128 v[36:39], v1 offset:17408
  s_waitcnt lgkmcnt(2)
  v_mfma_f32_32x32x16_bf16 v[16:31], a[28:31], v[44:47], v[16:31]
  ds_read_b128 v[40:43], v1 offset:18432
  s_waitcnt lgkmcnt(2)
  v_mfma_f32_32x32x16_bf16 v[16:31], a[64:67], v[32:35], v[16:31]
  ds_read_b128 v[44:47], v1 offset:19456
  s_waitcnt lgkmcnt(2)
  v_mfma_f32_32x32x16_bf16 v[16:31], a[68:71], v[36:39], v[16:31]
  ds_read_b128 v[32:35], v1 offset:20480
  s_waitcnt lgkmcnt(2)
  v_mfma_f32_32x32x16_bf16 v[16:31], a[72:75], v[40:43], v[16:31]
  ds_read_b128 v[36:39], v1 offset:21504
  s_waitcnt lgkmcnt(2)
  v_mfma_f32_32x32x16_bf16 v[16:31], a[76:79], v[44:47], v[16:31]
  ds_read_b128 v[40:43], v1 offset:22528
  s_waitcnt lgkmcnt(2)
  v_mfma_f32_32x32x16_bf16 v[16:31], a[80:83], v[32:35], v[16:31]
  ds_read_b128 v[44:47], v1 offset:23552
  s_waitcnt lgkmcnt(2)
  v_mfma_f32_32x32x16_bf16 v[16:31], a[84:87], v[36:39], v[16:31]
  ds_read_b128 v[32:35], v1 offset:32768
  s_waitcnt lgkmcnt(2)
  v_mfma_f32_32x32x16_bf16 v[16:31], a[88:91], v[40:43], v[16:31]
  ds_read_b128 v[36:39], v1 offset:33792
  s_waitcnt lgkmcnt(2)
  v_mfma_f32_32x32x16_bf16 v[16:31], a[92:95], v[44:47], v[16:31]
  ds_read_b128 v[40:43], v1 offset:34816
  s_waitcnt lgkmcnt(2)
  v_mfma_f32_32x32x16_bf16 v[16:31], a[128:131], v[32:35], v[16:31]
  ds_read_b128 v[44:47], v1 offset:35840
  s_waitcnt lgkmcnt(2)
  v_mfma_f32_32x32x16_bf16 v[16:31], a[132:135], v[36:39], v[16:31]
  ds_read_b128 v[32:35], v1 offset:36864
  s_waitcnt lgkmcnt(2)
  v_mfma_f32_32x32x16_bf16 v[16:31], a[136:139], v[40:43], v[16:31]
  ds_read_b128 v[36:39], v1 offset:37888
  s_waitcnt lgkmcnt(2)
  v_mfma_f32_32x32x16_bf16 v[16:31], a[140:143], v[44:47], v[16:31]
  ds_read_b128 v[40:43], v1 offset:38912
  s_waitcnt lgkmcnt(2)
  v_mfma_f32_32x32x16_bf16 v[16:31], a[144:147], v[32:35], v[16:31]
  ds_read_b128 v[44:47], v1 offset:39936
  s_waitcnt lgkmcnt(2)
  v_mfma_f32_32x32x16_bf16 v[16:31], a[148:151], v[36:39], v[16:31]
  ds_read_b128 v[32:35], v1 offset:49152
  s_waitcnt lgkmcnt(2)
  v_mfma_f32_32x32x16_bf16 v[16:31], a[152:155], v[40:43], v[16:31]
  ds_read_b128 v[36:39], v1 offset:50176
  s_waitcnt lgkmcnt(2)
  v_mfma_f32_32x32x16_bf16 v[16:31], a[156:159], v[44:47], v[16:31]
  ds_read_b128 v[40:43], v1 offset:51200
  s_waitcnt lgkmcnt(2)
  v_mfma_f32_32x32x16_bf16 v[16:31], a[192:195], v[32:35], v[16:31]
  ds_read_b128 v[44:47], v1 offset:52224
  s_waitcnt lgkmcnt(2)
  v_mfma_f32_32x32x16_bf16 v[16:31], a[196:199], v[36:39], v[16:31]
  ds_read_b128 v[32:35], v1 offset:53248
  s_waitcnt lgkmcnt(2)
  v_mfma_f32_32x32x16_bf16 v[16:31], a[200:203], v[40:43], v[16:31]
  ds_read_b128 v[36:39], v1 offset:54272
  s_waitcnt lgkmcnt(2)
  v_mfma_f32_32x32x16_bf16 v[16:31], a[204:207], v[44:47], v[16:31]
  ds_read_b128 v[40:43], v1 offset:55296
  s_waitcnt lgkmcnt(2)
  v_mfma_f32_32x32x16_bf16 v[16:31], a[208:211], v[32:35], v[16:31]
  ds_read_b128 v[44:47], v1 offset:56320
  s_waitcnt lgkmcnt(2)
  v_mfma_f32_32x32x16_bf16 v[16:31], a[212:215], v[36:39], v[16:31]
  s_waitcnt lgkmcnt(1)
  v_mfma_f32_32x32x16_bf16 v[16:31], a[216:219], v[40:43], v[16:31]
  s_waitcnt lgkmcnt(0)
  v_mfma_f32_32x32x16_bf16 v[16:31], a[220:223], v[44:47], v[16:31]
  s_waitcnt vmcnt(0)
  s_barrier
  ds_read_b128 v[32:35], v1 offset:8192
  ds_read_b128 v[36:39], v1 offset:9216
  ds_read_b128 v[40:43], v1 offset:10240
  s_cmp_eq_u32 s43, 0
  s_cbranch_scc1 L_op_103
  s_mov_b64 exec, 1
  buffer_store_dword v5, v3, s[8:11], s39 offen sc1
  s_mov_b64 exec, -1
L_op_103:
  s_mov_b32 s43, 0
  s_cmp_eq_u32 s32, 63
  s_cbranch_scc1 L_on_104
  v_cmp_gt_u32 vcc, s41, v4
  s_cbranch_vccnz L_on_104
  s_mov_b32 s43, 1
  s_waitcnt lgkmcnt(2)
  v_mfma_f32_32x32x16_bf16 v[16:31], a[32:35], v[32:35], v[16:31]
  ds_read_b128 v[44:47], v1 offset:11264
  s_sub_u32 s6, s41, 1
  s_lshl_b32 s6, s6, 18
  s_add_u32 s44, s36, s6
  s_waitcnt lgkmcnt(2)
  v_mfma_f32_32x32x16_bf16 v[16:31], a[36:39], v[36:39], v[16:31]
  ds_read_b128 v[32:35], v1 offset:12288
  s_add_u32 m0, s42, 0
  s_add_u32 s45, s44, 0
  buffer_load_dwordx4 v0, s[8:11], s45 offen offset:0 lds
  s_waitcnt lgkmcnt(2)
  v_mfma_f32_32x32x16_bf16 v[16:31], a[40:43], v[40:43], v[16:31]
  ds_read_b128 v[36:39], v1 offset:13312
  buffer_load_dwordx4 v0, s[8:11], s45 offen offset:1024 lds
  s_waitcnt lgkmcnt(2)
  v_mfma_f32_32x32x16_bf16 v[16:31], a[44:47], v[44:47], v[16:31]
  ds_read_b128 v[40:43], v1 offset:14336
  buffer_load_dwordx4 v0, s[8:11], s45 offen offset:2048 lds
  s_waitcnt lgkmcnt(2)
  v_mfma_f32_32x32x16_bf16 v[16:31], a[48:51], v[32:35], v[16:31]
  ds_read_b128 v[44:47], v1 offset:15360
  buffer_load_dwordx4 v0, s[8:11], s45 offen offset:3072 lds
  s_waitcnt lgkmcnt(2)
  v_mfma_f32_32x32x16_bf16 v[16:31], a[52:55], v[36:39], v[16:31]
  ds_read_b128 v[32:35], v1 offset:24576
  s_waitcnt lgkmcnt(2)
  v_mfma_f32_32x32x16_bf16 v[16:31], a[56:59], v[40:43], v[16:31]
  ds_read_b128 v[36:39], v1 offset:25600
  s_add_u32 m0, s42, 4096
  s_add_u32 s45, s44, 4096
  buffer_load_dwordx4 v0, s[8:11], s45 offen offset:0 lds
  s_waitcnt lgkmcnt(2)
  v_mfma_f32_32x32x16_bf16 v[16:31], a[60:63], v[44:47], v[16:31]
  ds_read_b128 v[40:43], v1 offset:26624
  s_waitcnt lgkmcnt(2)
  v_mfma_f32_32x32x16_bf16 v[16:31], a[96:99], v[32:35], v[16:31]
  ds_read_b128 v[44:47], v1 offset:27648
  buffer_load_dwordx4 v0, s[8:11], s45 offen offset:1024 lds
  s_waitcnt lgkmcnt(2)
  v_mfma_f32_32x32x16_bf16 v[16:31], a[100:103], v[36:39], v[16:31]
  ds_read_b128 v[32:35], v1 offset:28672
  s_waitcnt lgkmcnt(2)
  v_mfma_f32_32x32x16_bf16 v[16:31], a[104:107], v[40:43], v[16:31]
  ds_read_b128 v[36:39], v1 offset:29696
  buffer_load_dwordx4 v0, s[8:11], s45 offen offset:2048 lds
  s_waitcnt lgkmcnt(2)
  v_mfma_f32_32x32x16_bf16 v[16:31], a[108:111], v[44:47], v[16:31]
  ds_read_b128 v[40:43], v1 offset:30720
  s_waitcnt lgkmcnt(2)
  v_mfma_f32_32x32x16_bf16 v[16:31], a[112:115], v[32:35], v[16:31]
  ds_read_b128 v[44:47], v1 offset:31744
  buffer_load_dwordx4 v0, s[8:11], s45 offen offset:3072 lds
  s_waitcnt lgkmcnt(2)
  v_mfma_f32_32x32x16_bf16 v[16:31], a[116:119], v[36:39], v[16:31]
  ds_read_b128 v[32:35], v1 offset:40960
  s_waitcnt lgkmcnt(2)
  v_mfma_f32_32x32x16_bf16 v[16:31], a[120:123], v[40:43], v[16:31]
  ds_read_b128 v[36:39], v1 offset:41984
  s_add_u32 m0, s42, 8192
  s_add_u32 s45, s44, 8192
  buffer_load_dwordx4 v0, s[8:11], s45 offen offset:0 lds
  s_waitcnt lgkmcnt(2)
  v_mfma_f32_32x32x16_bf16 v[16:31], a[124:127], v[44:47], v[16:31]
  ds_read_b128 v[40:43], v1 offset:43008
  s_waitcnt lgkmcnt(2)
  v_mfma_f32_32x32x16_bf16 v[16:31], a[160:163], v[32:35], v[16:31]
  ds_read_b128 v[44:47], v1 offset:44032
  buffer_load_dwordx4 v0, s[8:11], s45 offen offset:1024 lds
  s_waitcnt lgkmcnt(2)
  v_mfma_f32_32x32x16_bf16 v[16:31], a[164:167], v[36:39], v[16:31]
  ds_read_b128 v[32:35], v1 offset:45056
  s_waitcnt lgkmcnt(2)
  v_mfma_f32_32x32x16_bf16 v[16:31], a[168:171], v[40:43], v[16:31]
  ds_read_b128 v[36:39], v1 offset:46080
  buffer_load_dwordx4 v0, s[8:11], s45 offen offset:2048 lds
  s_waitcnt lgkmcnt(2)
  v_mfma_f32_32x32x16_bf16 v[16:31], a[172:175], v[44:47], v[16:31]
  ds_read_b128 v[40:43], v1 offset:47104
  s_waitcnt lgkmcnt(2)
  v_mfma_f32_32x32x16_bf16 v[16:31], a[176:179], v[32:35], v[16:31]
  ds_read_b128 v[44:47], v1 offset:48128
  buffer_load_dwordx4 v0, s[8:11], s45 offen offset:3072 lds
  s_waitcnt lgkmcnt(2)
  v_mfma_f32_32x32x16_bf16 v[16:31], a[180:183], v[36:39], v[16:31]
  ds_read_b128 v[32:35], v1 offset:57344
  s_waitcnt lgkmcnt(2)
  v_mfma_f32_32x32x16_bf16 v[16:31], a[184:187], v[40:43], v[16:31]
  ds_read_b128 v[36:39], v1 offset:58368
  s_add_u32 m0, s42, 12288
  s_add_u32 s45, s44, 12288
  buffer_load_dwordx4 v0, s[8:11], s45 offen offset:0 lds
  s_waitcnt lgkmcnt(2)
  v_mfma_f32_32x32x16_bf16 v[16:31], a[188:191], v[44:47], v[16:31]
  ds_read_b128 v[40:43], v1 offset:59392
  s_waitcnt lgkmcnt(2)
  v_mfma_f32_32x32x16_bf16 v[16:31], a[224:227], v[32:35], v[16:31]
  ds_read_b128 v[44:47], v1 offset:60416
  buffer_load_dwordx4 v0, s[8:11], s45 offen offset:1024 lds
  s_waitcnt lgkmcnt(2)
  v_mfma_f32_32x32x16_bf16 v[16:31], a[228:231], v[36:39], v[16:31]
  ds_read_b128 v[32:35], v1 offset:61440
  s_waitcnt lgkmcnt(2)
  v_mfma_f32_32x32x16_bf16 v[16:31], a[232:235], v[40:43], v[16:31]
  ds_read_b128 v[36:39], v1 offset:62464
  buffer_load_dwordx4 v0, s[8:11], s45 offen offset:2048 lds
  s_waitcnt lgkmcnt(2)
  v_mfma_f32_32x32x16_bf16 v[16:31], a[236:239], v[44:47], v[16:31]
  ds_read_b128 v[40:43], v1 offset:63488
  s_waitcnt lgkmcnt(2)
  v_mfma_f32_32x32x16_bf16 v[16:31], a[240:243], v[32:35], v[16:31]
  ds_read_b128 v[44:47], v1 offset:64512
  buffer_load_dwordx4 v0, s[8:11], s45 offen offset:3072 lds
  s_waitcnt lgkmcnt(2)
  v_mfma_f32_32x32x16_bf16 v[16:31], a[244:247], v[36:39], v[16:31]
  s_waitcnt lgkmcnt(1)
  v_mfma_f32_32x32x16_bf16 v[16:31], a[248:251], v[40:43], v[16:31]
  s_xor_b32 s42, s42, 0x10000
  s_waitcnt lgkmcnt(0)
  v_mfma_f32_32x32x16_bf16 v[16:31], a[252:255], v[44:47], v[16:31]
  s_branch L_o_h2
L_on_104:
  s_waitcnt lgkmcnt(2)
  v_mfma_f32_32x32x16_bf16 v[16:31], a[32:35], v[32:35], v[16:31]
  ds_read_b128 v[44:47], v1 offset:11264
  s_waitcnt lgkmcnt(2)
  v_mfma_f32_32x32x16_bf16 v[16:31], a[36:39], v[36:39], v[16:31]
  ds_read_b128 v[32:35], v1 offset:12288
  s_waitcnt lgkmcnt(2)
  v_mfma_f32_32x32x16_bf16 v[16:31], a[40:43], v[40:43], v[16:31]
  ds_read_b128 v[36:39], v1 offset:13312
  s_waitcnt lgkmcnt(2)
  v_mfma_f32_32x32x16_bf16 v[16:31], a[44:47], v[44:47], v[16:31]
  ds_read_b128 v[40:43], v1 offset:14336
  s_waitcnt lgkmcnt(2)
  v_mfma_f32_32x32x16_bf16 v[16:31], a[48:51], v[32:35], v[16:31]
  ds_read_b128 v[44:47], v1 offset:15360
  s_waitcnt lgkmcnt(2)
  v_mfma_f32_32x32x16_bf16 v[16:31], a[52:55], v[36:39], v[16:31]
  ds_read_b128 v[32:35], v1 offset:24576
  s_waitcnt lgkmcnt(2)
  v_mfma_f32_32x32x16_bf16 v[16:31], a[56:59], v[40:43], v[16:31]
  ds_read_b128 v[36:39], v1 offset:25600
  s_waitcnt lgkmcnt(2)
  v_mfma_f32_32x32x16_bf16 v[16:31], a[60:63], v[44:47], v[16:31]
  ds_read_b128 v[40:43], v1 offset:26624
  s_waitcnt lgkmcnt(2)
  v_mfma_f32_32x32x16_bf16 v[16:31], a[96:99], v[32:35], v[16:31]
  ds_read_b128 v[44:47], v1 offset:27648
  s_waitcnt lgkmcnt(2)
  v_mfma_f32_32x32x16_bf16 v[16:31], a[100:103], v[36:39], v[16:31]
  ds_read_b128 v[32:35], v1 offset:28672
  s_waitcnt lgkmcnt(2)
  v_mfma_f32_32x32x16_bf16 v[16:31], a[104:107], v[40:43], v[16:31]
  ds_read_b128 v[36:39], v1 offset:29696
  s_waitcnt lgkmcnt(2)
  v_mfma_f32_32x32x16_bf16 v[16:31], a[108:111], v[44:47], v[16:31]
  ds_read_b128 v[40:43], v1 offset:30720
  s_waitcnt lgkmcnt(2)
  v_mfma_f32_32x32x16_bf16 v[16:31], a[112:115], v[32:35], v[16:31]
  ds_read_b128 v[44:47], v1 offset:31744
  s_waitcnt lgkmcnt(2)
  v_mfma_f32_32x32x16_bf16 v[16:31], a[116:119], v[36:39], v[16:31]
  ds_read_b128 v[32:35], v1 offset:40960
  s_waitcnt lgkmcnt(2)
  v_mfma_f32_32x32x16_bf16 v[16:31], a[120:123], v[40:43], v[16:31]
  ds_read_b128 v[36:39], v1 offset:41984
  s_waitcnt lgkmcnt(2)
  v_mfma_f32_32x32x16_bf16 v[16:31], a[124:127], v[44:47], v[16:31]
  ds_read_b128 v[40:43], v1 offset:43008
  s_waitcnt lgkmcnt(2)
  v_mfma_f32_32x32x16_bf16 v[16:31], a[160:163], v[32:35], v[16:31]
  ds_read_b128 v[44:47], v1 offset:44032
  s_waitcnt lgkmcnt(2)
  v_mfma_f32_32x32x16_bf16 v[16:31], a[164:167], v[36:39], v[16:31]
  ds_read_b128 v[32:35], v1 offset:45056
  s_waitcnt lgkmcnt(2)
  v_mfma_f32_32x32x16_bf16 v[16:31], a[168:171], v[40:43], v[16:31]
  ds_read_b128 v[36:39], v1 offset:46080
  s_waitcnt lgkmcnt(2)
  v_mfma_f32_32x32x16_bf16 v[16:31], a[172:175], v[44:47], v[16:31]
  ds_read_b128 v[40:43], v1 offset:47104
  s_waitcnt lgkmcnt(2)
  v_mfma_f32_32x32x16_bf16 v[16:31], a[176:179], v[32:35], v[16:31]
  ds_read_b128 v[44:47], v1 offset:48128
  s_waitcnt lgkmcnt(2)
  v_mfma_f32_32x32x16_bf16 v[16:31], a[180:183], v[36:39], v[16:31]
  ds_read_b128 v[32:35], v1 offset:57344
  s_waitcnt lgkmcnt(2)
  v_mfma_f32_32x32x16_bf16 v[16:31], a[184:187], v[40:43], v[16:31]
  ds_read_b128 v[36:39], v1 offset:58368
  s_waitcnt lgkmcnt(2)
  v_mfma_f32_32x32x16_bf16 v[16:31], a[188:191], v[44:47], v[16:31]
  ds_read_b128 v[40:43], v1 offset:59392
  s_waitcnt lgkmcnt(2)
  v_mfma_f32_32x32x16_bf16 v[16:31], a[224:227], v[32:35], v[16:31]
  ds_read_b128 v[44:47], v1 offset:60416
  s_waitcnt lgkmcnt(2)
  v_mfma_f32_32x32x16_bf16 v[16:31], a[228:231], v[36:39], v[16:31]
  ds_read_b128 v[32:35], v1 offset:61440
  s_waitcnt lgkmcnt(2)
  v_mfma_f32_32x32x16_bf16 v[16:31], a[232:235], v[40:43], v[16:31]
  ds_read_b128 v[36:39], v1 offset:62464
  s_waitcnt lgkmcnt(2)
  v_mfma_f32_32x32x16_bf16 v[16:31], a[236:239], v[44:47], v[16:31]
  ds_read_b128 v[40:43], v1 offset:63488
  s_waitcnt lgkmcnt(2)
  v_mfma_f32_32x32x16_bf16 v[16:31], a[240:243], v[32:35], v[16:31]
  ds_read_b128 v[44:47], v1 offset:64512
  s_waitcnt lgkmcnt(2)
  v_mfma_f32_32x32x16_bf16 v[16:31], a[244:247], v[36:39], v[16:31]
  s_waitcnt lgkmcnt(1)
  v_mfma_f32_32x32x16_bf16 v[16:31], a[248:251], v[40:43], v[16:31]
  s_waitcnt lgkmcnt(0)
  v_mfma_f32_32x32x16_bf16 v[16:31], a[252:255], v[44:47], v[16:31]
L_o_h2:
  s_lshl_b32 s6, s32, 17
  s_add_u32 s44, s37, s6
  s_add_u32 s32, s32, 1
  v_xor_b32 v1, 0x10000, v1
  v_mov_b32 v5, s32
  s_nop 6
  v_cvt_pk_bf16_f32 v48, v16, v17
  v_cvt_pk_bf16_f32 v49, v18, v19
  v_cvt_pk_bf16_f32 v50, v20, v21
  v_cvt_pk_bf16_f32 v51, v22, v23
  buffer_store_dwordx4 v[48:51], v0, s[8:11], s44 offen offset:0 sc1
  v_cvt_pk_bf16_f32 v52, v24, v25
  v_cvt_pk_bf16_f32 v53, v26, v27
  v_cvt_pk_bf16_f32 v54, v28, v29
  v_cvt_pk_bf16_f32 v55, v30, v31
  buffer_store_dwordx4 v[52:55], v0, s[8:11], s44 offen offset:1024 sc1
  s_cmp_eq_u32 s43, 0
  s_waitcnt vmcnt(2)
  s_cbranch_scc0 L_o_loop
  s_waitcnt vmcnt(0)
  s_mov_b64 exec, 1
  buffer_store_dword v5, v3, s[8:11], s39 offen sc1
  s_mov_b64 exec, -1
  s_cmp_lt_u32 s32, 64
  s_cbranch_scc1 L_o_wait
  s_waitcnt vmcnt(0)
  s_endpgm
L_pro:
  s_max_u32 s6, s4, 3
  s_sub_u32 s6, s6, 3
  s_lshl_b32 s6, s6, 5
  s_add_u32 s6, s6, s5
  s_lshl_b32 s62, s6, 15
  s_lshl_b32 s6, s6, 2
  s_add_u32 s60, s6, s3
  s_lshl_b32 s6, s60, 2
  s_add_u32 s6, s6, 0x710000
  v_mov_b32 v1, 0
  v_lshlrev_b32 v2, 4, v0
  s_mov_b64 exec, 1
  buffer_store_dword v1, v1, s[8:11], s6 offen sc1
  s_mov_b64 exec, -1
  v_lshlrev_b32 v16, 2, v0
  s_lshl_b32 s6, s60, 8
  s_lshl_b32 s7, s60, 1
  s_mov_b32 s16, s66
  s_mov_b32 s17, s67
  s_mov_b32 s18, 0x20000
  s_mov_b32 s19, 0x20000
  buffer_load_dword v20, v16, s[16:19], s6 offen
  s_mov_b32 s20, s68
  s_mov_b32 s21, s69
  s_mov_b32 s22, 0x20000
  s_mov_b32 s23, 0x20000
  buffer_load_dword v21, v16, s[20:23], s6 offen
  s_mov_b32 s24, s70
  s_mov_b32 s25, s71
  s_mov_b32 s26, 0x20000
  s_mov_b32 s27, 0x20000
  buffer_load_dword v22, v16, s[24:27], s6 offen
  s_mov_b32 s28, s72
  s_mov_b32 s29, s73
  s_mov_b32 s30, 0x20000
  s_mov_b32 s31, 0x20000
  buffer_load_dword v23, v16, s[28:31], s6 offen
  s_mov_b32 s16, s74
  s_mov_b32 s17, s75
  s_mov_b32 s18, 0x400
  s_mov_b32 s19, 0x20000
  buffer_load_ushort v24, v1, s[16:19], s7 offen
  s_mov_b32 s20, s76
  s_mov_b32 s21, s77
  s_mov_b32 s22, 0x400
  s_mov_b32 s23, 0x20000
  buffer_load_ushort v232, v1, s[20:23], s7 offen
  s_waitcnt vmcnt(6)
  s_barrier
  s_cmp_lg_u32 s3, 0
  s_cbranch_scc1 L_sd_105
  s_mov_b64 exec, 1
  s_and_b32 s6, s4, 3
  s_lshl_b32 s6, s6, 6
  v_mov_b32 v18, 16
  v_mov_b32 v19, 1
  buffer_atomic_add v19, v18, s[12:15], s6 offen sc1
  s_mov_b64 exec, -1
L_sd_105:
  v_and_b32 v16, 15, v0
  v_and_b32 v17, 7, v16
  v_lshrrev_b32 v18, 3, v16
  v_lshl_add_u32 v19, v18, 7, v17
  v_add_u32 v19, 1, v19
  v_cvt_f32_u32 v4, v19
  v_and_b32 v19, 3, v16
  v_lshrrev_b32 v25, 2, v16
  v_lshlrev_b32 v25, 6, v25
  v_add_u32 v19, v19, v25
  v_lshlrev_b32 v19, 1, v19
  v_add_u32 v19, 258, v19
  v_cmp_gt_u32 vcc, 8, v16
  s_nop 1
  v_cndmask_b32 v19, 0, v19, vcc
  v_cvt_f32_u32 v5, v19
  v_and_b32 v19, 1, v16
  v_lshrrev_b32 v25, 1, v17
  v_lshlrev_b32 v25, 7, v25
  v_lshl_add_u32 v19, v19, 2, v25
  v_add_u32 v19, 516, v19
  v_lshlrev_b32 v25, 7, v17
  v_add_u32 v25, 1032, v25
  v_cndmask_b32 v19, v25, v19, vcc
  v_cvt_f32_u32 v6, v19
  v_lshlrev_b32 v19, 3, v16
  v_cvt_f32_u32 v7, v19
  v_lshrrev_b32 v19, 4, v0
  s_lshl_b32 s6, s3, 11
  v_lshl_add_u32 v3, v19, 6, s6
  v_lshlrev_b32 v16, 4, v0
  v_cvt_f32_u32 v16, v16
  s_mul_i32 s63, s3, 4352
  s_add_u32 s63, s63, 8192
  v_sub_f32 v17, 0x45800000, v16
  v_sub_f32 v18, 0x457fe000, v16
  v_cvt_pk_bf16_f32 v17, v17, v18
  v_lshlrev_b32 v160, 16, v17
  v_and_b32 v161, 0xffff0000, v17
  v_cvt_u32_f32 v160, v160
  v_cvt_u32_f32 v161, v161
  v_add_u32 v160, s63, v160
  v_add_u32 v161, s63, v161
  v_sub_f32 v17, 0x457fc000, v16
  v_sub_f32 v18, 0x457fa000, v16
  v_cvt_pk_bf16_f32 v17, v17, v18
  v_lshlrev_b32 v162, 16, v17
  v_and_b32 v163, 0xffff0000, v17
  v_cvt_u32_f32 v162, v162
  v_cvt_u32_f32 v163, v163
  v_add_u32 v162, s63, v162
  v_add_u32 v163, s63, v163
  v_sub_f32 v17, 0x457f8000, v16
  v_sub_f32 v18, 0x457f6000, v16
  v_cvt_pk_bf16_f32 v17, v17, v18
  v_lshlrev_b32 v164, 16, v17
  v_and_b32 v165, 0xffff0000, v17
  v_cvt_u32_f32 v164, v164
  v_cvt_u32_f32 v165, v165
  v_add_u32 v164, s63, v164
  v_add_u32 v165, s63, v165
  v_sub_f32 v17, 0x457f4000, v16
  v_sub_f32 v18, 0x457f2000, v16
  v_cvt_pk_bf16_f32 v17, v17, v18
  v_lshlrev_b32 v166, 16, v17
  v_and_b32 v167, 0xffff0000, v17
  v_cvt_u32_f32 v166, v166
  v_cvt_u32_f32 v167, v167
  v_add_u32 v166, s63, v166
  v_add_u32 v167, s63, v167
  v_sub_f32 v17, 0x45400000, v16
  v_sub_f32 v18, 0x453fe000, v16
  v_cvt_pk_bf16_f32 v17, v17, v18
  v_lshlrev_b32 v168, 16, v17
  v_and_b32 v169, 0xffff0000, v17
  v_cvt_u32_f32 v168, v168
  v_cvt_u32_f32 v169, v169
  v_add_u32 v168, s63, v168
  v_add_u32 v169, s63, v169
  v_sub_f32 v17, 0x453fc000, v16
  v_sub_f32 v18, 0x453fa000, v16
  v_cvt_pk_bf16_f32 v17, v17, v18
  v_lshlrev_b32 v170, 16, v17
  v_and_b32 v171, 0xffff0000, v17
  v_cvt_u32_f32 v170, v170
  v_cvt_u32_f32 v171, v171
  v_add_u32 v170, s63, v170
  v_add_u32 v171, s63, v171
  v_sub_f32 v17, 0x453f8000, v16
  v_sub_f32 v18, 0x453f6000, v16
  v_cvt_pk_bf16_f32 v17, v17, v18
  v_lshlrev_b32 v172, 16, v17
  v_and_b32 v173, 0xffff0000, v17
  v_cvt_u32_f32 v172, v172
  v_cvt_u32_f32 v173, v173
  v_add_u32 v172, s63, v172
  v_add_u32 v173, s63, v173
  v_sub_f32 v17, 0x453f4000, v16
  v_sub_f32 v18, 0x453f2000, v16
  v_cvt_pk_bf16_f32 v17, v17, v18
  v_lshlrev_b32 v174, 16, v17
  v_and_b32 v175, 0xffff0000, v17
  v_cvt_u32_f32 v174, v174
  v_cvt_u32_f32 v175, v175
  v_add_u32 v174, s63, v174
  v_add_u32 v175, s63, v175
  v_sub_f32 v17, 0x45000000, v16
  v_sub_f32 v18, 0x44ffc000, v16
  v_cvt_pk_bf16_f32 v17, v17, v18
  v_lshlrev_b32 v176, 16, v17
  v_and_b32 v177, 0xffff0000, v17
  v_cvt_u32_f32 v176, v176
  v_cvt_u32_f32 v177, v177
  v_add_u32 v176, s63, v176
  v_add_u32 v177, s63, v177
  v_sub_f32 v17, 0x44ff8000, v16
  v_sub_f32 v18, 0x44ff4000, v16
  v_cvt_pk_bf16_f32 v17, v17, v18
  v_lshlrev_b32 v178, 16, v17
  v_and_b32 v179, 0xffff0000, v17
  v_cvt_u32_f32 v178, v178
  v_cvt_u32_f32 v179, v179
  v_add_u32 v178, s63, v178
  v_add_u32 v179, s63, v179
  v_sub_f32 v17, 0x44ff0000, v16
  v_sub_f32 v18, 0x44fec000, v16
  v_cvt_pk_bf16_f32 v17, v17, v18
  v_lshlrev_b32 v180, 16, v17
  v_and_b32 v181, 0xffff0000, v17
  v_cvt_u32_f32 v180, v180
  v_cvt_u32_f32 v181, v181
  v_add_u32 v180, s63, v180
  v_add_u32 v181, s63, v181
  v_sub_f32 v17, 0x44fe8000, v16
  v_sub_f32 v18, 0x44fe4000, v16
  v_cvt_pk_bf16_f32 v17, v17, v18
  v_lshlrev_b32 v182, 16, v17
  v_and_b32 v183, 0xffff0000, v17
  v_cvt_u32_f32 v182, v182
  v_cvt_u32_f32 v183, v183
  v_add_u32 v182, s63, v182
  v_add_u32 v183, s63, v183
  v_sub_f32 v17, 0x44800000, v16
  v_sub_f32 v18, 0x447f8000, v16
  v_cvt_pk_bf16_f32 v17, v17, v18
  v_lshlrev_b32 v184, 16, v17
  v_and_b32 v185, 0xffff0000, v17
  v_cvt_u32_f32 v184, v184
  v_cvt_u32_f32 v185, v185
  v_add_u32 v184, s63, v184
  v_add_u32 v185, s63, v185
  v_sub_f32 v17, 0x447f0000, v16
  v_sub_f32 v18, 0x447e8000, v16
  v_cvt_pk_bf16_f32 v17, v17, v18
  v_lshlrev_b32 v186, 16, v17
  v_and_b32 v187, 0xffff0000, v17
  v_cvt_u32_f32 v186, v186
  v_cvt_u32_f32 v187, v187
  v_add_u32 v186, s63, v186
  v_add_u32 v187, s63, v187
  v_sub_f32 v17, 0x447e0000, v16
  v_sub_f32 v18, 0x447d8000, v16
  v_cvt_pk_bf16_f32 v17, v17, v18
  v_lshlrev_b32 v188, 16, v17
  v_and_b32 v189, 0xffff0000, v17
  v_cvt_u32_f32 v188, v188
  v_cvt_u32_f32 v189, v189
  v_add_u32 v188, s63, v188
  v_add_u32 v189, s63, v189
  v_sub_f32 v17, 0x447d0000, v16
  v_sub_f32 v18, 0x447c8000, v16
  v_cvt_pk_bf16_f32 v17, v17, v18
  v_lshlrev_b32 v190, 16, v17
  v_and_b32 v191, 0xffff0000, v17
  v_cvt_u32_f32 v190, v190
  v_cvt_u32_f32 v191, v191
  v_add_u32 v190, s63, v190
  v_add_u32 v191, s63, v191
  s_waitcnt vmcnt(1)
  v_lshlrev_b32 v24, 16, v24
  v_mul_f32 v26, 0x3fb8aa3b, v24
  v_mov_b32 v27, 0x3fb8aa3b
  v_fma_f32 v27, v24, v27, -v26
  v_fmac_f32 v27, 0x32a57060, v24
  v_exp_f32 v26, v26
  v_mul_f32 v27, 0x3f317218, v27
  v_fma_f32 v24, v26, v27, v26
  v_cvt_pk_bf16_f32 v24, v24, v24
  v_and_b32 v24, 0xffff0000, v24
  v_lshlrev_b32 v32, 16, v20
  v_and_b32 v36, 0xffff0000, v20
  v_lshlrev_b32 v33, 16, v21
  v_and_b32 v37, 0xffff0000, v21
  v_lshlrev_b32 v34, 16, v22
  v_and_b32 v38, 0xffff0000, v22
  v_lshlrev_b32 v35, 16, v23
  v_and_b32 v39, 0xffff0000, v23
  v_max3_f32 v28, |v34|, |v35|, |v38|
  v_max_f32 v28, |v39|, v28
  s_nop 1
  v_max_f32_dpp v28, v28, v28 quad_perm:[1,0,3,2] row_mask:0xf bank_mask:0xf
  s_nop 1
  v_max_f32_dpp v28, v28, v28 quad_perm:[2,3,0,1] row_mask:0xf bank_mask:0xf
  s_nop 1
  v_max_f32_dpp v28, v28, v28 row_half_mirror row_mask:0xf bank_mask:0xf
  s_nop 1
  v_max_f32_dpp v28, v28, v28 row_mirror row_mask:0xf bank_mask:0xf
  v_mov_b32 v29, v28
  s_nop 1
  v_permlane16_swap_b32 v28, v29
  v_max_f32 v28, v28, v29
  v_mov_b32 v29, v28
  s_nop 1
  v_permlane32_swap_b32 v28, v29
  v_max_f32 v28, v28, v29
  v_frexp_exp_i32_f32 v28, v28
  v_sub_u32 v29, 0, v28
  v_mul_f32 v26, 0x3fb8aa3b, v32
  v_mov_b32 v27, 0x3fb8aa3b
  v_fma_f32 v27, v32, v27, -v26
  v_fmac_f32 v27, 0x32a57060, v32
  v_exp_f32 v26, v26
  v_mul_f32 v27, 0x3f317218, v27
  v_fma_f32 v32, v26, v27, v26
  v_cvt_pk_bf16_f32 v32, v32, v32
  v_and_b32 v32, 0xffff0000, v32
  v_mul_f32 v32, v32, v24
  v_mul_f32 v33, v33, v24
  v_ldexp_f32 v34, v34, v29
  v_ldexp_f32 v35, v35, v29
  v_mul_f32 v32, 0xbfb8aa3b, v32
  v_mul_f32 v33, 0x3e22f983, v33
  v_mul_f32 v26, 0x3fb8aa3b, v36
  v_mov_b32 v27, 0x3fb8aa3b
  v_fma_f32 v27, v36, v27, -v26
  v_fmac_f32 v27, 0x32a57060, v36
  v_exp_f32 v26, v26
  v_mul_f32 v27, 0x3f317218, v27
  v_fma_f32 v36, v26, v27, v26
  v_cvt_pk_bf16_f32 v36, v36, v36
  v_and_b32 v36, 0xffff0000, v36
  v_mul_f32 v36, v36, v24
  v_mul_f32 v37, v37, v24
  v_ldexp_f32 v38, v38, v29
  v_ldexp_f32 v39, v39, v29
  v_mul_f32 v36, 0xbfb8aa3b, v36
  v_mul_f32 v37, 0x3e22f983, v37
  v_add_f32 v24, v24, v24
  v_ldexp_f32 v233, v24, v28
  s_lshl_b32 s6, s3, 11
  v_lshl_add_u32 v16, v0, 5, s6
  ds_write_b128 v16, v[32:35] offset:0
  ds_write_b128 v16, v[36:39] offset:16
  ds_read_b128 v[8:11], v3 offset:0
  v_mov_b32 v48, 0
  v_mov_b32 v49, 0
  v_mov_b32 v50, 0
  v_mov_b32 v51, 0
  v_mov_b32 v52, 0
  v_mov_b32 v53, 0
  v_mov_b32 v54, 0
  v_mov_b32 v55, 0
  v_mov_b32 v56, 0
  v_mov_b32 v57, 0
  v_mov_b32 v58, 0
  v_mov_b32 v59, 0
  v_mov_b32 v16, 0
  v_mov_b32 v17, 0
  v_mov_b32 v18, 0
  v_mov_b32 v19, 0
  v_mov_b32 v20, 0
  v_mov_b32 v21, 0
  v_mov_b32 v22, 0
  v_mov_b32 v23, 0
  v_mov_b32 v24, 0
  v_mov_b32 v25, 0
  v_mov_b32 v26, 0
  v_mov_b32 v27, 0
  v_mov_b32 v28, 0
  v_mov_b32 v29, 0
  v_mov_b32 v30, 0
  v_mov_b32 v31, 0
  s_mov_b32 s6, 2
L_kg_106:
  s_waitcnt lgkmcnt(0)
  ds_read_b128 v[12:15], v3 offset:16
  v_mfma_f32_16x16x32_f16 v[48:51], v[16:19], v[28:31], v[48:51]
  v_pk_mul_f32 v[38:39], v[8:9], v[6:7] op_sel:[0,1] op_sel_hi:[1,1]
  v_mfma_f32_16x16x32_f16 v[52:55], v[20:23], v[28:31], v[52:55]
  v_pk_mul_f32 v[32:33], v[8:9], v[4:5] op_sel:[0,0] op_sel_hi:[1,0]
  v_mfma_f32_16x16x32_f16 v[56:59], v[24:27], v[28:31], v[56:59]
  v_pk_mul_f32 v[34:35], v[8:9], v[4:5] op_sel:[0,1] op_sel_hi:[1,1]
  v_pk_mul_f32 v[36:37], v[8:9], v[6:7] op_sel:[0,0] op_sel_hi:[1,0]
  v_fract_f32 v39, v39
  v_fract_f32 v33, v33
  v_fract_f32 v35, v35
  v_fract_f32 v37, v37
  v_exp_f32 v38, v38
  v_cos_f32 v46, v39
  v_sin_f32 v47, v39
  v_exp_f32 v32, v32
  v_cos_f32 v40, v33
  v_sin_f32 v41, v33
  v_exp_f32 v34, v34
  v_cos_f32 v42, v35
  v_sin_f32 v43, v35
  v_exp_f32 v36, v36
  v_cos_f32 v44, v37
  v_sin_f32 v45, v37
  v_pk_mul_f32 v[46:47], v[46:47], v[38:39] op_sel_hi:[1,0]
  v_pk_mul_f32 v[40:41], v[40:41], v[32:33] op_sel_hi:[1,0]
  v_pk_mul_f32 v[42:43], v[42:43], v[34:35] op_sel_hi:[1,0]
  v_pk_mul_f32 v[44:45], v[44:45], v[36:37] op_sel_hi:[1,0]
  v_pk_mul_f32 v[32:33], v[46:47], v[10:11] op_sel_hi:[1,0] neg_hi:[1,0]
  v_cvt_pk_f16_f32 v16, v40, v41
  v_pk_fma_f32 v[32:33], v[46:47], v[10:11], v[32:33] op_sel:[1,1,0] op_sel_hi:[0,1,1] neg_lo:[1,0,0] neg_hi:[1,0,0]
  v_cvt_pk_f16_f32 v20, v42, v43
  v_cvt_pk_f16_f32 v24, v44, v45
  v_cvt_pk_f16_f32 v28, v32, v33
  s_waitcnt lgkmcnt(0)
  ds_read_b128 v[8:11], v3 offset:32
  v_pk_mul_f32 v[38:39], v[12:13], v[6:7] op_sel:[0,1] op_sel_hi:[1,1]
  v_pk_mul_f32 v[32:33], v[12:13], v[4:5] op_sel:[0,0] op_sel_hi:[1,0]
  v_pk_mul_f32 v[34:35], v[12:13], v[4:5] op_sel:[0,1] op_sel_hi:[1,1]
  v_pk_mul_f32 v[36:37], v[12:13], v[6:7] op_sel:[0,0] op_sel_hi:[1,0]
  v_fract_f32 v39, v39
  v_fract_f32 v33, v33
  v_fract_f32 v35, v35
  v_fract_f32 v37, v37
  v_exp_f32 v38, v38
  v_cos_f32 v46, v39
  v_sin_f32 v47, v39
  v_exp_f32 v32, v32
  v_cos_f32 v40, v33
  v_sin_f32 v41, v33
  v_exp_f32 v34, v34
  v_cos_f32 v42, v35
  v_sin_f32 v43, v35
  v_exp_f32 v36, v36
  v_cos_f32 v44, v37
  v_sin_f32 v45, v37
  v_pk_mul_f32 v[46:47], v[46:47], v[38:39] op_sel_hi:[1,0]
  v_pk_mul_f32 v[40:41], v[40:41], v[32:33] op_sel_hi:[1,0]
  v_pk_mul_f32 v[42:43], v[42:43], v[34:35] op_sel_hi:[1,0]
  v_pk_mul_f32 v[44:45], v[44:45], v[36:37] op_sel_hi:[1,0]
  v_pk_mul_f32 v[32:33], v[46:47], v[14:15] op_sel_hi:[1,0] neg_hi:[1,0]
  v_cvt_pk_f16_f32 v17, v40, v41
  v_pk_fma_f32 v[32:33], v[46:47], v[14:15], v[32:33] op_sel:[1,1,0] op_sel_hi:[0,1,1] neg_lo:[1,0,0] neg_hi:[1,0,0]
  v_cvt_pk_f16_f32 v21, v42, v43
  v_cvt_pk_f16_f32 v25, v44, v45
  v_cvt_pk_f16_f32 v29, v32, v33
  s_waitcnt lgkmcnt(0)
  ds_read_b128 v[12:15], v3 offset:48
  v_pk_mul_f32 v[38:39], v[8:9], v[6:7] op_sel:[0,1] op_sel_hi:[1,1]
  v_pk_mul_f32 v[32:33], v[8:9], v[4:5] op_sel:[0,0] op_sel_hi:[1,0]
  v_pk_mul_f32 v[34:35], v[8:9], v[4:5] op_sel:[0,1] op_sel_hi:[1,1]
  v_pk_mul_f32 v[36:37], v[8:9], v[6:7] op_sel:[0,0] op_sel_hi:[1,0]
  v_fract_f32 v39, v39
  v_fract_f32 v33, v33
  v_fract_f32 v35, v35
  v_fract_f32 v37, v37
  v_exp_f32 v38, v38
  v_cos_f32 v46, v39
  v_sin_f32 v47, v39
  v_exp_f32 v32, v32
  v_cos_f32 v40, v33
  v_sin_f32 v41, v33
  v_exp_f32 v34, v34
  v_cos_f32 v42, v35
  v_sin_f32 v43, v35
  v_exp_f32 v36, v36
  v_cos_f32 v44, v37
  v_sin_f32 v45, v37
  v_pk_mul_f32 v[46:47], v[46:47], v[38:39] op_sel_hi:[1,0]
  v_pk_mul_f32 v[40:41], v[40:41], v[32:33] op_sel_hi:[1,0]
  v_pk_mul_f32 v[42:43], v[42:43], v[34:35] op_sel_hi:[1,0]
  v_pk_mul_f32 v[44:45], v[44:45], v[36:37] op_sel_hi:[1,0]
  v_pk_mul_f32 v[32:33], v[46:47], v[10:11] op_sel_hi:[1,0] neg_hi:[1,0]
  v_cvt_pk_f16_f32 v18, v40, v41
  v_pk_fma_f32 v[32:33], v[46:47], v[10:11], v[32:33] op_sel:[1,1,0] op_sel_hi:[0,1,1] neg_lo:[1,0,0] neg_hi:[1,0,0]
  v_cvt_pk_f16_f32 v22, v42, v43
  v_cvt_pk_f16_f32 v26, v44, v45
  v_cvt_pk_f16_f32 v30, v32, v33
  s_waitcnt lgkmcnt(0)
  ds_read_b128 v[8:11], v3 offset:256
  v_pk_mul_f32 v[38:39], v[12:13], v[6:7] op_sel:[0,1] op_sel_hi:[1,1]
  v_pk_mul_f32 v[32:33], v[12:13], v[4:5] op_sel:[0,0] op_sel_hi:[1,0]
  v_pk_mul_f32 v[34:35], v[12:13], v[4:5] op_sel:[0,1] op_sel_hi:[1,1]
  v_pk_mul_f32 v[36:37], v[12:13], v[6:7] op_sel:[0,0] op_sel_hi:[1,0]
  v_fract_f32 v39, v39
  v_fract_f32 v33, v33
  v_fract_f32 v35, v35
  v_fract_f32 v37, v37
  v_exp_f32 v38, v38
  v_cos_f32 v46, v39
  v_sin_f32 v47, v39
  v_exp_f32 v32, v32
  v_cos_f32 v40, v33
  v_sin_f32 v41, v33
  v_exp_f32 v34, v34
  v_cos_f32 v42, v35
  v_sin_f32 v43, v35
  v_exp_f32 v36, v36
  v_cos_f32 v44, v37
  v_sin_f32 v45, v37
  v_pk_mul_f32 v[46:47], v[46:47], v[38:39] op_sel_hi:[1,0]
  v_pk_mul_f32 v[40:41], v[40:41], v[32:33] op_sel_hi:[1,0]
  v_pk_mul_f32 v[42:43], v[42:43], v[34:35] op_sel_hi:[1,0]
  v_pk_mul_f32 v[44:45], v[44:45], v[36:37] op_sel_hi:[1,0]
  v_pk_mul_f32 v[32:33], v[46:47], v[14:15] op_sel_hi:[1,0] neg_hi:[1,0]
  v_cvt_pk_f16_f32 v19, v40, v41
  v_pk_fma_f32 v[32:33], v[46:47], v[14:15], v[32:33] op_sel:[1,1,0] op_sel_hi:[0,1,1] neg_lo:[1,0,0] neg_hi:[1,0,0]
  v_cvt_pk_f16_f32 v23, v42, v43
  v_cvt_pk_f16_f32 v27, v44, v45
  v_cvt_pk_f16_f32 v31, v32, v33
  v_add_u32 v3, 256, v3
  s_sub_u32 s6, s6, 1
  s_cmp_lg_u32 s6, 0
  s_cbranch_scc1 L_kg_106
  s_mov_b32 s6, 2
L_kg_107:
  s_waitcnt lgkmcnt(0)
  ds_read_b128 v[12:15], v3 offset:16
  v_mfma_f32_16x16x32_f16 v[48:51], v[16:19], v[28:31], v[48:51]
  v_pk_mul_f32 v[38:39], v[8:9], v[6:7] op_sel:[0,1] op_sel_hi:[1,1]
  v_mfma_f32_16x16x32_f16 v[52:55], v[20:23], v[28:31], v[52:55]
  v_pk_mul_f32 v[32:33], v[8:9], v[4:5] op_sel:[0,0] op_sel_hi:[1,0]
  v_mfma_f32_16x16x32_f16 v[56:59], v[24:27], v[28:31], v[56:59]
  v_pk_mul_f32 v[34:35], v[8:9], v[4:5] op_sel:[0,1] op_sel_hi:[1,1]
  v_pk_mul_f32 v[36:37], v[8:9], v[6:7] op_sel:[0,0] op_sel_hi:[1,0]
  v_fract_f32 v39, v39
  v_fract_f32 v33, v33
  v_fract_f32 v35, v35
  v_fract_f32 v37, v37
  v_exp_f32 v38, v38
  v_cos_f32 v46, v39
  v_sin_f32 v47, v39
  v_exp_f32 v32, v32
  v_cos_f32 v40, v33
  v_sin_f32 v41, v33
  v_exp_f32 v34, v34
  v_cos_f32 v42, v35
  v_sin_f32 v43, v35
  v_exp_f32 v36, v36
  v_cos_f32 v44, v37
  v_sin_f32 v45, v37
  v_pk_mul_f32 v[46:47], v[46:47], v[38:39] op_sel_hi:[1,0]
  v_pk_mul_f32 v[40:41], v[40:41], v[32:33] op_sel_hi:[1,0]
  v_pk_mul_f32 v[42:43], v[42:43], v[34:35] op_sel_hi:[1,0]
  v_pk_mul_f32 v[44:45], v[44:45], v[36:37] op_sel_hi:[1,0]
  v_pk_mul_f32 v[32:33], v[46:47], v[10:11] op_sel_hi:[1,0] neg_hi:[1,0]
  v_cvt_pk_f16_f32 v16, v40, v41
  v_pk_fma_f32 v[32:33], v[46:47], v[10:11], v[32:33] op_sel:[1,1,0] op_sel_hi:[0,1,1] neg_lo:[1,0,0] neg_hi:[1,0,0]
  v_cvt_pk_f16_f32 v20, v42, v43
  v_cvt_pk_f16_f32 v24, v44, v45
  v_cvt_pk_f16_f32 v28, v32, v33
  s_waitcnt lgkmcnt(0)
  ds_read_b128 v[8:11], v3 offset:32
  v_pk_mul_f32 v[38:39], v[12:13], v[6:7] op_sel:[0,1] op_sel_hi:[1,1]
  v_pk_mul_f32 v[32:33], v[12:13], v[4:5] op_sel:[0,0] op_sel_hi:[1,0]
  v_pk_mul_f32 v[34:35], v[12:13], v[4:5] op_sel:[0,1] op_sel_hi:[1,1]
  v_pk_mul_f32 v[36:37], v[12:13], v[6:7] op_sel:[0,0] op_sel_hi:[1,0]
  v_fract_f32 v39, v39
  v_fract_f32 v33, v33
  v_fract_f32 v35, v35
  v_fract_f32 v37, v37
  v_exp_f32 v38, v38
  v_cos_f32 v46, v39
  v_sin_f32 v47, v39
  v_exp_f32 v32, v32
  v_cos_f32 v40, v33
  v_sin_f32 v41, v33
  v_exp_f32 v34, v34
  v_cos_f32 v42, v35
  v_sin_f32 v43, v35
  v_exp_f32 v36, v36
  v_cos_f32 v44, v37
  v_sin_f32 v45, v37
  v_pk_mul_f32 v[46:47], v[46:47], v[38:39] op_sel_hi:[1,0]
  v_pk_mul_f32 v[40:41], v[40:41], v[32:33] op_sel_hi:[1,0]
  v_pk_mul_f32 v[42:43], v[42:43], v[34:35] op_sel_hi:[1,0]
  v_pk_mul_f32 v[44:45], v[44:45], v[36:37] op_sel_hi:[1,0]
  v_pk_mul_f32 v[32:33], v[46:47], v[14:15] op_sel_hi:[1,0] neg_hi:[1,0]
  v_cvt_pk_f16_f32 v17, v40, v41
  v_pk_fma_f32 v[32:33], v[46:47], v[14:15], v[32:33] op_sel:[1,1,0] op_sel_hi:[0,1,1] neg_lo:[1,0,0] neg_hi:[1,0,0]
  v_cvt_pk_f16_f32 v21, v42, v43
  v_cvt_pk_f16_f32 v25, v44, v45
  v_cvt_pk_f16_f32 v29, v32, v33
  s_waitcnt lgkmcnt(0)
  ds_read_b128 v[12:15], v3 offset:48
  v_pk_mul_f32 v[38:39], v[8:9], v[6:7] op_sel:[0,1] op_sel_hi:[1,1]
  v_pk_mul_f32 v[32:33], v[8:9], v[4:5] op_sel:[0,0] op_sel_hi:[1,0]
  v_pk_mul_f32 v[34:35], v[8:9], v[4:5] op_sel:[0,1] op_sel_hi:[1,1]
  v_pk_mul_f32 v[36:37], v[8:9], v[6:7] op_sel:[0,0] op_sel_hi:[1,0]
  v_fract_f32 v39, v39
  v_fract_f32 v33, v33
  v_fract_f32 v35, v35
  v_fract_f32 v37, v37
  v_exp_f32 v38, v38
  v_cos_f32 v46, v39
  v_sin_f32 v47, v39
  v_exp_f32 v32, v32
  v_cos_f32 v40, v33
  v_sin_f32 v41, v33
  v_exp_f32 v34, v34
  v_cos_f32 v42, v35
  v_sin_f32 v43, v35
  v_exp_f32 v36, v36
  v_cos_f32 v44, v37
  v_sin_f32 v45, v37
  v_pk_mul_f32 v[46:47], v[46:47], v[38:39] op_sel_hi:[1,0]
  v_pk_mul_f32 v[40:41], v[40:41], v[32:33] op_sel_hi:[1,0]
  v_pk_mul_f32 v[42:43], v[42:43], v[34:35] op_sel_hi:[1,0]
  v_pk_mul_f32 v[44:45], v[44:45], v[36:37] op_sel_hi:[1,0]
  v_pk_mul_f32 v[32:33], v[46:47], v[10:11] op_sel_hi:[1,0] neg_hi:[1,0]
  v_cvt_pk_f16_f32 v18, v40, v41
  v_pk_fma_f32 v[32:33], v[46:47], v[10:11], v[32:33] op_sel:[1,1,0] op_sel_hi:[0,1,1] neg_lo:[1,0,0] neg_hi:[1,0,0]
  v_cvt_pk_f16_f32 v22, v42, v43
  v_cvt_pk_f16_f32 v26, v44, v45
  v_cvt_pk_f16_f32 v30, v32, v33
  s_waitcnt lgkmcnt(0)
  ds_read_b128 v[8:11], v3 offset:256
  v_pk_mul_f32 v[38:39], v[12:13], v[6:7] op_sel:[0,1] op_sel_hi:[1,1]
  v_pk_mul_f32 v[32:33], v[12:13], v[4:5] op_sel:[0,0] op_sel_hi:[1,0]
  v_pk_mul_f32 v[34:35], v[12:13], v[4:5] op_sel:[0,1] op_sel_hi:[1,1]
  v_pk_mul_f32 v[36:37], v[12:13], v[6:7] op_sel:[0,0] op_sel_hi:[1,0]
  v_fract_f32 v39, v39
  v_fract_f32 v33, v33
  v_fract_f32 v35, v35
  v_fract_f32 v37, v37
  v_exp_f32 v38, v38
  v_cos_f32 v46, v39
  v_sin_f32 v47, v39
  v_exp_f32 v32, v32
  v_cos_f32 v40, v33
  v_sin_f32 v41, v33
  v_exp_f32 v34, v34
  v_cos_f32 v42, v35
  v_sin_f32 v43, v35
  v_exp_f32 v36, v36
  v_cos_f32 v44, v37
  v_sin_f32 v45, v37
  v_pk_mul_f32 v[46:47], v[46:47], v[38:39] op_sel_hi:[1,0]
  v_pk_mul_f32 v[40:41], v[40:41], v[32:33] op_sel_hi:[1,0]
  v_pk_mul_f32 v[42:43], v[42:43], v[34:35] op_sel_hi:[1,0]
  v_pk_mul_f32 v[44:45], v[44:45], v[36:37] op_sel_hi:[1,0]
  v_pk_mul_f32 v[32:33], v[46:47], v[14:15] op_sel_hi:[1,0] neg_hi:[1,0]
  v_cvt_pk_f16_f32 v19, v40, v41
  v_pk_fma_f32 v[32:33], v[46:47], v[14:15], v[32:33] op_sel:[1,1,0] op_sel_hi:[0,1,1] neg_lo:[1,0,0] neg_hi:[1,0,0]
  v_cvt_pk_f16_f32 v23, v42, v43
  v_cvt_pk_f16_f32 v27, v44, v45
  v_cvt_pk_f16_f32 v31, v32, v33
  v_add_u32 v3, 256, v3
  s_sub_u32 s6, s6, 1
  s_cmp_lg_u32 s6, 0
  s_cbranch_scc1 L_kg_107
  s_mov_b32 s6, 2
L_kg_108:
  s_waitcnt lgkmcnt(0)
  ds_read_b128 v[12:15], v3 offset:16
  v_mfma_f32_16x16x32_f16 v[48:51], v[16:19], v[28:31], v[48:51]
  v_pk_mul_f32 v[38:39], v[8:9], v[6:7] op_sel:[0,1] op_sel_hi:[1,1]
  v_mfma_f32_16x16x32_f16 v[52:55], v[20:23], v[28:31], v[52:55]
  v_pk_mul_f32 v[32:33], v[8:9], v[4:5] op_sel:[0,0] op_sel_hi:[1,0]
  v_mfma_f32_16x16x32_f16 v[56:59], v[24:27], v[28:31], v[56:59]
  v_pk_mul_f32 v[34:35], v[8:9], v[4:5] op_sel:[0,1] op_sel_hi:[1,1]
  v_pk_mul_f32 v[36:37], v[8:9], v[6:7] op_sel:[0,0] op_sel_hi:[1,0]
  v_fract_f32 v39, v39
  v_fract_f32 v33, v33
  v_fract_f32 v35, v35
  v_fract_f32 v37, v37
  v_exp_f32 v38, v38
  v_cos_f32 v46, v39
  v_sin_f32 v47, v39
  v_exp_f32 v32, v32
  v_cos_f32 v40, v33
  v_sin_f32 v41, v33
  v_exp_f32 v34, v34
  v_cos_f32 v42, v35
  v_sin_f32 v43, v35
  v_exp_f32 v36, v36
  v_cos_f32 v44, v37
  v_sin_f32 v45, v37
  v_pk_mul_f32 v[46:47], v[46:47], v[38:39] op_sel_hi:[1,0]
  v_pk_mul_f32 v[40:41], v[40:41], v[32:33] op_sel_hi:[1,0]
  v_pk_mul_f32 v[42:43], v[42:43], v[34:35] op_sel_hi:[1,0]
  v_pk_mul_f32 v[44:45], v[44:45], v[36:37] op_sel_hi:[1,0]
  v_pk_mul_f32 v[32:33], v[46:47], v[10:11] op_sel_hi:[1,0] neg_hi:[1,0]
  v_cvt_pk_f16_f32 v16, v40, v41
  v_pk_fma_f32 v[32:33], v[46:47], v[10:11], v[32:33] op_sel:[1,1,0] op_sel_hi:[0,1,1] neg_lo:[1,0,0] neg_hi:[1,0,0]
  v_cvt_pk_f16_f32 v20, v42, v43
  v_cvt_pk_f16_f32 v24, v44, v45
  v_cvt_pk_f16_f32 v28, v32, v33
  s_waitcnt lgkmcnt(0)
  ds_read_b128 v[8:11], v3 offset:32
  v_pk_mul_f32 v[38:39], v[12:13], v[6:7] op_sel:[0,1] op_sel_hi:[1,1]
  v_pk_mul_f32 v[32:33], v[12:13], v[4:5] op_sel:[0,0] op_sel_hi:[1,0]
  v_pk_mul_f32 v[34:35], v[12:13], v[4:5] op_sel:[0,1] op_sel_hi:[1,1]
  v_pk_mul_f32 v[36:37], v[12:13], v[6:7] op_sel:[0,0] op_sel_hi:[1,0]
  v_fract_f32 v39, v39
  v_fract_f32 v33, v33
  v_fract_f32 v35, v35
  v_fract_f32 v37, v37
  v_exp_f32 v38, v38
  v_cos_f32 v46, v39
  v_sin_f32 v47, v39
  v_exp_f32 v32, v32
  v_cos_f32 v40, v33
  v_sin_f32 v41, v33
  v_exp_f32 v34, v34
  v_cos_f32 v42, v35
  v_sin_f32 v43, v35
  v_exp_f32 v36, v36
  v_cos_f32 v44, v37
  v_sin_f32 v45, v37
  v_pk_mul_f32 v[46:47], v[46:47], v[38:39] op_sel_hi:[1,0]
  v_pk_mul_f32 v[40:41], v[40:41], v[32:33] op_sel_hi:[1,0]
  v_pk_mul_f32 v[42:43], v[42:43], v[34:35] op_sel_hi:[1,0]
  v_pk_mul_f32 v[44:45], v[44:45], v[36:37] op_sel_hi:[1,0]
  v_pk_mul_f32 v[32:33], v[46:47], v[14:15] op_sel_hi:[1,0] neg_hi:[1,0]
  v_cvt_pk_f16_f32 v17, v40, v41
  v_pk_fma_f32 v[32:33], v[46:47], v[14:15], v[32:33] op_sel:[1,1,0] op_sel_hi:[0,1,1] neg_lo:[1,0,0] neg_hi:[1,0,0]
  v_cvt_pk_f16_f32 v21, v42, v43
  v_cvt_pk_f16_f32 v25, v44, v45
  v_cvt_pk_f16_f32 v29, v32, v33
  s_waitcnt lgkmcnt(0)
  ds_read_b128 v[12:15], v3 offset:48
  v_pk_mul_f32 v[38:39], v[8:9], v[6:7] op_sel:[0,1] op_sel_hi:[1,1]
  v_pk_mul_f32 v[32:33], v[8:9], v[4:5] op_sel:[0,0] op_sel_hi:[1,0]
  v_pk_mul_f32 v[34:35], v[8:9], v[4:5] op_sel:[0,1] op_sel_hi:[1,1]
  v_pk_mul_f32 v[36:37], v[8:9], v[6:7] op_sel:[0,0] op_sel_hi:[1,0]
  v_fract_f32 v39, v39
  v_fract_f32 v33, v33
  v_fract_f32 v35, v35
  v_fract_f32 v37, v37
  v_exp_f32 v38, v38
  v_cos_f32 v46, v39
  v_sin_f32 v47, v39
  v_exp_f32 v32, v32
  v_cos_f32 v40, v33
  v_sin_f32 v41, v33
  v_exp_f32 v34, v34
  v_cos_f32 v42, v35
  v_sin_f32 v43, v35
  v_exp_f32 v36, v36
  v_cos_f32 v44, v37
  v_sin_f32 v45, v37
  v_pk_mul_f32 v[46:47], v[46:47], v[38:39] op_sel_hi:[1,0]
  v_pk_mul_f32 v[40:41], v[40:41], v[32:33] op_sel_hi:[1,0]
  v_pk_mul_f32 v[42:43], v[42:43], v[34:35] op_sel_hi:[1,0]
  v_pk_mul_f32 v[44:45], v[44:45], v[36:37] op_sel_hi:[1,0]
  v_pk_mul_f32 v[32:33], v[46:47], v[10:11] op_sel_hi:[1,0] neg_hi:[1,0]
  v_cvt_pk_f16_f32 v18, v40, v41
  v_pk_fma_f32 v[32:33], v[46:47], v[10:11], v[32:33] op_sel:[1,1,0] op_sel_hi:[0,1,1] neg_lo:[1,0,0] neg_hi:[1,0,0]
  v_cvt_pk_f16_f32 v22, v42, v43
  v_cvt_pk_f16_f32 v26, v44, v45
  v_cvt_pk_f16_f32 v30, v32, v33
  s_waitcnt lgkmcnt(0)
  ds_read_b128 v[8:11], v3 offset:256
  v_pk_mul_f32 v[38:39], v[12:13], v[6:7] op_sel:[0,1] op_sel_hi:[1,1]
  v_pk_mul_f32 v[32:33], v[12:13], v[4:5] op_sel:[0,0] op_sel_hi:[1,0]
  v_pk_mul_f32 v[34:35], v[12:13], v[4:5] op_sel:[0,1] op_sel_hi:[1,1]
  v_pk_mul_f32 v[36:37], v[12:13], v[6:7] op_sel:[0,0] op_sel_hi:[1,0]
  v_fract_f32 v39, v39
  v_fract_f32 v33, v33
  v_fract_f32 v35, v35
  v_fract_f32 v37, v37
  v_exp_f32 v38, v38
  v_cos_f32 v46, v39
  v_sin_f32 v47, v39
  v_exp_f32 v32, v32
  v_cos_f32 v40, v33
  v_sin_f32 v41, v33
  v_exp_f32 v34, v34
  v_cos_f32 v42, v35
  v_sin_f32 v43, v35
  v_exp_f32 v36, v36
  v_cos_f32 v44, v37
  v_sin_f32 v45, v37
  v_pk_mul_f32 v[46:47], v[46:47], v[38:39] op_sel_hi:[1,0]
  v_pk_mul_f32 v[40:41], v[40:41], v[32:33] op_sel_hi:[1,0]
  v_pk_mul_f32 v[42:43], v[42:43], v[34:35] op_sel_hi:[1,0]
  v_pk_mul_f32 v[44:45], v[44:45], v[36:37] op_sel_hi:[1,0]
  v_pk_mul_f32 v[32:33], v[46:47], v[14:15] op_sel_hi:[1,0] neg_hi:[1,0]
  v_cvt_pk_f16_f32 v19, v40, v41
  v_pk_fma_f32 v[32:33], v[46:47], v[14:15], v[32:33] op_sel:[1,1,0] op_sel_hi:[0,1,1] neg_lo:[1,0,0] neg_hi:[1,0,0]
  v_cvt_pk_f16_f32 v23, v42, v43
  v_cvt_pk_f16_f32 v27, v44, v45
  v_cvt_pk_f16_f32 v31, v32, v33
  v_add_u32 v3, 256, v3
  s_sub_u32 s6, s6, 1
  s_cmp_lg_u32 s6, 0
  s_cbranch_scc1 L_kg_108
  s_cmp_lg_u32 s3, 0
  s_cbranch_scc1 L_wdo_110
  s_mov_b32 s7, 0
  v_mbcnt_lo_u32_b32 v216, -1, 0
  v_and_b32 v216, 3, v216
  v_lshlrev_b32 v216, 6, v216
L_wd_109:
  buffer_load_dword v217, v216, s[12:15], 0 offen offset:16 sc1
  s_waitcnt vmcnt(0)
  v_cmp_ne_u32 vcc, 64, v217
  s_cbranch_vccz L_wdo_110
  s_add_u32 s7, s7, 1
  s_cmp_lt_u32 s7, 131072
  s_cbranch_scc1 L_wd_109
  s_mov_b32 s6, 50
  s_branch L_err
L_wdo_110:
  s_barrier
  s_lshl_b32 s6, s3, 13
  s_add_u32 s6, s6, s62
  s_add_u32 s6, s6, 0xb000000
  s_lshl_b32 s7, s3, 10
  v_lshlrev_b32 v216, 7, v0
  s_add_u32 m0, s7, 44064
  s_nop 0
  buffer_load_dwordx4 v216, s[8:11], s6 offen lds
  s_add_u32 s6, s6, 16
  s_add_u32 m0, s7, 48192
  s_nop 0
  buffer_load_dwordx4 v216, s[8:11], s6 offen lds
  s_add_u32 s6, s6, 16
  s_add_u32 m0, s7, 52320
  s_nop 0
  buffer_load_dwordx4 v216, s[8:11], s6 offen lds
  s_add_u32 s6, s6, 16
  s_add_u32 m0, s7, 56448
  s_nop 0
  buffer_load_dwordx4 v216, s[8:11], s6 offen lds
  s_add_u32 s6, s6, 16
  s_add_u32 m0, s7, 60544
  s_nop 0
  buffer_load_dwordx4 v216, s[8:11], s6 offen lds
  s_add_u32 s6, s6, 16
  s_add_u32 m0, s7, 64640
  s_nop 0
  buffer_load_dwordx4 v216, s[8:11], s6 offen lds
  s_add_u32 s6, s6, 16
  s_add_u32 m0, s7, 68736
  s_nop 0
  buffer_load_dwordx4 v216, s[8:11], s6 offen lds
  s_add_u32 s6, s6, 16
  s_add_u32 m0, s7, 72832
  s_nop 0
  buffer_load_dwordx4 v216, s[8:11], s6 offen lds
  s_add_u32 s6, s6, 16
  s_mov_b32 s6, 2
L_kg_111:
  s_waitcnt lgkmcnt(0)
  ds_read_b128 v[12:15], v3 offset:16
  v_mfma_f32_16x16x32_f16 v[48:51], v[16:19], v[28:31], v[48:51]
  v_pk_mul_f32 v[38:39], v[8:9], v[6:7] op_sel:[0,1] op_sel_hi:[1,1]
  v_mfma_f32_16x16x32_f16 v[52:55], v[20:23], v[28:31], v[52:55]
  v_pk_mul_f32 v[32:33], v[8:9], v[4:5] op_sel:[0,0] op_sel_hi:[1,0]
  v_mfma_f32_16x16x32_f16 v[56:59], v[24:27], v[28:31], v[56:59]
  v_pk_mul_f32 v[34:35], v[8:9], v[4:5] op_sel:[0,1] op_sel_hi:[1,1]
  v_pk_mul_f32 v[36:37], v[8:9], v[6:7] op_sel:[0,0] op_sel_hi:[1,0]
  v_fract_f32 v39, v39
  v_fract_f32 v33, v33
  v_fract_f32 v35, v35
  v_fract_f32 v37, v37
  v_exp_f32 v38, v38
  v_cos_f32 v46, v39
  v_sin_f32 v47, v39
  v_exp_f32 v32, v32
  v_cos_f32 v40, v33
  v_sin_f32 v41, v33
  v_exp_f32 v34, v34
  v_cos_f32 v42, v35
  v_sin_f32 v43, v35
  v_exp_f32 v36, v36
  v_cos_f32 v44, v37
  v_sin_f32 v45, v37
  v_pk_mul_f32 v[46:47], v[46:47], v[38:39] op_sel_hi:[1,0]
  v_pk_mul_f32 v[40:41], v[40:41], v[32:33] op_sel_hi:[1,0]
  v_pk_mul_f32 v[42:43], v[42:43], v[34:35] op_sel_hi:[1,0]
  v_pk_mul_f32 v[44:45], v[44:45], v[36:37] op_sel_hi:[1,0]
  v_pk_mul_f32 v[32:33], v[46:47], v[10:11] op_sel_hi:[1,0] neg_hi:[1,0]
  v_cvt_pk_f16_f32 v16, v40, v41
  v_pk_fma_f32 v[32:33], v[46:47], v[10:11], v[32:33] op_sel:[1,1,0] op_sel_hi:[0,1,1] neg_lo:[1,0,0] neg_hi:[1,0,0]
  v_cvt_pk_f16_f32 v20, v42, v43
  v_cvt_pk_f16_f32 v24, v44, v45
  v_cvt_pk_f16_f32 v28, v32, v33
  s_waitcnt lgkmcnt(0)
  ds_read_b128 v[8:11], v3 offset:32
  v_pk_mul_f32 v[38:39], v[12:13], v[6:7] op_sel:[0,1] op_sel_hi:[1,1]
  v_pk_mul_f32 v[32:33], v[12:13], v[4:5] op_sel:[0,0] op_sel_hi:[1,0]
  v_pk_mul_f32 v[34:35], v[12:13], v[4:5] op_sel:[0,1] op_sel_hi:[1,1]
  v_pk_mul_f32 v[36:37], v[12:13], v[6:7] op_sel:[0,0] op_sel_hi:[1,0]
  v_fract_f32 v39, v39
  v_fract_f32 v33, v33
  v_fract_f32 v35, v35
  v_fract_f32 v37, v37
  v_exp_f32 v38, v38
  v_cos_f32 v46, v39
  v_sin_f32 v47, v39
  v_exp_f32 v32, v32
  v_cos_f32 v40, v33
  v_sin_f32 v41, v33
  v_exp_f32 v34, v34
  v_cos_f32 v42, v35
  v_sin_f32 v43, v35
  v_exp_f32 v36, v36
  v_cos_f32 v44, v37
  v_sin_f32 v45, v37
  v_pk_mul_f32 v[46:47], v[46:47], v[38:39] op_sel_hi:[1,0]
  v_pk_mul_f32 v[40:41], v[40:41], v[32:33] op_sel_hi:[1,0]
  v_pk_mul_f32 v[42:43], v[42:43], v[34:35] op_sel_hi:[1,0]
  v_pk_mul_f32 v[44:45], v[44:45], v[36:37] op_sel_hi:[1,0]
  v_pk_mul_f32 v[32:33], v[46:47], v[14:15] op_sel_hi:[1,0] neg_hi:[1,0]
  v_cvt_pk_f16_f32 v17, v40, v41
  v_pk_fma_f32 v[32:33], v[46:47], v[14:15], v[32:33] op_sel:[1,1,0] op_sel_hi:[0,1,1] neg_lo:[1,0,0] neg_hi:[1,0,0]
  v_cvt_pk_f16_f32 v21, v42, v43
  v_cvt_pk_f16_f32 v25, v44, v45
  v_cvt_pk_f16_f32 v29, v32, v33
  s_waitcnt lgkmcnt(0)
  ds_read_b128 v[12:15], v3 offset:48
  v_pk_mul_f32 v[38:39], v[8:9], v[6:7] op_sel:[0,1] op_sel_hi:[1,1]
  v_pk_mul_f32 v[32:33], v[8:9], v[4:5] op_sel:[0,0] op_sel_hi:[1,0]
  v_pk_mul_f32 v[34:35], v[8:9], v[4:5] op_sel:[0,1] op_sel_hi:[1,1]
  v_pk_mul_f32 v[36:37], v[8:9], v[6:7] op_sel:[0,0] op_sel_hi:[1,0]
  v_fract_f32 v39, v39
  v_fract_f32 v33, v33
  v_fract_f32 v35, v35
  v_fract_f32 v37, v37
  v_exp_f32 v38, v38
  v_cos_f32 v46, v39
  v_sin_f32 v47, v39
  v_exp_f32 v32, v32
  v_cos_f32 v40, v33
  v_sin_f32 v41, v33
  v_exp_f32 v34, v34
  v_cos_f32 v42, v35
  v_sin_f32 v43, v35
  v_exp_f32 v36, v36
  v_cos_f32 v44, v37
  v_sin_f32 v45, v37
  v_pk_mul_f32 v[46:47], v[46:47], v[38:39] op_sel_hi:[1,0]
  v_pk_mul_f32 v[40:41], v[40:41], v[32:33] op_sel_hi:[1,0]
  v_pk_mul_f32 v[42:43], v[42:43], v[34:35] op_sel_hi:[1,0]
  v_pk_mul_f32 v[44:45], v[44:45], v[36:37] op_sel_hi:[1,0]
  v_pk_mul_f32 v[32:33], v[46:47], v[10:11] op_sel_hi:[1,0] neg_hi:[1,0]
  v_cvt_pk_f16_f32 v18, v40, v41
  v_pk_fma_f32 v[32:33], v[46:47], v[10:11], v[32:33] op_sel:[1,1,0] op_sel_hi:[0,1,1] neg_lo:[1,0,0] neg_hi:[1,0,0]
  v_cvt_pk_f16_f32 v22, v42, v43
  v_cvt_pk_f16_f32 v26, v44, v45
  v_cvt_pk_f16_f32 v30, v32, v33
  s_waitcnt lgkmcnt(0)
  ds_read_b128 v[8:11], v3 offset:256
  v_pk_mul_f32 v[38:39], v[12:13], v[6:7] op_sel:[0,1] op_sel_hi:[1,1]
  v_pk_mul_f32 v[32:33], v[12:13], v[4:5] op_sel:[0,0] op_sel_hi:[1,0]
  v_pk_mul_f32 v[34:35], v[12:13], v[4:5] op_sel:[0,1] op_sel_hi:[1,1]
  v_pk_mul_f32 v[36:37], v[12:13], v[6:7] op_sel:[0,0] op_sel_hi:[1,0]
  v_fract_f32 v39, v39
  v_fract_f32 v33, v33
  v_fract_f32 v35, v35
  v_fract_f32 v37, v37
  v_exp_f32 v38, v38
  v_cos_f32 v46, v39
  v_sin_f32 v47, v39
  v_exp_f32 v32, v32
  v_cos_f32 v40, v33
  v_sin_f32 v41, v33
  v_exp_f32 v34, v34
  v_cos_f32 v42, v35
  v_sin_f32 v43, v35
  v_exp_f32 v36, v36
  v_cos_f32 v44, v37
  v_sin_f32 v45, v37
  v_pk_mul_f32 v[46:47], v[46:47], v[38:39] op_sel_hi:[1,0]
  v_pk_mul_f32 v[40:41], v[40:41], v[32:33] op_sel_hi:[1,0]
  v_pk_mul_f32 v[42:43], v[42:43], v[34:35] op_sel_hi:[1,0]
  v_pk_mul_f32 v[44:45], v[44:45], v[36:37] op_sel_hi:[1,0]
  v_pk_mul_f32 v[32:33], v[46:47], v[14:15] op_sel_hi:[1,0] neg_hi:[1,0]
  v_cvt_pk_f16_f32 v19, v40, v41
  v_pk_fma_f32 v[32:33], v[46:47], v[14:15], v[32:33] op_sel:[1,1,0] op_sel_hi:[0,1,1] neg_lo:[1,0,0] neg_hi:[1,0,0]
  v_cvt_pk_f16_f32 v23, v42, v43
  v_cvt_pk_f16_f32 v27, v44, v45
  v_cvt_pk_f16_f32 v31, v32, v33
  v_add_u32 v3, 256, v3
  s_sub_u32 s6, s6, 1
  s_cmp_lg_u32 s6, 0
  s_cbranch_scc1 L_kg_111
  v_mfma_f32_16x16x32_f16 v[48:51], v[16:19], v[28:31], v[48:51]
  v_mfma_f32_16x16x32_f16 v[52:55], v[20:23], v[28:31], v[52:55]
  v_mfma_f32_16x16x32_f16 v[56:59], v[24:27], v[28:31], v[56:59]
  s_waitcnt lgkmcnt(0)
  s_nop 4
  v_mul_f32 v48, v48, v233
  v_mul_f32 v49, v49, v233
  v_mul_f32 v50, v50, v233
  v_mul_f32 v51, v51, v233
  v_mul_f32 v52, v52, v233
  v_mul_f32 v53, v53, v233
  v_mul_f32 v54, v54, v233
  v_mul_f32 v55, v55, v233
  v_mul_f32 v56, v56, v233
  v_mul_f32 v57, v57, v233
  v_mul_f32 v58, v58, v233
  v_mul_f32 v59, v59, v233
  v_readlane_b32 s61, v52, 32
  v_lshrrev_b32 v16, 4, v0
  v_and_b32 v17, 15, v0
  v_lshlrev_b32 v17, 4, v17
  v_add_u32 v17, s63, v17
  v_lshrrev_b32 v18, 1, v16
  v_and_b32 v19, 1, v16
  v_lshlrev_b32 v20, 8, v18
  v_lshl_add_u32 v20, v19, 3, v20
  v_add3_u32 v20, v20, v17, 2
  v_lshlrev_b32 v21, 8, v19
  v_add_u32 v21, 516, v21
  v_cmp_eq_u32 vcc, 0, v18
  s_nop 1
  v_cndmask_b32 v21, 0, v21, vcc
  v_cndmask_b32 v22, 0, 4, vcc
  v_add_u32 v21, v21, v17
  v_lshlrev_b32 v23, 9, v19
  v_add_u32 v23, 1032, v23
  v_lshlrev_b32 v24, 10, v19
  v_add_u32 v24, 2064, v24
  v_cndmask_b32 v23, v24, v23, vcc
  v_add_u32 v23, v23, v17
  v_mov_b32 v24, 0x100
  v_cndmask_b32 v24, v24, 8, vcc
  v_mov_b32 v25, 0x200
  v_cndmask_b32 v25, v25, v24, vcc
  v_mov_b32 v26, 0x100
  v_cndmask_b32 v25, v25, v26, vcc
  v_cvt_pk_bf16_f32 v32, v48, v49
  v_cvt_pk_bf16_f32 v33, v50, v51
  v_cvt_pk_bf16_f32 v34, v52, v53
  v_cvt_pk_bf16_f32 v35, v54, v55
  v_cvt_pk_bf16_f32 v36, v56, v57
  v_cvt_pk_bf16_f32 v37, v58, v59
  ds_write_b16 v21, v34
  v_add_u32 v21, v21, v22
  ds_write_b16_d16_hi v21, v34
  v_add_u32 v21, v21, v22
  ds_write_b16 v21, v35
  v_add_u32 v21, v21, v22
  ds_write_b16_d16_hi v21, v35
  ds_write_b16 v20, v32 offset:0
  ds_write_b16_d16_hi v20, v32 offset:2
  ds_write_b16 v20, v33 offset:4
  ds_write_b16_d16_hi v20, v33 offset:6
  ds_write_b16 v23, v36
  v_add_u32 v26, v23, v24
  v_add_u32 v23, v23, v25
  ds_write_b16_d16_hi v26, v36
  ds_write_b16 v23, v37
  v_add_u32 v23, v23, v24
  ds_write_b16_d16_hi v23, v37
  ds_read_u16 v160, v160
  ds_read_u16 v161, v161
  ds_read_u16 v162, v162
  ds_read_u16 v163, v163
  ds_read_u16 v164, v164
  ds_read_u16 v165, v165
  ds_read_u16 v166, v166
  ds_read_u16 v167, v167
  ds_read_u16 v168, v168
  ds_read_u16 v169, v169
  ds_read_u16 v170, v170
  ds_read_u16 v171, v171
  ds_read_u16 v172, v172
  ds_read_u16 v173, v173
  ds_read_u16 v174, v174
  ds_read_u16 v175, v175
  ds_read_u16 v176, v176
  ds_read_u16 v177, v177
  ds_read_u16 v178, v178
  ds_read_u16 v179, v179
  ds_read_u16 v180, v180
  ds_read_u16 v181, v181
  ds_read_u16 v182, v182
  ds_read_u16 v183, v183
  ds_read_u16 v184, v184
  ds_read_u16 v185, v185
  ds_read_u16 v186, v186
  ds_read_u16 v187, v187
  ds_read_u16 v188, v188
  ds_read_u16 v189, v189
  ds_read_u16 v190, v190
  ds_read_u16 v191, v191
  s_mul_i32 s6, s3, 4608
  s_add_u32 s6, s6, 25600
  v_add_u32 v16, s6, v2
  s_mul_i32 s7, s60, 4608
  s_add_u32 s7, s7, 0x400000
  v_mov_b32 v21, 0
  v_mov_b32 v22, 0
  v_mov_b32 v23, 0
  v_mov_b32 v20, s61
  v_cmp_eq_u32 vcc, 30, v0
  s_nop 1
  v_cndmask_b32 v20, 0, v20, vcc
  s_mul_i32 s62, s3, 4128
  s_add_u32 s62, s62, 44032
  v_and_b32 v24, 16, v2
  v_add_u32 v24, s62, v24
  v_mov_b32 v28, 0
  v_mov_b32 v29, 0
  v_mov_b32 v30, 0
  v_mov_b32 v31, 0
  s_waitcnt lgkmcnt(15)
  v_lshl_or_b32 v160, v161, 16, v160
  v_lshl_or_b32 v161, v163, 16, v162
  v_lshl_or_b32 v162, v165, 16, v164
  v_lshl_or_b32 v163, v167, 16, v166
  ds_write_b128 v16, v[160:163] offset:0
  buffer_store_dwordx4 v[160:163], v2, s[8:11], s7 offen offset:0 sc1
  s_waitcnt lgkmcnt(15)
  s_waitcnt lgkmcnt(15)
  v_lshl_or_b32 v168, v169, 16, v168
  v_lshl_or_b32 v169, v171, 16, v170
  v_lshl_or_b32 v170, v173, 16, v172
  v_lshl_or_b32 v171, v175, 16, v174
  ds_write_b128 v16, v[168:171] offset:1024
  buffer_store_dwordx4 v[168:171], v2, s[8:11], s7 offen offset:1024 sc1
  s_waitcnt lgkmcnt(10)
  v_lshl_or_b32 v176, v177, 16, v176
  v_lshl_or_b32 v177, v179, 16, v178
  v_lshl_or_b32 v178, v181, 16, v180
  v_lshl_or_b32 v179, v183, 16, v182
  ds_write_b128 v16, v[176:179] offset:2048
  buffer_store_dwordx4 v[176:179], v2, s[8:11], s7 offen offset:2048 sc1
  s_waitcnt lgkmcnt(3)
  v_lshl_or_b32 v184, v185, 16, v184
  v_lshl_or_b32 v185, v187, 16, v186
  v_lshl_or_b32 v186, v189, 16, v188
  v_lshl_or_b32 v187, v191, 16, v190
  ds_write_b128 v16, v[184:187] offset:3072
  buffer_store_dwordx4 v[184:187], v2, s[8:11], s7 offen offset:3072 sc1
  s_add_u32 s7, s7, 4096
  ds_write_b128 v24, v[28:31]
  s_mov_b32 exec_hi, 0
  ds_write_b128 v16, v[20:23] offset:4096
  buffer_store_dwordx4 v[20:23], v2, s[8:11], s7 offen sc1
  s_mov_b32 exec_hi, -1
  v_and_b32 v16, 15, v0
  v_lshrrev_b32 v17, 4, v0
  v_lshlrev_b32 v18, 5, v16
  s_add_u32 s6, s6, 480
  v_sub_u32 v18, s6, v18
  v_lshl_add_u32 v4, v17, 4, v18
  v_lshlrev_b32 v18, 1, v16
  v_lshl_add_u32 v18, v17, 4, v18
  v_and_b32 v6, 2, v18
  v_and_b32 v18, -4, v18
  v_add_u32 v5, s62, v18
  v_lshlrev_b32 v18, 5, v16
  v_lshl_add_u32 v18, v17, 3, v18
  v_add3_u32 v7, v18, s62, 32
  s_lshl_b32 s7, s3, 12
  s_add_u32 s7, s7, 60544
  v_add_u32 v8, s7, v18
  v_lshrrev_b32 v18, 1, v16
  v_lshlrev_b32 v18, 15, v18
  v_and_b32 v19, 1, v16
  v_lshl_or_b32 v18, v19, 5, v18
  v_lshl_or_b32 v9, v17, 3, v18
  v_lshlrev_b32 v31, 16, v232
  v_add_u32 v60, 1024, v5
  v_add_u32 v61, 2048, v5
  v_add_u32 v62, 3072, v5
  s_lshl_b32 s62, s60, 6
  s_add_u32 s62, s62, 0x0
  s_waitcnt vmcnt(5) lgkmcnt(0)
  s_barrier
  ds_read_b128 a[32:35], v4 offset:4032
  ds_read_b128 a[36:39], v4 offset:3968
  ds_read_b128 a[40:43], v4 offset:3904
  ds_read2_b32 v[10:11], v62 offset0:240 offset1:241
  ds_read2_b32 v[12:13], v62 offset0:242 offset1:243
  ds_read_b32 v14, v62 offset:976
  ds_read2_b32 v[16:17], v62 offset0:112 offset1:113
  ds_read2_b32 v[18:19], v62 offset0:114 offset1:115
  ds_read_b32 v20, v62 offset:464
  ds_read2_b32 v[32:33], v61 offset0:240 offset1:241
  ds_read2_b32 v[34:35], v61 offset0:242 offset1:243
  ds_read_b32 v36, v61 offset:976
  ds_read2_b32 v[38:39], v61 offset0:112 offset1:113
  ds_read2_b32 v[40:41], v61 offset0:114 offset1:115
  ds_read_b32 v42, v61 offset:464
  ds_read2_b32 v[44:45], v60 offset0:240 offset1:241
  ds_read2_b32 v[46:47], v60 offset0:242 offset1:243
  ds_read_b32 v48, v60 offset:976
  s_waitcnt lgkmcnt(12)
  v_alignbyte_b32 v26, v11, v10, v6
  v_alignbyte_b32 v27, v12, v11, v6
  v_alignbyte_b32 v28, v13, v12, v6
  v_alignbyte_b32 v29, v14, v13, v6
  s_waitcnt lgkmcnt(9)
  v_alignbyte_b32 v56, v17, v16, v6
  v_alignbyte_b32 v57, v18, v17, v6
  v_alignbyte_b32 v58, v19, v18, v6
  v_alignbyte_b32 v59, v20, v19, v6
  v_accvgpr_write_b32 a92, v56
  v_accvgpr_write_b32 a93, v57
  v_accvgpr_write_b32 a94, v58
  v_accvgpr_write_b32 a95, v59
  v_mfma_f32_16x16x32_bf16 a[28:31], v[26:29], a[32:35], 0
  ds_read2_b32 v[10:11], v60 offset0:112 offset1:113
  ds_read2_b32 v[12:13], v60 offset0:114 offset1:115
  ds_read_b32 v14, v60 offset:464
  ds_read_b128 a[44:47], v4 offset:3840
  s_waitcnt lgkmcnt(10)
  v_alignbyte_b32 v252, v33, v32, v6
  v_alignbyte_b32 v253, v34, v33, v6
  v_alignbyte_b32 v254, v35, v34, v6
  v_alignbyte_b32 v255, v36, v35, v6
  v_mfma_f32_16x16x32_bf16 a[24:27], a[92:95], a[32:35], 0
  ds_read2_b32 v[16:17], v5 offset0:240 offset1:241
  ds_read2_b32 v[18:19], v5 offset0:242 offset1:243
  ds_read_b32 v20, v5 offset:976
  s_waitcnt lgkmcnt(10)
  v_alignbyte_b32 v220, v39, v38, v6
  v_alignbyte_b32 v221, v40, v39, v6
  v_alignbyte_b32 v222, v41, v40, v6
  v_alignbyte_b32 v223, v42, v41, v6
  v_mfma_f32_16x16x32_bf16 a[20:23], v[252:255], a[32:35], 0
  ds_read2_b32 v[32:33], v5 offset0:112 offset1:113
  ds_read2_b32 v[34:35], v5 offset0:114 offset1:115
  ds_read_b32 v36, v5 offset:464
  s_waitcnt lgkmcnt(10)
  v_alignbyte_b32 v188, v45, v44, v6
  v_alignbyte_b32 v189, v46, v45, v6
  v_alignbyte_b32 v190, v47, v46, v6
  v_alignbyte_b32 v191, v48, v47, v6
  v_mfma_f32_16x16x32_bf16 a[16:19], v[220:223], a[32:35], 0
  ds_read2_b32 v[38:39], v62 offset0:224 offset1:225
  ds_read2_b32 v[40:41], v62 offset0:226 offset1:227
  ds_read_b32 v42, v62 offset:912
  s_waitcnt lgkmcnt(10)
  v_alignbyte_b32 v156, v11, v10, v6
  v_alignbyte_b32 v157, v12, v11, v6
  v_alignbyte_b32 v158, v13, v12, v6
  v_alignbyte_b32 v159, v14, v13, v6
  v_mfma_f32_16x16x32_bf16 a[12:15], v[188:191], a[32:35], 0
  ds_read2_b32 v[44:45], v62 offset0:96 offset1:97
  ds_read2_b32 v[46:47], v62 offset0:98 offset1:99
  ds_read_b32 v48, v62 offset:400
  s_waitcnt lgkmcnt(9)
  v_alignbyte_b32 v124, v17, v16, v6
  v_alignbyte_b32 v125, v18, v17, v6
  v_alignbyte_b32 v126, v19, v18, v6
  v_alignbyte_b32 v127, v20, v19, v6
  v_mfma_f32_16x16x32_bf16 a[8:11], v[156:159], a[32:35], 0
  ds_read2_b32 v[10:11], v61 offset0:224 offset1:225
  ds_read2_b32 v[12:13], v61 offset0:226 offset1:227
  ds_read_b32 v14, v61 offset:912
  s_waitcnt lgkmcnt(9)
  v_alignbyte_b32 v92, v33, v32, v6
  v_alignbyte_b32 v93, v34, v33, v6
  v_alignbyte_b32 v94, v35, v34, v6
  v_alignbyte_b32 v95, v36, v35, v6
  v_mfma_f32_16x16x32_bf16 a[4:7], v[124:127], a[32:35], 0
  ds_read2_b32 v[16:17], v61 offset0:96 offset1:97
  ds_read2_b32 v[18:19], v61 offset0:98 offset1:99
  ds_read_b32 v20, v61 offset:400
  s_waitcnt lgkmcnt(9)
  v_alignbyte_b32 v22, v39, v38, v6
  v_alignbyte_b32 v23, v40, v39, v6
  v_alignbyte_b32 v24, v41, v40, v6
  v_alignbyte_b32 v25, v42, v41, v6
  v_mfma_f32_16x16x32_bf16 a[0:3], v[92:95], a[32:35], 0
  ds_read2_b32 v[32:33], v60 offset0:224 offset1:225
  ds_read2_b32 v[34:35], v60 offset0:226 offset1:227
  ds_read_b32 v36, v60 offset:912
  s_waitcnt lgkmcnt(9)
  v_alignbyte_b32 v56, v45, v44, v6
  v_alignbyte_b32 v57, v46, v45, v6
  v_alignbyte_b32 v58, v47, v46, v6
  v_alignbyte_b32 v59, v48, v47, v6
  v_accvgpr_write_b32 a88, v56
  v_accvgpr_write_b32 a89, v57
  v_accvgpr_write_b32 a90, v58
  v_accvgpr_write_b32 a91, v59
  v_mfma_f32_16x16x32_bf16 a[28:31], v[22:25], a[36:39], a[28:31]
  ds_read2_b32 v[38:39], v60 offset0:96 offset1:97
  ds_read2_b32 v[40:41], v60 offset0:98 offset1:99
  ds_read_b32 v42, v60 offset:400
  ds_read_b128 a[32:35], v4 offset:3776
  s_waitcnt lgkmcnt(10)
  v_alignbyte_b32 v248, v11, v10, v6
  v_alignbyte_b32 v249, v12, v11, v6
  v_alignbyte_b32 v250, v13, v12, v6
  v_alignbyte_b32 v251, v14, v13, v6
  v_mfma_f32_16x16x32_bf16 a[24:27], a[88:91], a[36:39], a[24:27]
  ds_read2_b32 v[44:45], v5 offset0:224 offset1:225
  ds_read2_b32 v[46:47], v5 offset0:226 offset1:227
  ds_read_b32 v48, v5 offset:912
  s_waitcnt lgkmcnt(10)
  v_alignbyte_b32 v216, v17, v16, v6
  v_alignbyte_b32 v217, v18, v17, v6
  v_alignbyte_b32 v218, v19, v18, v6
  v_alignbyte_b32 v219, v20, v19, v6
  v_mfma_f32_16x16x32_bf16 a[20:23], v[248:251], a[36:39], a[20:23]
  ds_read2_b32 v[10:11], v5 offset0:96 offset1:97
  ds_read2_b32 v[12:13], v5 offset0:98 offset1:99
  ds_read_b32 v14, v5 offset:400
  s_waitcnt lgkmcnt(10)
  v_alignbyte_b32 v184, v33, v32, v6
  v_alignbyte_b32 v185, v34, v33, v6
  v_alignbyte_b32 v186, v35, v34, v6
  v_alignbyte_b32 v187, v36, v35, v6
  v_mfma_f32_16x16x32_bf16 a[16:19], v[216:219], a[36:39], a[16:19]
  ds_read2_b32 v[16:17], v62 offset0:208 offset1:209
  ds_read2_b32 v[18:19], v62 offset0:210 offset1:211
  ds_read_b32 v20, v62 offset:848
  s_waitcnt lgkmcnt(10)
  v_alignbyte_b32 v152, v39, v38, v6
  v_alignbyte_b32 v153, v40, v39, v6
  v_alignbyte_b32 v154, v41, v40, v6
  v_alignbyte_b32 v155, v42, v41, v6
  v_mfma_f32_16x16x32_bf16 a[12:15], v[184:187], a[36:39], a[12:15]
  ds_read2_b32 v[32:33], v62 offset0:80 offset1:81
  ds_read2_b32 v[34:35], v62 offset0:82 offset1:83
  ds_read_b32 v36, v62 offset:336
  s_waitcnt lgkmcnt(9)
  v_alignbyte_b32 v120, v45, v44, v6
  v_alignbyte_b32 v121, v46, v45, v6
  v_alignbyte_b32 v122, v47, v46, v6
  v_alignbyte_b32 v123, v48, v47, v6
  v_mfma_f32_16x16x32_bf16 a[8:11], v[152:155], a[36:39], a[8:11]
  ds_read2_b32 v[38:39], v61 offset0:208 offset1:209
  ds_read2_b32 v[40:41], v61 offset0:210 offset1:211
  ds_read_b32 v42, v61 offset:848
  s_waitcnt lgkmcnt(9)
  v_alignbyte_b32 v88, v11, v10, v6
  v_alignbyte_b32 v89, v12, v11, v6
  v_alignbyte_b32 v90, v13, v12, v6
  v_alignbyte_b32 v91, v14, v13, v6
  v_mfma_f32_16x16x32_bf16 a[4:7], v[120:123], a[36:39], a[4:7]
  ds_read2_b32 v[44:45], v61 offset0:80 offset1:81
  ds_read2_b32 v[46:47], v61 offset0:82 offset1:83
  ds_read_b32 v48, v61 offset:336
  s_waitcnt lgkmcnt(9)
  v_alignbyte_b32 v26, v17, v16, v6
  v_alignbyte_b32 v27, v18, v17, v6
  v_alignbyte_b32 v28, v19, v18, v6
  v_alignbyte_b32 v29, v20, v19, v6
  v_mfma_f32_16x16x32_bf16 a[0:3], v[88:91], a[36:39], a[0:3]
  ds_read2_b32 v[10:11], v60 offset0:208 offset1:209
  ds_read2_b32 v[12:13], v60 offset0:210 offset1:211
  ds_read_b32 v14, v60 offset:848
  s_waitcnt lgkmcnt(9)
  v_alignbyte_b32 v56, v33, v32, v6
  v_alignbyte_b32 v57, v34, v33, v6
  v_alignbyte_b32 v58, v35, v34, v6
  v_alignbyte_b32 v59, v36, v35, v6
  v_accvgpr_write_b32 a84, v56
  v_accvgpr_write_b32 a85, v57
  v_accvgpr_write_b32 a86, v58
  v_accvgpr_write_b32 a87, v59
  v_mfma_f32_16x16x32_bf16 a[28:31], v[26:29], a[40:43], a[28:31]
  ds_read2_b32 v[16:17], v60 offset0:80 offset1:81
  ds_read2_b32 v[18:19], v60 offset0:82 offset1:83
  ds_read_b32 v20, v60 offset:336
  ds_read_b128 a[36:39], v4 offset:3712
  s_waitcnt lgkmcnt(10)
  v_alignbyte_b32 v244, v39, v38, v6
  v_alignbyte_b32 v245, v40, v39, v6
  v_alignbyte_b32 v246, v41, v40, v6
  v_alignbyte_b32 v247, v42, v41, v6
  v_mfma_f32_16x16x32_bf16 a[24:27], a[84:87], a[40:43], a[24:27]
  ds_read2_b32 v[32:33], v5 offset0:208 offset1:209
  ds_read2_b32 v[34:35], v5 offset0:210 offset1:211
  ds_read_b32 v36, v5 offset:848
  s_waitcnt lgkmcnt(10)
  v_alignbyte_b32 v212, v45, v44, v6
  v_alignbyte_b32 v213, v46, v45, v6
  v_alignbyte_b32 v214, v47, v46, v6
  v_alignbyte_b32 v215, v48, v47, v6
  v_mfma_f32_16x16x32_bf16 a[20:23], v[244:247], a[40:43], a[20:23]
  ds_read2_b32 v[38:39], v5 offset0:80 offset1:81
  ds_read2_b32 v[40:41], v5 offset0:82 offset1:83
  ds_read_b32 v42, v5 offset:336
  s_waitcnt lgkmcnt(10)
  v_alignbyte_b32 v180, v11, v10, v6
  v_alignbyte_b32 v181, v12, v11, v6
  v_alignbyte_b32 v182, v13, v12, v6
  v_alignbyte_b32 v183, v14, v13, v6
  v_mfma_f32_16x16x32_bf16 a[16:19], v[212:215], a[40:43], a[16:19]
  ds_read2_b32 v[44:45], v62 offset0:192 offset1:193
  ds_read2_b32 v[46:47], v62 offset0:194 offset1:195
  ds_read_b32 v48, v62 offset:784
  s_waitcnt lgkmcnt(10)
  v_alignbyte_b32 v148, v17, v16, v6
  v_alignbyte_b32 v149, v18, v17, v6
  v_alignbyte_b32 v150, v19, v18, v6
  v_alignbyte_b32 v151, v20, v19, v6
  v_mfma_f32_16x16x32_bf16 a[12:15], v[180:183], a[40:43], a[12:15]
  ds_read2_b32 v[10:11], v62 offset0:64 offset1:65
  ds_read2_b32 v[12:13], v62 offset0:66 offset1:67
  ds_read_b32 v14, v62 offset:272
  s_waitcnt lgkmcnt(9)
  v_alignbyte_b32 v116, v33, v32, v6
  v_alignbyte_b32 v117, v34, v33, v6
  v_alignbyte_b32 v118, v35, v34, v6
  v_alignbyte_b32 v119, v36, v35, v6
  v_mfma_f32_16x16x32_bf16 a[8:11], v[148:151], a[40:43], a[8:11]
  ds_read2_b32 v[16:17], v61 offset0:192 offset1:193
  ds_read2_b32 v[18:19], v61 offset0:194 offset1:195
  ds_read_b32 v20, v61 offset:784
  s_waitcnt lgkmcnt(9)
  v_alignbyte_b32 v84, v39, v38, v6
  v_alignbyte_b32 v85, v40, v39, v6
  v_alignbyte_b32 v86, v41, v40, v6
  v_alignbyte_b32 v87, v42, v41, v6
  v_mfma_f32_16x16x32_bf16 a[4:7], v[116:119], a[40:43], a[4:7]
  ds_read2_b32 v[32:33], v61 offset0:64 offset1:65
  ds_read2_b32 v[34:35], v61 offset0:66 offset1:67
  ds_read_b32 v36, v61 offset:272
  s_waitcnt lgkmcnt(9)
  v_alignbyte_b32 v22, v45, v44, v6
  v_alignbyte_b32 v23, v46, v45, v6
  v_alignbyte_b32 v24, v47, v46, v6
  v_alignbyte_b32 v25, v48, v47, v6
  v_mfma_f32_16x16x32_bf16 a[0:3], v[84:87], a[40:43], a[0:3]
  ds_read2_b32 v[38:39], v60 offset0:192 offset1:193
  ds_read2_b32 v[40:41], v60 offset0:194 offset1:195
  ds_read_b32 v42, v60 offset:784
  s_waitcnt lgkmcnt(9)
  v_alignbyte_b32 v56, v11, v10, v6
  v_alignbyte_b32 v57, v12, v11, v6
  v_alignbyte_b32 v58, v13, v12, v6
  v_alignbyte_b32 v59, v14, v13, v6
  v_accvgpr_write_b32 a80, v56
  v_accvgpr_write_b32 a81, v57
  v_accvgpr_write_b32 a82, v58
  v_accvgpr_write_b32 a83, v59
  v_mfma_f32_16x16x32_bf16 a[28:31], v[22:25], a[44:47], a[28:31]
  ds_read2_b32 v[44:45], v60 offset0:64 offset1:65
  ds_read2_b32 v[46:47], v60 offset0:66 offset1:67
  ds_read_b32 v48, v60 offset:272
  ds_read_b128 a[40:43], v4 offset:3648
  s_waitcnt lgkmcnt(10)
  v_alignbyte_b32 v240, v17, v16, v6
  v_alignbyte_b32 v241, v18, v17, v6
  v_alignbyte_b32 v242, v19, v18, v6
  v_alignbyte_b32 v243, v20, v19, v6
  v_mfma_f32_16x16x32_bf16 a[24:27], a[80:83], a[44:47], a[24:27]
  ds_read2_b32 v[10:11], v5 offset0:192 offset1:193
  ds_read2_b32 v[12:13], v5 offset0:194 offset1:195
  ds_read_b32 v14, v5 offset:784
  s_waitcnt lgkmcnt(10)
  v_alignbyte_b32 v208, v33, v32, v6
  v_alignbyte_b32 v209, v34, v33, v6
  v_alignbyte_b32 v210, v35, v34, v6
  v_alignbyte_b32 v211, v36, v35, v6
  v_mfma_f32_16x16x32_bf16 a[20:23], v[240:243], a[44:47], a[20:23]
  ds_read2_b32 v[16:17], v5 offset0:64 offset1:65
  ds_read2_b32 v[18:19], v5 offset0:66 offset1:67
  ds_read_b32 v20, v5 offset:272
  s_waitcnt lgkmcnt(10)
  v_alignbyte_b32 v176, v39, v38, v6
  v_alignbyte_b32 v177, v40, v39, v6
  v_alignbyte_b32 v178, v41, v40, v6
  v_alignbyte_b32 v179, v42, v41, v6
  v_mfma_f32_16x16x32_bf16 a[16:19], v[208:211], a[44:47], a[16:19]
  ds_read2_b32 v[32:33], v62 offset0:176 offset1:177
  ds_read2_b32 v[34:35], v62 offset0:178 offset1:179
  ds_read_b32 v36, v62 offset:720
  s_waitcnt lgkmcnt(10)
  v_alignbyte_b32 v144, v45, v44, v6
  v_alignbyte_b32 v145, v46, v45, v6
  v_alignbyte_b32 v146, v47, v46, v6
  v_alignbyte_b32 v147, v48, v47, v6
  v_mfma_f32_16x16x32_bf16 a[12:15], v[176:179], a[44:47], a[12:15]
  ds_read2_b32 v[38:39], v62 offset0:48 offset1:49
  ds_read2_b32 v[40:41], v62 offset0:50 offset1:51
  ds_read_b32 v42, v62 offset:208
  s_waitcnt lgkmcnt(9)
  v_alignbyte_b32 v112, v11, v10, v6
  v_alignbyte_b32 v113, v12, v11, v6
  v_alignbyte_b32 v114, v13, v12, v6
  v_alignbyte_b32 v115, v14, v13, v6
  v_mfma_f32_16x16x32_bf16 a[8:11], v[144:147], a[44:47], a[8:11]
  ds_read2_b32 v[44:45], v61 offset0:176 offset1:177
  ds_read2_b32 v[46:47], v61 offset0:178 offset1:179
  ds_read_b32 v48, v61 offset:720
  s_waitcnt lgkmcnt(9)
  v_alignbyte_b32 v80, v17, v16, v6
  v_alignbyte_b32 v81, v18, v17, v6
  v_alignbyte_b32 v82, v19, v18, v6
  v_alignbyte_b32 v83, v20, v19, v6
  v_mfma_f32_16x16x32_bf16 a[4:7], v[112:115], a[44:47], a[4:7]
  ds_read2_b32 v[10:11], v61 offset0:48 offset1:49
  ds_read2_b32 v[12:13], v61 offset0:50 offset1:51
  ds_read_b32 v14, v61 offset:208
  s_waitcnt lgkmcnt(9)
  v_alignbyte_b32 v26, v33, v32, v6
  v_alignbyte_b32 v27, v34, v33, v6
  v_alignbyte_b32 v28, v35, v34, v6
  v_alignbyte_b32 v29, v36, v35, v6
  v_mfma_f32_16x16x32_bf16 a[0:3], v[80:83], a[44:47], a[0:3]
  ds_read2_b32 v[16:17], v60 offset0:176 offset1:177
  ds_read2_b32 v[18:19], v60 offset0:178 offset1:179
  ds_read_b32 v20, v60 offset:720
  s_waitcnt lgkmcnt(9)
  v_alignbyte_b32 v56, v39, v38, v6
  v_alignbyte_b32 v57, v40, v39, v6
  v_alignbyte_b32 v58, v41, v40, v6
  v_alignbyte_b32 v59, v42, v41, v6
  v_accvgpr_write_b32 a76, v56
  v_accvgpr_write_b32 a77, v57
  v_accvgpr_write_b32 a78, v58
  v_accvgpr_write_b32 a79, v59
  v_mfma_f32_16x16x32_bf16 a[28:31], v[26:29], a[32:35], a[28:31]
  ds_read2_b32 v[32:33], v60 offset0:48 offset1:49
  ds_read2_b32 v[34:35], v60 offset0:50 offset1:51
  ds_read_b32 v36, v60 offset:208
  ds_read_b128 a[44:47], v4 offset:3584
  s_waitcnt lgkmcnt(10)
  v_alignbyte_b32 v236, v45, v44, v6
  v_alignbyte_b32 v237, v46, v45, v6
  v_alignbyte_b32 v238, v47, v46, v6
  v_alignbyte_b32 v239, v48, v47, v6
  v_mfma_f32_16x16x32_bf16 a[24:27], a[76:79], a[32:35], a[24:27]
  ds_read2_b32 v[38:39], v5 offset0:176 offset1:177
  ds_read2_b32 v[40:41], v5 offset0:178 offset1:179
  ds_read_b32 v42, v5 offset:720
  s_waitcnt lgkmcnt(10)
  v_alignbyte_b32 v204, v11, v10, v6
  v_alignbyte_b32 v205, v12, v11, v6
  v_alignbyte_b32 v206, v13, v12, v6
  v_alignbyte_b32 v207, v14, v13, v6
  v_mfma_f32_16x16x32_bf16 a[20:23], v[236:239], a[32:35], a[20:23]
  ds_read2_b32 v[44:45], v5 offset0:48 offset1:49
  ds_read2_b32 v[46:47], v5 offset0:50 offset1:51
  ds_read_b32 v48, v5 offset:208
  s_waitcnt lgkmcnt(10)
  v_alignbyte_b32 v172, v17, v16, v6
  v_alignbyte_b32 v173, v18, v17, v6
  v_alignbyte_b32 v174, v19, v18, v6
  v_alignbyte_b32 v175, v20, v19, v6
  v_mfma_f32_16x16x32_bf16 a[16:19], v[204:207], a[32:35], a[16:19]
  ds_read2_b32 v[10:11], v62 offset0:160 offset1:161
  ds_read2_b32 v[12:13], v62 offset0:162 offset1:163
  ds_read_b32 v14, v62 offset:656
  s_waitcnt lgkmcnt(10)
  v_alignbyte_b32 v140, v33, v32, v6
  v_alignbyte_b32 v141, v34, v33, v6
  v_alignbyte_b32 v142, v35, v34, v6
  v_alignbyte_b32 v143, v36, v35, v6
  v_mfma_f32_16x16x32_bf16 a[12:15], v[172:175], a[32:35], a[12:15]
  ds_read2_b32 v[16:17], v62 offset0:32 offset1:33
  ds_read2_b32 v[18:19], v62 offset0:34 offset1:35
  ds_read_b32 v20, v62 offset:144
  s_waitcnt lgkmcnt(9)
  v_alignbyte_b32 v108, v39, v38, v6
  v_alignbyte_b32 v109, v40, v39, v6
  v_alignbyte_b32 v110, v41, v40, v6
  v_alignbyte_b32 v111, v42, v41, v6
  v_mfma_f32_16x16x32_bf16 a[8:11], v[140:143], a[32:35], a[8:11]
  ds_read2_b32 v[32:33], v61 offset0:160 offset1:161
  ds_read2_b32 v[34:35], v61 offset0:162 offset1:163
  ds_read_b32 v36, v61 offset:656
  s_waitcnt lgkmcnt(9)
  v_alignbyte_b32 v76, v45, v44, v6
  v_alignbyte_b32 v77, v46, v45, v6
  v_alignbyte_b32 v78, v47, v46, v6
  v_alignbyte_b32 v79, v48, v47, v6
  v_mfma_f32_16x16x32_bf16 a[4:7], v[108:111], a[32:35], a[4:7]
  ds_read2_b32 v[38:39], v61 offset0:32 offset1:33
  ds_read2_b32 v[40:41], v61 offset0:34 offset1:35
  ds_read_b32 v42, v61 offset:144
  s_waitcnt lgkmcnt(9)
  v_alignbyte_b32 v22, v11, v10, v6
  v_alignbyte_b32 v23, v12, v11, v6
  v_alignbyte_b32 v24, v13, v12, v6
  v_alignbyte_b32 v25, v14, v13, v6
  v_mfma_f32_16x16x32_bf16 a[0:3], v[76:79], a[32:35], a[0:3]
  ds_read2_b32 v[44:45], v60 offset0:160 offset1:161
  ds_read2_b32 v[46:47], v60 offset0:162 offset1:163
  ds_read_b32 v48, v60 offset:656
  s_waitcnt lgkmcnt(9)
  v_alignbyte_b32 v56, v17, v16, v6
  v_alignbyte_b32 v57, v18, v17, v6
  v_alignbyte_b32 v58, v19, v18, v6
  v_alignbyte_b32 v59, v20, v19, v6
  v_accvgpr_write_b32 a72, v56
  v_accvgpr_write_b32 a73, v57
  v_accvgpr_write_b32 a74, v58
  v_accvgpr_write_b32 a75, v59
  v_mfma_f32_16x16x32_bf16 a[28:31], v[22:25], a[36:39], a[28:31]
  ds_read2_b32 v[10:11], v60 offset0:32 offset1:33
  ds_read2_b32 v[12:13], v60 offset0:34 offset1:35
  ds_read_b32 v14, v60 offset:144
  ds_read_b128 a[32:35], v4 offset:3520
  s_waitcnt lgkmcnt(10)
  v_alignbyte_b32 v232, v33, v32, v6
  v_alignbyte_b32 v233, v34, v33, v6
  v_alignbyte_b32 v234, v35, v34, v6
  v_alignbyte_b32 v235, v36, v35, v6
  v_mfma_f32_16x16x32_bf16 a[24:27], a[72:75], a[36:39], a[24:27]
  ds_read2_b32 v[16:17], v5 offset0:160 offset1:161
  ds_read2_b32 v[18:19], v5 offset0:162 offset1:163
  ds_read_b32 v20, v5 offset:656
  s_waitcnt lgkmcnt(10)
  v_alignbyte_b32 v200, v39, v38, v6
  v_alignbyte_b32 v201, v40, v39, v6
  v_alignbyte_b32 v202, v41, v40, v6
  v_alignbyte_b32 v203, v42, v41, v6
  v_mfma_f32_16x16x32_bf16 a[20:23], v[232:235], a[36:39], a[20:23]
  ds_read2_b32 v[32:33], v5 offset0:32 offset1:33
  ds_read2_b32 v[34:35], v5 offset0:34 offset1:35
  ds_read_b32 v36, v5 offset:144
  s_waitcnt lgkmcnt(10)
  v_alignbyte_b32 v168, v45, v44, v6
  v_alignbyte_b32 v169, v46, v45, v6
  v_alignbyte_b32 v170, v47, v46, v6
  v_alignbyte_b32 v171, v48, v47, v6
  v_mfma_f32_16x16x32_bf16 a[16:19], v[200:203], a[36:39], a[16:19]
  ds_read2_b32 v[38:39], v62 offset0:144 offset1:145
  ds_read2_b32 v[40:41], v62 offset0:146 offset1:147
  ds_read_b32 v42, v62 offset:592
  s_waitcnt lgkmcnt(10)
  v_alignbyte_b32 v136, v11, v10, v6
  v_alignbyte_b32 v137, v12, v11, v6
  v_alignbyte_b32 v138, v13, v12, v6
  v_alignbyte_b32 v139, v14, v13, v6
  v_mfma_f32_16x16x32_bf16 a[12:15], v[168:171], a[36:39], a[12:15]
  ds_read2_b32 v[44:45], v62 offset0:16 offset1:17
  ds_read2_b32 v[46:47], v62 offset0:18 offset1:19
  ds_read_b32 v48, v62 offset:80
  s_waitcnt lgkmcnt(9)
  v_alignbyte_b32 v104, v17, v16, v6
  v_alignbyte_b32 v105, v18, v17, v6
  v_alignbyte_b32 v106, v19, v18, v6
  v_alignbyte_b32 v107, v20, v19, v6
  v_mfma_f32_16x16x32_bf16 a[8:11], v[136:139], a[36:39], a[8:11]
  ds_read2_b32 v[10:11], v61 offset0:144 offset1:145
  ds_read2_b32 v[12:13], v61 offset0:146 offset1:147
  ds_read_b32 v14, v61 offset:592
  s_waitcnt lgkmcnt(9)
  v_alignbyte_b32 v72, v33, v32, v6
  v_alignbyte_b32 v73, v34, v33, v6
  v_alignbyte_b32 v74, v35, v34, v6
  v_alignbyte_b32 v75, v36, v35, v6
  v_mfma_f32_16x16x32_bf16 a[4:7], v[104:107], a[36:39], a[4:7]
  ds_read2_b32 v[16:17], v61 offset0:16 offset1:17
  ds_read2_b32 v[18:19], v61 offset0:18 offset1:19
  ds_read_b32 v20, v61 offset:80
  s_waitcnt lgkmcnt(9)
  v_alignbyte_b32 v26, v39, v38, v6
  v_alignbyte_b32 v27, v40, v39, v6
  v_alignbyte_b32 v28, v41, v40, v6
  v_alignbyte_b32 v29, v42, v41, v6
  v_mfma_f32_16x16x32_bf16 a[0:3], v[72:75], a[36:39], a[0:3]
  ds_read2_b32 v[32:33], v60 offset0:144 offset1:145
  ds_read2_b32 v[34:35], v60 offset0:146 offset1:147
  ds_read_b32 v36, v60 offset:592
  s_waitcnt lgkmcnt(9)
  v_alignbyte_b32 v56, v45, v44, v6
  v_alignbyte_b32 v57, v46, v45, v6
  v_alignbyte_b32 v58, v47, v46, v6
  v_alignbyte_b32 v59, v48, v47, v6
  v_accvgpr_write_b32 a68, v56
  v_accvgpr_write_b32 a69, v57
  v_accvgpr_write_b32 a70, v58
  v_accvgpr_write_b32 a71, v59
  v_mfma_f32_16x16x32_bf16 a[28:31], v[26:29], a[40:43], a[28:31]
  ds_read2_b32 v[38:39], v60 offset0:16 offset1:17
  ds_read2_b32 v[40:41], v60 offset0:18 offset1:19
  ds_read_b32 v42, v60 offset:80
  ds_read_b128 a[36:39], v4 offset:3456
  s_waitcnt lgkmcnt(10)
  v_alignbyte_b32 v228, v11, v10, v6
  v_alignbyte_b32 v229, v12, v11, v6
  v_alignbyte_b32 v230, v13, v12, v6
  v_alignbyte_b32 v231, v14, v13, v6
  v_mfma_f32_16x16x32_bf16 a[24:27], a[68:71], a[40:43], a[24:27]
  ds_read2_b32 v[44:45], v5 offset0:144 offset1:145
  ds_read2_b32 v[46:47], v5 offset0:146 offset1:147
  ds_read_b32 v48, v5 offset:592
  s_waitcnt lgkmcnt(10)
  v_alignbyte_b32 v196, v17, v16, v6
  v_alignbyte_b32 v197, v18, v17, v6
  v_alignbyte_b32 v198, v19, v18, v6
  v_alignbyte_b32 v199, v20, v19, v6
  v_mfma_f32_16x16x32_bf16 a[20:23], v[228:231], a[40:43], a[20:23]
  ds_read2_b32 v[10:11], v5 offset0:16 offset1:17
  ds_read2_b32 v[12:13], v5 offset0:18 offset1:19
  ds_read_b32 v14, v5 offset:80
  s_waitcnt lgkmcnt(10)
  v_alignbyte_b32 v164, v33, v32, v6
  v_alignbyte_b32 v165, v34, v33, v6
  v_alignbyte_b32 v166, v35, v34, v6
  v_alignbyte_b32 v167, v36, v35, v6
  v_mfma_f32_16x16x32_bf16 a[16:19], v[196:199], a[40:43], a[16:19]
  ds_read2_b32 v[16:17], v62 offset0:128 offset1:129
  ds_read2_b32 v[18:19], v62 offset0:130 offset1:131
  ds_read_b32 v20, v62 offset:528
  s_waitcnt lgkmcnt(10)
  v_alignbyte_b32 v132, v39, v38, v6
  v_alignbyte_b32 v133, v40, v39, v6
  v_alignbyte_b32 v134, v41, v40, v6
  v_alignbyte_b32 v135, v42, v41, v6
  v_mfma_f32_16x16x32_bf16 a[12:15], v[164:167], a[40:43], a[12:15]
  ds_read2_b32 v[32:33], v62 offset0:0 offset1:1
  ds_read2_b32 v[34:35], v62 offset0:2 offset1:3
  ds_read_b32 v36, v62 offset:16
  s_waitcnt lgkmcnt(9)
  v_alignbyte_b32 v100, v45, v44, v6
  v_alignbyte_b32 v101, v46, v45, v6
  v_alignbyte_b32 v102, v47, v46, v6
  v_alignbyte_b32 v103, v48, v47, v6
  v_mfma_f32_16x16x32_bf16 a[8:11], v[132:135], a[40:43], a[8:11]
  ds_read2_b32 v[38:39], v61 offset0:128 offset1:129
  ds_read2_b32 v[40:41], v61 offset0:130 offset1:131
  ds_read_b32 v42, v61 offset:528
  s_waitcnt lgkmcnt(9)
  v_alignbyte_b32 v68, v11, v10, v6
  v_alignbyte_b32 v69, v12, v11, v6
  v_alignbyte_b32 v70, v13, v12, v6
  v_alignbyte_b32 v71, v14, v13, v6
  v_mfma_f32_16x16x32_bf16 a[4:7], v[100:103], a[40:43], a[4:7]
  ds_read2_b32 v[44:45], v61 offset0:0 offset1:1
  ds_read2_b32 v[46:47], v61 offset0:2 offset1:3
  ds_read_b32 v48, v61 offset:16
  s_waitcnt lgkmcnt(9)
  v_alignbyte_b32 v22, v17, v16, v6
  v_alignbyte_b32 v23, v18, v17, v6
  v_alignbyte_b32 v24, v19, v18, v6
  v_alignbyte_b32 v25, v20, v19, v6
  v_mfma_f32_16x16x32_bf16 a[0:3], v[68:71], a[40:43], a[0:3]
  ds_read2_b32 v[10:11], v60 offset0:128 offset1:129
  ds_read2_b32 v[12:13], v60 offset0:130 offset1:131
  ds_read_b32 v14, v60 offset:528
  s_waitcnt lgkmcnt(9)
  v_alignbyte_b32 v56, v33, v32, v6
  v_alignbyte_b32 v57, v34, v33, v6
  v_alignbyte_b32 v58, v35, v34, v6
  v_alignbyte_b32 v59, v36, v35, v6
  v_accvgpr_write_b32 a64, v56
  v_accvgpr_write_b32 a65, v57
  v_accvgpr_write_b32 a66, v58
  v_accvgpr_write_b32 a67, v59
  v_mfma_f32_16x16x32_bf16 a[28:31], v[22:25], a[44:47], a[28:31]
  ds_read2_b32 v[16:17], v60 offset0:0 offset1:1
  ds_read2_b32 v[18:19], v60 offset0:2 offset1:3
  ds_read_b32 v20, v60 offset:16
  ds_read_b128 a[40:43], v4 offset:3392
  s_waitcnt lgkmcnt(10)
  v_alignbyte_b32 v224, v39, v38, v6
  v_alignbyte_b32 v225, v40, v39, v6
  v_alignbyte_b32 v226, v41, v40, v6
  v_alignbyte_b32 v227, v42, v41, v6
  v_mfma_f32_16x16x32_bf16 a[24:27], a[64:67], a[44:47], a[24:27]
  ds_read2_b32 v[32:33], v5 offset0:128 offset1:129
  ds_read2_b32 v[34:35], v5 offset0:130 offset1:131
  ds_read_b32 v36, v5 offset:528
  s_waitcnt lgkmcnt(10)
  v_alignbyte_b32 v192, v45, v44, v6
  v_alignbyte_b32 v193, v46, v45, v6
  v_alignbyte_b32 v194, v47, v46, v6
  v_alignbyte_b32 v195, v48, v47, v6
  v_mfma_f32_16x16x32_bf16 a[20:23], v[224:227], a[44:47], a[20:23]
  ds_read2_b32 v[38:39], v5 offset0:0 offset1:1
  ds_read2_b32 v[40:41], v5 offset0:2 offset1:3
  ds_read_b32 v42, v5 offset:16
  s_waitcnt lgkmcnt(10)
  v_alignbyte_b32 v160, v11, v10, v6
  v_alignbyte_b32 v161, v12, v11, v6
  v_alignbyte_b32 v162, v13, v12, v6
  v_alignbyte_b32 v163, v14, v13, v6
  v_mfma_f32_16x16x32_bf16 a[16:19], v[192:195], a[44:47], a[16:19]
  s_waitcnt lgkmcnt(7)
  v_alignbyte_b32 v128, v17, v16, v6
  v_alignbyte_b32 v129, v18, v17, v6
  v_alignbyte_b32 v130, v19, v18, v6
  v_alignbyte_b32 v131, v20, v19, v6
  v_mfma_f32_16x16x32_bf16 a[12:15], v[160:163], a[44:47], a[12:15]
  s_waitcnt lgkmcnt(3)
  v_alignbyte_b32 v96, v33, v32, v6
  v_alignbyte_b32 v97, v34, v33, v6
  v_alignbyte_b32 v98, v35, v34, v6
  v_alignbyte_b32 v99, v36, v35, v6
  v_mfma_f32_16x16x32_bf16 a[8:11], v[128:131], a[44:47], a[8:11]
  s_waitcnt lgkmcnt(0)
  v_alignbyte_b32 v64, v39, v38, v6
  v_alignbyte_b32 v65, v40, v39, v6
  v_alignbyte_b32 v66, v41, v40, v6
  v_alignbyte_b32 v67, v42, v41, v6
  v_mfma_f32_16x16x32_bf16 a[4:7], v[96:99], a[44:47], a[4:7]
  s_nop 0
  v_mfma_f32_16x16x32_bf16 a[0:3], v[64:67], a[44:47], a[0:3]
  v_mfma_f32_16x16x32_bf16 a[28:31], a[92:95], a[32:35], a[28:31]
  ds_read_b128 a[44:47], v4 offset:3328
  ds_read_b64 v[36:37], v7 offset:0
  ds_read_b64 v[38:39], v8 offset:0
  s_nop 3
  v_accvgpr_read_b32 v44, a0
  v_accvgpr_read_b32 v45, a1
  v_mfma_f32_16x16x32_bf16 a[24:27], v[252:255], a[32:35], a[24:27]
  v_accvgpr_read_b32 v46, a2
  v_accvgpr_read_b32 v47, a3
  v_mfma_f32_16x16x32_bf16 a[20:23], v[220:223], a[32:35], a[20:23]
  s_waitcnt lgkmcnt(0)
  v_lshlrev_b32 v48, 16, v36
  v_and_b32 v49, 0xffff0000, v36
  v_mfma_f32_16x16x32_bf16 a[16:19], v[188:191], a[32:35], a[16:19]
  v_lshlrev_b32 v50, 16, v37
  v_and_b32 v51, 0xffff0000, v37
  v_mfma_f32_16x16x32_bf16 a[12:15], v[156:159], a[32:35], a[12:15]
  v_lshlrev_b32 v32, 16, v38
  v_and_b32 v33, 0xffff0000, v38
  v_mfma_f32_16x16x32_bf16 a[8:11], v[124:127], a[32:35], a[8:11]
  v_lshlrev_b32 v34, 16, v39
  v_and_b32 v35, 0xffff0000, v39
  v_mfma_f32_16x16x32_bf16 a[4:7], v[92:95], a[32:35], a[4:7]
  v_mul_f32 v52, v48, v31
  v_mul_f32 v53, v49, v31
  v_mfma_f32_16x16x32_bf16 a[28:31], a[88:91], a[36:39], a[28:31]
  ds_read_b128 a[32:35], v4 offset:3264
  v_mul_f32 v54, v50, v31
  v_mul_f32 v55, v51, v31
  v_mfma_f32_16x16x32_bf16 a[24:27], v[248:251], a[36:39], a[24:27]
  v_fmac_f32 v44, s61, v48
  v_fmac_f32 v45, s61, v49
  v_mfma_f32_16x16x32_bf16 a[20:23], v[216:219], a[36:39], a[20:23]
  v_fmac_f32 v46, s61, v50
  v_fmac_f32 v47, s61, v51
  v_mfma_f32_16x16x32_bf16 a[16:19], v[184:187], a[36:39], a[16:19]
  v_cvt_pk_bf16_f32 v36, v52, v53
  v_cvt_pk_bf16_f32 v37, v54, v55
  v_mfma_f32_16x16x32_bf16 a[12:15], v[152:155], a[36:39], a[12:15]
  v_lshlrev_b32 v52, 16, v36
  v_and_b32 v53, 0xffff0000, v36
  v_mfma_f32_16x16x32_bf16 a[8:11], v[120:123], a[36:39], a[8:11]
  v_lshlrev_b32 v54, 16, v37
  v_and_b32 v55, 0xffff0000, v37
  v_mfma_f32_16x16x32_bf16 a[4:7], v[88:91], a[36:39], a[4:7]
  v_cvt_pk_bf16_f32 v36, v44, v45
  v_cvt_pk_bf16_f32 v37, v46, v47
  v_mfma_f32_16x16x32_bf16 a[28:31], a[84:87], a[40:43], a[28:31]
  ds_read_b128 a[36:39], v4 offset:3200
  v_lshlrev_b32 v44, 16, v36
  v_and_b32 v45, 0xffff0000, v36
  v_mfma_f32_16x16x32_bf16 a[24:27], v[244:247], a[40:43], a[24:27]
  v_lshlrev_b32 v46, 16, v37
  v_and_b32 v47, 0xffff0000, v37
  v_mfma_f32_16x16x32_bf16 a[20:23], v[212:215], a[40:43], a[20:23]
  v_add_f32 v44, v44, v52
  v_add_f32 v45, v45, v53
  v_mfma_f32_16x16x32_bf16 a[16:19], v[180:183], a[40:43], a[16:19]
  v_add_f32 v46, v46, v54
  v_add_f32 v47, v47, v55
  v_mfma_f32_16x16x32_bf16 a[12:15], v[148:151], a[40:43], a[12:15]
  v_cvt_pk_bf16_f32 v36, v44, v45
  v_cvt_pk_bf16_f32 v37, v46, v47
  v_mfma_f32_16x16x32_bf16 a[8:11], v[116:119], a[40:43], a[8:11]
  v_lshlrev_b32 v44, 16, v36
  v_and_b32 v45, 0xffff0000, v36
  v_mfma_f32_16x16x32_bf16 a[4:7], v[84:87], a[40:43], a[4:7]
  v_lshlrev_b32 v46, 16, v37
  v_and_b32 v47, 0xffff0000, v37
  v_mfma_f32_16x16x32_bf16 a[28:31], a[80:83], a[44:47], a[28:31]
  ds_read_b128 a[40:43], v4 offset:3136
  v_add_f32 v44, v44, v32
  v_add_f32 v45, v45, v33
  v_mfma_f32_16x16x32_bf16 a[24:27], v[240:243], a[44:47], a[24:27]
  v_add_f32 v46, v46, v34
  v_add_f32 v47, v47, v35
  v_mfma_f32_16x16x32_bf16 a[20:23], v[208:211], a[44:47], a[20:23]
  v_cvt_pk_bf16_f32 v36, v44, v45
  v_cvt_pk_bf16_f32 v37, v46, v47
  v_mfma_f32_16x16x32_bf16 a[16:19], v[176:179], a[44:47], a[16:19]
  s_add_u32 s6, s62, 0
  buffer_store_dwordx2 v[36:37], v9, s[8:11], s6 offen sc1
  v_mfma_f32_16x16x32_bf16 a[12:15], v[144:147], a[44:47], a[12:15]
  v_mfma_f32_16x16x32_bf16 a[8:11], v[112:115], a[44:47], a[8:11]
  v_mfma_f32_16x16x32_bf16 a[4:7], v[80:83], a[44:47], a[4:7]
  s_waitcnt lgkmcnt(2)
  v_mfma_f32_16x16x32_bf16 a[28:31], a[76:79], a[32:35], a[28:31]
  ds_read_b128 a[44:47], v4 offset:3072
  v_mfma_f32_16x16x32_bf16 a[24:27], v[236:239], a[32:35], a[24:27]
  v_mfma_f32_16x16x32_bf16 a[20:23], v[204:207], a[32:35], a[20:23]
  v_mfma_f32_16x16x32_bf16 a[16:19], v[172:175], a[32:35], a[16:19]
  v_mfma_f32_16x16x32_bf16 a[12:15], v[140:143], a[32:35], a[12:15]
  v_mfma_f32_16x16x32_bf16 a[8:11], v[108:111], a[32:35], a[8:11]
  v_mfma_f32_16x16x32_bf16 a[4:7], v[76:79], a[32:35], a[4:7]
  s_waitcnt lgkmcnt(2)
  v_mfma_f32_16x16x32_bf16 a[28:31], a[72:75], a[36:39], a[28:31]
  ds_read_b128 a[32:35], v4 offset:3008
  v_mfma_f32_16x16x32_bf16 a[24:27], v[232:235], a[36:39], a[24:27]
  v_mfma_f32_16x16x32_bf16 a[20:23], v[200:203], a[36:39], a[20:23]
  v_mfma_f32_16x16x32_bf16 a[16:19], v[168:171], a[36:39], a[16:19]
  v_mfma_f32_16x16x32_bf16 a[12:15], v[136:139], a[36:39], a[12:15]
  v_mfma_f32_16x16x32_bf16 a[8:11], v[104:107], a[36:39], a[8:11]
  v_mfma_f32_16x16x32_bf16 a[4:7], v[72:75], a[36:39], a[4:7]
  s_waitcnt lgkmcnt(2)
  v_mfma_f32_16x16x32_bf16 a[28:31], a[68:71], a[40:43], a[28:31]
  ds_read_b128 a[36:39], v4 offset:2944
  v_mfma_f32_16x16x32_bf16 a[24:27], v[228:231], a[40:43], a[24:27]
  v_mfma_f32_16x16x32_bf16 a[20:23], v[196:199], a[40:43], a[20:23]
  v_mfma_f32_16x16x32_bf16 a[16:19], v[164:167], a[40:43], a[16:19]
  v_mfma_f32_16x16x32_bf16 a[12:15], v[132:135], a[40:43], a[12:15]
  v_mfma_f32_16x16x32_bf16 a[8:11], v[100:103], a[40:43], a[8:11]
  v_mfma_f32_16x16x32_bf16 a[4:7], v[68:71], a[40:43], a[4:7]
  s_waitcnt lgkmcnt(2)
  v_mfma_f32_16x16x32_bf16 a[28:31], a[64:67], a[44:47], a[28:31]
  ds_read_b128 a[40:43], v4 offset:2880
  v_mfma_f32_16x16x32_bf16 a[24:27], v[224:227], a[44:47], a[24:27]
  v_mfma_f32_16x16x32_bf16 a[20:23], v[192:195], a[44:47], a[20:23]
  v_mfma_f32_16x16x32_bf16 a[16:19], v[160:163], a[44:47], a[16:19]
  v_mfma_f32_16x16x32_bf16 a[12:15], v[128:131], a[44:47], a[12:15]
  v_mfma_f32_16x16x32_bf16 a[8:11], v[96:99], a[44:47], a[8:11]
  v_mfma_f32_16x16x32_bf16 a[4:7], v[64:67], a[44:47], a[4:7]
  s_waitcnt lgkmcnt(2)
  v_mfma_f32_16x16x32_bf16 a[28:31], v[252:255], a[32:35], a[28:31]
  ds_read_b128 a[44:47], v4 offset:2816
  ds_read_b64 v[36:37], v7 offset:512
  ds_read_b64 v[38:39], v8 offset:512
  s_nop 2
  v_accvgpr_read_b32 v44, a4
  v_accvgpr_read_b32 v45, a5
  v_mfma_f32_16x16x32_bf16 a[24:27], v[220:223], a[32:35], a[24:27]
  v_accvgpr_read_b32 v46, a6
  v_accvgpr_read_b32 v47, a7
  v_mfma_f32_16x16x32_bf16 a[20:23], v[188:191], a[32:35], a[20:23]
  s_waitcnt lgkmcnt(0)
  v_lshlrev_b32 v48, 16, v36
  v_and_b32 v49, 0xffff0000, v36
  v_mfma_f32_16x16x32_bf16 a[16:19], v[156:159], a[32:35], a[16:19]
  v_lshlrev_b32 v50, 16, v37
  v_and_b32 v51, 0xffff0000, v37
  v_mfma_f32_16x16x32_bf16 a[12:15], v[124:127], a[32:35], a[12:15]
  v_lshlrev_b32 v32, 16, v38
  v_and_b32 v33, 0xffff0000, v38
  v_mfma_f32_16x16x32_bf16 a[8:11], v[92:95], a[32:35], a[8:11]
  v_lshlrev_b32 v34, 16, v39
  v_and_b32 v35, 0xffff0000, v39
  v_mfma_f32_16x16x32_bf16 a[28:31], v[248:251], a[36:39], a[28:31]
  ds_read_b128 a[32:35], v4 offset:2752
  v_mul_f32 v52, v48, v31
  v_mul_f32 v53, v49, v31
  v_mfma_f32_16x16x32_bf16 a[24:27], v[216:219], a[36:39], a[24:27]
  v_mul_f32 v54, v50, v31
  v_mul_f32 v55, v51, v31
  v_mfma_f32_16x16x32_bf16 a[20:23], v[184:187], a[36:39], a[20:23]
  v_fmac_f32 v44, s61, v48
  v_fmac_f32 v45, s61, v49
  v_mfma_f32_16x16x32_bf16 a[16:19], v[152:155], a[36:39], a[16:19]
  v_fmac_f32 v46, s61, v50
  v_fmac_f32 v47, s61, v51
  v_mfma_f32_16x16x32_bf16 a[12:15], v[120:123], a[36:39], a[12:15]
  v_cvt_pk_bf16_f32 v36, v52, v53
  v_cvt_pk_bf16_f32 v37, v54, v55
  v_mfma_f32_16x16x32_bf16 a[8:11], v[88:91], a[36:39], a[8:11]
  v_lshlrev_b32 v52, 16, v36
  v_and_b32 v53, 0xffff0000, v36
  v_mfma_f32_16x16x32_bf16 a[28:31], v[244:247], a[40:43], a[28:31]
  ds_read_b128 a[36:39], v4 offset:2688
  v_lshlrev_b32 v54, 16, v37
  v_and_b32 v55, 0xffff0000, v37
  v_mfma_f32_16x16x32_bf16 a[24:27], v[212:215], a[40:43], a[24:27]
  v_cvt_pk_bf16_f32 v36, v44, v45
  v_cvt_pk_bf16_f32 v37, v46, v47
  v_mfma_f32_16x16x32_bf16 a[20:23], v[180:183], a[40:43], a[20:23]
  v_lshlrev_b32 v44, 16, v36
  v_and_b32 v45, 0xffff0000, v36
  v_mfma_f32_16x16x32_bf16 a[16:19], v[148:151], a[40:43], a[16:19]
  v_lshlrev_b32 v46, 16, v37
  v_and_b32 v47, 0xffff0000, v37
  v_mfma_f32_16x16x32_bf16 a[12:15], v[116:119], a[40:43], a[12:15]
  v_add_f32 v44, v44, v52
  v_add_f32 v45, v45, v53
  v_mfma_f32_16x16x32_bf16 a[8:11], v[84:87], a[40:43], a[8:11]
  v_add_f32 v46, v46, v54
  v_add_f32 v47, v47, v55
  v_mfma_f32_16x16x32_bf16 a[28:31], v[240:243], a[44:47], a[28:31]
  ds_read_b128 a[40:43], v4 offset:2624
  v_cvt_pk_bf16_f32 v36, v44, v45
  v_cvt_pk_bf16_f32 v37, v46, v47
  v_mfma_f32_16x16x32_bf16 a[24:27], v[208:211], a[44:47], a[24:27]
  v_lshlrev_b32 v44, 16, v36
  v_and_b32 v45, 0xffff0000, v36
  v_mfma_f32_16x16x32_bf16 a[20:23], v[176:179], a[44:47], a[20:23]
  v_lshlrev_b32 v46, 16, v37
  v_and_b32 v47, 0xffff0000, v37
  v_mfma_f32_16x16x32_bf16 a[16:19], v[144:147], a[44:47], a[16:19]
  v_add_f32 v44, v44, v32
  v_add_f32 v45, v45, v33
  v_mfma_f32_16x16x32_bf16 a[12:15], v[112:115], a[44:47], a[12:15]
  v_add_f32 v46, v46, v34
  v_add_f32 v47, v47, v35
  v_mfma_f32_16x16x32_bf16 a[8:11], v[80:83], a[44:47], a[8:11]
  v_cvt_pk_bf16_f32 v36, v44, v45
  v_cvt_pk_bf16_f32 v37, v46, v47
  s_waitcnt lgkmcnt(2)
  v_mfma_f32_16x16x32_bf16 a[28:31], v[236:239], a[32:35], a[28:31]
  ds_read_b128 a[44:47], v4 offset:2560
  s_add_u32 s6, s62, 262144
  buffer_store_dwordx2 v[36:37], v9, s[8:11], s6 offen sc1
  v_mfma_f32_16x16x32_bf16 a[24:27], v[204:207], a[32:35], a[24:27]
  v_mfma_f32_16x16x32_bf16 a[20:23], v[172:175], a[32:35], a[20:23]
  v_mfma_f32_16x16x32_bf16 a[16:19], v[140:143], a[32:35], a[16:19]
  v_mfma_f32_16x16x32_bf16 a[12:15], v[108:111], a[32:35], a[12:15]
  v_mfma_f32_16x16x32_bf16 a[8:11], v[76:79], a[32:35], a[8:11]
  s_waitcnt lgkmcnt(2)
  v_mfma_f32_16x16x32_bf16 a[28:31], v[232:235], a[36:39], a[28:31]
  ds_read_b128 a[32:35], v4 offset:2496
  v_mfma_f32_16x16x32_bf16 a[24:27], v[200:203], a[36:39], a[24:27]
  v_mfma_f32_16x16x32_bf16 a[20:23], v[168:171], a[36:39], a[20:23]
  v_mfma_f32_16x16x32_bf16 a[16:19], v[136:139], a[36:39], a[16:19]
  v_mfma_f32_16x16x32_bf16 a[12:15], v[104:107], a[36:39], a[12:15]
  v_mfma_f32_16x16x32_bf16 a[8:11], v[72:75], a[36:39], a[8:11]
  s_waitcnt lgkmcnt(2)
  v_mfma_f32_16x16x32_bf16 a[28:31], v[228:231], a[40:43], a[28:31]
  ds_read_b128 a[36:39], v4 offset:2432
  v_mfma_f32_16x16x32_bf16 a[24:27], v[196:199], a[40:43], a[24:27]
  v_mfma_f32_16x16x32_bf16 a[20:23], v[164:167], a[40:43], a[20:23]
  v_mfma_f32_16x16x32_bf16 a[16:19], v[132:135], a[40:43], a[16:19]
  v_mfma_f32_16x16x32_bf16 a[12:15], v[100:103], a[40:43], a[12:15]
  v_mfma_f32_16x16x32_bf16 a[8:11], v[68:71], a[40:43], a[8:11]
  s_waitcnt lgkmcnt(2)
  v_mfma_f32_16x16x32_bf16 a[28:31], v[224:227], a[44:47], a[28:31]
  ds_read_b128 a[40:43], v4 offset:2368
  v_mfma_f32_16x16x32_bf16 a[24:27], v[192:195], a[44:47], a[24:27]
  v_mfma_f32_16x16x32_bf16 a[20:23], v[160:163], a[44:47], a[20:23]
  v_mfma_f32_16x16x32_bf16 a[16:19], v[128:131], a[44:47], a[16:19]
  v_mfma_f32_16x16x32_bf16 a[12:15], v[96:99], a[44:47], a[12:15]
  v_mfma_f32_16x16x32_bf16 a[8:11], v[64:67], a[44:47], a[8:11]
  s_waitcnt lgkmcnt(2)
  v_mfma_f32_16x16x32_bf16 a[28:31], v[220:223], a[32:35], a[28:31]
  ds_read_b128 a[44:47], v4 offset:2304
  ds_read_b64 v[36:37], v7 offset:1024
  ds_read_b64 v[38:39], v8 offset:1024
  s_nop 2
  v_accvgpr_read_b32 v44, a8
  v_accvgpr_read_b32 v45, a9
  v_mfma_f32_16x16x32_bf16 a[24:27], v[188:191], a[32:35], a[24:27]
  v_accvgpr_read_b32 v46, a10
  v_accvgpr_read_b32 v47, a11
  v_mfma_f32_16x16x32_bf16 a[20:23], v[156:159], a[32:35], a[20:23]
  s_waitcnt lgkmcnt(0)
  v_lshlrev_b32 v48, 16, v36
  v_and_b32 v49, 0xffff0000, v36
  v_mfma_f32_16x16x32_bf16 a[16:19], v[124:127], a[32:35], a[16:19]
  v_lshlrev_b32 v50, 16, v37
  v_and_b32 v51, 0xffff0000, v37
  v_mfma_f32_16x16x32_bf16 a[12:15], v[92:95], a[32:35], a[12:15]
  v_lshlrev_b32 v32, 16, v38
  v_and_b32 v33, 0xffff0000, v38
  v_mfma_f32_16x16x32_bf16 a[28:31], v[216:219], a[36:39], a[28:31]
  ds_read_b128 a[32:35], v4 offset:2240
  v_lshlrev_b32 v34, 16, v39
  v_and_b32 v35, 0xffff0000, v39
  v_mfma_f32_16x16x32_bf16 a[24:27], v[184:187], a[36:39], a[24:27]
  v_mul_f32 v52, v48, v31
  v_mul_f32 v53, v49, v31
  v_mfma_f32_16x16x32_bf16 a[20:23], v[152:155], a[36:39], a[20:23]
  v_mul_f32 v54, v50, v31
  v_mul_f32 v55, v51, v31
  v_mfma_f32_16x16x32_bf16 a[16:19], v[120:123], a[36:39], a[16:19]
  v_fmac_f32 v44, s61, v48
  v_fmac_f32 v45, s61, v49
  v_mfma_f32_16x16x32_bf16 a[12:15], v[88:91], a[36:39], a[12:15]
  v_fmac_f32 v46, s61, v50
  v_fmac_f32 v47, s61, v51
  v_mfma_f32_16x16x32_bf16 a[28:31], v[212:215], a[40:43], a[28:31]
  ds_read_b128 a[36:39], v4 offset:2176
  v_cvt_pk_bf16_f32 v36, v52, v53
  v_cvt_pk_bf16_f32 v37, v54, v55
  v_mfma_f32_16x16x32_bf16 a[24:27], v[180:183], a[40:43], a[24:27]
  v_lshlrev_b32 v52, 16, v36
  v_and_b32 v53, 0xffff0000, v36
  v_mfma_f32_16x16x32_bf16 a[20:23], v[148:151], a[40:43], a[20:23]
  v_lshlrev_b32 v54, 16, v37
  v_and_b32 v55, 0xffff0000, v37
  v_mfma_f32_16x16x32_bf16 a[16:19], v[116:119], a[40:43], a[16:19]
  v_cvt_pk_bf16_f32 v36, v44, v45
  v_cvt_pk_bf16_f32 v37, v46, v47
  v_mfma_f32_16x16x32_bf16 a[12:15], v[84:87], a[40:43], a[12:15]
  v_lshlrev_b32 v44, 16, v36
  v_and_b32 v45, 0xffff0000, v36
  v_mfma_f32_16x16x32_bf16 a[28:31], v[208:211], a[44:47], a[28:31]
  ds_read_b128 a[40:43], v4 offset:2112
  v_lshlrev_b32 v46, 16, v37
  v_and_b32 v47, 0xffff0000, v37
  v_mfma_f32_16x16x32_bf16 a[24:27], v[176:179], a[44:47], a[24:27]
  v_add_f32 v44, v44, v52
  v_add_f32 v45, v45, v53
  v_mfma_f32_16x16x32_bf16 a[20:23], v[144:147], a[44:47], a[20:23]
  v_add_f32 v46, v46, v54
  v_add_f32 v47, v47, v55
  v_mfma_f32_16x16x32_bf16 a[16:19], v[112:115], a[44:47], a[16:19]
  v_cvt_pk_bf16_f32 v36, v44, v45
  v_cvt_pk_bf16_f32 v37, v46, v47
  v_mfma_f32_16x16x32_bf16 a[12:15], v[80:83], a[44:47], a[12:15]
  v_lshlrev_b32 v44, 16, v36
  v_and_b32 v45, 0xffff0000, v36
  s_waitcnt lgkmcnt(2)
  v_mfma_f32_16x16x32_bf16 a[28:31], v[204:207], a[32:35], a[28:31]
  ds_read_b128 a[44:47], v4 offset:2048
  v_lshlrev_b32 v46, 16, v37
  v_and_b32 v47, 0xffff0000, v37
  v_mfma_f32_16x16x32_bf16 a[24:27], v[172:175], a[32:35], a[24:27]
  v_add_f32 v44, v44, v32
  v_add_f32 v45, v45, v33
  v_mfma_f32_16x16x32_bf16 a[20:23], v[140:143], a[32:35], a[20:23]
  v_add_f32 v46, v46, v34
  v_add_f32 v47, v47, v35
  v_mfma_f32_16x16x32_bf16 a[16:19], v[108:111], a[32:35], a[16:19]
  v_cvt_pk_bf16_f32 v36, v44, v45
  v_cvt_pk_bf16_f32 v37, v46, v47
  v_mfma_f32_16x16x32_bf16 a[12:15], v[76:79], a[32:35], a[12:15]
  s_add_u32 s6, s62, 524288
  buffer_store_dwordx2 v[36:37], v9, s[8:11], s6 offen sc1
  s_waitcnt lgkmcnt(2)
  v_mfma_f32_16x16x32_bf16 a[28:31], v[200:203], a[36:39], a[28:31]
  ds_read_b128 a[32:35], v4 offset:1984
  v_mfma_f32_16x16x32_bf16 a[24:27], v[168:171], a[36:39], a[24:27]
  v_mfma_f32_16x16x32_bf16 a[20:23], v[136:139], a[36:39], a[20:23]
  v_mfma_f32_16x16x32_bf16 a[16:19], v[104:107], a[36:39], a[16:19]
  v_mfma_f32_16x16x32_bf16 a[12:15], v[72:75], a[36:39], a[12:15]
  s_waitcnt lgkmcnt(2)
  v_mfma_f32_16x16x32_bf16 a[28:31], v[196:199], a[40:43], a[28:31]
  ds_read_b128 a[36:39], v4 offset:1920
  v_mfma_f32_16x16x32_bf16 a[24:27], v[164:167], a[40:43], a[24:27]
  v_mfma_f32_16x16x32_bf16 a[20:23], v[132:135], a[40:43], a[20:23]
  v_mfma_f32_16x16x32_bf16 a[16:19], v[100:103], a[40:43], a[16:19]
  v_mfma_f32_16x16x32_bf16 a[12:15], v[68:71], a[40:43], a[12:15]
  s_waitcnt lgkmcnt(2)
  v_mfma_f32_16x16x32_bf16 a[28:31], v[192:195], a[44:47], a[28:31]
  ds_read_b128 a[40:43], v4 offset:1856
  v_mfma_f32_16x16x32_bf16 a[24:27], v[160:163], a[44:47], a[24:27]
  v_mfma_f32_16x16x32_bf16 a[20:23], v[128:131], a[44:47], a[20:23]
  v_mfma_f32_16x16x32_bf16 a[16:19], v[96:99], a[44:47], a[16:19]
  v_mfma_f32_16x16x32_bf16 a[12:15], v[64:67], a[44:47], a[12:15]
  s_waitcnt lgkmcnt(2)
  v_mfma_f32_16x16x32_bf16 a[28:31], v[188:191], a[32:35], a[28:31]
  ds_read_b128 a[44:47], v4 offset:1792
  ds_read_b64 v[36:37], v7 offset:1536
  ds_read_b64 v[38:39], v8 offset:1536
  s_nop 2
  v_accvgpr_read_b32 v44, a12
  v_accvgpr_read_b32 v45, a13
  v_mfma_f32_16x16x32_bf16 a[24:27], v[156:159], a[32:35], a[24:27]
  v_accvgpr_read_b32 v46, a14
  v_accvgpr_read_b32 v47, a15
  v_mfma_f32_16x16x32_bf16 a[20:23], v[124:127], a[32:35], a[20:23]
  s_waitcnt lgkmcnt(0)
  v_lshlrev_b32 v48, 16, v36
  v_and_b32 v49, 0xffff0000, v36
  v_mfma_f32_16x16x32_bf16 a[16:19], v[92:95], a[32:35], a[16:19]
  v_lshlrev_b32 v50, 16, v37
  v_and_b32 v51, 0xffff0000, v37
  v_mfma_f32_16x16x32_bf16 a[28:31], v[184:187], a[36:39], a[28:31]
  ds_read_b128 a[32:35], v4 offset:1728
  v_lshlrev_b32 v32, 16, v38
  v_and_b32 v33, 0xffff0000, v38
  v_mfma_f32_16x16x32_bf16 a[24:27], v[152:155], a[36:39], a[24:27]
  v_lshlrev_b32 v34, 16, v39
  v_and_b32 v35, 0xffff0000, v39
  v_mfma_f32_16x16x32_bf16 a[20:23], v[120:123], a[36:39], a[20:23]
  v_mul_f32 v52, v48, v31
  v_mul_f32 v53, v49, v31
  v_mfma_f32_16x16x32_bf16 a[16:19], v[88:91], a[36:39], a[16:19]
  v_mul_f32 v54, v50, v31
  v_mul_f32 v55, v51, v31
  v_mfma_f32_16x16x32_bf16 a[28:31], v[180:183], a[40:43], a[28:31]
  ds_read_b128 a[36:39], v4 offset:1664
  v_fmac_f32 v44, s61, v48
  v_fmac_f32 v45, s61, v49
  v_mfma_f32_16x16x32_bf16 a[24:27], v[148:151], a[40:43], a[24:27]
  v_fmac_f32 v46, s61, v50
  v_fmac_f32 v47, s61, v51
  v_mfma_f32_16x16x32_bf16 a[20:23], v[116:119], a[40:43], a[20:23]
  v_cvt_pk_bf16_f32 v36, v52, v53
  v_cvt_pk_bf16_f32 v37, v54, v55
  v_mfma_f32_16x16x32_bf16 a[16:19], v[84:87], a[40:43], a[16:19]
  v_lshlrev_b32 v52, 16, v36
  v_and_b32 v53, 0xffff0000, v36
  v_mfma_f32_16x16x32_bf16 a[28:31], v[176:179], a[44:47], a[28:31]
  ds_read_b128 a[40:43], v4 offset:1600
  v_lshlrev_b32 v54, 16, v37
  v_and_b32 v55, 0xffff0000, v37
  v_mfma_f32_16x16x32_bf16 a[24:27], v[144:147], a[44:47], a[24:27]
  v_cvt_pk_bf16_f32 v36, v44, v45
  v_cvt_pk_bf16_f32 v37, v46, v47
  v_mfma_f32_16x16x32_bf16 a[20:23], v[112:115], a[44:47], a[20:23]
  v_lshlrev_b32 v44, 16, v36
  v_and_b32 v45, 0xffff0000, v36
  v_mfma_f32_16x16x32_bf16 a[16:19], v[80:83], a[44:47], a[16:19]
  v_lshlrev_b32 v46, 16, v37
  v_and_b32 v47, 0xffff0000, v37
  s_waitcnt lgkmcnt(2)
  v_mfma_f32_16x16x32_bf16 a[28:31], v[172:175], a[32:35], a[28:31]
  ds_read_b128 a[44:47], v4 offset:1536
  v_add_f32 v44, v44, v52
  v_add_f32 v45, v45, v53
  v_mfma_f32_16x16x32_bf16 a[24:27], v[140:143], a[32:35], a[24:27]
  v_add_f32 v46, v46, v54
  v_add_f32 v47, v47, v55
  v_mfma_f32_16x16x32_bf16 a[20:23], v[108:111], a[32:35], a[20:23]
  v_cvt_pk_bf16_f32 v36, v44, v45
  v_cvt_pk_bf16_f32 v37, v46, v47
  v_mfma_f32_16x16x32_bf16 a[16:19], v[76:79], a[32:35], a[16:19]
  v_lshlrev_b32 v44, 16, v36
  v_and_b32 v45, 0xffff0000, v36
  s_waitcnt lgkmcnt(2)
  v_mfma_f32_16x16x32_bf16 a[28:31], v[168:171], a[36:39], a[28:31]
  ds_read_b128 a[32:35], v4 offset:1472
  v_lshlrev_b32 v46, 16, v37
  v_and_b32 v47, 0xffff0000, v37
  v_mfma_f32_16x16x32_bf16 a[24:27], v[136:139], a[36:39], a[24:27]
  v_add_f32 v44, v44, v32
  v_add_f32 v45, v45, v33
  v_mfma_f32_16x16x32_bf16 a[20:23], v[104:107], a[36:39], a[20:23]
  v_add_f32 v46, v46, v34
  v_add_f32 v47, v47, v35
  v_mfma_f32_16x16x32_bf16 a[16:19], v[72:75], a[36:39], a[16:19]
  v_cvt_pk_bf16_f32 v36, v44, v45
  v_cvt_pk_bf16_f32 v37, v46, v47
  s_waitcnt lgkmcnt(2)
  v_mfma_f32_16x16x32_bf16 a[28:31], v[164:167], a[40:43], a[28:31]
  ds_read_b128 a[36:39], v4 offset:1408
  s_add_u32 s6, s62, 786432
  buffer_store_dwordx2 v[36:37], v9, s[8:11], s6 offen sc1
  v_mfma_f32_16x16x32_bf16 a[24:27], v[132:135], a[40:43], a[24:27]
  v_mfma_f32_16x16x32_bf16 a[20:23], v[100:103], a[40:43], a[20:23]
  v_mfma_f32_16x16x32_bf16 a[16:19], v[68:71], a[40:43], a[16:19]
  s_waitcnt lgkmcnt(2)
  v_mfma_f32_16x16x32_bf16 a[28:31], v[160:163], a[44:47], a[28:31]
  ds_read_b128 a[40:43], v4 offset:1344
  v_mfma_f32_16x16x32_bf16 a[24:27], v[128:131], a[44:47], a[24:27]
  v_mfma_f32_16x16x32_bf16 a[20:23], v[96:99], a[44:47], a[20:23]
  v_mfma_f32_16x16x32_bf16 a[16:19], v[64:67], a[44:47], a[16:19]
  s_waitcnt lgkmcnt(2)
  v_mfma_f32_16x16x32_bf16 a[28:31], v[156:159], a[32:35], a[28:31]
  ds_read_b128 a[44:47], v4 offset:1280
  ds_read_b64 v[36:37], v7 offset:2048
  ds_read_b64 v[38:39], v8 offset:2048
  s_nop 2
  v_accvgpr_read_b32 v44, a16
  v_accvgpr_read_b32 v45, a17
  v_mfma_f32_16x16x32_bf16 a[24:27], v[124:127], a[32:35], a[24:27]
  v_accvgpr_read_b32 v46, a18
  v_accvgpr_read_b32 v47, a19
  v_mfma_f32_16x16x32_bf16 a[20:23], v[92:95], a[32:35], a[20:23]
  s_waitcnt lgkmcnt(0)
  v_lshlrev_b32 v48, 16, v36
  v_and_b32 v49, 0xffff0000, v36
  v_mfma_f32_16x16x32_bf16 a[28:31], v[152:155], a[36:39], a[28:31]
  ds_read_b128 a[32:35], v4 offset:1216
  v_lshlrev_b32 v50, 16, v37
  v_and_b32 v51, 0xffff0000, v37
  v_mfma_f32_16x16x32_bf16 a[24:27], v[120:123], a[36:39], a[24:27]
  v_lshlrev_b32 v32, 16, v38
  v_and_b32 v33, 0xffff0000, v38
  v_mfma_f32_16x16x32_bf16 a[20:23], v[88:91], a[36:39], a[20:23]
  v_lshlrev_b32 v34, 16, v39
  v_and_b32 v35, 0xffff0000, v39
  v_mfma_f32_16x16x32_bf16 a[28:31], v[148:151], a[40:43], a[28:31]
  ds_read_b128 a[36:39], v4 offset:1152
  v_mul_f32 v52, v48, v31
  v_mul_f32 v53, v49, v31
  v_mfma_f32_16x16x32_bf16 a[24:27], v[116:119], a[40:43], a[24:27]
  v_mul_f32 v54, v50, v31
  v_mul_f32 v55, v51, v31
  v_mfma_f32_16x16x32_bf16 a[20:23], v[84:87], a[40:43], a[20:23]
  v_fmac_f32 v44, s61, v48
  v_fmac_f32 v45, s61, v49
  v_mfma_f32_16x16x32_bf16 a[28:31], v[144:147], a[44:47], a[28:31]
  ds_read_b128 a[40:43], v4 offset:1088
  v_fmac_f32 v46, s61, v50
  v_fmac_f32 v47, s61, v51
  v_mfma_f32_16x16x32_bf16 a[24:27], v[112:115], a[44:47], a[24:27]
  v_cvt_pk_bf16_f32 v36, v52, v53
  v_cvt_pk_bf16_f32 v37, v54, v55
  v_mfma_f32_16x16x32_bf16 a[20:23], v[80:83], a[44:47], a[20:23]
  v_lshlrev_b32 v52, 16, v36
  v_and_b32 v53, 0xffff0000, v36
  s_waitcnt lgkmcnt(2)
  v_mfma_f32_16x16x32_bf16 a[28:31], v[140:143], a[32:35], a[28:31]
  ds_read_b128 a[44:47], v4 offset:1024
  v_lshlrev_b32 v54, 16, v37
  v_and_b32 v55, 0xffff0000, v37
  v_mfma_f32_16x16x32_bf16 a[24:27], v[108:111], a[32:35], a[24:27]
  v_cvt_pk_bf16_f32 v36, v44, v45
  v_cvt_pk_bf16_f32 v37, v46, v47
  v_mfma_f32_16x16x32_bf16 a[20:23], v[76:79], a[32:35], a[20:23]
  v_lshlrev_b32 v44, 16, v36
  v_and_b32 v45, 0xffff0000, v36
  s_waitcnt lgkmcnt(2)
  v_mfma_f32_16x16x32_bf16 a[28:31], v[136:139], a[36:39], a[28:31]
  ds_read_b128 a[32:35], v4 offset:960
  v_lshlrev_b32 v46, 16, v37
  v_and_b32 v47, 0xffff0000, v37
  v_mfma_f32_16x16x32_bf16 a[24:27], v[104:107], a[36:39], a[24:27]
  v_add_f32 v44, v44, v52
  v_add_f32 v45, v45, v53
  v_mfma_f32_16x16x32_bf16 a[20:23], v[72:75], a[36:39], a[20:23]
  v_add_f32 v46, v46, v54
  v_add_f32 v47, v47, v55
  s_waitcnt lgkmcnt(2)
  v_mfma_f32_16x16x32_bf16 a[28:31], v[132:135], a[40:43], a[28:31]
  ds_read_b128 a[36:39], v4 offset:896
  v_cvt_pk_bf16_f32 v36, v44, v45
  v_cvt_pk_bf16_f32 v37, v46, v47
  v_mfma_f32_16x16x32_bf16 a[24:27], v[100:103], a[40:43], a[24:27]
  v_lshlrev_b32 v44, 16, v36
  v_and_b32 v45, 0xffff0000, v36
  v_mfma_f32_16x16x32_bf16 a[20:23], v[68:71], a[40:43], a[20:23]
  v_lshlrev_b32 v46, 16, v37
  v_and_b32 v47, 0xffff0000, v37
  s_waitcnt lgkmcnt(2)
  v_mfma_f32_16x16x32_bf16 a[28:31], v[128:131], a[44:47], a[28:31]
  ds_read_b128 a[40:43], v4 offset:832
  v_add_f32 v44, v44, v32
  v_add_f32 v45, v45, v33
  v_mfma_f32_16x16x32_bf16 a[24:27], v[96:99], a[44:47], a[24:27]
  v_add_f32 v46, v46, v34
  v_add_f32 v47, v47, v35
  v_mfma_f32_16x16x32_bf16 a[20:23], v[64:67], a[44:47], a[20:23]
  v_cvt_pk_bf16_f32 v36, v44, v45
  v_cvt_pk_bf16_f32 v37, v46, v47
  s_waitcnt lgkmcnt(2)
  v_mfma_f32_16x16x32_bf16 a[28:31], v[124:127], a[32:35], a[28:31]
  ds_read_b128 a[44:47], v4 offset:768
  s_add_u32 s6, s62, 1048576
  buffer_store_dwordx2 v[36:37], v9, s[8:11], s6 offen sc1
  v_mfma_f32_16x16x32_bf16 a[24:27], v[92:95], a[32:35], a[24:27]
  ds_read_b64 v[36:37], v7 offset:2560
  ds_read_b64 v[38:39], v8 offset:2560
  v_accvgpr_read_b32 v44, a20
  v_accvgpr_read_b32 v45, a21
  s_waitcnt lgkmcnt(4)
  v_mfma_f32_16x16x32_bf16 a[28:31], v[120:123], a[36:39], a[28:31]
  ds_read_b128 a[32:35], v4 offset:704
  v_accvgpr_read_b32 v46, a22
  v_accvgpr_read_b32 v47, a23
  v_mfma_f32_16x16x32_bf16 a[24:27], v[88:91], a[36:39], a[24:27]
  s_waitcnt lgkmcnt(1)
  v_lshlrev_b32 v48, 16, v36
  v_and_b32 v49, 0xffff0000, v36
  v_mfma_f32_16x16x32_bf16 a[28:31], v[116:119], a[40:43], a[28:31]
  ds_read_b128 a[36:39], v4 offset:640
  v_lshlrev_b32 v50, 16, v37
  v_and_b32 v51, 0xffff0000, v37
  v_mfma_f32_16x16x32_bf16 a[24:27], v[84:87], a[40:43], a[24:27]
  v_lshlrev_b32 v32, 16, v38
  v_and_b32 v33, 0xffff0000, v38
  v_mfma_f32_16x16x32_bf16 a[28:31], v[112:115], a[44:47], a[28:31]
  ds_read_b128 a[40:43], v4 offset:576
  v_lshlrev_b32 v34, 16, v39
  v_and_b32 v35, 0xffff0000, v39
  v_mfma_f32_16x16x32_bf16 a[24:27], v[80:83], a[44:47], a[24:27]
  v_mul_f32 v52, v48, v31
  v_mul_f32 v53, v49, v31
  s_waitcnt lgkmcnt(2)
  v_mfma_f32_16x16x32_bf16 a[28:31], v[108:111], a[32:35], a[28:31]
  ds_read_b128 a[44:47], v4 offset:512
  v_mul_f32 v54, v50, v31
  v_mul_f32 v55, v51, v31
  v_mfma_f32_16x16x32_bf16 a[24:27], v[76:79], a[32:35], a[24:27]
  v_fmac_f32 v44, s61, v48
  v_fmac_f32 v45, s61, v49
  s_waitcnt lgkmcnt(2)
  v_mfma_f32_16x16x32_bf16 a[28:31], v[104:107], a[36:39], a[28:31]
  ds_read_b128 a[32:35], v4 offset:448
  v_fmac_f32 v46, s61, v50
  v_fmac_f32 v47, s61, v51
  v_mfma_f32_16x16x32_bf16 a[24:27], v[72:75], a[36:39], a[24:27]
  v_cvt_pk_bf16_f32 v36, v52, v53
  v_cvt_pk_bf16_f32 v37, v54, v55
  s_waitcnt lgkmcnt(2)
  v_mfma_f32_16x16x32_bf16 a[28:31], v[100:103], a[40:43], a[28:31]
  ds_read_b128 a[36:39], v4 offset:384
  v_lshlrev_b32 v52, 16, v36
  v_and_b32 v53, 0xffff0000, v36
  v_mfma_f32_16x16x32_bf16 a[24:27], v[68:71], a[40:43], a[24:27]
  v_lshlrev_b32 v54, 16, v37
  v_and_b32 v55, 0xffff0000, v37
  s_waitcnt lgkmcnt(2)
  v_mfma_f32_16x16x32_bf16 a[28:31], v[96:99], a[44:47], a[28:31]
  ds_read_b128 a[40:43], v4 offset:320
  v_cvt_pk_bf16_f32 v36, v44, v45
  v_cvt_pk_bf16_f32 v37, v46, v47
  v_mfma_f32_16x16x32_bf16 a[24:27], v[64:67], a[44:47], a[24:27]
  v_lshlrev_b32 v44, 16, v36
  v_and_b32 v45, 0xffff0000, v36
  s_waitcnt lgkmcnt(2)
  v_mfma_f32_16x16x32_bf16 a[28:31], v[92:95], a[32:35], a[28:31]
  ds_read_b128 a[44:47], v4 offset:256
  v_lshlrev_b32 v46, 16, v37
  v_and_b32 v47, 0xffff0000, v37
  s_waitcnt lgkmcnt(2)
  v_mfma_f32_16x16x32_bf16 a[28:31], v[88:91], a[36:39], a[28:31]
  ds_read_b128 a[32:35], v4 offset:192
  v_add_f32 v44, v44, v52
  v_add_f32 v45, v45, v53
  s_waitcnt lgkmcnt(2)
  v_mfma_f32_16x16x32_bf16 a[28:31], v[84:87], a[40:43], a[28:31]
  ds_read_b128 a[36:39], v4 offset:128
  v_add_f32 v46, v46, v54
  v_add_f32 v47, v47, v55
  s_waitcnt lgkmcnt(2)
  v_mfma_f32_16x16x32_bf16 a[28:31], v[80:83], a[44:47], a[28:31]
  ds_read_b128 a[40:43], v4 offset:64
  v_cvt_pk_bf16_f32 v36, v44, v45
  v_cvt_pk_bf16_f32 v37, v46, v47
  s_waitcnt lgkmcnt(2)
  v_mfma_f32_16x16x32_bf16 a[28:31], v[76:79], a[32:35], a[28:31]
  ds_read_b128 a[44:47], v4 offset:0
  v_lshlrev_b32 v44, 16, v36
  v_and_b32 v45, 0xffff0000, v36
  s_waitcnt lgkmcnt(2)
  v_mfma_f32_16x16x32_bf16 a[28:31], v[72:75], a[36:39], a[28:31]
  v_lshlrev_b32 v46, 16, v37
  v_and_b32 v47, 0xffff0000, v37
  s_waitcnt lgkmcnt(1)
  v_mfma_f32_16x16x32_bf16 a[28:31], v[68:71], a[40:43], a[28:31]
  v_add_f32 v44, v44, v32
  v_add_f32 v45, v45, v33
  s_waitcnt lgkmcnt(0)
  v_mfma_f32_16x16x32_bf16 a[28:31], v[64:67], a[44:47], a[28:31]
  v_add_f32 v46, v46, v34
  v_add_f32 v47, v47, v35
  v_cvt_pk_bf16_f32 v36, v44, v45
  v_cvt_pk_bf16_f32 v37, v46, v47
  s_add_u32 s6, s62, 1310720
  buffer_store_dwordx2 v[36:37], v9, s[8:11], s6 offen sc1
  ds_read_b64 v[36:37], v7 offset:3072
  ds_read_b64 v[38:39], v8 offset:3072
  v_accvgpr_read_b32 v44, a24
  v_accvgpr_read_b32 v45, a25
  v_accvgpr_read_b32 v46, a26
  v_accvgpr_read_b32 v47, a27
  s_waitcnt lgkmcnt(0)
  v_lshlrev_b32 v48, 16, v36
  v_and_b32 v49, 0xffff0000, v36
  v_lshlrev_b32 v50, 16, v37
  v_and_b32 v51, 0xffff0000, v37
  v_lshlrev_b32 v32, 16, v38
  v_and_b32 v33, 0xffff0000, v38
  v_lshlrev_b32 v34, 16, v39
  v_and_b32 v35, 0xffff0000, v39
  v_mul_f32 v52, v48, v31
  v_mul_f32 v53, v49, v31
  v_mul_f32 v54, v50, v31
  v_mul_f32 v55, v51, v31
  v_fmac_f32 v44, s61, v48
  v_fmac_f32 v45, s61, v49
  v_fmac_f32 v46, s61, v50
  v_fmac_f32 v47, s61, v51
  v_cvt_pk_bf16_f32 v36, v52, v53
  v_cvt_pk_bf16_f32 v37, v54, v55
  v_lshlrev_b32 v52, 16, v36
  v_and_b32 v53, 0xffff0000, v36
  v_lshlrev_b32 v54, 16, v37
  v_and_b32 v55, 0xffff0000, v37
  v_cvt_pk_bf16_f32 v36, v44, v45
  v_cvt_pk_bf16_f32 v37, v46, v47
  v_lshlrev_b32 v44, 16, v36
  v_and_b32 v45, 0xffff0000, v36
  v_lshlrev_b32 v46, 16, v37
  v_and_b32 v47, 0xffff0000, v37
  v_add_f32 v44, v44, v52
  v_add_f32 v45, v45, v53
  v_add_f32 v46, v46, v54
  v_add_f32 v47, v47, v55
  v_cvt_pk_bf16_f32 v36, v44, v45
  v_cvt_pk_bf16_f32 v37, v46, v47
  v_lshlrev_b32 v44, 16, v36
  v_and_b32 v45, 0xffff0000, v36
  v_lshlrev_b32 v46, 16, v37
  v_and_b32 v47, 0xffff0000, v37
  v_add_f32 v44, v44, v32
  v_add_f32 v45, v45, v33
  v_add_f32 v46, v46, v34
  v_add_f32 v47, v47, v35
  v_cvt_pk_bf16_f32 v36, v44, v45
  v_cvt_pk_bf16_f32 v37, v46, v47
  s_add_u32 s6, s62, 1572864
  buffer_store_dwordx2 v[36:37], v9, s[8:11], s6 offen sc1
  ds_read_b64 v[36:37], v7 offset:3584
  ds_read_b64 v[38:39], v8 offset:3584
  v_accvgpr_read_b32 v44, a28
  v_accvgpr_read_b32 v45, a29
  v_accvgpr_read_b32 v46, a30
  v_accvgpr_read_b32 v47, a31
  s_waitcnt lgkmcnt(0)
  v_lshlrev_b32 v48, 16, v36
  v_and_b32 v49, 0xffff0000, v36
  v_lshlrev_b32 v50, 16, v37
  v_and_b32 v51, 0xffff0000, v37
  v_lshlrev_b32 v32, 16, v38
  v_and_b32 v33, 0xffff0000, v38
  v_lshlrev_b32 v34, 16, v39
  v_and_b32 v35, 0xffff0000, v39
  v_mul_f32 v52, v48, v31
  v_mul_f32 v53, v49, v31
  v_mul_f32 v54, v50, v31
  v_mul_f32 v55, v51, v31
  v_fmac_f32 v44, s61, v48
  v_fmac_f32 v45, s61, v49
  v_fmac_f32 v46, s61, v50
  v_fmac_f32 v47, s61, v51
  v_cvt_pk_bf16_f32 v36, v52, v53
  v_cvt_pk_bf16_f32 v37, v54, v55
  v_lshlrev_b32 v52, 16, v36
  v_and_b32 v53, 0xffff0000, v36
  v_lshlrev_b32 v54, 16, v37
  v_and_b32 v55, 0xffff0000, v37
  v_cvt_pk_bf16_f32 v36, v44, v45
  v_cvt_pk_bf16_f32 v37, v46, v47
  v_lshlrev_b32 v44, 16, v36
  v_and_b32 v45, 0xffff0000, v36
  v_lshlrev_b32 v46, 16, v37
  v_and_b32 v47, 0xffff0000, v37
  v_add_f32 v44, v44, v52
  v_add_f32 v45, v45, v53
  v_add_f32 v46, v46, v54
  v_add_f32 v47, v47, v55
  v_cvt_pk_bf16_f32 v36, v44, v45
  v_cvt_pk_bf16_f32 v37, v46, v47
  v_lshlrev_b32 v44, 16, v36
  v_and_b32 v45, 0xffff0000, v36
  v_lshlrev_b32 v46, 16, v37
  v_and_b32 v47, 0xffff0000, v37
  v_add_f32 v44, v44, v32
  v_add_f32 v45, v45, v33
  v_add_f32 v46, v46, v34
  v_add_f32 v47, v47, v35
  v_cvt_pk_bf16_f32 v36, v44, v45
  v_cvt_pk_bf16_f32 v37, v46, v47
  s_add_u32 s6, s62, 1835008
  buffer_store_dwordx2 v[36:37], v9, s[8:11], s6 offen sc1
  s_lshl_b32 s6, s60, 2
  s_add_u32 s6, s6, 0x710000
  v_mov_b32 v16, 127
  s_waitcnt vmcnt(0)
  s_mov_b64 exec, 1
  buffer_store_dword v16, v1, s[8:11], s6 offen sc1
  s_mov_b64 exec, -1
  s_barrier
  s_cmp_eq_u32 s4, 1
  s_cbranch_scc1 L_rec2
  s_cmp_eq_u32 s4, 6
  s_cbranch_scc1 L_o2
  s_branch L_p2
L_c:
  v_lshlrev_b32 v4, 2, v0
  v_lshlrev_b32 v0, 4, v0
  v_mov_b32 v1, 0
  v_mov_b32 v2, 150016
  s_lshl_b32 s6, s5, 8
  s_add_u32 s6, s6, 0x704000
  s_add_u32 s7, s6, 0x2000
  buffer_store_dword v1, v4, s[8:11], s6 offen sc1
  buffer_store_dword v1, v4, s[8:11], s7 offen sc1
  s_lshl_b32 s6, s5, 3
  s_add_u32 s6, s6, 0x710800
  s_mov_b64 exec, 3
  buffer_store_dword v1, v4, s[8:11], s6 offen sc1
  s_mov_b64 exec, -1
  s_waitcnt vmcnt(0)
  s_barrier
  s_cmp_lg_u32 s3, 0
  s_cbranch_scc1 L_sd_112
  s_mov_b64 exec, 1
  s_and_b32 s6, s4, 3
  s_lshl_b32 s6, s6, 6
  v_mov_b32 v6, 16
  v_mov_b32 v7, 1
  buffer_atomic_add v7, v6, s[12:15], s6 offen sc1
  s_mov_b64 exec, -1
L_sd_112:
  v_bfe_u32 v5, v0, 5, 4
  v_mul_u32_u24 v5, 4128, v5
  v_and_b32 v6, 16, v0
  v_add3_u32 v5, v5, v6, v1
  v_mov_b32 v8, 0
  v_mov_b32 v9, 0
  v_mov_b32 v10, 0
  v_mov_b32 v11, 0
  v_add_u32 v5, 73728, v5
  ds_write_b128 v5, v[8:11]
  ds_write_b128 v2, v[8:11]
  v_accvgpr_write_b32 a0, 0
  v_accvgpr_write_b32 a1, 0
  v_accvgpr_write_b32 a2, 0
  v_accvgpr_write_b32 a3, 0
  v_accvgpr_write_b32 a4, 0
  v_accvgpr_write_b32 a5, 0
  v_accvgpr_write_b32 a6, 0
  v_accvgpr_write_b32 a7, 0
  v_accvgpr_write_b32 a8, 0
  v_accvgpr_write_b32 a9, 0
  v_accvgpr_write_b32 a10, 0
  v_accvgpr_write_b32 a11, 0
  v_accvgpr_write_b32 a12, 0
  v_accvgpr_write_b32 a13, 0
  v_accvgpr_write_b32 a14, 0
  v_accvgpr_write_b32 a15, 0
  v_accvgpr_write_b32 a16, 0
  v_accvgpr_write_b32 a17, 0
  v_accvgpr_write_b32 a18, 0
  v_accvgpr_write_b32 a19, 0
  v_accvgpr_write_b32 a20, 0
  v_accvgpr_write_b32 a21, 0
  v_accvgpr_write_b32 a22, 0
  v_accvgpr_write_b32 a23, 0
  v_accvgpr_write_b32 a24, 0
  v_accvgpr_write_b32 a25, 0
  v_accvgpr_write_b32 a26, 0
  v_accvgpr_write_b32 a27, 0
  v_accvgpr_write_b32 a28, 0
  v_accvgpr_write_b32 a29, 0
  v_accvgpr_write_b32 a30, 0
  v_accvgpr_write_b32 a31, 0
  v_accvgpr_write_b32 a32, 0
  v_accvgpr_write_b32 a33, 0
  v_accvgpr_write_b32 a34, 0
  v_accvgpr_write_b32 a35, 0
  v_accvgpr_write_b32 a36, 0
  v_accvgpr_write_b32 a37, 0
  v_accvgpr_write_b32 a38, 0
  v_accvgpr_write_b32 a39, 0
  v_accvgpr_write_b32 a40, 0
  v_accvgpr_write_b32 a41, 0
  v_accvgpr_write_b32 a42, 0
  v_accvgpr_write_b32 a43, 0
  v_accvgpr_write_b32 a44, 0
  v_accvgpr_write_b32 a45, 0
  v_accvgpr_write_b32 a46, 0
  v_accvgpr_write_b32 a47, 0
  v_accvgpr_write_b32 a48, 0
  v_accvgpr_write_b32 a49, 0
  v_accvgpr_write_b32 a50, 0
  v_accvgpr_write_b32 a51, 0
  v_accvgpr_write_b32 a52, 0
  v_accvgpr_write_b32 a53, 0
  v_accvgpr_write_b32 a54, 0
  v_accvgpr_write_b32 a55, 0
  v_accvgpr_write_b32 a56, 0
  v_accvgpr_write_b32 a57, 0
  v_accvgpr_write_b32 a58, 0
  v_accvgpr_write_b32 a59, 0
  v_accvgpr_write_b32 a60, 0
  v_accvgpr_write_b32 a61, 0
  v_accvgpr_write_b32 a62, 0
  v_accvgpr_write_b32 a63, 0
  v_accvgpr_write_b32 a64, 0
  v_accvgpr_write_b32 a65, 0
  v_accvgpr_write_b32 a66, 0
  v_accvgpr_write_b32 a67, 0
  v_accvgpr_write_b32 a68, 0
  v_accvgpr_write_b32 a69, 0
  v_accvgpr_write_b32 a70, 0
  v_accvgpr_write_b32 a71, 0
  v_accvgpr_write_b32 a72, 0
  v_accvgpr_write_b32 a73, 0
  v_accvgpr_write_b32 a74, 0
  v_accvgpr_write_b32 a75, 0
  v_accvgpr_write_b32 a76, 0
  v_accvgpr_write_b32 a77, 0
  v_accvgpr_write_b32 a78, 0
  v_accvgpr_write_b32 a79, 0
  v_accvgpr_write_b32 a80, 0
  v_accvgpr_write_b32 a81, 0
  v_accvgpr_write_b32 a82, 0
  v_accvgpr_write_b32 a83, 0
  v_accvgpr_write_b32 a84, 0
  v_accvgpr_write_b32 a85, 0
  v_accvgpr_write_b32 a86, 0
  v_accvgpr_write_b32 a87, 0
  v_accvgpr_write_b32 a88, 0
  v_accvgpr_write_b32 a89, 0
  v_accvgpr_write_b32 a90, 0
  v_accvgpr_write_b32 a91, 0
  v_accvgpr_write_b32 a92, 0
  v_accvgpr_write_b32 a93, 0
  v_accvgpr_write_b32 a94, 0
  v_accvgpr_write_b32 a95, 0
  v_accvgpr_write_b32 a96, 0
  v_accvgpr_write_b32 a97, 0
  v_accvgpr_write_b32 a98, 0
  v_accvgpr_write_b32 a99, 0
  v_accvgpr_write_b32 a100, 0
  v_accvgpr_write_b32 a101, 0
  v_accvgpr_write_b32 a102, 0
  v_accvgpr_write_b32 a103, 0
  v_accvgpr_write_b32 a104, 0
  v_accvgpr_write_b32 a105, 0
  v_accvgpr_write_b32 a106, 0
  v_accvgpr_write_b32 a107, 0
  v_accvgpr_write_b32 a108, 0
  v_accvgpr_write_b32 a109, 0
  v_accvgpr_write_b32 a110, 0
  v_accvgpr_write_b32 a111, 0
  v_accvgpr_write_b32 a112, 0
  v_accvgpr_write_b32 a113, 0
  v_accvgpr_write_b32 a114, 0
  v_accvgpr_write_b32 a115, 0
  v_accvgpr_write_b32 a116, 0
  v_accvgpr_write_b32 a117, 0
  v_accvgpr_write_b32 a118, 0
  v_accvgpr_write_b32 a119, 0
  v_accvgpr_write_b32 a120, 0
  v_accvgpr_write_b32 a121, 0
  v_accvgpr_write_b32 a122, 0
  v_accvgpr_write_b32 a123, 0
  v_accvgpr_write_b32 a124, 0
  v_accvgpr_write_b32 a125, 0
  v_accvgpr_write_b32 a126, 0
  v_accvgpr_write_b32 a127, 0
  v_accvgpr_write_b32 a128, 0
  v_accvgpr_write_b32 a129, 0
  v_accvgpr_write_b32 a130, 0
  v_accvgpr_write_b32 a131, 0
  v_accvgpr_write_b32 a132, 0
  v_accvgpr_write_b32 a133, 0
  v_accvgpr_write_b32 a134, 0
  v_accvgpr_write_b32 a135, 0
  v_accvgpr_write_b32 a136, 0
  v_accvgpr_write_b32 a137, 0
  v_accvgpr_write_b32 a138, 0
  v_accvgpr_write_b32 a139, 0
  v_accvgpr_write_b32 a140, 0
  v_accvgpr_write_b32 a141, 0
  v_accvgpr_write_b32 a142, 0
  v_accvgpr_write_b32 a143, 0
  v_accvgpr_write_b32 a144, 0
  v_accvgpr_write_b32 a145, 0
  v_accvgpr_write_b32 a146, 0
  v_accvgpr_write_b32 a147, 0
  v_accvgpr_write_b32 a148, 0
  v_accvgpr_write_b32 a149, 0
  v_accvgpr_write_b32 a150, 0
  v_accvgpr_write_b32 a151, 0
  v_accvgpr_write_b32 a152, 0
  v_accvgpr_write_b32 a153, 0
  v_accvgpr_write_b32 a154, 0
  v_accvgpr_write_b32 a155, 0
  v_accvgpr_write_b32 a156, 0
  v_accvgpr_write_b32 a157, 0
  v_accvgpr_write_b32 a158, 0
  v_accvgpr_write_b32 a159, 0
  v_accvgpr_write_b32 a160, 0
  v_accvgpr_write_b32 a161, 0
  v_accvgpr_write_b32 a162, 0
  v_accvgpr_write_b32 a163, 0
  v_accvgpr_write_b32 a164, 0
  v_accvgpr_write_b32 a165, 0
  v_accvgpr_write_b32 a166, 0
  v_accvgpr_write_b32 a167, 0
  v_accvgpr_write_b32 a168, 0
  v_accvgpr_write_b32 a169, 0
  v_accvgpr_write_b32 a170, 0
  v_accvgpr_write_b32 a171, 0
  v_accvgpr_write_b32 a172, 0
  v_accvgpr_write_b32 a173, 0
  v_accvgpr_write_b32 a174, 0
  v_accvgpr_write_b32 a175, 0
  v_accvgpr_write_b32 a176, 0
  v_accvgpr_write_b32 a177, 0
  v_accvgpr_write_b32 a178, 0
  v_accvgpr_write_b32 a179, 0
  v_accvgpr_write_b32 a180, 0
  v_accvgpr_write_b32 a181, 0
  v_accvgpr_write_b32 a182, 0
  v_accvgpr_write_b32 a183, 0
  v_accvgpr_write_b32 a184, 0
  v_accvgpr_write_b32 a185, 0
  v_accvgpr_write_b32 a186, 0
  v_accvgpr_write_b32 a187, 0
  v_accvgpr_write_b32 a188, 0
  v_accvgpr_write_b32 a189, 0
  v_accvgpr_write_b32 a190, 0
  v_accvgpr_write_b32 a191, 0
  v_accvgpr_write_b32 a192, 0
  v_accvgpr_write_b32 a193, 0
  v_accvgpr_write_b32 a194, 0
  v_accvgpr_write_b32 a195, 0
  v_accvgpr_write_b32 a196, 0
  v_accvgpr_write_b32 a197, 0
  v_accvgpr_write_b32 a198, 0
  v_accvgpr_write_b32 a199, 0
  v_accvgpr_write_b32 a200, 0
  v_accvgpr_write_b32 a201, 0
  v_accvgpr_write_b32 a202, 0
  v_accvgpr_write_b32 a203, 0
  v_accvgpr_write_b32 a204, 0
  v_accvgpr_write_b32 a205, 0
  v_accvgpr_write_b32 a206, 0
  v_accvgpr_write_b32 a207, 0
  v_accvgpr_write_b32 a208, 0
  v_accvgpr_write_b32 a209, 0
  v_accvgpr_write_b32 a210, 0
  v_accvgpr_write_b32 a211, 0
  v_accvgpr_write_b32 a212, 0
  v_accvgpr_write_b32 a213, 0
  v_accvgpr_write_b32 a214, 0
  v_accvgpr_write_b32 a215, 0
  v_accvgpr_write_b32 a216, 0
  v_accvgpr_write_b32 a217, 0
  v_accvgpr_write_b32 a218, 0
  v_accvgpr_write_b32 a219, 0
  v_accvgpr_write_b32 a220, 0
  v_accvgpr_write_b32 a221, 0
  v_accvgpr_write_b32 a222, 0
  v_accvgpr_write_b32 a223, 0
  v_accvgpr_write_b32 a224, 0
  v_accvgpr_write_b32 a225, 0
  v_accvgpr_write_b32 a226, 0
  v_accvgpr_write_b32 a227, 0
  v_accvgpr_write_b32 a228, 0
  v_accvgpr_write_b32 a229, 0
  v_accvgpr_write_b32 a230, 0
  v_accvgpr_write_b32 a231, 0
  v_accvgpr_write_b32 a232, 0
  v_accvgpr_write_b32 a233, 0
  v_accvgpr_write_b32 a234, 0
  v_accvgpr_write_b32 a235, 0
  v_accvgpr_write_b32 a236, 0
  v_accvgpr_write_b32 a237, 0
  v_accvgpr_write_b32 a238, 0
  v_accvgpr_write_b32 a239, 0
  v_accvgpr_write_b32 a240, 0
  v_accvgpr_write_b32 a241, 0
  v_accvgpr_write_b32 a242, 0
  v_accvgpr_write_b32 a243, 0
  v_accvgpr_write_b32 a244, 0
  v_accvgpr_write_b32 a245, 0
  v_accvgpr_write_b32 a246, 0
  v_accvgpr_write_b32 a247, 0
  v_accvgpr_write_b32 a248, 0
  v_accvgpr_write_b32 a249, 0
  v_accvgpr_write_b32 a250, 0
  v_accvgpr_write_b32 a251, 0
  v_accvgpr_write_b32 a252, 0
  v_accvgpr_write_b32 a253, 0
  v_accvgpr_write_b32 a254, 0
  v_accvgpr_write_b32 a255, 0
  s_cmp_lg_u32 s3, 0
  s_cbranch_scc1 L_wdo_114
  s_mov_b32 s7, 0
  v_mbcnt_lo_u32_b32 v8, -1, 0
  v_and_b32 v8, 3, v8
  v_lshlrev_b32 v8, 6, v8
L_wd_113:
  buffer_load_dword v9, v8, s[12:15], 0 offen offset:16 sc1
  s_waitcnt vmcnt(0)
  v_cmp_ne_u32 vcc, 64, v9
  s_cbranch_vccz L_wdo_114
  s_add_u32 s7, s7, 1
  s_cmp_lt_u32 s7, 131072
  s_cbranch_scc1 L_wd_113
  s_mov_b32 s6, 40
  s_branch L_err
L_wdo_114:
  s_barrier
  v_and_b32 v4, 60, v4
  s_lshl_b32 s6, s5, 6
  s_add_u32 s34, s6, 0x710000
  s_mov_b32 s33, 1
  s_mov_b32 s7, 0
L_pl_115:
  buffer_load_dword v8, v4, s[8:11], s34 offen offset:0 sc1
  s_waitcnt vmcnt(0)
  v_cmp_gt_u32 vcc, s33, v8
  s_cbranch_vccz L_plo_116
  s_add_u32 s7, s7, 1
  s_cmp_lt_u32 s7, 131072
  s_cbranch_scc1 L_pl_115
  s_mov_b32 s6, 41
  s_branch L_err
L_plo_116:
  s_mul_i32 s34, s5, 73728
  s_mul_i32 s35, s3, 18432
  s_add_u32 s34, s34, s35
  s_add_u32 s34, s34, 0x400000
  s_add_u32 m0, s35, 0
  s_add_u32 s6, s34, 0
  buffer_load_dwordx4 v0, s[8:11], s6 offen offset:0 lds
  buffer_load_dwordx4 v0, s[8:11], s6 offen offset:1024 lds
  buffer_load_dwordx4 v0, s[8:11], s6 offen offset:2048 lds
  buffer_load_dwordx4 v0, s[8:11], s6 offen offset:3072 lds
  s_add_u32 m0, s35, 4096
  s_add_u32 s6, s34, 4096
  buffer_load_dwordx4 v0, s[8:11], s6 offen offset:0 lds
  buffer_load_dwordx4 v0, s[8:11], s6 offen offset:1024 lds
  buffer_load_dwordx4 v0, s[8:11], s6 offen offset:2048 lds
  buffer_load_dwordx4 v0, s[8:11], s6 offen offset:3072 lds
  s_add_u32 m0, s35, 8192
  s_add_u32 s6, s34, 8192
  buffer_load_dwordx4 v0, s[8:11], s6 offen offset:0 lds
  buffer_load_dwordx4 v0, s[8:11], s6 offen offset:1024 lds
  buffer_load_dwordx4 v0, s[8:11], s6 offen offset:2048 lds
  buffer_load_dwordx4 v0, s[8:11], s6 offen offset:3072 lds
  s_add_u32 m0, s35, 12288
  s_add_u32 s6, s34, 12288
  buffer_load_dwordx4 v0, s[8:11], s6 offen offset:0 lds
  buffer_load_dwordx4 v0, s[8:11], s6 offen offset:1024 lds
  buffer_load_dwordx4 v0, s[8:11], s6 offen offset:2048 lds
  buffer_load_dwordx4 v0, s[8:11], s6 offen offset:3072 lds
  s_add_u32 m0, s35, 16384
  s_add_u32 s6, s34, 16384
  buffer_load_dwordx4 v0, s[8:11], s6 offen offset:0 lds
  buffer_load_dwordx4 v0, s[8:11], s6 offen offset:1024 lds
  s_mov_b32 s32, 0
  s_waitcnt vmcnt(0) lgkmcnt(0)
  s_barrier
  s_cmp_ge_u32 s3, 2
  s_cbranch_scc1 L_c_res
  s_mov_b32 s16, s76
  s_mov_b32 s17, s77
  s_mov_b32 s18, 0x400
  s_mov_b32 s19, 0x20000
  v_bfe_u32 v16, v0, 4, 4
  v_lshrrev_b32 v17, 8, v0
  v_lshrrev_b32 v18, 7, v0
  s_lshl_b32 s6, s5, 5
  s_lshl_b32 s7, s3, 4
  s_add_u32 s6, s6, s7
  v_lshlrev_b32 v19, 1, v18
  buffer_load_ushort v12, v19, s[16:19], s6 offen
  s_mul_i32 s6, s3, 36864
  v_mul_u32_u24 v19, 4608, v18
  v_add_u32 v19, s6, v19
  ds_read_b32 v11, v19 offset:4576
  s_add_u32 s6, s6, 480
  v_lshlrev_b32 v19, 5, v16
  v_sub_u32 v19, s6, v19
  v_lshl_add_u32 v4, v17, 4, v19
  s_mul_i32 s6, s3, 33024
  s_add_u32 s6, s6, 73728
  v_lshlrev_b32 v19, 1, v16
  v_lshl_add_u32 v19, v17, 4, v19
  v_add_u32 v5, s6, v19
  v_mul_u32_u24 v19, 4128, v18
  v_bfe_u32 v20, v0, 1, 6
  v_add3_u32 v19, v19, v20, s6
  v_add_u32 v8, 32, v19
  s_lshl_b32 s6, s3, 10
  s_add_u32 s6, s6, 147968
  v_add_u32 v7, s6, v0
  v_and_b32 v19, 1, v16
  v_lshlrev_b32 v19, 6, v19
  v_lshl_add_u32 v19, v17, 4, v19
  v_add_u32 v6, s6, v19
  v_lshrrev_b32 v10, 1, v0
  s_lshl_b32 s6, s3, 9
  s_add_u32 s35, s6, 139776
  s_lshl_b32 s7, s5, 10
  s_add_u32 s6, s6, s7
  s_add_u32 s40, s6, 0x200000
  s_lshl_b32 s6, s5, 3
  s_lshl_b32 s7, s3, 2
  s_add_u32 s6, s6, s7
  s_add_u32 s39, s6, 0x710800
  v_add_u32 v14, s7, v2
  s_waitcnt vmcnt(0) lgkmcnt(0)
  v_lshlrev_b32 v12, 16, v12
  v_and_b32 v15, 2, v5
  v_and_b32 v5, -4, v5
  v_add_u32 v104, 0, v5
  v_add_u32 v105, 4128, v5
  v_add_u32 v106, 8256, v5
  v_add_u32 v107, 12384, v5
  v_add_u32 v108, 16512, v5
  v_add_u32 v109, 20640, v5
  v_add_u32 v110, 24768, v5
  v_add_u32 v111, 28896, v5
L_c_conv0:
  s_add_u32 s33, s32, 1
  s_and_b32 s6, s32, 7
  s_lshl_b32 s7, s6, 10
  s_add_u32 s7, s7, s35
  v_add_u32 v9, s7, v10
  s_lshl_b32 s6, s6, 1
  s_lshl_b32 s42, 0x30003, s6
  v_mov_b32 v13, s33
  ds_read_b128 v[48:51], v4 offset:3584
  ds_read_b128 v[52:55], v4 offset:8192
  ds_read_b128 v[56:59], v4 offset:12800
  ds_read_b128 v[60:63], v4 offset:17408
  ds_read_b128 v[64:67], v4 offset:22016
  ds_read_b128 v[68:71], v4 offset:26624
  ds_read_b128 v[72:75], v4 offset:31232
  ds_read_b128 v[76:79], v4 offset:35840
  s_mov_b32 s7, 0
L_lw_117:
  ds_read_b32 v88, v2 offset:0
  s_waitcnt lgkmcnt(0)
  v_cmp_gt_i32 vcc, s33, v88
  s_cbranch_vccz L_lwo_118
  s_add_u32 s7, s7, 1
  s_cmp_lt_u32 s7, 131072
  s_cbranch_scc1 L_lw_117
  s_mov_b32 s6, 42
  s_branch L_err
L_lwo_118:
  ds_read2_b32 v[112:113], v104 offset0:0 offset1:1
  ds_read2_b32 v[114:115], v104 offset0:2 offset1:3
  ds_read_b32 v116, v104 offset:16
  ds_read2_b32 v[118:119], v105 offset0:0 offset1:1
  ds_read2_b32 v[120:121], v105 offset0:2 offset1:3
  ds_read_b32 v122, v105 offset:16
  ds_read2_b32 v[124:125], v106 offset0:0 offset1:1
  ds_read2_b32 v[126:127], v106 offset0:2 offset1:3
  ds_read_b32 v128, v106 offset:16
  ds_read2_b32 v[130:131], v107 offset0:0 offset1:1
  ds_read2_b32 v[132:133], v107 offset0:2 offset1:3
  ds_read_b32 v134, v107 offset:16
  s_waitcnt lgkmcnt(9)
  v_alignbyte_b32 v16, v113, v112, v15
  v_alignbyte_b32 v17, v114, v113, v15
  v_alignbyte_b32 v18, v115, v114, v15
  v_alignbyte_b32 v19, v116, v115, v15
  ds_read2_b32 v[112:113], v108 offset0:0 offset1:1
  ds_read2_b32 v[114:115], v108 offset0:2 offset1:3
  ds_read_b32 v116, v108 offset:16
  s_waitcnt lgkmcnt(9)
  v_alignbyte_b32 v20, v119, v118, v15
  v_alignbyte_b32 v21, v120, v119, v15
  v_alignbyte_b32 v22, v121, v120, v15
  v_alignbyte_b32 v23, v122, v121, v15
  ds_read2_b32 v[118:119], v109 offset0:0 offset1:1
  ds_read2_b32 v[120:121], v109 offset0:2 offset1:3
  ds_read_b32 v122, v109 offset:16
  v_mfma_f32_16x16x32_bf16 a[0:3], v[16:19], v[48:51], a[0:3]
  s_waitcnt lgkmcnt(9)
  v_alignbyte_b32 v24, v125, v124, v15
  v_alignbyte_b32 v25, v126, v125, v15
  v_alignbyte_b32 v26, v127, v126, v15
  v_alignbyte_b32 v27, v128, v127, v15
  ds_read2_b32 v[124:125], v110 offset0:0 offset1:1
  ds_read2_b32 v[126:127], v110 offset0:2 offset1:3
  ds_read_b32 v128, v110 offset:16
  v_mfma_f32_16x16x32_bf16 a[32:35], v[20:23], v[52:55], a[32:35]
  s_waitcnt lgkmcnt(9)
  v_alignbyte_b32 v28, v131, v130, v15
  v_alignbyte_b32 v29, v132, v131, v15
  v_alignbyte_b32 v30, v133, v132, v15
  v_alignbyte_b32 v31, v134, v133, v15
  ds_read2_b32 v[130:131], v111 offset0:0 offset1:1
  ds_read2_b32 v[132:133], v111 offset0:2 offset1:3
  ds_read_b32 v134, v111 offset:16
  v_mfma_f32_16x16x32_bf16 a[64:67], v[24:27], v[56:59], a[64:67]
  s_waitcnt lgkmcnt(9)
  v_alignbyte_b32 v32, v113, v112, v15
  v_alignbyte_b32 v33, v114, v113, v15
  v_alignbyte_b32 v34, v115, v114, v15
  v_alignbyte_b32 v35, v116, v115, v15
  ds_read_b64 v[84:85], v8
  ds_read_b64 v[86:87], v9
  v_mfma_f32_16x16x32_bf16 a[96:99], v[28:31], v[60:63], a[96:99]
  s_waitcnt lgkmcnt(8)
  v_alignbyte_b32 v36, v119, v118, v15
  v_alignbyte_b32 v37, v120, v119, v15
  v_alignbyte_b32 v38, v121, v120, v15
  v_alignbyte_b32 v39, v122, v121, v15
  v_mfma_f32_16x16x32_bf16 a[128:131], v[32:35], v[64:67], a[128:131]
  s_waitcnt lgkmcnt(5)
  v_alignbyte_b32 v40, v125, v124, v15
  v_alignbyte_b32 v41, v126, v125, v15
  v_alignbyte_b32 v42, v127, v126, v15
  v_alignbyte_b32 v43, v128, v127, v15
  v_mfma_f32_16x16x32_bf16 a[160:163], v[36:39], v[68:71], a[160:163]
  s_waitcnt lgkmcnt(2)
  v_alignbyte_b32 v44, v131, v130, v15
  v_alignbyte_b32 v45, v132, v131, v15
  v_alignbyte_b32 v46, v133, v132, v15
  v_alignbyte_b32 v47, v134, v133, v15
  v_mfma_f32_16x16x32_bf16 a[192:195], v[40:43], v[72:75], a[192:195]
  s_nop 0
  v_mfma_f32_16x16x32_bf16 a[224:227], v[44:47], v[76:79], a[224:227]
  s_waitcnt lgkmcnt(0)
  ds_read_b128 v[48:51], v4 offset:3072
  ds_read_b128 v[52:55], v4 offset:7680
  ds_read_b128 v[56:59], v4 offset:12288
  ds_read_b128 v[60:63], v4 offset:16896
  ds_read_b128 v[64:67], v4 offset:21504
  ds_read_b128 v[68:71], v4 offset:26112
  ds_read_b128 v[72:75], v4 offset:30720
  ds_read_b128 v[76:79], v4 offset:35328
  s_mov_b32 exec_lo, s42
  s_mov_b32 exec_hi, s42
  ds_write_b128 v6, a[0:3] offset:0
  ds_write_b128 v6, a[32:35] offset:128
  ds_write_b128 v6, a[64:67] offset:256
  ds_write_b128 v6, a[96:99] offset:384
  ds_write_b128 v6, a[128:131] offset:512
  ds_write_b128 v6, a[160:163] offset:640
  ds_write_b128 v6, a[192:195] offset:768
  ds_write_b128 v6, a[224:227] offset:896
  s_mov_b64 exec, -1
  ds_read_b128 v[80:83], v7
  ds_write_b32 v14, v13 offset:8
  v_lshlrev_b32 v88, 16, v84
  v_and_b32 v89, 0xffff0000, v84
  v_lshlrev_b32 v90, 16, v85
  v_and_b32 v91, 0xffff0000, v85
  v_lshlrev_b32 v96, 16, v86
  v_and_b32 v97, 0xffff0000, v86
  v_lshlrev_b32 v98, 16, v87
  v_and_b32 v99, 0xffff0000, v87
  v_mul_f32 v92, v88, v12
  v_mul_f32 v93, v89, v12
  v_mul_f32 v94, v90, v12
  v_mul_f32 v95, v91, v12
  v_cvt_pk_bf16_f32 v84, v92, v93
  v_cvt_pk_bf16_f32 v85, v94, v95
  v_lshlrev_b32 v92, 16, v84
  v_and_b32 v93, 0xffff0000, v84
  v_lshlrev_b32 v94, 16, v85
  v_and_b32 v95, 0xffff0000, v85
  s_waitcnt lgkmcnt(1)
  v_fmac_f32 v80, v88, v11
  v_fmac_f32 v81, v89, v11
  v_fmac_f32 v82, v90, v11
  v_fmac_f32 v83, v91, v11
  v_cvt_pk_bf16_f32 v84, v80, v81
  v_cvt_pk_bf16_f32 v85, v82, v83
  v_lshlrev_b32 v80, 16, v84
  v_and_b32 v81, 0xffff0000, v84
  v_lshlrev_b32 v82, 16, v85
  v_and_b32 v83, 0xffff0000, v85
  v_add_f32 v80, v80, v92
  v_add_f32 v81, v81, v93
  v_add_f32 v82, v82, v94
  v_add_f32 v83, v83, v95
  v_cvt_pk_bf16_f32 v84, v80, v81
  v_cvt_pk_bf16_f32 v85, v82, v83
  v_lshlrev_b32 v80, 16, v84
  v_and_b32 v81, 0xffff0000, v84
  v_lshlrev_b32 v82, 16, v85
  v_and_b32 v83, 0xffff0000, v85
  v_add_f32 v80, v80, v96
  v_add_f32 v81, v81, v97
  v_add_f32 v82, v82, v98
  v_add_f32 v83, v83, v99
  v_cvt_pk_bf16_f32 v84, v80, v81
  v_cvt_pk_bf16_f32 v85, v82, v83
  buffer_store_dwordx2 v[84:85], v10, s[8:11], s40 offen sc1
  v_mfma_f32_16x16x32_bf16 a[4:7], v[16:19], v[48:51], a[4:7]
  ds_read_b128 v[48:51], v4 offset:2560
  v_mfma_f32_16x16x32_bf16 a[36:39], v[20:23], v[52:55], a[36:39]
  ds_read_b128 v[52:55], v4 offset:7168
  v_mfma_f32_16x16x32_bf16 a[68:71], v[24:27], v[56:59], a[68:71]
  ds_read_b128 v[56:59], v4 offset:11776
  v_mfma_f32_16x16x32_bf16 a[100:103], v[28:31], v[60:63], a[100:103]
  ds_read_b128 v[60:63], v4 offset:16384
  v_mfma_f32_16x16x32_bf16 a[132:135], v[32:35], v[64:67], a[132:135]
  ds_read_b128 v[64:67], v4 offset:20992
  v_mfma_f32_16x16x32_bf16 a[164:167], v[36:39], v[68:71], a[164:167]
  ds_read_b128 v[68:71], v4 offset:25600
  v_mfma_f32_16x16x32_bf16 a[196:199], v[40:43], v[72:75], a[196:199]
  ds_read_b128 v[72:75], v4 offset:30208
  v_mfma_f32_16x16x32_bf16 a[228:231], v[44:47], v[76:79], a[228:231]
  ds_read_b128 v[76:79], v4 offset:34816
  s_waitcnt lgkmcnt(7)
  v_mfma_f32_16x16x32_bf16 a[8:11], v[16:19], v[48:51], a[8:11]
  ds_read_b128 v[48:51], v4 offset:2048
  s_waitcnt lgkmcnt(7)
  v_mfma_f32_16x16x32_bf16 a[40:43], v[20:23], v[52:55], a[40:43]
  ds_read_b128 v[52:55], v4 offset:6656
  s_waitcnt lgkmcnt(7)
  v_mfma_f32_16x16x32_bf16 a[72:75], v[24:27], v[56:59], a[72:75]
  ds_read_b128 v[56:59], v4 offset:11264
  s_waitcnt lgkmcnt(7)
  v_mfma_f32_16x16x32_bf16 a[104:107], v[28:31], v[60:63], a[104:107]
  ds_read_b128 v[60:63], v4 offset:15872
  s_waitcnt lgkmcnt(7)
  v_mfma_f32_16x16x32_bf16 a[136:139], v[32:35], v[64:67], a[136:139]
  ds_read_b128 v[64:67], v4 offset:20480
  s_waitcnt lgkmcnt(7)
  v_mfma_f32_16x16x32_bf16 a[168:171], v[36:39], v[68:71], a[168:171]
  ds_read_b128 v[68:71], v4 offset:25088
  s_waitcnt lgkmcnt(7)
  v_mfma_f32_16x16x32_bf16 a[200:203], v[40:43], v[72:75], a[200:203]
  ds_read_b128 v[72:75], v4 offset:29696
  s_waitcnt lgkmcnt(7)
  v_mfma_f32_16x16x32_bf16 a[232:235], v[44:47], v[76:79], a[232:235]
  ds_read_b128 v[76:79], v4 offset:34304
  s_waitcnt lgkmcnt(7)
  v_mfma_f32_16x16x32_bf16 a[12:15], v[16:19], v[48:51], a[12:15]
  ds_read_b128 v[48:51], v4 offset:1536
  s_waitcnt lgkmcnt(7)
  v_mfma_f32_16x16x32_bf16 a[44:47], v[20:23], v[52:55], a[44:47]
  ds_read_b128 v[52:55], v4 offset:6144
  s_waitcnt lgkmcnt(7)
  v_mfma_f32_16x16x32_bf16 a[76:79], v[24:27], v[56:59], a[76:79]
  ds_read_b128 v[56:59], v4 offset:10752
  s_waitcnt lgkmcnt(7)
  v_mfma_f32_16x16x32_bf16 a[108:111], v[28:31], v[60:63], a[108:111]
  ds_read_b128 v[60:63], v4 offset:15360
  s_waitcnt lgkmcnt(7)
  v_mfma_f32_16x16x32_bf16 a[140:143], v[32:35], v[64:67], a[140:143]
  ds_read_b128 v[64:67], v4 offset:19968
  s_waitcnt lgkmcnt(7)
  v_mfma_f32_16x16x32_bf16 a[172:175], v[36:39], v[68:71], a[172:175]
  ds_read_b128 v[68:71], v4 offset:24576
  s_waitcnt lgkmcnt(7)
  v_mfma_f32_16x16x32_bf16 a[204:207], v[40:43], v[72:75], a[204:207]
  ds_read_b128 v[72:75], v4 offset:29184
  s_waitcnt lgkmcnt(7)
  v_mfma_f32_16x16x32_bf16 a[236:239], v[44:47], v[76:79], a[236:239]
  ds_read_b128 v[76:79], v4 offset:33792
  s_waitcnt lgkmcnt(7)
  v_mfma_f32_16x16x32_bf16 a[16:19], v[16:19], v[48:51], a[16:19]
  ds_read_b128 v[48:51], v4 offset:1024
  s_waitcnt lgkmcnt(7)
  v_mfma_f32_16x16x32_bf16 a[48:51], v[20:23], v[52:55], a[48:51]
  ds_read_b128 v[52:55], v4 offset:5632
  s_waitcnt lgkmcnt(7)
  v_mfma_f32_16x16x32_bf16 a[80:83], v[24:27], v[56:59], a[80:83]
  ds_read_b128 v[56:59], v4 offset:10240
  s_waitcnt lgkmcnt(7)
  v_mfma_f32_16x16x32_bf16 a[112:115], v[28:31], v[60:63], a[112:115]
  ds_read_b128 v[60:63], v4 offset:14848
  s_waitcnt lgkmcnt(7)
  v_mfma_f32_16x16x32_bf16 a[144:147], v[32:35], v[64:67], a[144:147]
  ds_read_b128 v[64:67], v4 offset:19456
  s_waitcnt lgkmcnt(7)
  v_mfma_f32_16x16x32_bf16 a[176:179], v[36:39], v[68:71], a[176:179]
  ds_read_b128 v[68:71], v4 offset:24064
  s_waitcnt lgkmcnt(7)
  v_mfma_f32_16x16x32_bf16 a[208:211], v[40:43], v[72:75], a[208:211]
  ds_read_b128 v[72:75], v4 offset:28672
  s_waitcnt lgkmcnt(7)
  v_mfma_f32_16x16x32_bf16 a[240:243], v[44:47], v[76:79], a[240:243]
  ds_read_b128 v[76:79], v4 offset:33280
  s_waitcnt lgkmcnt(7)
  v_mfma_f32_16x16x32_bf16 a[20:23], v[16:19], v[48:51], a[20:23]
  ds_read_b128 v[48:51], v4 offset:512
  s_waitcnt lgkmcnt(7)
  v_mfma_f32_16x16x32_bf16 a[52:55], v[20:23], v[52:55], a[52:55]
  ds_read_b128 v[52:55], v4 offset:5120
  s_waitcnt lgkmcnt(7)
  v_mfma_f32_16x16x32_bf16 a[84:87], v[24:27], v[56:59], a[84:87]
  ds_read_b128 v[56:59], v4 offset:9728
  s_waitcnt lgkmcnt(7)
  v_mfma_f32_16x16x32_bf16 a[116:119], v[28:31], v[60:63], a[116:119]
  ds_read_b128 v[60:63], v4 offset:14336
  s_waitcnt lgkmcnt(7)
  v_mfma_f32_16x16x32_bf16 a[148:151], v[32:35], v[64:67], a[148:151]
  ds_read_b128 v[64:67], v4 offset:18944
  s_waitcnt lgkmcnt(7)
  v_mfma_f32_16x16x32_bf16 a[180:183], v[36:39], v[68:71], a[180:183]
  ds_read_b128 v[68:71], v4 offset:23552
  s_waitcnt lgkmcnt(7)
  v_mfma_f32_16x16x32_bf16 a[212:215], v[40:43], v[72:75], a[212:215]
  ds_read_b128 v[72:75], v4 offset:28160
  s_waitcnt lgkmcnt(7)
  v_mfma_f32_16x16x32_bf16 a[244:247], v[44:47], v[76:79], a[244:247]
  ds_read_b128 v[76:79], v4 offset:32768
  s_waitcnt lgkmcnt(7)
  v_mfma_f32_16x16x32_bf16 a[24:27], v[16:19], v[48:51], a[24:27]
  ds_read_b128 v[48:51], v4 offset:0
  s_waitcnt lgkmcnt(7)
  v_mfma_f32_16x16x32_bf16 a[56:59], v[20:23], v[52:55], a[56:59]
  ds_read_b128 v[52:55], v4 offset:4608
  s_waitcnt lgkmcnt(7)
  v_mfma_f32_16x16x32_bf16 a[88:91], v[24:27], v[56:59], a[88:91]
  ds_read_b128 v[56:59], v4 offset:9216
  s_waitcnt lgkmcnt(7)
  v_mfma_f32_16x16x32_bf16 a[120:123], v[28:31], v[60:63], a[120:123]
  ds_read_b128 v[60:63], v4 offset:13824
  s_waitcnt lgkmcnt(7)
  v_mfma_f32_16x16x32_bf16 a[152:155], v[32:35], v[64:67], a[152:155]
  ds_read_b128 v[64:67], v4 offset:18432
  s_waitcnt lgkmcnt(7)
  v_mfma_f32_16x16x32_bf16 a[184:187], v[36:39], v[68:71], a[184:187]
  ds_read_b128 v[68:71], v4 offset:23040
  s_waitcnt lgkmcnt(7)
  v_mfma_f32_16x16x32_bf16 a[216:219], v[40:43], v[72:75], a[216:219]
  ds_read_b128 v[72:75], v4 offset:27648
  s_waitcnt lgkmcnt(7)
  v_mfma_f32_16x16x32_bf16 a[248:251], v[44:47], v[76:79], a[248:251]
  ds_read_b128 v[76:79], v4 offset:32256
  s_waitcnt lgkmcnt(7)
  v_mfma_f32_16x16x32_bf16 a[28:31], v[16:19], v[48:51], a[28:31]
  s_waitcnt lgkmcnt(6)
  v_mfma_f32_16x16x32_bf16 a[60:63], v[20:23], v[52:55], a[60:63]
  s_waitcnt lgkmcnt(5)
  v_mfma_f32_16x16x32_bf16 a[92:95], v[24:27], v[56:59], a[92:95]
  s_waitcnt lgkmcnt(4)
  v_mfma_f32_16x16x32_bf16 a[124:127], v[28:31], v[60:63], a[124:127]
  s_waitcnt lgkmcnt(3)
  v_mfma_f32_16x16x32_bf16 a[156:159], v[32:35], v[64:67], a[156:159]
  s_waitcnt lgkmcnt(2)
  v_mfma_f32_16x16x32_bf16 a[188:191], v[36:39], v[68:71], a[188:191]
  s_waitcnt lgkmcnt(1)
  v_mfma_f32_16x16x32_bf16 a[220:223], v[40:43], v[72:75], a[220:223]
  s_waitcnt lgkmcnt(0)
  v_mfma_f32_16x16x32_bf16 a[252:255], v[44:47], v[76:79], a[252:255]
  v_add_u32 v104, 64, v104
  v_add_u32 v105, 64, v105
  v_add_u32 v106, 64, v106
  v_add_u32 v107, 64, v107
  v_add_u32 v108, 64, v108
  v_add_u32 v109, 64, v109
  v_add_u32 v110, 64, v110
  v_add_u32 v111, 64, v111
  v_add_u32 v4, 64, v4
  v_add_u32 v8, 64, v8
  s_add_u32 s40, s40, 0x8000
  s_waitcnt vmcnt(0)
  s_mov_b64 exec, 1
  buffer_store_dword v13, v1, s[8:11], s39 offen sc1
  s_mov_b64 exec, -1
  s_add_u32 s32, s32, 1
  s_and_b32 s6, s32, 7
  s_cbranch_scc1 L_c_conv0
L_c_conv1:
  s_add_u32 s33, s32, 1
  s_and_b32 s6, s32, 7
  s_lshl_b32 s7, s6, 10
  s_add_u32 s7, s7, s35
  v_add_u32 v9, s7, v10
  s_lshl_b32 s6, s6, 1
  s_lshl_b32 s42, 0x30003, s6
  v_mov_b32 v13, s33
  ds_read_b128 v[48:51], v4 offset:3072
  ds_read_b128 v[52:55], v4 offset:7680
  ds_read_b128 v[56:59], v4 offset:12288
  ds_read_b128 v[60:63], v4 offset:16896
  ds_read_b128 v[64:67], v4 offset:21504
  ds_read_b128 v[68:71], v4 offset:26112
  ds_read_b128 v[72:75], v4 offset:30720
  ds_read_b128 v[76:79], v4 offset:35328
  s_mov_b32 s7, 0
L_lw_119:
  ds_read_b32 v88, v2 offset:0
  s_waitcnt lgkmcnt(0)
  v_cmp_gt_i32 vcc, s33, v88
  s_cbranch_vccz L_lwo_120
  s_add_u32 s7, s7, 1
  s_cmp_lt_u32 s7, 131072
  s_cbranch_scc1 L_lw_119
  s_mov_b32 s6, 42
  s_branch L_err
L_lwo_120:
  ds_read2_b32 v[112:113], v104 offset0:0 offset1:1
  ds_read2_b32 v[114:115], v104 offset0:2 offset1:3
  ds_read_b32 v116, v104 offset:16
  ds_read2_b32 v[118:119], v105 offset0:0 offset1:1
  ds_read2_b32 v[120:121], v105 offset0:2 offset1:3
  ds_read_b32 v122, v105 offset:16
  ds_read2_b32 v[124:125], v106 offset0:0 offset1:1
  ds_read2_b32 v[126:127], v106 offset0:2 offset1:3
  ds_read_b32 v128, v106 offset:16
  ds_read2_b32 v[130:131], v107 offset0:0 offset1:1
  ds_read2_b32 v[132:133], v107 offset0:2 offset1:3
  ds_read_b32 v134, v107 offset:16
  s_waitcnt lgkmcnt(9)
  v_alignbyte_b32 v16, v113, v112, v15
  v_alignbyte_b32 v17, v114, v113, v15
  v_alignbyte_b32 v18, v115, v114, v15
  v_alignbyte_b32 v19, v116, v115, v15
  ds_read2_b32 v[112:113], v108 offset0:0 offset1:1
  ds_read2_b32 v[114:115], v108 offset0:2 offset1:3
  ds_read_b32 v116, v108 offset:16
  s_waitcnt lgkmcnt(9)
  v_alignbyte_b32 v20, v119, v118, v15
  v_alignbyte_b32 v21, v120, v119, v15
  v_alignbyte_b32 v22, v121, v120, v15
  v_alignbyte_b32 v23, v122, v121, v15
  ds_read2_b32 v[118:119], v109 offset0:0 offset1:1
  ds_read2_b32 v[120:121], v109 offset0:2 offset1:3
  ds_read_b32 v122, v109 offset:16
  v_mfma_f32_16x16x32_bf16 a[4:7], v[16:19], v[48:51], a[4:7]
  s_waitcnt lgkmcnt(9)
  v_alignbyte_b32 v24, v125, v124, v15
  v_alignbyte_b32 v25, v126, v125, v15
  v_alignbyte_b32 v26, v127, v126, v15
  v_alignbyte_b32 v27, v128, v127, v15
  ds_read2_b32 v[124:125], v110 offset0:0 offset1:1
  ds_read2_b32 v[126:127], v110 offset0:2 offset1:3
  ds_read_b32 v128, v110 offset:16
  v_mfma_f32_16x16x32_bf16 a[36:39], v[20:23], v[52:55], a[36:39]
  s_waitcnt lgkmcnt(9)
  v_alignbyte_b32 v28, v131, v130, v15
  v_alignbyte_b32 v29, v132, v131, v15
  v_alignbyte_b32 v30, v133, v132, v15
  v_alignbyte_b32 v31, v134, v133, v15
  ds_read2_b32 v[130:131], v111 offset0:0 offset1:1
  ds_read2_b32 v[132:133], v111 offset0:2 offset1:3
  ds_read_b32 v134, v111 offset:16
  v_mfma_f32_16x16x32_bf16 a[68:71], v[24:27], v[56:59], a[68:71]
  s_waitcnt lgkmcnt(9)
  v_alignbyte_b32 v32, v113, v112, v15
  v_alignbyte_b32 v33, v114, v113, v15
  v_alignbyte_b32 v34, v115, v114, v15
  v_alignbyte_b32 v35, v116, v115, v15
  ds_read_b64 v[84:85], v8
  ds_read_b64 v[86:87], v9
  v_mfma_f32_16x16x32_bf16 a[100:103], v[28:31], v[60:63], a[100:103]
  s_waitcnt lgkmcnt(8)
  v_alignbyte_b32 v36, v119, v118, v15
  v_alignbyte_b32 v37, v120, v119, v15
  v_alignbyte_b32 v38, v121, v120, v15
  v_alignbyte_b32 v39, v122, v121, v15
  v_mfma_f32_16x16x32_bf16 a[132:135], v[32:35], v[64:67], a[132:135]
  s_waitcnt lgkmcnt(5)
  v_alignbyte_b32 v40, v125, v124, v15
  v_alignbyte_b32 v41, v126, v125, v15
  v_alignbyte_b32 v42, v127, v126, v15
  v_alignbyte_b32 v43, v128, v127, v15
  v_mfma_f32_16x16x32_bf16 a[164:167], v[36:39], v[68:71], a[164:167]
  s_waitcnt lgkmcnt(2)
  v_alignbyte_b32 v44, v131, v130, v15
  v_alignbyte_b32 v45, v132, v131, v15
  v_alignbyte_b32 v46, v133, v132, v15
  v_alignbyte_b32 v47, v134, v133, v15
  v_mfma_f32_16x16x32_bf16 a[196:199], v[40:43], v[72:75], a[196:199]
  s_nop 0
  v_mfma_f32_16x16x32_bf16 a[228:231], v[44:47], v[76:79], a[228:231]
  s_waitcnt lgkmcnt(0)
  ds_read_b128 v[48:51], v4 offset:2560
  ds_read_b128 v[52:55], v4 offset:7168
  ds_read_b128 v[56:59], v4 offset:11776
  ds_read_b128 v[60:63], v4 offset:16384
  ds_read_b128 v[64:67], v4 offset:20992
  ds_read_b128 v[68:71], v4 offset:25600
  ds_read_b128 v[72:75], v4 offset:30208
  ds_read_b128 v[76:79], v4 offset:34816
  s_mov_b32 exec_lo, s42
  s_mov_b32 exec_hi, s42
  ds_write_b128 v6, a[4:7] offset:0
  ds_write_b128 v6, a[36:39] offset:128
  ds_write_b128 v6, a[68:71] offset:256
  ds_write_b128 v6, a[100:103] offset:384
  ds_write_b128 v6, a[132:135] offset:512
  ds_write_b128 v6, a[164:167] offset:640
  ds_write_b128 v6, a[196:199] offset:768
  ds_write_b128 v6, a[228:231] offset:896
  s_mov_b64 exec, -1
  ds_read_b128 v[80:83], v7
  ds_write_b32 v14, v13 offset:8
  v_lshlrev_b32 v88, 16, v84
  v_and_b32 v89, 0xffff0000, v84
  v_lshlrev_b32 v90, 16, v85
  v_and_b32 v91, 0xffff0000, v85
  v_lshlrev_b32 v96, 16, v86
  v_and_b32 v97, 0xffff0000, v86
  v_lshlrev_b32 v98, 16, v87
  v_and_b32 v99, 0xffff0000, v87
  v_mul_f32 v92, v88, v12
  v_mul_f32 v93, v89, v12
  v_mul_f32 v94, v90, v12
  v_mul_f32 v95, v91, v12
  v_cvt_pk_bf16_f32 v84, v92, v93
  v_cvt_pk_bf16_f32 v85, v94, v95
  v_lshlrev_b32 v92, 16, v84
  v_and_b32 v93, 0xffff0000, v84
  v_lshlrev_b32 v94, 16, v85
  v_and_b32 v95, 0xffff0000, v85
  s_waitcnt lgkmcnt(1)
  v_fmac_f32 v80, v88, v11
  v_fmac_f32 v81, v89, v11
  v_fmac_f32 v82, v90, v11
  v_fmac_f32 v83, v91, v11
  v_cvt_pk_bf16_f32 v84, v80, v81
  v_cvt_pk_bf16_f32 v85, v82, v83
  v_lshlrev_b32 v80, 16, v84
  v_and_b32 v81, 0xffff0000, v84
  v_lshlrev_b32 v82, 16, v85
  v_and_b32 v83, 0xffff0000, v85
  v_add_f32 v80, v80, v92
  v_add_f32 v81, v81, v93
  v_add_f32 v82, v82, v94
  v_add_f32 v83, v83, v95
  v_cvt_pk_bf16_f32 v84, v80, v81
  v_cvt_pk_bf16_f32 v85, v82, v83
  v_lshlrev_b32 v80, 16, v84
  v_and_b32 v81, 0xffff0000, v84
  v_lshlrev_b32 v82, 16, v85
  v_and_b32 v83, 0xffff0000, v85
  v_add_f32 v80, v80, v96
  v_add_f32 v81, v81, v97
  v_add_f32 v82, v82, v98
  v_add_f32 v83, v83, v99
  v_cvt_pk_bf16_f32 v84, v80, v81
  v_cvt_pk_bf16_f32 v85, v82, v83
  buffer_store_dwordx2 v[84:85], v10, s[8:11], s40 offen sc1
  v_mfma_f32_16x16x32_bf16 a[8:11], v[16:19], v[48:51], a[8:11]
  ds_read_b128 v[48:51], v4 offset:2048
  v_mfma_f32_16x16x32_bf16 a[40:43], v[20:23], v[52:55], a[40:43]
  ds_read_b128 v[52:55], v4 offset:6656
  v_mfma_f32_16x16x32_bf16 a[72:75], v[24:27], v[56:59], a[72:75]
  ds_read_b128 v[56:59], v4 offset:11264
  v_mfma_f32_16x16x32_bf16 a[104:107], v[28:31], v[60:63], a[104:107]
  ds_read_b128 v[60:63], v4 offset:15872
  v_mfma_f32_16x16x32_bf16 a[136:139], v[32:35], v[64:67], a[136:139]
  ds_read_b128 v[64:67], v4 offset:20480
  v_mfma_f32_16x16x32_bf16 a[168:171], v[36:39], v[68:71], a[168:171]
  ds_read_b128 v[68:71], v4 offset:25088
  v_mfma_f32_16x16x32_bf16 a[200:203], v[40:43], v[72:75], a[200:203]
  ds_read_b128 v[72:75], v4 offset:29696
  v_mfma_f32_16x16x32_bf16 a[232:235], v[44:47], v[76:79], a[232:235]
  ds_read_b128 v[76:79], v4 offset:34304
  s_waitcnt lgkmcnt(7)
  v_mfma_f32_16x16x32_bf16 a[12:15], v[16:19], v[48:51], a[12:15]
  ds_read_b128 v[48:51], v4 offset:1536
  s_waitcnt lgkmcnt(7)
  v_mfma_f32_16x16x32_bf16 a[44:47], v[20:23], v[52:55], a[44:47]
  ds_read_b128 v[52:55], v4 offset:6144
  s_waitcnt lgkmcnt(7)
  v_mfma_f32_16x16x32_bf16 a[76:79], v[24:27], v[56:59], a[76:79]
  ds_read_b128 v[56:59], v4 offset:10752
  s_waitcnt lgkmcnt(7)
  v_mfma_f32_16x16x32_bf16 a[108:111], v[28:31], v[60:63], a[108:111]
  ds_read_b128 v[60:63], v4 offset:15360
  s_waitcnt lgkmcnt(7)
  v_mfma_f32_16x16x32_bf16 a[140:143], v[32:35], v[64:67], a[140:143]
  ds_read_b128 v[64:67], v4 offset:19968
  s_waitcnt lgkmcnt(7)
  v_mfma_f32_16x16x32_bf16 a[172:175], v[36:39], v[68:71], a[172:175]
  ds_read_b128 v[68:71], v4 offset:24576
  s_waitcnt lgkmcnt(7)
  v_mfma_f32_16x16x32_bf16 a[204:207], v[40:43], v[72:75], a[204:207]
  ds_read_b128 v[72:75], v4 offset:29184
  s_waitcnt lgkmcnt(7)
  v_mfma_f32_16x16x32_bf16 a[236:239], v[44:47], v[76:79], a[236:239]
  ds_read_b128 v[76:79], v4 offset:33792
  s_waitcnt lgkmcnt(7)
  v_mfma_f32_16x16x32_bf16 a[16:19], v[16:19], v[48:51], a[16:19]
  ds_read_b128 v[48:51], v4 offset:1024
  s_waitcnt lgkmcnt(7)
  v_mfma_f32_16x16x32_bf16 a[48:51], v[20:23], v[52:55], a[48:51]
  ds_read_b128 v[52:55], v4 offset:5632
  s_waitcnt lgkmcnt(7)
  v_mfma_f32_16x16x32_bf16 a[80:83], v[24:27], v[56:59], a[80:83]
  ds_read_b128 v[56:59], v4 offset:10240
  s_waitcnt lgkmcnt(7)
  v_mfma_f32_16x16x32_bf16 a[112:115], v[28:31], v[60:63], a[112:115]
  ds_read_b128 v[60:63], v4 offset:14848
  s_waitcnt lgkmcnt(7)
  v_mfma_f32_16x16x32_bf16 a[144:147], v[32:35], v[64:67], a[144:147]
  ds_read_b128 v[64:67], v4 offset:19456
  s_waitcnt lgkmcnt(7)
  v_mfma_f32_16x16x32_bf16 a[176:179], v[36:39], v[68:71], a[176:179]
  ds_read_b128 v[68:71], v4 offset:24064
  s_waitcnt lgkmcnt(7)
  v_mfma_f32_16x16x32_bf16 a[208:211], v[40:43], v[72:75], a[208:211]
  ds_read_b128 v[72:75], v4 offset:28672
  s_waitcnt lgkmcnt(7)
  v_mfma_f32_16x16x32_bf16 a[240:243], v[44:47], v[76:79], a[240:243]
  ds_read_b128 v[76:79], v4 offset:33280
  s_waitcnt lgkmcnt(7)
  v_mfma_f32_16x16x32_bf16 a[20:23], v[16:19], v[48:51], a[20:23]
  ds_read_b128 v[48:51], v4 offset:512
  s_waitcnt lgkmcnt(7)
  v_mfma_f32_16x16x32_bf16 a[52:55], v[20:23], v[52:55], a[52:55]
  ds_read_b128 v[52:55], v4 offset:5120
  s_waitcnt lgkmcnt(7)
  v_mfma_f32_16x16x32_bf16 a[84:87], v[24:27], v[56:59], a[84:87]
  ds_read_b128 v[56:59], v4 offset:9728
  s_waitcnt lgkmcnt(7)
  v_mfma_f32_16x16x32_bf16 a[116:119], v[28:31], v[60:63], a[116:119]
  ds_read_b128 v[60:63], v4 offset:14336
  s_waitcnt lgkmcnt(7)
  v_mfma_f32_16x16x32_bf16 a[148:151], v[32:35], v[64:67], a[148:151]
  ds_read_b128 v[64:67], v4 offset:18944
  s_waitcnt lgkmcnt(7)
  v_mfma_f32_16x16x32_bf16 a[180:183], v[36:39], v[68:71], a[180:183]
  ds_read_b128 v[68:71], v4 offset:23552
  s_waitcnt lgkmcnt(7)
  v_mfma_f32_16x16x32_bf16 a[212:215], v[40:43], v[72:75], a[212:215]
  ds_read_b128 v[72:75], v4 offset:28160
  s_waitcnt lgkmcnt(7)
  v_mfma_f32_16x16x32_bf16 a[244:247], v[44:47], v[76:79], a[244:247]
  ds_read_b128 v[76:79], v4 offset:32768
  s_waitcnt lgkmcnt(7)
  v_mfma_f32_16x16x32_bf16 a[24:27], v[16:19], v[48:51], a[24:27]
  ds_read_b128 v[48:51], v4 offset:0
  s_waitcnt lgkmcnt(7)
  v_mfma_f32_16x16x32_bf16 a[56:59], v[20:23], v[52:55], a[56:59]
  ds_read_b128 v[52:55], v4 offset:4608
  s_waitcnt lgkmcnt(7)
  v_mfma_f32_16x16x32_bf16 a[88:91], v[24:27], v[56:59], a[88:91]
  ds_read_b128 v[56:59], v4 offset:9216
  s_waitcnt lgkmcnt(7)
  v_mfma_f32_16x16x32_bf16 a[120:123], v[28:31], v[60:63], a[120:123]
  ds_read_b128 v[60:63], v4 offset:13824
  s_waitcnt lgkmcnt(7)
  v_mfma_f32_16x16x32_bf16 a[152:155], v[32:35], v[64:67], a[152:155]
  ds_read_b128 v[64:67], v4 offset:18432
  s_waitcnt lgkmcnt(7)
  v_mfma_f32_16x16x32_bf16 a[184:187], v[36:39], v[68:71], a[184:187]
  ds_read_b128 v[68:71], v4 offset:23040
  s_waitcnt lgkmcnt(7)
  v_mfma_f32_16x16x32_bf16 a[216:219], v[40:43], v[72:75], a[216:219]
  ds_read_b128 v[72:75], v4 offset:27648
  s_waitcnt lgkmcnt(7)
  v_mfma_f32_16x16x32_bf16 a[248:251], v[44:47], v[76:79], a[248:251]
  ds_read_b128 v[76:79], v4 offset:32256
  s_waitcnt lgkmcnt(7)
  v_mfma_f32_16x16x32_bf16 a[28:31], v[16:19], v[48:51], a[28:31]
  s_waitcnt lgkmcnt(6)
  v_mfma_f32_16x16x32_bf16 a[60:63], v[20:23], v[52:55], a[60:63]
  s_waitcnt lgkmcnt(5)
  v_mfma_f32_16x16x32_bf16 a[92:95], v[24:27], v[56:59], a[92:95]
  s_waitcnt lgkmcnt(4)
  v_mfma_f32_16x16x32_bf16 a[124:127], v[28:31], v[60:63], a[124:127]
  s_waitcnt lgkmcnt(3)
  v_mfma_f32_16x16x32_bf16 a[156:159], v[32:35], v[64:67], a[156:159]
  s_waitcnt lgkmcnt(2)
  v_mfma_f32_16x16x32_bf16 a[188:191], v[36:39], v[68:71], a[188:191]
  s_waitcnt lgkmcnt(1)
  v_mfma_f32_16x16x32_bf16 a[220:223], v[40:43], v[72:75], a[220:223]
  s_waitcnt lgkmcnt(0)
  v_mfma_f32_16x16x32_bf16 a[252:255], v[44:47], v[76:79], a[252:255]
  v_add_u32 v104, 64, v104
  v_add_u32 v105, 64, v105
  v_add_u32 v106, 64, v106
  v_add_u32 v107, 64, v107
  v_add_u32 v108, 64, v108
  v_add_u32 v109, 64, v109
  v_add_u32 v110, 64, v110
  v_add_u32 v111, 64, v111
  v_add_u32 v4, 64, v4
  v_add_u32 v8, 64, v8
  s_add_u32 s40, s40, 0x8000
  s_waitcnt vmcnt(0)
  s_mov_b64 exec, 1
  buffer_store_dword v13, v1, s[8:11], s39 offen sc1
  s_mov_b64 exec, -1
  s_add_u32 s32, s32, 1
  s_and_b32 s6, s32, 7
  s_cbranch_scc1 L_c_conv1
L_c_conv2:
  s_add_u32 s33, s32, 1
  s_and_b32 s6, s32, 7
  s_lshl_b32 s7, s6, 10
  s_add_u32 s7, s7, s35
  v_add_u32 v9, s7, v10
  s_lshl_b32 s6, s6, 1
  s_lshl_b32 s42, 0x30003, s6
  v_mov_b32 v13, s33
  ds_read_b128 v[48:51], v4 offset:2560
  ds_read_b128 v[52:55], v4 offset:7168
  ds_read_b128 v[56:59], v4 offset:11776
  ds_read_b128 v[60:63], v4 offset:16384
  ds_read_b128 v[64:67], v4 offset:20992
  ds_read_b128 v[68:71], v4 offset:25600
  ds_read_b128 v[72:75], v4 offset:30208
  ds_read_b128 v[76:79], v4 offset:34816
  s_mov_b32 s7, 0
L_lw_121:
  ds_read_b32 v88, v2 offset:0
  s_waitcnt lgkmcnt(0)
  v_cmp_gt_i32 vcc, s33, v88
  s_cbranch_vccz L_lwo_122
  s_add_u32 s7, s7, 1
  s_cmp_lt_u32 s7, 131072
  s_cbranch_scc1 L_lw_121
  s_mov_b32 s6, 42
  s_branch L_err
L_lwo_122:
  ds_read2_b32 v[112:113], v104 offset0:0 offset1:1
  ds_read2_b32 v[114:115], v104 offset0:2 offset1:3
  ds_read_b32 v116, v104 offset:16
  ds_read2_b32 v[118:119], v105 offset0:0 offset1:1
  ds_read2_b32 v[120:121], v105 offset0:2 offset1:3
  ds_read_b32 v122, v105 offset:16
  ds_read2_b32 v[124:125], v106 offset0:0 offset1:1
  ds_read2_b32 v[126:127], v106 offset0:2 offset1:3
  ds_read_b32 v128, v106 offset:16
  ds_read2_b32 v[130:131], v107 offset0:0 offset1:1
  ds_read2_b32 v[132:133], v107 offset0:2 offset1:3
  ds_read_b32 v134, v107 offset:16
  s_waitcnt lgkmcnt(9)
  v_alignbyte_b32 v16, v113, v112, v15
  v_alignbyte_b32 v17, v114, v113, v15
  v_alignbyte_b32 v18, v115, v114, v15
  v_alignbyte_b32 v19, v116, v115, v15
  ds_read2_b32 v[112:113], v108 offset0:0 offset1:1
  ds_read2_b32 v[114:115], v108 offset0:2 offset1:3
  ds_read_b32 v116, v108 offset:16
  s_waitcnt lgkmcnt(9)
  v_alignbyte_b32 v20, v119, v118, v15
  v_alignbyte_b32 v21, v120, v119, v15
  v_alignbyte_b32 v22, v121, v120, v15
  v_alignbyte_b32 v23, v122, v121, v15
  ds_read2_b32 v[118:119], v109 offset0:0 offset1:1
  ds_read2_b32 v[120:121], v109 offset0:2 offset1:3
  ds_read_b32 v122, v109 offset:16
  v_mfma_f32_16x16x32_bf16 a[8:11], v[16:19], v[48:51], a[8:11]
  s_waitcnt lgkmcnt(9)
  v_alignbyte_b32 v24, v125, v124, v15
  v_alignbyte_b32 v25, v126, v125, v15
  v_alignbyte_b32 v26, v127, v126, v15
  v_alignbyte_b32 v27, v128, v127, v15
  ds_read2_b32 v[124:125], v110 offset0:0 offset1:1
  ds_read2_b32 v[126:127], v110 offset0:2 offset1:3
  ds_read_b32 v128, v110 offset:16
  v_mfma_f32_16x16x32_bf16 a[40:43], v[20:23], v[52:55], a[40:43]
  s_waitcnt lgkmcnt(9)
  v_alignbyte_b32 v28, v131, v130, v15
  v_alignbyte_b32 v29, v132, v131, v15
  v_alignbyte_b32 v30, v133, v132, v15
  v_alignbyte_b32 v31, v134, v133, v15
  ds_read2_b32 v[130:131], v111 offset0:0 offset1:1
  ds_read2_b32 v[132:133], v111 offset0:2 offset1:3
  ds_read_b32 v134, v111 offset:16
  v_mfma_f32_16x16x32_bf16 a[72:75], v[24:27], v[56:59], a[72:75]
  s_waitcnt lgkmcnt(9)
  v_alignbyte_b32 v32, v113, v112, v15
  v_alignbyte_b32 v33, v114, v113, v15
  v_alignbyte_b32 v34, v115, v114, v15
  v_alignbyte_b32 v35, v116, v115, v15
  ds_read_b64 v[84:85], v8
  ds_read_b64 v[86:87], v9
  v_mfma_f32_16x16x32_bf16 a[104:107], v[28:31], v[60:63], a[104:107]
  s_waitcnt lgkmcnt(8)
  v_alignbyte_b32 v36, v119, v118, v15
  v_alignbyte_b32 v37, v120, v119, v15
  v_alignbyte_b32 v38, v121, v120, v15
  v_alignbyte_b32 v39, v122, v121, v15
  v_mfma_f32_16x16x32_bf16 a[136:139], v[32:35], v[64:67], a[136:139]
  s_waitcnt lgkmcnt(5)
  v_alignbyte_b32 v40, v125, v124, v15
  v_alignbyte_b32 v41, v126, v125, v15
  v_alignbyte_b32 v42, v127, v126, v15
  v_alignbyte_b32 v43, v128, v127, v15
  v_mfma_f32_16x16x32_bf16 a[168:171], v[36:39], v[68:71], a[168:171]
  s_waitcnt lgkmcnt(2)
  v_alignbyte_b32 v44, v131, v130, v15
  v_alignbyte_b32 v45, v132, v131, v15
  v_alignbyte_b32 v46, v133, v132, v15
  v_alignbyte_b32 v47, v134, v133, v15
  v_mfma_f32_16x16x32_bf16 a[200:203], v[40:43], v[72:75], a[200:203]
  s_nop 0
  v_mfma_f32_16x16x32_bf16 a[232:235], v[44:47], v[76:79], a[232:235]
  s_waitcnt lgkmcnt(0)
  ds_read_b128 v[48:51], v4 offset:2048
  ds_read_b128 v[52:55], v4 offset:6656
  ds_read_b128 v[56:59], v4 offset:11264
  ds_read_b128 v[60:63], v4 offset:15872
  ds_read_b128 v[64:67], v4 offset:20480
  ds_read_b128 v[68:71], v4 offset:25088
  ds_read_b128 v[72:75], v4 offset:29696
  ds_read_b128 v[76:79], v4 offset:34304
  s_mov_b32 exec_lo, s42
  s_mov_b32 exec_hi, s42
  ds_write_b128 v6, a[8:11] offset:0
  ds_write_b128 v6, a[40:43] offset:128
  ds_write_b128 v6, a[72:75] offset:256
  ds_write_b128 v6, a[104:107] offset:384
  ds_write_b128 v6, a[136:139] offset:512
  ds_write_b128 v6, a[168:171] offset:640
  ds_write_b128 v6, a[200:203] offset:768
  ds_write_b128 v6, a[232:235] offset:896
  s_mov_b64 exec, -1
  ds_read_b128 v[80:83], v7
  ds_write_b32 v14, v13 offset:8
  v_lshlrev_b32 v88, 16, v84
  v_and_b32 v89, 0xffff0000, v84
  v_lshlrev_b32 v90, 16, v85
  v_and_b32 v91, 0xffff0000, v85
  v_lshlrev_b32 v96, 16, v86
  v_and_b32 v97, 0xffff0000, v86
  v_lshlrev_b32 v98, 16, v87
  v_and_b32 v99, 0xffff0000, v87
  v_mul_f32 v92, v88, v12
  v_mul_f32 v93, v89, v12
  v_mul_f32 v94, v90, v12
  v_mul_f32 v95, v91, v12
  v_cvt_pk_bf16_f32 v84, v92, v93
  v_cvt_pk_bf16_f32 v85, v94, v95
  v_lshlrev_b32 v92, 16, v84
  v_and_b32 v93, 0xffff0000, v84
  v_lshlrev_b32 v94, 16, v85
  v_and_b32 v95, 0xffff0000, v85
  s_waitcnt lgkmcnt(1)
  v_fmac_f32 v80, v88, v11
  v_fmac_f32 v81, v89, v11
  v_fmac_f32 v82, v90, v11
  v_fmac_f32 v83, v91, v11
  v_cvt_pk_bf16_f32 v84, v80, v81
  v_cvt_pk_bf16_f32 v85, v82, v83
  v_lshlrev_b32 v80, 16, v84
  v_and_b32 v81, 0xffff0000, v84
  v_lshlrev_b32 v82, 16, v85
  v_and_b32 v83, 0xffff0000, v85
  v_add_f32 v80, v80, v92
  v_add_f32 v81, v81, v93
  v_add_f32 v82, v82, v94
  v_add_f32 v83, v83, v95
  v_cvt_pk_bf16_f32 v84, v80, v81
  v_cvt_pk_bf16_f32 v85, v82, v83
  v_lshlrev_b32 v80, 16, v84
  v_and_b32 v81, 0xffff0000, v84
  v_lshlrev_b32 v82, 16, v85
  v_and_b32 v83, 0xffff0000, v85
  v_add_f32 v80, v80, v96
  v_add_f32 v81, v81, v97
  v_add_f32 v82, v82, v98
  v_add_f32 v83, v83, v99
  v_cvt_pk_bf16_f32 v84, v80, v81
  v_cvt_pk_bf16_f32 v85, v82, v83
  buffer_store_dwordx2 v[84:85], v10, s[8:11], s40 offen sc1
  v_mfma_f32_16x16x32_bf16 a[12:15], v[16:19], v[48:51], a[12:15]
  ds_read_b128 v[48:51], v4 offset:1536
  v_mfma_f32_16x16x32_bf16 a[44:47], v[20:23], v[52:55], a[44:47]
  ds_read_b128 v[52:55], v4 offset:6144
  v_mfma_f32_16x16x32_bf16 a[76:79], v[24:27], v[56:59], a[76:79]
  ds_read_b128 v[56:59], v4 offset:10752
  v_mfma_f32_16x16x32_bf16 a[108:111], v[28:31], v[60:63], a[108:111]
  ds_read_b128 v[60:63], v4 offset:15360
  v_mfma_f32_16x16x32_bf16 a[140:143], v[32:35], v[64:67], a[140:143]
  ds_read_b128 v[64:67], v4 offset:19968
  v_mfma_f32_16x16x32_bf16 a[172:175], v[36:39], v[68:71], a[172:175]
  ds_read_b128 v[68:71], v4 offset:24576
  v_mfma_f32_16x16x32_bf16 a[204:207], v[40:43], v[72:75], a[204:207]
  ds_read_b128 v[72:75], v4 offset:29184
  v_mfma_f32_16x16x32_bf16 a[236:239], v[44:47], v[76:79], a[236:239]
  ds_read_b128 v[76:79], v4 offset:33792
  s_waitcnt lgkmcnt(7)
  v_mfma_f32_16x16x32_bf16 a[16:19], v[16:19], v[48:51], a[16:19]
  ds_read_b128 v[48:51], v4 offset:1024
  s_waitcnt lgkmcnt(7)
  v_mfma_f32_16x16x32_bf16 a[48:51], v[20:23], v[52:55], a[48:51]
  ds_read_b128 v[52:55], v4 offset:5632
  s_waitcnt lgkmcnt(7)
  v_mfma_f32_16x16x32_bf16 a[80:83], v[24:27], v[56:59], a[80:83]
  ds_read_b128 v[56:59], v4 offset:10240
  s_waitcnt lgkmcnt(7)
  v_mfma_f32_16x16x32_bf16 a[112:115], v[28:31], v[60:63], a[112:115]
  ds_read_b128 v[60:63], v4 offset:14848
  s_waitcnt lgkmcnt(7)
  v_mfma_f32_16x16x32_bf16 a[144:147], v[32:35], v[64:67], a[144:147]
  ds_read_b128 v[64:67], v4 offset:19456
  s_waitcnt lgkmcnt(7)
  v_mfma_f32_16x16x32_bf16 a[176:179], v[36:39], v[68:71], a[176:179]
  ds_read_b128 v[68:71], v4 offset:24064
  s_waitcnt lgkmcnt(7)
  v_mfma_f32_16x16x32_bf16 a[208:211], v[40:43], v[72:75], a[208:211]
  ds_read_b128 v[72:75], v4 offset:28672
  s_waitcnt lgkmcnt(7)
  v_mfma_f32_16x16x32_bf16 a[240:243], v[44:47], v[76:79], a[240:243]
  ds_read_b128 v[76:79], v4 offset:33280
  s_waitcnt lgkmcnt(7)
  v_mfma_f32_16x16x32_bf16 a[20:23], v[16:19], v[48:51], a[20:23]
  ds_read_b128 v[48:51], v4 offset:512
  s_waitcnt lgkmcnt(7)
  v_mfma_f32_16x16x32_bf16 a[52:55], v[20:23], v[52:55], a[52:55]
  ds_read_b128 v[52:55], v4 offset:5120
  s_waitcnt lgkmcnt(7)
  v_mfma_f32_16x16x32_bf16 a[84:87], v[24:27], v[56:59], a[84:87]
  ds_read_b128 v[56:59], v4 offset:9728
  s_waitcnt lgkmcnt(7)
  v_mfma_f32_16x16x32_bf16 a[116:119], v[28:31], v[60:63], a[116:119]
  ds_read_b128 v[60:63], v4 offset:14336
  s_waitcnt lgkmcnt(7)
  v_mfma_f32_16x16x32_bf16 a[148:151], v[32:35], v[64:67], a[148:151]
  ds_read_b128 v[64:67], v4 offset:18944
  s_waitcnt lgkmcnt(7)
  v_mfma_f32_16x16x32_bf16 a[180:183], v[36:39], v[68:71], a[180:183]
  ds_read_b128 v[68:71], v4 offset:23552
  s_waitcnt lgkmcnt(7)
  v_mfma_f32_16x16x32_bf16 a[212:215], v[40:43], v[72:75], a[212:215]
  ds_read_b128 v[72:75], v4 offset:28160
  s_waitcnt lgkmcnt(7)
  v_mfma_f32_16x16x32_bf16 a[244:247], v[44:47], v[76:79], a[244:247]
  ds_read_b128 v[76:79], v4 offset:32768
  s_waitcnt lgkmcnt(7)
  v_mfma_f32_16x16x32_bf16 a[24:27], v[16:19], v[48:51], a[24:27]
  ds_read_b128 v[48:51], v4 offset:0
  s_waitcnt lgkmcnt(7)
  v_mfma_f32_16x16x32_bf16 a[56:59], v[20:23], v[52:55], a[56:59]
  ds_read_b128 v[52:55], v4 offset:4608
  s_waitcnt lgkmcnt(7)
  v_mfma_f32_16x16x32_bf16 a[88:91], v[24:27], v[56:59], a[88:91]
  ds_read_b128 v[56:59], v4 offset:9216
  s_waitcnt lgkmcnt(7)
  v_mfma_f32_16x16x32_bf16 a[120:123], v[28:31], v[60:63], a[120:123]
  ds_read_b128 v[60:63], v4 offset:13824
  s_waitcnt lgkmcnt(7)
  v_mfma_f32_16x16x32_bf16 a[152:155], v[32:35], v[64:67], a[152:155]
  ds_read_b128 v[64:67], v4 offset:18432
  s_waitcnt lgkmcnt(7)
  v_mfma_f32_16x16x32_bf16 a[184:187], v[36:39], v[68:71], a[184:187]
  ds_read_b128 v[68:71], v4 offset:23040
  s_waitcnt lgkmcnt(7)
  v_mfma_f32_16x16x32_bf16 a[216:219], v[40:43], v[72:75], a[216:219]
  ds_read_b128 v[72:75], v4 offset:27648
  s_waitcnt lgkmcnt(7)
  v_mfma_f32_16x16x32_bf16 a[248:251], v[44:47], v[76:79], a[248:251]
  ds_read_b128 v[76:79], v4 offset:32256
  s_waitcnt lgkmcnt(7)
  v_mfma_f32_16x16x32_bf16 a[28:31], v[16:19], v[48:51], a[28:31]
  s_waitcnt lgkmcnt(6)
  v_mfma_f32_16x16x32_bf16 a[60:63], v[20:23], v[52:55], a[60:63]
  s_waitcnt lgkmcnt(5)
  v_mfma_f32_16x16x32_bf16 a[92:95], v[24:27], v[56:59], a[92:95]
  s_waitcnt lgkmcnt(4)
  v_mfma_f32_16x16x32_bf16 a[124:127], v[28:31], v[60:63], a[124:127]
  s_waitcnt lgkmcnt(3)
  v_mfma_f32_16x16x32_bf16 a[156:159], v[32:35], v[64:67], a[156:159]
  s_waitcnt lgkmcnt(2)
  v_mfma_f32_16x16x32_bf16 a[188:191], v[36:39], v[68:71], a[188:191]
  s_waitcnt lgkmcnt(1)
  v_mfma_f32_16x16x32_bf16 a[220:223], v[40:43], v[72:75], a[220:223]
  s_waitcnt lgkmcnt(0)
  v_mfma_f32_16x16x32_bf16 a[252:255], v[44:47], v[76:79], a[252:255]
  v_add_u32 v104, 64, v104
  v_add_u32 v105, 64, v105
  v_add_u32 v106, 64, v106
  v_add_u32 v107, 64, v107
  v_add_u32 v108, 64, v108
  v_add_u32 v109, 64, v109
  v_add_u32 v110, 64, v110
  v_add_u32 v111, 64, v111
  v_add_u32 v4, 64, v4
  v_add_u32 v8, 64, v8
  s_add_u32 s40, s40, 0x8000
  s_waitcnt vmcnt(0)
  s_mov_b64 exec, 1
  buffer_store_dword v13, v1, s[8:11], s39 offen sc1
  s_mov_b64 exec, -1
  s_add_u32 s32, s32, 1
  s_and_b32 s6, s32, 7
  s_cbranch_scc1 L_c_conv2
L_c_conv3:
  s_add_u32 s33, s32, 1
  s_and_b32 s6, s32, 7
  s_lshl_b32 s7, s6, 10
  s_add_u32 s7, s7, s35
  v_add_u32 v9, s7, v10
  s_lshl_b32 s6, s6, 1
  s_lshl_b32 s42, 0x30003, s6
  v_mov_b32 v13, s33
  ds_read_b128 v[48:51], v4 offset:2048
  ds_read_b128 v[52:55], v4 offset:6656
  ds_read_b128 v[56:59], v4 offset:11264
  ds_read_b128 v[60:63], v4 offset:15872
  ds_read_b128 v[64:67], v4 offset:20480
  ds_read_b128 v[68:71], v4 offset:25088
  ds_read_b128 v[72:75], v4 offset:29696
  ds_read_b128 v[76:79], v4 offset:34304
  s_mov_b32 s7, 0
L_lw_123:
  ds_read_b32 v88, v2 offset:0
  s_waitcnt lgkmcnt(0)
  v_cmp_gt_i32 vcc, s33, v88
  s_cbranch_vccz L_lwo_124
  s_add_u32 s7, s7, 1
  s_cmp_lt_u32 s7, 131072
  s_cbranch_scc1 L_lw_123
  s_mov_b32 s6, 42
  s_branch L_err
L_lwo_124:
  ds_read2_b32 v[112:113], v104 offset0:0 offset1:1
  ds_read2_b32 v[114:115], v104 offset0:2 offset1:3
  ds_read_b32 v116, v104 offset:16
  ds_read2_b32 v[118:119], v105 offset0:0 offset1:1
  ds_read2_b32 v[120:121], v105 offset0:2 offset1:3
  ds_read_b32 v122, v105 offset:16
  ds_read2_b32 v[124:125], v106 offset0:0 offset1:1
  ds_read2_b32 v[126:127], v106 offset0:2 offset1:3
  ds_read_b32 v128, v106 offset:16
  ds_read2_b32 v[130:131], v107 offset0:0 offset1:1
  ds_read2_b32 v[132:133], v107 offset0:2 offset1:3
  ds_read_b32 v134, v107 offset:16
  s_waitcnt lgkmcnt(9)
  v_alignbyte_b32 v16, v113, v112, v15
  v_alignbyte_b32 v17, v114, v113, v15
  v_alignbyte_b32 v18, v115, v114, v15
  v_alignbyte_b32 v19, v116, v115, v15
  ds_read2_b32 v[112:113], v108 offset0:0 offset1:1
  ds_read2_b32 v[114:115], v108 offset0:2 offset1:3
  ds_read_b32 v116, v108 offset:16
  s_waitcnt lgkmcnt(9)
  v_alignbyte_b32 v20, v119, v118, v15
  v_alignbyte_b32 v21, v120, v119, v15
  v_alignbyte_b32 v22, v121, v120, v15
  v_alignbyte_b32 v23, v122, v121, v15
  ds_read2_b32 v[118:119], v109 offset0:0 offset1:1
  ds_read2_b32 v[120:121], v109 offset0:2 offset1:3
  ds_read_b32 v122, v109 offset:16
  v_mfma_f32_16x16x32_bf16 a[12:15], v[16:19], v[48:51], a[12:15]
  s_waitcnt lgkmcnt(9)
  v_alignbyte_b32 v24, v125, v124, v15
  v_alignbyte_b32 v25, v126, v125, v15
  v_alignbyte_b32 v26, v127, v126, v15
  v_alignbyte_b32 v27, v128, v127, v15
  ds_read2_b32 v[124:125], v110 offset0:0 offset1:1
  ds_read2_b32 v[126:127], v110 offset0:2 offset1:3
  ds_read_b32 v128, v110 offset:16
  v_mfma_f32_16x16x32_bf16 a[44:47], v[20:23], v[52:55], a[44:47]
  s_waitcnt lgkmcnt(9)
  v_alignbyte_b32 v28, v131, v130, v15
  v_alignbyte_b32 v29, v132, v131, v15
  v_alignbyte_b32 v30, v133, v132, v15
  v_alignbyte_b32 v31, v134, v133, v15
  ds_read2_b32 v[130:131], v111 offset0:0 offset1:1
  ds_read2_b32 v[132:133], v111 offset0:2 offset1:3
  ds_read_b32 v134, v111 offset:16
  v_mfma_f32_16x16x32_bf16 a[76:79], v[24:27], v[56:59], a[76:79]
  s_waitcnt lgkmcnt(9)
  v_alignbyte_b32 v32, v113, v112, v15
  v_alignbyte_b32 v33, v114, v113, v15
  v_alignbyte_b32 v34, v115, v114, v15
  v_alignbyte_b32 v35, v116, v115, v15
  ds_read_b64 v[84:85], v8
  ds_read_b64 v[86:87], v9
  v_mfma_f32_16x16x32_bf16 a[108:111], v[28:31], v[60:63], a[108:111]
  s_waitcnt lgkmcnt(8)
  v_alignbyte_b32 v36, v119, v118, v15
  v_alignbyte_b32 v37, v120, v119, v15
  v_alignbyte_b32 v38, v121, v120, v15
  v_alignbyte_b32 v39, v122, v121, v15
  v_mfma_f32_16x16x32_bf16 a[140:143], v[32:35], v[64:67], a[140:143]
  s_waitcnt lgkmcnt(5)
  v_alignbyte_b32 v40, v125, v124, v15
  v_alignbyte_b32 v41, v126, v125, v15
  v_alignbyte_b32 v42, v127, v126, v15
  v_alignbyte_b32 v43, v128, v127, v15
  v_mfma_f32_16x16x32_bf16 a[172:175], v[36:39], v[68:71], a[172:175]
  s_waitcnt lgkmcnt(2)
  v_alignbyte_b32 v44, v131, v130, v15
  v_alignbyte_b32 v45, v132, v131, v15
  v_alignbyte_b32 v46, v133, v132, v15
  v_alignbyte_b32 v47, v134, v133, v15
  v_mfma_f32_16x16x32_bf16 a[204:207], v[40:43], v[72:75], a[204:207]
  s_nop 0
  v_mfma_f32_16x16x32_bf16 a[236:239], v[44:47], v[76:79], a[236:239]
  s_waitcnt lgkmcnt(0)
  ds_read_b128 v[48:51], v4 offset:1536
  ds_read_b128 v[52:55], v4 offset:6144
  ds_read_b128 v[56:59], v4 offset:10752
  ds_read_b128 v[60:63], v4 offset:15360
  ds_read_b128 v[64:67], v4 offset:19968
  ds_read_b128 v[68:71], v4 offset:24576
  ds_read_b128 v[72:75], v4 offset:29184
  ds_read_b128 v[76:79], v4 offset:33792
  s_mov_b32 exec_lo, s42
  s_mov_b32 exec_hi, s42
  ds_write_b128 v6, a[12:15] offset:0
  ds_write_b128 v6, a[44:47] offset:128
  ds_write_b128 v6, a[76:79] offset:256
  ds_write_b128 v6, a[108:111] offset:384
  ds_write_b128 v6, a[140:143] offset:512
  ds_write_b128 v6, a[172:175] offset:640
  ds_write_b128 v6, a[204:207] offset:768
  ds_write_b128 v6, a[236:239] offset:896
  s_mov_b64 exec, -1
  ds_read_b128 v[80:83], v7
  ds_write_b32 v14, v13 offset:8
  v_lshlrev_b32 v88, 16, v84
  v_and_b32 v89, 0xffff0000, v84
  v_lshlrev_b32 v90, 16, v85
  v_and_b32 v91, 0xffff0000, v85
  v_lshlrev_b32 v96, 16, v86
  v_and_b32 v97, 0xffff0000, v86
  v_lshlrev_b32 v98, 16, v87
  v_and_b32 v99, 0xffff0000, v87
  v_mul_f32 v92, v88, v12
  v_mul_f32 v93, v89, v12
  v_mul_f32 v94, v90, v12
  v_mul_f32 v95, v91, v12
  v_cvt_pk_bf16_f32 v84, v92, v93
  v_cvt_pk_bf16_f32 v85, v94, v95
  v_lshlrev_b32 v92, 16, v84
  v_and_b32 v93, 0xffff0000, v84
  v_lshlrev_b32 v94, 16, v85
  v_and_b32 v95, 0xffff0000, v85
  s_waitcnt lgkmcnt(1)
  v_fmac_f32 v80, v88, v11
  v_fmac_f32 v81, v89, v11
  v_fmac_f32 v82, v90, v11
  v_fmac_f32 v83, v91, v11
  v_cvt_pk_bf16_f32 v84, v80, v81
  v_cvt_pk_bf16_f32 v85, v82, v83
  v_lshlrev_b32 v80, 16, v84
  v_and_b32 v81, 0xffff0000, v84
  v_lshlrev_b32 v82, 16, v85
  v_and_b32 v83, 0xffff0000, v85
  v_add_f32 v80, v80, v92
  v_add_f32 v81, v81, v93
  v_add_f32 v82, v82, v94
  v_add_f32 v83, v83, v95
  v_cvt_pk_bf16_f32 v84, v80, v81
  v_cvt_pk_bf16_f32 v85, v82, v83
  v_lshlrev_b32 v80, 16, v84
  v_and_b32 v81, 0xffff0000, v84
  v_lshlrev_b32 v82, 16, v85
  v_and_b32 v83, 0xffff0000, v85
  v_add_f32 v80, v80, v96
  v_add_f32 v81, v81, v97
  v_add_f32 v82, v82, v98
  v_add_f32 v83, v83, v99
  v_cvt_pk_bf16_f32 v84, v80, v81
  v_cvt_pk_bf16_f32 v85, v82, v83
  buffer_store_dwordx2 v[84:85], v10, s[8:11], s40 offen sc1
  v_mfma_f32_16x16x32_bf16 a[16:19], v[16:19], v[48:51], a[16:19]
  ds_read_b128 v[48:51], v4 offset:1024
  v_mfma_f32_16x16x32_bf16 a[48:51], v[20:23], v[52:55], a[48:51]
  ds_read_b128 v[52:55], v4 offset:5632
  v_mfma_f32_16x16x32_bf16 a[80:83], v[24:27], v[56:59], a[80:83]
  ds_read_b128 v[56:59], v4 offset:10240
  v_mfma_f32_16x16x32_bf16 a[112:115], v[28:31], v[60:63], a[112:115]
  ds_read_b128 v[60:63], v4 offset:14848
  v_mfma_f32_16x16x32_bf16 a[144:147], v[32:35], v[64:67], a[144:147]
  ds_read_b128 v[64:67], v4 offset:19456
  v_mfma_f32_16x16x32_bf16 a[176:179], v[36:39], v[68:71], a[176:179]
  ds_read_b128 v[68:71], v4 offset:24064
  v_mfma_f32_16x16x32_bf16 a[208:211], v[40:43], v[72:75], a[208:211]
  ds_read_b128 v[72:75], v4 offset:28672
  v_mfma_f32_16x16x32_bf16 a[240:243], v[44:47], v[76:79], a[240:243]
  ds_read_b128 v[76:79], v4 offset:33280
  s_waitcnt lgkmcnt(7)
  v_mfma_f32_16x16x32_bf16 a[20:23], v[16:19], v[48:51], a[20:23]
  ds_read_b128 v[48:51], v4 offset:512
  s_waitcnt lgkmcnt(7)
  v_mfma_f32_16x16x32_bf16 a[52:55], v[20:23], v[52:55], a[52:55]
  ds_read_b128 v[52:55], v4 offset:5120
  s_waitcnt lgkmcnt(7)
  v_mfma_f32_16x16x32_bf16 a[84:87], v[24:27], v[56:59], a[84:87]
  ds_read_b128 v[56:59], v4 offset:9728
  s_waitcnt lgkmcnt(7)
  v_mfma_f32_16x16x32_bf16 a[116:119], v[28:31], v[60:63], a[116:119]
  ds_read_b128 v[60:63], v4 offset:14336
  s_waitcnt lgkmcnt(7)
  v_mfma_f32_16x16x32_bf16 a[148:151], v[32:35], v[64:67], a[148:151]
  ds_read_b128 v[64:67], v4 offset:18944
  s_waitcnt lgkmcnt(7)
  v_mfma_f32_16x16x32_bf16 a[180:183], v[36:39], v[68:71], a[180:183]
  ds_read_b128 v[68:71], v4 offset:23552
  s_waitcnt lgkmcnt(7)
  v_mfma_f32_16x16x32_bf16 a[212:215], v[40:43], v[72:75], a[212:215]
  ds_read_b128 v[72:75], v4 offset:28160
  s_waitcnt lgkmcnt(7)
  v_mfma_f32_16x16x32_bf16 a[244:247], v[44:47], v[76:79], a[244:247]
  ds_read_b128 v[76:79], v4 offset:32768
  s_waitcnt lgkmcnt(7)
  v_mfma_f32_16x16x32_bf16 a[24:27], v[16:19], v[48:51], a[24:27]
  ds_read_b128 v[48:51], v4 offset:0
  s_waitcnt lgkmcnt(7)
  v_mfma_f32_16x16x32_bf16 a[56:59], v[20:23], v[52:55], a[56:59]
  ds_read_b128 v[52:55], v4 offset:4608
  s_waitcnt lgkmcnt(7)
  v_mfma_f32_16x16x32_bf16 a[88:91], v[24:27], v[56:59], a[88:91]
  ds_read_b128 v[56:59], v4 offset:9216
  s_waitcnt lgkmcnt(7)
  v_mfma_f32_16x16x32_bf16 a[120:123], v[28:31], v[60:63], a[120:123]
  ds_read_b128 v[60:63], v4 offset:13824
  s_waitcnt lgkmcnt(7)
  v_mfma_f32_16x16x32_bf16 a[152:155], v[32:35], v[64:67], a[152:155]
  ds_read_b128 v[64:67], v4 offset:18432
  s_waitcnt lgkmcnt(7)
  v_mfma_f32_16x16x32_bf16 a[184:187], v[36:39], v[68:71], a[184:187]
  ds_read_b128 v[68:71], v4 offset:23040
  s_waitcnt lgkmcnt(7)
  v_mfma_f32_16x16x32_bf16 a[216:219], v[40:43], v[72:75], a[216:219]
  ds_read_b128 v[72:75], v4 offset:27648
  s_waitcnt lgkmcnt(7)
  v_mfma_f32_16x16x32_bf16 a[248:251], v[44:47], v[76:79], a[248:251]
  ds_read_b128 v[76:79], v4 offset:32256
  s_waitcnt lgkmcnt(7)
  v_mfma_f32_16x16x32_bf16 a[28:31], v[16:19], v[48:51], a[28:31]
  s_waitcnt lgkmcnt(6)
  v_mfma_f32_16x16x32_bf16 a[60:63], v[20:23], v[52:55], a[60:63]
  s_waitcnt lgkmcnt(5)
  v_mfma_f32_16x16x32_bf16 a[92:95], v[24:27], v[56:59], a[92:95]
  s_waitcnt lgkmcnt(4)
  v_mfma_f32_16x16x32_bf16 a[124:127], v[28:31], v[60:63], a[124:127]
  s_waitcnt lgkmcnt(3)
  v_mfma_f32_16x16x32_bf16 a[156:159], v[32:35], v[64:67], a[156:159]
  s_waitcnt lgkmcnt(2)
  v_mfma_f32_16x16x32_bf16 a[188:191], v[36:39], v[68:71], a[188:191]
  s_waitcnt lgkmcnt(1)
  v_mfma_f32_16x16x32_bf16 a[220:223], v[40:43], v[72:75], a[220:223]
  s_waitcnt lgkmcnt(0)
  v_mfma_f32_16x16x32_bf16 a[252:255], v[44:47], v[76:79], a[252:255]
  v_add_u32 v104, 64, v104
  v_add_u32 v105, 64, v105
  v_add_u32 v106, 64, v106
  v_add_u32 v107, 64, v107
  v_add_u32 v108, 64, v108
  v_add_u32 v109, 64, v109
  v_add_u32 v110, 64, v110
  v_add_u32 v111, 64, v111
  v_add_u32 v4, 64, v4
  v_add_u32 v8, 64, v8
  s_add_u32 s40, s40, 0x8000
  s_waitcnt vmcnt(0)
  s_mov_b64 exec, 1
  buffer_store_dword v13, v1, s[8:11], s39 offen sc1
  s_mov_b64 exec, -1
  s_add_u32 s32, s32, 1
  s_and_b32 s6, s32, 7
  s_cbranch_scc1 L_c_conv3
L_c_conv4:
  s_add_u32 s33, s32, 1
  s_and_b32 s6, s32, 7
  s_lshl_b32 s7, s6, 10
  s_add_u32 s7, s7, s35
  v_add_u32 v9, s7, v10
  s_lshl_b32 s6, s6, 1
  s_lshl_b32 s42, 0x30003, s6
  v_mov_b32 v13, s33
  ds_read_b128 v[48:51], v4 offset:1536
  ds_read_b128 v[52:55], v4 offset:6144
  ds_read_b128 v[56:59], v4 offset:10752
  ds_read_b128 v[60:63], v4 offset:15360
  ds_read_b128 v[64:67], v4 offset:19968
  ds_read_b128 v[68:71], v4 offset:24576
  ds_read_b128 v[72:75], v4 offset:29184
  ds_read_b128 v[76:79], v4 offset:33792
  s_mov_b32 s7, 0
L_lw_125:
  ds_read_b32 v88, v2 offset:0
  s_waitcnt lgkmcnt(0)
  v_cmp_gt_i32 vcc, s33, v88
  s_cbranch_vccz L_lwo_126
  s_add_u32 s7, s7, 1
  s_cmp_lt_u32 s7, 131072
  s_cbranch_scc1 L_lw_125
  s_mov_b32 s6, 42
  s_branch L_err
L_lwo_126:
  ds_read2_b32 v[112:113], v104 offset0:0 offset1:1
  ds_read2_b32 v[114:115], v104 offset0:2 offset1:3
  ds_read_b32 v116, v104 offset:16
  ds_read2_b32 v[118:119], v105 offset0:0 offset1:1
  ds_read2_b32 v[120:121], v105 offset0:2 offset1:3
  ds_read_b32 v122, v105 offset:16
  ds_read2_b32 v[124:125], v106 offset0:0 offset1:1
  ds_read2_b32 v[126:127], v106 offset0:2 offset1:3
  ds_read_b32 v128, v106 offset:16
  ds_read2_b32 v[130:131], v107 offset0:0 offset1:1
  ds_read2_b32 v[132:133], v107 offset0:2 offset1:3
  ds_read_b32 v134, v107 offset:16
  s_waitcnt lgkmcnt(9)
  v_alignbyte_b32 v16, v113, v112, v15
  v_alignbyte_b32 v17, v114, v113, v15
  v_alignbyte_b32 v18, v115, v114, v15
  v_alignbyte_b32 v19, v116, v115, v15
  ds_read2_b32 v[112:113], v108 offset0:0 offset1:1
  ds_read2_b32 v[114:115], v108 offset0:2 offset1:3
  ds_read_b32 v116, v108 offset:16
  s_waitcnt lgkmcnt(9)
  v_alignbyte_b32 v20, v119, v118, v15
  v_alignbyte_b32 v21, v120, v119, v15
  v_alignbyte_b32 v22, v121, v120, v15
  v_alignbyte_b32 v23, v122, v121, v15
  ds_read2_b32 v[118:119], v109 offset0:0 offset1:1
  ds_read2_b32 v[120:121], v109 offset0:2 offset1:3
  ds_read_b32 v122, v109 offset:16
  v_mfma_f32_16x16x32_bf16 a[16:19], v[16:19], v[48:51], a[16:19]
  s_waitcnt lgkmcnt(9)
  v_alignbyte_b32 v24, v125, v124, v15
  v_alignbyte_b32 v25, v126, v125, v15
  v_alignbyte_b32 v26, v127, v126, v15
  v_alignbyte_b32 v27, v128, v127, v15
  ds_read2_b32 v[124:125], v110 offset0:0 offset1:1
  ds_read2_b32 v[126:127], v110 offset0:2 offset1:3
  ds_read_b32 v128, v110 offset:16
  v_mfma_f32_16x16x32_bf16 a[48:51], v[20:23], v[52:55], a[48:51]
  s_waitcnt lgkmcnt(9)
  v_alignbyte_b32 v28, v131, v130, v15
  v_alignbyte_b32 v29, v132, v131, v15
  v_alignbyte_b32 v30, v133, v132, v15
  v_alignbyte_b32 v31, v134, v133, v15
  ds_read2_b32 v[130:131], v111 offset0:0 offset1:1
  ds_read2_b32 v[132:133], v111 offset0:2 offset1:3
  ds_read_b32 v134, v111 offset:16
  v_mfma_f32_16x16x32_bf16 a[80:83], v[24:27], v[56:59], a[80:83]
  s_waitcnt lgkmcnt(9)
  v_alignbyte_b32 v32, v113, v112, v15
  v_alignbyte_b32 v33, v114, v113, v15
  v_alignbyte_b32 v34, v115, v114, v15
  v_alignbyte_b32 v35, v116, v115, v15
  ds_read_b64 v[84:85], v8
  ds_read_b64 v[86:87], v9
  v_mfma_f32_16x16x32_bf16 a[112:115], v[28:31], v[60:63], a[112:115]
  s_waitcnt lgkmcnt(8)
  v_alignbyte_b32 v36, v119, v118, v15
  v_alignbyte_b32 v37, v120, v119, v15
  v_alignbyte_b32 v38, v121, v120, v15
  v_alignbyte_b32 v39, v122, v121, v15
  v_mfma_f32_16x16x32_bf16 a[144:147], v[32:35], v[64:67], a[144:147]
  s_waitcnt lgkmcnt(5)
  v_alignbyte_b32 v40, v125, v124, v15
  v_alignbyte_b32 v41, v126, v125, v15
  v_alignbyte_b32 v42, v127, v126, v15
  v_alignbyte_b32 v43, v128, v127, v15
  v_mfma_f32_16x16x32_bf16 a[176:179], v[36:39], v[68:71], a[176:179]
  s_waitcnt lgkmcnt(2)
  v_alignbyte_b32 v44, v131, v130, v15
  v_alignbyte_b32 v45, v132, v131, v15
  v_alignbyte_b32 v46, v133, v132, v15
  v_alignbyte_b32 v47, v134, v133, v15
  v_mfma_f32_16x16x32_bf16 a[208:211], v[40:43], v[72:75], a[208:211]
  s_nop 0
  v_mfma_f32_16x16x32_bf16 a[240:243], v[44:47], v[76:79], a[240:243]
  s_waitcnt lgkmcnt(0)
  ds_read_b128 v[48:51], v4 offset:1024
  ds_read_b128 v[52:55], v4 offset:5632
  ds_read_b128 v[56:59], v4 offset:10240
  ds_read_b128 v[60:63], v4 offset:14848
  ds_read_b128 v[64:67], v4 offset:19456
  ds_read_b128 v[68:71], v4 offset:24064
  ds_read_b128 v[72:75], v4 offset:28672
  ds_read_b128 v[76:79], v4 offset:33280
  s_mov_b32 exec_lo, s42
  s_mov_b32 exec_hi, s42
  ds_write_b128 v6, a[16:19] offset:0
  ds_write_b128 v6, a[48:51] offset:128
  ds_write_b128 v6, a[80:83] offset:256
  ds_write_b128 v6, a[112:115] offset:384
  ds_write_b128 v6, a[144:147] offset:512
  ds_write_b128 v6, a[176:179] offset:640
  ds_write_b128 v6, a[208:211] offset:768
  ds_write_b128 v6, a[240:243] offset:896
  s_mov_b64 exec, -1
  ds_read_b128 v[80:83], v7
  ds_write_b32 v14, v13 offset:8
  v_lshlrev_b32 v88, 16, v84
  v_and_b32 v89, 0xffff0000, v84
  v_lshlrev_b32 v90, 16, v85
  v_and_b32 v91, 0xffff0000, v85
  v_lshlrev_b32 v96, 16, v86
  v_and_b32 v97, 0xffff0000, v86
  v_lshlrev_b32 v98, 16, v87
  v_and_b32 v99, 0xffff0000, v87
  v_mul_f32 v92, v88, v12
  v_mul_f32 v93, v89, v12
  v_mul_f32 v94, v90, v12
  v_mul_f32 v95, v91, v12
  v_cvt_pk_bf16_f32 v84, v92, v93
  v_cvt_pk_bf16_f32 v85, v94, v95
  v_lshlrev_b32 v92, 16, v84
  v_and_b32 v93, 0xffff0000, v84
  v_lshlrev_b32 v94, 16, v85
  v_and_b32 v95, 0xffff0000, v85
  s_waitcnt lgkmcnt(1)
  v_fmac_f32 v80, v88, v11
  v_fmac_f32 v81, v89, v11
  v_fmac_f32 v82, v90, v11
  v_fmac_f32 v83, v91, v11
  v_cvt_pk_bf16_f32 v84, v80, v81
  v_cvt_pk_bf16_f32 v85, v82, v83
  v_lshlrev_b32 v80, 16, v84
  v_and_b32 v81, 0xffff0000, v84
  v_lshlrev_b32 v82, 16, v85
  v_and_b32 v83, 0xffff0000, v85
  v_add_f32 v80, v80, v92
  v_add_f32 v81, v81, v93
  v_add_f32 v82, v82, v94
  v_add_f32 v83, v83, v95
  v_cvt_pk_bf16_f32 v84, v80, v81
  v_cvt_pk_bf16_f32 v85, v82, v83
  v_lshlrev_b32 v80, 16, v84
  v_and_b32 v81, 0xffff0000, v84
  v_lshlrev_b32 v82, 16, v85
  v_and_b32 v83, 0xffff0000, v85
  v_add_f32 v80, v80, v96
  v_add_f32 v81, v81, v97
  v_add_f32 v82, v82, v98
  v_add_f32 v83, v83, v99
  v_cvt_pk_bf16_f32 v84, v80, v81
  v_cvt_pk_bf16_f32 v85, v82, v83
  buffer_store_dwordx2 v[84:85], v10, s[8:11], s40 offen sc1
  v_mfma_f32_16x16x32_bf16 a[20:23], v[16:19], v[48:51], a[20:23]
  ds_read_b128 v[48:51], v4 offset:512
  v_mfma_f32_16x16x32_bf16 a[52:55], v[20:23], v[52:55], a[52:55]
  ds_read_b128 v[52:55], v4 offset:5120
  v_mfma_f32_16x16x32_bf16 a[84:87], v[24:27], v[56:59], a[84:87]
  ds_read_b128 v[56:59], v4 offset:9728
  v_mfma_f32_16x16x32_bf16 a[116:119], v[28:31], v[60:63], a[116:119]
  ds_read_b128 v[60:63], v4 offset:14336
  v_mfma_f32_16x16x32_bf16 a[148:151], v[32:35], v[64:67], a[148:151]
  ds_read_b128 v[64:67], v4 offset:18944
  v_mfma_f32_16x16x32_bf16 a[180:183], v[36:39], v[68:71], a[180:183]
  ds_read_b128 v[68:71], v4 offset:23552
  v_mfma_f32_16x16x32_bf16 a[212:215], v[40:43], v[72:75], a[212:215]
  ds_read_b128 v[72:75], v4 offset:28160
  v_mfma_f32_16x16x32_bf16 a[244:247], v[44:47], v[76:79], a[244:247]
  ds_read_b128 v[76:79], v4 offset:32768
  s_waitcnt lgkmcnt(7)
  v_mfma_f32_16x16x32_bf16 a[24:27], v[16:19], v[48:51], a[24:27]
  ds_read_b128 v[48:51], v4 offset:0
  s_waitcnt lgkmcnt(7)
  v_mfma_f32_16x16x32_bf16 a[56:59], v[20:23], v[52:55], a[56:59]
  ds_read_b128 v[52:55], v4 offset:4608
  s_waitcnt lgkmcnt(7)
  v_mfma_f32_16x16x32_bf16 a[88:91], v[24:27], v[56:59], a[88:91]
  ds_read_b128 v[56:59], v4 offset:9216
  s_waitcnt lgkmcnt(7)
  v_mfma_f32_16x16x32_bf16 a[120:123], v[28:31], v[60:63], a[120:123]
  ds_read_b128 v[60:63], v4 offset:13824
  s_waitcnt lgkmcnt(7)
  v_mfma_f32_16x16x32_bf16 a[152:155], v[32:35], v[64:67], a[152:155]
  ds_read_b128 v[64:67], v4 offset:18432
  s_waitcnt lgkmcnt(7)
  v_mfma_f32_16x16x32_bf16 a[184:187], v[36:39], v[68:71], a[184:187]
  ds_read_b128 v[68:71], v4 offset:23040
  s_waitcnt lgkmcnt(7)
  v_mfma_f32_16x16x32_bf16 a[216:219], v[40:43], v[72:75], a[216:219]
  ds_read_b128 v[72:75], v4 offset:27648
  s_waitcnt lgkmcnt(7)
  v_mfma_f32_16x16x32_bf16 a[248:251], v[44:47], v[76:79], a[248:251]
  ds_read_b128 v[76:79], v4 offset:32256
  s_waitcnt lgkmcnt(7)
  v_mfma_f32_16x16x32_bf16 a[28:31], v[16:19], v[48:51], a[28:31]
  s_waitcnt lgkmcnt(6)
  v_mfma_f32_16x16x32_bf16 a[60:63], v[20:23], v[52:55], a[60:63]
  s_waitcnt lgkmcnt(5)
  v_mfma_f32_16x16x32_bf16 a[92:95], v[24:27], v[56:59], a[92:95]
  s_waitcnt lgkmcnt(4)
  v_mfma_f32_16x16x32_bf16 a[124:127], v[28:31], v[60:63], a[124:127]
  s_waitcnt lgkmcnt(3)
  v_mfma_f32_16x16x32_bf16 a[156:159], v[32:35], v[64:67], a[156:159]
  s_waitcnt lgkmcnt(2)
  v_mfma_f32_16x16x32_bf16 a[188:191], v[36:39], v[68:71], a[188:191]
  s_waitcnt lgkmcnt(1)
  v_mfma_f32_16x16x32_bf16 a[220:223], v[40:43], v[72:75], a[220:223]
  s_waitcnt lgkmcnt(0)
  v_mfma_f32_16x16x32_bf16 a[252:255], v[44:47], v[76:79], a[252:255]
  v_add_u32 v104, 64, v104
  v_add_u32 v105, 64, v105
  v_add_u32 v106, 64, v106
  v_add_u32 v107, 64, v107
  v_add_u32 v108, 64, v108
  v_add_u32 v109, 64, v109
  v_add_u32 v110, 64, v110
  v_add_u32 v111, 64, v111
  v_add_u32 v4, 64, v4
  v_add_u32 v8, 64, v8
  s_add_u32 s40, s40, 0x8000
  s_waitcnt vmcnt(0)
  s_mov_b64 exec, 1
  buffer_store_dword v13, v1, s[8:11], s39 offen sc1
  s_mov_b64 exec, -1
  s_add_u32 s32, s32, 1
  s_and_b32 s6, s32, 7
  s_cbranch_scc1 L_c_conv4
L_c_conv5:
  s_add_u32 s33, s32, 1
  s_and_b32 s6, s32, 7
  s_lshl_b32 s7, s6, 10
  s_add_u32 s7, s7, s35
  v_add_u32 v9, s7, v10
  s_lshl_b32 s6, s6, 1
  s_lshl_b32 s42, 0x30003, s6
  v_mov_b32 v13, s33
  ds_read_b128 v[48:51], v4 offset:1024
  ds_read_b128 v[52:55], v4 offset:5632
  ds_read_b128 v[56:59], v4 offset:10240
  ds_read_b128 v[60:63], v4 offset:14848
  ds_read_b128 v[64:67], v4 offset:19456
  ds_read_b128 v[68:71], v4 offset:24064
  ds_read_b128 v[72:75], v4 offset:28672
  ds_read_b128 v[76:79], v4 offset:33280
  s_mov_b32 s7, 0
L_lw_127:
  ds_read_b32 v88, v2 offset:0
  s_waitcnt lgkmcnt(0)
  v_cmp_gt_i32 vcc, s33, v88
  s_cbranch_vccz L_lwo_128
  s_add_u32 s7, s7, 1
  s_cmp_lt_u32 s7, 131072
  s_cbranch_scc1 L_lw_127
  s_mov_b32 s6, 42
  s_branch L_err
L_lwo_128:
  ds_read2_b32 v[112:113], v104 offset0:0 offset1:1
  ds_read2_b32 v[114:115], v104 offset0:2 offset1:3
  ds_read_b32 v116, v104 offset:16
  ds_read2_b32 v[118:119], v105 offset0:0 offset1:1
  ds_read2_b32 v[120:121], v105 offset0:2 offset1:3
  ds_read_b32 v122, v105 offset:16
  ds_read2_b32 v[124:125], v106 offset0:0 offset1:1
  ds_read2_b32 v[126:127], v106 offset0:2 offset1:3
  ds_read_b32 v128, v106 offset:16
  ds_read2_b32 v[130:131], v107 offset0:0 offset1:1
  ds_read2_b32 v[132:133], v107 offset0:2 offset1:3
  ds_read_b32 v134, v107 offset:16
  s_waitcnt lgkmcnt(9)
  v_alignbyte_b32 v16, v113, v112, v15
  v_alignbyte_b32 v17, v114, v113, v15
  v_alignbyte_b32 v18, v115, v114, v15
  v_alignbyte_b32 v19, v116, v115, v15
  ds_read2_b32 v[112:113], v108 offset0:0 offset1:1
  ds_read2_b32 v[114:115], v108 offset0:2 offset1:3
  ds_read_b32 v116, v108 offset:16
  s_waitcnt lgkmcnt(9)
  v_alignbyte_b32 v20, v119, v118, v15
  v_alignbyte_b32 v21, v120, v119, v15
  v_alignbyte_b32 v22, v121, v120, v15
  v_alignbyte_b32 v23, v122, v121, v15
  ds_read2_b32 v[118:119], v109 offset0:0 offset1:1
  ds_read2_b32 v[120:121], v109 offset0:2 offset1:3
  ds_read_b32 v122, v109 offset:16
  v_mfma_f32_16x16x32_bf16 a[20:23], v[16:19], v[48:51], a[20:23]
  s_waitcnt lgkmcnt(9)
  v_alignbyte_b32 v24, v125, v124, v15
  v_alignbyte_b32 v25, v126, v125, v15
  v_alignbyte_b32 v26, v127, v126, v15
  v_alignbyte_b32 v27, v128, v127, v15
  ds_read2_b32 v[124:125], v110 offset0:0 offset1:1
  ds_read2_b32 v[126:127], v110 offset0:2 offset1:3
  ds_read_b32 v128, v110 offset:16
  v_mfma_f32_16x16x32_bf16 a[52:55], v[20:23], v[52:55], a[52:55]
  s_waitcnt lgkmcnt(9)
  v_alignbyte_b32 v28, v131, v130, v15
  v_alignbyte_b32 v29, v132, v131, v15
  v_alignbyte_b32 v30, v133, v132, v15
  v_alignbyte_b32 v31, v134, v133, v15
  ds_read2_b32 v[130:131], v111 offset0:0 offset1:1
  ds_read2_b32 v[132:133], v111 offset0:2 offset1:3
  ds_read_b32 v134, v111 offset:16
  v_mfma_f32_16x16x32_bf16 a[84:87], v[24:27], v[56:59], a[84:87]
  s_waitcnt lgkmcnt(9)
  v_alignbyte_b32 v32, v113, v112, v15
  v_alignbyte_b32 v33, v114, v113, v15
  v_alignbyte_b32 v34, v115, v114, v15
  v_alignbyte_b32 v35, v116, v115, v15
  ds_read_b64 v[84:85], v8
  ds_read_b64 v[86:87], v9
  v_mfma_f32_16x16x32_bf16 a[116:119], v[28:31], v[60:63], a[116:119]
  s_waitcnt lgkmcnt(8)
  v_alignbyte_b32 v36, v119, v118, v15
  v_alignbyte_b32 v37, v120, v119, v15
  v_alignbyte_b32 v38, v121, v120, v15
  v_alignbyte_b32 v39, v122, v121, v15
  v_mfma_f32_16x16x32_bf16 a[148:151], v[32:35], v[64:67], a[148:151]
  s_waitcnt lgkmcnt(5)
  v_alignbyte_b32 v40, v125, v124, v15
  v_alignbyte_b32 v41, v126, v125, v15
  v_alignbyte_b32 v42, v127, v126, v15
  v_alignbyte_b32 v43, v128, v127, v15
  v_mfma_f32_16x16x32_bf16 a[180:183], v[36:39], v[68:71], a[180:183]
  s_waitcnt lgkmcnt(2)
  v_alignbyte_b32 v44, v131, v130, v15
  v_alignbyte_b32 v45, v132, v131, v15
  v_alignbyte_b32 v46, v133, v132, v15
  v_alignbyte_b32 v47, v134, v133, v15
  v_mfma_f32_16x16x32_bf16 a[212:215], v[40:43], v[72:75], a[212:215]
  s_nop 0
  v_mfma_f32_16x16x32_bf16 a[244:247], v[44:47], v[76:79], a[244:247]
  s_waitcnt lgkmcnt(0)
  ds_read_b128 v[48:51], v4 offset:512
  ds_read_b128 v[52:55], v4 offset:5120
  ds_read_b128 v[56:59], v4 offset:9728
  ds_read_b128 v[60:63], v4 offset:14336
  ds_read_b128 v[64:67], v4 offset:18944
  ds_read_b128 v[68:71], v4 offset:23552
  ds_read_b128 v[72:75], v4 offset:28160
  ds_read_b128 v[76:79], v4 offset:32768
  s_mov_b32 exec_lo, s42
  s_mov_b32 exec_hi, s42
  ds_write_b128 v6, a[20:23] offset:0
  ds_write_b128 v6, a[52:55] offset:128
  ds_write_b128 v6, a[84:87] offset:256
  ds_write_b128 v6, a[116:119] offset:384
  ds_write_b128 v6, a[148:151] offset:512
  ds_write_b128 v6, a[180:183] offset:640
  ds_write_b128 v6, a[212:215] offset:768
  ds_write_b128 v6, a[244:247] offset:896
  s_mov_b64 exec, -1
  ds_read_b128 v[80:83], v7
  ds_write_b32 v14, v13 offset:8
  v_lshlrev_b32 v88, 16, v84
  v_and_b32 v89, 0xffff0000, v84
  v_lshlrev_b32 v90, 16, v85
  v_and_b32 v91, 0xffff0000, v85
  v_lshlrev_b32 v96, 16, v86
  v_and_b32 v97, 0xffff0000, v86
  v_lshlrev_b32 v98, 16, v87
  v_and_b32 v99, 0xffff0000, v87
  v_mul_f32 v92, v88, v12
  v_mul_f32 v93, v89, v12
  v_mul_f32 v94, v90, v12
  v_mul_f32 v95, v91, v12
  v_cvt_pk_bf16_f32 v84, v92, v93
  v_cvt_pk_bf16_f32 v85, v94, v95
  v_lshlrev_b32 v92, 16, v84
  v_and_b32 v93, 0xffff0000, v84
  v_lshlrev_b32 v94, 16, v85
  v_and_b32 v95, 0xffff0000, v85
  s_waitcnt lgkmcnt(1)
  v_fmac_f32 v80, v88, v11
  v_fmac_f32 v81, v89, v11
  v_fmac_f32 v82, v90, v11
  v_fmac_f32 v83, v91, v11
  v_cvt_pk_bf16_f32 v84, v80, v81
  v_cvt_pk_bf16_f32 v85, v82, v83
  v_lshlrev_b32 v80, 16, v84
  v_and_b32 v81, 0xffff0000, v84
  v_lshlrev_b32 v82, 16, v85
  v_and_b32 v83, 0xffff0000, v85
  v_add_f32 v80, v80, v92
  v_add_f32 v81, v81, v93
  v_add_f32 v82, v82, v94
  v_add_f32 v83, v83, v95
  v_cvt_pk_bf16_f32 v84, v80, v81
  v_cvt_pk_bf16_f32 v85, v82, v83
  v_lshlrev_b32 v80, 16, v84
  v_and_b32 v81, 0xffff0000, v84
  v_lshlrev_b32 v82, 16, v85
  v_and_b32 v83, 0xffff0000, v85
  v_add_f32 v80, v80, v96
  v_add_f32 v81, v81, v97
  v_add_f32 v82, v82, v98
  v_add_f32 v83, v83, v99
  v_cvt_pk_bf16_f32 v84, v80, v81
  v_cvt_pk_bf16_f32 v85, v82, v83
  buffer_store_dwordx2 v[84:85], v10, s[8:11], s40 offen sc1
  v_mfma_f32_16x16x32_bf16 a[24:27], v[16:19], v[48:51], a[24:27]
  ds_read_b128 v[48:51], v4 offset:0
  v_mfma_f32_16x16x32_bf16 a[56:59], v[20:23], v[52:55], a[56:59]
  ds_read_b128 v[52:55], v4 offset:4608
  v_mfma_f32_16x16x32_bf16 a[88:91], v[24:27], v[56:59], a[88:91]
  ds_read_b128 v[56:59], v4 offset:9216
  v_mfma_f32_16x16x32_bf16 a[120:123], v[28:31], v[60:63], a[120:123]
  ds_read_b128 v[60:63], v4 offset:13824
  v_mfma_f32_16x16x32_bf16 a[152:155], v[32:35], v[64:67], a[152:155]
  ds_read_b128 v[64:67], v4 offset:18432
  v_mfma_f32_16x16x32_bf16 a[184:187], v[36:39], v[68:71], a[184:187]
  ds_read_b128 v[68:71], v4 offset:23040
  v_mfma_f32_16x16x32_bf16 a[216:219], v[40:43], v[72:75], a[216:219]
  ds_read_b128 v[72:75], v4 offset:27648
  v_mfma_f32_16x16x32_bf16 a[248:251], v[44:47], v[76:79], a[248:251]
  ds_read_b128 v[76:79], v4 offset:32256
  s_waitcnt lgkmcnt(7)
  v_mfma_f32_16x16x32_bf16 a[28:31], v[16:19], v[48:51], a[28:31]
  s_waitcnt lgkmcnt(6)
  v_mfma_f32_16x16x32_bf16 a[60:63], v[20:23], v[52:55], a[60:63]
  s_waitcnt lgkmcnt(5)
  v_mfma_f32_16x16x32_bf16 a[92:95], v[24:27], v[56:59], a[92:95]
  s_waitcnt lgkmcnt(4)
  v_mfma_f32_16x16x32_bf16 a[124:127], v[28:31], v[60:63], a[124:127]
  s_waitcnt lgkmcnt(3)
  v_mfma_f32_16x16x32_bf16 a[156:159], v[32:35], v[64:67], a[156:159]
  s_waitcnt lgkmcnt(2)
  v_mfma_f32_16x16x32_bf16 a[188:191], v[36:39], v[68:71], a[188:191]
  s_waitcnt lgkmcnt(1)
  v_mfma_f32_16x16x32_bf16 a[220:223], v[40:43], v[72:75], a[220:223]
  s_waitcnt lgkmcnt(0)
  v_mfma_f32_16x16x32_bf16 a[252:255], v[44:47], v[76:79], a[252:255]
  v_add_u32 v104, 64, v104
  v_add_u32 v105, 64, v105
  v_add_u32 v106, 64, v106
  v_add_u32 v107, 64, v107
  v_add_u32 v108, 64, v108
  v_add_u32 v109, 64, v109
  v_add_u32 v110, 64, v110
  v_add_u32 v111, 64, v111
  v_add_u32 v4, 64, v4
  v_add_u32 v8, 64, v8
  s_add_u32 s40, s40, 0x8000
  s_waitcnt vmcnt(0)
  s_mov_b64 exec, 1
  buffer_store_dword v13, v1, s[8:11], s39 offen sc1
  s_mov_b64 exec, -1
  s_add_u32 s32, s32, 1
  s_and_b32 s6, s32, 7
  s_cbranch_scc1 L_c_conv5
L_c_conv6:
  s_add_u32 s33, s32, 1
  s_and_b32 s6, s32, 7
  s_lshl_b32 s7, s6, 10
  s_add_u32 s7, s7, s35
  v_add_u32 v9, s7, v10
  s_lshl_b32 s6, s6, 1
  s_lshl_b32 s42, 0x30003, s6
  v_mov_b32 v13, s33
  ds_read_b128 v[48:51], v4 offset:512
  ds_read_b128 v[52:55], v4 offset:5120
  ds_read_b128 v[56:59], v4 offset:9728
  ds_read_b128 v[60:63], v4 offset:14336
  ds_read_b128 v[64:67], v4 offset:18944
  ds_read_b128 v[68:71], v4 offset:23552
  ds_read_b128 v[72:75], v4 offset:28160
  ds_read_b128 v[76:79], v4 offset:32768
  s_mov_b32 s7, 0
L_lw_129:
  ds_read_b32 v88, v2 offset:0
  s_waitcnt lgkmcnt(0)
  v_cmp_gt_i32 vcc, s33, v88
  s_cbranch_vccz L_lwo_130
  s_add_u32 s7, s7, 1
  s_cmp_lt_u32 s7, 131072
  s_cbranch_scc1 L_lw_129
  s_mov_b32 s6, 42
  s_branch L_err
L_lwo_130:
  ds_read2_b32 v[112:113], v104 offset0:0 offset1:1
  ds_read2_b32 v[114:115], v104 offset0:2 offset1:3
  ds_read_b32 v116, v104 offset:16
  ds_read2_b32 v[118:119], v105 offset0:0 offset1:1
  ds_read2_b32 v[120:121], v105 offset0:2 offset1:3
  ds_read_b32 v122, v105 offset:16
  ds_read2_b32 v[124:125], v106 offset0:0 offset1:1
  ds_read2_b32 v[126:127], v106 offset0:2 offset1:3
  ds_read_b32 v128, v106 offset:16
  ds_read2_b32 v[130:131], v107 offset0:0 offset1:1
  ds_read2_b32 v[132:133], v107 offset0:2 offset1:3
  ds_read_b32 v134, v107 offset:16
  s_waitcnt lgkmcnt(9)
  v_alignbyte_b32 v16, v113, v112, v15
  v_alignbyte_b32 v17, v114, v113, v15
  v_alignbyte_b32 v18, v115, v114, v15
  v_alignbyte_b32 v19, v116, v115, v15
  ds_read2_b32 v[112:113], v108 offset0:0 offset1:1
  ds_read2_b32 v[114:115], v108 offset0:2 offset1:3
  ds_read_b32 v116, v108 offset:16
  s_waitcnt lgkmcnt(9)
  v_alignbyte_b32 v20, v119, v118, v15
  v_alignbyte_b32 v21, v120, v119, v15
  v_alignbyte_b32 v22, v121, v120, v15
  v_alignbyte_b32 v23, v122, v121, v15
  ds_read2_b32 v[118:119], v109 offset0:0 offset1:1
  ds_read2_b32 v[120:121], v109 offset0:2 offset1:3
  ds_read_b32 v122, v109 offset:16
  v_mfma_f32_16x16x32_bf16 a[24:27], v[16:19], v[48:51], a[24:27]
  s_waitcnt lgkmcnt(9)
  v_alignbyte_b32 v24, v125, v124, v15
  v_alignbyte_b32 v25, v126, v125, v15
  v_alignbyte_b32 v26, v127, v126, v15
  v_alignbyte_b32 v27, v128, v127, v15
  ds_read2_b32 v[124:125], v110 offset0:0 offset1:1
  ds_read2_b32 v[126:127], v110 offset0:2 offset1:3
  ds_read_b32 v128, v110 offset:16
  v_mfma_f32_16x16x32_bf16 a[56:59], v[20:23], v[52:55], a[56:59]
  s_waitcnt lgkmcnt(9)
  v_alignbyte_b32 v28, v131, v130, v15
  v_alignbyte_b32 v29, v132, v131, v15
  v_alignbyte_b32 v30, v133, v132, v15
  v_alignbyte_b32 v31, v134, v133, v15
  ds_read2_b32 v[130:131], v111 offset0:0 offset1:1
  ds_read2_b32 v[132:133], v111 offset0:2 offset1:3
  ds_read_b32 v134, v111 offset:16
  v_mfma_f32_16x16x32_bf16 a[88:91], v[24:27], v[56:59], a[88:91]
  s_waitcnt lgkmcnt(9)
  v_alignbyte_b32 v32, v113, v112, v15
  v_alignbyte_b32 v33, v114, v113, v15
  v_alignbyte_b32 v34, v115, v114, v15
  v_alignbyte_b32 v35, v116, v115, v15
  ds_read_b64 v[84:85], v8
  ds_read_b64 v[86:87], v9
  v_mfma_f32_16x16x32_bf16 a[120:123], v[28:31], v[60:63], a[120:123]
  s_waitcnt lgkmcnt(8)
  v_alignbyte_b32 v36, v119, v118, v15
  v_alignbyte_b32 v37, v120, v119, v15
  v_alignbyte_b32 v38, v121, v120, v15
  v_alignbyte_b32 v39, v122, v121, v15
  v_mfma_f32_16x16x32_bf16 a[152:155], v[32:35], v[64:67], a[152:155]
  s_waitcnt lgkmcnt(5)
  v_alignbyte_b32 v40, v125, v124, v15
  v_alignbyte_b32 v41, v126, v125, v15
  v_alignbyte_b32 v42, v127, v126, v15
  v_alignbyte_b32 v43, v128, v127, v15
  v_mfma_f32_16x16x32_bf16 a[184:187], v[36:39], v[68:71], a[184:187]
  s_waitcnt lgkmcnt(2)
  v_alignbyte_b32 v44, v131, v130, v15
  v_alignbyte_b32 v45, v132, v131, v15
  v_alignbyte_b32 v46, v133, v132, v15
  v_alignbyte_b32 v47, v134, v133, v15
  v_mfma_f32_16x16x32_bf16 a[216:219], v[40:43], v[72:75], a[216:219]
  s_nop 0
  v_mfma_f32_16x16x32_bf16 a[248:251], v[44:47], v[76:79], a[248:251]
  s_waitcnt lgkmcnt(0)
  ds_read_b128 v[48:51], v4 offset:0
  ds_read_b128 v[52:55], v4 offset:4608
  ds_read_b128 v[56:59], v4 offset:9216
  ds_read_b128 v[60:63], v4 offset:13824
  ds_read_b128 v[64:67], v4 offset:18432
  ds_read_b128 v[68:71], v4 offset:23040
  ds_read_b128 v[72:75], v4 offset:27648
  ds_read_b128 v[76:79], v4 offset:32256
  s_mov_b32 exec_lo, s42
  s_mov_b32 exec_hi, s42
  ds_write_b128 v6, a[24:27] offset:0
  ds_write_b128 v6, a[56:59] offset:128
  ds_write_b128 v6, a[88:91] offset:256
  ds_write_b128 v6, a[120:123] offset:384
  ds_write_b128 v6, a[152:155] offset:512
  ds_write_b128 v6, a[184:187] offset:640
  ds_write_b128 v6, a[216:219] offset:768
  ds_write_b128 v6, a[248:251] offset:896
  s_mov_b64 exec, -1
  ds_read_b128 v[80:83], v7
  ds_write_b32 v14, v13 offset:8
  v_lshlrev_b32 v88, 16, v84
  v_and_b32 v89, 0xffff0000, v84
  v_lshlrev_b32 v90, 16, v85
  v_and_b32 v91, 0xffff0000, v85
  v_lshlrev_b32 v96, 16, v86
  v_and_b32 v97, 0xffff0000, v86
  v_lshlrev_b32 v98, 16, v87
  v_and_b32 v99, 0xffff0000, v87
  v_mul_f32 v92, v88, v12
  v_mul_f32 v93, v89, v12
  v_mul_f32 v94, v90, v12
  v_mul_f32 v95, v91, v12
  v_cvt_pk_bf16_f32 v84, v92, v93
  v_cvt_pk_bf16_f32 v85, v94, v95
  v_lshlrev_b32 v92, 16, v84
  v_and_b32 v93, 0xffff0000, v84
  v_lshlrev_b32 v94, 16, v85
  v_and_b32 v95, 0xffff0000, v85
  s_waitcnt lgkmcnt(1)
  v_fmac_f32 v80, v88, v11
  v_fmac_f32 v81, v89, v11
  v_fmac_f32 v82, v90, v11
  v_fmac_f32 v83, v91, v11
  v_cvt_pk_bf16_f32 v84, v80, v81
  v_cvt_pk_bf16_f32 v85, v82, v83
  v_lshlrev_b32 v80, 16, v84
  v_and_b32 v81, 0xffff0000, v84
  v_lshlrev_b32 v82, 16, v85
  v_and_b32 v83, 0xffff0000, v85
  v_add_f32 v80, v80, v92
  v_add_f32 v81, v81, v93
  v_add_f32 v82, v82, v94
  v_add_f32 v83, v83, v95
  v_cvt_pk_bf16_f32 v84, v80, v81
  v_cvt_pk_bf16_f32 v85, v82, v83
  v_lshlrev_b32 v80, 16, v84
  v_and_b32 v81, 0xffff0000, v84
  v_lshlrev_b32 v82, 16, v85
  v_and_b32 v83, 0xffff0000, v85
  v_add_f32 v80, v80, v96
  v_add_f32 v81, v81, v97
  v_add_f32 v82, v82, v98
  v_add_f32 v83, v83, v99
  v_cvt_pk_bf16_f32 v84, v80, v81
  v_cvt_pk_bf16_f32 v85, v82, v83
  buffer_store_dwordx2 v[84:85], v10, s[8:11], s40 offen sc1
  v_mfma_f32_16x16x32_bf16 a[28:31], v[16:19], v[48:51], a[28:31]
  v_mfma_f32_16x16x32_bf16 a[60:63], v[20:23], v[52:55], a[60:63]
  v_mfma_f32_16x16x32_bf16 a[92:95], v[24:27], v[56:59], a[92:95]
  v_mfma_f32_16x16x32_bf16 a[124:127], v[28:31], v[60:63], a[124:127]
  v_mfma_f32_16x16x32_bf16 a[156:159], v[32:35], v[64:67], a[156:159]
  v_mfma_f32_16x16x32_bf16 a[188:191], v[36:39], v[68:71], a[188:191]
  v_mfma_f32_16x16x32_bf16 a[220:223], v[40:43], v[72:75], a[220:223]
  v_mfma_f32_16x16x32_bf16 a[252:255], v[44:47], v[76:79], a[252:255]
  v_add_u32 v104, 64, v104
  v_add_u32 v105, 64, v105
  v_add_u32 v106, 64, v106
  v_add_u32 v107, 64, v107
  v_add_u32 v108, 64, v108
  v_add_u32 v109, 64, v109
  v_add_u32 v110, 64, v110
  v_add_u32 v111, 64, v111
  v_add_u32 v4, 64, v4
  v_add_u32 v8, 64, v8
  s_add_u32 s40, s40, 0x8000
  s_waitcnt vmcnt(0)
  s_mov_b64 exec, 1
  buffer_store_dword v13, v1, s[8:11], s39 offen sc1
  s_mov_b64 exec, -1
  s_add_u32 s32, s32, 1
  s_and_b32 s6, s32, 7
  s_cbranch_scc1 L_c_conv6
L_c_conv7:
  s_add_u32 s33, s32, 1
  s_and_b32 s6, s32, 7
  s_lshl_b32 s7, s6, 10
  s_add_u32 s7, s7, s35
  v_add_u32 v9, s7, v10
  s_lshl_b32 s6, s6, 1
  s_lshl_b32 s42, 0x30003, s6
  v_mov_b32 v13, s33
  ds_read_b128 v[48:51], v4 offset:0
  ds_read_b128 v[52:55], v4 offset:4608
  ds_read_b128 v[56:59], v4 offset:9216
  ds_read_b128 v[60:63], v4 offset:13824
  ds_read_b128 v[64:67], v4 offset:18432
  ds_read_b128 v[68:71], v4 offset:23040
  ds_read_b128 v[72:75], v4 offset:27648
  ds_read_b128 v[76:79], v4 offset:32256
  s_mov_b32 s7, 0
L_lw_131:
  ds_read_b32 v88, v2 offset:0
  s_waitcnt lgkmcnt(0)
  v_cmp_gt_i32 vcc, s33, v88
  s_cbranch_vccz L_lwo_132
  s_add_u32 s7, s7, 1
  s_cmp_lt_u32 s7, 131072
  s_cbranch_scc1 L_lw_131
  s_mov_b32 s6, 42
  s_branch L_err
L_lwo_132:
  ds_read2_b32 v[112:113], v104 offset0:0 offset1:1
  ds_read2_b32 v[114:115], v104 offset0:2 offset1:3
  ds_read_b32 v116, v104 offset:16
  ds_read2_b32 v[118:119], v105 offset0:0 offset1:1
  ds_read2_b32 v[120:121], v105 offset0:2 offset1:3
  ds_read_b32 v122, v105 offset:16
  ds_read2_b32 v[124:125], v106 offset0:0 offset1:1
  ds_read2_b32 v[126:127], v106 offset0:2 offset1:3
  ds_read_b32 v128, v106 offset:16
  ds_read2_b32 v[130:131], v107 offset0:0 offset1:1
  ds_read2_b32 v[132:133], v107 offset0:2 offset1:3
  ds_read_b32 v134, v107 offset:16
  s_waitcnt lgkmcnt(9)
  v_alignbyte_b32 v16, v113, v112, v15
  v_alignbyte_b32 v17, v114, v113, v15
  v_alignbyte_b32 v18, v115, v114, v15
  v_alignbyte_b32 v19, v116, v115, v15
  ds_read2_b32 v[112:113], v108 offset0:0 offset1:1
  ds_read2_b32 v[114:115], v108 offset0:2 offset1:3
  ds_read_b32 v116, v108 offset:16
  s_waitcnt lgkmcnt(9)
  v_alignbyte_b32 v20, v119, v118, v15
  v_alignbyte_b32 v21, v120, v119, v15
  v_alignbyte_b32 v22, v121, v120, v15
  v_alignbyte_b32 v23, v122, v121, v15
  ds_read2_b32 v[118:119], v109 offset0:0 offset1:1
  ds_read2_b32 v[120:121], v109 offset0:2 offset1:3
  ds_read_b32 v122, v109 offset:16
  v_mfma_f32_16x16x32_bf16 a[28:31], v[16:19], v[48:51], a[28:31]
  s_waitcnt lgkmcnt(9)
  v_alignbyte_b32 v24, v125, v124, v15
  v_alignbyte_b32 v25, v126, v125, v15
  v_alignbyte_b32 v26, v127, v126, v15
  v_alignbyte_b32 v27, v128, v127, v15
  ds_read2_b32 v[124:125], v110 offset0:0 offset1:1
  ds_read2_b32 v[126:127], v110 offset0:2 offset1:3
  ds_read_b32 v128, v110 offset:16
  v_mfma_f32_16x16x32_bf16 a[60:63], v[20:23], v[52:55], a[60:63]
  s_waitcnt lgkmcnt(9)
  v_alignbyte_b32 v28, v131, v130, v15
  v_alignbyte_b32 v29, v132, v131, v15
  v_alignbyte_b32 v30, v133, v132, v15
  v_alignbyte_b32 v31, v134, v133, v15
  ds_read2_b32 v[130:131], v111 offset0:0 offset1:1
  ds_read2_b32 v[132:133], v111 offset0:2 offset1:3
  ds_read_b32 v134, v111 offset:16
  v_mfma_f32_16x16x32_bf16 a[92:95], v[24:27], v[56:59], a[92:95]
  s_waitcnt lgkmcnt(9)
  v_alignbyte_b32 v32, v113, v112, v15
  v_alignbyte_b32 v33, v114, v113, v15
  v_alignbyte_b32 v34, v115, v114, v15
  v_alignbyte_b32 v35, v116, v115, v15
  ds_read_b64 v[84:85], v8
  ds_read_b64 v[86:87], v9
  v_mfma_f32_16x16x32_bf16 a[124:127], v[28:31], v[60:63], a[124:127]
  s_waitcnt lgkmcnt(8)
  v_alignbyte_b32 v36, v119, v118, v15
  v_alignbyte_b32 v37, v120, v119, v15
  v_alignbyte_b32 v38, v121, v120, v15
  v_alignbyte_b32 v39, v122, v121, v15
  v_mfma_f32_16x16x32_bf16 a[156:159], v[32:35], v[64:67], a[156:159]
  s_waitcnt lgkmcnt(5)
  v_alignbyte_b32 v40, v125, v124, v15
  v_alignbyte_b32 v41, v126, v125, v15
  v_alignbyte_b32 v42, v127, v126, v15
  v_alignbyte_b32 v43, v128, v127, v15
  v_mfma_f32_16x16x32_bf16 a[188:191], v[36:39], v[68:71], a[188:191]
  s_waitcnt lgkmcnt(2)
  v_alignbyte_b32 v44, v131, v130, v15
  v_alignbyte_b32 v45, v132, v131, v15
  v_alignbyte_b32 v46, v133, v132, v15
  v_alignbyte_b32 v47, v134, v133, v15
  v_mfma_f32_16x16x32_bf16 a[220:223], v[40:43], v[72:75], a[220:223]
  s_nop 0
  v_mfma_f32_16x16x32_bf16 a[252:255], v[44:47], v[76:79], a[252:255]
  s_waitcnt lgkmcnt(0)
  s_mov_b32 exec_lo, s42
  s_mov_b32 exec_hi, s42
  ds_write_b128 v6, a[28:31] offset:0
  ds_write_b128 v6, a[60:63] offset:128
  ds_write_b128 v6, a[92:95] offset:256
  ds_write_b128 v6, a[124:127] offset:384
  ds_write_b128 v6, a[156:159] offset:512
  ds_write_b128 v6, a[188:191] offset:640
  ds_write_b128 v6, a[220:223] offset:768
  ds_write_b128 v6, a[252:255] offset:896
  s_mov_b64 exec, -1
  ds_read_b128 v[80:83], v7
  ds_write_b32 v14, v13 offset:8
  v_lshlrev_b32 v88, 16, v84
  v_and_b32 v89, 0xffff0000, v84
  v_lshlrev_b32 v90, 16, v85
  v_and_b32 v91, 0xffff0000, v85
  v_lshlrev_b32 v96, 16, v86
  v_and_b32 v97, 0xffff0000, v86
  v_lshlrev_b32 v98, 16, v87
  v_and_b32 v99, 0xffff0000, v87
  v_mul_f32 v92, v88, v12
  v_mul_f32 v93, v89, v12
  v_mul_f32 v94, v90, v12
  v_mul_f32 v95, v91, v12
  v_cvt_pk_bf16_f32 v84, v92, v93
  v_cvt_pk_bf16_f32 v85, v94, v95
  v_lshlrev_b32 v92, 16, v84
  v_and_b32 v93, 0xffff0000, v84
  v_lshlrev_b32 v94, 16, v85
  v_and_b32 v95, 0xffff0000, v85
  s_waitcnt lgkmcnt(1)
  v_fmac_f32 v80, v88, v11
  v_fmac_f32 v81, v89, v11
  v_fmac_f32 v82, v90, v11
  v_fmac_f32 v83, v91, v11
  v_cvt_pk_bf16_f32 v84, v80, v81
  v_cvt_pk_bf16_f32 v85, v82, v83
  v_lshlrev_b32 v80, 16, v84
  v_and_b32 v81, 0xffff0000, v84
  v_lshlrev_b32 v82, 16, v85
  v_and_b32 v83, 0xffff0000, v85
  v_add_f32 v80, v80, v92
  v_add_f32 v81, v81, v93
  v_add_f32 v82, v82, v94
  v_add_f32 v83, v83, v95
  v_cvt_pk_bf16_f32 v84, v80, v81
  v_cvt_pk_bf16_f32 v85, v82, v83
  v_lshlrev_b32 v80, 16, v84
  v_and_b32 v81, 0xffff0000, v84
  v_lshlrev_b32 v82, 16, v85
  v_and_b32 v83, 0xffff0000, v85
  v_add_f32 v80, v80, v96
  v_add_f32 v81, v81, v97
  v_add_f32 v82, v82, v98
  v_add_f32 v83, v83, v99
  v_cvt_pk_bf16_f32 v84, v80, v81
  v_cvt_pk_bf16_f32 v85, v82, v83
  buffer_store_dwordx2 v[84:85], v10, s[8:11], s40 offen sc1
  v_add_u32 v104, 64, v104
  v_add_u32 v105, 64, v105
  v_add_u32 v106, 64, v106
  v_add_u32 v107, 64, v107
  v_add_u32 v108, 64, v108
  v_add_u32 v109, 64, v109
  v_add_u32 v110, 64, v110
  v_add_u32 v111, 64, v111
  v_add_u32 v4, 64, v4
  v_add_u32 v8, 64, v8
  s_add_u32 s40, s40, 0x8000
  s_waitcnt vmcnt(0)
  s_mov_b64 exec, 1
  buffer_store_dword v13, v1, s[8:11], s39 offen sc1
  s_mov_b64 exec, -1
  s_add_u32 s32, s32, 1
  s_and_b32 s6, s32, 7
  s_cbranch_scc1 L_c_conv7
  s_waitcnt vmcnt(0)
  s_endpgm
L_c_res:
  s_mov_b32 s16, s92
  s_mov_b32 s17, s93
  s_mov_b32 s18, 0x200000
  s_mov_b32 s19, 0x20000
  s_and_b32 s6, s3, 1
  s_mul_i32 s37, s6, 0x200000
  s_mul_i32 s38, s6, 0x800000
  s_lshl_b32 s39, s6, 11
  s_lshl_b32 s7, s5, 10
  s_add_u32 s37, s37, s7
  s_add_u32 s37, s37, 0x0
  s_add_u32 s38, s38, s7
  s_add_u32 s38, s38, 0x8800000
  s_lshr_b32 s6, s5, 3
  s_lshl_b32 s6, s6, 7
  s_add_u32 s39, s39, s6
  s_and_b32 s6, s5, 6
  s_lshl_b32 s6, s6, 1
  s_add_u32 s39, s39, s6
  s_add_u32 s39, s39, 0x711000
  s_lshl_b32 s41, s5, 5
  v_bfe_u32 v16, v0, 4, 5
  v_lshrrev_b32 v17, 9, v0
  v_lshlrev_b32 v18, 1, v16
  v_lshl_or_b32 v4, v17, 8, v18
  v_add_u32 v8, 139776, v4
  v_mul_u32_u24 v19, 16512, v17
  v_add_u32 v19, v19, v18
  v_add_u32 v7, 73760, v19
  v_bfe_u32 v19, v0, 4, 2
  v_lshlrev_b32 v5, 9, v19
  v_lshrrev_b32 v6, 1, v0
  v_lshlrev_b32 v19, 10, v16
  v_lshl_or_b32 v9, v17, 3, v19
L_c_rloop:
  s_add_u32 s33, s32, 1
  s_mov_b32 s7, 0
L_pl_133:
  buffer_load_dword v16, v5, s[8:11], s39 offen offset:0 sc1
  s_waitcnt vmcnt(0)
  v_cmp_gt_u32 vcc, s33, v16
  s_cbranch_vccz L_plo_134
  s_add_u32 s7, s7, 1
  s_cmp_lt_u32 s7, 131072
  s_cbranch_scc1 L_pl_133
  s_mov_b32 s6, 43
  s_branch L_err
L_plo_134:
  s_add_u32 s6, s38, 0
  buffer_load_dwordx4 v[16:19], v0, s[8:11], s6 offen
  s_add_u32 s6, s38, 32768
  buffer_load_dwordx4 v[20:23], v0, s[8:11], s6 offen
  s_add_u32 s6, s38, 65536
  buffer_load_dwordx4 v[24:27], v0, s[8:11], s6 offen
  s_add_u32 s6, s38, 98304
  buffer_load_dwordx4 v[28:31], v0, s[8:11], s6 offen
  buffer_load_ushort v32, v4, s[8:11], s37 offen offset:0
  buffer_load_ushort v33, v4, s[8:11], s37 offen offset:64
  buffer_load_ushort v34, v4, s[8:11], s37 offen offset:128
  buffer_load_ushort v35, v4, s[8:11], s37 offen offset:192
  buffer_load_ushort v36, v4, s[8:11], s37 offen offset:512
  buffer_load_ushort v37, v4, s[8:11], s37 offen offset:576
  buffer_load_ushort v38, v4, s[8:11], s37 offen offset:640
  buffer_load_ushort v39, v4, s[8:11], s37 offen offset:704
  s_add_u32 s38, s38, 0x20000
  s_add_u32 s37, s37, 0x8000
  s_waitcnt vmcnt(11)
  v_lshlrev_b32 v40, 16, v16
  v_and_b32 v41, 0xffff0000, v16
  v_lshlrev_b32 v42, 16, v17
  v_and_b32 v43, 0xffff0000, v17
  v_lshlrev_b32 v44, 16, v18
  v_and_b32 v45, 0xffff0000, v18
  v_lshlrev_b32 v46, 16, v19
  v_and_b32 v47, 0xffff0000, v19
  s_waitcnt vmcnt(10)
  v_lshlrev_b32 v52, 16, v20
  v_and_b32 v53, 0xffff0000, v20
  v_add_f32 v40, v40, v52
  v_add_f32 v41, v41, v53
  v_lshlrev_b32 v52, 16, v21
  v_and_b32 v53, 0xffff0000, v21
  v_add_f32 v42, v42, v52
  v_add_f32 v43, v43, v53
  v_lshlrev_b32 v52, 16, v22
  v_and_b32 v53, 0xffff0000, v22
  v_add_f32 v44, v44, v52
  v_add_f32 v45, v45, v53
  v_lshlrev_b32 v52, 16, v23
  v_and_b32 v53, 0xffff0000, v23
  v_add_f32 v46, v46, v52
  v_add_f32 v47, v47, v53
  s_waitcnt vmcnt(9)
  v_lshlrev_b32 v52, 16, v24
  v_and_b32 v53, 0xffff0000, v24
  v_add_f32 v40, v40, v52
  v_add_f32 v41, v41, v53
  v_lshlrev_b32 v52, 16, v25
  v_and_b32 v53, 0xffff0000, v25
  v_add_f32 v42, v42, v52
  v_add_f32 v43, v43, v53
  v_lshlrev_b32 v52, 16, v26
  v_and_b32 v53, 0xffff0000, v26
  v_add_f32 v44, v44, v52
  v_add_f32 v45, v45, v53
  v_lshlrev_b32 v52, 16, v27
  v_and_b32 v53, 0xffff0000, v27
  v_add_f32 v46, v46, v52
  v_add_f32 v47, v47, v53
  s_waitcnt vmcnt(8)
  v_lshlrev_b32 v52, 16, v28
  v_and_b32 v53, 0xffff0000, v28
  v_add_f32 v40, v40, v52
  v_add_f32 v41, v41, v53
  v_lshlrev_b32 v52, 16, v29
  v_and_b32 v53, 0xffff0000, v29
  v_add_f32 v42, v42, v52
  v_add_f32 v43, v43, v53
  v_lshlrev_b32 v52, 16, v30
  v_and_b32 v53, 0xffff0000, v30
  v_add_f32 v44, v44, v52
  v_add_f32 v45, v45, v53
  v_lshlrev_b32 v52, 16, v31
  v_and_b32 v53, 0xffff0000, v31
  v_add_f32 v46, v46, v52
  v_add_f32 v47, v47, v53
  v_cvt_pk_bf16_f32 v48, v40, v41
  v_cvt_pk_bf16_f32 v49, v42, v43
  v_cvt_pk_bf16_f32 v50, v44, v45
  v_cvt_pk_bf16_f32 v51, v46, v47
  v_lshlrev_b32 v40, 16, v48
  v_and_b32 v41, 0xffff0000, v48
  v_lshlrev_b32 v42, 16, v49
  v_and_b32 v43, 0xffff0000, v49
  v_lshlrev_b32 v44, 16, v50
  v_and_b32 v45, 0xffff0000, v50
  v_lshlrev_b32 v46, 16, v51
  v_and_b32 v47, 0xffff0000, v51
  s_waitcnt vmcnt(0)
  v_lshlrev_b32 v32, 16, v32
  v_lshlrev_b32 v33, 16, v33
  v_lshlrev_b32 v34, 16, v34
  v_lshlrev_b32 v35, 16, v35
  v_lshlrev_b32 v36, 16, v36
  v_lshlrev_b32 v37, 16, v37
  v_lshlrev_b32 v38, 16, v38
  v_lshlrev_b32 v39, 16, v39
  v_add_f32 v40, v40, v32
  v_add_f32 v41, v41, v33
  v_add_f32 v42, v42, v34
  v_add_f32 v43, v43, v35
  v_add_f32 v44, v44, v36
  v_add_f32 v45, v45, v37
  v_add_f32 v46, v46, v38
  v_add_f32 v47, v47, v39
  v_cvt_pk_bf16_f32 v48, v40, v41
  v_cvt_pk_bf16_f32 v49, v42, v43
  v_cvt_pk_bf16_f32 v50, v44, v45
  v_cvt_pk_bf16_f32 v51, v46, v47
  s_cmp_eq_u32 s3, 2
  s_cbranch_scc1 L_c_ln
  buffer_store_dwordx2 v[48:49], v9, s[16:19], s41 offen
  buffer_store_dwordx2 v[50:51], v9, s[16:19], s41 offen offset:16
  s_add_u32 s41, s41, 0x8000
  s_branch L_c_rnext
L_c_ln:
  v_lshlrev_b32 v40, 16, v48
  v_and_b32 v41, 0xffff0000, v48
  v_lshlrev_b32 v42, 16, v49
  v_and_b32 v43, 0xffff0000, v49
  v_lshlrev_b32 v44, 16, v50
  v_and_b32 v45, 0xffff0000, v50
  v_lshlrev_b32 v46, 16, v51
  v_and_b32 v47, 0xffff0000, v51
  v_add_f32 v52, v40, v41
  v_mul_f32 v53, v40, v40
  v_fmac_f32 v53, v41, v41
  v_add_f32 v52, v52, v42
  v_fmac_f32 v53, v42, v42
  v_add_f32 v52, v52, v43
  v_fmac_f32 v53, v43, v43
  v_add_f32 v52, v52, v44
  v_fmac_f32 v53, v44, v44
  v_add_f32 v52, v52, v45
  v_fmac_f32 v53, v45, v45
  v_add_f32 v52, v52, v46
  v_fmac_f32 v53, v46, v46
  v_add_f32 v52, v52, v47
  v_fmac_f32 v53, v47, v47
  s_lshr_b32 s6, s32, 1
  s_andn2_b32 s36, 1, s6
  s_and_b32 s6, s32, 1
  s_lshl_b32 s6, s6, 13
  s_add_u32 s34, s6, 0x704000
  s_add_u32 s35, s34, 4096
  s_lshl_b32 s6, s5, 8
  s_add_u32 s6, s6, s34
  v_mov_b32 v54, v52
  v_mov_b32 v55, v53
  s_nop 0
  v_permlane32_swap_b32 v52, v54
  v_permlane32_swap_b32 v53, v55
  v_add_f32 v52, v52, v54
  v_add_f32 v53, v53, v55
  v_bfi_b32 v53, 1, s36, v53
  s_mov_b32 exec_hi, 0
  buffer_store_dwordx2 v[52:53], v6, s[8:11], s6 offen
  s_cmp_lg_u32 s32, 63
  s_cbranch_scc1 L_c_nl
  buffer_store_dwordx2 v[52:53], v6, s[8:11], s6 offen sc1
L_c_nl:
  s_mov_b32 exec_hi, -1
  buffer_load_dwordx2 v[64:65], v6, s[8:11], s34 offen offset:0 sc1
  buffer_load_dwordx2 v[66:67], v6, s[8:11], s34 offen offset:512 sc1
  buffer_load_dwordx2 v[68:69], v6, s[8:11], s34 offen offset:1024 sc1
  buffer_load_dwordx2 v[70:71], v6, s[8:11], s34 offen offset:1536 sc1
  buffer_load_dwordx2 v[72:73], v6, s[8:11], s34 offen offset:2048 sc1
  buffer_load_dwordx2 v[74:75], v6, s[8:11], s34 offen offset:2560 sc1
  buffer_load_dwordx2 v[76:77], v6, s[8:11], s34 offen offset:3072 sc1
  buffer_load_dwordx2 v[78:79], v6, s[8:11], s34 offen offset:3584 sc1
  buffer_load_dwordx2 v[80:81], v6, s[8:11], s35 offen offset:0 sc1
  buffer_load_dwordx2 v[82:83], v6, s[8:11], s35 offen offset:512 sc1
  buffer_load_dwordx2 v[84:85], v6, s[8:11], s35 offen offset:1024 sc1
  buffer_load_dwordx2 v[86:87], v6, s[8:11], s35 offen offset:1536 sc1
  buffer_load_dwordx2 v[88:89], v6, s[8:11], s35 offen offset:2048 sc1
  buffer_load_dwordx2 v[90:91], v6, s[8:11], s35 offen offset:2560 sc1
  buffer_load_dwordx2 v[92:93], v6, s[8:11], s35 offen offset:3072 sc1
  buffer_load_dwordx2 v[94:95], v6, s[8:11], s35 offen offset:3584 sc1
  s_sub_u32 s33, s32, 7
  s_mov_b32 s7, 0
L_lw_135:
  ds_read_b64 v[52:53], v2 offset:8
  s_waitcnt lgkmcnt(0)
  v_min_i32 v52, v52, v53
  v_cmp_gt_i32 vcc, s33, v52
  s_cbranch_vccz L_lwo_136
  s_add_u32 s7, s7, 1
  s_cmp_lt_u32 s7, 131072
  s_cbranch_scc1 L_lw_135
  s_mov_b32 s6, 44
  s_branch L_err
L_lwo_136:
  s_and_b32 s6, s32, 7
  s_lshl_b32 s6, s6, 10
  v_add_u32 v52, s6, v8
  ds_write_b16 v52, v48 offset:0
  ds_write_b16_d16_hi v52, v48 offset:64
  ds_write_b16 v52, v49 offset:128
  ds_write_b16_d16_hi v52, v49 offset:192
  ds_write_b16 v52, v50 offset:512
  ds_write_b16_d16_hi v52, v50 offset:576
  ds_write_b16 v52, v51 offset:640
  ds_write_b16_d16_hi v52, v51 offset:704
  s_mov_b32 s7, 0
L_c_g:
  s_waitcnt vmcnt(0)
  v_bitop3_b32 v16, v65, v67, s36 bitop3:0x7e
  v_bitop3_b32 v17, v69, v71, s36 bitop3:0x7e
  v_bitop3_b32 v18, v73, v75, s36 bitop3:0x7e
  v_bitop3_b32 v19, v77, v79, s36 bitop3:0x7e
  v_bitop3_b32 v20, v81, v83, s36 bitop3:0x7e
  v_bitop3_b32 v21, v85, v87, s36 bitop3:0x7e
  v_bitop3_b32 v22, v89, v91, s36 bitop3:0x7e
  v_bitop3_b32 v23, v93, v95, s36 bitop3:0x7e
  v_or3_b32 v16, v16, v17, v18
  v_or3_b32 v19, v19, v20, v21
  v_or3_b32 v16, v16, v22, v23
  v_bitop3_b32 v16, v16, v19, 1 bitop3:0xa8
  v_cmp_ne_u32 vcc, 0, v16
  s_cbranch_vccz L_c_gok
  buffer_load_dwordx2 v[64:65], v6, s[8:11], s34 offen offset:0 sc1
  buffer_load_dwordx2 v[66:67], v6, s[8:11], s34 offen offset:512 sc1
  buffer_load_dwordx2 v[68:69], v6, s[8:11], s34 offen offset:1024 sc1
  buffer_load_dwordx2 v[70:71], v6, s[8:11], s34 offen offset:1536 sc1
  buffer_load_dwordx2 v[72:73], v6, s[8:11], s34 offen offset:2048 sc1
  buffer_load_dwordx2 v[74:75], v6, s[8:11], s34 offen offset:2560 sc1
  buffer_load_dwordx2 v[76:77], v6, s[8:11], s34 offen offset:3072 sc1
  buffer_load_dwordx2 v[78:79], v6, s[8:11], s34 offen offset:3584 sc1
  buffer_load_dwordx2 v[80:81], v6, s[8:11], s35 offen offset:0 sc1
  buffer_load_dwordx2 v[82:83], v6, s[8:11], s35 offen offset:512 sc1
  buffer_load_dwordx2 v[84:85], v6, s[8:11], s35 offen offset:1024 sc1
  buffer_load_dwordx2 v[86:87], v6, s[8:11], s35 offen offset:1536 sc1
  buffer_load_dwordx2 v[88:89], v6, s[8:11], s35 offen offset:2048 sc1
  buffer_load_dwordx2 v[90:91], v6, s[8:11], s35 offen offset:2560 sc1
  buffer_load_dwordx2 v[92:93], v6, s[8:11], s35 offen offset:3072 sc1
  buffer_load_dwordx2 v[94:95], v6, s[8:11], s35 offen offset:3584 sc1
  s_and_b32 s6, s7, 31
  s_cmp_lg_u32 s6, 31
  s_cbranch_scc1 L_tf_137
  buffer_wbl2 sc1
  s_waitcnt vmcnt(0)
  buffer_inv sc1
  s_waitcnt vmcnt(0)
L_tf_137:
  s_add_u32 s7, s7, 1
  s_cmp_lt_u32 s7, 131072
  s_cbranch_scc1 L_c_g
  s_mov_b32 s6, 45
  s_branch L_err
L_c_gok:
  v_add_f32 v64, v64, v80
  v_add_f32 v65, v65, v81
  v_add_f32 v66, v66, v82
  v_add_f32 v67, v67, v83
  v_add_f32 v68, v68, v84
  v_add_f32 v69, v69, v85
  v_add_f32 v70, v70, v86
  v_add_f32 v71, v71, v87
  v_add_f32 v72, v72, v88
  v_add_f32 v73, v73, v89
  v_add_f32 v74, v74, v90
  v_add_f32 v75, v75, v91
  v_add_f32 v76, v76, v92
  v_add_f32 v77, v77, v93
  v_add_f32 v78, v78, v94
  v_add_f32 v79, v79, v95
  v_add_f32 v64, v64, v72
  v_add_f32 v65, v65, v73
  v_add_f32 v66, v66, v74
  v_add_f32 v67, v67, v75
  v_add_f32 v68, v68, v76
  v_add_f32 v69, v69, v77
  v_add_f32 v70, v70, v78
  v_add_f32 v71, v71, v79
  v_add_f32 v64, v64, v68
  v_add_f32 v65, v65, v69
  v_add_f32 v66, v66, v70
  v_add_f32 v67, v67, v71
  v_add_f32 v52, v64, v66
  v_add_f32 v53, v65, v67
  v_mov_b32 v54, v52
  v_mov_b32 v55, v53
  s_nop 0
  v_permlane32_swap_b32 v52, v54
  v_permlane32_swap_b32 v53, v55
  v_add_f32 v52, v52, v54
  v_add_f32 v53, v53, v55
  v_mul_f32 v52, 0x3b000000, v52
  v_mul_f32 v54, v52, v52
  v_mul_f32 v53, 0x3b000000, v53
  v_sub_f32 v53, v53, v54
  v_max_f32 v53, 0, v53
  v_cvt_pk_bf16_f32 v53, v53, v53
  v_and_b32 v53, 0xffff0000, v53
  v_add_f32 v53, 0x3727c5ac, v53
  v_cvt_pk_bf16_f32 v53, v53, v53
  v_and_b32 v53, 0xffff0000, v53
  v_sqrt_f32 v53, v53
  v_cvt_pk_bf16_f32 v52, v52, v52
  v_and_b32 v52, 0xffff0000, v52
  v_cvt_pk_bf16_f32 v53, v53, v53
  v_and_b32 v53, 0xffff0000, v53
  v_rcp_f32 v53, v53
  v_sub_f32 v40, v40, v52
  v_sub_f32 v41, v41, v52
  v_sub_f32 v42, v42, v52
  v_sub_f32 v43, v43, v52
  v_sub_f32 v44, v44, v52
  v_sub_f32 v45, v45, v52
  v_sub_f32 v46, v46, v52
  v_sub_f32 v47, v47, v52
  v_cvt_pk_bf16_f32 v48, v40, v41
  v_cvt_pk_bf16_f32 v49, v42, v43
  v_cvt_pk_bf16_f32 v50, v44, v45
  v_cvt_pk_bf16_f32 v51, v46, v47
  v_lshlrev_b32 v40, 16, v48
  v_and_b32 v41, 0xffff0000, v48
  v_lshlrev_b32 v42, 16, v49
  v_and_b32 v43, 0xffff0000, v49
  v_lshlrev_b32 v44, 16, v50
  v_and_b32 v45, 0xffff0000, v50
  v_lshlrev_b32 v46, 16, v51
  v_and_b32 v47, 0xffff0000, v51
  v_mul_f32 v40, v40, v53
  v_mul_f32 v41, v41, v53
  v_mul_f32 v42, v42, v53
  v_mul_f32 v43, v43, v53
  v_mul_f32 v44, v44, v53
  v_mul_f32 v45, v45, v53
  v_mul_f32 v46, v46, v53
  v_mul_f32 v47, v47, v53
  v_cvt_pk_bf16_f32 v48, v40, v41
  v_cvt_pk_bf16_f32 v49, v42, v43
  v_cvt_pk_bf16_f32 v50, v44, v45
  v_cvt_pk_bf16_f32 v51, v46, v47
  s_add_u32 s6, s32, 1
  v_mov_b32 v52, s6
  ds_write_b16 v7, v48 offset:0
  ds_write_b16_d16_hi v7, v48 offset:4128
  ds_write_b16 v7, v49 offset:8256
  ds_write_b16_d16_hi v7, v49 offset:12384
  ds_write_b16 v7, v50 offset:33024
  ds_write_b16_d16_hi v7, v50 offset:37152
  ds_write_b16 v7, v51 offset:41280
  ds_write_b16_d16_hi v7, v51 offset:45408
  ds_write_b32 v2, v52
  v_add_u32 v7, 64, v7
L_c_rnext:
  s_add_u32 s32, s32, 1
  s_cmp_lt_u32 s32, 64
  s_cbranch_scc1 L_c_rloop
  s_waitcnt vmcnt(0)
  s_endpgm
.section .rodata,"a"
.p2align 6
.amdhsa_kernel interleave_layers__ssm_conv_s4d__memory_aug_recurrent_mem_tr__prompt_kernel
  .amdhsa_next_free_vgpr 512
  .amdhsa_next_free_sgpr 102
  .amdhsa_accum_offset 256
  .amdhsa_group_segment_fixed_size 0
  .amdhsa_kernarg_size 136
  .amdhsa_user_sgpr_count 2
  .amdhsa_user_sgpr_kernarg_segment_ptr 1
  .amdhsa_system_sgpr_workgroup_id_x 1
.end_amdhsa_kernel
```

```asm
; @launch grid=(256,1,1) block=(256,1,1) lds=163840
.amdgcn_target "amdgcn-amd-amdhsa--gfx950"
.text
.globl interleave_layers__ssm_conv_s4d__memory_aug_recurrent_mem_tr__prompt_kernel
.p2align 8
.type interleave_layers__ssm_conv_s4d__memory_aug_recurrent_mem_tr__prompt_kernel,@function
interleave_layers__ssm_conv_s4d__memory_aug_recurrent_mem_tr__prompt_kernel:
  s_cmp_ge_u32 s2, 256
  s_cbranch_scc1 L_end
  s_load_dwordx16 s[64:79], s[0:1], 0
  s_load_dwordx16 s[80:95], s[0:1], 64
  s_load_dwordx2 s[96:97], s[0:1], 128
  s_getreg_b32 s4, hwreg(HW_REG_XCC_ID,0,4)
  v_lshrrev_b32 v1, 6, v0
  v_and_b32 v0, 63, v0
  s_and_b32 s4, s4, 7
  v_readfirstlane_b32 s3, v1
  s_lshl_b32 s4, s4, 2
  s_lshr_b32 s4, 0x10765432, s4
  s_and_b32 s4, s4, 7
  s_waitcnt lgkmcnt(0)
  s_mov_b32 s12, s94
  s_mov_b32 s13, s95
  s_mov_b32 s14, 0x100
  s_mov_b32 s15, 0x20000
  s_mov_b32 s8, s96
  s_mov_b32 s9, s97
  s_mov_b32 s10, 0x10000000
  s_mov_b32 s11, 0x20000
  s_mov_b32 s16, s64
  s_mov_b32 s17, s65
  s_mov_b32 s18, 0x200000
  s_mov_b32 s19, 0x20000
  s_lshl_b32 s6, s2, 3
  s_lshl_b32 s7, s3, 1
  s_add_u32 s32, s6, s7
  s_lshl_b32 s6, s32, 10
  v_lshlrev_b32 v4, 5, v0
  buffer_load_dwordx4 v[40:43], v4, s[16:19], s6 offen
  buffer_load_dwordx4 v[44:47], v4, s[16:19], s6 offen offset:16
  s_cmp_lg_u32 s3, 0
  s_cbranch_scc1 L_tk_1
  s_and_b32 s6, s4, 3
  s_lshl_b32 s6, s6, 6
  s_and_b32 s7, s4, 4
  s_add_u32 s6, s6, s7
  s_mov_b64 exec, 1
  v_mov_b32 v2, s6
  v_mov_b32 v3, 1
  buffer_atomic_add v3, v2, s[12:15], 0 offen sc0 sc1
  s_mov_b64 exec, -1
L_tk_1:
  s_cmp_lg_u32 s3, 0
  s_waitcnt vmcnt(1)
  s_cbranch_scc0 L_xw_2
  s_waitcnt vmcnt(0)
L_xw_2:
  v_mov_b32 v5, 0
  v_mov_b32 v6, 0
  v_mov_b32 v7, 0x3f803f80
  v_dot2c_f32_bf16 v5, v40, v7
  v_dot2c_f32_bf16 v6, v40, v40
  v_dot2c_f32_bf16 v5, v41, v7
  v_dot2c_f32_bf16 v6, v41, v41
  v_dot2c_f32_bf16 v5, v42, v7
  v_dot2c_f32_bf16 v6, v42, v42
  v_dot2c_f32_bf16 v5, v43, v7
  v_dot2c_f32_bf16 v6, v43, v43
  v_dot2c_f32_bf16 v5, v44, v7
  v_dot2c_f32_bf16 v6, v44, v44
  v_dot2c_f32_bf16 v5, v45, v7
  v_dot2c_f32_bf16 v6, v45, v45
  v_dot2c_f32_bf16 v5, v46, v7
  v_dot2c_f32_bf16 v6, v46, v46
  v_dot2c_f32_bf16 v5, v47, v7
  v_dot2c_f32_bf16 v6, v47, v47
  s_nop 1
  v_add_f32_dpp v5, v5, v5 quad_perm:[1,0,3,2] row_mask:0xf bank_mask:0xf
  v_add_f32_dpp v6, v6, v6 quad_perm:[1,0,3,2] row_mask:0xf bank_mask:0xf
  s_nop 0
  v_add_f32_dpp v5, v5, v5 quad_perm:[2,3,0,1] row_mask:0xf bank_mask:0xf
  v_add_f32_dpp v6, v6, v6 quad_perm:[2,3,0,1] row_mask:0xf bank_mask:0xf
  s_nop 0
  v_add_f32_dpp v5, v5, v5 row_half_mirror row_mask:0xf bank_mask:0xf
  v_add_f32_dpp v6, v6, v6 row_half_mirror row_mask:0xf bank_mask:0xf
  s_nop 0
  v_add_f32_dpp v5, v5, v5 row_mirror row_mask:0xf bank_mask:0xf
  v_add_f32_dpp v6, v6, v6 row_mirror row_mask:0xf bank_mask:0xf
  v_mov_b32 v8, v5
  v_mov_b32 v9, v6
  s_nop 0
  v_permlane16_swap_b32 v5, v8
  v_permlane16_swap_b32 v6, v9
  v_add_f32 v8, v5, v8
  v_add_f32 v9, v6, v9
  v_mul_f32 v8, 0x3b000000, v8
  v_mul_f32 v10, v8, v8
  v_mul_f32 v9, 0x3b000000, v9
  v_sub_f32 v9, v9, v10
  v_max_f32 v9, 0, v9
  v_cvt_pk_bf16_f32 v9, v9, v9
  v_and_b32 v9, 0xffff0000, v9
  v_add_f32 v9, 0x3727c5ac, v9
  v_cvt_pk_bf16_f32 v9, v9, v9
  v_and_b32 v9, 0xffff0000, v9
  v_sqrt_f32 v9, v9
  v_cvt_pk_bf16_f32 v8, v8, v8
  v_and_b32 v8, 0xffff0000, v8
  v_cvt_pk_bf16_f32 v9, v9, v9
  v_and_b32 v9, 0xffff0000, v9
  v_rcp_f32 v9, v9
  v_lshlrev_b32 v16, 16, v40
  v_and_b32 v17, 0xffff0000, v40
  v_lshlrev_b32 v18, 16, v41
  v_and_b32 v19, 0xffff0000, v41
  v_lshlrev_b32 v20, 16, v42
  v_and_b32 v21, 0xffff0000, v42
  v_lshlrev_b32 v22, 16, v43
  v_and_b32 v23, 0xffff0000, v43
  v_lshlrev_b32 v24, 16, v44
  v_and_b32 v25, 0xffff0000, v44
  v_lshlrev_b32 v26, 16, v45
  v_and_b32 v27, 0xffff0000, v45
  v_lshlrev_b32 v28, 16, v46
  v_and_b32 v29, 0xffff0000, v46
  v_lshlrev_b32 v30, 16, v47
  v_and_b32 v31, 0xffff0000, v47
  v_sub_f32 v16, v16, v8
  v_sub_f32 v17, v17, v8
  v_sub_f32 v18, v18, v8
  v_sub_f32 v19, v19, v8
  v_sub_f32 v20, v20, v8
  v_sub_f32 v21, v21, v8
  v_sub_f32 v22, v22, v8
  v_sub_f32 v23, v23, v8
  v_sub_f32 v24, v24, v8
  v_sub_f32 v25, v25, v8
  v_sub_f32 v26, v26, v8
  v_sub_f32 v27, v27, v8
  v_sub_f32 v28, v28, v8
  v_sub_f32 v29, v29, v8
  v_sub_f32 v30, v30, v8
  v_sub_f32 v31, v31, v8
  v_cvt_pk_bf16_f32 v32, v16, v17
  v_cvt_pk_bf16_f32 v33, v18, v19
  v_cvt_pk_bf16_f32 v34, v20, v21
  v_cvt_pk_bf16_f32 v35, v22, v23
  v_cvt_pk_bf16_f32 v36, v24, v25
  v_cvt_pk_bf16_f32 v37, v26, v27
  v_cvt_pk_bf16_f32 v38, v28, v29
  v_cvt_pk_bf16_f32 v39, v30, v31
  v_lshlrev_b32 v16, 16, v32
  v_and_b32 v17, 0xffff0000, v32
  v_lshlrev_b32 v18, 16, v33
  v_and_b32 v19, 0xffff0000, v33
  v_lshlrev_b32 v20, 16, v34
  v_and_b32 v21, 0xffff0000, v34
  v_lshlrev_b32 v22, 16, v35
  v_and_b32 v23, 0xffff0000, v35
  v_lshlrev_b32 v24, 16, v36
  v_and_b32 v25, 0xffff0000, v36
  v_lshlrev_b32 v26, 16, v37
  v_and_b32 v27, 0xffff0000, v37
  v_lshlrev_b32 v28, 16, v38
  v_and_b32 v29, 0xffff0000, v38
  v_lshlrev_b32 v30, 16, v39
  v_and_b32 v31, 0xffff0000, v39
  v_mul_f32 v16, v16, v9
  v_mul_f32 v17, v17, v9
  v_mul_f32 v18, v18, v9
  v_mul_f32 v19, v19, v9
  v_mul_f32 v20, v20, v9
  v_mul_f32 v21, v21, v9
  v_mul_f32 v22, v22, v9
  v_mul_f32 v23, v23, v9
  v_mul_f32 v24, v24, v9
  v_mul_f32 v25, v25, v9
  v_mul_f32 v26, v26, v9
  v_mul_f32 v27, v27, v9
  v_mul_f32 v28, v28, v9
  v_mul_f32 v29, v29, v9
  v_mul_f32 v30, v30, v9
  v_mul_f32 v31, v31, v9
  v_cvt_pk_bf16_f32 v32, v16, v17
  v_cvt_pk_bf16_f32 v33, v18, v19
  v_cvt_pk_bf16_f32 v34, v20, v21
  v_cvt_pk_bf16_f32 v35, v22, v23
  v_cvt_pk_bf16_f32 v36, v24, v25
  v_cvt_pk_bf16_f32 v37, v26, v27
  v_cvt_pk_bf16_f32 v38, v28, v29
  v_cvt_pk_bf16_f32 v39, v30, v31
  s_mov_b32 s6, 0x05040100
  s_mov_b32 s7, 0x07060302
  v_and_b32 v4, 31, v0
  v_mul_u32_u24 v4, 528, v4
  v_lshrrev_b32 v5, 5, v0
  v_lshl_add_u32 v4, v5, 8, v4
  s_lshl_b32 s34, s3, 2
  s_add_u32 s34, s34, 64
  v_add_u32 v4, s34, v4
  v_permlane32_swap_b32 v32, v36
  v_permlane32_swap_b32 v33, v37
  v_permlane32_swap_b32 v34, v38
  v_permlane32_swap_b32 v35, v39
  v_perm_b32 v16, v36, v32, s6
  ds_write_b32 v4, v16 offset:0
  v_perm_b32 v17, v36, v32, s7
  ds_write_b32 v4, v17 offset:16
  v_perm_b32 v18, v37, v33, s6
  ds_write_b32 v4, v18 offset:32
  v_perm_b32 v19, v37, v33, s7
  ds_write_b32 v4, v19 offset:48
  v_perm_b32 v20, v38, v34, s6
  ds_write_b32 v4, v20 offset:128
  v_perm_b32 v21, v38, v34, s7
  ds_write_b32 v4, v21 offset:144
  v_perm_b32 v22, v39, v35, s6
  ds_write_b32 v4, v22 offset:160
  v_perm_b32 v23, v39, v35, s7
  ds_write_b32 v4, v23 offset:176
  v_permlane32_swap_b32 v40, v44
  v_permlane32_swap_b32 v41, v45
  v_permlane32_swap_b32 v42, v46
  v_permlane32_swap_b32 v43, v47
  v_perm_b32 v24, v44, v40, s6
  ds_write_b32 v4, v24 offset:64
  v_perm_b32 v25, v44, v40, s7
  ds_write_b32 v4, v25 offset:80
  v_perm_b32 v26, v45, v41, s6
  ds_write_b32 v4, v26 offset:96
  v_perm_b32 v27, v45, v41, s7
  ds_write_b32 v4, v27 offset:112
  v_perm_b32 v28, v46, v42, s6
  ds_write_b32 v4, v28 offset:192
  v_perm_b32 v29, v46, v42, s7
  ds_write_b32 v4, v29 offset:208
  v_perm_b32 v30, v47, v43, s6
  ds_write_b32 v4, v30 offset:224
  v_perm_b32 v31, v47, v43, s7
  ds_write_b32 v4, v31 offset:240
  s_cmp_lg_u32 s3, 0
  s_cbranch_scc1 L_rl_3
  s_waitcnt vmcnt(0)
  v_readfirstlane_b32 s5, v3
  s_cmp_lt_u32 s5, 32
  s_cbranch_scc1 L_rok_4
  s_mov_b64 exec, 1
  v_mov_b32 v2, 32
  v_mov_b32 v3, 1
  buffer_atomic_add v3, v2, s[12:15], 0 offen sc0 sc1
  s_waitcnt vmcnt(0)
  v_readfirstlane_b32 s33, v3
  s_mov_b64 exec, -1
  s_mov_b32 s7, 0
  v_lshlrev_b32 v2, 2, v0
L_row_5:
  buffer_load_dword v3, v2, s[12:15], 0 offen sc1
  s_waitcnt vmcnt(0)
  s_mov_b32 s34, 0
  v_readlane_b32 s40, v3, 0
  v_readlane_b32 s41, v3, 16
  v_readlane_b32 s42, v3, 32
  v_readlane_b32 s43, v3, 48
  v_readlane_b32 s44, v3, 1
  v_readlane_b32 s45, v3, 17
  v_readlane_b32 s46, v3, 33
  v_readlane_b32 s47, v3, 49
  s_add_u32 s34, s34, s40
  s_add_u32 s34, s34, s41
  s_add_u32 s34, s34, s42
  s_add_u32 s34, s34, s43
  s_add_u32 s34, s34, s44
  s_add_u32 s34, s34, s45
  s_add_u32 s34, s34, s46
  s_add_u32 s34, s34, s47
  s_cmp_eq_u32 s34, 256
  s_cbranch_scc1 L_row2_6
  s_add_u32 s7, s7, 1
  s_cmp_lt_u32 s7, 131072
  s_cbranch_scc1 L_row_5
  s_mov_b32 s6, 1
  s_branch L_err
L_row2_6:
  s_min_u32 s5, s40, 32
  s_sub_u32 s35, 32, s5
  s_cmp_ge_u32 s33, s35
  s_cbranch_scc1 L_ovn_7
  s_add_u32 s5, s5, s33
  s_mov_b32 s4, 0
  s_branch L_rok_4
L_ovn_7:
  s_sub_u32 s33, s33, s35
  s_min_u32 s5, s41, 32
  s_sub_u32 s35, 32, s5
  s_cmp_ge_u32 s33, s35
  s_cbranch_scc1 L_ovn_8
  s_add_u32 s5, s5, s33
  s_mov_b32 s4, 1
  s_branch L_rok_4
L_ovn_8:
  s_sub_u32 s33, s33, s35
  s_min_u32 s5, s42, 32
  s_sub_u32 s35, 32, s5
  s_cmp_ge_u32 s33, s35
  s_cbranch_scc1 L_ovn_9
  s_add_u32 s5, s5, s33
  s_mov_b32 s4, 2
  s_branch L_rok_4
L_ovn_9:
  s_sub_u32 s33, s33, s35
  s_min_u32 s5, s43, 32
  s_sub_u32 s35, 32, s5
  s_cmp_ge_u32 s33, s35
  s_cbranch_scc1 L_ovn_10
  s_add_u32 s5, s5, s33
  s_mov_b32 s4, 3
  s_branch L_rok_4
L_ovn_10:
  s_sub_u32 s33, s33, s35
  s_min_u32 s5, s44, 32
  s_sub_u32 s35, 32, s5
  s_cmp_ge_u32 s33, s35
  s_cbranch_scc1 L_ovn_11
  s_add_u32 s5, s5, s33
  s_mov_b32 s4, 4
  s_branch L_rok_4
L_ovn_11:
  s_sub_u32 s33, s33, s35
  s_min_u32 s5, s45, 32
  s_sub_u32 s35, 32, s5
  s_cmp_ge_u32 s33, s35
  s_cbranch_scc1 L_ovn_12
  s_add_u32 s5, s5, s33
  s_mov_b32 s4, 5
  s_branch L_rok_4
L_ovn_12:
  s_sub_u32 s33, s33, s35
  s_min_u32 s5, s46, 32
  s_sub_u32 s35, 32, s5
  s_cmp_ge_u32 s33, s35
  s_cbranch_scc1 L_ovn_13
  s_add_u32 s5, s5, s33
  s_mov_b32 s4, 6
  s_branch L_rok_4
L_ovn_13:
  s_sub_u32 s33, s33, s35
  s_min_u32 s5, s47, 32
  s_sub_u32 s35, 32, s5
  s_cmp_ge_u32 s33, s35
  s_cbranch_scc1 L_ovn_14
  s_add_u32 s5, s5, s33
  s_mov_b32 s4, 7
  s_branch L_rok_4
L_ovn_14:
  s_sub_u32 s33, s33, s35
  s_mov_b32 s6, 2
  s_branch L_err
L_rok_4:
  s_lshl_b32 s6, s4, 5
  s_add_u32 s6, s6, s5
  v_mov_b32 v2, 0
  v_mov_b32 v3, s6
  ds_write_b32 v2, v3
L_rl_3:
  v_lshrrev_b32 v4, 5, v0
  s_lshl_b32 s6, s3, 1
  v_add_u32 v4, s6, v4
  v_mul_u32_u24 v4, 528, v4
  v_and_b32 v5, 31, v0
  v_lshl_add_u32 v4, v5, 4, v4
  v_lshrrev_b32 v5, 3, v0
  v_lshlrev_b32 v5, 15, v5
  v_and_b32 v6, 7, v0
  v_lshl_or_b32 v5, v6, 4, v5
  s_lshl_b32 s6, s3, 18
  s_lshl_b32 s7, s2, 7
  s_add_u32 s6, s6, s7
  s_add_u32 s6, s6, 0xb000000
  s_waitcnt lgkmcnt(0)
  s_barrier
  ds_read_b128 v[16:19], v4 offset:64
  ds_read_b128 v[20:23], v4 offset:4288
  ds_read_b128 v[24:27], v4 offset:8512
  ds_read_b128 v[28:31], v4 offset:12736
  s_waitcnt lgkmcnt(3)
  buffer_store_dwordx4 v[16:19], v5, s[8:11], s6 offen sc1
  s_add_u32 s6, s6, 1048576
  s_waitcnt lgkmcnt(2)
  buffer_store_dwordx4 v[20:23], v5, s[8:11], s6 offen sc1
  s_add_u32 s6, s6, 1048576
  s_waitcnt lgkmcnt(1)
  buffer_store_dwordx4 v[24:27], v5, s[8:11], s6 offen sc1
  s_add_u32 s6, s6, 1048576
  s_waitcnt lgkmcnt(0)
  buffer_store_dwordx4 v[28:31], v5, s[8:11], s6 offen sc1
  s_add_u32 s6, s6, 1048576
  v_mov_b32 v2, 0
  ds_read_b32 v3, v2
  s_waitcnt lgkmcnt(0)
  v_readfirstlane_b32 s6, v3
  s_barrier
  s_lshr_b32 s4, s6, 5
  s_and_b32 s4, s4, 7
  s_and_b32 s5, s6, 31
  s_cmp_eq_u32 s4, 0
  s_cbranch_scc1 L_rec
  s_cmp_eq_u32 s4, 1
  s_cbranch_scc1 L_rec
  s_cmp_eq_u32 s4, 2
  s_cbranch_scc1 L_p
  s_cmp_eq_u32 s4, 3
  s_cbranch_scc1 L_p
  s_cmp_eq_u32 s4, 4
  s_cbranch_scc1 L_p
  s_cmp_eq_u32 s4, 5
  s_cbranch_scc1 L_p
  s_cmp_eq_u32 s4, 6
  s_cbranch_scc1 L_o
  s_cmp_eq_u32 s4, 7
  s_cbranch_scc1 L_c
  s_waitcnt vmcnt(0)
  s_barrier
  s_cmp_lg_u32 s3, 0
  s_cbranch_scc1 L_sd_15
  s_mov_b64 exec, 1
  s_and_b32 s6, s4, 3
  s_lshl_b32 s6, s6, 6
  v_mov_b32 v2, 16
  v_mov_b32 v3, 1
  buffer_atomic_add v3, v2, s[12:15], s6 offen sc1
  s_mov_b64 exec, -1
L_sd_15:
  s_waitcnt vmcnt(0)
  s_endpgm
L_err:
  s_mov_b64 exec, 1
  s_lshl_b32 s7, s4, 2
  s_add_u32 s7, s7, 160
  v_mov_b32 v2, s7
  v_mov_b32 v3, s6
  buffer_store_dword v3, v2, s[12:15], 0 offen sc1
  s_waitcnt vmcnt(0)
L_end:
  s_endpgm
L_rec:
  s_and_b32 s58, s4, 1
  s_mul_i32 s35, s58, 0x2000000
  s_add_u32 s35, s35, 0x800000
  s_mul_i32 s36, s58, 0x1000000
  s_add_u32 s36, s36, 0x4800000
  s_mul_i32 s39, s58, 0x40000
  s_add_u32 s39, s39, 0x740000
  s_mul_i32 s44, s58, 0x2000
  s_add_u32 s44, s44, 0x708000
  s_lshl_b32 s6, s5, 14
  s_lshl_b32 s7, s3, 11
  s_add_u32 s35, s35, s6
  s_add_u32 s35, s35, s7
  s_mov_b32 s48, s7
  s_lshl_b32 s6, s5, 8
  s_add_u32 s43, s44, s6
  s_add_u32 s44, s44, s7
  s_lshl_b32 s7, s5, 13
  s_add_u32 s41, s39, s7
  s_add_u32 s42, s41, 4096
  s_add_u32 s39, s39, s6
  s_add_u32 s40, s39, 32768
  s_lshl_b32 s7, s5, 12
  s_add_u32 s36, s36, s7
  s_lshl_b32 s7, s3, 10
  s_add_u32 s36, s36, s7
  s_add_u32 s53, s48, 8192
  s_add_u32 s37, s48, 16384
  s_lshl_b32 s6, s58, 13
  s_lshl_b32 s7, s5, 7
  s_add_u32 s38, s6, s7
  s_add_u32 s38, s38, 0x714000
  s_mov_b32 s54, 0x00ff00ff
  s_mov_b32 s55, 0x00ff00ff
  s_mov_b32 s56, 0x33333333
  s_mov_b32 s57, 0x33333333
  s_mov_b32 s34, 0x3e0293ee
  s_add_u32 s6, s3, 1
  s_and_b32 s6, s6, 3
  s_lshl_b32 s45, s6, 11
  s_add_u32 s6, s3, 2
  s_and_b32 s6, s6, 3
  s_lshl_b32 s46, s6, 11
  s_add_u32 s6, s3, 3
  s_and_b32 s6, s6, 3
  s_lshl_b32 s47, s6, 11
  v_and_b32 v16, 15, v0
  v_lshrrev_b32 v17, 4, v0
  v_lshlrev_b32 v1, 4, v0
  s_lshl_b32 s6, s3, 8
  s_add_u32 s6, s6, 24576
  v_mul_u32_u24 v18, 1088, v17
  v_lshl_add_u32 v18, v16, 3, v18
  v_add_u32 v2, s6, v18
  v_and_b32 v18, 3, v0
  v_mul_u32_u24 v18, 1088, v18
  v_bfe_u32 v19, v0, 2, 3
  v_lshl_add_u32 v18, v19, 3, v18
  v_lshrrev_b32 v19, 5, v0
  v_lshl_add_u32 v18, v19, 7, v18
  v_add_u32 v3, 24576, v18
  v_and_b32 v18, 7, v0
  v_bfe_u32 v19, v0, 3, 1
  v_lshl_or_b32 v18, v19, 4, v18
  v_lshlrev_b32 v18, 4, v18
  v_lshl_add_u32 v18, v17, 9, v18
  v_add_u32 v4, 8192, v18
  v_lshrrev_b32 v18, 2, v16
  v_and_b32 v19, 1, v0
  v_lshl_or_b32 v18, v18, 1, v19
  v_mul_u32_u24 v18, 288, v18
  v_lshl_add_u32 v18, v17, 2, v18
  s_lshl_b32 s6, s3, 6
  s_add_u32 s6, s6, 28928
  v_add_u32 v5, s6, v18
  v_lshrrev_b32 v18, 1, v16
  v_mul_u32_u24 v18, 288, v18
  v_lshl_add_u32 v18, v17, 5, v18
  v_lshl_add_u32 v18, v19, 4, v18
  v_add_u32 v6, 28928, v18
  s_lshl_b32 s6, s3, 15
  s_add_u32 s6, s6, 32768
  v_add_u32 v7, s6, v1
  v_lshrrev_b32 v18, 2, v16
  v_lshlrev_b32 v18, 13, v18
  v_and_b32 v19, 3, v0
  v_lshl_or_b32 v19, v17, 2, v19
  v_lshl_or_b32 v18, v19, 4, v18
  s_lshl_b32 s6, s3, 16
  v_add_u32 v8, s6, v18
  v_lshlrev_b32 v18, 4, v16
  v_lshl_or_b32 v18, v17, 9, v18
  v_add_u32 v9, s37, v18
  v_mov_b32 v10, 0x3f803f80
  v_mov_b32 v11, 0x3f803f80
  v_mov_b32 v12, 0
  v_mov_b32 v13, 0
  v_mov_b32 v14, 0
  v_mov_b32 v15, 0
  buffer_store_dwordx4 v[12:15], v8, s[8:11], s39 offen sc1
  buffer_store_dwordx4 v[12:15], v8, s[8:11], s40 offen sc1
  s_add_u32 s6, s36, 0
  buffer_store_dwordx4 v[12:15], v1, s[8:11], s6 offen sc1
  s_add_u32 s6, s36, 131072
  buffer_store_dwordx4 v[12:15], v1, s[8:11], s6 offen sc1
  s_add_u32 s6, s36, 262144
  buffer_store_dwordx4 v[12:15], v1, s[8:11], s6 offen sc1
  s_add_u32 s6, s36, 393216
  buffer_store_dwordx4 v[12:15], v1, s[8:11], s6 offen sc1
  s_mov_b64 exec, 0xffff
  buffer_store_dwordx4 v[12:15], v1, s[8:11], s43 offen sc1
  s_mov_b64 exec, -1
  s_cmp_eq_u32 s4, 1
  s_cbranch_scc1 L_pro
  s_branch L_rec3
L_rec2:
  v_and_b32 v16, 15, v0
  v_lshrrev_b32 v17, 4, v0
  v_lshlrev_b32 v1, 4, v0
  s_lshl_b32 s6, s3, 8
  s_add_u32 s6, s6, 24576
  v_mul_u32_u24 v18, 1088, v17
  v_lshl_add_u32 v18, v16, 3, v18
  v_add_u32 v2, s6, v18
  v_and_b32 v18, 3, v0
  v_mul_u32_u24 v18, 1088, v18
  v_bfe_u32 v19, v0, 2, 3
  v_lshl_add_u32 v18, v19, 3, v18
  v_lshrrev_b32 v19, 5, v0
  v_lshl_add_u32 v18, v19, 7, v18
  v_add_u32 v3, 24576, v18
  v_and_b32 v18, 7, v0
  v_bfe_u32 v19, v0, 3, 1
  v_lshl_or_b32 v18, v19, 4, v18
  v_lshlrev_b32 v18, 4, v18
  v_lshl_add_u32 v18, v17, 9, v18
  v_add_u32 v4, 8192, v18
  v_lshrrev_b32 v18, 2, v16
  v_and_b32 v19, 1, v0
  v_lshl_or_b32 v18, v18, 1, v19
  v_mul_u32_u24 v18, 288, v18
  v_lshl_add_u32 v18, v17, 2, v18
  s_lshl_b32 s6, s3, 6
  s_add_u32 s6, s6, 28928
  v_add_u32 v5, s6, v18
  v_lshrrev_b32 v18, 1, v16
  v_mul_u32_u24 v18, 288, v18
  v_lshl_add_u32 v18, v17, 5, v18
  v_lshl_add_u32 v18, v19, 4, v18
  v_add_u32 v6, 28928, v18
  s_lshl_b32 s6, s3, 15
  s_add_u32 s6, s6, 32768
  v_add_u32 v7, s6, v1
  v_lshrrev_b32 v18, 2, v16
  v_lshlrev_b32 v18, 13, v18
  v_and_b32 v19, 3, v0
  v_lshl_or_b32 v19, v17, 2, v19
  v_lshl_or_b32 v18, v19, 4, v18
  s_lshl_b32 s6, s3, 16
  v_add_u32 v8, s6, v18
  v_lshlrev_b32 v18, 4, v16
  v_lshl_or_b32 v18, v17, 9, v18
  v_add_u32 v9, s37, v18
  v_mov_b32 v10, 0x3f803f80
  v_mov_b32 v11, 0x3f803f80
  v_mov_b32 v12, 0
  v_mov_b32 v13, 0
  v_mov_b32 v14, 0
  v_mov_b32 v15, 0
L_rec3:
  s_mov_b32 s16, s82
  s_mov_b32 s17, s83
  s_mov_b32 s18, 0x400000
  s_mov_b32 s19, 0x20000
  s_mov_b32 s20, s84
  s_mov_b32 s21, s85
  s_mov_b32 s22, 0x400000
  s_mov_b32 s23, 0x20000
  s_mov_b32 s24, s86
  s_mov_b32 s25, s87
  s_mov_b32 s26, 0x400000
  s_mov_b32 s27, 0x20000
  s_mov_b32 s28, s88
  s_mov_b32 s29, s89
  s_mov_b32 s30, 0x400000
  s_mov_b32 s31, 0x20000
  s_lshr_b32 s6, 0x72, s4
  s_bitcmp1_b32 s6, 0
  s_cbranch_scc1 L_rdn_16
  s_waitcnt vmcnt(0)
  s_barrier
  s_cmp_lg_u32 s3, 0
  s_cbranch_scc1 L_sd_17
  s_mov_b64 exec, 1
  s_and_b32 s6, s4, 3
  s_lshl_b32 s6, s6, 6
  v_mov_b32 v18, 16
  v_mov_b32 v19, 1
  buffer_atomic_add v19, v18, s[12:15], s6 offen sc1
  s_mov_b64 exec, -1
L_sd_17:
L_rdn_16:
  v_bfe_u32 v16, v0, 4, 1
  v_lshrrev_b32 v17, 5, v0
  v_lshl_or_b32 v18, v17, 5, v16
  s_and_b32 s6, s3, 1
  s_lshr_b32 s7, s3, 1
  s_lshl_b32 s60, s6, 4
  s_lshl_b32 s7, s7, 6
  s_add_u32 s7, s7, s60
  v_add_u32 v18, s7, v18
  v_lshlrev_b32 v18, 13, v18
  v_lshrrev_b32 v19, 4, v0
  s_lshl_b32 s6, s6, 2
  v_or_b32 v19, s6, v19
  v_lshlrev_b32 v19, 1, v19
  v_and_b32 v116, 15, v0
  v_xor_b32 v19, v19, v116
  v_lshl_or_b32 v116, v19, 4, v18
  v_bfe_u32 v18, v0, 2, 2
  v_lshl_or_b32 v19, v16, 2, v18
  v_lshl_or_b32 v18, v17, 3, v18
  v_lshl_or_b32 v18, v16, 5, v18
  v_lshlrev_b32 v18, 8, v18
  s_lshl_b32 s6, s3, 1
  v_xor_b32 v19, s6, v19
  v_lshl_or_b32 v18, v19, 5, v18
  v_and_b32 v19, 3, v0
  v_lshl_or_b32 v18, v19, 3, v18
  v_add_u32 v120, 32768, v18
  v_xor_b32 v121, 32, v120
  v_add_u32 v122, 0x10000, v120
  v_add_u32 v123, 0x10000, v121
  v_lshrrev_b32 v16, 4, v0
  v_and_b32 v17, 15, v0
  v_lshlrev_b32 v18, 1, v16
  v_xor_b32 v17, v17, v18
  v_lshlrev_b32 v17, 4, v17
  v_lshl_or_b32 v118, v16, 10, v17
  v_xor_b32 v119, 0x80, v118
  s_lshl_b32 s60, s3, 13
  s_add_u32 s60, s60, 32768
  v_bfe_u32 v17, v0, 2, 2
  v_bfe_u32 v18, v0, 4, 1
  v_lshl_or_b32 v18, v18, 2, v17
  v_lshl_or_b32 v17, v16, 3, v17
  v_lshlrev_b32 v17, 8, v17
  v_lshl_or_b32 v17, v18, 5, v17
  v_lshl_or_b32 v17, v19, 3, v17
  v_add_u32 v124, s60, v17
  v_add_u32 v127, s60, v1
  s_lshl_b32 s63, s5, 8
  s_add_u32 s61, s63, 0
  s_add_u32 m0, s60, 0
  s_add_u32 s62, s61, 0
  buffer_load_dwordx4 v116, s[16:19], s62 offen lds
  s_add_u32 m0, s60, 1024
  s_add_u32 s62, s61, 16384
  buffer_load_dwordx4 v116, s[16:19], s62 offen lds
  s_add_u32 m0, s60, 2048
  s_add_u32 s62, s61, 32768
  buffer_load_dwordx4 v116, s[16:19], s62 offen lds
  s_add_u32 m0, s60, 3072
  s_add_u32 s62, s61, 49152
  buffer_load_dwordx4 v116, s[16:19], s62 offen lds
  s_add_u32 m0, s60, 4096
  s_add_u32 s62, s61, 65536
  buffer_load_dwordx4 v116, s[16:19], s62 offen lds
  s_add_u32 m0, s60, 5120
  s_add_u32 s62, s61, 81920
  buffer_load_dwordx4 v116, s[16:19], s62 offen lds
  s_add_u32 m0, s60, 6144
  s_add_u32 s62, s61, 98304
  buffer_load_dwordx4 v116, s[16:19], s62 offen lds
  s_add_u32 m0, s60, 7168
  s_add_u32 s62, s61, 114688
  buffer_load_dwordx4 v116, s[16:19], s62 offen lds
  s_add_u32 s61, s63, 1048576
  s_add_u32 m0, s60, 32768
  s_add_u32 s62, s61, 0
  buffer_load_dwordx4 v116, s[16:19], s62 offen lds
  s_add_u32 m0, s60, 33792
  s_add_u32 s62, s61, 16384
  buffer_load_dwordx4 v116, s[16:19], s62 offen lds
  s_add_u32 m0, s60, 34816
  s_add_u32 s62, s61, 32768
  buffer_load_dwordx4 v116, s[16:19], s62 offen lds
  s_add_u32 m0, s60, 35840
  s_add_u32 s62, s61, 49152
  buffer_load_dwordx4 v116, s[16:19], s62 offen lds
  s_add_u32 m0, s60, 36864
  s_add_u32 s62, s61, 65536
  buffer_load_dwordx4 v116, s[16:19], s62 offen lds
  s_add_u32 m0, s60, 37888
  s_add_u32 s62, s61, 81920
  buffer_load_dwordx4 v116, s[16:19], s62 offen lds
  s_add_u32 m0, s60, 38912
  s_add_u32 s62, s61, 98304
  buffer_load_dwordx4 v116, s[16:19], s62 offen lds
  s_add_u32 m0, s60, 39936
  s_add_u32 s62, s61, 114688
  buffer_load_dwordx4 v116, s[16:19], s62 offen lds
  s_add_u32 s61, s63, 2097152
  s_add_u32 m0, s60, 65536
  s_add_u32 s62, s61, 0
  buffer_load_dwordx4 v116, s[16:19], s62 offen lds
  s_add_u32 m0, s60, 66560
  s_add_u32 s62, s61, 16384
  buffer_load_dwordx4 v116, s[16:19], s62 offen lds
  s_add_u32 m0, s60, 67584
  s_add_u32 s62, s61, 32768
  buffer_load_dwordx4 v116, s[16:19], s62 offen lds
  s_add_u32 m0, s60, 68608
  s_add_u32 s62, s61, 49152
  buffer_load_dwordx4 v116, s[16:19], s62 offen lds
  s_add_u32 m0, s60, 69632
  s_add_u32 s62, s61, 65536
  buffer_load_dwordx4 v116, s[16:19], s62 offen lds
  s_add_u32 m0, s60, 70656
  s_add_u32 s62, s61, 81920
  buffer_load_dwordx4 v116, s[16:19], s62 offen lds
  s_add_u32 m0, s60, 71680
  s_add_u32 s62, s61, 98304
  buffer_load_dwordx4 v116, s[16:19], s62 offen lds
  s_add_u32 m0, s60, 72704
  s_add_u32 s62, s61, 114688
  buffer_load_dwordx4 v116, s[16:19], s62 offen lds
  s_waitcnt vmcnt(16)
  s_barrier
  s_add_u32 s61, s63, 3145728
  s_add_u32 m0, s60, 98304
  s_add_u32 s62, s61, 0
  buffer_load_dwordx4 v116, s[16:19], s62 offen lds
  s_add_u32 m0, s60, 99328
  s_add_u32 s62, s61, 16384
  buffer_load_dwordx4 v116, s[16:19], s62 offen lds
  s_add_u32 m0, s60, 100352
  s_add_u32 s62, s61, 32768
  buffer_load_dwordx4 v116, s[16:19], s62 offen lds
  s_add_u32 m0, s60, 101376
  s_add_u32 s62, s61, 49152
  buffer_load_dwordx4 v116, s[16:19], s62 offen lds
  s_add_u32 m0, s60, 102400
  s_add_u32 s62, s61, 65536
  buffer_load_dwordx4 v116, s[16:19], s62 offen lds
  s_add_u32 m0, s60, 103424
  s_add_u32 s62, s61, 81920
  buffer_load_dwordx4 v116, s[16:19], s62 offen lds
  s_add_u32 m0, s60, 104448
  s_add_u32 s62, s61, 98304
  buffer_load_dwordx4 v116, s[16:19], s62 offen lds
  s_add_u32 m0, s60, 105472
  s_add_u32 s62, s61, 114688
  buffer_load_dwordx4 v116, s[16:19], s62 offen lds
  s_cmp_eq_u32 s3, 1
  s_cbranch_scc1 L_lv_20
  s_cmp_eq_u32 s3, 2
  s_cbranch_scc1 L_lv_21
  s_cmp_eq_u32 s3, 3
  s_cbranch_scc1 L_lv_22
L_lv_19:
  ds_read_b64_tr_b16 a[0:1], v120 offset:0
  ds_read_b64_tr_b16 a[2:3], v120 offset:1024
  ds_read_b64_tr_b16 a[4:5], v120 offset:4096
  ds_read_b64_tr_b16 a[6:7], v120 offset:5120
  ds_read_b64_tr_b16 a[8:9], v121 offset:0
  ds_read_b64_tr_b16 a[10:11], v121 offset:1024
  ds_read_b64_tr_b16 a[12:13], v121 offset:4096
  ds_read_b64_tr_b16 a[14:15], v121 offset:5120
  ds_read_b64_tr_b16 a[16:17], v120 offset:16384
  ds_read_b64_tr_b16 a[18:19], v120 offset:17408
  ds_read_b64_tr_b16 a[20:21], v120 offset:20480
  ds_read_b64_tr_b16 a[22:23], v120 offset:21504
  ds_read_b64_tr_b16 a[24:25], v121 offset:16384
  ds_read_b64_tr_b16 a[26:27], v121 offset:17408
  ds_read_b64_tr_b16 a[28:29], v121 offset:20480
  ds_read_b64_tr_b16 a[30:31], v121 offset:21504
  s_branch L_lw_18
L_lv_20:
  ds_read_b64_tr_b16 a[96:97], v120 offset:0
  ds_read_b64_tr_b16 a[98:99], v120 offset:1024
  ds_read_b64_tr_b16 a[100:101], v120 offset:4096
  ds_read_b64_tr_b16 a[102:103], v120 offset:5120
  ds_read_b64_tr_b16 a[104:105], v121 offset:0
  ds_read_b64_tr_b16 a[106:107], v121 offset:1024
  ds_read_b64_tr_b16 a[108:109], v121 offset:4096
  ds_read_b64_tr_b16 a[110:111], v121 offset:5120
  ds_read_b64_tr_b16 a[112:113], v120 offset:16384
  ds_read_b64_tr_b16 a[114:115], v120 offset:17408
  ds_read_b64_tr_b16 a[116:117], v120 offset:20480
  ds_read_b64_tr_b16 a[118:119], v120 offset:21504
  ds_read_b64_tr_b16 a[120:121], v121 offset:16384
  ds_read_b64_tr_b16 a[122:123], v121 offset:17408
  ds_read_b64_tr_b16 a[124:125], v121 offset:20480
  ds_read_b64_tr_b16 a[126:127], v121 offset:21504
  s_branch L_lw_18
L_lv_21:
  ds_read_b64_tr_b16 a[64:65], v120 offset:0
  ds_read_b64_tr_b16 a[66:67], v120 offset:1024
  ds_read_b64_tr_b16 a[68:69], v120 offset:4096
  ds_read_b64_tr_b16 a[70:71], v120 offset:5120
  ds_read_b64_tr_b16 a[72:73], v121 offset:0
  ds_read_b64_tr_b16 a[74:75], v121 offset:1024
  ds_read_b64_tr_b16 a[76:77], v121 offset:4096
  ds_read_b64_tr_b16 a[78:79], v121 offset:5120
  ds_read_b64_tr_b16 a[80:81], v120 offset:16384
  ds_read_b64_tr_b16 a[82:83], v120 offset:17408
  ds_read_b64_tr_b16 a[84:85], v120 offset:20480
  ds_read_b64_tr_b16 a[86:87], v120 offset:21504
  ds_read_b64_tr_b16 a[88:89], v121 offset:16384
  ds_read_b64_tr_b16 a[90:91], v121 offset:17408
  ds_read_b64_tr_b16 a[92:93], v121 offset:20480
  ds_read_b64_tr_b16 a[94:95], v121 offset:21504
  s_branch L_lw_18
L_lv_22:
  ds_read_b64_tr_b16 a[32:33], v120 offset:0
  ds_read_b64_tr_b16 a[34:35], v120 offset:1024
  ds_read_b64_tr_b16 a[36:37], v120 offset:4096
  ds_read_b64_tr_b16 a[38:39], v120 offset:5120
  ds_read_b64_tr_b16 a[40:41], v121 offset:0
  ds_read_b64_tr_b16 a[42:43], v121 offset:1024
  ds_read_b64_tr_b16 a[44:45], v121 offset:4096
  ds_read_b64_tr_b16 a[46:47], v121 offset:5120
  ds_read_b64_tr_b16 a[48:49], v120 offset:16384
  ds_read_b64_tr_b16 a[50:51], v120 offset:17408
  ds_read_b64_tr_b16 a[52:53], v120 offset:20480
  ds_read_b64_tr_b16 a[54:55], v120 offset:21504
  ds_read_b64_tr_b16 a[56:57], v121 offset:16384
  ds_read_b64_tr_b16 a[58:59], v121 offset:17408
  ds_read_b64_tr_b16 a[60:61], v121 offset:20480
  ds_read_b64_tr_b16 a[62:63], v121 offset:21504
L_lw_18:
  s_waitcnt lgkmcnt(0)
  s_waitcnt vmcnt(16)
  s_barrier
  s_add_u32 s61, s63, 0
  s_add_u32 m0, s60, 0
  s_add_u32 s62, s61, 0
  buffer_load_dwordx4 v116, s[20:23], s62 offen lds
  s_add_u32 m0, s60, 1024
  s_add_u32 s62, s61, 16384
  buffer_load_dwordx4 v116, s[20:23], s62 offen lds
  s_add_u32 m0, s60, 2048
  s_add_u32 s62, s61, 32768
  buffer_load_dwordx4 v116, s[20:23], s62 offen lds
  s_add_u32 m0, s60, 3072
  s_add_u32 s62, s61, 49152
  buffer_load_dwordx4 v116, s[20:23], s62 offen lds
  s_add_u32 m0, s60, 4096
  s_add_u32 s62, s61, 65536
  buffer_load_dwordx4 v116, s[20:23], s62 offen lds
  s_add_u32 m0, s60, 5120
  s_add_u32 s62, s61, 81920
  buffer_load_dwordx4 v116, s[20:23], s62 offen lds
  s_add_u32 m0, s60, 6144
  s_add_u32 s62, s61, 98304
  buffer_load_dwordx4 v116, s[20:23], s62 offen lds
  s_add_u32 m0, s60, 7168
  s_add_u32 s62, s61, 114688
  buffer_load_dwordx4 v116, s[20:23], s62 offen lds
  s_cmp_eq_u32 s3, 1
  s_cbranch_scc1 L_lv_25
  s_cmp_eq_u32 s3, 2
  s_cbranch_scc1 L_lv_26
  s_cmp_eq_u32 s3, 3
  s_cbranch_scc1 L_lv_27
L_lv_24:
  ds_read_b64_tr_b16 a[32:33], v120 offset:32768
  ds_read_b64_tr_b16 a[34:35], v120 offset:33792
  ds_read_b64_tr_b16 a[36:37], v120 offset:36864
  ds_read_b64_tr_b16 a[38:39], v120 offset:37888
  ds_read_b64_tr_b16 a[40:41], v121 offset:32768
  ds_read_b64_tr_b16 a[42:43], v121 offset:33792
  ds_read_b64_tr_b16 a[44:45], v121 offset:36864
  ds_read_b64_tr_b16 a[46:47], v121 offset:37888
  ds_read_b64_tr_b16 a[48:49], v120 offset:49152
  ds_read_b64_tr_b16 a[50:51], v120 offset:50176
  ds_read_b64_tr_b16 a[52:53], v120 offset:53248
  ds_read_b64_tr_b16 a[54:55], v120 offset:54272
  ds_read_b64_tr_b16 a[56:57], v121 offset:49152
  ds_read_b64_tr_b16 a[58:59], v121 offset:50176
  ds_read_b64_tr_b16 a[60:61], v121 offset:53248
  ds_read_b64_tr_b16 a[62:63], v121 offset:54272
  s_branch L_lw_23
L_lv_25:
  ds_read_b64_tr_b16 a[0:1], v120 offset:32768
  ds_read_b64_tr_b16 a[2:3], v120 offset:33792
  ds_read_b64_tr_b16 a[4:5], v120 offset:36864
  ds_read_b64_tr_b16 a[6:7], v120 offset:37888
  ds_read_b64_tr_b16 a[8:9], v121 offset:32768
  ds_read_b64_tr_b16 a[10:11], v121 offset:33792
  ds_read_b64_tr_b16 a[12:13], v121 offset:36864
  ds_read_b64_tr_b16 a[14:15], v121 offset:37888
  ds_read_b64_tr_b16 a[16:17], v120 offset:49152
  ds_read_b64_tr_b16 a[18:19], v120 offset:50176
  ds_read_b64_tr_b16 a[20:21], v120 offset:53248
  ds_read_b64_tr_b16 a[22:23], v120 offset:54272
  ds_read_b64_tr_b16 a[24:25], v121 offset:49152
  ds_read_b64_tr_b16 a[26:27], v121 offset:50176
  ds_read_b64_tr_b16 a[28:29], v121 offset:53248
  ds_read_b64_tr_b16 a[30:31], v121 offset:54272
  s_branch L_lw_23
L_lv_26:
  ds_read_b64_tr_b16 a[96:97], v120 offset:32768
  ds_read_b64_tr_b16 a[98:99], v120 offset:33792
  ds_read_b64_tr_b16 a[100:101], v120 offset:36864
  ds_read_b64_tr_b16 a[102:103], v120 offset:37888
  ds_read_b64_tr_b16 a[104:105], v121 offset:32768
  ds_read_b64_tr_b16 a[106:107], v121 offset:33792
  ds_read_b64_tr_b16 a[108:109], v121 offset:36864
  ds_read_b64_tr_b16 a[110:111], v121 offset:37888
  ds_read_b64_tr_b16 a[112:113], v120 offset:49152
  ds_read_b64_tr_b16 a[114:115], v120 offset:50176
  ds_read_b64_tr_b16 a[116:117], v120 offset:53248
  ds_read_b64_tr_b16 a[118:119], v120 offset:54272
  ds_read_b64_tr_b16 a[120:121], v121 offset:49152
  ds_read_b64_tr_b16 a[122:123], v121 offset:50176
  ds_read_b64_tr_b16 a[124:125], v121 offset:53248
  ds_read_b64_tr_b16 a[126:127], v121 offset:54272
  s_branch L_lw_23
L_lv_27:
  ds_read_b64_tr_b16 a[64:65], v120 offset:32768
  ds_read_b64_tr_b16 a[66:67], v120 offset:33792
  ds_read_b64_tr_b16 a[68:69], v120 offset:36864
  ds_read_b64_tr_b16 a[70:71], v120 offset:37888
  ds_read_b64_tr_b16 a[72:73], v121 offset:32768
  ds_read_b64_tr_b16 a[74:75], v121 offset:33792
  ds_read_b64_tr_b16 a[76:77], v121 offset:36864
  ds_read_b64_tr_b16 a[78:79], v121 offset:37888
  ds_read_b64_tr_b16 a[80:81], v120 offset:49152
  ds_read_b64_tr_b16 a[82:83], v120 offset:50176
  ds_read_b64_tr_b16 a[84:85], v120 offset:53248
  ds_read_b64_tr_b16 a[86:87], v120 offset:54272
  ds_read_b64_tr_b16 a[88:89], v121 offset:49152
  ds_read_b64_tr_b16 a[90:91], v121 offset:50176
  ds_read_b64_tr_b16 a[92:93], v121 offset:53248
  ds_read_b64_tr_b16 a[94:95], v121 offset:54272
L_lw_23:
  s_waitcnt lgkmcnt(0)
  s_waitcnt vmcnt(16)
  s_barrier
  s_add_u32 s61, s63, 1048576
  s_add_u32 m0, s60, 32768
  s_add_u32 s62, s61, 0
  buffer_load_dwordx4 v116, s[20:23], s62 offen lds
  s_add_u32 m0, s60, 33792
  s_add_u32 s62, s61, 16384
  buffer_load_dwordx4 v116, s[20:23], s62 offen lds
  s_add_u32 m0, s60, 34816
  s_add_u32 s62, s61, 32768
  buffer_load_dwordx4 v116, s[20:23], s62 offen lds
  s_add_u32 m0, s60, 35840
  s_add_u32 s62, s61, 49152
  buffer_load_dwordx4 v116, s[20:23], s62 offen lds
  s_add_u32 m0, s60, 36864
  s_add_u32 s62, s61, 65536
  buffer_load_dwordx4 v116, s[20:23], s62 offen lds
  s_add_u32 m0, s60, 37888
  s_add_u32 s62, s61, 81920
  buffer_load_dwordx4 v116, s[20:23], s62 offen lds
  s_add_u32 m0, s60, 38912
  s_add_u32 s62, s61, 98304
  buffer_load_dwordx4 v116, s[20:23], s62 offen lds
  s_add_u32 m0, s60, 39936
  s_add_u32 s62, s61, 114688
  buffer_load_dwordx4 v116, s[20:23], s62 offen lds
  s_cmp_eq_u32 s3, 1
  s_cbranch_scc1 L_lv_30
  s_cmp_eq_u32 s3, 2
  s_cbranch_scc1 L_lv_31
  s_cmp_eq_u32 s3, 3
  s_cbranch_scc1 L_lv_32
L_lv_29:
  ds_read_b64_tr_b16 a[64:65], v122 offset:0
  ds_read_b64_tr_b16 a[66:67], v122 offset:1024
  ds_read_b64_tr_b16 a[68:69], v122 offset:4096
  ds_read_b64_tr_b16 a[70:71], v122 offset:5120
  ds_read_b64_tr_b16 a[72:73], v123 offset:0
  ds_read_b64_tr_b16 a[74:75], v123 offset:1024
  ds_read_b64_tr_b16 a[76:77], v123 offset:4096
  ds_read_b64_tr_b16 a[78:79], v123 offset:5120
  ds_read_b64_tr_b16 a[80:81], v122 offset:16384
  ds_read_b64_tr_b16 a[82:83], v122 offset:17408
  ds_read_b64_tr_b16 a[84:85], v122 offset:20480
  ds_read_b64_tr_b16 a[86:87], v122 offset:21504
  ds_read_b64_tr_b16 a[88:89], v123 offset:16384
  ds_read_b64_tr_b16 a[90:91], v123 offset:17408
  ds_read_b64_tr_b16 a[92:93], v123 offset:20480
  ds_read_b64_tr_b16 a[94:95], v123 offset:21504
  s_branch L_lw_28
L_lv_30:
  ds_read_b64_tr_b16 a[32:33], v122 offset:0
  ds_read_b64_tr_b16 a[34:35], v122 offset:1024
  ds_read_b64_tr_b16 a[36:37], v122 offset:4096
  ds_read_b64_tr_b16 a[38:39], v122 offset:5120
  ds_read_b64_tr_b16 a[40:41], v123 offset:0
  ds_read_b64_tr_b16 a[42:43], v123 offset:1024
  ds_read_b64_tr_b16 a[44:45], v123 offset:4096
  ds_read_b64_tr_b16 a[46:47], v123 offset:5120
  ds_read_b64_tr_b16 a[48:49], v122 offset:16384
  ds_read_b64_tr_b16 a[50:51], v122 offset:17408
  ds_read_b64_tr_b16 a[52:53], v122 offset:20480
  ds_read_b64_tr_b16 a[54:55], v122 offset:21504
  ds_read_b64_tr_b16 a[56:57], v123 offset:16384
  ds_read_b64_tr_b16 a[58:59], v123 offset:17408
  ds_read_b64_tr_b16 a[60:61], v123 offset:20480
  ds_read_b64_tr_b16 a[62:63], v123 offset:21504
  s_branch L_lw_28
L_lv_31:
  ds_read_b64_tr_b16 a[0:1], v122 offset:0
  ds_read_b64_tr_b16 a[2:3], v122 offset:1024
  ds_read_b64_tr_b16 a[4:5], v122 offset:4096
  ds_read_b64_tr_b16 a[6:7], v122 offset:5120
  ds_read_b64_tr_b16 a[8:9], v123 offset:0
  ds_read_b64_tr_b16 a[10:11], v123 offset:1024
  ds_read_b64_tr_b16 a[12:13], v123 offset:4096
  ds_read_b64_tr_b16 a[14:15], v123 offset:5120
  ds_read_b64_tr_b16 a[16:17], v122 offset:16384
  ds_read_b64_tr_b16 a[18:19], v122 offset:17408
  ds_read_b64_tr_b16 a[20:21], v122 offset:20480
  ds_read_b64_tr_b16 a[22:23], v122 offset:21504
  ds_read_b64_tr_b16 a[24:25], v123 offset:16384
  ds_read_b64_tr_b16 a[26:27], v123 offset:17408
  ds_read_b64_tr_b16 a[28:29], v123 offset:20480
  ds_read_b64_tr_b16 a[30:31], v123 offset:21504
  s_branch L_lw_28
L_lv_32:
  ds_read_b64_tr_b16 a[96:97], v122 offset:0
  ds_read_b64_tr_b16 a[98:99], v122 offset:1024
  ds_read_b64_tr_b16 a[100:101], v122 offset:4096
  ds_read_b64_tr_b16 a[102:103], v122 offset:5120
  ds_read_b64_tr_b16 a[104:105], v123 offset:0
  ds_read_b64_tr_b16 a[106:107], v123 offset:1024
  ds_read_b64_tr_b16 a[108:109], v123 offset:4096
  ds_read_b64_tr_b16 a[110:111], v123 offset:5120
  ds_read_b64_tr_b16 a[112:113], v122 offset:16384
  ds_read_b64_tr_b16 a[114:115], v122 offset:17408
  ds_read_b64_tr_b16 a[116:117], v122 offset:20480
  ds_read_b64_tr_b16 a[118:119], v122 offset:21504
  ds_read_b64_tr_b16 a[120:121], v123 offset:16384
  ds_read_b64_tr_b16 a[122:123], v123 offset:17408
  ds_read_b64_tr_b16 a[124:125], v123 offset:20480
  ds_read_b64_tr_b16 a[126:127], v123 offset:21504
L_lw_28:
  s_waitcnt lgkmcnt(0)
  s_waitcnt vmcnt(16)
  s_barrier
  s_add_u32 s61, s63, 2097152
  s_add_u32 m0, s60, 65536
  s_add_u32 s62, s61, 0
  buffer_load_dwordx4 v116, s[20:23], s62 offen lds
  s_add_u32 m0, s60, 66560
  s_add_u32 s62, s61, 16384
  buffer_load_dwordx4 v116, s[20:23], s62 offen lds
  s_add_u32 m0, s60, 67584
  s_add_u32 s62, s61, 32768
  buffer_load_dwordx4 v116, s[20:23], s62 offen lds
  s_add_u32 m0, s60, 68608
  s_add_u32 s62, s61, 49152
  buffer_load_dwordx4 v116, s[20:23], s62 offen lds
  s_add_u32 m0, s60, 69632
  s_add_u32 s62, s61, 65536
  buffer_load_dwordx4 v116, s[20:23], s62 offen lds
  s_add_u32 m0, s60, 70656
  s_add_u32 s62, s61, 81920
  buffer_load_dwordx4 v116, s[20:23], s62 offen lds
  s_add_u32 m0, s60, 71680
  s_add_u32 s62, s61, 98304
  buffer_load_dwordx4 v116, s[20:23], s62 offen lds
  s_add_u32 m0, s60, 72704
  s_add_u32 s62, s61, 114688
  buffer_load_dwordx4 v116, s[20:23], s62 offen lds
  s_cmp_eq_u32 s3, 1
  s_cbranch_scc1 L_lv_35
  s_cmp_eq_u32 s3, 2
  s_cbranch_scc1 L_lv_36
  s_cmp_eq_u32 s3, 3
  s_cbranch_scc1 L_lv_37
L_lv_34:
  ds_read_b64_tr_b16 a[96:97], v122 offset:32768
  ds_read_b64_tr_b16 a[98:99], v122 offset:33792
  ds_read_b64_tr_b16 a[100:101], v122 offset:36864
  ds_read_b64_tr_b16 a[102:103], v122 offset:37888
  ds_read_b64_tr_b16 a[104:105], v123 offset:32768
  ds_read_b64_tr_b16 a[106:107], v123 offset:33792
  ds_read_b64_tr_b16 a[108:109], v123 offset:36864
  ds_read_b64_tr_b16 a[110:111], v123 offset:37888
  ds_read_b64_tr_b16 a[112:113], v122 offset:49152
  ds_read_b64_tr_b16 a[114:115], v122 offset:50176
  ds_read_b64_tr_b16 a[116:117], v122 offset:53248
  ds_read_b64_tr_b16 a[118:119], v122 offset:54272
  ds_read_b64_tr_b16 a[120:121], v123 offset:49152
  ds_read_b64_tr_b16 a[122:123], v123 offset:50176
  ds_read_b64_tr_b16 a[124:125], v123 offset:53248
  ds_read_b64_tr_b16 a[126:127], v123 offset:54272
  s_branch L_lw_33
L_lv_35:
  ds_read_b64_tr_b16 a[64:65], v122 offset:32768
  ds_read_b64_tr_b16 a[66:67], v122 offset:33792
  ds_read_b64_tr_b16 a[68:69], v122 offset:36864
  ds_read_b64_tr_b16 a[70:71], v122 offset:37888
  ds_read_b64_tr_b16 a[72:73], v123 offset:32768
  ds_read_b64_tr_b16 a[74:75], v123 offset:33792
  ds_read_b64_tr_b16 a[76:77], v123 offset:36864
  ds_read_b64_tr_b16 a[78:79], v123 offset:37888
  ds_read_b64_tr_b16 a[80:81], v122 offset:49152
  ds_read_b64_tr_b16 a[82:83], v122 offset:50176
  ds_read_b64_tr_b16 a[84:85], v122 offset:53248
  ds_read_b64_tr_b16 a[86:87], v122 offset:54272
  ds_read_b64_tr_b16 a[88:89], v123 offset:49152
  ds_read_b64_tr_b16 a[90:91], v123 offset:50176
  ds_read_b64_tr_b16 a[92:93], v123 offset:53248
  ds_read_b64_tr_b16 a[94:95], v123 offset:54272
  s_branch L_lw_33
L_lv_36:
  ds_read_b64_tr_b16 a[32:33], v122 offset:32768
  ds_read_b64_tr_b16 a[34:35], v122 offset:33792
  ds_read_b64_tr_b16 a[36:37], v122 offset:36864
  ds_read_b64_tr_b16 a[38:39], v122 offset:37888
  ds_read_b64_tr_b16 a[40:41], v123 offset:32768
  ds_read_b64_tr_b16 a[42:43], v123 offset:33792
  ds_read_b64_tr_b16 a[44:45], v123 offset:36864
  ds_read_b64_tr_b16 a[46:47], v123 offset:37888
  ds_read_b64_tr_b16 a[48:49], v122 offset:49152
  ds_read_b64_tr_b16 a[50:51], v122 offset:50176
  ds_read_b64_tr_b16 a[52:53], v122 offset:53248
  ds_read_b64_tr_b16 a[54:55], v122 offset:54272
  ds_read_b64_tr_b16 a[56:57], v123 offset:49152
  ds_read_b64_tr_b16 a[58:59], v123 offset:50176
  ds_read_b64_tr_b16 a[60:61], v123 offset:53248
  ds_read_b64_tr_b16 a[62:63], v123 offset:54272
  s_branch L_lw_33
L_lv_37:
  ds_read_b64_tr_b16 a[0:1], v122 offset:32768
  ds_read_b64_tr_b16 a[2:3], v122 offset:33792
  ds_read_b64_tr_b16 a[4:5], v122 offset:36864
  ds_read_b64_tr_b16 a[6:7], v122 offset:37888
  ds_read_b64_tr_b16 a[8:9], v123 offset:32768
  ds_read_b64_tr_b16 a[10:11], v123 offset:33792
  ds_read_b64_tr_b16 a[12:13], v123 offset:36864
  ds_read_b64_tr_b16 a[14:15], v123 offset:37888
  ds_read_b64_tr_b16 a[16:17], v122 offset:49152
  ds_read_b64_tr_b16 a[18:19], v122 offset:50176
  ds_read_b64_tr_b16 a[20:21], v122 offset:53248
  ds_read_b64_tr_b16 a[22:23], v122 offset:54272
  ds_read_b64_tr_b16 a[24:25], v123 offset:49152
  ds_read_b64_tr_b16 a[26:27], v123 offset:50176
  ds_read_b64_tr_b16 a[28:29], v123 offset:53248
  ds_read_b64_tr_b16 a[30:31], v123 offset:54272
L_lw_33:
  s_waitcnt lgkmcnt(0)
  s_waitcnt vmcnt(16)
  s_barrier
  s_add_u32 s61, s63, 3145728
  s_add_u32 m0, s60, 98304
  s_add_u32 s62, s61, 0
  buffer_load_dwordx4 v116, s[20:23], s62 offen lds
  s_add_u32 m0, s60, 99328
  s_add_u32 s62, s61, 16384
  buffer_load_dwordx4 v116, s[20:23], s62 offen lds
  s_add_u32 m0, s60, 100352
  s_add_u32 s62, s61, 32768
  buffer_load_dwordx4 v116, s[20:23], s62 offen lds
  s_add_u32 m0, s60, 101376
  s_add_u32 s62, s61, 49152
  buffer_load_dwordx4 v116, s[20:23], s62 offen lds
  s_add_u32 m0, s60, 102400
  s_add_u32 s62, s61, 65536
  buffer_load_dwordx4 v116, s[20:23], s62 offen lds
  s_add_u32 m0, s60, 103424
  s_add_u32 s62, s61, 81920
  buffer_load_dwordx4 v116, s[20:23], s62 offen lds
  s_add_u32 m0, s60, 104448
  s_add_u32 s62, s61, 98304
  buffer_load_dwordx4 v116, s[20:23], s62 offen lds
  s_add_u32 m0, s60, 105472
  s_add_u32 s62, s61, 114688
  buffer_load_dwordx4 v116, s[20:23], s62 offen lds
  s_cmp_eq_u32 s3, 1
  s_cbranch_scc1 L_lv_40
  s_cmp_eq_u32 s3, 2
  s_cbranch_scc1 L_lv_41
  s_cmp_eq_u32 s3, 3
  s_cbranch_scc1 L_lv_42
L_lv_39:
  ds_read_b64_tr_b16 a[128:129], v120 offset:0
  ds_read_b64_tr_b16 a[130:131], v120 offset:1024
  ds_read_b64_tr_b16 a[132:133], v120 offset:4096
  ds_read_b64_tr_b16 a[134:135], v120 offset:5120
  ds_read_b64_tr_b16 a[136:137], v121 offset:0
  ds_read_b64_tr_b16 a[138:139], v121 offset:1024
  ds_read_b64_tr_b16 a[140:141], v121 offset:4096
  ds_read_b64_tr_b16 a[142:143], v121 offset:5120
  ds_read_b64_tr_b16 a[144:145], v120 offset:16384
  ds_read_b64_tr_b16 a[146:147], v120 offset:17408
  ds_read_b64_tr_b16 a[148:149], v120 offset:20480
  ds_read_b64_tr_b16 a[150:151], v120 offset:21504
  ds_read_b64_tr_b16 a[152:153], v121 offset:16384
  ds_read_b64_tr_b16 a[154:155], v121 offset:17408
  ds_read_b64_tr_b16 a[156:157], v121 offset:20480
  ds_read_b64_tr_b16 a[158:159], v121 offset:21504
  s_branch L_lw_38
L_lv_40:
  ds_read_b64_tr_b16 a[224:225], v120 offset:0
  ds_read_b64_tr_b16 a[226:227], v120 offset:1024
  ds_read_b64_tr_b16 a[228:229], v120 offset:4096
  ds_read_b64_tr_b16 a[230:231], v120 offset:5120
  ds_read_b64_tr_b16 a[232:233], v121 offset:0
  ds_read_b64_tr_b16 a[234:235], v121 offset:1024
  ds_read_b64_tr_b16 a[236:237], v121 offset:4096
  ds_read_b64_tr_b16 a[238:239], v121 offset:5120
  ds_read_b64_tr_b16 a[240:241], v120 offset:16384
  ds_read_b64_tr_b16 a[242:243], v120 offset:17408
  ds_read_b64_tr_b16 a[244:245], v120 offset:20480
  ds_read_b64_tr_b16 a[246:247], v120 offset:21504
  ds_read_b64_tr_b16 a[248:249], v121 offset:16384
  ds_read_b64_tr_b16 a[250:251], v121 offset:17408
  ds_read_b64_tr_b16 a[252:253], v121 offset:20480
  ds_read_b64_tr_b16 a[254:255], v121 offset:21504
  s_branch L_lw_38
L_lv_41:
  ds_read_b64_tr_b16 a[192:193], v120 offset:0
  ds_read_b64_tr_b16 a[194:195], v120 offset:1024
  ds_read_b64_tr_b16 a[196:197], v120 offset:4096
  ds_read_b64_tr_b16 a[198:199], v120 offset:5120
  ds_read_b64_tr_b16 a[200:201], v121 offset:0
  ds_read_b64_tr_b16 a[202:203], v121 offset:1024
  ds_read_b64_tr_b16 a[204:205], v121 offset:4096
  ds_read_b64_tr_b16 a[206:207], v121 offset:5120
  ds_read_b64_tr_b16 a[208:209], v120 offset:16384
  ds_read_b64_tr_b16 a[210:211], v120 offset:17408
  ds_read_b64_tr_b16 a[212:213], v120 offset:20480
  ds_read_b64_tr_b16 a[214:215], v120 offset:21504
  ds_read_b64_tr_b16 a[216:217], v121 offset:16384
  ds_read_b64_tr_b16 a[218:219], v121 offset:17408
  ds_read_b64_tr_b16 a[220:221], v121 offset:20480
  ds_read_b64_tr_b16 a[222:223], v121 offset:21504
  s_branch L_lw_38
L_lv_42:
  ds_read_b64_tr_b16 a[160:161], v120 offset:0
  ds_read_b64_tr_b16 a[162:163], v120 offset:1024
  ds_read_b64_tr_b16 a[164:165], v120 offset:4096
  ds_read_b64_tr_b16 a[166:167], v120 offset:5120
  ds_read_b64_tr_b16 a[168:169], v121 offset:0
  ds_read_b64_tr_b16 a[170:171], v121 offset:1024
  ds_read_b64_tr_b16 a[172:173], v121 offset:4096
  ds_read_b64_tr_b16 a[174:175], v121 offset:5120
  ds_read_b64_tr_b16 a[176:177], v120 offset:16384
  ds_read_b64_tr_b16 a[178:179], v120 offset:17408
  ds_read_b64_tr_b16 a[180:181], v120 offset:20480
  ds_read_b64_tr_b16 a[182:183], v120 offset:21504
  ds_read_b64_tr_b16 a[184:185], v121 offset:16384
  ds_read_b64_tr_b16 a[186:187], v121 offset:17408
  ds_read_b64_tr_b16 a[188:189], v121 offset:20480
  ds_read_b64_tr_b16 a[190:191], v121 offset:21504
L_lw_38:
  s_waitcnt lgkmcnt(0)
  s_waitcnt vmcnt(16)
  s_barrier
  s_add_u32 s61, s63, 0
  s_add_u32 m0, s60, 0
  s_add_u32 s62, s61, 0
  buffer_load_dwordx4 v116, s[24:27], s62 offen lds
  s_add_u32 m0, s60, 1024
  s_add_u32 s62, s61, 16384
  buffer_load_dwordx4 v116, s[24:27], s62 offen lds
  s_add_u32 m0, s60, 2048
  s_add_u32 s62, s61, 32768
  buffer_load_dwordx4 v116, s[24:27], s62 offen lds
  s_add_u32 m0, s60, 3072
  s_add_u32 s62, s61, 49152
  buffer_load_dwordx4 v116, s[24:27], s62 offen lds
  s_add_u32 m0, s60, 4096
  s_add_u32 s62, s61, 65536
  buffer_load_dwordx4 v116, s[24:27], s62 offen lds
  s_add_u32 m0, s60, 5120
  s_add_u32 s62, s61, 81920
  buffer_load_dwordx4 v116, s[24:27], s62 offen lds
  s_add_u32 m0, s60, 6144
  s_add_u32 s62, s61, 98304
  buffer_load_dwordx4 v116, s[24:27], s62 offen lds
  s_add_u32 m0, s60, 7168
  s_add_u32 s62, s61, 114688
  buffer_load_dwordx4 v116, s[24:27], s62 offen lds
  s_cmp_eq_u32 s3, 1
  s_cbranch_scc1 L_lv_45
  s_cmp_eq_u32 s3, 2
  s_cbranch_scc1 L_lv_46
  s_cmp_eq_u32 s3, 3
  s_cbranch_scc1 L_lv_47
L_lv_44:
  ds_read_b64_tr_b16 a[160:161], v120 offset:32768
  ds_read_b64_tr_b16 a[162:163], v120 offset:33792
  ds_read_b64_tr_b16 a[164:165], v120 offset:36864
  ds_read_b64_tr_b16 a[166:167], v120 offset:37888
  ds_read_b64_tr_b16 a[168:169], v121 offset:32768
  ds_read_b64_tr_b16 a[170:171], v121 offset:33792
  ds_read_b64_tr_b16 a[172:173], v121 offset:36864
  ds_read_b64_tr_b16 a[174:175], v121 offset:37888
  ds_read_b64_tr_b16 a[176:177], v120 offset:49152
  ds_read_b64_tr_b16 a[178:179], v120 offset:50176
  ds_read_b64_tr_b16 a[180:181], v120 offset:53248
  ds_read_b64_tr_b16 a[182:183], v120 offset:54272
  ds_read_b64_tr_b16 a[184:185], v121 offset:49152
  ds_read_b64_tr_b16 a[186:187], v121 offset:50176
  ds_read_b64_tr_b16 a[188:189], v121 offset:53248
  ds_read_b64_tr_b16 a[190:191], v121 offset:54272
  s_branch L_lw_43
L_lv_45:
  ds_read_b64_tr_b16 a[128:129], v120 offset:32768
  ds_read_b64_tr_b16 a[130:131], v120 offset:33792
  ds_read_b64_tr_b16 a[132:133], v120 offset:36864
  ds_read_b64_tr_b16 a[134:135], v120 offset:37888
  ds_read_b64_tr_b16 a[136:137], v121 offset:32768
  ds_read_b64_tr_b16 a[138:139], v121 offset:33792
  ds_read_b64_tr_b16 a[140:141], v121 offset:36864
  ds_read_b64_tr_b16 a[142:143], v121 offset:37888
  ds_read_b64_tr_b16 a[144:145], v120 offset:49152
  ds_read_b64_tr_b16 a[146:147], v120 offset:50176
  ds_read_b64_tr_b16 a[148:149], v120 offset:53248
  ds_read_b64_tr_b16 a[150:151], v120 offset:54272
  ds_read_b64_tr_b16 a[152:153], v121 offset:49152
  ds_read_b64_tr_b16 a[154:155], v121 offset:50176
  ds_read_b64_tr_b16 a[156:157], v121 offset:53248
  ds_read_b64_tr_b16 a[158:159], v121 offset:54272
  s_branch L_lw_43
L_lv_46:
  ds_read_b64_tr_b16 a[224:225], v120 offset:32768
  ds_read_b64_tr_b16 a[226:227], v120 offset:33792
  ds_read_b64_tr_b16 a[228:229], v120 offset:36864
  ds_read_b64_tr_b16 a[230:231], v120 offset:37888
  ds_read_b64_tr_b16 a[232:233], v121 offset:32768
  ds_read_b64_tr_b16 a[234:235], v121 offset:33792
  ds_read_b64_tr_b16 a[236:237], v121 offset:36864
  ds_read_b64_tr_b16 a[238:239], v121 offset:37888
  ds_read_b64_tr_b16 a[240:241], v120 offset:49152
  ds_read_b64_tr_b16 a[242:243], v120 offset:50176
  ds_read_b64_tr_b16 a[244:245], v120 offset:53248
  ds_read_b64_tr_b16 a[246:247], v120 offset:54272
  ds_read_b64_tr_b16 a[248:249], v121 offset:49152
  ds_read_b64_tr_b16 a[250:251], v121 offset:50176
  ds_read_b64_tr_b16 a[252:253], v121 offset:53248
  ds_read_b64_tr_b16 a[254:255], v121 offset:54272
  s_branch L_lw_43
L_lv_47:
  ds_read_b64_tr_b16 a[192:193], v120 offset:32768
  ds_read_b64_tr_b16 a[194:195], v120 offset:33792
  ds_read_b64_tr_b16 a[196:197], v120 offset:36864
  ds_read_b64_tr_b16 a[198:199], v120 offset:37888
  ds_read_b64_tr_b16 a[200:201], v121 offset:32768
  ds_read_b64_tr_b16 a[202:203], v121 offset:33792
  ds_read_b64_tr_b16 a[204:205], v121 offset:36864
  ds_read_b64_tr_b16 a[206:207], v121 offset:37888
  ds_read_b64_tr_b16 a[208:209], v120 offset:49152
  ds_read_b64_tr_b16 a[210:211], v120 offset:50176
  ds_read_b64_tr_b16 a[212:213], v120 offset:53248
  ds_read_b64_tr_b16 a[214:215], v120 offset:54272
  ds_read_b64_tr_b16 a[216:217], v121 offset:49152
  ds_read_b64_tr_b16 a[218:219], v121 offset:50176
  ds_read_b64_tr_b16 a[220:221], v121 offset:53248
  ds_read_b64_tr_b16 a[222:223], v121 offset:54272
L_lw_43:
  s_waitcnt lgkmcnt(0)
  s_waitcnt vmcnt(16)
  s_barrier
  s_add_u32 s61, s63, 1048576
  s_add_u32 m0, s60, 32768
  s_add_u32 s62, s61, 0
  buffer_load_dwordx4 v116, s[24:27], s62 offen lds
  s_add_u32 m0, s60, 33792
  s_add_u32 s62, s61, 16384
  buffer_load_dwordx4 v116, s[24:27], s62 offen lds
  s_add_u32 m0, s60, 34816
  s_add_u32 s62, s61, 32768
  buffer_load_dwordx4 v116, s[24:27], s62 offen lds
  s_add_u32 m0, s60, 35840
  s_add_u32 s62, s61, 49152
  buffer_load_dwordx4 v116, s[24:27], s62 offen lds
  s_add_u32 m0, s60, 36864
  s_add_u32 s62, s61, 65536
  buffer_load_dwordx4 v116, s[24:27], s62 offen lds
  s_add_u32 m0, s60, 37888
  s_add_u32 s62, s61, 81920
  buffer_load_dwordx4 v116, s[24:27], s62 offen lds
  s_add_u32 m0, s60, 38912
  s_add_u32 s62, s61, 98304
  buffer_load_dwordx4 v116, s[24:27], s62 offen lds
  s_add_u32 m0, s60, 39936
  s_add_u32 s62, s61, 114688
  buffer_load_dwordx4 v116, s[24:27], s62 offen lds
  s_cmp_eq_u32 s3, 1
  s_cbranch_scc1 L_lv_50
  s_cmp_eq_u32 s3, 2
  s_cbranch_scc1 L_lv_51
  s_cmp_eq_u32 s3, 3
  s_cbranch_scc1 L_lv_52
L_lv_49:
  ds_read_b64_tr_b16 a[192:193], v122 offset:0
  ds_read_b64_tr_b16 a[194:195], v122 offset:1024
  ds_read_b64_tr_b16 a[196:197], v122 offset:4096
  ds_read_b64_tr_b16 a[198:199], v122 offset:5120
  ds_read_b64_tr_b16 a[200:201], v123 offset:0
  ds_read_b64_tr_b16 a[202:203], v123 offset:1024
  ds_read_b64_tr_b16 a[204:205], v123 offset:4096
  ds_read_b64_tr_b16 a[206:207], v123 offset:5120
  ds_read_b64_tr_b16 a[208:209], v122 offset:16384
  ds_read_b64_tr_b16 a[210:211], v122 offset:17408
  ds_read_b64_tr_b16 a[212:213], v122 offset:20480
  ds_read_b64_tr_b16 a[214:215], v122 offset:21504
  ds_read_b64_tr_b16 a[216:217], v123 offset:16384
  ds_read_b64_tr_b16 a[218:219], v123 offset:17408
  ds_read_b64_tr_b16 a[220:221], v123 offset:20480
  ds_read_b64_tr_b16 a[222:223], v123 offset:21504
  s_branch L_lw_48
L_lv_50:
  ds_read_b64_tr_b16 a[160:161], v122 offset:0
  ds_read_b64_tr_b16 a[162:163], v122 offset:1024
  ds_read_b64_tr_b16 a[164:165], v122 offset:4096
  ds_read_b64_tr_b16 a[166:167], v122 offset:5120
  ds_read_b64_tr_b16 a[168:169], v123 offset:0
  ds_read_b64_tr_b16 a[170:171], v123 offset:1024
  ds_read_b64_tr_b16 a[172:173], v123 offset:4096
  ds_read_b64_tr_b16 a[174:175], v123 offset:5120
  ds_read_b64_tr_b16 a[176:177], v122 offset:16384
  ds_read_b64_tr_b16 a[178:179], v122 offset:17408
  ds_read_b64_tr_b16 a[180:181], v122 offset:20480
  ds_read_b64_tr_b16 a[182:183], v122 offset:21504
  ds_read_b64_tr_b16 a[184:185], v123 offset:16384
  ds_read_b64_tr_b16 a[186:187], v123 offset:17408
  ds_read_b64_tr_b16 a[188:189], v123 offset:20480
  ds_read_b64_tr_b16 a[190:191], v123 offset:21504
  s_branch L_lw_48
L_lv_51:
  ds_read_b64_tr_b16 a[128:129], v122 offset:0
  ds_read_b64_tr_b16 a[130:131], v122 offset:1024
  ds_read_b64_tr_b16 a[132:133], v122 offset:4096
  ds_read_b64_tr_b16 a[134:135], v122 offset:5120
  ds_read_b64_tr_b16 a[136:137], v123 offset:0
  ds_read_b64_tr_b16 a[138:139], v123 offset:1024
  ds_read_b64_tr_b16 a[140:141], v123 offset:4096
  ds_read_b64_tr_b16 a[142:143], v123 offset:5120
  ds_read_b64_tr_b16 a[144:145], v122 offset:16384
  ds_read_b64_tr_b16 a[146:147], v122 offset:17408
  ds_read_b64_tr_b16 a[148:149], v122 offset:20480
  ds_read_b64_tr_b16 a[150:151], v122 offset:21504
  ds_read_b64_tr_b16 a[152:153], v123 offset:16384
  ds_read_b64_tr_b16 a[154:155], v123 offset:17408
  ds_read_b64_tr_b16 a[156:157], v123 offset:20480
  ds_read_b64_tr_b16 a[158:159], v123 offset:21504
  s_branch L_lw_48
L_lv_52:
  ds_read_b64_tr_b16 a[224:225], v122 offset:0
  ds_read_b64_tr_b16 a[226:227], v122 offset:1024
  ds_read_b64_tr_b16 a[228:229], v122 offset:4096
  ds_read_b64_tr_b16 a[230:231], v122 offset:5120
  ds_read_b64_tr_b16 a[232:233], v123 offset:0
  ds_read_b64_tr_b16 a[234:235], v123 offset:1024
  ds_read_b64_tr_b16 a[236:237], v123 offset:4096
  ds_read_b64_tr_b16 a[238:239], v123 offset:5120
  ds_read_b64_tr_b16 a[240:241], v122 offset:16384
  ds_read_b64_tr_b16 a[242:243], v122 offset:17408
  ds_read_b64_tr_b16 a[244:245], v122 offset:20480
  ds_read_b64_tr_b16 a[246:247], v122 offset:21504
  ds_read_b64_tr_b16 a[248:249], v123 offset:16384
  ds_read_b64_tr_b16 a[250:251], v123 offset:17408
  ds_read_b64_tr_b16 a[252:253], v123 offset:20480
  ds_read_b64_tr_b16 a[254:255], v123 offset:21504
L_lw_48:
  s_waitcnt lgkmcnt(0)
  s_waitcnt vmcnt(16)
  s_barrier
  s_add_u32 s61, s63, 2097152
  s_add_u32 m0, s60, 65536
  s_add_u32 s62, s61, 0
  buffer_load_dwordx4 v116, s[24:27], s62 offen lds
  s_add_u32 m0, s60, 66560
  s_add_u32 s62, s61, 16384
  buffer_load_dwordx4 v116, s[24:27], s62 offen lds
  s_add_u32 m0, s60, 67584
  s_add_u32 s62, s61, 32768
  buffer_load_dwordx4 v116, s[24:27], s62 offen lds
  s_add_u32 m0, s60, 68608
  s_add_u32 s62, s61, 49152
  buffer_load_dwordx4 v116, s[24:27], s62 offen lds
  s_add_u32 m0, s60, 69632
  s_add_u32 s62, s61, 65536
  buffer_load_dwordx4 v116, s[24:27], s62 offen lds
  s_add_u32 m0, s60, 70656
  s_add_u32 s62, s61, 81920
  buffer_load_dwordx4 v116, s[24:27], s62 offen lds
  s_add_u32 m0, s60, 71680
  s_add_u32 s62, s61, 98304
  buffer_load_dwordx4 v116, s[24:27], s62 offen lds
  s_add_u32 m0, s60, 72704
  s_add_u32 s62, s61, 114688
  buffer_load_dwordx4 v116, s[24:27], s62 offen lds
  s_cmp_eq_u32 s3, 1
  s_cbranch_scc1 L_lv_55
  s_cmp_eq_u32 s3, 2
  s_cbranch_scc1 L_lv_56
  s_cmp_eq_u32 s3, 3
  s_cbranch_scc1 L_lv_57
L_lv_54:
  ds_read_b64_tr_b16 a[224:225], v122 offset:32768
  ds_read_b64_tr_b16 a[226:227], v122 offset:33792
  ds_read_b64_tr_b16 a[228:229], v122 offset:36864
  ds_read_b64_tr_b16 a[230:231], v122 offset:37888
  ds_read_b64_tr_b16 a[232:233], v123 offset:32768
  ds_read_b64_tr_b16 a[234:235], v123 offset:33792
  ds_read_b64_tr_b16 a[236:237], v123 offset:36864
  ds_read_b64_tr_b16 a[238:239], v123 offset:37888
  ds_read_b64_tr_b16 a[240:241], v122 offset:49152
  ds_read_b64_tr_b16 a[242:243], v122 offset:50176
  ds_read_b64_tr_b16 a[244:245], v122 offset:53248
  ds_read_b64_tr_b16 a[246:247], v122 offset:54272
  ds_read_b64_tr_b16 a[248:249], v123 offset:49152
  ds_read_b64_tr_b16 a[250:251], v123 offset:50176
  ds_read_b64_tr_b16 a[252:253], v123 offset:53248
  ds_read_b64_tr_b16 a[254:255], v123 offset:54272
  s_branch L_lw_53
L_lv_55:
  ds_read_b64_tr_b16 a[192:193], v122 offset:32768
  ds_read_b64_tr_b16 a[194:195], v122 offset:33792
  ds_read_b64_tr_b16 a[196:197], v122 offset:36864
  ds_read_b64_tr_b16 a[198:199], v122 offset:37888
  ds_read_b64_tr_b16 a[200:201], v123 offset:32768
  ds_read_b64_tr_b16 a[202:203], v123 offset:33792
  ds_read_b64_tr_b16 a[204:205], v123 offset:36864
  ds_read_b64_tr_b16 a[206:207], v123 offset:37888
  ds_read_b64_tr_b16 a[208:209], v122 offset:49152
  ds_read_b64_tr_b16 a[210:211], v122 offset:50176
  ds_read_b64_tr_b16 a[212:213], v122 offset:53248
  ds_read_b64_tr_b16 a[214:215], v122 offset:54272
  ds_read_b64_tr_b16 a[216:217], v123 offset:49152
  ds_read_b64_tr_b16 a[218:219], v123 offset:50176
  ds_read_b64_tr_b16 a[220:221], v123 offset:53248
  ds_read_b64_tr_b16 a[222:223], v123 offset:54272
  s_branch L_lw_53
L_lv_56:
  ds_read_b64_tr_b16 a[160:161], v122 offset:32768
  ds_read_b64_tr_b16 a[162:163], v122 offset:33792
  ds_read_b64_tr_b16 a[164:165], v122 offset:36864
  ds_read_b64_tr_b16 a[166:167], v122 offset:37888
  ds_read_b64_tr_b16 a[168:169], v123 offset:32768
  ds_read_b64_tr_b16 a[170:171], v123 offset:33792
  ds_read_b64_tr_b16 a[172:173], v123 offset:36864
  ds_read_b64_tr_b16 a[174:175], v123 offset:37888
  ds_read_b64_tr_b16 a[176:177], v122 offset:49152
  ds_read_b64_tr_b16 a[178:179], v122 offset:50176
  ds_read_b64_tr_b16 a[180:181], v122 offset:53248
  ds_read_b64_tr_b16 a[182:183], v122 offset:54272
  ds_read_b64_tr_b16 a[184:185], v123 offset:49152
  ds_read_b64_tr_b16 a[186:187], v123 offset:50176
  ds_read_b64_tr_b16 a[188:189], v123 offset:53248
  ds_read_b64_tr_b16 a[190:191], v123 offset:54272
  s_branch L_lw_53
L_lv_57:
  ds_read_b64_tr_b16 a[128:129], v122 offset:32768
  ds_read_b64_tr_b16 a[130:131], v122 offset:33792
  ds_read_b64_tr_b16 a[132:133], v122 offset:36864
  ds_read_b64_tr_b16 a[134:135], v122 offset:37888
  ds_read_b64_tr_b16 a[136:137], v123 offset:32768
  ds_read_b64_tr_b16 a[138:139], v123 offset:33792
  ds_read_b64_tr_b16 a[140:141], v123 offset:36864
  ds_read_b64_tr_b16 a[142:143], v123 offset:37888
  ds_read_b64_tr_b16 a[144:145], v122 offset:49152
  ds_read_b64_tr_b16 a[146:147], v122 offset:50176
  ds_read_b64_tr_b16 a[148:149], v122 offset:53248
  ds_read_b64_tr_b16 a[150:151], v122 offset:54272
  ds_read_b64_tr_b16 a[152:153], v123 offset:49152
  ds_read_b64_tr_b16 a[154:155], v123 offset:50176
  ds_read_b64_tr_b16 a[156:157], v123 offset:53248
  ds_read_b64_tr_b16 a[158:159], v123 offset:54272
L_lw_53:
  s_waitcnt lgkmcnt(0)
  s_waitcnt vmcnt(16)
  s_barrier
  s_add_u32 s61, s63, 3145728
  s_add_u32 m0, s60, 98304
  s_add_u32 s62, s61, 0
  buffer_load_dwordx4 v116, s[24:27], s62 offen lds
  s_add_u32 m0, s60, 99328
  s_add_u32 s62, s61, 16384
  buffer_load_dwordx4 v116, s[24:27], s62 offen lds
  s_add_u32 m0, s60, 100352
  s_add_u32 s62, s61, 32768
  buffer_load_dwordx4 v116, s[24:27], s62 offen lds
  s_add_u32 m0, s60, 101376
  s_add_u32 s62, s61, 49152
  buffer_load_dwordx4 v116, s[24:27], s62 offen lds
  s_add_u32 m0, s60, 102400
  s_add_u32 s62, s61, 65536
  buffer_load_dwordx4 v116, s[24:27], s62 offen lds
  s_add_u32 m0, s60, 103424
  s_add_u32 s62, s61, 81920
  buffer_load_dwordx4 v116, s[24:27], s62 offen lds
  s_add_u32 m0, s60, 104448
  s_add_u32 s62, s61, 98304
  buffer_load_dwordx4 v116, s[24:27], s62 offen lds
  s_add_u32 m0, s60, 105472
  s_add_u32 s62, s61, 114688
  buffer_load_dwordx4 v116, s[24:27], s62 offen lds
  s_cmp_eq_u32 s3, 1
  s_cbranch_scc1 L_lv_60
  s_cmp_eq_u32 s3, 2
  s_cbranch_scc1 L_lv_61
  s_cmp_eq_u32 s3, 3
  s_cbranch_scc1 L_lv_62
L_lv_59:
  ds_read_b64_tr_b16 v[128:129], v120 offset:0
  ds_read_b64_tr_b16 v[130:131], v120 offset:1024
  ds_read_b64_tr_b16 v[132:133], v120 offset:4096
  ds_read_b64_tr_b16 v[134:135], v120 offset:5120
  ds_read_b64_tr_b16 v[136:137], v121 offset:0
  ds_read_b64_tr_b16 v[138:139], v121 offset:1024
  ds_read_b64_tr_b16 v[140:141], v121 offset:4096
  ds_read_b64_tr_b16 v[142:143], v121 offset:5120
  ds_read_b64_tr_b16 v[144:145], v120 offset:16384
  ds_read_b64_tr_b16 v[146:147], v120 offset:17408
  ds_read_b64_tr_b16 v[148:149], v120 offset:20480
  ds_read_b64_tr_b16 v[150:151], v120 offset:21504
  ds_read_b64_tr_b16 v[152:153], v121 offset:16384
  ds_read_b64_tr_b16 v[154:155], v121 offset:17408
  ds_read_b64_tr_b16 v[156:157], v121 offset:20480
  ds_read_b64_tr_b16 v[158:159], v121 offset:21504
  s_branch L_lw_58
L_lv_60:
  ds_read_b64_tr_b16 v[224:225], v120 offset:0
  ds_read_b64_tr_b16 v[226:227], v120 offset:1024
  ds_read_b64_tr_b16 v[228:229], v120 offset:4096
  ds_read_b64_tr_b16 v[230:231], v120 offset:5120
  ds_read_b64_tr_b16 v[232:233], v121 offset:0
  ds_read_b64_tr_b16 v[234:235], v121 offset:1024
  ds_read_b64_tr_b16 v[236:237], v121 offset:4096
  ds_read_b64_tr_b16 v[238:239], v121 offset:5120
  ds_read_b64_tr_b16 v[240:241], v120 offset:16384
  ds_read_b64_tr_b16 v[242:243], v120 offset:17408
  ds_read_b64_tr_b16 v[244:245], v120 offset:20480
  ds_read_b64_tr_b16 v[246:247], v120 offset:21504
  ds_read_b64_tr_b16 v[248:249], v121 offset:16384
  ds_read_b64_tr_b16 v[250:251], v121 offset:17408
  ds_read_b64_tr_b16 v[252:253], v121 offset:20480
  ds_read_b64_tr_b16 v[254:255], v121 offset:21504
  s_branch L_lw_58
L_lv_61:
  ds_read_b64_tr_b16 v[192:193], v120 offset:0
  ds_read_b64_tr_b16 v[194:195], v120 offset:1024
  ds_read_b64_tr_b16 v[196:197], v120 offset:4096
  ds_read_b64_tr_b16 v[198:199], v120 offset:5120
  ds_read_b64_tr_b16 v[200:201], v121 offset:0
  ds_read_b64_tr_b16 v[202:203], v121 offset:1024
  ds_read_b64_tr_b16 v[204:205], v121 offset:4096
  ds_read_b64_tr_b16 v[206:207], v121 offset:5120
  ds_read_b64_tr_b16 v[208:209], v120 offset:16384
  ds_read_b64_tr_b16 v[210:211], v120 offset:17408
  ds_read_b64_tr_b16 v[212:213], v120 offset:20480
  ds_read_b64_tr_b16 v[214:215], v120 offset:21504
  ds_read_b64_tr_b16 v[216:217], v121 offset:16384
  ds_read_b64_tr_b16 v[218:219], v121 offset:17408
  ds_read_b64_tr_b16 v[220:221], v121 offset:20480
  ds_read_b64_tr_b16 v[222:223], v121 offset:21504
  s_branch L_lw_58
L_lv_62:
  ds_read_b64_tr_b16 v[160:161], v120 offset:0
  ds_read_b64_tr_b16 v[162:163], v120 offset:1024
  ds_read_b64_tr_b16 v[164:165], v120 offset:4096
  ds_read_b64_tr_b16 v[166:167], v120 offset:5120
  ds_read_b64_tr_b16 v[168:169], v121 offset:0
  ds_read_b64_tr_b16 v[170:171], v121 offset:1024
  ds_read_b64_tr_b16 v[172:173], v121 offset:4096
  ds_read_b64_tr_b16 v[174:175], v121 offset:5120
  ds_read_b64_tr_b16 v[176:177], v120 offset:16384
  ds_read_b64_tr_b16 v[178:179], v120 offset:17408
  ds_read_b64_tr_b16 v[180:181], v120 offset:20480
  ds_read_b64_tr_b16 v[182:183], v120 offset:21504
  ds_read_b64_tr_b16 v[184:185], v121 offset:16384
  ds_read_b64_tr_b16 v[186:187], v121 offset:17408
  ds_read_b64_tr_b16 v[188:189], v121 offset:20480
  ds_read_b64_tr_b16 v[190:191], v121 offset:21504
L_lw_58:
  s_waitcnt lgkmcnt(0)
  s_waitcnt vmcnt(16)
  s_barrier
  s_lshl_b32 s61, s5, 17
  s_lshl_b32 s62, s3, 15
  s_add_u32 s61, s61, s62
  s_add_u32 s61, s61, 0
  s_add_u32 m0, s60, 0
  s_add_u32 s62, s61, 0
  buffer_load_dwordx4 v118, s[28:31], s62 offen lds
  s_add_u32 m0, s60, 1024
  s_add_u32 s62, s61, 4096
  buffer_load_dwordx4 v118, s[28:31], s62 offen lds
  s_add_u32 m0, s60, 2048
  s_add_u32 s62, s61, 8192
  buffer_load_dwordx4 v119, s[28:31], s62 offen lds
  s_add_u32 m0, s60, 3072
  s_add_u32 s62, s61, 12288
  buffer_load_dwordx4 v119, s[28:31], s62 offen lds
  s_add_u32 m0, s60, 4096
  s_add_u32 s62, s61, 16384
  buffer_load_dwordx4 v118, s[28:31], s62 offen lds
  s_add_u32 m0, s60, 5120
  s_add_u32 s62, s61, 20480
  buffer_load_dwordx4 v118, s[28:31], s62 offen lds
  s_add_u32 m0, s60, 6144
  s_add_u32 s62, s61, 24576
  buffer_load_dwordx4 v119, s[28:31], s62 offen lds
  s_add_u32 m0, s60, 7168
  s_add_u32 s62, s61, 28672
  buffer_load_dwordx4 v119, s[28:31], s62 offen lds
  s_cmp_eq_u32 s3, 1
  s_cbranch_scc1 L_lv_65
  s_cmp_eq_u32 s3, 2
  s_cbranch_scc1 L_lv_66
  s_cmp_eq_u32 s3, 3
  s_cbranch_scc1 L_lv_67
L_lv_64:
  ds_read_b64_tr_b16 v[160:161], v120 offset:32768
  ds_read_b64_tr_b16 v[162:163], v120 offset:33792
  ds_read_b64_tr_b16 v[164:165], v120 offset:36864
  ds_read_b64_tr_b16 v[166:167], v120 offset:37888
  ds_read_b64_tr_b16 v[168:169], v121 offset:32768
  ds_read_b64_tr_b16 v[170:171], v121 offset:33792
  ds_read_b64_tr_b16 v[172:173], v121 offset:36864
  ds_read_b64_tr_b16 v[174:175], v121 offset:37888
  ds_read_b64_tr_b16 v[176:177], v120 offset:49152
  ds_read_b64_tr_b16 v[178:179], v120 offset:50176
  ds_read_b64_tr_b16 v[180:181], v120 offset:53248
  ds_read_b64_tr_b16 v[182:183], v120 offset:54272
  ds_read_b64_tr_b16 v[184:185], v121 offset:49152
  ds_read_b64_tr_b16 v[186:187], v121 offset:50176
  ds_read_b64_tr_b16 v[188:189], v121 offset:53248
  ds_read_b64_tr_b16 v[190:191], v121 offset:54272
  s_branch L_lw_63
L_lv_65:
  ds_read_b64_tr_b16 v[128:129], v120 offset:32768
  ds_read_b64_tr_b16 v[130:131], v120 offset:33792
  ds_read_b64_tr_b16 v[132:133], v120 offset:36864
  ds_read_b64_tr_b16 v[134:135], v120 offset:37888
  ds_read_b64_tr_b16 v[136:137], v121 offset:32768
  ds_read_b64_tr_b16 v[138:139], v121 offset:33792
  ds_read_b64_tr_b16 v[140:141], v121 offset:36864
  ds_read_b64_tr_b16 v[142:143], v121 offset:37888
  ds_read_b64_tr_b16 v[144:145], v120 offset:49152
  ds_read_b64_tr_b16 v[146:147], v120 offset:50176
  ds_read_b64_tr_b16 v[148:149], v120 offset:53248
  ds_read_b64_tr_b16 v[150:151], v120 offset:54272
  ds_read_b64_tr_b16 v[152:153], v121 offset:49152
  ds_read_b64_tr_b16 v[154:155], v121 offset:50176
  ds_read_b64_tr_b16 v[156:157], v121 offset:53248
  ds_read_b64_tr_b16 v[158:159], v121 offset:54272
  s_branch L_lw_63
L_lv_66:
  ds_read_b64_tr_b16 v[224:225], v120 offset:32768
  ds_read_b64_tr_b16 v[226:227], v120 offset:33792
  ds_read_b64_tr_b16 v[228:229], v120 offset:36864
  ds_read_b64_tr_b16 v[230:231], v120 offset:37888
  ds_read_b64_tr_b16 v[232:233], v121 offset:32768
  ds_read_b64_tr_b16 v[234:235], v121 offset:33792
  ds_read_b64_tr_b16 v[236:237], v121 offset:36864
  ds_read_b64_tr_b16 v[238:239], v121 offset:37888
  ds_read_b64_tr_b16 v[240:241], v120 offset:49152
  ds_read_b64_tr_b16 v[242:243], v120 offset:50176
  ds_read_b64_tr_b16 v[244:245], v120 offset:53248
  ds_read_b64_tr_b16 v[246:247], v120 offset:54272
  ds_read_b64_tr_b16 v[248:249], v121 offset:49152
  ds_read_b64_tr_b16 v[250:251], v121 offset:50176
  ds_read_b64_tr_b16 v[252:253], v121 offset:53248
  ds_read_b64_tr_b16 v[254:255], v121 offset:54272
  s_branch L_lw_63
L_lv_67:
  ds_read_b64_tr_b16 v[192:193], v120 offset:32768
  ds_read_b64_tr_b16 v[194:195], v120 offset:33792
  ds_read_b64_tr_b16 v[196:197], v120 offset:36864
  ds_read_b64_tr_b16 v[198:199], v120 offset:37888
  ds_read_b64_tr_b16 v[200:201], v121 offset:32768
  ds_read_b64_tr_b16 v[202:203], v121 offset:33792
  ds_read_b64_tr_b16 v[204:205], v121 offset:36864
  ds_read_b64_tr_b16 v[206:207], v121 offset:37888
  ds_read_b64_tr_b16 v[208:209], v120 offset:49152
  ds_read_b64_tr_b16 v[210:211], v120 offset:50176
  ds_read_b64_tr_b16 v[212:213], v120 offset:53248
  ds_read_b64_tr_b16 v[214:215], v120 offset:54272
  ds_read_b64_tr_b16 v[216:217], v121 offset:49152
  ds_read_b64_tr_b16 v[218:219], v121 offset:50176
  ds_read_b64_tr_b16 v[220:221], v121 offset:53248
  ds_read_b64_tr_b16 v[222:223], v121 offset:54272
L_lw_63:
  s_waitcnt lgkmcnt(0)
  s_waitcnt vmcnt(16)
  s_barrier
  s_lshl_b32 s61, s5, 17
  s_lshl_b32 s62, s3, 15
  s_add_u32 s61, s61, s62
  s_add_u32 s61, s61, 256
  s_add_u32 m0, s60, 32768
  s_add_u32 s62, s61, 0
  buffer_load_dwordx4 v118, s[28:31], s62 offen lds
  s_add_u32 m0, s60, 33792
  s_add_u32 s62, s61, 4096
  buffer_load_dwordx4 v118, s[28:31], s62 offen lds
  s_add_u32 m0, s60, 34816
  s_add_u32 s62, s61, 8192
  buffer_load_dwordx4 v119, s[28:31], s62 offen lds
  s_add_u32 m0, s60, 35840
  s_add_u32 s62, s61, 12288
  buffer_load_dwordx4 v119, s[28:31], s62 offen lds
  s_add_u32 m0, s60, 36864
  s_add_u32 s62, s61, 16384
  buffer_load_dwordx4 v118, s[28:31], s62 offen lds
  s_add_u32 m0, s60, 37888
  s_add_u32 s62, s61, 20480
  buffer_load_dwordx4 v118, s[28:31], s62 offen lds
  s_add_u32 m0, s60, 38912
  s_add_u32 s62, s61, 24576
  buffer_load_dwordx4 v119, s[28:31], s62 offen lds
  s_add_u32 m0, s60, 39936
  s_add_u32 s62, s61, 28672
  buffer_load_dwordx4 v119, s[28:31], s62 offen lds
  s_cmp_eq_u32 s3, 1
  s_cbranch_scc1 L_lv_70
  s_cmp_eq_u32 s3, 2
  s_cbranch_scc1 L_lv_71
  s_cmp_eq_u32 s3, 3
  s_cbranch_scc1 L_lv_72
L_lv_69:
  ds_read_b64_tr_b16 v[192:193], v122 offset:0
  ds_read_b64_tr_b16 v[194:195], v122 offset:1024
  ds_read_b64_tr_b16 v[196:197], v122 offset:4096
  ds_read_b64_tr_b16 v[198:199], v122 offset:5120
  ds_read_b64_tr_b16 v[200:201], v123 offset:0
  ds_read_b64_tr_b16 v[202:203], v123 offset:1024
  ds_read_b64_tr_b16 v[204:205], v123 offset:4096
  ds_read_b64_tr_b16 v[206:207], v123 offset:5120
  ds_read_b64_tr_b16 v[208:209], v122 offset:16384
  ds_read_b64_tr_b16 v[210:211], v122 offset:17408
  ds_read_b64_tr_b16 v[212:213], v122 offset:20480
  ds_read_b64_tr_b16 v[214:215], v122 offset:21504
  ds_read_b64_tr_b16 v[216:217], v123 offset:16384
  ds_read_b64_tr_b16 v[218:219], v123 offset:17408
  ds_read_b64_tr_b16 v[220:221], v123 offset:20480
  ds_read_b64_tr_b16 v[222:223], v123 offset:21504
  s_branch L_lw_68
L_lv_70:
  ds_read_b64_tr_b16 v[160:161], v122 offset:0
  ds_read_b64_tr_b16 v[162:163], v122 offset:1024
  ds_read_b64_tr_b16 v[164:165], v122 offset:4096
  ds_read_b64_tr_b16 v[166:167], v122 offset:5120
  ds_read_b64_tr_b16 v[168:169], v123 offset:0
  ds_read_b64_tr_b16 v[170:171], v123 offset:1024
  ds_read_b64_tr_b16 v[172:173], v123 offset:4096
  ds_read_b64_tr_b16 v[174:175], v123 offset:5120
  ds_read_b64_tr_b16 v[176:177], v122 offset:16384
  ds_read_b64_tr_b16 v[178:179], v122 offset:17408
  ds_read_b64_tr_b16 v[180:181], v122 offset:20480
  ds_read_b64_tr_b16 v[182:183], v122 offset:21504
  ds_read_b64_tr_b16 v[184:185], v123 offset:16384
  ds_read_b64_tr_b16 v[186:187], v123 offset:17408
  ds_read_b64_tr_b16 v[188:189], v123 offset:20480
  ds_read_b64_tr_b16 v[190:191], v123 offset:21504
  s_branch L_lw_68
L_lv_71:
  ds_read_b64_tr_b16 v[128:129], v122 offset:0
  ds_read_b64_tr_b16 v[130:131], v122 offset:1024
  ds_read_b64_tr_b16 v[132:133], v122 offset:4096
  ds_read_b64_tr_b16 v[134:135], v122 offset:5120
  ds_read_b64_tr_b16 v[136:137], v123 offset:0
  ds_read_b64_tr_b16 v[138:139], v123 offset:1024
  ds_read_b64_tr_b16 v[140:141], v123 offset:4096
  ds_read_b64_tr_b16 v[142:143], v123 offset:5120
  ds_read_b64_tr_b16 v[144:145], v122 offset:16384
  ds_read_b64_tr_b16 v[146:147], v122 offset:17408
  ds_read_b64_tr_b16 v[148:149], v122 offset:20480
  ds_read_b64_tr_b16 v[150:151], v122 offset:21504
  ds_read_b64_tr_b16 v[152:153], v123 offset:16384
  ds_read_b64_tr_b16 v[154:155], v123 offset:17408
  ds_read_b64_tr_b16 v[156:157], v123 offset:20480
  ds_read_b64_tr_b16 v[158:159], v123 offset:21504
  s_branch L_lw_68
L_lv_72:
  ds_read_b64_tr_b16 v[224:225], v122 offset:0
  ds_read_b64_tr_b16 v[226:227], v122 offset:1024
  ds_read_b64_tr_b16 v[228:229], v122 offset:4096
  ds_read_b64_tr_b16 v[230:231], v122 offset:5120
  ds_read_b64_tr_b16 v[232:233], v123 offset:0
  ds_read_b64_tr_b16 v[234:235], v123 offset:1024
  ds_read_b64_tr_b16 v[236:237], v123 offset:4096
  ds_read_b64_tr_b16 v[238:239], v123 offset:5120
  ds_read_b64_tr_b16 v[240:241], v122 offset:16384
  ds_read_b64_tr_b16 v[242:243], v122 offset:17408
  ds_read_b64_tr_b16 v[244:245], v122 offset:20480
  ds_read_b64_tr_b16 v[246:247], v122 offset:21504
  ds_read_b64_tr_b16 v[248:249], v123 offset:16384
  ds_read_b64_tr_b16 v[250:251], v123 offset:17408
  ds_read_b64_tr_b16 v[252:253], v123 offset:20480
  ds_read_b64_tr_b16 v[254:255], v123 offset:21504
L_lw_68:
  s_waitcnt lgkmcnt(0)
  s_waitcnt vmcnt(16)
  s_barrier
  s_lshl_b32 s61, s5, 17
  s_lshl_b32 s62, s3, 15
  s_add_u32 s61, s61, s62
  s_add_u32 s61, s61, 512
  s_add_u32 m0, s60, 65536
  s_add_u32 s62, s61, 0
  buffer_load_dwordx4 v118, s[28:31], s62 offen lds
  s_add_u32 m0, s60, 66560
  s_add_u32 s62, s61, 4096
  buffer_load_dwordx4 v118, s[28:31], s62 offen lds
  s_add_u32 m0, s60, 67584
  s_add_u32 s62, s61, 8192
  buffer_load_dwordx4 v119, s[28:31], s62 offen lds
  s_add_u32 m0, s60, 68608
  s_add_u32 s62, s61, 12288
  buffer_load_dwordx4 v119, s[28:31], s62 offen lds
  s_add_u32 m0, s60, 69632
  s_add_u32 s62, s61, 16384
  buffer_load_dwordx4 v118, s[28:31], s62 offen lds
  s_add_u32 m0, s60, 70656
  s_add_u32 s62, s61, 20480
  buffer_load_dwordx4 v118, s[28:31], s62 offen lds
  s_add_u32 m0, s60, 71680
  s_add_u32 s62, s61, 24576
  buffer_load_dwordx4 v119, s[28:31], s62 offen lds
  s_add_u32 m0, s60, 72704
  s_add_u32 s62, s61, 28672
  buffer_load_dwordx4 v119, s[28:31], s62 offen lds
  s_cmp_eq_u32 s3, 1
  s_cbranch_scc1 L_lv_75
  s_cmp_eq_u32 s3, 2
  s_cbranch_scc1 L_lv_76
  s_cmp_eq_u32 s3, 3
  s_cbranch_scc1 L_lv_77
L_lv_74:
  ds_read_b64_tr_b16 v[224:225], v122 offset:32768
  ds_read_b64_tr_b16 v[226:227], v122 offset:33792
  ds_read_b64_tr_b16 v[228:229], v122 offset:36864
  ds_read_b64_tr_b16 v[230:231], v122 offset:37888
  ds_read_b64_tr_b16 v[232:233], v123 offset:32768
  ds_read_b64_tr_b16 v[234:235], v123 offset:33792
  ds_read_b64_tr_b16 v[236:237], v123 offset:36864
  ds_read_b64_tr_b16 v[238:239], v123 offset:37888
  ds_read_b64_tr_b16 v[240:241], v122 offset:49152
  ds_read_b64_tr_b16 v[242:243], v122 offset:50176
  ds_read_b64_tr_b16 v[244:245], v122 offset:53248
  ds_read_b64_tr_b16 v[246:247], v122 offset:54272
  ds_read_b64_tr_b16 v[248:249], v123 offset:49152
  ds_read_b64_tr_b16 v[250:251], v123 offset:50176
  ds_read_b64_tr_b16 v[252:253], v123 offset:53248
  ds_read_b64_tr_b16 v[254:255], v123 offset:54272
  s_branch L_lw_73
L_lv_75:
  ds_read_b64_tr_b16 v[192:193], v122 offset:32768
  ds_read_b64_tr_b16 v[194:195], v122 offset:33792
  ds_read_b64_tr_b16 v[196:197], v122 offset:36864
  ds_read_b64_tr_b16 v[198:199], v122 offset:37888
  ds_read_b64_tr_b16 v[200:201], v123 offset:32768
  ds_read_b64_tr_b16 v[202:203], v123 offset:33792
  ds_read_b64_tr_b16 v[204:205], v123 offset:36864
  ds_read_b64_tr_b16 v[206:207], v123 offset:37888
  ds_read_b64_tr_b16 v[208:209], v122 offset:49152
  ds_read_b64_tr_b16 v[210:211], v122 offset:50176
  ds_read_b64_tr_b16 v[212:213], v122 offset:53248
  ds_read_b64_tr_b16 v[214:215], v122 offset:54272
  ds_read_b64_tr_b16 v[216:217], v123 offset:49152
  ds_read_b64_tr_b16 v[218:219], v123 offset:50176
  ds_read_b64_tr_b16 v[220:221], v123 offset:53248
  ds_read_b64_tr_b16 v[222:223], v123 offset:54272
  s_branch L_lw_73
L_lv_76:
  ds_read_b64_tr_b16 v[160:161], v122 offset:32768
  ds_read_b64_tr_b16 v[162:163], v122 offset:33792
  ds_read_b64_tr_b16 v[164:165], v122 offset:36864
  ds_read_b64_tr_b16 v[166:167], v122 offset:37888
  ds_read_b64_tr_b16 v[168:169], v123 offset:32768
  ds_read_b64_tr_b16 v[170:171], v123 offset:33792
  ds_read_b64_tr_b16 v[172:173], v123 offset:36864
  ds_read_b64_tr_b16 v[174:175], v123 offset:37888
  ds_read_b64_tr_b16 v[176:177], v122 offset:49152
  ds_read_b64_tr_b16 v[178:179], v122 offset:50176
  ds_read_b64_tr_b16 v[180:181], v122 offset:53248
  ds_read_b64_tr_b16 v[182:183], v122 offset:54272
  ds_read_b64_tr_b16 v[184:185], v123 offset:49152
  ds_read_b64_tr_b16 v[186:187], v123 offset:50176
  ds_read_b64_tr_b16 v[188:189], v123 offset:53248
  ds_read_b64_tr_b16 v[190:191], v123 offset:54272
  s_branch L_lw_73
L_lv_77:
  ds_read_b64_tr_b16 v[128:129], v122 offset:32768
  ds_read_b64_tr_b16 v[130:131], v122 offset:33792
  ds_read_b64_tr_b16 v[132:133], v122 offset:36864
  ds_read_b64_tr_b16 v[134:135], v122 offset:37888
  ds_read_b64_tr_b16 v[136:137], v123 offset:32768
  ds_read_b64_tr_b16 v[138:139], v123 offset:33792
  ds_read_b64_tr_b16 v[140:141], v123 offset:36864
  ds_read_b64_tr_b16 v[142:143], v123 offset:37888
  ds_read_b64_tr_b16 v[144:145], v122 offset:49152
  ds_read_b64_tr_b16 v[146:147], v122 offset:50176
  ds_read_b64_tr_b16 v[148:149], v122 offset:53248
  ds_read_b64_tr_b16 v[150:151], v122 offset:54272
  ds_read_b64_tr_b16 v[152:153], v123 offset:49152
  ds_read_b64_tr_b16 v[154:155], v123 offset:50176
  ds_read_b64_tr_b16 v[156:157], v123 offset:53248
  ds_read_b64_tr_b16 v[158:159], v123 offset:54272
L_lw_73:
  s_waitcnt lgkmcnt(0)
  s_waitcnt vmcnt(16)
  s_barrier
  s_lshl_b32 s61, s5, 17
  s_lshl_b32 s62, s3, 15
  s_add_u32 s61, s61, s62
  s_add_u32 s61, s61, 768
  s_add_u32 m0, s60, 98304
  s_add_u32 s62, s61, 0
  buffer_load_dwordx4 v118, s[28:31], s62 offen lds
  s_add_u32 m0, s60, 99328
  s_add_u32 s62, s61, 4096
  buffer_load_dwordx4 v118, s[28:31], s62 offen lds
  s_add_u32 m0, s60, 100352
  s_add_u32 s62, s61, 8192
  buffer_load_dwordx4 v119, s[28:31], s62 offen lds
  s_add_u32 m0, s60, 101376
  s_add_u32 s62, s61, 12288
  buffer_load_dwordx4 v119, s[28:31], s62 offen lds
  s_add_u32 m0, s60, 102400
  s_add_u32 s62, s61, 16384
  buffer_load_dwordx4 v118, s[28:31], s62 offen lds
  s_add_u32 m0, s60, 103424
  s_add_u32 s62, s61, 20480
  buffer_load_dwordx4 v118, s[28:31], s62 offen lds
  s_add_u32 m0, s60, 104448
  s_add_u32 s62, s61, 24576
  buffer_load_dwordx4 v119, s[28:31], s62 offen lds
  s_add_u32 m0, s60, 105472
  s_add_u32 s62, s61, 28672
  buffer_load_dwordx4 v119, s[28:31], s62 offen lds
  v_xor_b32 v126, 0, v124
  ds_read_b64_tr_b16 v[20:21], v126 offset:0
  ds_read_b64_tr_b16 v[22:23], v126 offset:1024
  v_xor_b32 v126, 32, v124
  ds_read_b64_tr_b16 v[24:25], v126 offset:0
  ds_read_b64_tr_b16 v[26:27], v126 offset:1024
  v_xor_b32 v126, 64, v124
  ds_read_b64_tr_b16 v[28:29], v126 offset:0
  ds_read_b64_tr_b16 v[30:31], v126 offset:1024
  v_xor_b32 v126, 96, v124
  ds_read_b64_tr_b16 v[32:33], v126 offset:0
  ds_read_b64_tr_b16 v[34:35], v126 offset:1024
  v_xor_b32 v126, 128, v124
  ds_read_b64_tr_b16 v[36:37], v126 offset:0
  ds_read_b64_tr_b16 v[38:39], v126 offset:1024
  v_xor_b32 v126, 160, v124
  ds_read_b64_tr_b16 v[40:41], v126 offset:0
  ds_read_b64_tr_b16 v[42:43], v126 offset:1024
  v_xor_b32 v126, 192, v124
  ds_read_b64_tr_b16 v[44:45], v126 offset:0
  ds_read_b64_tr_b16 v[46:47], v126 offset:1024
  v_xor_b32 v126, 224, v124
  ds_read_b64_tr_b16 v[48:49], v126 offset:0
  ds_read_b64_tr_b16 v[50:51], v126 offset:1024
  s_waitcnt lgkmcnt(0)
  ds_write_b128 v127, v[20:23] offset:0
  ds_write_b128 v127, v[24:27] offset:1024
  ds_write_b128 v127, v[28:31] offset:2048
  ds_write_b128 v127, v[32:35] offset:3072
  ds_write_b128 v127, v[36:39] offset:4096
  ds_write_b128 v127, v[40:43] offset:5120
  ds_write_b128 v127, v[44:47] offset:6144
  ds_write_b128 v127, v[48:51] offset:7168
  s_waitcnt lgkmcnt(0)
  v_add_u32 v124, 0x8000, v124
  v_add_u32 v127, 0x8000, v127
  s_waitcnt vmcnt(16)
  v_xor_b32 v126, 0, v124
  ds_read_b64_tr_b16 v[20:21], v126 offset:0
  ds_read_b64_tr_b16 v[22:23], v126 offset:1024
  v_xor_b32 v126, 32, v124
  ds_read_b64_tr_b16 v[24:25], v126 offset:0
  ds_read_b64_tr_b16 v[26:27], v126 offset:1024
  v_xor_b32 v126, 64, v124
  ds_read_b64_tr_b16 v[28:29], v126 offset:0
  ds_read_b64_tr_b16 v[30:31], v126 offset:1024
  v_xor_b32 v126, 96, v124
  ds_read_b64_tr_b16 v[32:33], v126 offset:0
  ds_read_b64_tr_b16 v[34:35], v126 offset:1024
  v_xor_b32 v126, 128, v124
  ds_read_b64_tr_b16 v[36:37], v126 offset:0
  ds_read_b64_tr_b16 v[38:39], v126 offset:1024
  v_xor_b32 v126, 160, v124
  ds_read_b64_tr_b16 v[40:41], v126 offset:0
  ds_read_b64_tr_b16 v[42:43], v126 offset:1024
  v_xor_b32 v126, 192, v124
  ds_read_b64_tr_b16 v[44:45], v126 offset:0
  ds_read_b64_tr_b16 v[46:47], v126 offset:1024
  v_xor_b32 v126, 224, v124
  ds_read_b64_tr_b16 v[48:49], v126 offset:0
  ds_read_b64_tr_b16 v[50:51], v126 offset:1024
  s_waitcnt lgkmcnt(0)
  ds_write_b128 v127, v[20:23] offset:0
  ds_write_b128 v127, v[24:27] offset:1024
  ds_write_b128 v127, v[28:31] offset:2048
  ds_write_b128 v127, v[32:35] offset:3072
  ds_write_b128 v127, v[36:39] offset:4096
  ds_write_b128 v127, v[40:43] offset:5120
  ds_write_b128 v127, v[44:47] offset:6144
  ds_write_b128 v127, v[48:51] offset:7168
  s_waitcnt lgkmcnt(0)
  v_add_u32 v124, 0x8000, v124
  v_add_u32 v127, 0x8000, v127
  s_waitcnt vmcnt(8)
  v_xor_b32 v126, 0, v124
  ds_read_b64_tr_b16 v[20:21], v126 offset:0
  ds_read_b64_tr_b16 v[22:23], v126 offset:1024
  v_xor_b32 v126, 32, v124
  ds_read_b64_tr_b16 v[24:25], v126 offset:0
  ds_read_b64_tr_b16 v[26:27], v126 offset:1024
  v_xor_b32 v126, 64, v124
  ds_read_b64_tr_b16 v[28:29], v126 offset:0
  ds_read_b64_tr_b16 v[30:31], v126 offset:1024
  v_xor_b32 v126, 96, v124
  ds_read_b64_tr_b16 v[32:33], v126 offset:0
  ds_read_b64_tr_b16 v[34:35], v126 offset:1024
  v_xor_b32 v126, 128, v124
  ds_read_b64_tr_b16 v[36:37], v126 offset:0
  ds_read_b64_tr_b16 v[38:39], v126 offset:1024
  v_xor_b32 v126, 160, v124
  ds_read_b64_tr_b16 v[40:41], v126 offset:0
  ds_read_b64_tr_b16 v[42:43], v126 offset:1024
  v_xor_b32 v126, 192, v124
  ds_read_b64_tr_b16 v[44:45], v126 offset:0
  ds_read_b64_tr_b16 v[46:47], v126 offset:1024
  v_xor_b32 v126, 224, v124
  ds_read_b64_tr_b16 v[48:49], v126 offset:0
  ds_read_b64_tr_b16 v[50:51], v126 offset:1024
  s_waitcnt lgkmcnt(0)
  ds_write_b128 v127, v[20:23] offset:0
  ds_write_b128 v127, v[24:27] offset:1024
  ds_write_b128 v127, v[28:31] offset:2048
  ds_write_b128 v127, v[32:35] offset:3072
  ds_write_b128 v127, v[36:39] offset:4096
  ds_write_b128 v127, v[40:43] offset:5120
  ds_write_b128 v127, v[44:47] offset:6144
  ds_write_b128 v127, v[48:51] offset:7168
  s_waitcnt lgkmcnt(0)
  v_add_u32 v124, 0x8000, v124
  v_add_u32 v127, 0x8000, v127
  s_waitcnt vmcnt(0)
  v_xor_b32 v126, 0, v124
  ds_read_b64_tr_b16 v[20:21], v126 offset:0
  ds_read_b64_tr_b16 v[22:23], v126 offset:1024
  v_xor_b32 v126, 32, v124
  ds_read_b64_tr_b16 v[24:25], v126 offset:0
  ds_read_b64_tr_b16 v[26:27], v126 offset:1024
  v_xor_b32 v126, 64, v124
  ds_read_b64_tr_b16 v[28:29], v126 offset:0
  ds_read_b64_tr_b16 v[30:31], v126 offset:1024
  v_xor_b32 v126, 96, v124
  ds_read_b64_tr_b16 v[32:33], v126 offset:0
  ds_read_b64_tr_b16 v[34:35], v126 offset:1024
  v_xor_b32 v126, 128, v124
  ds_read_b64_tr_b16 v[36:37], v126 offset:0
  ds_read_b64_tr_b16 v[38:39], v126 offset:1024
  v_xor_b32 v126, 160, v124
  ds_read_b64_tr_b16 v[40:41], v126 offset:0
  ds_read_b64_tr_b16 v[42:43], v126 offset:1024
  v_xor_b32 v126, 192, v124
  ds_read_b64_tr_b16 v[44:45], v126 offset:0
  ds_read_b64_tr_b16 v[46:47], v126 offset:1024
  v_xor_b32 v126, 224, v124
  ds_read_b64_tr_b16 v[48:49], v126 offset:0
  ds_read_b64_tr_b16 v[50:51], v126 offset:1024
  s_waitcnt lgkmcnt(0)
  ds_write_b128 v127, v[20:23] offset:0
  ds_write_b128 v127, v[24:27] offset:1024
  ds_write_b128 v127, v[28:31] offset:2048
  ds_write_b128 v127, v[32:35] offset:3072
  ds_write_b128 v127, v[36:39] offset:4096
  ds_write_b128 v127, v[40:43] offset:5120
  ds_write_b128 v127, v[44:47] offset:6144
  ds_write_b128 v127, v[48:51] offset:7168
  s_waitcnt lgkmcnt(0)
  v_add_u32 v124, 0x8000, v124
  v_add_u32 v127, 0x8000, v127
  s_mov_b32 s16, s80
  s_mov_b32 s17, s81
  s_mov_b32 s18, 0x2000
  s_mov_b32 s19, 0x20000
  v_and_b32 v16, 15, v0
  v_lshrrev_b32 v17, 1, v16
  v_lshlrev_b32 v17, 10, v17
  v_and_b32 v18, 1, v0
  v_lshl_or_b32 v17, v18, 6, v17
  v_lshrrev_b32 v19, 4, v0
  v_lshl_or_b32 v17, v19, 3, v17
  s_lshl_b32 s6, s3, 8
  buffer_load_dwordx2 v[20:21], v17, s[16:19], s6 offen offset:0
  buffer_load_dwordx2 v[22:23], v17, s[16:19], s6 offen offset:32
  buffer_load_dwordx2 v[24:25], v17, s[16:19], s6 offen offset:128
  buffer_load_dwordx2 v[26:27], v17, s[16:19], s6 offen offset:160
  v_mov_b32 v19, 0x4444
  v_mov_b32 v16, 0xeeee
  v_cmp_eq_u32 vcc, 0, v18
  s_nop 1
  v_cndmask_b32 v0, v16, v19, vcc
  s_mov_b32 s7, 0
  v_mbcnt_lo_u32_b32 v16, -1, 0
  v_and_b32 v16, 3, v16
  v_lshlrev_b32 v16, 6, v16
L_wd_78:
  buffer_load_dword v17, v16, s[12:15], 0 offen offset:16 sc1
  s_waitcnt vmcnt(0)
  v_cmp_ne_u32 vcc, 64, v17
  s_cbranch_vccz L_wdo_79
  s_add_u32 s7, s7, 1
  s_cmp_lt_u32 s7, 131072
  s_cbranch_scc1 L_wd_78
  s_mov_b32 s6, 10
  s_branch L_err
L_wdo_79:
  s_mov_b32 s32, 0
  s_mov_b32 s49, 1
  s_mov_b32 s33, 1
  s_mov_b32 s59, 1
  s_and_b32 s6, s32, 3
  s_lshl_b32 s6, s6, 19
  s_add_u32 s6, s6, s35
  s_sub_u32 s60, s6, s53
  s_add_u32 s61, s60, 4096
  s_mov_b32 s7, 0
L_kvs_80:
  buffer_load_dwordx4 v[52:55], v4, s[8:11], s60 offen offset:0 sc1
  buffer_load_dwordx4 v[68:71], v4, s[8:11], s60 offen offset:128 sc1
  buffer_load_dwordx4 v[56:59], v4, s[8:11], s60 offen offset:2048 sc1
  buffer_load_dwordx4 v[72:75], v4, s[8:11], s60 offen offset:2176 sc1
  buffer_load_dwordx4 v[60:63], v4, s[8:11], s61 offen offset:0 sc1
  buffer_load_dwordx4 v[76:79], v4, s[8:11], s61 offen offset:128 sc1
  buffer_load_dwordx4 v[64:67], v4, s[8:11], s61 offen offset:2048 sc1
  buffer_load_dwordx4 v[80:83], v4, s[8:11], s61 offen offset:2176 sc1
  buffer_load_dwordx4 v[108:111], v9, s[8:11], s60 offen offset:0 sc1
  buffer_load_dwordx4 v[112:115], v9, s[8:11], s60 offen offset:256 sc1
  s_waitcnt vmcnt(0)
  v_bitop3_b32 v16, v52, v56, s59 bitop3:0x7e
  v_bitop3_b32 v17, v60, v64, s59 bitop3:0x7e
  v_bitop3_b32 v18, v68, v72, s59 bitop3:0x7e
  v_bitop3_b32 v19, v76, v80, s59 bitop3:0x7e
  v_or3_b32 v16, v16, v17, v18
  v_bitop3_b32 v17, v108, v112, s59 bitop3:0x7e
  v_or3_b32 v16, v16, v17, v19
  v_and_b32 v16, 1, v16
  v_cmp_ne_u32 vcc, 0, v16
  s_cbranch_vccz L_rec_go
  s_add_u32 s7, s7, 1
  s_cmp_lt_u32 s7, 131072
  s_cbranch_scc1 L_kvs_80
  s_mov_b32 s6, 13
  s_branch L_err
L_rec_go:
  s_add_u32 s6, s32, 1
  s_and_b32 s6, s6, 3
  s_lshl_b32 s6, s6, 19
  s_add_u32 s50, s35, s6
  s_add_u32 s51, s50, 0x2000
  v_add_u32 v116, s48, v1
  v_add_u32 v117, s45, v1
  v_add_u32 v118, s46, v1
  v_add_u32 v119, s47, v1
  v_mov_b64 v[84:85], 0
  v_mov_b64 v[86:87], 0
  v_mov_b64 v[88:89], 0
  v_mov_b64 v[90:91], 0
  v_mov_b64 v[92:93], 0
  v_mov_b64 v[94:95], 0
  v_mov_b64 v[96:97], 0
  v_mov_b64 v[98:99], 0
  v_mov_b64 v[100:101], 0
  v_mov_b64 v[102:103], 0
  v_mov_b64 v[104:105], 0
  v_mov_b64 v[106:107], 0
  s_mov_b64 s[60:61], 0
  s_branch L_rec_step
L_rec_loop:
  buffer_load_dwordx4 v[20:23], v1, s[8:11], s44 offen sc1
  buffer_load_dwordx4 v[24:27], v1, s[8:11], s44 offen offset:1024 sc1
  s_mov_b32 s7, 0
  v_add_u32 v116, s48, v1
  v_add_u32 v117, s45, v1
  v_add_u32 v118, s46, v1
  v_add_u32 v119, s47, v1
  v_mov_b64 v[84:85], 0
  v_mov_b64 v[86:87], 0
  v_mov_b64 v[88:89], 0
  v_mov_b64 v[90:91], 0
  v_mov_b64 v[92:93], 0
  v_mov_b64 v[94:95], 0
  v_mov_b64 v[96:97], 0
  v_mov_b64 v[98:99], 0
  v_mov_b64 v[100:101], 0
  v_mov_b64 v[102:103], 0
  v_mov_b64 v[104:105], 0
  v_mov_b64 v[106:107], 0
  buffer_load_dwordx4 v[120:123], v1, s[8:11], s44 offen sc1
  buffer_load_dwordx4 v[124:127], v1, s[8:11], s44 offen offset:1024 sc1
  s_branch L_rec_gather1
L_rec_gather:
  buffer_load_dwordx4 v[120:123], v1, s[8:11], s44 offen sc1
  buffer_load_dwordx4 v[124:127], v1, s[8:11], s44 offen offset:1024 sc1
L_rec_gather1:
  s_waitcnt vmcnt(2)
  v_bitop3_b32 v16, v20, v22, s33 bitop3:0x7e
  v_bitop3_b32 v17, v24, v26, s33 bitop3:0x7e
  v_bitop3_b32 v16, v16, v17, 1 bitop3:0xa8
  v_cmp_ne_u32 vcc, 0, v16
  s_cbranch_vccz L_rec_got
  buffer_load_dwordx4 v[20:23], v1, s[8:11], s44 offen sc1
  buffer_load_dwordx4 v[24:27], v1, s[8:11], s44 offen offset:1024 sc1
  s_waitcnt vmcnt(2)
  v_bitop3_b32 v16, v120, v122, s33 bitop3:0x7e
  v_bitop3_b32 v17, v124, v126, s33 bitop3:0x7e
  v_bitop3_b32 v16, v16, v17, 1 bitop3:0xa8
  v_cmp_ne_u32 vcc, 0, v16
  s_cbranch_vccz L_rec_got1
  s_and_b32 s6, s7, 31
  s_cmp_lg_u32 s6, 31
  s_cbranch_scc1 L_tf_81
  buffer_wbl2 sc1
  s_waitcnt vmcnt(0)
  buffer_inv sc1
  s_waitcnt vmcnt(0)
L_tf_81:
  s_add_u32 s7, s7, 1
  s_cmp_lt_u32 s7, 131072
  s_cbranch_scc1 L_rec_gather
  s_mov_b32 s6, 12
  s_branch L_err
L_rec_got1:
  v_mov_b64 v[20:21], v[120:121]
  v_mov_b64 v[22:23], v[122:123]
  v_mov_b64 v[24:25], v[124:125]
  v_mov_b64 v[26:27], v[126:127]
L_rec_got:
  s_mov_b32 s63, s7
  s_xor_b32 s33, s33, 1
L_rec_step:
  ds_write_b128 v116, v[20:23]
  ds_write_b128 v116, v[24:27] offset:1024
  v_smfmac_f32_16x16x64_bf16 v[84:87], v[20:23], a[0:7], v0
  s_and_b32 s6, s32, 3
  v_smfmac_f32_16x16x64_bf16 v[88:91], v[20:23], a[8:15], v0
  s_lshl_b32 s6, s6, 17
  v_smfmac_f32_16x16x64_bf16 v[84:87], v[24:27], a[16:23], v0
  s_add_u32 s52, s36, s6
  v_smfmac_f32_16x16x64_bf16 v[88:91], v[24:27], a[24:31], v0
  s_cmp_lg_u64 s[60:61], 0
  s_waitcnt lgkmcnt(0)
  s_barrier
  ds_read_b128 v[28:31], v117 offset:0
  ds_read_b128 v[32:35], v117 offset:1024
  v_smfmac_f32_16x16x64_bf16 v[92:95], v[20:23], a[128:135], v0
  ds_read_b128 v[36:39], v118 offset:0
  ds_read_b128 v[40:43], v118 offset:1024
  v_smfmac_f32_16x16x64_bf16 v[96:99], v[20:23], a[136:143], v0
  ds_read_b128 v[44:47], v119 offset:0
  ds_read_b128 v[48:51], v119 offset:1024
  v_smfmac_f32_16x16x64_bf16 v[92:95], v[24:27], a[144:151], v0
  v_smfmac_f32_16x16x64_bf16 v[96:99], v[24:27], a[152:159], v0
  v_smfmac_f32_16x16x64_bf16 v[100:103], v[20:23], v[128:135], v0
  v_smfmac_f32_16x16x64_bf16 v[104:107], v[20:23], v[136:143], v0
  v_smfmac_f32_16x16x64_bf16 v[100:103], v[24:27], v[144:151], v0
  v_smfmac_f32_16x16x64_bf16 v[104:107], v[24:27], v[152:159], v0
  s_cbranch_scc1 L_rec_kvwait
L_rec_kvok:
  s_waitcnt lgkmcnt(5)
  v_smfmac_f32_16x16x64_bf16 v[84:87], v[28:31], a[32:39], v0
  v_smfmac_f32_16x16x64_bf16 v[88:91], v[28:31], a[40:47], v0
  s_mov_b32 m0, s53
  s_waitcnt lgkmcnt(4)
  v_smfmac_f32_16x16x64_bf16 v[84:87], v[32:35], a[48:55], v0
  v_smfmac_f32_16x16x64_bf16 v[88:91], v[32:35], a[56:63], v0
  buffer_load_dwordx4 v1, s[8:11], s50 offen sc1 lds
  s_waitcnt lgkmcnt(3)
  v_smfmac_f32_16x16x64_bf16 v[84:87], v[36:39], a[64:71], v0
  v_smfmac_f32_16x16x64_bf16 v[88:91], v[36:39], a[72:79], v0
  buffer_load_dwordx4 v1, s[8:11], s50 offen offset:1024 sc1 lds
  s_waitcnt lgkmcnt(2)
  v_smfmac_f32_16x16x64_bf16 v[84:87], v[40:43], a[80:87], v0
  v_smfmac_f32_16x16x64_bf16 v[88:91], v[40:43], a[88:95], v0
  s_mov_b32 m0, s37
  s_waitcnt lgkmcnt(1)
  v_smfmac_f32_16x16x64_bf16 v[84:87], v[44:47], a[96:103], v0
  v_smfmac_f32_16x16x64_bf16 v[88:91], v[44:47], a[104:111], v0
  buffer_load_dwordx4 v1, s[8:11], s51 offen sc1 lds
  s_waitcnt lgkmcnt(0)
  v_smfmac_f32_16x16x64_bf16 v[84:87], v[48:51], a[112:119], v0
  v_smfmac_f32_16x16x64_bf16 v[88:91], v[48:51], a[120:127], v0
  buffer_load_dwordx4 v1, s[8:11], s51 offen offset:1024 sc1 lds
  v_smfmac_f32_16x16x64_bf16 v[92:95], v[28:31], a[160:167], v0
  v_smfmac_f32_16x16x64_bf16 v[92:95], v[32:35], a[176:183], v0
  v_smfmac_f32_16x16x64_bf16 v[92:95], v[36:39], a[192:199], v0
  v_smfmac_f32_16x16x64_bf16 v[92:95], v[40:43], a[208:215], v0
  v_smfmac_f32_16x16x64_bf16 v[92:95], v[44:47], a[224:231], v0
  s_nop 0
  v_add_f32 v84, v84, v85
  v_add_f32 v86, v86, v87
  v_smfmac_f32_16x16x64_bf16 v[92:95], v[48:51], a[240:247], v0
  v_cvt_pk_bf16_f32 v16, v84, v86
  v_add_f32 v88, v88, v89
  v_smfmac_f32_16x16x64_bf16 v[96:99], v[28:31], a[168:175], v0
  v_add_f32 v90, v90, v91
  v_cvt_pk_bf16_f32 v18, v88, v90
  v_smfmac_f32_16x16x64_bf16 v[96:99], v[32:35], a[184:191], v0
  v_smfmac_f32_16x16x64_bf16 v[96:99], v[36:39], a[200:207], v0
  s_nop 0
  v_add_f32 v92, v92, v93
  v_smfmac_f32_16x16x64_bf16 v[96:99], v[40:43], a[216:223], v0
  v_add_f32 v94, v94, v95
  v_smfmac_f32_16x16x64_bf16 v[96:99], v[44:47], a[232:239], v0
  v_cvt_pk_bf16_f32 v17, v92, v94
  v_smfmac_f32_16x16x64_bf16 v[96:99], v[48:51], a[248:255], v0
  ds_write_b64 v2, v[16:17]
  v_smfmac_f32_16x16x64_bf16 v[100:103], v[28:31], v[160:167], v0
  v_smfmac_f32_16x16x64_bf16 v[104:107], v[28:31], v[168:175], v0
  s_nop 4
  v_add_f32 v96, v96, v97
  v_add_f32 v98, v98, v99
  v_cvt_pk_bf16_f32 v19, v96, v98
  ds_write_b64 v2, v[18:19] offset:128
  v_smfmac_f32_16x16x64_bf16 v[100:103], v[32:35], v[176:183], v0
  v_smfmac_f32_16x16x64_bf16 v[104:107], v[32:35], v[184:191], v0
  s_waitcnt lgkmcnt(0)
  s_barrier
  ds_read_b64_tr_b16 v[84:85], v3 offset:0
  ds_read_b64_tr_b16 v[86:87], v3 offset:64
  v_smfmac_f32_16x16x64_bf16 v[100:103], v[36:39], v[192:199], v0
  ds_read_b64_tr_b16 v[88:89], v3 offset:256
  ds_read_b64_tr_b16 v[90:91], v3 offset:320
  v_smfmac_f32_16x16x64_bf16 v[104:107], v[36:39], v[200:207], v0
  ds_read_b64_tr_b16 v[92:93], v3 offset:512
  ds_read_b64_tr_b16 v[94:95], v3 offset:576
  v_smfmac_f32_16x16x64_bf16 v[100:103], v[40:43], v[208:215], v0
  ds_read_b64_tr_b16 v[96:97], v3 offset:768
  ds_read_b64_tr_b16 v[98:99], v3 offset:832
  v_smfmac_f32_16x16x64_bf16 v[104:107], v[40:43], v[216:223], v0
  s_waitcnt vmcnt(4)
  s_waitcnt lgkmcnt(6)
  v_mfma_f32_16x16x32_bf16 v[116:119], v[52:55], v[84:87], 0
  v_mfma_f32_16x16x32_bf16 v[120:123], v[68:71], v[84:87], 0
  v_mfma_f32_16x16x32_bf16 v[124:127], v[84:87], v[84:87], 0
  s_waitcnt lgkmcnt(4)
  v_mfma_f32_16x16x32_bf16 v[116:119], v[56:59], v[88:91], v[116:119]
  v_mfma_f32_16x16x32_bf16 v[120:123], v[72:75], v[88:91], v[120:123]
  v_mfma_f32_16x16x32_bf16 v[124:127], v[88:91], v[88:91], v[124:127]
  s_waitcnt lgkmcnt(2)
  v_mfma_f32_16x16x32_bf16 v[116:119], v[60:63], v[92:95], v[116:119]
  v_mfma_f32_16x16x32_bf16 v[120:123], v[76:79], v[92:95], v[120:123]
  v_mfma_f32_16x16x32_bf16 v[124:127], v[92:95], v[92:95], v[124:127]
  s_waitcnt lgkmcnt(0)
  v_mfma_f32_16x16x32_bf16 v[116:119], v[64:67], v[96:99], v[116:119]
  v_mfma_f32_16x16x32_bf16 v[120:123], v[80:83], v[96:99], v[120:123]
  v_mfma_f32_16x16x32_bf16 v[124:127], v[96:99], v[96:99], v[124:127]
  v_smfmac_f32_16x16x64_bf16 v[100:103], v[44:47], v[224:231], v0
  ds_read_b128 v[52:55], v7 offset:0
  ds_read_b128 v[56:59], v7 offset:8192
  s_nop 2
  v_max3_f32 v88, v116, v117, v118
  v_max3_f32 v89, v120, v121, v122
  v_max3_f32 v88, v88, v119, v123
  v_max3_f32 v89, v89, v126, v127
  v_max_f32 v88, v88, v89
  v_max_f32 v89, v88, v89
  v_smfmac_f32_16x16x64_bf16 v[104:107], v[44:47], v[232:239], v0
  ds_read_b128 v[60:63], v7 offset:1024
  v_permlane32_swap_b32 v88, v89
  v_max_f32 v88, v88, v89
  v_max_f32 v89, v88, v89
  v_smfmac_f32_16x16x64_bf16 v[100:103], v[48:51], v[240:247], v0
  ds_read_b128 v[64:67], v7 offset:9216
  v_permlane16_swap_b32 v88, v89
  v_max_f32 v88, v88, v89
  v_mul_f32 v88, s34, v88
  v_smfmac_f32_16x16x64_bf16 v[104:107], v[48:51], v[248:255], v0
  v_fma_f32 v126, v126, s34, -v88
  v_fma_f32 v127, v127, s34, -v88
  v_exp_f32 v126, v126
  ds_read_b128 v[68:71], v7 offset:16384
  v_exp_f32 v127, v127
  ds_read_b128 v[72:75], v7 offset:24576
  v_fma_f32 v116, v116, s34, -v88
  v_fma_f32 v117, v117, s34, -v88
  v_fma_f32 v118, v118, s34, -v88
  v_fma_f32 v119, v119, s34, -v88
  v_cvt_pk_bf16_f32 v12, v126, v127
  v_exp_f32 v116, v116
  ds_read_b128 v[76:79], v7 offset:17408
  v_exp_f32 v117, v117
  ds_read_b128 v[80:83], v7 offset:25600
  v_mfma_f32_16x16x16_bf16 v[124:127], v[10:11], v[12:13], 0
  v_exp_f32 v118, v118
  ds_read_b128 v[20:23], v7 offset:2048
  v_exp_f32 v119, v119
  ds_read_b128 v[24:27], v7 offset:10240
  v_add_f32 v100, v100, v101
  v_add_f32 v102, v102, v103
  v_cvt_pk_bf16_f32 v16, v100, v102
  v_cvt_pk_bf16_f32 v92, v116, v117
  v_cvt_pk_bf16_f32 v93, v118, v119
  v_add_f32 v104, v104, v105
  v_add_f32 v106, v106, v107
  v_cvt_pk_bf16_f32 v18, v104, v106
  v_mfma_f32_16x16x16_bf16 v[124:127], v[10:11], v[92:93], v[124:127]
  v_bfi_b32 v16, 1, s59, v16
  v_fma_f32 v120, v120, s34, -v88
  v_fma_f32 v121, v121, s34, -v88
  buffer_store_dwordx4 v[16:19], v1, s[8:11], s52 offen sc1
  v_mfma_f32_16x16x16_bf16 v[100:103], v[16:17], v[12:13], 0
  v_fma_f32 v122, v122, s34, -v88
  v_fma_f32 v123, v123, s34, -v88
  v_mfma_f32_16x16x16_bf16 v[104:107], v[18:19], v[12:13], 0
  v_exp_f32 v120, v120
  ds_read_b128 v[28:31], v7 offset:3072
  v_exp_f32 v121, v121
  ds_read_b128 v[32:35], v7 offset:11264
  v_exp_f32 v122, v122
  ds_read_b128 v[36:39], v7 offset:18432
  v_exp_f32 v123, v123
  ds_read_b128 v[40:43], v7 offset:26624
  s_cmp_eq_u32 s32, 63
  v_cvt_pk_bf16_f32 v94, v120, v121
  v_cvt_pk_bf16_f32 v95, v122, v123
  s_cbranch_scc1 L_rec_last
  s_nop 0
  v_mfma_f32_16x16x16_bf16 v[124:127], v[10:11], v[94:95], v[124:127]
  v_mfma_f32_16x16x32_bf16 v[100:103], v[108:111], v[92:95], v[100:103]
  v_mfma_f32_16x16x32_bf16 v[104:107], v[112:115], v[92:95], v[104:107]
  ds_read_b128 v[44:47], v7 offset:19456
  ds_read_b128 v[48:51], v7 offset:27648
  s_nop 3
  v_rcp_f32 v124, v124
  s_nop 0
  v_pk_mul_f32 v[100:101], v[100:101], v[124:125] op_sel_hi:[1,0]
  v_pk_mul_f32 v[102:103], v[102:103], v[124:125] op_sel_hi:[1,0]
  v_cvt_pk_bf16_f32 v116, v100, v101
  v_cvt_pk_bf16_f32 v117, v102, v103
  v_pk_mul_f32 v[104:105], v[104:105], v[124:125] op_sel_hi:[1,0]
  v_pk_mul_f32 v[106:107], v[106:107], v[124:125] op_sel_hi:[1,0]
  v_cvt_pk_bf16_f32 v118, v104, v105
  v_cvt_pk_bf16_f32 v119, v106, v107
  s_mov_b64 exec, s[56:57]
  ds_write2_b32 v5, v116, v117 offset0:0 offset1:4
  ds_write2_b32 v5, v118, v119 offset0:8 offset1:12
  s_mov_b64 exec, -1
  v_mfma_f32_32x32x8_bf16 v[84:99], v[12:13], v[14:15], 0
  v_mfma_f32_32x32x8_bf16 v[100:115], v[12:13], v[14:15], 0
  s_waitcnt vmcnt(1) lgkmcnt(0)
  s_barrier
  ds_read_b128 v[116:119], v6
  ds_read_b128 v[120:123], v6 offset:128
  s_waitcnt lgkmcnt(1)
  s_nop 3
  v_smfmac_f32_16x16x64_bf16 v[84:87], v[116:119], v[52:59], v0
  ds_read_b128 v[52:55], v7 offset:4096
  ds_read_b128 v[56:59], v7 offset:12288
  v_smfmac_f32_16x16x64_bf16 v[88:91], v[116:119], v[60:67], v0
  ds_read_b128 v[60:63], v7 offset:5120
  ds_read_b128 v[64:67], v7 offset:13312
  s_waitcnt lgkmcnt(4)
  v_smfmac_f32_16x16x64_bf16 v[84:87], v[120:123], v[68:75], v0
  ds_read_b128 v[68:71], v7 offset:20480
  ds_read_b128 v[72:75], v7 offset:28672
  v_smfmac_f32_16x16x64_bf16 v[88:91], v[120:123], v[76:83], v0
  ds_read_b128 v[76:79], v7 offset:21504
  ds_read_b128 v[80:83], v7 offset:29696
  v_smfmac_f32_16x16x64_bf16 v[92:95], v[116:119], v[20:27], v0
  ds_read_b128 v[20:23], v7 offset:6144
  ds_read_b128 v[24:27], v7 offset:14336
  v_smfmac_f32_16x16x64_bf16 v[96:99], v[116:119], v[28:35], v0
  ds_read_b128 v[28:31], v7 offset:7168
  ds_read_b128 v[32:35], v7 offset:15360
  v_add_f32 v84, v84, v85
  v_smfmac_f32_16x16x64_bf16 v[92:95], v[120:123], v[36:43], v0
  ds_read_b128 v[36:39], v7 offset:22528
  ds_read_b128 v[40:43], v7 offset:30720
  v_add_f32 v86, v86, v87
  v_smfmac_f32_16x16x64_bf16 v[96:99], v[120:123], v[44:51], v0
  ds_read_b128 v[44:47], v7 offset:23552
  ds_read_b128 v[48:51], v7 offset:31744
  v_cvt_pk_bf16_f32 v124, v84, v86
  s_waitcnt lgkmcnt(14)
  v_smfmac_f32_16x16x64_bf16 v[100:103], v[116:119], v[52:59], v0
  v_add_f32 v88, v88, v89
  v_add_f32 v90, v90, v91
  s_waitcnt lgkmcnt(12)
  v_smfmac_f32_16x16x64_bf16 v[104:107], v[116:119], v[60:67], v0
  v_cvt_pk_bf16_f32 v125, v88, v90
  v_add_f32 v92, v92, v93
  s_waitcnt lgkmcnt(10)
  v_smfmac_f32_16x16x64_bf16 v[100:103], v[120:123], v[68:75], v0
  v_add_f32 v94, v94, v95
  v_cvt_pk_bf16_f32 v126, v92, v94
  s_waitcnt lgkmcnt(8)
  v_smfmac_f32_16x16x64_bf16 v[104:107], v[120:123], v[76:83], v0
  v_add_f32 v96, v96, v97
  v_add_f32 v98, v98, v99
  s_waitcnt lgkmcnt(6)
  v_smfmac_f32_16x16x64_bf16 v[108:111], v[116:119], v[20:27], v0
  v_cvt_pk_bf16_f32 v127, v96, v98
  v_bfi_b32 v124, 1, s33, v124
  s_waitcnt lgkmcnt(4)
  v_smfmac_f32_16x16x64_bf16 v[112:115], v[116:119], v[28:35], v0
  buffer_store_dwordx4 v[124:127], v8, s[8:11], s39 offen
  v_add_f32 v100, v100, v101
  s_waitcnt lgkmcnt(2)
  v_smfmac_f32_16x16x64_bf16 v[108:111], v[120:123], v[36:43], v0
  v_add_f32 v102, v102, v103
  v_cvt_pk_bf16_f32 v16, v100, v102
  s_waitcnt lgkmcnt(0)
  v_smfmac_f32_16x16x64_bf16 v[112:115], v[120:123], v[44:51], v0
  v_add_f32 v104, v104, v105
  v_add_f32 v106, v106, v107
  v_cvt_pk_bf16_f32 v17, v104, v106
  s_nop 0
  v_add_f32 v108, v108, v109
  v_add_f32 v110, v110, v111
  v_cvt_pk_bf16_f32 v18, v108, v110
  s_nop 0
  v_add_f32 v112, v112, v113
  v_add_f32 v114, v114, v115
  v_cvt_pk_bf16_f32 v19, v112, v114
  v_bfi_b32 v16, 1, s33, v16
  buffer_store_dwordx4 v[16:19], v8, s[8:11], s40 offen
  s_add_u32 s32, s32, 1
  ds_read_b128 v[52:55], v4 offset:0
  ds_read_b128 v[68:71], v4 offset:128
  ds_read_b128 v[56:59], v4 offset:2048
  ds_read_b128 v[72:75], v4 offset:2176
  ds_read_b128 v[60:63], v4 offset:4096
  ds_read_b128 v[76:79], v4 offset:4224
  ds_read_b128 v[64:67], v4 offset:6144
  ds_read_b128 v[80:83], v4 offset:6272
  ds_read_b128 v[108:111], v9
  ds_read_b128 v[112:115], v9 offset:256
  s_lshr_b32 s6, s32, 2
  s_andn2_b32 s59, 1, s6
  s_add_u32 s6, s32, 1
  s_and_b32 s6, s6, 3
  s_lshl_b32 s6, s6, 19
  s_add_u32 s50, s35, s6
  s_add_u32 s51, s50, 0x2000
  v_bfe_u32 v19, v1, 4, 4
  v_and_b32 v16, 1, v19
  v_lshlrev_b32 v17, 4, v16
  v_mov_b32 v18, 0x3f80
  v_lshlrev_b32 v17, v17, v18
  v_lshrrev_b32 v18, 1, v19
  v_cmp_eq_u32 vcc, 0, v18
  s_nop 1
  v_cndmask_b32 v120, 0, v17, vcc
  v_cmp_eq_u32 vcc, 1, v18
  s_nop 1
  v_cndmask_b32 v121, 0, v17, vcc
  v_cmp_eq_u32 vcc, 2, v18
  s_nop 1
  v_cndmask_b32 v122, 0, v17, vcc
  v_cmp_eq_u32 vcc, 3, v18
  s_nop 1
  v_cndmask_b32 v123, 0, v17, vcc
  v_lshlrev_b32 v16, 5, v16
  v_bfe_u32 v17, v19, 2, 1
  v_lshl_or_b32 v16, v17, 4, v16
  v_bfe_u32 v17, v19, 1, 1
  v_lshl_or_b32 v16, v17, 3, v16
  v_lshrrev_b32 v17, 8, v1
  v_lshl_or_b32 v124, v17, 6, v16
  s_waitcnt lgkmcnt(0)
  v_bitop3_b32 v16, v52, v56, s59 bitop3:0x7e
  v_bitop3_b32 v17, v60, v64, s59 bitop3:0x7e
  v_bitop3_b32 v18, v68, v72, s59 bitop3:0x7e
  v_bitop3_b32 v19, v76, v80, s59 bitop3:0x7e
  v_or3_b32 v16, v16, v17, v18
  v_bitop3_b32 v17, v108, v112, s59 bitop3:0x7e
  v_or3_b32 v16, v16, v17, v19
  v_and_b32 v16, 1, v16
  v_cmp_ne_u32 s[60:61], 0, v16
  v_mov_b32 v19, v124
  s_cmp_lg_u32 s3, 0
  s_cbranch_scc1 L_rec_nored
  s_mov_b32 s7, 0
L_rec_rr:
  buffer_load_dwordx4 v[20:23], v1, s[8:11], s41 offen offset:0 sc1
  buffer_load_dwordx4 v[24:27], v1, s[8:11], s41 offen offset:1024 sc1
  buffer_load_dwordx4 v[28:31], v1, s[8:11], s41 offen offset:2048 sc1
  buffer_load_dwordx4 v[32:35], v1, s[8:11], s41 offen offset:3072 sc1
  buffer_load_dwordx4 v[36:39], v1, s[8:11], s42 offen offset:0 sc1
  buffer_load_dwordx4 v[40:43], v1, s[8:11], s42 offen offset:1024 sc1
  buffer_load_dwordx4 v[44:47], v1, s[8:11], s42 offen offset:2048 sc1
  buffer_load_dwordx4 v[48:51], v1, s[8:11], s42 offen offset:3072 sc1
  s_waitcnt vmcnt(7)
  v_mfma_f32_16x16x32_bf16 v[124:127], v[20:23], v[120:123], 0
  s_waitcnt vmcnt(6)
  v_mfma_f32_16x16x32_bf16 v[124:127], v[24:27], v[120:123], v[124:127]
  v_bitop3_b32 v16, v20, v24, s33 bitop3:0x7e
  s_waitcnt vmcnt(5)
  v_mfma_f32_16x16x32_bf16 v[124:127], v[28:31], v[120:123], v[124:127]
  s_waitcnt vmcnt(4)
  v_mfma_f32_16x16x32_bf16 v[124:127], v[32:35], v[120:123], v[124:127]
  v_bitop3_b32 v17, v28, v32, s33 bitop3:0x7e
  s_waitcnt vmcnt(3)
  v_mfma_f32_16x16x32_bf16 v[124:127], v[36:39], v[120:123], v[124:127]
  s_waitcnt vmcnt(2)
  v_mfma_f32_16x16x32_bf16 v[124:127], v[40:43], v[120:123], v[124:127]
  v_bitop3_b32 v18, v36, v40, s33 bitop3:0x7e
  s_waitcnt vmcnt(1)
  v_mfma_f32_16x16x32_bf16 v[124:127], v[44:47], v[120:123], v[124:127]
  v_or3_b32 v16, v16, v17, v18
  s_waitcnt vmcnt(0)
  v_mfma_f32_16x16x32_bf16 v[124:127], v[48:51], v[120:123], v[124:127]
  v_bitop3_b32 v17, v44, v48, s33 bitop3:0x7e
  v_bitop3_b32 v16, v16, v17, 1 bitop3:0xa8
  v_cmp_ne_u32 vcc, 0, v16
  s_cbranch_vccz L_rec_red
  s_and_b32 s6, s7, 31
  s_cmp_lg_u32 s6, 31
  s_cbranch_scc1 L_tf_82
  buffer_wbl2 sc1
  s_waitcnt vmcnt(0)
  buffer_inv sc1
  s_waitcnt vmcnt(0)
L_tf_82:
  s_add_u32 s7, s7, 1
  s_cmp_lt_u32 s7, 131072
  s_cbranch_scc1 L_rec_rr
  s_mov_b32 s6, 14
  s_branch L_err
L_rec_red:
  s_nop 3
  v_cvt_pk_bf16_f32 v124, v124, v125
  v_cvt_pk_bf16_f32 v125, v126, v127
  v_bfi_b32 v124, 1, s33, v124
  s_mov_b64 exec, s[54:55]
  buffer_store_dwordx2 v[124:125], v19, s[8:11], s43 offen
  s_cmp_lg_u32 s32, 63
  s_cbranch_scc1 L_rec_nl
  buffer_store_dwordx2 v[124:125], v19, s[8:11], s43 offen sc1
L_rec_nl:
  s_mov_b64 exec, -1
  s_barrier
  s_branch L_rec_loop
L_rec_nored:
  s_barrier
  s_branch L_rec_loop
L_rec_kvwait:
  s_and_b32 s6, s32, 3
  s_lshl_b32 s6, s6, 19
  s_add_u32 s6, s6, s35
  s_sub_u32 s60, s6, s53
  s_add_u32 s61, s60, 4096
  s_mov_b32 s7, 0
L_kvs_83:
  buffer_load_dwordx4 v[52:55], v4, s[8:11], s60 offen offset:0 sc1
  buffer_load_dwordx4 v[68:71], v4, s[8:11], s60 offen offset:128 sc1
  buffer_load_dwordx4 v[56:59], v4, s[8:11], s60 offen offset:2048 sc1
  buffer_load_dwordx4 v[72:75], v4, s[8:11], s60 offen offset:2176 sc1
  buffer_load_dwordx4 v[60:63], v4, s[8:11], s61 offen offset:0 sc1
  buffer_load_dwordx4 v[76:79], v4, s[8:11], s61 offen offset:128 sc1
  buffer_load_dwordx4 v[64:67], v4, s[8:11], s61 offen offset:2048 sc1
  buffer_load_dwordx4 v[80:83], v4, s[8:11], s61 offen offset:2176 sc1
  buffer_load_dwordx4 v[108:111], v9, s[8:11], s60 offen offset:0 sc1
  buffer_load_dwordx4 v[112:115], v9, s[8:11], s60 offen offset:256 sc1
  s_waitcnt vmcnt(0)
  v_bitop3_b32 v16, v52, v56, s59 bitop3:0x7e
  v_bitop3_b32 v17, v60, v64, s59 bitop3:0x7e
  v_bitop3_b32 v18, v68, v72, s59 bitop3:0x7e
  v_bitop3_b32 v19, v76, v80, s59 bitop3:0x7e
  v_or3_b32 v16, v16, v17, v18
  v_bitop3_b32 v17, v108, v112, s59 bitop3:0x7e
  v_or3_b32 v16, v16, v17, v19
  v_and_b32 v16, 1, v16
  v_cmp_ne_u32 vcc, 0, v16
  s_cbranch_vccz L_rec_kvok
  s_add_u32 s7, s7, 1
  s_cmp_lt_u32 s7, 131072
  s_cbranch_scc1 L_kvs_83
  s_mov_b32 s6, 13
  s_branch L_err
L_rec_last:
  s_waitcnt vmcnt(0)
  s_endpgm
L_p:
  s_sub_u32 s35, s4, 2
  s_lshr_b32 s35, s35, 1
  s_and_b32 s6, s4, 1
  s_lshl_b32 s6, s6, 4
  s_and_b32 s36, s5, 15
  s_add_u32 s36, s36, s6
  s_lshr_b32 s37, s5, 4
  s_mul_i32 s38, s35, 0x200000
  s_add_u32 s38, s38, 0x0
  s_mul_i32 s39, s35, 0x2000000
  s_add_u32 s39, s39, 0x800000
  s_mul_i32 s40, s35, 0x1000000
  s_add_u32 s40, s40, 0x4800000
  s_mul_i32 s41, s35, 0x1000000
  s_add_u32 s41, s41, 0x6800000
  s_mul_i32 s44, s35, 0x800
  s_add_u32 s44, s44, 0x710000
  s_lshl_b32 s6, s3, 13
  s_add_u32 s38, s38, s6
  s_add_u32 s53, s6, 0
  s_lshl_b32 s6, s36, 14
  s_lshl_b32 s7, s3, 11
  s_add_u32 s39, s39, s6
  s_add_u32 s39, s39, s7
  s_lshl_b32 s6, s36, 12
  s_lshl_b32 s7, s3, 10
  s_add_u32 s40, s40, s6
  s_add_u32 s40, s40, s7
  s_lshl_b32 s6, s36, 13
  s_lshr_b32 s7, s3, 1
  s_lshl_b32 s7, s7, 12
  s_add_u32 s41, s41, s6
  s_add_u32 s41, s41, s7
  s_lshl_b32 s6, s35, 13
  s_lshl_b32 s7, s37, 12
  s_add_u32 s6, s6, s7
  s_lshl_b32 s7, s36, 7
  s_add_u32 s6, s6, s7
  s_lshl_b32 s7, s3, 2
  s_add_u32 s6, s6, s7
  s_add_u32 s43, s6, 0x718000
  s_mov_b32 s34, 0x3e0293ee
  v_mov_b32 v12, 0
  v_mov_b32 v13, 0
  v_mov_b32 v14, 0
  v_mov_b32 v15, 0
  v_lshlrev_b32 v16, 4, v0
  s_lshl_b32 s6, s37, 19
  s_add_u32 s6, s6, s39
  s_mov_b64 exec, 1
  buffer_store_dword v12, v12, s[8:11], s43 offen sc1
  s_mov_b64 exec, -1
  buffer_store_dwordx4 v[12:15], v16, s[8:11], s6 offen offset:0 sc1
  buffer_store_dwordx4 v[12:15], v16, s[8:11], s6 offen offset:1024 sc1
  s_add_u32 s6, s6, 8192
  buffer_store_dwordx4 v[12:15], v16, s[8:11], s6 offen offset:0 sc1
  buffer_store_dwordx4 v[12:15], v16, s[8:11], s6 offen offset:1024 sc1
  s_add_u32 s6, s6, 1040384
  buffer_store_dwordx4 v[12:15], v16, s[8:11], s6 offen offset:0 sc1
  buffer_store_dwordx4 v[12:15], v16, s[8:11], s6 offen offset:1024 sc1
  s_add_u32 s6, s6, 8192
  buffer_store_dwordx4 v[12:15], v16, s[8:11], s6 offen offset:0 sc1
  buffer_store_dwordx4 v[12:15], v16, s[8:11], s6 offen offset:1024 sc1
  s_cmp_ge_u32 s4, 4
  s_cbranch_scc1 L_pro
L_p2:
  v_mov_b32 v12, 0
  v_mov_b32 v13, 0
  v_lshlrev_b32 v0, 4, v0
  s_mov_b32 s16, s82
  s_mov_b32 s17, s83
  s_mov_b32 s18, 0x400000
  s_mov_b32 s19, 0x20000
  s_mov_b32 s20, s84
  s_mov_b32 s21, s85
  s_mov_b32 s22, 0x400000
  s_mov_b32 s23, 0x20000
  s_mov_b32 s24, s86
  s_mov_b32 s25, s87
  s_mov_b32 s26, 0x400000
  s_mov_b32 s27, 0x20000
  v_mov_b32 v80, 0x3f803f80
  v_mov_b32 v81, 0x3f803f80
  v_mov_b32 v82, 0x3f803f80
  v_mov_b32 v83, 0x3f803f80
  v_lshrrev_b32 v104, 4, v0
  v_lshrrev_b32 v100, 8, v0
  v_lshlrev_b32 v105, 2, v100
  v_and_b32 v104, 15, v104
  v_xor_b32 v104, v104, v105
  v_mul_u32_u24 v100, 8192, v100
  v_lshl_add_u32 v100, v104, 4, v100
  v_bfe_u32 v104, v0, 6, 2
  v_lshlrev_b32 v105, 2, v104
  v_bfe_u32 v106, v0, 8, 1
  v_lshlrev_b32 v106, 1, v106
  v_bfe_u32 v107, v0, 5, 1
  v_or_b32 v106, v106, v107
  s_lshl_b32 s6, s3, 2
  v_or_b32 v106, s6, v106
  v_xor_b32 v106, v106, v105
  v_lshlrev_b32 v106, 4, v106
  v_bfe_u32 v107, v0, 4, 1
  v_lshl_or_b32 v106, v107, 3, v106
  v_bfe_u32 v107, v0, 9, 1
  v_lshl_or_b32 v104, v107, 3, v104
  v_lshl_or_b32 v104, v104, 8, v106
  v_add_u32 v105, 0x10000, v104
  s_lshl_b32 s60, s3, 13
  s_mul_i32 s63, s3, 262144
  s_lshr_b32 s6, 0x72, s4
  s_bitcmp1_b32 s6, 0
  s_cbranch_scc1 L_rdn_84
  s_waitcnt vmcnt(0)
  s_barrier
  s_cmp_lg_u32 s3, 0
  s_cbranch_scc1 L_sd_85
  s_mov_b64 exec, 1
  s_and_b32 s6, s4, 3
  s_lshl_b32 s6, s6, 6
  v_mov_b32 v18, 16
  v_mov_b32 v19, 1
  buffer_atomic_add v19, v18, s[12:15], s6 offen sc1
  s_mov_b64 exec, -1
L_sd_85:
L_rdn_84:
  s_lshl_b32 s61, s36, 8
  s_add_u32 s61, s61, 0
  s_add_u32 s61, s61, s63
  s_add_u32 m0, s60, 0
  s_add_u32 s62, s61, 0
  buffer_load_dwordx4 v100, s[16:19], s62 offen lds
  s_add_u32 m0, s60, 1024
  s_add_u32 s62, s61, 32768
  buffer_load_dwordx4 v100, s[16:19], s62 offen lds
  s_add_u32 m0, s60, 2048
  s_add_u32 s62, s61, 65536
  buffer_load_dwordx4 v100, s[16:19], s62 offen lds
  s_add_u32 m0, s60, 3072
  s_add_u32 s62, s61, 98304
  buffer_load_dwordx4 v100, s[16:19], s62 offen lds
  s_add_u32 m0, s60, 4096
  s_add_u32 s62, s61, 131072
  buffer_load_dwordx4 v100, s[16:19], s62 offen lds
  s_add_u32 m0, s60, 5120
  s_add_u32 s62, s61, 163840
  buffer_load_dwordx4 v100, s[16:19], s62 offen lds
  s_add_u32 m0, s60, 6144
  s_add_u32 s62, s61, 196608
  buffer_load_dwordx4 v100, s[16:19], s62 offen lds
  s_add_u32 m0, s60, 7168
  s_add_u32 s62, s61, 229376
  buffer_load_dwordx4 v100, s[16:19], s62 offen lds
  s_lshl_b32 s61, s36, 8
  s_add_u32 s61, s61, 1048576
  s_add_u32 s61, s61, s63
  s_add_u32 m0, s60, 32768
  s_add_u32 s62, s61, 0
  buffer_load_dwordx4 v100, s[16:19], s62 offen lds
  s_add_u32 m0, s60, 33792
  s_add_u32 s62, s61, 32768
  buffer_load_dwordx4 v100, s[16:19], s62 offen lds
  s_add_u32 m0, s60, 34816
  s_add_u32 s62, s61, 65536
  buffer_load_dwordx4 v100, s[16:19], s62 offen lds
  s_add_u32 m0, s60, 35840
  s_add_u32 s62, s61, 98304
  buffer_load_dwordx4 v100, s[16:19], s62 offen lds
  s_add_u32 m0, s60, 36864
  s_add_u32 s62, s61, 131072
  buffer_load_dwordx4 v100, s[16:19], s62 offen lds
  s_add_u32 m0, s60, 37888
  s_add_u32 s62, s61, 163840
  buffer_load_dwordx4 v100, s[16:19], s62 offen lds
  s_add_u32 m0, s60, 38912
  s_add_u32 s62, s61, 196608
  buffer_load_dwordx4 v100, s[16:19], s62 offen lds
  s_add_u32 m0, s60, 39936
  s_add_u32 s62, s61, 229376
  buffer_load_dwordx4 v100, s[16:19], s62 offen lds
  s_lshl_b32 s61, s36, 8
  s_add_u32 s61, s61, 2097152
  s_add_u32 s61, s61, s63
  s_add_u32 m0, s60, 65536
  s_add_u32 s62, s61, 0
  buffer_load_dwordx4 v100, s[16:19], s62 offen lds
  s_add_u32 m0, s60, 66560
  s_add_u32 s62, s61, 32768
  buffer_load_dwordx4 v100, s[16:19], s62 offen lds
  s_add_u32 m0, s60, 67584
  s_add_u32 s62, s61, 65536
  buffer_load_dwordx4 v100, s[16:19], s62 offen lds
  s_add_u32 m0, s60, 68608
  s_add_u32 s62, s61, 98304
  buffer_load_dwordx4 v100, s[16:19], s62 offen lds
  s_add_u32 m0, s60, 69632
  s_add_u32 s62, s61, 131072
  buffer_load_dwordx4 v100, s[16:19], s62 offen lds
  s_add_u32 m0, s60, 70656
  s_add_u32 s62, s61, 163840
  buffer_load_dwordx4 v100, s[16:19], s62 offen lds
  s_add_u32 m0, s60, 71680
  s_add_u32 s62, s61, 196608
  buffer_load_dwordx4 v100, s[16:19], s62 offen lds
  s_add_u32 m0, s60, 72704
  s_add_u32 s62, s61, 229376
  buffer_load_dwordx4 v100, s[16:19], s62 offen lds
  s_waitcnt vmcnt(16)
  s_barrier
  s_lshl_b32 s61, s36, 8
  s_add_u32 s61, s61, 3145728
  s_add_u32 s61, s61, s63
  s_add_u32 m0, s60, 98304
  s_add_u32 s62, s61, 0
  buffer_load_dwordx4 v100, s[16:19], s62 offen lds
  s_add_u32 m0, s60, 99328
  s_add_u32 s62, s61, 32768
  buffer_load_dwordx4 v100, s[16:19], s62 offen lds
  s_add_u32 m0, s60, 100352
  s_add_u32 s62, s61, 65536
  buffer_load_dwordx4 v100, s[16:19], s62 offen lds
  s_add_u32 m0, s60, 101376
  s_add_u32 s62, s61, 98304
  buffer_load_dwordx4 v100, s[16:19], s62 offen lds
  s_add_u32 m0, s60, 102400
  s_add_u32 s62, s61, 131072
  buffer_load_dwordx4 v100, s[16:19], s62 offen lds
  s_add_u32 m0, s60, 103424
  s_add_u32 s62, s61, 163840
  buffer_load_dwordx4 v100, s[16:19], s62 offen lds
  s_add_u32 m0, s60, 104448
  s_add_u32 s62, s61, 196608
  buffer_load_dwordx4 v100, s[16:19], s62 offen lds
  s_add_u32 m0, s60, 105472
  s_add_u32 s62, s61, 229376
  buffer_load_dwordx4 v100, s[16:19], s62 offen lds
  ds_read_b64_tr_b16 a[0:1], v104 offset:0
  ds_read_b64_tr_b16 a[2:3], v104 offset:1024
  ds_read_b64_tr_b16 a[4:5], v104 offset:4096
  ds_read_b64_tr_b16 a[6:7], v104 offset:5120
  ds_read_b64_tr_b16 a[8:9], v104 offset:8192
  ds_read_b64_tr_b16 a[10:11], v104 offset:9216
  ds_read_b64_tr_b16 a[12:13], v104 offset:12288
  ds_read_b64_tr_b16 a[14:15], v104 offset:13312
  ds_read_b64_tr_b16 a[16:17], v104 offset:16384
  ds_read_b64_tr_b16 a[18:19], v104 offset:17408
  ds_read_b64_tr_b16 a[20:21], v104 offset:20480
  ds_read_b64_tr_b16 a[22:23], v104 offset:21504
  ds_read_b64_tr_b16 a[24:25], v104 offset:24576
  ds_read_b64_tr_b16 a[26:27], v104 offset:25600
  ds_read_b64_tr_b16 a[28:29], v104 offset:28672
  ds_read_b64_tr_b16 a[30:31], v104 offset:29696
  s_waitcnt lgkmcnt(0)
  v_mfma_f32_32x32x16_bf16 v[32:47], v[80:83], a[0:3], 0
  v_mfma_f32_32x32x16_bf16 v[32:47], v[80:83], a[4:7], v[32:47]
  v_mfma_f32_32x32x16_bf16 v[32:47], v[80:83], a[8:11], v[32:47]
  v_mfma_f32_32x32x16_bf16 v[32:47], v[80:83], a[12:15], v[32:47]
  v_mfma_f32_32x32x16_bf16 v[32:47], v[80:83], a[16:19], v[32:47]
  v_mfma_f32_32x32x16_bf16 v[32:47], v[80:83], a[20:23], v[32:47]
  v_mfma_f32_32x32x16_bf16 v[32:47], v[80:83], a[24:27], v[32:47]
  v_mfma_f32_32x32x16_bf16 v[32:47], v[80:83], a[28:31], v[32:47]
  s_waitcnt vmcnt(16)
  s_barrier
  s_lshl_b32 s61, s36, 8
  s_add_u32 s61, s61, 0
  s_add_u32 s61, s61, s63
  s_add_u32 m0, s60, 0
  s_add_u32 s62, s61, 0
  buffer_load_dwordx4 v100, s[20:23], s62 offen lds
  s_add_u32 m0, s60, 1024
  s_add_u32 s62, s61, 32768
  buffer_load_dwordx4 v100, s[20:23], s62 offen lds
  s_add_u32 m0, s60, 2048
  s_add_u32 s62, s61, 65536
  buffer_load_dwordx4 v100, s[20:23], s62 offen lds
  s_add_u32 m0, s60, 3072
  s_add_u32 s62, s61, 98304
  buffer_load_dwordx4 v100, s[20:23], s62 offen lds
  s_add_u32 m0, s60, 4096
  s_add_u32 s62, s61, 131072
  buffer_load_dwordx4 v100, s[20:23], s62 offen lds
  s_add_u32 m0, s60, 5120
  s_add_u32 s62, s61, 163840
  buffer_load_dwordx4 v100, s[20:23], s62 offen lds
  s_add_u32 m0, s60, 6144
  s_add_u32 s62, s61, 196608
  buffer_load_dwordx4 v100, s[20:23], s62 offen lds
  s_add_u32 m0, s60, 7168
  s_add_u32 s62, s61, 229376
  buffer_load_dwordx4 v100, s[20:23], s62 offen lds
  ds_read_b64_tr_b16 a[32:33], v104 offset:32768
  ds_read_b64_tr_b16 a[34:35], v104 offset:33792
  ds_read_b64_tr_b16 a[36:37], v104 offset:36864
  ds_read_b64_tr_b16 a[38:39], v104 offset:37888
  ds_read_b64_tr_b16 a[40:41], v104 offset:40960
  ds_read_b64_tr_b16 a[42:43], v104 offset:41984
  ds_read_b64_tr_b16 a[44:45], v104 offset:45056
  ds_read_b64_tr_b16 a[46:47], v104 offset:46080
  ds_read_b64_tr_b16 a[48:49], v104 offset:49152
  ds_read_b64_tr_b16 a[50:51], v104 offset:50176
  ds_read_b64_tr_b16 a[52:53], v104 offset:53248
  ds_read_b64_tr_b16 a[54:55], v104 offset:54272
  ds_read_b64_tr_b16 a[56:57], v104 offset:57344
  ds_read_b64_tr_b16 a[58:59], v104 offset:58368
  ds_read_b64_tr_b16 a[60:61], v104 offset:61440
  ds_read_b64_tr_b16 a[62:63], v104 offset:62464
  s_waitcnt lgkmcnt(0)
  v_mfma_f32_32x32x16_bf16 v[32:47], v[80:83], a[32:35], v[32:47]
  v_mfma_f32_32x32x16_bf16 v[32:47], v[80:83], a[36:39], v[32:47]
  v_mfma_f32_32x32x16_bf16 v[32:47], v[80:83], a[40:43], v[32:47]
  v_mfma_f32_32x32x16_bf16 v[32:47], v[80:83], a[44:47], v[32:47]
  v_mfma_f32_32x32x16_bf16 v[32:47], v[80:83], a[48:51], v[32:47]
  v_mfma_f32_32x32x16_bf16 v[32:47], v[80:83], a[52:55], v[32:47]
  v_mfma_f32_32x32x16_bf16 v[32:47], v[80:83], a[56:59], v[32:47]
  v_mfma_f32_32x32x16_bf16 v[32:47], v[80:83], a[60:63], v[32:47]
  s_waitcnt vmcnt(16)
  s_barrier
  s_lshl_b32 s61, s36, 8
  s_add_u32 s61, s61, 1048576
  s_add_u32 s61, s61, s63
  s_add_u32 m0, s60, 32768
  s_add_u32 s62, s61, 0
  buffer_load_dwordx4 v100, s[20:23], s62 offen lds
  s_add_u32 m0, s60, 33792
  s_add_u32 s62, s61, 32768
  buffer_load_dwordx4 v100, s[20:23], s62 offen lds
  s_add_u32 m0, s60, 34816
  s_add_u32 s62, s61, 65536
  buffer_load_dwordx4 v100, s[20:23], s62 offen lds
  s_add_u32 m0, s60, 35840
  s_add_u32 s62, s61, 98304
  buffer_load_dwordx4 v100, s[20:23], s62 offen lds
  s_add_u32 m0, s60, 36864
  s_add_u32 s62, s61, 131072
  buffer_load_dwordx4 v100, s[20:23], s62 offen lds
  s_add_u32 m0, s60, 37888
  s_add_u32 s62, s61, 163840
  buffer_load_dwordx4 v100, s[20:23], s62 offen lds
  s_add_u32 m0, s60, 38912
  s_add_u32 s62, s61, 196608
  buffer_load_dwordx4 v100, s[20:23], s62 offen lds
  s_add_u32 m0, s60, 39936
  s_add_u32 s62, s61, 229376
  buffer_load_dwordx4 v100, s[20:23], s62 offen lds
  ds_read_b64_tr_b16 a[64:65], v105 offset:0
  ds_read_b64_tr_b16 a[66:67], v105 offset:1024
  ds_read_b64_tr_b16 a[68:69], v105 offset:4096
  ds_read_b64_tr_b16 a[70:71], v105 offset:5120
  ds_read_b64_tr_b16 a[72:73], v105 offset:8192
  ds_read_b64_tr_b16 a[74:75], v105 offset:9216
  ds_read_b64_tr_b16 a[76:77], v105 offset:12288
  ds_read_b64_tr_b16 a[78:79], v105 offset:13312
  ds_read_b64_tr_b16 a[80:81], v105 offset:16384
  ds_read_b64_tr_b16 a[82:83], v105 offset:17408
  ds_read_b64_tr_b16 a[84:85], v105 offset:20480
  ds_read_b64_tr_b16 a[86:87], v105 offset:21504
  ds_read_b64_tr_b16 a[88:89], v105 offset:24576
  ds_read_b64_tr_b16 a[90:91], v105 offset:25600
  ds_read_b64_tr_b16 a[92:93], v105 offset:28672
  ds_read_b64_tr_b16 a[94:95], v105 offset:29696
  s_waitcnt lgkmcnt(0)
  v_mfma_f32_32x32x16_bf16 v[32:47], v[80:83], a[64:67], v[32:47]
  v_mfma_f32_32x32x16_bf16 v[32:47], v[80:83], a[68:71], v[32:47]
  v_mfma_f32_32x32x16_bf16 v[32:47], v[80:83], a[72:75], v[32:47]
  v_mfma_f32_32x32x16_bf16 v[32:47], v[80:83], a[76:79], v[32:47]
  v_mfma_f32_32x32x16_bf16 v[32:47], v[80:83], a[80:83], v[32:47]
  v_mfma_f32_32x32x16_bf16 v[32:47], v[80:83], a[84:87], v[32:47]
  v_mfma_f32_32x32x16_bf16 v[32:47], v[80:83], a[88:91], v[32:47]
  v_mfma_f32_32x32x16_bf16 v[32:47], v[80:83], a[92:95], v[32:47]
  s_waitcnt vmcnt(16)
  s_barrier
  s_lshl_b32 s61, s36, 8
  s_add_u32 s61, s61, 2097152
  s_add_u32 s61, s61, s63
  s_add_u32 m0, s60, 65536
  s_add_u32 s62, s61, 0
  buffer_load_dwordx4 v100, s[20:23], s62 offen lds
  s_add_u32 m0, s60, 66560
  s_add_u32 s62, s61, 32768
  buffer_load_dwordx4 v100, s[20:23], s62 offen lds
  s_add_u32 m0, s60, 67584
  s_add_u32 s62, s61, 65536
  buffer_load_dwordx4 v100, s[20:23], s62 offen lds
  s_add_u32 m0, s60, 68608
  s_add_u32 s62, s61, 98304
  buffer_load_dwordx4 v100, s[20:23], s62 offen lds
  s_add_u32 m0, s60, 69632
  s_add_u32 s62, s61, 131072
  buffer_load_dwordx4 v100, s[20:23], s62 offen lds
  s_add_u32 m0, s60, 70656
  s_add_u32 s62, s61, 163840
  buffer_load_dwordx4 v100, s[20:23], s62 offen lds
  s_add_u32 m0, s60, 71680
  s_add_u32 s62, s61, 196608
  buffer_load_dwordx4 v100, s[20:23], s62 offen lds
  s_add_u32 m0, s60, 72704
  s_add_u32 s62, s61, 229376
  buffer_load_dwordx4 v100, s[20:23], s62 offen lds
  ds_read_b64_tr_b16 a[96:97], v105 offset:32768
  ds_read_b64_tr_b16 a[98:99], v105 offset:33792
  ds_read_b64_tr_b16 a[100:101], v105 offset:36864
  ds_read_b64_tr_b16 a[102:103], v105 offset:37888
  ds_read_b64_tr_b16 a[104:105], v105 offset:40960
  ds_read_b64_tr_b16 a[106:107], v105 offset:41984
  ds_read_b64_tr_b16 a[108:109], v105 offset:45056
  ds_read_b64_tr_b16 a[110:111], v105 offset:46080
  ds_read_b64_tr_b16 a[112:113], v105 offset:49152
  ds_read_b64_tr_b16 a[114:115], v105 offset:50176
  ds_read_b64_tr_b16 a[116:117], v105 offset:53248
  ds_read_b64_tr_b16 a[118:119], v105 offset:54272
  ds_read_b64_tr_b16 a[120:121], v105 offset:57344
  ds_read_b64_tr_b16 a[122:123], v105 offset:58368
  ds_read_b64_tr_b16 a[124:125], v105 offset:61440
  ds_read_b64_tr_b16 a[126:127], v105 offset:62464
  s_waitcnt lgkmcnt(0)
  v_mfma_f32_32x32x16_bf16 v[32:47], v[80:83], a[96:99], v[32:47]
  v_mfma_f32_32x32x16_bf16 v[32:47], v[80:83], a[100:103], v[32:47]
  v_mfma_f32_32x32x16_bf16 v[32:47], v[80:83], a[104:107], v[32:47]
  v_mfma_f32_32x32x16_bf16 v[32:47], v[80:83], a[108:111], v[32:47]
  v_mfma_f32_32x32x16_bf16 v[32:47], v[80:83], a[112:115], v[32:47]
  v_mfma_f32_32x32x16_bf16 v[32:47], v[80:83], a[116:119], v[32:47]
  v_mfma_f32_32x32x16_bf16 v[32:47], v[80:83], a[120:123], v[32:47]
  v_mfma_f32_32x32x16_bf16 v[32:47], v[80:83], a[124:127], v[32:47]
  s_waitcnt vmcnt(16)
  s_barrier
  s_lshl_b32 s61, s36, 8
  s_add_u32 s61, s61, 3145728
  s_add_u32 s61, s61, s63
  s_add_u32 m0, s60, 98304
  s_add_u32 s62, s61, 0
  buffer_load_dwordx4 v100, s[20:23], s62 offen lds
  s_add_u32 m0, s60, 99328
  s_add_u32 s62, s61, 32768
  buffer_load_dwordx4 v100, s[20:23], s62 offen lds
  s_add_u32 m0, s60, 100352
  s_add_u32 s62, s61, 65536
  buffer_load_dwordx4 v100, s[20:23], s62 offen lds
  s_add_u32 m0, s60, 101376
  s_add_u32 s62, s61, 98304
  buffer_load_dwordx4 v100, s[20:23], s62 offen lds
  s_add_u32 m0, s60, 102400
  s_add_u32 s62, s61, 131072
  buffer_load_dwordx4 v100, s[20:23], s62 offen lds
  s_add_u32 m0, s60, 103424
  s_add_u32 s62, s61, 163840
  buffer_load_dwordx4 v100, s[20:23], s62 offen lds
  s_add_u32 m0, s60, 104448
  s_add_u32 s62, s61, 196608
  buffer_load_dwordx4 v100, s[20:23], s62 offen lds
  s_add_u32 m0, s60, 105472
  s_add_u32 s62, s61, 229376
  buffer_load_dwordx4 v100, s[20:23], s62 offen lds
  ds_read_b64_tr_b16 a[128:129], v104 offset:0
  ds_read_b64_tr_b16 a[130:131], v104 offset:1024
  ds_read_b64_tr_b16 a[132:133], v104 offset:4096
  ds_read_b64_tr_b16 a[134:135], v104 offset:5120
  ds_read_b64_tr_b16 a[136:137], v104 offset:8192
  ds_read_b64_tr_b16 a[138:139], v104 offset:9216
  ds_read_b64_tr_b16 a[140:141], v104 offset:12288
  ds_read_b64_tr_b16 a[142:143], v104 offset:13312
  ds_read_b64_tr_b16 a[144:145], v104 offset:16384
  ds_read_b64_tr_b16 a[146:147], v104 offset:17408
  ds_read_b64_tr_b16 a[148:149], v104 offset:20480
  ds_read_b64_tr_b16 a[150:151], v104 offset:21504
  ds_read_b64_tr_b16 a[152:153], v104 offset:24576
  ds_read_b64_tr_b16 a[154:155], v104 offset:25600
  ds_read_b64_tr_b16 a[156:157], v104 offset:28672
  ds_read_b64_tr_b16 a[158:159], v104 offset:29696
  s_waitcnt lgkmcnt(0)
  v_mfma_f32_32x32x16_bf16 v[48:63], v[80:83], a[128:131], 0
  v_mfma_f32_32x32x16_bf16 v[48:63], v[80:83], a[132:135], v[48:63]
  v_mfma_f32_32x32x16_bf16 v[48:63], v[80:83], a[136:139], v[48:63]
  v_mfma_f32_32x32x16_bf16 v[48:63], v[80:83], a[140:143], v[48:63]
  v_mfma_f32_32x32x16_bf16 v[48:63], v[80:83], a[144:147], v[48:63]
  v_mfma_f32_32x32x16_bf16 v[48:63], v[80:83], a[148:151], v[48:63]
  v_mfma_f32_32x32x16_bf16 v[48:63], v[80:83], a[152:155], v[48:63]
  v_mfma_f32_32x32x16_bf16 v[48:63], v[80:83], a[156:159], v[48:63]
  s_waitcnt vmcnt(16)
  s_barrier
  s_lshl_b32 s61, s36, 8
  s_add_u32 s61, s61, 0
  s_add_u32 s61, s61, s63
  s_add_u32 m0, s60, 0
  s_add_u32 s62, s61, 0
  buffer_load_dwordx4 v100, s[24:27], s62 offen lds
  s_add_u32 m0, s60, 1024
  s_add_u32 s62, s61, 32768
  buffer_load_dwordx4 v100, s[24:27], s62 offen lds
  s_add_u32 m0, s60, 2048
  s_add_u32 s62, s61, 65536
  buffer_load_dwordx4 v100, s[24:27], s62 offen lds
  s_add_u32 m0, s60, 3072
  s_add_u32 s62, s61, 98304
  buffer_load_dwordx4 v100, s[24:27], s62 offen lds
  s_add_u32 m0, s60, 4096
  s_add_u32 s62, s61, 131072
  buffer_load_dwordx4 v100, s[24:27], s62 offen lds
  s_add_u32 m0, s60, 5120
  s_add_u32 s62, s61, 163840
  buffer_load_dwordx4 v100, s[24:27], s62 offen lds
  s_add_u32 m0, s60, 6144
  s_add_u32 s62, s61, 196608
  buffer_load_dwordx4 v100, s[24:27], s62 offen lds
  s_add_u32 m0, s60, 7168
  s_add_u32 s62, s61, 229376
  buffer_load_dwordx4 v100, s[24:27], s62 offen lds
  ds_read_b64_tr_b16 a[160:161], v104 offset:32768
  ds_read_b64_tr_b16 a[162:163], v104 offset:33792
  ds_read_b64_tr_b16 a[164:165], v104 offset:36864
  ds_read_b64_tr_b16 a[166:167], v104 offset:37888
  ds_read_b64_tr_b16 a[168:169], v104 offset:40960
  ds_read_b64_tr_b16 a[170:171], v104 offset:41984
  ds_read_b64_tr_b16 a[172:173], v104 offset:45056
  ds_read_b64_tr_b16 a[174:175], v104 offset:46080
  ds_read_b64_tr_b16 a[176:177], v104 offset:49152
  ds_read_b64_tr_b16 a[178:179], v104 offset:50176
  ds_read_b64_tr_b16 a[180:181], v104 offset:53248
  ds_read_b64_tr_b16 a[182:183], v104 offset:54272
  ds_read_b64_tr_b16 a[184:185], v104 offset:57344
  ds_read_b64_tr_b16 a[186:187], v104 offset:58368
  ds_read_b64_tr_b16 a[188:189], v104 offset:61440
  ds_read_b64_tr_b16 a[190:191], v104 offset:62464
  s_waitcnt lgkmcnt(0)
  v_mfma_f32_32x32x16_bf16 v[48:63], v[80:83], a[160:163], v[48:63]
  v_mfma_f32_32x32x16_bf16 v[48:63], v[80:83], a[164:167], v[48:63]
  v_mfma_f32_32x32x16_bf16 v[48:63], v[80:83], a[168:171], v[48:63]
  v_mfma_f32_32x32x16_bf16 v[48:63], v[80:83], a[172:175], v[48:63]
  v_mfma_f32_32x32x16_bf16 v[48:63], v[80:83], a[176:179], v[48:63]
  v_mfma_f32_32x32x16_bf16 v[48:63], v[80:83], a[180:183], v[48:63]
  v_mfma_f32_32x32x16_bf16 v[48:63], v[80:83], a[184:187], v[48:63]
  v_mfma_f32_32x32x16_bf16 v[48:63], v[80:83], a[188:191], v[48:63]
  s_waitcnt vmcnt(16)
  s_barrier
  s_lshl_b32 s61, s36, 8
  s_add_u32 s61, s61, 1048576
  s_add_u32 s61, s61, s63
  s_add_u32 m0, s60, 32768
  s_add_u32 s62, s61, 0
  buffer_load_dwordx4 v100, s[24:27], s62 offen lds
  s_add_u32 m0, s60, 33792
  s_add_u32 s62, s61, 32768
  buffer_load_dwordx4 v100, s[24:27], s62 offen lds
  s_add_u32 m0, s60, 34816
  s_add_u32 s62, s61, 65536
  buffer_load_dwordx4 v100, s[24:27], s62 offen lds
  s_add_u32 m0, s60, 35840
  s_add_u32 s62, s61, 98304
  buffer_load_dwordx4 v100, s[24:27], s62 offen lds
  s_add_u32 m0, s60, 36864
  s_add_u32 s62, s61, 131072
  buffer_load_dwordx4 v100, s[24:27], s62 offen lds
  s_add_u32 m0, s60, 37888
  s_add_u32 s62, s61, 163840
  buffer_load_dwordx4 v100, s[24:27], s62 offen lds
  s_add_u32 m0, s60, 38912
  s_add_u32 s62, s61, 196608
  buffer_load_dwordx4 v100, s[24:27], s62 offen lds
  s_add_u32 m0, s60, 39936
  s_add_u32 s62, s61, 229376
  buffer_load_dwordx4 v100, s[24:27], s62 offen lds
  ds_read_b64_tr_b16 a[192:193], v105 offset:0
  ds_read_b64_tr_b16 a[194:195], v105 offset:1024
  ds_read_b64_tr_b16 a[196:197], v105 offset:4096
  ds_read_b64_tr_b16 a[198:199], v105 offset:5120
  ds_read_b64_tr_b16 a[200:201], v105 offset:8192
  ds_read_b64_tr_b16 a[202:203], v105 offset:9216
  ds_read_b64_tr_b16 a[204:205], v105 offset:12288
  ds_read_b64_tr_b16 a[206:207], v105 offset:13312
  ds_read_b64_tr_b16 a[208:209], v105 offset:16384
  ds_read_b64_tr_b16 a[210:211], v105 offset:17408
  ds_read_b64_tr_b16 a[212:213], v105 offset:20480
  ds_read_b64_tr_b16 a[214:215], v105 offset:21504
  ds_read_b64_tr_b16 a[216:217], v105 offset:24576
  ds_read_b64_tr_b16 a[218:219], v105 offset:25600
  ds_read_b64_tr_b16 a[220:221], v105 offset:28672
  ds_read_b64_tr_b16 a[222:223], v105 offset:29696
  s_waitcnt lgkmcnt(0)
  v_mfma_f32_32x32x16_bf16 v[48:63], v[80:83], a[192:195], v[48:63]
  v_mfma_f32_32x32x16_bf16 v[48:63], v[80:83], a[196:199], v[48:63]
  v_mfma_f32_32x32x16_bf16 v[48:63], v[80:83], a[200:203], v[48:63]
  v_mfma_f32_32x32x16_bf16 v[48:63], v[80:83], a[204:207], v[48:63]
  v_mfma_f32_32x32x16_bf16 v[48:63], v[80:83], a[208:211], v[48:63]
  v_mfma_f32_32x32x16_bf16 v[48:63], v[80:83], a[212:215], v[48:63]
  v_mfma_f32_32x32x16_bf16 v[48:63], v[80:83], a[216:219], v[48:63]
  v_mfma_f32_32x32x16_bf16 v[48:63], v[80:83], a[220:223], v[48:63]
  s_waitcnt vmcnt(16)
  s_barrier
  s_lshl_b32 s61, s36, 8
  s_add_u32 s61, s61, 2097152
  s_add_u32 s61, s61, s63
  s_add_u32 m0, s60, 65536
  s_add_u32 s62, s61, 0
  buffer_load_dwordx4 v100, s[24:27], s62 offen lds
  s_add_u32 m0, s60, 66560
  s_add_u32 s62, s61, 32768
  buffer_load_dwordx4 v100, s[24:27], s62 offen lds
  s_add_u32 m0, s60, 67584
  s_add_u32 s62, s61, 65536
  buffer_load_dwordx4 v100, s[24:27], s62 offen lds
  s_add_u32 m0, s60, 68608
  s_add_u32 s62, s61, 98304
  buffer_load_dwordx4 v100, s[24:27], s62 offen lds
  s_add_u32 m0, s60, 69632
  s_add_u32 s62, s61, 131072
  buffer_load_dwordx4 v100, s[24:27], s62 offen lds
  s_add_u32 m0, s60, 70656
  s_add_u32 s62, s61, 163840
  buffer_load_dwordx4 v100, s[24:27], s62 offen lds
  s_add_u32 m0, s60, 71680
  s_add_u32 s62, s61, 196608
  buffer_load_dwordx4 v100, s[24:27], s62 offen lds
  s_add_u32 m0, s60, 72704
  s_add_u32 s62, s61, 229376
  buffer_load_dwordx4 v100, s[24:27], s62 offen lds
  ds_read_b64_tr_b16 a[224:225], v105 offset:32768
  ds_read_b64_tr_b16 a[226:227], v105 offset:33792
  ds_read_b64_tr_b16 a[228:229], v105 offset:36864
  ds_read_b64_tr_b16 a[230:231], v105 offset:37888
  ds_read_b64_tr_b16 a[232:233], v105 offset:40960
  ds_read_b64_tr_b16 a[234:235], v105 offset:41984
  ds_read_b64_tr_b16 a[236:237], v105 offset:45056
  ds_read_b64_tr_b16 a[238:239], v105 offset:46080
  ds_read_b64_tr_b16 a[240:241], v105 offset:49152
  ds_read_b64_tr_b16 a[242:243], v105 offset:50176
  ds_read_b64_tr_b16 a[244:245], v105 offset:53248
  ds_read_b64_tr_b16 a[246:247], v105 offset:54272
  ds_read_b64_tr_b16 a[248:249], v105 offset:57344
  ds_read_b64_tr_b16 a[250:251], v105 offset:58368
  ds_read_b64_tr_b16 a[252:253], v105 offset:61440
  ds_read_b64_tr_b16 a[254:255], v105 offset:62464
  s_waitcnt lgkmcnt(0)
  v_mfma_f32_32x32x16_bf16 v[48:63], v[80:83], a[224:227], v[48:63]
  v_mfma_f32_32x32x16_bf16 v[48:63], v[80:83], a[228:231], v[48:63]
  v_mfma_f32_32x32x16_bf16 v[48:63], v[80:83], a[232:235], v[48:63]
  v_mfma_f32_32x32x16_bf16 v[48:63], v[80:83], a[236:239], v[48:63]
  v_mfma_f32_32x32x16_bf16 v[48:63], v[80:83], a[240:243], v[48:63]
  v_mfma_f32_32x32x16_bf16 v[48:63], v[80:83], a[244:247], v[48:63]
  v_mfma_f32_32x32x16_bf16 v[48:63], v[80:83], a[248:251], v[48:63]
  v_mfma_f32_32x32x16_bf16 v[48:63], v[80:83], a[252:255], v[48:63]
  s_waitcnt vmcnt(16)
  s_barrier
  s_lshl_b32 s61, s36, 8
  s_add_u32 s61, s61, 3145728
  s_add_u32 s61, s61, s63
  s_add_u32 m0, s60, 98304
  s_add_u32 s62, s61, 0
  buffer_load_dwordx4 v100, s[24:27], s62 offen lds
  s_add_u32 m0, s60, 99328
  s_add_u32 s62, s61, 32768
  buffer_load_dwordx4 v100, s[24:27], s62 offen lds
  s_add_u32 m0, s60, 100352
  s_add_u32 s62, s61, 65536
  buffer_load_dwordx4 v100, s[24:27], s62 offen lds
  s_add_u32 m0, s60, 101376
  s_add_u32 s62, s61, 98304
  buffer_load_dwordx4 v100, s[24:27], s62 offen lds
  s_add_u32 m0, s60, 102400
  s_add_u32 s62, s61, 131072
  buffer_load_dwordx4 v100, s[24:27], s62 offen lds
  s_add_u32 m0, s60, 103424
  s_add_u32 s62, s61, 163840
  buffer_load_dwordx4 v100, s[24:27], s62 offen lds
  s_add_u32 m0, s60, 104448
  s_add_u32 s62, s61, 196608
  buffer_load_dwordx4 v100, s[24:27], s62 offen lds
  s_add_u32 m0, s60, 105472
  s_add_u32 s62, s61, 229376
  buffer_load_dwordx4 v100, s[24:27], s62 offen lds
  ds_read_b64_tr_b16 v[128:129], v104 offset:0
  ds_read_b64_tr_b16 v[130:131], v104 offset:1024
  ds_read_b64_tr_b16 v[132:133], v104 offset:4096
  ds_read_b64_tr_b16 v[134:135], v104 offset:5120
  ds_read_b64_tr_b16 v[136:137], v104 offset:8192
  ds_read_b64_tr_b16 v[138:139], v104 offset:9216
  ds_read_b64_tr_b16 v[140:141], v104 offset:12288
  ds_read_b64_tr_b16 v[142:143], v104 offset:13312
  ds_read_b64_tr_b16 v[144:145], v104 offset:16384
  ds_read_b64_tr_b16 v[146:147], v104 offset:17408
  ds_read_b64_tr_b16 v[148:149], v104 offset:20480
  ds_read_b64_tr_b16 v[150:151], v104 offset:21504
  ds_read_b64_tr_b16 v[152:153], v104 offset:24576
  ds_read_b64_tr_b16 v[154:155], v104 offset:25600
  ds_read_b64_tr_b16 v[156:157], v104 offset:28672
  ds_read_b64_tr_b16 v[158:159], v104 offset:29696
  s_waitcnt lgkmcnt(0)
  v_mfma_f32_32x32x16_bf16 v[64:79], v[80:83], v[128:131], 0
  v_mfma_f32_32x32x16_bf16 v[64:79], v[80:83], v[132:135], v[64:79]
  v_mfma_f32_32x32x16_bf16 v[64:79], v[80:83], v[136:139], v[64:79]
  v_mfma_f32_32x32x16_bf16 v[64:79], v[80:83], v[140:143], v[64:79]
  v_mfma_f32_32x32x16_bf16 v[64:79], v[80:83], v[144:147], v[64:79]
  v_mfma_f32_32x32x16_bf16 v[64:79], v[80:83], v[148:151], v[64:79]
  v_mfma_f32_32x32x16_bf16 v[64:79], v[80:83], v[152:155], v[64:79]
  v_mfma_f32_32x32x16_bf16 v[64:79], v[80:83], v[156:159], v[64:79]
  s_waitcnt vmcnt(16)
  s_barrier
  ds_read_b64_tr_b16 v[160:161], v104 offset:32768
  ds_read_b64_tr_b16 v[162:163], v104 offset:33792
  ds_read_b64_tr_b16 v[164:165], v104 offset:36864
  ds_read_b64_tr_b16 v[166:167], v104 offset:37888
  ds_read_b64_tr_b16 v[168:169], v104 offset:40960
  ds_read_b64_tr_b16 v[170:171], v104 offset:41984
  ds_read_b64_tr_b16 v[172:173], v104 offset:45056
  ds_read_b64_tr_b16 v[174:175], v104 offset:46080
  ds_read_b64_tr_b16 v[176:177], v104 offset:49152
  ds_read_b64_tr_b16 v[178:179], v104 offset:50176
  ds_read_b64_tr_b16 v[180:181], v104 offset:53248
  ds_read_b64_tr_b16 v[182:183], v104 offset:54272
  ds_read_b64_tr_b16 v[184:185], v104 offset:57344
  ds_read_b64_tr_b16 v[186:187], v104 offset:58368
  ds_read_b64_tr_b16 v[188:189], v104 offset:61440
  ds_read_b64_tr_b16 v[190:191], v104 offset:62464
  s_waitcnt lgkmcnt(0)
  v_mfma_f32_32x32x16_bf16 v[64:79], v[80:83], v[160:163], v[64:79]
  v_mfma_f32_32x32x16_bf16 v[64:79], v[80:83], v[164:167], v[64:79]
  v_mfma_f32_32x32x16_bf16 v[64:79], v[80:83], v[168:171], v[64:79]
  v_mfma_f32_32x32x16_bf16 v[64:79], v[80:83], v[172:175], v[64:79]
  v_mfma_f32_32x32x16_bf16 v[64:79], v[80:83], v[176:179], v[64:79]
  v_mfma_f32_32x32x16_bf16 v[64:79], v[80:83], v[180:183], v[64:79]
  v_mfma_f32_32x32x16_bf16 v[64:79], v[80:83], v[184:187], v[64:79]
  v_mfma_f32_32x32x16_bf16 v[64:79], v[80:83], v[188:191], v[64:79]
  s_waitcnt vmcnt(8)
  s_barrier
  ds_read_b64_tr_b16 v[192:193], v105 offset:0
  ds_read_b64_tr_b16 v[194:195], v105 offset:1024
  ds_read_b64_tr_b16 v[196:197], v105 offset:4096
  ds_read_b64_tr_b16 v[198:199], v105 offset:5120
  ds_read_b64_tr_b16 v[200:201], v105 offset:8192
  ds_read_b64_tr_b16 v[202:203], v105 offset:9216
  ds_read_b64_tr_b16 v[204:205], v105 offset:12288
  ds_read_b64_tr_b16 v[206:207], v105 offset:13312
  ds_read_b64_tr_b16 v[208:209], v105 offset:16384
  ds_read_b64_tr_b16 v[210:211], v105 offset:17408
  ds_read_b64_tr_b16 v[212:213], v105 offset:20480
  ds_read_b64_tr_b16 v[214:215], v105 offset:21504
  ds_read_b64_tr_b16 v[216:217], v105 offset:24576
  ds_read_b64_tr_b16 v[218:219], v105 offset:25600
  ds_read_b64_tr_b16 v[220:221], v105 offset:28672
  ds_read_b64_tr_b16 v[222:223], v105 offset:29696
  s_waitcnt lgkmcnt(0)
  v_mfma_f32_32x32x16_bf16 v[64:79], v[80:83], v[192:195], v[64:79]
  v_mfma_f32_32x32x16_bf16 v[64:79], v[80:83], v[196:199], v[64:79]
  v_mfma_f32_32x32x16_bf16 v[64:79], v[80:83], v[200:203], v[64:79]
  v_mfma_f32_32x32x16_bf16 v[64:79], v[80:83], v[204:207], v[64:79]
  v_mfma_f32_32x32x16_bf16 v[64:79], v[80:83], v[208:211], v[64:79]
  v_mfma_f32_32x32x16_bf16 v[64:79], v[80:83], v[212:215], v[64:79]
  v_mfma_f32_32x32x16_bf16 v[64:79], v[80:83], v[216:219], v[64:79]
  v_mfma_f32_32x32x16_bf16 v[64:79], v[80:83], v[220:223], v[64:79]
  s_waitcnt vmcnt(0)
  s_barrier
  ds_read_b64_tr_b16 v[224:225], v105 offset:32768
  ds_read_b64_tr_b16 v[226:227], v105 offset:33792
  ds_read_b64_tr_b16 v[228:229], v105 offset:36864
  ds_read_b64_tr_b16 v[230:231], v105 offset:37888
  ds_read_b64_tr_b16 v[232:233], v105 offset:40960
  ds_read_b64_tr_b16 v[234:235], v105 offset:41984
  ds_read_b64_tr_b16 v[236:237], v105 offset:45056
  ds_read_b64_tr_b16 v[238:239], v105 offset:46080
  ds_read_b64_tr_b16 v[240:241], v105 offset:49152
  ds_read_b64_tr_b16 v[242:243], v105 offset:50176
  ds_read_b64_tr_b16 v[244:245], v105 offset:53248
  ds_read_b64_tr_b16 v[246:247], v105 offset:54272
  ds_read_b64_tr_b16 v[248:249], v105 offset:57344
  ds_read_b64_tr_b16 v[250:251], v105 offset:58368
  ds_read_b64_tr_b16 v[252:253], v105 offset:61440
  ds_read_b64_tr_b16 v[254:255], v105 offset:62464
  s_waitcnt lgkmcnt(0)
  v_mfma_f32_32x32x16_bf16 v[64:79], v[80:83], v[224:227], v[64:79]
  v_mfma_f32_32x32x16_bf16 v[64:79], v[80:83], v[228:231], v[64:79]
  v_mfma_f32_32x32x16_bf16 v[64:79], v[80:83], v[232:235], v[64:79]
  v_mfma_f32_32x32x16_bf16 v[64:79], v[80:83], v[236:239], v[64:79]
  v_mfma_f32_32x32x16_bf16 v[64:79], v[80:83], v[240:243], v[64:79]
  v_mfma_f32_32x32x16_bf16 v[64:79], v[80:83], v[244:247], v[64:79]
  v_mfma_f32_32x32x16_bf16 v[64:79], v[80:83], v[248:251], v[64:79]
  v_mfma_f32_32x32x16_bf16 v[64:79], v[80:83], v[252:255], v[64:79]
  s_barrier
  v_bfe_u32 v16, v0, 4, 4
  v_lshrrev_b32 v17, 8, v0
  v_lshrrev_b32 v114, 2, v0
  v_bfe_u32 v18, v0, 6, 2
  v_lshrrev_b32 v19, 9, v0
  v_lshl_or_b32 v18, v19, 3, v18
  v_lshlrev_b32 v18, 6, v18
  v_and_b32 v20, 1, v17
  v_lshl_or_b32 v18, v20, 5, v18
  v_and_b32 v20, 3, v16
  v_lshl_or_b32 v1, v20, 3, v18
  v_and_b32 v18, 7, v16
  v_lshrrev_b32 v20, 3, v16
  v_lshl_or_b32 v18, v20, 4, v18
  v_lshlrev_b32 v18, 4, v18
  v_lshl_add_u32 v18, v17, 9, v18
  v_add_u32 v2, 73728, v18
  s_and_b32 s6, s3, 1
  s_lshl_b32 s6, s6, 8
  v_lshlrev_b32 v18, 4, v16
  v_lshl_or_b32 v18, v17, 9, v18
  v_add_u32 v113, s6, v18
  v_add_u32 v3, 65536, v113
  s_lshr_b32 s7, s3, 1
  s_lshl_b32 s6, s7, 12
  s_add_u32 s6, s6, 81920
  v_add_u32 v4, s6, v18
  s_lshl_b32 s6, s3, 11
  s_add_u32 s6, s6, 32768
  v_add_u32 v112, s6, v0
  v_mul_u32_u24 v18, 1088, v17
  v_lshl_add_u32 v18, v16, 3, v18
  s_lshl_b32 s6, s3, 8
  s_add_u32 s6, s6, 57344
  v_add_u32 v5, s6, v18
  s_lshl_b32 s6, s7, 9
  s_add_u32 s6, s6, 57344
  v_add_u32 v7, s6, v18
  v_and_b32 v18, 3, v16
  v_mul_u32_u24 v18, 1088, v18
  v_bfe_u32 v20, v0, 6, 3
  v_lshl_add_u32 v18, v20, 3, v18
  v_lshl_add_u32 v18, v19, 7, v18
  v_add_u32 v6, 57344, v18
  s_lshl_b32 s6, s3, 7
  s_add_u32 s6, s6, 61952
  v_lshlrev_b32 v18, 4, v19
  v_add_u32 v8, s6, v18
  v_and_b32 v18, 0x7c, v114
  v_add_u32 v9, s6, v18
  v_lshlrev_b32 v18, 1, v18
  v_add_u32 v15, 62464, v18
  s_lshl_b32 s6, s3, 13
  v_add_u32 v14, s6, v1
  v_mov_b32 v10, 0x3f803f80
  v_mov_b32 v11, 0x3f803f80
  s_and_b32 s6, s3, 1
  s_lshl_b32 s6, s6, 4
  v_add_u32 v16, s6, v16
  v_lshlrev_b32 v18, 4, v19
  v_and_b32 v20, 1, v17
  v_lshl_or_b32 v18, v20, 2, v18
  v_sub_u32 v16, v16, v18
  v_mov_b32 v17, 0xf149f2ca
  v_cmp_gt_i32 vcc, 0, v16
  s_nop 1
  v_cndmask_b32 v24, 0, v17, vcc
  v_cmp_gt_i32 vcc, 1, v16
  s_nop 1
  v_cndmask_b32 v25, 0, v17, vcc
  v_cmp_gt_i32 vcc, 2, v16
  s_nop 1
  v_cndmask_b32 v26, 0, v17, vcc
  v_cmp_gt_i32 vcc, 3, v16
  s_nop 1
  v_cndmask_b32 v27, 0, v17, vcc
  v_cmp_gt_i32 vcc, 8, v16
  s_nop 1
  v_cndmask_b32 v28, 0, v17, vcc
  v_cmp_gt_i32 vcc, 9, v16
  s_nop 1
  v_cndmask_b32 v29, 0, v17, vcc
  v_cmp_gt_i32 vcc, 10, v16
  s_nop 1
  v_cndmask_b32 v30, 0, v17, vcc
  v_cmp_gt_i32 vcc, 11, v16
  s_nop 1
  v_cndmask_b32 v31, 0, v17, vcc
  v_cmp_gt_u32 vcc, 512, v0
  v_cvt_pk_bf16_f32 v33, v32, v32
  v_and_b32 v33, 0xffff0000, v33
  v_sub_f32 v32, v32, v33
  v_cvt_pk_bf16_f32 v32, v32, v33
  v_cndmask_b32 v16, 0, v32, vcc
  v_cvt_pk_bf16_f32 v49, v48, v48
  v_and_b32 v49, 0xffff0000, v49
  v_sub_f32 v48, v48, v49
  v_cvt_pk_bf16_f32 v48, v48, v49
  v_cndmask_b32 v17, 0, v48, vcc
  v_cvt_pk_bf16_f32 v65, v64, v64
  v_and_b32 v65, 0xffff0000, v65
  v_sub_f32 v64, v64, v65
  v_cvt_pk_bf16_f32 v64, v64, v65
  v_cndmask_b32 v18, 0, v64, vcc
  v_mov_b32 v19, 0
  v_mov_b32 v21, 0
  v_mov_b32 v22, 0
  s_mov_b32 s7, 0
  v_mbcnt_lo_u32_b32 v92, -1, 0
  v_and_b32 v92, 3, v92
  v_lshlrev_b32 v92, 6, v92
L_wd_86:
  buffer_load_dword v93, v92, s[12:15], 0 offen offset:16 sc1
  s_waitcnt vmcnt(0)
  v_cmp_ne_u32 vcc, 64, v93
  s_cbranch_vccz L_wdo_87
  s_add_u32 s7, s7, 1
  s_cmp_lt_u32 s7, 131072
  s_cbranch_scc1 L_wd_86
  s_mov_b32 s6, 20
  s_branch L_err
L_wdo_87:
  s_mov_b32 s32, 0
  s_mov_b32 s52, 0
  s_mov_b32 s33, s37
  s_add_u32 s49, s33, 1
  s_cmp_lg_u32 s35, 0
  s_cbranch_scc1 L_p1_88
  s_mov_b32 s7, 0
L_pl_89:
  buffer_load_dwordx4 v[32:35], v0, s[8:11], s44 offen offset:0 sc1
  buffer_load_dwordx4 v[36:39], v0, s[8:11], s44 offen offset:1024 sc1
  s_waitcnt vmcnt(0)
  v_min3_u32 v32, v32, v33, v34
  v_min3_u32 v35, v35, v36, v37
  v_min3_u32 v32, v32, v38, v39
  v_min_u32 v32, v32, v35
  v_cmp_gt_u32 vcc, s49, v32
  s_cbranch_vccz L_plo_90
  s_add_u32 s7, s7, 1
  s_cmp_lt_u32 s7, 131072
  s_cbranch_scc1 L_pl_89
  s_mov_b32 s6, 21
  s_branch L_err
L_plo_90:
L_p1_88:
L_p_xwait:
  s_mov_b32 s7, 0
L_pl_91:
  buffer_load_dword v92, v114, s[8:11], s44 offen offset:0 sc1
  s_waitcnt vmcnt(0)
  v_cmp_gt_u32 vcc, s49, v92
  s_cbranch_vccz L_plo_92
  s_add_u32 s7, s7, 1
  s_cmp_lt_u32 s7, 131072
  s_cbranch_scc1 L_pl_91
  s_mov_b32 s6, 22
  s_branch L_err
L_plo_92:
  s_sub_u32 s6, s49, 1
  s_lshl_b32 s6, s6, 15
  s_add_u32 s45, s38, s6
  s_mov_b32 m0, s53
  s_add_u32 s6, s45, 4096
  buffer_load_dwordx4 v0, s[8:11], s45 offen offset:0 lds
  buffer_load_dwordx4 v0, s[8:11], s45 offen offset:1024 lds
  buffer_load_dwordx4 v0, s[8:11], s45 offen offset:2048 lds
  buffer_load_dwordx4 v0, s[8:11], s45 offen offset:3072 lds
  s_add_u32 m0, s53, 4096
  s_nop 0
  buffer_load_dwordx4 v0, s[8:11], s6 offen offset:0 lds
  buffer_load_dwordx4 v0, s[8:11], s6 offen offset:1024 lds
  buffer_load_dwordx4 v0, s[8:11], s6 offen offset:2048 lds
  buffer_load_dwordx4 v0, s[8:11], s6 offen offset:3072 lds
  s_waitcnt vmcnt(0)
L_p_loop:
  s_barrier
  s_and_b32 s6, s33, 3
  s_lshl_b32 s6, s6, 19
  s_add_u32 s46, s39, s6
  s_lshr_b32 s6, s33, 2
  s_andn2_b32 s42, 1, s6
  s_add_u32 s49, s33, 3
  s_lshl_b32 s7, s3, 8
  ds_read_b64_tr_b16 v[80:81], v1 offset:0
  ds_read_b64_tr_b16 v[82:83], v1 offset:256
  ds_read_b64_tr_b16 v[84:85], v1 offset:1024
  ds_read_b64_tr_b16 v[86:87], v1 offset:1280
  ds_read_b64_tr_b16 v[96:97], v14 offset:0
  ds_read_b64_tr_b16 v[98:99], v14 offset:256
  v_mov_b32 v92, 0
  v_mov_b32 v93, 0
  v_add_u32 v108, s7, v15
  s_waitcnt lgkmcnt(4)
  v_mfma_f32_32x32x16_bf16 v[48:63], a[128:131], v[80:83], 0
  ds_read_b64_tr_b16 v[88:89], v1 offset:2048
  ds_read_b64_tr_b16 v[90:91], v1 offset:2304
  s_waitcnt lgkmcnt(2)
  ds_read_b64_tr_b16 v[100:101], v14 offset:1024
  ds_read_b64_tr_b16 v[102:103], v14 offset:1280
  v_lshlrev_b32 v104, 16, v96
  v_mfma_f32_32x32x16_bf16 v[64:79], v[80:83], v[128:131], 0
  v_and_b32 v105, 0xffff0000, v96
  v_add_f32 v92, v92, v104
  v_fmac_f32 v93, v104, v104
  v_add_f32 v92, v92, v105
  v_mfma_f32_32x32x16_bf16 v[32:47], a[0:3], v[80:83], 0
  v_fmac_f32 v93, v105, v105
  v_lshlrev_b32 v106, 16, v97
  v_and_b32 v107, 0xffff0000, v97
  v_mfma_f32_32x32x16_bf16 v[48:63], a[132:135], v[84:87], v[48:63]
  ds_read_b64_tr_b16 v[80:81], v1 offset:3072
  ds_read_b64_tr_b16 v[82:83], v1 offset:3328
  v_add_f32 v92, v92, v106
  v_mfma_f32_32x32x16_bf16 v[64:79], v[84:87], v[132:135], v[64:79]
  v_fmac_f32 v93, v106, v106
  v_add_f32 v92, v92, v107
  v_fmac_f32 v93, v107, v107
  v_lshlrev_b32 v104, 16, v98
  v_mfma_f32_32x32x16_bf16 v[32:47], a[4:7], v[84:87], v[32:47]
  v_and_b32 v105, 0xffff0000, v98
  v_add_f32 v92, v92, v104
  v_fmac_f32 v93, v104, v104
  s_waitcnt lgkmcnt(4)
  v_mfma_f32_32x32x16_bf16 v[48:63], a[136:139], v[88:91], v[48:63]
  ds_read_b64_tr_b16 v[84:85], v1 offset:4096
  ds_read_b64_tr_b16 v[86:87], v1 offset:4352
  v_add_f32 v92, v92, v105
  v_mfma_f32_32x32x16_bf16 v[64:79], v[88:91], v[136:139], v[64:79]
  v_fmac_f32 v93, v105, v105
  v_lshlrev_b32 v106, 16, v99
  v_and_b32 v107, 0xffff0000, v99
  v_add_f32 v92, v92, v106
  v_mfma_f32_32x32x16_bf16 v[32:47], a[8:11], v[88:91], v[32:47]
  v_fmac_f32 v93, v106, v106
  v_add_f32 v92, v92, v107
  v_fmac_f32 v93, v107, v107
  s_waitcnt lgkmcnt(2)
  v_mfma_f32_32x32x16_bf16 v[48:63], a[140:143], v[80:83], v[48:63]
  ds_read_b64_tr_b16 v[88:89], v1 offset:5120
  ds_read_b64_tr_b16 v[90:91], v1 offset:5376
  ds_read_b64_tr_b16 v[96:97], v14 offset:2048
  ds_read_b64_tr_b16 v[98:99], v14 offset:2304
  v_lshlrev_b32 v104, 16, v100
  v_mfma_f32_32x32x16_bf16 v[64:79], v[80:83], v[140:143], v[64:79]
  v_and_b32 v105, 0xffff0000, v100
  v_add_f32 v92, v92, v104
  v_fmac_f32 v93, v104, v104
  v_add_f32 v92, v92, v105
  v_mfma_f32_32x32x16_bf16 v[32:47], a[12:15], v[80:83], v[32:47]
  v_fmac_f32 v93, v105, v105
  v_lshlrev_b32 v106, 16, v101
  v_and_b32 v107, 0xffff0000, v101
  s_waitcnt lgkmcnt(4)
  v_mfma_f32_32x32x16_bf16 v[48:63], a[144:147], v[84:87], v[48:63]
  ds_read_b64_tr_b16 v[80:81], v1 offset:6144
  ds_read_b64_tr_b16 v[82:83], v1 offset:6400
  v_add_f32 v92, v92, v106
  v_mfma_f32_32x32x16_bf16 v[64:79], v[84:87], v[144:147], v[64:79]
  v_fmac_f32 v93, v106, v106
  v_add_f32 v92, v92, v107
  v_fmac_f32 v93, v107, v107
  v_lshlrev_b32 v104, 16, v102
  v_mfma_f32_32x32x16_bf16 v[32:47], a[16:19], v[84:87], v[32:47]
  v_and_b32 v105, 0xffff0000, v102
  v_add_f32 v92, v92, v104
  v_fmac_f32 v93, v104, v104
  s_cmp_eq_u32 s52, 2
  s_cbranch_scc0 L_p_nof
  s_waitcnt vmcnt(0)
  s_mov_b64 exec, 1
  buffer_store_dword v126, v13, s[8:11], s43 offen sc1
  s_mov_b64 exec, -1
L_p_nof:
  s_waitcnt lgkmcnt(4)
  v_mfma_f32_32x32x16_bf16 v[48:63], a[148:151], v[88:91], v[48:63]
  ds_read_b64_tr_b16 v[84:85], v1 offset:7168
  ds_read_b64_tr_b16 v[86:87], v1 offset:7424
  v_add_f32 v92, v92, v105
  v_mfma_f32_32x32x16_bf16 v[64:79], v[88:91], v[148:151], v[64:79]
  v_fmac_f32 v93, v105, v105
  v_lshlrev_b32 v106, 16, v103
  v_and_b32 v107, 0xffff0000, v103
  v_add_f32 v92, v92, v106
  v_mfma_f32_32x32x16_bf16 v[32:47], a[20:23], v[88:91], v[32:47]
  v_fmac_f32 v93, v106, v106
  v_add_f32 v92, v92, v107
  v_fmac_f32 v93, v107, v107
  s_waitcnt lgkmcnt(2)
  v_mfma_f32_32x32x16_bf16 v[48:63], a[152:155], v[80:83], v[48:63]
  ds_read_b64_tr_b16 v[88:89], v1 offset:8192
  ds_read_b64_tr_b16 v[90:91], v1 offset:8448
  ds_read_b64_tr_b16 v[100:101], v14 offset:3072
  ds_read_b64_tr_b16 v[102:103], v14 offset:3328
  v_lshlrev_b32 v104, 16, v96
  v_mfma_f32_32x32x16_bf16 v[64:79], v[80:83], v[152:155], v[64:79]
  v_and_b32 v105, 0xffff0000, v96
  v_add_f32 v92, v92, v104
  v_fmac_f32 v93, v104, v104
  v_add_f32 v92, v92, v105
  v_mfma_f32_32x32x16_bf16 v[32:47], a[24:27], v[80:83], v[32:47]
  v_fmac_f32 v93, v105, v105
  v_lshlrev_b32 v106, 16, v97
  v_and_b32 v107, 0xffff0000, v97
  s_waitcnt lgkmcnt(4)
  v_mfma_f32_32x32x16_bf16 v[48:63], a[156:159], v[84:87], v[48:63]
  ds_read_b64_tr_b16 v[80:81], v1 offset:9216
  ds_read_b64_tr_b16 v[82:83], v1 offset:9472
  v_add_f32 v92, v92, v106
  v_mfma_f32_32x32x16_bf16 v[64:79], v[84:87], v[156:159], v[64:79]
  v_fmac_f32 v93, v106, v106
  v_add_f32 v92, v92, v107
  v_fmac_f32 v93, v107, v107
  v_lshlrev_b32 v104, 16, v98
  v_mfma_f32_32x32x16_bf16 v[32:47], a[28:31], v[84:87], v[32:47]
  v_and_b32 v105, 0xffff0000, v98
  v_add_f32 v92, v92, v104
  v_fmac_f32 v93, v104, v104
  s_waitcnt lgkmcnt(4)
  v_mfma_f32_32x32x16_bf16 v[48:63], a[160:163], v[88:91], v[48:63]
  ds_read_b64_tr_b16 v[84:85], v1 offset:10240
  ds_read_b64_tr_b16 v[86:87], v1 offset:10496
  v_add_f32 v92, v92, v105
  v_mfma_f32_32x32x16_bf16 v[64:79], v[88:91], v[160:163], v[64:79]
  v_fmac_f32 v93, v105, v105
  v_lshlrev_b32 v106, 16, v99
  v_and_b32 v107, 0xffff0000, v99
  v_add_f32 v92, v92, v106
  v_mfma_f32_32x32x16_bf16 v[32:47], a[32:35], v[88:91], v[32:47]
  v_fmac_f32 v93, v106, v106
  v_add_f32 v92, v92, v107
  v_fmac_f32 v93, v107, v107
  s_waitcnt lgkmcnt(2)
  v_mfma_f32_32x32x16_bf16 v[48:63], a[164:167], v[80:83], v[48:63]
  ds_read_b64_tr_b16 v[88:89], v1 offset:11264
  ds_read_b64_tr_b16 v[90:91], v1 offset:11520
  ds_read_b64_tr_b16 v[96:97], v14 offset:4096
  ds_read_b64_tr_b16 v[98:99], v14 offset:4352
  v_lshlrev_b32 v104, 16, v100
  v_mfma_f32_32x32x16_bf16 v[64:79], v[80:83], v[164:167], v[64:79]
  v_and_b32 v105, 0xffff0000, v100
  v_add_f32 v92, v92, v104
  v_fmac_f32 v93, v104, v104
  v_add_f32 v92, v92, v105
  v_mfma_f32_32x32x16_bf16 v[32:47], a[36:39], v[80:83], v[32:47]
  v_fmac_f32 v93, v105, v105
  v_lshlrev_b32 v106, 16, v101
  v_and_b32 v107, 0xffff0000, v101
  s_waitcnt lgkmcnt(4)
  v_mfma_f32_32x32x16_bf16 v[48:63], a[168:171], v[84:87], v[48:63]
  ds_read_b64_tr_b16 v[80:81], v1 offset:12288
  ds_read_b64_tr_b16 v[82:83], v1 offset:12544
  v_add_f32 v92, v92, v106
  v_mfma_f32_32x32x16_bf16 v[64:79], v[84:87], v[168:171], v[64:79]
  v_fmac_f32 v93, v106, v106
  v_add_f32 v92, v92, v107
  v_fmac_f32 v93, v107, v107
  v_lshlrev_b32 v104, 16, v102
  v_mfma_f32_32x32x16_bf16 v[32:47], a[40:43], v[84:87], v[32:47]
  v_and_b32 v105, 0xffff0000, v102
  v_add_f32 v92, v92, v104
  v_fmac_f32 v93, v104, v104
  s_waitcnt lgkmcnt(4)
  v_mfma_f32_32x32x16_bf16 v[48:63], a[172:175], v[88:91], v[48:63]
  ds_read_b64_tr_b16 v[84:85], v1 offset:13312
  ds_read_b64_tr_b16 v[86:87], v1 offset:13568
  v_add_f32 v92, v92, v105
  v_mfma_f32_32x32x16_bf16 v[64:79], v[88:91], v[172:175], v[64:79]
  v_fmac_f32 v93, v105, v105
  v_lshlrev_b32 v106, 16, v103
  v_and_b32 v107, 0xffff0000, v103
  v_add_f32 v92, v92, v106
  v_mfma_f32_32x32x16_bf16 v[32:47], a[44:47], v[88:91], v[32:47]
  v_fmac_f32 v93, v106, v106
  v_add_f32 v92, v92, v107
  v_fmac_f32 v93, v107, v107
  s_waitcnt lgkmcnt(2)
  v_mfma_f32_32x32x16_bf16 v[48:63], a[176:179], v[80:83], v[48:63]
  ds_read_b64_tr_b16 v[88:89], v1 offset:14336
  ds_read_b64_tr_b16 v[90:91], v1 offset:14592
  ds_read_b64_tr_b16 v[100:101], v14 offset:5120
  ds_read_b64_tr_b16 v[102:103], v14 offset:5376
  v_lshlrev_b32 v104, 16, v96
  v_mfma_f32_32x32x16_bf16 v[64:79], v[80:83], v[176:179], v[64:79]
  v_and_b32 v105, 0xffff0000, v96
  v_add_f32 v92, v92, v104
  v_fmac_f32 v93, v104, v104
  v_add_f32 v92, v92, v105
  v_mfma_f32_32x32x16_bf16 v[32:47], a[48:51], v[80:83], v[32:47]
  v_fmac_f32 v93, v105, v105
  v_lshlrev_b32 v106, 16, v97
  v_and_b32 v107, 0xffff0000, v97
  s_waitcnt lgkmcnt(4)
  v_mfma_f32_32x32x16_bf16 v[48:63], a[180:183], v[84:87], v[48:63]
  ds_read_b64_tr_b16 v[80:81], v1 offset:15360
  ds_read_b64_tr_b16 v[82:83], v1 offset:15616
  v_add_f32 v92, v92, v106
  v_mfma_f32_32x32x16_bf16 v[64:79], v[84:87], v[180:183], v[64:79]
  v_fmac_f32 v93, v106, v106
  v_add_f32 v92, v92, v107
  v_fmac_f32 v93, v107, v107
  v_lshlrev_b32 v104, 16, v98
  v_mfma_f32_32x32x16_bf16 v[32:47], a[52:55], v[84:87], v[32:47]
  v_and_b32 v105, 0xffff0000, v98
  v_add_f32 v92, v92, v104
  v_fmac_f32 v93, v104, v104
  s_waitcnt lgkmcnt(4)
  v_mfma_f32_32x32x16_bf16 v[48:63], a[184:187], v[88:91], v[48:63]
  ds_read_b64_tr_b16 v[84:85], v1 offset:16384
  ds_read_b64_tr_b16 v[86:87], v1 offset:16640
  v_add_f32 v92, v92, v105
  v_mfma_f32_32x32x16_bf16 v[64:79], v[88:91], v[184:187], v[64:79]
  v_fmac_f32 v93, v105, v105
  v_lshlrev_b32 v106, 16, v99
  v_and_b32 v107, 0xffff0000, v99
  v_add_f32 v92, v92, v106
  v_mfma_f32_32x32x16_bf16 v[32:47], a[56:59], v[88:91], v[32:47]
  v_fmac_f32 v93, v106, v106
  v_add_f32 v92, v92, v107
  v_fmac_f32 v93, v107, v107
  s_waitcnt lgkmcnt(2)
  v_mfma_f32_32x32x16_bf16 v[48:63], a[188:191], v[80:83], v[48:63]
  ds_read_b64_tr_b16 v[88:89], v1 offset:17408
  ds_read_b64_tr_b16 v[90:91], v1 offset:17664
  ds_read_b64_tr_b16 v[96:97], v14 offset:6144
  ds_read_b64_tr_b16 v[98:99], v14 offset:6400
  v_lshlrev_b32 v104, 16, v100
  v_mfma_f32_32x32x16_bf16 v[64:79], v[80:83], v[188:191], v[64:79]
  v_and_b32 v105, 0xffff0000, v100
  v_add_f32 v92, v92, v104
  v_fmac_f32 v93, v104, v104
  v_add_f32 v92, v92, v105
  v_mfma_f32_32x32x16_bf16 v[32:47], a[60:63], v[80:83], v[32:47]
  v_fmac_f32 v93, v105, v105
  v_lshlrev_b32 v106, 16, v101
  v_and_b32 v107, 0xffff0000, v101
  s_waitcnt lgkmcnt(4)
  v_mfma_f32_32x32x16_bf16 v[48:63], a[192:195], v[84:87], v[48:63]
  ds_read_b64_tr_b16 v[80:81], v1 offset:18432
  ds_read_b64_tr_b16 v[82:83], v1 offset:18688
  v_add_f32 v92, v92, v106
  v_mfma_f32_32x32x16_bf16 v[64:79], v[84:87], v[192:195], v[64:79]
  v_fmac_f32 v93, v106, v106
  v_add_f32 v92, v92, v107
  v_fmac_f32 v93, v107, v107
  v_lshlrev_b32 v104, 16, v102
  v_mfma_f32_32x32x16_bf16 v[32:47], a[64:67], v[84:87], v[32:47]
  v_and_b32 v105, 0xffff0000, v102
  v_add_f32 v92, v92, v104
  v_fmac_f32 v93, v104, v104
  s_waitcnt lgkmcnt(4)
  v_mfma_f32_32x32x16_bf16 v[48:63], a[196:199], v[88:91], v[48:63]
  ds_read_b64_tr_b16 v[84:85], v1 offset:19456
  ds_read_b64_tr_b16 v[86:87], v1 offset:19712
  v_add_f32 v92, v92, v105
  v_mfma_f32_32x32x16_bf16 v[64:79], v[88:91], v[196:199], v[64:79]
  v_fmac_f32 v93, v105, v105
  v_lshlrev_b32 v106, 16, v103
  v_and_b32 v107, 0xffff0000, v103
  v_add_f32 v92, v92, v106
  v_mfma_f32_32x32x16_bf16 v[32:47], a[68:71], v[88:91], v[32:47]
  v_fmac_f32 v93, v106, v106
  v_add_f32 v92, v92, v107
  v_fmac_f32 v93, v107, v107
  s_waitcnt lgkmcnt(2)
  v_mfma_f32_32x32x16_bf16 v[48:63], a[200:203], v[80:83], v[48:63]
  ds_read_b64_tr_b16 v[88:89], v1 offset:20480
  ds_read_b64_tr_b16 v[90:91], v1 offset:20736
  ds_read_b64_tr_b16 v[100:101], v14 offset:7168
  ds_read_b64_tr_b16 v[102:103], v14 offset:7424
  v_lshlrev_b32 v104, 16, v96
  v_mfma_f32_32x32x16_bf16 v[64:79], v[80:83], v[200:203], v[64:79]
  v_and_b32 v105, 0xffff0000, v96
  v_add_f32 v92, v92, v104
  v_fmac_f32 v93, v104, v104
  v_add_f32 v92, v92, v105
  v_mfma_f32_32x32x16_bf16 v[32:47], a[72:75], v[80:83], v[32:47]
  v_fmac_f32 v93, v105, v105
  v_lshlrev_b32 v106, 16, v97
  v_and_b32 v107, 0xffff0000, v97
  s_waitcnt lgkmcnt(4)
  v_mfma_f32_32x32x16_bf16 v[48:63], a[204:207], v[84:87], v[48:63]
  ds_read_b64_tr_b16 v[80:81], v1 offset:21504
  ds_read_b64_tr_b16 v[82:83], v1 offset:21760
  v_add_f32 v92, v92, v106
  v_mfma_f32_32x32x16_bf16 v[64:79], v[84:87], v[204:207], v[64:79]
  v_fmac_f32 v93, v106, v106
  v_add_f32 v92, v92, v107
  v_fmac_f32 v93, v107, v107
  v_lshlrev_b32 v104, 16, v98
  v_mfma_f32_32x32x16_bf16 v[32:47], a[76:79], v[84:87], v[32:47]
  v_and_b32 v105, 0xffff0000, v98
  v_add_f32 v92, v92, v104
  v_fmac_f32 v93, v104, v104
  s_waitcnt lgkmcnt(4)
  v_mfma_f32_32x32x16_bf16 v[48:63], a[208:211], v[88:91], v[48:63]
  ds_read_b64_tr_b16 v[84:85], v1 offset:22528
  ds_read_b64_tr_b16 v[86:87], v1 offset:22784
  v_add_f32 v92, v92, v105
  v_mfma_f32_32x32x16_bf16 v[64:79], v[88:91], v[208:211], v[64:79]
  v_fmac_f32 v93, v105, v105
  v_lshlrev_b32 v106, 16, v99
  v_and_b32 v107, 0xffff0000, v99
  v_add_f32 v92, v92, v106
  v_mfma_f32_32x32x16_bf16 v[32:47], a[80:83], v[88:91], v[32:47]
  v_fmac_f32 v93, v106, v106
  v_add_f32 v92, v92, v107
  v_fmac_f32 v93, v107, v107
  s_waitcnt lgkmcnt(2)
  v_mfma_f32_32x32x16_bf16 v[48:63], a[212:215], v[80:83], v[48:63]
  ds_read_b64_tr_b16 v[88:89], v1 offset:23552
  ds_read_b64_tr_b16 v[90:91], v1 offset:23808
  v_mfma_f32_32x32x16_bf16 v[64:79], v[80:83], v[212:215], v[64:79]
  v_lshlrev_b32 v104, 16, v100
  v_and_b32 v105, 0xffff0000, v100
  v_add_f32 v92, v92, v104
  v_fmac_f32 v93, v104, v104
  v_mfma_f32_32x32x16_bf16 v[32:47], a[84:87], v[80:83], v[32:47]
  v_add_f32 v92, v92, v105
  v_fmac_f32 v93, v105, v105
  v_lshlrev_b32 v106, 16, v101
  v_and_b32 v107, 0xffff0000, v101
  s_waitcnt lgkmcnt(2)
  v_mfma_f32_32x32x16_bf16 v[48:63], a[216:219], v[84:87], v[48:63]
  ds_read_b64_tr_b16 v[80:81], v1 offset:24576
  ds_read_b64_tr_b16 v[82:83], v1 offset:24832
  v_add_f32 v92, v92, v106
  v_mfma_f32_32x32x16_bf16 v[64:79], v[84:87], v[216:219], v[64:79]
  v_fmac_f32 v93, v106, v106
  v_add_f32 v92, v92, v107
  v_fmac_f32 v93, v107, v107
  v_lshlrev_b32 v104, 16, v102
  v_mfma_f32_32x32x16_bf16 v[32:47], a[88:91], v[84:87], v[32:47]
  v_and_b32 v105, 0xffff0000, v102
  v_add_f32 v92, v92, v104
  v_fmac_f32 v93, v104, v104
  s_waitcnt lgkmcnt(2)
  v_mfma_f32_32x32x16_bf16 v[48:63], a[220:223], v[88:91], v[48:63]
  ds_read_b64_tr_b16 v[84:85], v1 offset:25600
  ds_read_b64_tr_b16 v[86:87], v1 offset:25856
  v_add_f32 v92, v92, v105
  v_mfma_f32_32x32x16_bf16 v[64:79], v[88:91], v[220:223], v[64:79]
  v_fmac_f32 v93, v105, v105
  v_lshlrev_b32 v106, 16, v103
  v_and_b32 v107, 0xffff0000, v103
  v_add_f32 v92, v92, v106
  v_mfma_f32_32x32x16_bf16 v[32:47], a[92:95], v[88:91], v[32:47]
  v_fmac_f32 v93, v106, v106
  v_add_f32 v92, v92, v107
  v_fmac_f32 v93, v107, v107
  s_waitcnt lgkmcnt(2)
  v_mfma_f32_32x32x16_bf16 v[48:63], a[224:227], v[80:83], v[48:63]
  ds_read_b64_tr_b16 v[88:89], v1 offset:26624
  ds_read_b64_tr_b16 v[90:91], v1 offset:26880
  v_mov_b32 v94, v92
  v_mfma_f32_32x32x16_bf16 v[64:79], v[80:83], v[224:227], v[64:79]
  v_mov_b32 v95, v93
  v_permlane32_swap_b32 v92, v94
  s_nop 0
  v_permlane32_swap_b32 v93, v95
  v_add_f32 v92, v92, v94
  v_mfma_f32_32x32x16_bf16 v[32:47], a[96:99], v[80:83], v[32:47]
  v_add_f32 v93, v93, v95
  ds_write_b64 v108, v[92:93]
  s_waitcnt lgkmcnt(3)
  v_mfma_f32_32x32x16_bf16 v[48:63], a[228:231], v[84:87], v[48:63]
  ds_read_b64_tr_b16 v[80:81], v1 offset:27648
  ds_read_b64_tr_b16 v[82:83], v1 offset:27904
  v_mfma_f32_32x32x16_bf16 v[64:79], v[84:87], v[228:231], v[64:79]
  s_waitcnt lgkmcnt(2)
  s_barrier
  ds_read_b64 v[96:97], v15 offset:0
  ds_read_b64 v[98:99], v15 offset:256
  v_mfma_f32_32x32x16_bf16 v[32:47], a[100:103], v[84:87], v[32:47]
  ds_read_b64 v[100:101], v15 offset:512
  ds_read_b64 v[102:103], v15 offset:768
  v_mfma_f32_32x32x16_bf16 v[48:63], a[232:235], v[88:91], v[48:63]
  ds_read_b64_tr_b16 v[84:85], v1 offset:28672
  ds_read_b64_tr_b16 v[86:87], v1 offset:28928
  v_mfma_f32_32x32x16_bf16 v[64:79], v[88:91], v[232:235], v[64:79]
  v_mfma_f32_32x32x16_bf16 v[32:47], a[104:107], v[88:91], v[32:47]
  s_waitcnt lgkmcnt(6)
  v_mfma_f32_32x32x16_bf16 v[48:63], a[236:239], v[80:83], v[48:63]
  ds_read_b64_tr_b16 v[88:89], v1 offset:29696
  ds_read_b64_tr_b16 v[90:91], v1 offset:29952
  s_waitcnt lgkmcnt(4)
  v_mfma_f32_32x32x16_bf16 v[64:79], v[80:83], v[236:239], v[64:79]
  v_add_f32 v92, v96, v98
  v_add_f32 v93, v97, v99
  v_add_f32 v94, v100, v102
  v_add_f32 v95, v101, v103
  v_mfma_f32_32x32x16_bf16 v[32:47], a[108:111], v[80:83], v[32:47]
  v_add_f32 v92, v92, v94
  v_add_f32 v93, v93, v95
  v_mul_f32 v92, 0x3b000000, v92
  s_waitcnt lgkmcnt(2)
  v_mfma_f32_32x32x16_bf16 v[48:63], a[240:243], v[84:87], v[48:63]
  ds_read_b64_tr_b16 v[80:81], v1 offset:30720
  ds_read_b64_tr_b16 v[82:83], v1 offset:30976
  v_mul_f32 v94, v92, v92
  v_mfma_f32_32x32x16_bf16 v[64:79], v[84:87], v[240:243], v[64:79]
  v_mul_f32 v93, 0x3b000000, v93
  v_sub_f32 v93, v93, v94
  v_max_f32 v93, 0, v93
  v_cvt_pk_bf16_f32 v93, v93, v93
  v_mfma_f32_32x32x16_bf16 v[32:47], a[112:115], v[84:87], v[32:47]
  v_and_b32 v93, 0xffff0000, v93
  v_add_f32 v93, 0x3727c5ac, v93
  v_cvt_pk_bf16_f32 v93, v93, v93
  s_waitcnt lgkmcnt(2)
  v_mfma_f32_32x32x16_bf16 v[48:63], a[244:247], v[88:91], v[48:63]
  ds_read_b64_tr_b16 v[84:85], v1 offset:31744
  ds_read_b64_tr_b16 v[86:87], v1 offset:32000
  v_and_b32 v93, 0xffff0000, v93
  v_mfma_f32_32x32x16_bf16 v[64:79], v[88:91], v[244:247], v[64:79]
  v_sqrt_f32 v93, v93
  v_cvt_pk_bf16_f32 v92, v92, v92
  v_and_b32 v92, 0xffff0000, v92
  v_cvt_pk_bf16_f32 v93, v93, v93
  v_mfma_f32_32x32x16_bf16 v[32:47], a[116:119], v[88:91], v[32:47]
  v_and_b32 v93, 0xffff0000, v93
  v_rcp_f32 v93, v93
  v_xor_b32 v92, 0x80000000, v92
  s_waitcnt lgkmcnt(2)
  v_mfma_f32_32x32x16_bf16 v[48:63], a[248:251], v[80:83], v[48:63]
  v_lshrrev_b32 v94, 16, v92
  v_mfma_f32_32x32x16_bf16 v[64:79], v[80:83], v[248:251], v[64:79]
  v_or_b32 v20, v92, v94
  v_or_b32 v23, v92, v94
  v_mov_b32 v92, v93
  ds_write_b32 v9, v93
  v_mfma_f32_32x32x16_bf16 v[32:47], a[120:123], v[80:83], v[32:47]
  s_waitcnt lgkmcnt(1)
  v_mfma_f32_32x32x16_bf16 v[48:63], a[252:255], v[84:87], v[48:63]
  ds_read_b128 v[96:99], v8 offset:0
  v_mfma_f32_32x32x16_bf16 v[64:79], v[84:87], v[252:255], v[64:79]
  ds_read_b128 v[100:103], v8 offset:32
  ds_read_b128 v[104:107], v8 offset:64
  ds_read_b128 v[108:111], v8 offset:96
  v_mfma_f32_32x32x16_bf16 v[32:47], a[124:127], v[84:87], v[32:47]
  s_sub_u32 s51, s33, 2
  s_and_b32 s6, s51, 3
  s_lshl_b32 s6, s6, 17
  s_add_u32 s47, s40, s6
  s_lshr_b32 s6, s51, 2
  s_andn2_b32 s50, 1, s6
  s_lshl_b32 s6, s51, 18
  s_add_u32 s48, s41, s6
  s_add_u32 s51, s51, 1
  buffer_load_dwordx4 v[116:119], v0, s[8:11], s47 offen sc1
  buffer_load_dword v115, v114, s[8:11], s44 offen sc1
  v_mfma_f32_32x32x8_bf16 v[48:63], v[16:17], v[22:23], v[48:63]
  v_mfma_f32_32x32x8_bf16 v[64:79], v[20:21], v[18:19], v[64:79]
  v_mfma_f32_32x32x8_bf16 v[32:47], v[16:17], v[20:21], v[32:47]
  s_add_u32 s7, s46, 0x2000
  s_nop 8
  v_pk_mul_f32 v[48:49], v[48:49], v[92:93]
  v_pk_mul_f32 v[50:51], v[50:51], v[92:93]
  v_pk_mul_f32 v[52:53], v[52:53], v[92:93]
  v_pk_mul_f32 v[54:55], v[54:55], v[92:93]
  v_pk_mul_f32 v[56:57], v[56:57], v[92:93]
  v_pk_mul_f32 v[58:59], v[58:59], v[92:93]
  v_pk_mul_f32 v[60:61], v[60:61], v[92:93]
  v_pk_mul_f32 v[62:63], v[62:63], v[92:93]
  v_cvt_pk_bf16_f32 v48, v48, v49
  v_cvt_pk_bf16_f32 v49, v50, v51
  v_cvt_pk_bf16_f32 v50, v52, v53
  v_cvt_pk_bf16_f32 v51, v54, v55
  v_cvt_pk_bf16_f32 v52, v56, v57
  v_cvt_pk_bf16_f32 v53, v58, v59
  v_cvt_pk_bf16_f32 v54, v60, v61
  v_cvt_pk_bf16_f32 v55, v62, v63
  v_bfi_b32 v48, 1, s42, v48
  v_bfi_b32 v52, 1, s42, v52
  buffer_store_dwordx4 v[48:51], v0, s[8:11], s46 offen offset:0 sc1
  ds_write_b128 v112, v[48:51] offset:8192
  buffer_store_dwordx4 v[52:55], v0, s[8:11], s46 offen offset:1024 sc1
  ds_write_b128 v112, v[52:55] offset:9216
  s_waitcnt lgkmcnt(2)
  v_pk_mul_f32 v[64:65], v[64:65], v[96:97]
  v_pk_mul_f32 v[66:67], v[66:67], v[98:99]
  v_pk_mul_f32 v[68:69], v[68:69], v[100:101]
  v_pk_mul_f32 v[70:71], v[70:71], v[102:103]
  v_pk_mul_f32 v[72:73], v[72:73], v[104:105]
  v_pk_mul_f32 v[74:75], v[74:75], v[106:107]
  v_pk_mul_f32 v[76:77], v[76:77], v[108:109]
  v_pk_mul_f32 v[78:79], v[78:79], v[110:111]
  v_cvt_pk_bf16_f32 v64, v64, v65
  v_cvt_pk_bf16_f32 v65, v66, v67
  v_cvt_pk_bf16_f32 v66, v68, v69
  v_cvt_pk_bf16_f32 v67, v70, v71
  v_cvt_pk_bf16_f32 v68, v72, v73
  v_cvt_pk_bf16_f32 v69, v74, v75
  v_cvt_pk_bf16_f32 v70, v76, v77
  v_cvt_pk_bf16_f32 v71, v78, v79
  v_bfi_b32 v64, 1, s42, v64
  v_bfi_b32 v68, 1, s42, v68
  buffer_store_dwordx4 v[64:67], v0, s[8:11], s7 offen offset:0 sc1
  ds_write_b128 v112, v[64:67] offset:16384
  buffer_store_dwordx4 v[68:71], v0, s[8:11], s7 offen offset:1024 sc1
  ds_write_b128 v112, v[68:71] offset:17408
  v_pk_mul_f32 v[32:33], v[32:33], v[92:93]
  v_pk_mul_f32 v[34:35], v[34:35], v[92:93]
  v_pk_mul_f32 v[36:37], v[36:37], v[92:93]
  v_pk_mul_f32 v[38:39], v[38:39], v[92:93]
  v_pk_mul_f32 v[40:41], v[40:41], v[92:93]
  v_pk_mul_f32 v[42:43], v[42:43], v[92:93]
  v_pk_mul_f32 v[44:45], v[44:45], v[92:93]
  v_pk_mul_f32 v[46:47], v[46:47], v[92:93]
  v_cvt_pk_bf16_f32 v32, v32, v33
  v_cvt_pk_bf16_f32 v33, v34, v35
  v_cvt_pk_bf16_f32 v34, v36, v37
  v_cvt_pk_bf16_f32 v35, v38, v39
  v_cvt_pk_bf16_f32 v36, v40, v41
  v_cvt_pk_bf16_f32 v37, v42, v43
  v_cvt_pk_bf16_f32 v38, v44, v45
  v_cvt_pk_bf16_f32 v39, v46, v47
  ds_write_b128 v112, v[32:35] offset:0
  ds_write_b128 v112, v[36:39] offset:1024
  s_cmp_eq_u32 s32, 0
  s_cbranch_scc1 L_p_first
L_p_att:
  ds_read_b128 v[64:67], v3 offset:0
  ds_read_b128 v[32:35], v2 offset:0
  ds_read_b128 v[48:51], v2 offset:128
  ds_read_b128 v[68:71], v3 offset:2048
  ds_read_b128 v[36:39], v2 offset:2048
  ds_read_b128 v[52:55], v2 offset:2176
  ds_read_b128 v[72:75], v3 offset:4096
  ds_read_b128 v[40:43], v2 offset:4096
  ds_read_b128 v[56:59], v2 offset:4224
  ds_read_b128 v[76:79], v3 offset:6144
  ds_read_b128 v[44:47], v2 offset:6144
  ds_read_b128 v[60:63], v2 offset:6272
  s_waitcnt lgkmcnt(9)
  v_mfma_f32_16x16x32_bf16 v[96:99], v[32:35], v[64:67], v[24:27]
  v_mfma_f32_16x16x32_bf16 v[100:103], v[48:51], v[64:67], v[28:31]
  s_waitcnt lgkmcnt(6)
  v_mfma_f32_16x16x32_bf16 v[96:99], v[36:39], v[68:71], v[96:99]
  v_mfma_f32_16x16x32_bf16 v[100:103], v[52:55], v[68:71], v[100:103]
  s_waitcnt lgkmcnt(3)
  v_mfma_f32_16x16x32_bf16 v[96:99], v[40:43], v[72:75], v[96:99]
  v_mfma_f32_16x16x32_bf16 v[100:103], v[56:59], v[72:75], v[100:103]
  s_waitcnt lgkmcnt(0)
  v_mfma_f32_16x16x32_bf16 v[96:99], v[44:47], v[76:79], v[96:99]
  v_mfma_f32_16x16x32_bf16 v[100:103], v[60:63], v[76:79], v[100:103]
  ds_read_b128 v[80:83], v4 offset:0
  ds_read_b128 v[84:87], v4 offset:256
  ds_read_b128 v[88:91], v4 offset:2048
  ds_read_b128 v[92:95], v4 offset:2304
  s_mov_b32 s7, 0
  s_waitcnt vmcnt(4)
L_p_km:
  v_bitop3_b32 v126, v116, s50, 1 bitop3:0x28
  v_cmp_ne_u32 vcc, 0, v126
  s_cbranch_vccz L_p_kmok
  buffer_load_dwordx4 v[116:119], v0, s[8:11], s47 offen sc1
  buffer_load_dword v115, v114, s[8:11], s44 offen sc1
  s_waitcnt vmcnt(0)
  s_add_u32 s7, s7, 1
  s_cmp_lt_u32 s7, 131072
  s_cbranch_scc1 L_p_km
  s_mov_b32 s6, 23
  s_branch L_err
L_p_kmok:
  ds_write_b64 v5, v[116:117]
  ds_write_b64 v5, v[118:119] offset:128
  v_max3_f32 v124, v96, v97, v98
  v_max3_f32 v125, v100, v101, v102
  v_max3_f32 v124, v124, v99, v103
  s_waitcnt lgkmcnt(0)
  s_barrier
  ds_read_b64_tr_b16 v[32:33], v6 offset:0
  ds_read_b64_tr_b16 v[34:35], v6 offset:64
  ds_read_b64_tr_b16 v[36:37], v6 offset:256
  ds_read_b64_tr_b16 v[38:39], v6 offset:320
  ds_read_b64_tr_b16 v[40:41], v6 offset:512
  ds_read_b64_tr_b16 v[42:43], v6 offset:576
  ds_read_b64_tr_b16 v[44:45], v6 offset:768
  ds_read_b64_tr_b16 v[46:47], v6 offset:832
  ds_read_b64 v[48:49], v7 offset:0
  ds_read_b64 v[50:51], v7 offset:128
  ds_read_b64 v[52:53], v7 offset:256
  ds_read_b64 v[54:55], v7 offset:384
  s_mov_b32 s52, 0
  s_cmp_ge_u32 s32, 31
  s_cbranch_scc1 L_nx_93
  v_cmp_gt_u32 vcc, s49, v115
  s_cbranch_vccnz L_nx_94
  s_mov_b32 s52, 1
  s_sub_u32 s6, s49, 1
  s_lshl_b32 s6, s6, 15
  s_add_u32 s45, s38, s6
  s_mov_b32 m0, s53
  s_add_u32 s6, s45, 4096
  buffer_load_dwordx4 v0, s[8:11], s45 offen offset:0 lds
  buffer_load_dwordx4 v0, s[8:11], s45 offen offset:1024 lds
  buffer_load_dwordx4 v0, s[8:11], s45 offen offset:2048 lds
  buffer_load_dwordx4 v0, s[8:11], s45 offen offset:3072 lds
  s_add_u32 m0, s53, 4096
  s_nop 0
  buffer_load_dwordx4 v0, s[8:11], s6 offen offset:0 lds
  buffer_load_dwordx4 v0, s[8:11], s6 offen offset:1024 lds
  buffer_load_dwordx4 v0, s[8:11], s6 offen offset:2048 lds
  buffer_load_dwordx4 v0, s[8:11], s6 offen offset:3072 lds
  s_branch L_nx_93
L_nx_94:
  buffer_load_dword v115, v114, s[8:11], s44 offen sc1
L_nx_93:
  s_waitcnt lgkmcnt(10)
  v_mfma_f32_16x16x32_bf16 v[104:107], v[32:35], v[64:67], 0
  s_waitcnt lgkmcnt(8)
  v_mfma_f32_16x16x32_bf16 v[104:107], v[36:39], v[68:71], v[104:107]
  s_waitcnt lgkmcnt(6)
  v_mfma_f32_16x16x32_bf16 v[104:107], v[40:43], v[72:75], v[104:107]
  s_waitcnt lgkmcnt(4)
  v_mfma_f32_16x16x32_bf16 v[104:107], v[44:47], v[76:79], v[104:107]
  v_max_f32 v124, v124, v125
  s_nop 6
  v_max3_f32 v124, v124, v106, v107
  v_mov_b32 v125, v124
  s_nop 1
  v_permlane32_swap_b32 v124, v125
  v_max_f32 v124, v124, v125
  v_max_f32 v125, v124, v125
  s_nop 1
  v_permlane16_swap_b32 v124, v125
  v_max_f32 v124, v124, v125
  v_mul_f32 v124, s34, v124
  v_fma_f32 v106, v106, s34, -v124
  v_fma_f32 v107, v107, s34, -v124
  v_fma_f32 v96, v96, s34, -v124
  v_fma_f32 v97, v97, s34, -v124
  v_fma_f32 v98, v98, s34, -v124
  v_fma_f32 v99, v99, s34, -v124
  v_fma_f32 v100, v100, s34, -v124
  v_fma_f32 v101, v101, s34, -v124
  v_fma_f32 v102, v102, s34, -v124
  v_fma_f32 v103, v103, s34, -v124
  v_exp_f32 v106, v106
  v_exp_f32 v107, v107
  v_exp_f32 v96, v96
  v_cvt_pk_bf16_f32 v12, v106, v107
  v_exp_f32 v97, v97
  s_waitcnt lgkmcnt(0)
  v_mfma_f32_16x16x16_bf16 v[108:111], v[10:11], v[12:13], 0
  v_mfma_f32_16x16x16_bf16 v[56:59], v[48:49], v[12:13], 0
  v_exp_f32 v98, v98
  v_exp_f32 v99, v99
  v_mfma_f32_16x16x16_bf16 v[60:63], v[50:51], v[12:13], 0
  v_exp_f32 v100, v100
  v_exp_f32 v101, v101
  v_mfma_f32_16x16x16_bf16 v[64:67], v[52:53], v[12:13], 0
  v_exp_f32 v102, v102
  v_exp_f32 v103, v103
  v_mfma_f32_16x16x16_bf16 v[68:71], v[54:55], v[12:13], 0
  v_cvt_pk_bf16_f32 v120, v96, v97
  v_cvt_pk_bf16_f32 v121, v98, v99
  v_cvt_pk_bf16_f32 v122, v100, v101
  v_cvt_pk_bf16_f32 v123, v102, v103
  v_mfma_f32_16x16x16_bf16 v[108:111], v[10:11], v[120:121], v[108:111]
  s_nop 0
  v_mfma_f32_16x16x16_bf16 v[108:111], v[10:11], v[122:123], v[108:111]
  v_mfma_f32_16x16x32_bf16 v[56:59], v[80:83], v[120:123], v[56:59]
  v_mfma_f32_16x16x32_bf16 v[60:63], v[84:87], v[120:123], v[60:63]
  v_mfma_f32_16x16x32_bf16 v[64:67], v[88:91], v[120:123], v[64:67]
  v_mfma_f32_16x16x32_bf16 v[68:71], v[92:95], v[120:123], v[68:71]
  s_nop 3
  v_rcp_f32 v108, v108
  v_mov_b32 v126, s51
  v_pk_mul_f32 v[56:57], v[56:57], v[108:109] op_sel_hi:[1,0]
  v_pk_mul_f32 v[58:59], v[58:59], v[108:109] op_sel_hi:[1,0]
  v_pk_mul_f32 v[60:61], v[60:61], v[108:109] op_sel_hi:[1,0]
  v_pk_mul_f32 v[62:63], v[62:63], v[108:109] op_sel_hi:[1,0]
  v_cvt_pk_bf16_f32 v56, v56, v57
  v_cvt_pk_bf16_f32 v57, v58, v59
  v_cvt_pk_bf16_f32 v58, v60, v61
  v_cvt_pk_bf16_f32 v59, v62, v63
  buffer_store_dwordx4 v[56:59], v113, s[8:11], s48 offen offset:0 sc1
  v_pk_mul_f32 v[64:65], v[64:65], v[108:109] op_sel_hi:[1,0]
  v_pk_mul_f32 v[66:67], v[66:67], v[108:109] op_sel_hi:[1,0]
  v_pk_mul_f32 v[68:69], v[68:69], v[108:109] op_sel_hi:[1,0]
  v_pk_mul_f32 v[70:71], v[70:71], v[108:109] op_sel_hi:[1,0]
  v_cvt_pk_bf16_f32 v64, v64, v65
  v_cvt_pk_bf16_f32 v65, v66, v67
  v_cvt_pk_bf16_f32 v66, v68, v69
  v_cvt_pk_bf16_f32 v67, v70, v71
  buffer_store_dwordx4 v[64:67], v113, s[8:11], s48 offen offset:2048 sc1
  s_cmp_ge_u32 s32, 31
  s_cbranch_scc1 L_p_of
  s_cmp_lg_u32 s52, 0
  s_cbranch_scc1 L_p_of3
  s_waitcnt vmcnt(2)
  v_cmp_gt_u32 vcc, s49, v115
  s_cbranch_vccnz L_p_of
  s_mov_b32 s52, 1
  s_sub_u32 s6, s49, 1
  s_lshl_b32 s6, s6, 15
  s_add_u32 s45, s38, s6
  s_mov_b32 m0, s53
  s_add_u32 s6, s45, 4096
  buffer_load_dwordx4 v0, s[8:11], s45 offen offset:0 lds
  buffer_load_dwordx4 v0, s[8:11], s45 offen offset:1024 lds
  buffer_load_dwordx4 v0, s[8:11], s45 offen offset:2048 lds
  buffer_load_dwordx4 v0, s[8:11], s45 offen offset:3072 lds
  s_add_u32 m0, s53, 4096
  s_nop 0
  buffer_load_dwordx4 v0, s[8:11], s6 offen offset:0 lds
  buffer_load_dwordx4 v0, s[8:11], s6 offen offset:1024 lds
  buffer_load_dwordx4 v0, s[8:11], s6 offen offset:2048 lds
  buffer_load_dwordx4 v0, s[8:11], s6 offen offset:3072 lds
  s_waitcnt vmcnt(8)
  s_mov_b64 exec, 1
  buffer_store_dword v126, v13, s[8:11], s43 offen sc1
  s_mov_b64 exec, -1
  s_waitcnt vmcnt(1)
  s_branch L_p_of2
L_p_of3:
  s_mov_b32 s52, 2
  s_waitcnt vmcnt(2)
  s_branch L_p_of2
L_p_of:
  s_waitcnt vmcnt(0)
  s_mov_b64 exec, 1
  buffer_store_dword v126, v13, s[8:11], s43 offen sc1
  s_mov_b64 exec, -1
L_p_of2:
L_p_next:
  v_xor_b32 v2, 0x18000, v2
  v_xor_b32 v3, 0x18000, v3
  v_xor_b32 v4, 0x18000, v4
  v_xor_b32 v112, 0x18000, v112
  s_add_u32 s32, s32, 1
  s_add_u32 s33, s33, 2
  s_cmp_gt_u32 s32, 32
  s_cbranch_scc1 L_p_end
  s_cmp_eq_u32 s32, 32
  s_cbranch_scc1 L_p_tail
  s_cmp_eq_u32 s52, 0
  s_cbranch_scc1 L_p_xwait
  s_branch L_p_loop
L_p_tail:
  s_sub_u32 s51, s33, 2
  s_and_b32 s6, s51, 3
  s_lshl_b32 s6, s6, 17
  s_add_u32 s47, s40, s6
  s_lshr_b32 s6, s51, 2
  s_andn2_b32 s50, 1, s6
  s_lshl_b32 s6, s51, 18
  s_add_u32 s48, s41, s6
  s_add_u32 s51, s51, 1
  buffer_load_dwordx4 v[116:119], v0, s[8:11], s47 offen sc1
  s_waitcnt vmcnt(0) lgkmcnt(0)
  s_barrier
  s_branch L_p_att
L_p_first:
  s_waitcnt vmcnt(0) lgkmcnt(0)
  s_barrier
  s_mov_b32 s52, 0
  s_cmp_ge_u32 s32, 31
  s_cbranch_scc1 L_nx_95
  v_cmp_gt_u32 vcc, s49, v115
  s_cbranch_vccnz L_nx_95
  s_mov_b32 s52, 1
  s_sub_u32 s6, s49, 1
  s_lshl_b32 s6, s6, 15
  s_add_u32 s45, s38, s6
  s_mov_b32 m0, s53
  s_add_u32 s6, s45, 4096
  buffer_load_dwordx4 v0, s[8:11], s45 offen offset:0 lds
  buffer_load_dwordx4 v0, s[8:11], s45 offen offset:1024 lds
  buffer_load_dwordx4 v0, s[8:11], s45 offen offset:2048 lds
  buffer_load_dwordx4 v0, s[8:11], s45 offen offset:3072 lds
  s_add_u32 m0, s53, 4096
  s_nop 0
  buffer_load_dwordx4 v0, s[8:11], s6 offen offset:0 lds
  buffer_load_dwordx4 v0, s[8:11], s6 offen offset:1024 lds
  buffer_load_dwordx4 v0, s[8:11], s6 offen offset:2048 lds
  buffer_load_dwordx4 v0, s[8:11], s6 offen offset:3072 lds
L_nx_95:
  s_cmp_lg_u32 s35, 0
  s_cbranch_scc1 L_p_f2
  s_mov_b32 s51, 127
  s_mov_b32 s7, 0
L_pl_97:
  buffer_load_dwordx4 v[32:35], v0, s[8:11], s44 offen offset:0 sc1
  buffer_load_dwordx4 v[36:39], v0, s[8:11], s44 offen offset:1024 sc1
  s_waitcnt vmcnt(0)
  v_min3_u32 v32, v32, v33, v34
  v_min3_u32 v35, v35, v36, v37
  v_min3_u32 v32, v32, v38, v39
  v_min_u32 v32, v32, v35
  v_cmp_gt_u32 vcc, s51, v32
  s_cbranch_vccz L_plo_98
  s_add_u32 s7, s7, 1
  s_cmp_lt_u32 s7, 131072
  s_cbranch_scc1 L_pl_97
  s_mov_b32 s6, 24
  s_branch L_err
L_plo_98:
L_p_f2:
  s_waitcnt vmcnt(0)
  s_branch L_p_next
L_p_end:
  s_waitcnt vmcnt(0)
  s_endpgm
L_o:
  s_lshr_b32 s33, s5, 4
  s_bfe_u32 s34, s5, 0x20002
  s_and_b32 s35, s5, 3
  s_mul_i32 s36, s33, 0x1000000
  s_add_u32 s36, s36, 0x6800000
  s_lshl_b32 s6, s34, 3
  s_lshl_b32 s7, s3, 1
  s_add_u32 s6, s6, s7
  s_lshl_b32 s7, s6, 13
  s_add_u32 s36, s36, s7
  s_lshl_b32 s6, s6, 7
  s_lshl_b32 s7, s33, 13
  s_add_u32 s6, s6, s7
  s_add_u32 s38, s6, 0x718000
  s_mul_i32 s37, s33, 0x800000
  s_add_u32 s37, s37, 0x8800000
  s_lshl_b32 s6, s34, 15
  s_add_u32 s37, s37, s6
  s_lshl_b32 s6, s35, 13
  s_add_u32 s37, s37, s6
  s_lshl_b32 s6, s3, 11
  s_add_u32 s37, s37, s6
  s_lshl_b32 s6, s35, 6
  s_lshl_b32 s7, s3, 4
  s_add_u32 s6, s6, s7
  s_lshl_b32 s7, s33, 8
  s_add_u32 s6, s6, s7
  s_add_u32 s39, s6, 0x710800
  s_lshl_b32 s42, s3, 14
  s_branch L_pro
L_o2:
  v_lshlrev_b32 v0, 4, v0
  s_mov_b32 s16, s88
  s_mov_b32 s17, s89
  s_mov_b32 s18, 0x400000
  s_mov_b32 s19, 0x20000
  v_lshrrev_b32 v104, 4, v0
  v_lshrrev_b32 v100, 8, v0
  v_lshlrev_b32 v105, 2, v100
  v_and_b32 v104, 15, v104
  v_xor_b32 v104, v104, v105
  v_mul_u32_u24 v100, 1024, v100
  v_lshl_add_u32 v100, v104, 4, v100
  v_bfe_u32 v104, v0, 6, 2
  v_lshlrev_b32 v105, 2, v104
  v_bfe_u32 v106, v0, 8, 1
  v_lshlrev_b32 v106, 1, v106
  v_bfe_u32 v107, v0, 5, 1
  v_or_b32 v106, v106, v107
  s_lshl_b32 s6, s3, 2
  v_or_b32 v106, s6, v106
  v_xor_b32 v106, v106, v105
  v_lshlrev_b32 v106, 4, v106
  v_bfe_u32 v107, v0, 4, 1
  v_lshl_or_b32 v106, v107, 3, v106
  v_bfe_u32 v107, v0, 9, 1
  v_lshl_or_b32 v104, v107, 2, v104
  v_lshl_or_b32 v104, v104, 8, v106
  v_add_u32 v105, 0x10000, v104
  s_lshl_b32 s60, s3, 13
  s_mul_i32 s63, s3, 32768
  s_lshl_b32 s61, s34, 20
  s_lshl_b32 s62, s35, 8
  s_add_u32 s61, s61, s62
  s_add_u32 s61, s61, 0
  s_add_u32 s61, s61, s63
  s_add_u32 m0, s60, 0
  s_add_u32 s62, s61, 0
  buffer_load_dwordx4 v100, s[16:19], s62 offen lds
  s_add_u32 m0, s60, 1024
  s_add_u32 s62, s61, 4096
  buffer_load_dwordx4 v100, s[16:19], s62 offen lds
  s_add_u32 m0, s60, 2048
  s_add_u32 s62, s61, 8192
  buffer_load_dwordx4 v100, s[16:19], s62 offen lds
  s_add_u32 m0, s60, 3072
  s_add_u32 s62, s61, 12288
  buffer_load_dwordx4 v100, s[16:19], s62 offen lds
  s_add_u32 m0, s60, 4096
  s_add_u32 s62, s61, 16384
  buffer_load_dwordx4 v100, s[16:19], s62 offen lds
  s_add_u32 m0, s60, 5120
  s_add_u32 s62, s61, 20480
  buffer_load_dwordx4 v100, s[16:19], s62 offen lds
  s_add_u32 m0, s60, 6144
  s_add_u32 s62, s61, 24576
  buffer_load_dwordx4 v100, s[16:19], s62 offen lds
  s_add_u32 m0, s60, 7168
  s_add_u32 s62, s61, 28672
  buffer_load_dwordx4 v100, s[16:19], s62 offen lds
  s_lshl_b32 s61, s34, 20
  s_lshl_b32 s62, s35, 8
  s_add_u32 s61, s61, s62
  s_add_u32 s61, s61, 131072
  s_add_u32 s61, s61, s63
  s_add_u32 m0, s60, 32768
  s_add_u32 s62, s61, 0
  buffer_load_dwordx4 v100, s[16:19], s62 offen lds
  s_add_u32 m0, s60, 33792
  s_add_u32 s62, s61, 4096
  buffer_load_dwordx4 v100, s[16:19], s62 offen lds
  s_add_u32 m0, s60, 34816
  s_add_u32 s62, s61, 8192
  buffer_load_dwordx4 v100, s[16:19], s62 offen lds
  s_add_u32 m0, s60, 35840
  s_add_u32 s62, s61, 12288
  buffer_load_dwordx4 v100, s[16:19], s62 offen lds
  s_add_u32 m0, s60, 36864
  s_add_u32 s62, s61, 16384
  buffer_load_dwordx4 v100, s[16:19], s62 offen lds
  s_add_u32 m0, s60, 37888
  s_add_u32 s62, s61, 20480
  buffer_load_dwordx4 v100, s[16:19], s62 offen lds
  s_add_u32 m0, s60, 38912
  s_add_u32 s62, s61, 24576
  buffer_load_dwordx4 v100, s[16:19], s62 offen lds
  s_add_u32 m0, s60, 39936
  s_add_u32 s62, s61, 28672
  buffer_load_dwordx4 v100, s[16:19], s62 offen lds
  s_lshl_b32 s61, s34, 20
  s_lshl_b32 s62, s35, 8
  s_add_u32 s61, s61, s62
  s_add_u32 s61, s61, 262144
  s_add_u32 s61, s61, s63
  s_add_u32 m0, s60, 65536
  s_add_u32 s62, s61, 0
  buffer_load_dwordx4 v100, s[16:19], s62 offen lds
  s_add_u32 m0, s60, 66560
  s_add_u32 s62, s61, 4096
  buffer_load_dwordx4 v100, s[16:19], s62 offen lds
  s_add_u32 m0, s60, 67584
  s_add_u32 s62, s61, 8192
  buffer_load_dwordx4 v100, s[16:19], s62 offen lds
  s_add_u32 m0, s60, 68608
  s_add_u32 s62, s61, 12288
  buffer_load_dwordx4 v100, s[16:19], s62 offen lds
  s_add_u32 m0, s60, 69632
  s_add_u32 s62, s61, 16384
  buffer_load_dwordx4 v100, s[16:19], s62 offen lds
  s_add_u32 m0, s60, 70656
  s_add_u32 s62, s61, 20480
  buffer_load_dwordx4 v100, s[16:19], s62 offen lds
  s_add_u32 m0, s60, 71680
  s_add_u32 s62, s61, 24576
  buffer_load_dwordx4 v100, s[16:19], s62 offen lds
  s_add_u32 m0, s60, 72704
  s_add_u32 s62, s61, 28672
  buffer_load_dwordx4 v100, s[16:19], s62 offen lds
  s_waitcnt vmcnt(16)
  s_barrier
  s_lshl_b32 s61, s34, 20
  s_lshl_b32 s62, s35, 8
  s_add_u32 s61, s61, s62
  s_add_u32 s61, s61, 393216
  s_add_u32 s61, s61, s63
  s_add_u32 m0, s60, 98304
  s_add_u32 s62, s61, 0
  buffer_load_dwordx4 v100, s[16:19], s62 offen lds
  s_add_u32 m0, s60, 99328
  s_add_u32 s62, s61, 4096
  buffer_load_dwordx4 v100, s[16:19], s62 offen lds
  s_add_u32 m0, s60, 100352
  s_add_u32 s62, s61, 8192
  buffer_load_dwordx4 v100, s[16:19], s62 offen lds
  s_add_u32 m0, s60, 101376
  s_add_u32 s62, s61, 12288
  buffer_load_dwordx4 v100, s[16:19], s62 offen lds
  s_add_u32 m0, s60, 102400
  s_add_u32 s62, s61, 16384
  buffer_load_dwordx4 v100, s[16:19], s62 offen lds
  s_add_u32 m0, s60, 103424
  s_add_u32 s62, s61, 20480
  buffer_load_dwordx4 v100, s[16:19], s62 offen lds
  s_add_u32 m0, s60, 104448
  s_add_u32 s62, s61, 24576
  buffer_load_dwordx4 v100, s[16:19], s62 offen lds
  s_add_u32 m0, s60, 105472
  s_add_u32 s62, s61, 28672
  buffer_load_dwordx4 v100, s[16:19], s62 offen lds
  ds_read_b64_tr_b16 a[0:1], v104 offset:0
  ds_read_b64_tr_b16 a[2:3], v104 offset:4096
  ds_read_b64_tr_b16 a[4:5], v104 offset:2048
  ds_read_b64_tr_b16 a[6:7], v104 offset:6144
  ds_read_b64_tr_b16 a[8:9], v104 offset:8192
  ds_read_b64_tr_b16 a[10:11], v104 offset:12288
  ds_read_b64_tr_b16 a[12:13], v104 offset:10240
  ds_read_b64_tr_b16 a[14:15], v104 offset:14336
  ds_read_b64_tr_b16 a[16:17], v104 offset:16384
  ds_read_b64_tr_b16 a[18:19], v104 offset:20480
  ds_read_b64_tr_b16 a[20:21], v104 offset:18432
  ds_read_b64_tr_b16 a[22:23], v104 offset:22528
  ds_read_b64_tr_b16 a[24:25], v104 offset:24576
  ds_read_b64_tr_b16 a[26:27], v104 offset:28672
  ds_read_b64_tr_b16 a[28:29], v104 offset:26624
  ds_read_b64_tr_b16 a[30:31], v104 offset:30720
  s_waitcnt lgkmcnt(0)
  s_waitcnt vmcnt(16)
  s_barrier
  s_lshl_b32 s61, s34, 20
  s_lshl_b32 s62, s35, 8
  s_add_u32 s61, s61, s62
  s_add_u32 s61, s61, 524288
  s_add_u32 s61, s61, s63
  s_add_u32 m0, s60, 0
  s_add_u32 s62, s61, 0
  buffer_load_dwordx4 v100, s[16:19], s62 offen lds
  s_add_u32 m0, s60, 1024
  s_add_u32 s62, s61, 4096
  buffer_load_dwordx4 v100, s[16:19], s62 offen lds
  s_add_u32 m0, s60, 2048
  s_add_u32 s62, s61, 8192
  buffer_load_dwordx4 v100, s[16:19], s62 offen lds
  s_add_u32 m0, s60, 3072
  s_add_u32 s62, s61, 12288
  buffer_load_dwordx4 v100, s[16:19], s62 offen lds
  s_add_u32 m0, s60, 4096
  s_add_u32 s62, s61, 16384
  buffer_load_dwordx4 v100, s[16:19], s62 offen lds
  s_add_u32 m0, s60, 5120
  s_add_u32 s62, s61, 20480
  buffer_load_dwordx4 v100, s[16:19], s62 offen lds
  s_add_u32 m0, s60, 6144
  s_add_u32 s62, s61, 24576
  buffer_load_dwordx4 v100, s[16:19], s62 offen lds
  s_add_u32 m0, s60, 7168
  s_add_u32 s62, s61, 28672
  buffer_load_dwordx4 v100, s[16:19], s62 offen lds
  ds_read_b64_tr_b16 a[32:33], v104 offset:32768
  ds_read_b64_tr_b16 a[34:35], v104 offset:36864
  ds_read_b64_tr_b16 a[36:37], v104 offset:34816
  ds_read_b64_tr_b16 a[38:39], v104 offset:38912
  ds_read_b64_tr_b16 a[40:41], v104 offset:40960
  ds_read_b64_tr_b16 a[42:43], v104 offset:45056
  ds_read_b64_tr_b16 a[44:45], v104 offset:43008
  ds_read_b64_tr_b16 a[46:47], v104 offset:47104
  ds_read_b64_tr_b16 a[48:49], v104 offset:49152
  ds_read_b64_tr_b16 a[50:51], v104 offset:53248
  ds_read_b64_tr_b16 a[52:53], v104 offset:51200
  ds_read_b64_tr_b16 a[54:55], v104 offset:55296
  ds_read_b64_tr_b16 a[56:57], v104 offset:57344
  ds_read_b64_tr_b16 a[58:59], v104 offset:61440
  ds_read_b64_tr_b16 a[60:61], v104 offset:59392
  ds_read_b64_tr_b16 a[62:63], v104 offset:63488
  s_waitcnt lgkmcnt(0)
  s_waitcnt vmcnt(16)
  s_barrier
  s_lshl_b32 s61, s34, 20
  s_lshl_b32 s62, s35, 8
  s_add_u32 s61, s61, s62
  s_add_u32 s61, s61, 655360
  s_add_u32 s61, s61, s63
  s_add_u32 m0, s60, 32768
  s_add_u32 s62, s61, 0
  buffer_load_dwordx4 v100, s[16:19], s62 offen lds
  s_add_u32 m0, s60, 33792
  s_add_u32 s62, s61, 4096
  buffer_load_dwordx4 v100, s[16:19], s62 offen lds
  s_add_u32 m0, s60, 34816
  s_add_u32 s62, s61, 8192
  buffer_load_dwordx4 v100, s[16:19], s62 offen lds
  s_add_u32 m0, s60, 35840
  s_add_u32 s62, s61, 12288
  buffer_load_dwordx4 v100, s[16:19], s62 offen lds
  s_add_u32 m0, s60, 36864
  s_add_u32 s62, s61, 16384
  buffer_load_dwordx4 v100, s[16:19], s62 offen lds
  s_add_u32 m0, s60, 37888
  s_add_u32 s62, s61, 20480
  buffer_load_dwordx4 v100, s[16:19], s62 offen lds
  s_add_u32 m0, s60, 38912
  s_add_u32 s62, s61, 24576
  buffer_load_dwordx4 v100, s[16:19], s62 offen lds
  s_add_u32 m0, s60, 39936
  s_add_u32 s62, s61, 28672
  buffer_load_dwordx4 v100, s[16:19], s62 offen lds
  ds_read_b64_tr_b16 a[64:65], v105 offset:0
  ds_read_b64_tr_b16 a[66:67], v105 offset:4096
  ds_read_b64_tr_b16 a[68:69], v105 offset:2048
  ds_read_b64_tr_b16 a[70:71], v105 offset:6144
  ds_read_b64_tr_b16 a[72:73], v105 offset:8192
  ds_read_b64_tr_b16 a[74:75], v105 offset:12288
  ds_read_b64_tr_b16 a[76:77], v105 offset:10240
  ds_read_b64_tr_b16 a[78:79], v105 offset:14336
  ds_read_b64_tr_b16 a[80:81], v105 offset:16384
  ds_read_b64_tr_b16 a[82:83], v105 offset:20480
  ds_read_b64_tr_b16 a[84:85], v105 offset:18432
  ds_read_b64_tr_b16 a[86:87], v105 offset:22528
  ds_read_b64_tr_b16 a[88:89], v105 offset:24576
  ds_read_b64_tr_b16 a[90:91], v105 offset:28672
  ds_read_b64_tr_b16 a[92:93], v105 offset:26624
  ds_read_b64_tr_b16 a[94:95], v105 offset:30720
  s_waitcnt lgkmcnt(0)
  s_waitcnt vmcnt(16)
  s_barrier
  s_lshl_b32 s61, s34, 20
  s_lshl_b32 s62, s35, 8
  s_add_u32 s61, s61, s62
  s_add_u32 s61, s61, 786432
  s_add_u32 s61, s61, s63
  s_add_u32 m0, s60, 65536
  s_add_u32 s62, s61, 0
  buffer_load_dwordx4 v100, s[16:19], s62 offen lds
  s_add_u32 m0, s60, 66560
  s_add_u32 s62, s61, 4096
  buffer_load_dwordx4 v100, s[16:19], s62 offen lds
  s_add_u32 m0, s60, 67584
  s_add_u32 s62, s61, 8192
  buffer_load_dwordx4 v100, s[16:19], s62 offen lds
  s_add_u32 m0, s60, 68608
  s_add_u32 s62, s61, 12288
  buffer_load_dwordx4 v100, s[16:19], s62 offen lds
  s_add_u32 m0, s60, 69632
  s_add_u32 s62, s61, 16384
  buffer_load_dwordx4 v100, s[16:19], s62 offen lds
  s_add_u32 m0, s60, 70656
  s_add_u32 s62, s61, 20480
  buffer_load_dwordx4 v100, s[16:19], s62 offen lds
  s_add_u32 m0, s60, 71680
  s_add_u32 s62, s61, 24576
  buffer_load_dwordx4 v100, s[16:19], s62 offen lds
  s_add_u32 m0, s60, 72704
  s_add_u32 s62, s61, 28672
  buffer_load_dwordx4 v100, s[16:19], s62 offen lds
  ds_read_b64_tr_b16 a[96:97], v105 offset:32768
  ds_read_b64_tr_b16 a[98:99], v105 offset:36864
  ds_read_b64_tr_b16 a[100:101], v105 offset:34816
  ds_read_b64_tr_b16 a[102:103], v105 offset:38912
  ds_read_b64_tr_b16 a[104:105], v105 offset:40960
  ds_read_b64_tr_b16 a[106:107], v105 offset:45056
  ds_read_b64_tr_b16 a[108:109], v105 offset:43008
  ds_read_b64_tr_b16 a[110:111], v105 offset:47104
  ds_read_b64_tr_b16 a[112:113], v105 offset:49152
  ds_read_b64_tr_b16 a[114:115], v105 offset:53248
  ds_read_b64_tr_b16 a[116:117], v105 offset:51200
  ds_read_b64_tr_b16 a[118:119], v105 offset:55296
  ds_read_b64_tr_b16 a[120:121], v105 offset:57344
  ds_read_b64_tr_b16 a[122:123], v105 offset:61440
  ds_read_b64_tr_b16 a[124:125], v105 offset:59392
  ds_read_b64_tr_b16 a[126:127], v105 offset:63488
  s_waitcnt lgkmcnt(0)
  s_waitcnt vmcnt(16)
  s_barrier
  s_lshl_b32 s61, s34, 20
  s_lshl_b32 s62, s35, 8
  s_add_u32 s61, s61, s62
  s_add_u32 s61, s61, 917504
  s_add_u32 s61, s61, s63
  s_add_u32 m0, s60, 98304
  s_add_u32 s62, s61, 0
  buffer_load_dwordx4 v100, s[16:19], s62 offen lds
  s_add_u32 m0, s60, 99328
  s_add_u32 s62, s61, 4096
  buffer_load_dwordx4 v100, s[16:19], s62 offen lds
  s_add_u32 m0, s60, 100352
  s_add_u32 s62, s61, 8192
  buffer_load_dwordx4 v100, s[16:19], s62 offen lds
  s_add_u32 m0, s60, 101376
  s_add_u32 s62, s61, 12288
  buffer_load_dwordx4 v100, s[16:19], s62 offen lds
  s_add_u32 m0, s60, 102400
  s_add_u32 s62, s61, 16384
  buffer_load_dwordx4 v100, s[16:19], s62 offen lds
  s_add_u32 m0, s60, 103424
  s_add_u32 s62, s61, 20480
  buffer_load_dwordx4 v100, s[16:19], s62 offen lds
  s_add_u32 m0, s60, 104448
  s_add_u32 s62, s61, 24576
  buffer_load_dwordx4 v100, s[16:19], s62 offen lds
  s_add_u32 m0, s60, 105472
  s_add_u32 s62, s61, 28672
  buffer_load_dwordx4 v100, s[16:19], s62 offen lds
  ds_read_b64_tr_b16 a[128:129], v104 offset:0
  ds_read_b64_tr_b16 a[130:131], v104 offset:4096
  ds_read_b64_tr_b16 a[132:133], v104 offset:2048
  ds_read_b64_tr_b16 a[134:135], v104 offset:6144
  ds_read_b64_tr_b16 a[136:137], v104 offset:8192
  ds_read_b64_tr_b16 a[138:139], v104 offset:12288
  ds_read_b64_tr_b16 a[140:141], v104 offset:10240
  ds_read_b64_tr_b16 a[142:143], v104 offset:14336
  ds_read_b64_tr_b16 a[144:145], v104 offset:16384
  ds_read_b64_tr_b16 a[146:147], v104 offset:20480
  ds_read_b64_tr_b16 a[148:149], v104 offset:18432
  ds_read_b64_tr_b16 a[150:151], v104 offset:22528
  ds_read_b64_tr_b16 a[152:153], v104 offset:24576
  ds_read_b64_tr_b16 a[154:155], v104 offset:28672
  ds_read_b64_tr_b16 a[156:157], v104 offset:26624
  ds_read_b64_tr_b16 a[158:159], v104 offset:30720
  s_waitcnt lgkmcnt(0)
  s_waitcnt vmcnt(16)
  s_barrier
  ds_read_b64_tr_b16 a[160:161], v104 offset:32768
  ds_read_b64_tr_b16 a[162:163], v104 offset:36864
  ds_read_b64_tr_b16 a[164:165], v104 offset:34816
  ds_read_b64_tr_b16 a[166:167], v104 offset:38912
  ds_read_b64_tr_b16 a[168:169], v104 offset:40960
  ds_read_b64_tr_b16 a[170:171], v104 offset:45056
  ds_read_b64_tr_b16 a[172:173], v104 offset:43008
  ds_read_b64_tr_b16 a[174:175], v104 offset:47104
  ds_read_b64_tr_b16 a[176:177], v104 offset:49152
  ds_read_b64_tr_b16 a[178:179], v104 offset:53248
  ds_read_b64_tr_b16 a[180:181], v104 offset:51200
  ds_read_b64_tr_b16 a[182:183], v104 offset:55296
  ds_read_b64_tr_b16 a[184:185], v104 offset:57344
  ds_read_b64_tr_b16 a[186:187], v104 offset:61440
  ds_read_b64_tr_b16 a[188:189], v104 offset:59392
  ds_read_b64_tr_b16 a[190:191], v104 offset:63488
  s_waitcnt lgkmcnt(0)
  s_waitcnt vmcnt(8)
  s_barrier
  ds_read_b64_tr_b16 a[192:193], v105 offset:0
  ds_read_b64_tr_b16 a[194:195], v105 offset:4096
  ds_read_b64_tr_b16 a[196:197], v105 offset:2048
  ds_read_b64_tr_b16 a[198:199], v105 offset:6144
  ds_read_b64_tr_b16 a[200:201], v105 offset:8192
  ds_read_b64_tr_b16 a[202:203], v105 offset:12288
  ds_read_b64_tr_b16 a[204:205], v105 offset:10240
  ds_read_b64_tr_b16 a[206:207], v105 offset:14336
  ds_read_b64_tr_b16 a[208:209], v105 offset:16384
  ds_read_b64_tr_b16 a[210:211], v105 offset:20480
  ds_read_b64_tr_b16 a[212:213], v105 offset:18432
  ds_read_b64_tr_b16 a[214:215], v105 offset:22528
  ds_read_b64_tr_b16 a[216:217], v105 offset:24576
  ds_read_b64_tr_b16 a[218:219], v105 offset:28672
  ds_read_b64_tr_b16 a[220:221], v105 offset:26624
  ds_read_b64_tr_b16 a[222:223], v105 offset:30720
  s_waitcnt lgkmcnt(0)
  s_waitcnt vmcnt(0)
  s_barrier
  ds_read_b64_tr_b16 a[224:225], v105 offset:32768
  ds_read_b64_tr_b16 a[226:227], v105 offset:36864
  ds_read_b64_tr_b16 a[228:229], v105 offset:34816
  ds_read_b64_tr_b16 a[230:231], v105 offset:38912
  ds_read_b64_tr_b16 a[232:233], v105 offset:40960
  ds_read_b64_tr_b16 a[234:235], v105 offset:45056
  ds_read_b64_tr_b16 a[236:237], v105 offset:43008
  ds_read_b64_tr_b16 a[238:239], v105 offset:47104
  ds_read_b64_tr_b16 a[240:241], v105 offset:49152
  ds_read_b64_tr_b16 a[242:243], v105 offset:53248
  ds_read_b64_tr_b16 a[244:245], v105 offset:51200
  ds_read_b64_tr_b16 a[246:247], v105 offset:55296
  ds_read_b64_tr_b16 a[248:249], v105 offset:57344
  ds_read_b64_tr_b16 a[250:251], v105 offset:61440
  ds_read_b64_tr_b16 a[252:253], v105 offset:59392
  ds_read_b64_tr_b16 a[254:255], v105 offset:63488
  s_waitcnt lgkmcnt(0)
  s_barrier
  v_mov_b32 v3, 0
  v_mov_b32 v1, v0
  v_bfe_u32 v2, v0, 6, 1
  v_lshlrev_b32 v2, 7, v2
  v_bfe_u32 v4, v0, 2, 4
  v_or_b32 v2, v2, v4
  v_bfe_u32 v6, v0, 2, 4
  v_and_b32 v6, 12, v6
  s_mov_b32 s7, 0
  v_mbcnt_lo_u32_b32 v16, -1, 0
  v_and_b32 v16, 3, v16
  v_lshlrev_b32 v16, 6, v16
L_wd_99:
  buffer_load_dword v17, v16, s[12:15], 0 offen offset:16 sc1
  s_waitcnt vmcnt(0)
  v_cmp_ne_u32 vcc, 64, v17
  s_cbranch_vccz L_wdo_100
  s_add_u32 s7, s7, 1
  s_cmp_lt_u32 s7, 131072
  s_cbranch_scc1 L_wd_99
  s_mov_b32 s6, 30
  s_branch L_err
L_wdo_100:
  s_mov_b32 s32, 0
  s_mov_b32 s41, 1
  s_mov_b32 s40, s38
L_o_wait:
  s_mov_b32 s7, 0
L_pl_101:
  buffer_load_dword v4, v2, s[8:11], s40 offen offset:0 sc1
  s_waitcnt vmcnt(0)
  v_cmp_gt_u32 vcc, s41, v4
  s_cbranch_vccz L_plo_102
  s_add_u32 s7, s7, 1
  s_cmp_lt_u32 s7, 131072
  s_cbranch_scc1 L_pl_101
  s_mov_b32 s6, 31
  s_branch L_err
L_plo_102:
  s_sub_u32 s6, s41, 1
  s_lshl_b32 s6, s6, 18
  s_add_u32 s44, s36, s6
  s_add_u32 m0, s42, 0
  s_add_u32 s45, s44, 0
  buffer_load_dwordx4 v0, s[8:11], s45 offen offset:0 lds
  buffer_load_dwordx4 v0, s[8:11], s45 offen offset:1024 lds
  buffer_load_dwordx4 v0, s[8:11], s45 offen offset:2048 lds
  buffer_load_dwordx4 v0, s[8:11], s45 offen offset:3072 lds
  s_add_u32 m0, s42, 4096
  s_add_u32 s45, s44, 4096
  buffer_load_dwordx4 v0, s[8:11], s45 offen offset:0 lds
  buffer_load_dwordx4 v0, s[8:11], s45 offen offset:1024 lds
  buffer_load_dwordx4 v0, s[8:11], s45 offen offset:2048 lds
  buffer_load_dwordx4 v0, s[8:11], s45 offen offset:3072 lds
  s_add_u32 m0, s42, 8192
  s_add_u32 s45, s44, 8192
  buffer_load_dwordx4 v0, s[8:11], s45 offen offset:0 lds
  buffer_load_dwordx4 v0, s[8:11], s45 offen offset:1024 lds
  buffer_load_dwordx4 v0, s[8:11], s45 offen offset:2048 lds
  buffer_load_dwordx4 v0, s[8:11], s45 offen offset:3072 lds
  s_add_u32 m0, s42, 12288
  s_add_u32 s45, s44, 12288
  buffer_load_dwordx4 v0, s[8:11], s45 offen offset:0 lds
  buffer_load_dwordx4 v0, s[8:11], s45 offen offset:1024 lds
  buffer_load_dwordx4 v0, s[8:11], s45 offen offset:2048 lds
  buffer_load_dwordx4 v0, s[8:11], s45 offen offset:3072 lds
  s_xor_b32 s42, s42, 0x10000
  s_mov_b32 s43, 0
  s_waitcnt vmcnt(8)
L_o_loop:
  s_barrier
  ds_read_b128 v[32:35], v1 offset:0
  ds_read_b128 v[36:39], v1 offset:1024
  ds_read_b128 v[40:43], v1 offset:2048
  s_add_u32 s41, s32, 2
  s_xor_b32 s40, s40, 0x1000
  buffer_load_dword v4, v2, s[8:11], s40 offen sc1
  buffer_load_dword v5, v6, s[8:11], s39 offen sc1
  s_waitcnt lgkmcnt(2)
  v_mfma_f32_32x32x16_bf16 v[16:31], a[0:3], v[32:35], 0
  ds_read_b128 v[44:47], v1 offset:3072
  s_waitcnt lgkmcnt(2)
  v_mfma_f32_32x32x16_bf16 v[16:31], a[4:7], v[36:39], v[16:31]
  ds_read_b128 v[32:35], v1 offset:4096
  s_waitcnt lgkmcnt(2)
  v_mfma_f32_32x32x16_bf16 v[16:31], a[8:11], v[40:43], v[16:31]
  ds_read_b128 v[36:39], v1 offset:5120
  s_waitcnt lgkmcnt(2)
  v_mfma_f32_32x32x16_bf16 v[16:31], a[12:15], v[44:47], v[16:31]
  ds_read_b128 v[40:43], v1 offset:6144
  s_waitcnt lgkmcnt(2)
  v_mfma_f32_32x32x16_bf16 v[16:31], a[16:19], v[32:35], v[16:31]
  ds_read_b128 v[44:47], v1 offset:7168
  s_waitcnt lgkmcnt(2)
  v_mfma_f32_32x32x16_bf16 v[16:31], a[20:23], v[36:39], v[16:31]
  ds_read_b128 v[32:35], v1 offset:16384
  s_waitcnt lgkmcnt(2)
  v_mfma_f32_32x32x16_bf16 v[16:31], a[24:27], v[40:43], v[16:31]
  ds_read_b128 v[36:39], v1 offset:17408
  s_waitcnt lgkmcnt(2)
  v_mfma_f32_32x32x16_bf16 v[16:31], a[28:31], v[44:47], v[16:31]
  ds_read_b128 v[40:43], v1 offset:18432
  s_waitcnt lgkmcnt(2)
  v_mfma_f32_32x32x16_bf16 v[16:31], a[64:67], v[32:35], v[16:31]
  ds_read_b128 v[44:47], v1 offset:19456
  s_waitcnt lgkmcnt(2)
  v_mfma_f32_32x32x16_bf16 v[16:31], a[68:71], v[36:39], v[16:31]
  ds_read_b128 v[32:35], v1 offset:20480
  s_waitcnt lgkmcnt(2)
  v_mfma_f32_32x32x16_bf16 v[16:31], a[72:75], v[40:43], v[16:31]
  ds_read_b128 v[36:39], v1 offset:21504
  s_waitcnt lgkmcnt(2)
  v_mfma_f32_32x32x16_bf16 v[16:31], a[76:79], v[44:47], v[16:31]
  ds_read_b128 v[40:43], v1 offset:22528
  s_waitcnt lgkmcnt(2)
  v_mfma_f32_32x32x16_bf16 v[16:31], a[80:83], v[32:35], v[16:31]
  ds_read_b128 v[44:47], v1 offset:23552
  s_waitcnt lgkmcnt(2)
  v_mfma_f32_32x32x16_bf16 v[16:31], a[84:87], v[36:39], v[16:31]
  ds_read_b128 v[32:35], v1 offset:32768
  s_waitcnt lgkmcnt(2)
  v_mfma_f32_32x32x16_bf16 v[16:31], a[88:91], v[40:43], v[16:31]
  ds_read_b128 v[36:39], v1 offset:33792
  s_waitcnt lgkmcnt(2)
  v_mfma_f32_32x32x16_bf16 v[16:31], a[92:95], v[44:47], v[16:31]
  ds_read_b128 v[40:43], v1 offset:34816
  s_waitcnt lgkmcnt(2)
  v_mfma_f32_32x32x16_bf16 v[16:31], a[128:131], v[32:35], v[16:31]
  ds_read_b128 v[44:47], v1 offset:35840
  s_waitcnt lgkmcnt(2)
  v_mfma_f32_32x32x16_bf16 v[16:31], a[132:135], v[36:39], v[16:31]
  ds_read_b128 v[32:35], v1 offset:36864
  s_waitcnt lgkmcnt(2)
  v_mfma_f32_32x32x16_bf16 v[16:31], a[136:139], v[40:43], v[16:31]
  ds_read_b128 v[36:39], v1 offset:37888
  s_waitcnt lgkmcnt(2)
  v_mfma_f32_32x32x16_bf16 v[16:31], a[140:143], v[44:47], v[16:31]
  ds_read_b128 v[40:43], v1 offset:38912
  s_waitcnt lgkmcnt(2)
  v_mfma_f32_32x32x16_bf16 v[16:31], a[144:147], v[32:35], v[16:31]
  ds_read_b128 v[44:47], v1 offset:39936
  s_waitcnt lgkmcnt(2)
  v_mfma_f32_32x32x16_bf16 v[16:31], a[148:151], v[36:39], v[16:31]
  ds_read_b128 v[32:35], v1 offset:49152
  s_waitcnt lgkmcnt(2)
  v_mfma_f32_32x32x16_bf16 v[16:31], a[152:155], v[40:43], v[16:31]
  ds_read_b128 v[36:39], v1 offset:50176
  s_waitcnt lgkmcnt(2)
  v_mfma_f32_32x32x16_bf16 v[16:31], a[156:159], v[44:47], v[16:31]
  ds_read_b128 v[40:43], v1 offset:51200
  s_waitcnt lgkmcnt(2)
  v_mfma_f32_32x32x16_bf16 v[16:31], a[192:195], v[32:35], v[16:31]
  ds_read_b128 v[44:47], v1 offset:52224
  s_waitcnt lgkmcnt(2)
  v_mfma_f32_32x32x16_bf16 v[16:31], a[196:199], v[36:39], v[16:31]
  ds_read_b128 v[32:35], v1 offset:53248
  s_waitcnt lgkmcnt(2)
  v_mfma_f32_32x32x16_bf16 v[16:31], a[200:203], v[40:43], v[16:31]
  ds_read_b128 v[36:39], v1 offset:54272
  s_waitcnt lgkmcnt(2)
  v_mfma_f32_32x32x16_bf16 v[16:31], a[204:207], v[44:47], v[16:31]
  ds_read_b128 v[40:43], v1 offset:55296
  s_waitcnt lgkmcnt(2)
  v_mfma_f32_32x32x16_bf16 v[16:31], a[208:211], v[32:35], v[16:31]
  ds_read_b128 v[44:47], v1 offset:56320
  s_waitcnt lgkmcnt(2)
  v_mfma_f32_32x32x16_bf16 v[16:31], a[212:215], v[36:39], v[16:31]
  s_waitcnt lgkmcnt(1)
  v_mfma_f32_32x32x16_bf16 v[16:31], a[216:219], v[40:43], v[16:31]
  s_waitcnt lgkmcnt(0)
  v_mfma_f32_32x32x16_bf16 v[16:31], a[220:223], v[44:47], v[16:31]
  s_waitcnt vmcnt(0)
  s_barrier
  ds_read_b128 v[32:35], v1 offset:8192
  ds_read_b128 v[36:39], v1 offset:9216
  ds_read_b128 v[40:43], v1 offset:10240
  s_mov_b32 s43, 0
  s_cmp_eq_u32 s32, 63
  s_cbranch_scc1 L_on_103
  v_cmp_gt_u32 vcc, s41, v4
  s_cbranch_vccnz L_on_103
  s_mov_b32 s43, 1
  s_waitcnt lgkmcnt(2)
  v_mfma_f32_32x32x16_bf16 v[16:31], a[32:35], v[32:35], v[16:31]
  ds_read_b128 v[44:47], v1 offset:11264
  s_sub_u32 s6, s41, 1
  s_lshl_b32 s6, s6, 18
  s_add_u32 s44, s36, s6
  s_waitcnt lgkmcnt(2)
  v_mfma_f32_32x32x16_bf16 v[16:31], a[36:39], v[36:39], v[16:31]
  ds_read_b128 v[32:35], v1 offset:12288
  s_add_u32 m0, s42, 0
  s_add_u32 s45, s44, 0
  buffer_load_dwordx4 v0, s[8:11], s45 offen offset:0 lds
  s_waitcnt lgkmcnt(2)
  v_mfma_f32_32x32x16_bf16 v[16:31], a[40:43], v[40:43], v[16:31]
  ds_read_b128 v[36:39], v1 offset:13312
  buffer_load_dwordx4 v0, s[8:11], s45 offen offset:1024 lds
  s_waitcnt lgkmcnt(2)
  v_mfma_f32_32x32x16_bf16 v[16:31], a[44:47], v[44:47], v[16:31]
  ds_read_b128 v[40:43], v1 offset:14336
  buffer_load_dwordx4 v0, s[8:11], s45 offen offset:2048 lds
  s_waitcnt lgkmcnt(2)
  v_mfma_f32_32x32x16_bf16 v[16:31], a[48:51], v[32:35], v[16:31]
  ds_read_b128 v[44:47], v1 offset:15360
  buffer_load_dwordx4 v0, s[8:11], s45 offen offset:3072 lds
  s_waitcnt lgkmcnt(2)
  v_mfma_f32_32x32x16_bf16 v[16:31], a[52:55], v[36:39], v[16:31]
  ds_read_b128 v[32:35], v1 offset:24576
  s_waitcnt lgkmcnt(2)
  v_mfma_f32_32x32x16_bf16 v[16:31], a[56:59], v[40:43], v[16:31]
  ds_read_b128 v[36:39], v1 offset:25600
  s_add_u32 m0, s42, 4096
  s_add_u32 s45, s44, 4096
  buffer_load_dwordx4 v0, s[8:11], s45 offen offset:0 lds
  s_waitcnt lgkmcnt(2)
  v_mfma_f32_32x32x16_bf16 v[16:31], a[60:63], v[44:47], v[16:31]
  ds_read_b128 v[40:43], v1 offset:26624
  s_waitcnt lgkmcnt(2)
  v_mfma_f32_32x32x16_bf16 v[16:31], a[96:99], v[32:35], v[16:31]
  ds_read_b128 v[44:47], v1 offset:27648
  buffer_load_dwordx4 v0, s[8:11], s45 offen offset:1024 lds
  s_waitcnt lgkmcnt(2)
  v_mfma_f32_32x32x16_bf16 v[16:31], a[100:103], v[36:39], v[16:31]
  ds_read_b128 v[32:35], v1 offset:28672
  s_waitcnt lgkmcnt(2)
  v_mfma_f32_32x32x16_bf16 v[16:31], a[104:107], v[40:43], v[16:31]
  ds_read_b128 v[36:39], v1 offset:29696
  buffer_load_dwordx4 v0, s[8:11], s45 offen offset:2048 lds
  s_waitcnt lgkmcnt(2)
  v_mfma_f32_32x32x16_bf16 v[16:31], a[108:111], v[44:47], v[16:31]
  ds_read_b128 v[40:43], v1 offset:30720
  s_waitcnt lgkmcnt(2)
  v_mfma_f32_32x32x16_bf16 v[16:31], a[112:115], v[32:35], v[16:31]
  ds_read_b128 v[44:47], v1 offset:31744
  buffer_load_dwordx4 v0, s[8:11], s45 offen offset:3072 lds
  s_waitcnt lgkmcnt(2)
  v_mfma_f32_32x32x16_bf16 v[16:31], a[116:119], v[36:39], v[16:31]
  ds_read_b128 v[32:35], v1 offset:40960
  s_waitcnt lgkmcnt(2)
  v_mfma_f32_32x32x16_bf16 v[16:31], a[120:123], v[40:43], v[16:31]
  ds_read_b128 v[36:39], v1 offset:41984
  s_add_u32 m0, s42, 8192
  s_add_u32 s45, s44, 8192
  buffer_load_dwordx4 v0, s[8:11], s45 offen offset:0 lds
  s_waitcnt lgkmcnt(2)
  v_mfma_f32_32x32x16_bf16 v[16:31], a[124:127], v[44:47], v[16:31]
  ds_read_b128 v[40:43], v1 offset:43008
  s_waitcnt lgkmcnt(2)
  v_mfma_f32_32x32x16_bf16 v[16:31], a[160:163], v[32:35], v[16:31]
  ds_read_b128 v[44:47], v1 offset:44032
  buffer_load_dwordx4 v0, s[8:11], s45 offen offset:1024 lds
  s_waitcnt lgkmcnt(2)
  v_mfma_f32_32x32x16_bf16 v[16:31], a[164:167], v[36:39], v[16:31]
  ds_read_b128 v[32:35], v1 offset:45056
  s_waitcnt lgkmcnt(2)
  v_mfma_f32_32x32x16_bf16 v[16:31], a[168:171], v[40:43], v[16:31]
  ds_read_b128 v[36:39], v1 offset:46080
  buffer_load_dwordx4 v0, s[8:11], s45 offen offset:2048 lds
  s_waitcnt lgkmcnt(2)
  v_mfma_f32_32x32x16_bf16 v[16:31], a[172:175], v[44:47], v[16:31]
  ds_read_b128 v[40:43], v1 offset:47104
  s_waitcnt lgkmcnt(2)
  v_mfma_f32_32x32x16_bf16 v[16:31], a[176:179], v[32:35], v[16:31]
  ds_read_b128 v[44:47], v1 offset:48128
  buffer_load_dwordx4 v0, s[8:11], s45 offen offset:3072 lds
  s_waitcnt lgkmcnt(2)
  v_mfma_f32_32x32x16_bf16 v[16:31], a[180:183], v[36:39], v[16:31]
  ds_read_b128 v[32:35], v1 offset:57344
  s_waitcnt lgkmcnt(2)
  v_mfma_f32_32x32x16_bf16 v[16:31], a[184:187], v[40:43], v[16:31]
  ds_read_b128 v[36:39], v1 offset:58368
  s_add_u32 m0, s42, 12288
  s_add_u32 s45, s44, 12288
  buffer_load_dwordx4 v0, s[8:11], s45 offen offset:0 lds
  s_waitcnt lgkmcnt(2)
  v_mfma_f32_32x32x16_bf16 v[16:31], a[188:191], v[44:47], v[16:31]
  ds_read_b128 v[40:43], v1 offset:59392
  s_waitcnt lgkmcnt(2)
  v_mfma_f32_32x32x16_bf16 v[16:31], a[224:227], v[32:35], v[16:31]
  ds_read_b128 v[44:47], v1 offset:60416
  buffer_load_dwordx4 v0, s[8:11], s45 offen offset:1024 lds
  s_waitcnt lgkmcnt(2)
  v_mfma_f32_32x32x16_bf16 v[16:31], a[228:231], v[36:39], v[16:31]
  ds_read_b128 v[32:35], v1 offset:61440
  s_waitcnt lgkmcnt(2)
  v_mfma_f32_32x32x16_bf16 v[16:31], a[232:235], v[40:43], v[16:31]
  ds_read_b128 v[36:39], v1 offset:62464
  buffer_load_dwordx4 v0, s[8:11], s45 offen offset:2048 lds
  s_waitcnt lgkmcnt(2)
  v_mfma_f32_32x32x16_bf16 v[16:31], a[236:239], v[44:47], v[16:31]
  ds_read_b128 v[40:43], v1 offset:63488
  s_waitcnt lgkmcnt(2)
  v_mfma_f32_32x32x16_bf16 v[16:31], a[240:243], v[32:35], v[16:31]
  ds_read_b128 v[44:47], v1 offset:64512
  buffer_load_dwordx4 v0, s[8:11], s45 offen offset:3072 lds
  s_waitcnt lgkmcnt(2)
  v_mfma_f32_32x32x16_bf16 v[16:31], a[244:247], v[36:39], v[16:31]
  s_waitcnt lgkmcnt(1)
  v_mfma_f32_32x32x16_bf16 v[16:31], a[248:251], v[40:43], v[16:31]
  s_xor_b32 s42, s42, 0x10000
  s_waitcnt lgkmcnt(0)
  v_mfma_f32_32x32x16_bf16 v[16:31], a[252:255], v[44:47], v[16:31]
  s_branch L_o_h2
L_on_103:
  s_waitcnt lgkmcnt(2)
  v_mfma_f32_32x32x16_bf16 v[16:31], a[32:35], v[32:35], v[16:31]
  ds_read_b128 v[44:47], v1 offset:11264
  s_waitcnt lgkmcnt(2)
  v_mfma_f32_32x32x16_bf16 v[16:31], a[36:39], v[36:39], v[16:31]
  ds_read_b128 v[32:35], v1 offset:12288
  s_waitcnt lgkmcnt(2)
  v_mfma_f32_32x32x16_bf16 v[16:31], a[40:43], v[40:43], v[16:31]
  ds_read_b128 v[36:39], v1 offset:13312
  s_waitcnt lgkmcnt(2)
  v_mfma_f32_32x32x16_bf16 v[16:31], a[44:47], v[44:47], v[16:31]
  ds_read_b128 v[40:43], v1 offset:14336
  s_waitcnt lgkmcnt(2)
  v_mfma_f32_32x32x16_bf16 v[16:31], a[48:51], v[32:35], v[16:31]
  ds_read_b128 v[44:47], v1 offset:15360
  s_waitcnt lgkmcnt(2)
  v_mfma_f32_32x32x16_bf16 v[16:31], a[52:55], v[36:39], v[16:31]
  ds_read_b128 v[32:35], v1 offset:24576
  s_waitcnt lgkmcnt(2)
  v_mfma_f32_32x32x16_bf16 v[16:31], a[56:59], v[40:43], v[16:31]
  ds_read_b128 v[36:39], v1 offset:25600
  s_waitcnt lgkmcnt(2)
  v_mfma_f32_32x32x16_bf16 v[16:31], a[60:63], v[44:47], v[16:31]
  ds_read_b128 v[40:43], v1 offset:26624
  s_waitcnt lgkmcnt(2)
  v_mfma_f32_32x32x16_bf16 v[16:31], a[96:99], v[32:35], v[16:31]
  ds_read_b128 v[44:47], v1 offset:27648
  s_waitcnt lgkmcnt(2)
  v_mfma_f32_32x32x16_bf16 v[16:31], a[100:103], v[36:39], v[16:31]
  ds_read_b128 v[32:35], v1 offset:28672
  s_waitcnt lgkmcnt(2)
  v_mfma_f32_32x32x16_bf16 v[16:31], a[104:107], v[40:43], v[16:31]
  ds_read_b128 v[36:39], v1 offset:29696
  s_waitcnt lgkmcnt(2)
  v_mfma_f32_32x32x16_bf16 v[16:31], a[108:111], v[44:47], v[16:31]
  ds_read_b128 v[40:43], v1 offset:30720
  s_waitcnt lgkmcnt(2)
  v_mfma_f32_32x32x16_bf16 v[16:31], a[112:115], v[32:35], v[16:31]
  ds_read_b128 v[44:47], v1 offset:31744
  s_waitcnt lgkmcnt(2)
  v_mfma_f32_32x32x16_bf16 v[16:31], a[116:119], v[36:39], v[16:31]
  ds_read_b128 v[32:35], v1 offset:40960
  s_waitcnt lgkmcnt(2)
  v_mfma_f32_32x32x16_bf16 v[16:31], a[120:123], v[40:43], v[16:31]
  ds_read_b128 v[36:39], v1 offset:41984
  s_waitcnt lgkmcnt(2)
  v_mfma_f32_32x32x16_bf16 v[16:31], a[124:127], v[44:47], v[16:31]
  ds_read_b128 v[40:43], v1 offset:43008
  s_waitcnt lgkmcnt(2)
  v_mfma_f32_32x32x16_bf16 v[16:31], a[160:163], v[32:35], v[16:31]
  ds_read_b128 v[44:47], v1 offset:44032
  s_waitcnt lgkmcnt(2)
  v_mfma_f32_32x32x16_bf16 v[16:31], a[164:167], v[36:39], v[16:31]
  ds_read_b128 v[32:35], v1 offset:45056
  s_waitcnt lgkmcnt(2)
  v_mfma_f32_32x32x16_bf16 v[16:31], a[168:171], v[40:43], v[16:31]
  ds_read_b128 v[36:39], v1 offset:46080
  s_waitcnt lgkmcnt(2)
  v_mfma_f32_32x32x16_bf16 v[16:31], a[172:175], v[44:47], v[16:31]
  ds_read_b128 v[40:43], v1 offset:47104
  s_waitcnt lgkmcnt(2)
  v_mfma_f32_32x32x16_bf16 v[16:31], a[176:179], v[32:35], v[16:31]
  ds_read_b128 v[44:47], v1 offset:48128
  s_waitcnt lgkmcnt(2)
  v_mfma_f32_32x32x16_bf16 v[16:31], a[180:183], v[36:39], v[16:31]
  ds_read_b128 v[32:35], v1 offset:57344
  s_waitcnt lgkmcnt(2)
  v_mfma_f32_32x32x16_bf16 v[16:31], a[184:187], v[40:43], v[16:31]
  ds_read_b128 v[36:39], v1 offset:58368
  s_waitcnt lgkmcnt(2)
  v_mfma_f32_32x32x16_bf16 v[16:31], a[188:191], v[44:47], v[16:31]
  ds_read_b128 v[40:43], v1 offset:59392
  s_waitcnt lgkmcnt(2)
  v_mfma_f32_32x32x16_bf16 v[16:31], a[224:227], v[32:35], v[16:31]
  ds_read_b128 v[44:47], v1 offset:60416
  s_waitcnt lgkmcnt(2)
  v_mfma_f32_32x32x16_bf16 v[16:31], a[228:231], v[36:39], v[16:31]
  ds_read_b128 v[32:35], v1 offset:61440
  s_waitcnt lgkmcnt(2)
  v_mfma_f32_32x32x16_bf16 v[16:31], a[232:235], v[40:43], v[16:31]
  ds_read_b128 v[36:39], v1 offset:62464
  s_waitcnt lgkmcnt(2)
  v_mfma_f32_32x32x16_bf16 v[16:31], a[236:239], v[44:47], v[16:31]
  ds_read_b128 v[40:43], v1 offset:63488
  s_waitcnt lgkmcnt(2)
  v_mfma_f32_32x32x16_bf16 v[16:31], a[240:243], v[32:35], v[16:31]
  ds_read_b128 v[44:47], v1 offset:64512
  s_waitcnt lgkmcnt(2)
  v_mfma_f32_32x32x16_bf16 v[16:31], a[244:247], v[36:39], v[16:31]
  s_waitcnt lgkmcnt(1)
  v_mfma_f32_32x32x16_bf16 v[16:31], a[248:251], v[40:43], v[16:31]
  s_waitcnt lgkmcnt(0)
  v_mfma_f32_32x32x16_bf16 v[16:31], a[252:255], v[44:47], v[16:31]
L_o_h2:
  s_sub_u32 s45, s32, 3
  v_cmp_gt_i32 vcc, s45, v5
  s_cbranch_vccz L_o_free
  s_mov_b32 s7, 0
L_o_bp:
  buffer_load_dword v5, v6, s[8:11], s39 offen sc1
  s_waitcnt vmcnt(0)
  v_cmp_gt_i32 vcc, s45, v5
  s_cbranch_vccz L_o_free
  s_add_u32 s7, s7, 1
  s_cmp_lt_u32 s7, 131072
  s_cbranch_scc1 L_o_bp
  s_mov_b32 s6, 32
  s_branch L_err
L_o_free:
  s_and_b32 s6, s32, 3
  s_lshl_b32 s6, s6, 17
  s_add_u32 s44, s37, s6
  s_lshr_b32 s6, s32, 2
  s_andn2_b32 s45, 1, s6
  s_add_u32 s32, s32, 1
  v_xor_b32 v1, 0x10000, v1
  s_nop 1
  v_cvt_pk_bf16_f32 v48, v16, v17
  v_cvt_pk_bf16_f32 v49, v18, v19
  v_cvt_pk_bf16_f32 v50, v20, v21
  v_cvt_pk_bf16_f32 v51, v22, v23
  v_bfi_b32 v48, 1, s45, v48
  buffer_store_dwordx4 v[48:51], v0, s[8:11], s44 offen offset:0 sc1
  v_cvt_pk_bf16_f32 v52, v24, v25
  v_cvt_pk_bf16_f32 v53, v26, v27
  v_cvt_pk_bf16_f32 v54, v28, v29
  v_cvt_pk_bf16_f32 v55, v30, v31
  v_bfi_b32 v52, 1, s45, v52
  buffer_store_dwordx4 v[52:55], v0, s[8:11], s44 offen offset:1024 sc1
  s_cmp_eq_u32 s43, 0
  s_waitcnt vmcnt(2)
  s_cbranch_scc0 L_o_loop
  s_cmp_lt_u32 s32, 64
  s_cbranch_scc1 L_o_wait
  s_waitcnt vmcnt(0)
  s_endpgm
L_pro:
  s_max_u32 s6, s4, 3
  s_sub_u32 s6, s6, 3
  s_lshl_b32 s6, s6, 5
  s_add_u32 s6, s6, s5
  s_lshl_b32 s62, s6, 15
  s_lshl_b32 s6, s6, 2
  s_add_u32 s60, s6, s3
  s_lshl_b32 s6, s60, 2
  s_add_u32 s6, s6, 0x710000
  v_mov_b32 v1, 0
  v_lshlrev_b32 v2, 4, v0
  s_mov_b64 exec, 1
  buffer_store_dword v1, v1, s[8:11], s6 offen sc1
  s_mov_b64 exec, -1
  v_lshlrev_b32 v16, 2, v0
  s_lshl_b32 s6, s60, 8
  s_lshl_b32 s7, s60, 1
  s_mov_b32 s16, s66
  s_mov_b32 s17, s67
  s_mov_b32 s18, 0x20000
  s_mov_b32 s19, 0x20000
  buffer_load_dword v20, v16, s[16:19], s6 offen
  s_mov_b32 s20, s68
  s_mov_b32 s21, s69
  s_mov_b32 s22, 0x20000
  s_mov_b32 s23, 0x20000
  buffer_load_dword v21, v16, s[20:23], s6 offen
  s_mov_b32 s24, s70
  s_mov_b32 s25, s71
  s_mov_b32 s26, 0x20000
  s_mov_b32 s27, 0x20000
  buffer_load_dword v22, v16, s[24:27], s6 offen
  s_mov_b32 s28, s72
  s_mov_b32 s29, s73
  s_mov_b32 s30, 0x20000
  s_mov_b32 s31, 0x20000
  buffer_load_dword v23, v16, s[28:31], s6 offen
  s_mov_b32 s16, s74
  s_mov_b32 s17, s75
  s_mov_b32 s18, 0x400
  s_mov_b32 s19, 0x20000
  buffer_load_ushort v24, v1, s[16:19], s7 offen
  s_mov_b32 s20, s76
  s_mov_b32 s21, s77
  s_mov_b32 s22, 0x400
  s_mov_b32 s23, 0x20000
  buffer_load_ushort v232, v1, s[20:23], s7 offen
  s_waitcnt vmcnt(6)
  s_barrier
  s_cmp_lg_u32 s3, 0
  s_cbranch_scc1 L_sd_104
  s_mov_b64 exec, 1
  s_and_b32 s6, s4, 3
  s_lshl_b32 s6, s6, 6
  v_mov_b32 v18, 16
  v_mov_b32 v19, 1
  buffer_atomic_add v19, v18, s[12:15], s6 offen sc1
  s_mov_b64 exec, -1
L_sd_104:
  v_and_b32 v16, 15, v0
  v_and_b32 v17, 7, v16
  v_lshrrev_b32 v18, 3, v16
  v_lshl_add_u32 v19, v18, 7, v17
  v_add_u32 v19, 1, v19
  v_cvt_f32_u32 v4, v19
  v_and_b32 v19, 3, v16
  v_lshrrev_b32 v25, 2, v16
  v_lshlrev_b32 v25, 6, v25
  v_add_u32 v19, v19, v25
  v_lshlrev_b32 v19, 1, v19
  v_add_u32 v19, 258, v19
  v_cmp_gt_u32 vcc, 8, v16
  s_nop 1
  v_cndmask_b32 v19, 0, v19, vcc
  v_cvt_f32_u32 v5, v19
  v_and_b32 v19, 1, v16
  v_lshrrev_b32 v25, 1, v17
  v_lshlrev_b32 v25, 7, v25
  v_lshl_add_u32 v19, v19, 2, v25
  v_add_u32 v19, 516, v19
  v_lshlrev_b32 v25, 7, v17
  v_add_u32 v25, 1032, v25
  v_cndmask_b32 v19, v25, v19, vcc
  v_cvt_f32_u32 v6, v19
  v_lshlrev_b32 v19, 3, v16
  v_cvt_f32_u32 v7, v19
  v_lshrrev_b32 v19, 4, v0
  s_lshl_b32 s6, s3, 11
  v_lshl_add_u32 v3, v19, 6, s6
  v_lshlrev_b32 v16, 4, v0
  v_cvt_f32_u32 v16, v16
  s_mul_i32 s63, s3, 4352
  s_add_u32 s63, s63, 8192
  v_sub_f32 v17, 0x45800000, v16
  v_sub_f32 v18, 0x457fe000, v16
  v_cvt_pk_bf16_f32 v17, v17, v18
  v_lshlrev_b32 v160, 16, v17
  v_and_b32 v161, 0xffff0000, v17
  v_cvt_u32_f32 v160, v160
  v_cvt_u32_f32 v161, v161
  v_add_u32 v160, s63, v160
  v_add_u32 v161, s63, v161
  v_sub_f32 v17, 0x457fc000, v16
  v_sub_f32 v18, 0x457fa000, v16
  v_cvt_pk_bf16_f32 v17, v17, v18
  v_lshlrev_b32 v162, 16, v17
  v_and_b32 v163, 0xffff0000, v17
  v_cvt_u32_f32 v162, v162
  v_cvt_u32_f32 v163, v163
  v_add_u32 v162, s63, v162
  v_add_u32 v163, s63, v163
  v_sub_f32 v17, 0x457f8000, v16
  v_sub_f32 v18, 0x457f6000, v16
  v_cvt_pk_bf16_f32 v17, v17, v18
  v_lshlrev_b32 v164, 16, v17
  v_and_b32 v165, 0xffff0000, v17
  v_cvt_u32_f32 v164, v164
  v_cvt_u32_f32 v165, v165
  v_add_u32 v164, s63, v164
  v_add_u32 v165, s63, v165
  v_sub_f32 v17, 0x457f4000, v16
  v_sub_f32 v18, 0x457f2000, v16
  v_cvt_pk_bf16_f32 v17, v17, v18
  v_lshlrev_b32 v166, 16, v17
  v_and_b32 v167, 0xffff0000, v17
  v_cvt_u32_f32 v166, v166
  v_cvt_u32_f32 v167, v167
  v_add_u32 v166, s63, v166
  v_add_u32 v167, s63, v167
  v_sub_f32 v17, 0x45400000, v16
  v_sub_f32 v18, 0x453fe000, v16
  v_cvt_pk_bf16_f32 v17, v17, v18
  v_lshlrev_b32 v168, 16, v17
  v_and_b32 v169, 0xffff0000, v17
  v_cvt_u32_f32 v168, v168
  v_cvt_u32_f32 v169, v169
  v_add_u32 v168, s63, v168
  v_add_u32 v169, s63, v169
  v_sub_f32 v17, 0x453fc000, v16
  v_sub_f32 v18, 0x453fa000, v16
  v_cvt_pk_bf16_f32 v17, v17, v18
  v_lshlrev_b32 v170, 16, v17
  v_and_b32 v171, 0xffff0000, v17
  v_cvt_u32_f32 v170, v170
  v_cvt_u32_f32 v171, v171
  v_add_u32 v170, s63, v170
  v_add_u32 v171, s63, v171
  v_sub_f32 v17, 0x453f8000, v16
  v_sub_f32 v18, 0x453f6000, v16
  v_cvt_pk_bf16_f32 v17, v17, v18
  v_lshlrev_b32 v172, 16, v17
  v_and_b32 v173, 0xffff0000, v17
  v_cvt_u32_f32 v172, v172
  v_cvt_u32_f32 v173, v173
  v_add_u32 v172, s63, v172
  v_add_u32 v173, s63, v173
  v_sub_f32 v17, 0x453f4000, v16
  v_sub_f32 v18, 0x453f2000, v16
  v_cvt_pk_bf16_f32 v17, v17, v18
  v_lshlrev_b32 v174, 16, v17
  v_and_b32 v175, 0xffff0000, v17
  v_cvt_u32_f32 v174, v174
  v_cvt_u32_f32 v175, v175
  v_add_u32 v174, s63, v174
  v_add_u32 v175, s63, v175
  v_sub_f32 v17, 0x45000000, v16
  v_sub_f32 v18, 0x44ffc000, v16
  v_cvt_pk_bf16_f32 v17, v17, v18
  v_lshlrev_b32 v176, 16, v17
  v_and_b32 v177, 0xffff0000, v17
  v_cvt_u32_f32 v176, v176
  v_cvt_u32_f32 v177, v177
  v_add_u32 v176, s63, v176
  v_add_u32 v177, s63, v177
  v_sub_f32 v17, 0x44ff8000, v16
  v_sub_f32 v18, 0x44ff4000, v16
  v_cvt_pk_bf16_f32 v17, v17, v18
  v_lshlrev_b32 v178, 16, v17
  v_and_b32 v179, 0xffff0000, v17
  v_cvt_u32_f32 v178, v178
  v_cvt_u32_f32 v179, v179
  v_add_u32 v178, s63, v178
  v_add_u32 v179, s63, v179
  v_sub_f32 v17, 0x44ff0000, v16
  v_sub_f32 v18, 0x44fec000, v16
  v_cvt_pk_bf16_f32 v17, v17, v18
  v_lshlrev_b32 v180, 16, v17
  v_and_b32 v181, 0xffff0000, v17
  v_cvt_u32_f32 v180, v180
  v_cvt_u32_f32 v181, v181
  v_add_u32 v180, s63, v180
  v_add_u32 v181, s63, v181
  v_sub_f32 v17, 0x44fe8000, v16
  v_sub_f32 v18, 0x44fe4000, v16
  v_cvt_pk_bf16_f32 v17, v17, v18
  v_lshlrev_b32 v182, 16, v17
  v_and_b32 v183, 0xffff0000, v17
  v_cvt_u32_f32 v182, v182
  v_cvt_u32_f32 v183, v183
  v_add_u32 v182, s63, v182
  v_add_u32 v183, s63, v183
  v_sub_f32 v17, 0x44800000, v16
  v_sub_f32 v18, 0x447f8000, v16
  v_cvt_pk_bf16_f32 v17, v17, v18
  v_lshlrev_b32 v184, 16, v17
  v_and_b32 v185, 0xffff0000, v17
  v_cvt_u32_f32 v184, v184
  v_cvt_u32_f32 v185, v185
  v_add_u32 v184, s63, v184
  v_add_u32 v185, s63, v185
  v_sub_f32 v17, 0x447f0000, v16
  v_sub_f32 v18, 0x447e8000, v16
  v_cvt_pk_bf16_f32 v17, v17, v18
  v_lshlrev_b32 v186, 16, v17
  v_and_b32 v187, 0xffff0000, v17
  v_cvt_u32_f32 v186, v186
  v_cvt_u32_f32 v187, v187
  v_add_u32 v186, s63, v186
  v_add_u32 v187, s63, v187
  v_sub_f32 v17, 0x447e0000, v16
  v_sub_f32 v18, 0x447d8000, v16
  v_cvt_pk_bf16_f32 v17, v17, v18
  v_lshlrev_b32 v188, 16, v17
  v_and_b32 v189, 0xffff0000, v17
  v_cvt_u32_f32 v188, v188
  v_cvt_u32_f32 v189, v189
  v_add_u32 v188, s63, v188
  v_add_u32 v189, s63, v189
  v_sub_f32 v17, 0x447d0000, v16
  v_sub_f32 v18, 0x447c8000, v16
  v_cvt_pk_bf16_f32 v17, v17, v18
  v_lshlrev_b32 v190, 16, v17
  v_and_b32 v191, 0xffff0000, v17
  v_cvt_u32_f32 v190, v190
  v_cvt_u32_f32 v191, v191
  v_add_u32 v190, s63, v190
  v_add_u32 v191, s63, v191
  s_waitcnt vmcnt(1)
  v_lshlrev_b32 v24, 16, v24
  v_mul_f32 v26, 0x3fb8aa3b, v24
  v_mov_b32 v27, 0x3fb8aa3b
  v_fma_f32 v27, v24, v27, -v26
  v_fmac_f32 v27, 0x32a57060, v24
  v_exp_f32 v26, v26
  v_mul_f32 v27, 0x3f317218, v27
  v_fma_f32 v24, v26, v27, v26
  v_cvt_pk_bf16_f32 v24, v24, v24
  v_and_b32 v24, 0xffff0000, v24
  v_lshlrev_b32 v32, 16, v20
  v_and_b32 v36, 0xffff0000, v20
  v_lshlrev_b32 v33, 16, v21
  v_and_b32 v37, 0xffff0000, v21
  v_lshlrev_b32 v34, 16, v22
  v_and_b32 v38, 0xffff0000, v22
  v_lshlrev_b32 v35, 16, v23
  v_and_b32 v39, 0xffff0000, v23
  v_max3_f32 v28, |v34|, |v35|, |v38|
  v_max_f32 v28, |v39|, v28
  s_nop 1
  v_max_f32_dpp v28, v28, v28 quad_perm:[1,0,3,2] row_mask:0xf bank_mask:0xf
  s_nop 1
  v_max_f32_dpp v28, v28, v28 quad_perm:[2,3,0,1] row_mask:0xf bank_mask:0xf
  s_nop 1
  v_max_f32_dpp v28, v28, v28 row_half_mirror row_mask:0xf bank_mask:0xf
  s_nop 1
  v_max_f32_dpp v28, v28, v28 row_mirror row_mask:0xf bank_mask:0xf
  v_mov_b32 v29, v28
  s_nop 1
  v_permlane16_swap_b32 v28, v29
  v_max_f32 v28, v28, v29
  v_mov_b32 v29, v28
  s_nop 1
  v_permlane32_swap_b32 v28, v29
  v_max_f32 v28, v28, v29
  v_frexp_exp_i32_f32 v28, v28
  v_sub_u32 v29, 0, v28
  v_mul_f32 v26, 0x3fb8aa3b, v32
  v_mov_b32 v27, 0x3fb8aa3b
  v_fma_f32 v27, v32, v27, -v26
  v_fmac_f32 v27, 0x32a57060, v32
  v_exp_f32 v26, v26
  v_mul_f32 v27, 0x3f317218, v27
  v_fma_f32 v32, v26, v27, v26
  v_cvt_pk_bf16_f32 v32, v32, v32
  v_and_b32 v32, 0xffff0000, v32
  v_mul_f32 v32, v32, v24
  v_mul_f32 v33, v33, v24
  v_ldexp_f32 v34, v34, v29
  v_ldexp_f32 v35, v35, v29
  v_mul_f32 v32, 0xbfb8aa3b, v32
  v_mul_f32 v33, 0x3e22f983, v33
  v_mul_f32 v26, 0x3fb8aa3b, v36
  v_mov_b32 v27, 0x3fb8aa3b
  v_fma_f32 v27, v36, v27, -v26
  v_fmac_f32 v27, 0x32a57060, v36
  v_exp_f32 v26, v26
  v_mul_f32 v27, 0x3f317218, v27
  v_fma_f32 v36, v26, v27, v26
  v_cvt_pk_bf16_f32 v36, v36, v36
  v_and_b32 v36, 0xffff0000, v36
  v_mul_f32 v36, v36, v24
  v_mul_f32 v37, v37, v24
  v_ldexp_f32 v38, v38, v29
  v_ldexp_f32 v39, v39, v29
  v_mul_f32 v36, 0xbfb8aa3b, v36
  v_mul_f32 v37, 0x3e22f983, v37
  v_add_f32 v24, v24, v24
  v_ldexp_f32 v233, v24, v28
  s_lshl_b32 s6, s3, 11
  v_lshl_add_u32 v16, v0, 5, s6
  ds_write_b128 v16, v[32:35] offset:0
  ds_write_b128 v16, v[36:39] offset:16
  ds_read_b128 v[8:11], v3 offset:0
  v_mov_b32 v48, 0
  v_mov_b32 v49, 0
  v_mov_b32 v50, 0
  v_mov_b32 v51, 0
  v_mov_b32 v52, 0
  v_mov_b32 v53, 0
  v_mov_b32 v54, 0
  v_mov_b32 v55, 0
  v_mov_b32 v56, 0
  v_mov_b32 v57, 0
  v_mov_b32 v58, 0
  v_mov_b32 v59, 0
  v_mov_b32 v16, 0
  v_mov_b32 v17, 0
  v_mov_b32 v18, 0
  v_mov_b32 v19, 0
  v_mov_b32 v20, 0
  v_mov_b32 v21, 0
  v_mov_b32 v22, 0
  v_mov_b32 v23, 0
  v_mov_b32 v24, 0
  v_mov_b32 v25, 0
  v_mov_b32 v26, 0
  v_mov_b32 v27, 0
  v_mov_b32 v28, 0
  v_mov_b32 v29, 0
  v_mov_b32 v30, 0
  v_mov_b32 v31, 0
  s_mov_b32 s6, 2
L_kg_105:
  s_waitcnt lgkmcnt(0)
  ds_read_b128 v[12:15], v3 offset:16
  v_mfma_f32_16x16x32_f16 v[48:51], v[16:19], v[28:31], v[48:51]
  v_pk_mul_f32 v[38:39], v[8:9], v[6:7] op_sel:[0,1] op_sel_hi:[1,1]
  v_mfma_f32_16x16x32_f16 v[52:55], v[20:23], v[28:31], v[52:55]
  v_pk_mul_f32 v[32:33], v[8:9], v[4:5] op_sel:[0,0] op_sel_hi:[1,0]
  v_mfma_f32_16x16x32_f16 v[56:59], v[24:27], v[28:31], v[56:59]
  v_pk_mul_f32 v[34:35], v[8:9], v[4:5] op_sel:[0,1] op_sel_hi:[1,1]
  v_pk_mul_f32 v[36:37], v[8:9], v[6:7] op_sel:[0,0] op_sel_hi:[1,0]
  v_fract_f32 v39, v39
  v_fract_f32 v33, v33
  v_fract_f32 v35, v35
  v_fract_f32 v37, v37
  v_exp_f32 v38, v38
  v_cos_f32 v46, v39
  v_sin_f32 v47, v39
  v_exp_f32 v32, v32
  v_cos_f32 v40, v33
  v_sin_f32 v41, v33
  v_exp_f32 v34, v34
  v_cos_f32 v42, v35
  v_sin_f32 v43, v35
  v_exp_f32 v36, v36
  v_cos_f32 v44, v37
  v_sin_f32 v45, v37
  v_pk_mul_f32 v[46:47], v[46:47], v[38:39] op_sel_hi:[1,0]
  v_pk_mul_f32 v[40:41], v[40:41], v[32:33] op_sel_hi:[1,0]
  v_pk_mul_f32 v[42:43], v[42:43], v[34:35] op_sel_hi:[1,0]
  v_pk_mul_f32 v[44:45], v[44:45], v[36:37] op_sel_hi:[1,0]
  v_pk_mul_f32 v[32:33], v[46:47], v[10:11] op_sel_hi:[1,0] neg_hi:[1,0]
  v_cvt_pk_f16_f32 v16, v40, v41
  v_pk_fma_f32 v[32:33], v[46:47], v[10:11], v[32:33] op_sel:[1,1,0] op_sel_hi:[0,1,1] neg_lo:[1,0,0] neg_hi:[1,0,0]
  v_cvt_pk_f16_f32 v20, v42, v43
  v_cvt_pk_f16_f32 v24, v44, v45
  v_cvt_pk_f16_f32 v28, v32, v33
  s_waitcnt lgkmcnt(0)
  ds_read_b128 v[8:11], v3 offset:32
  v_pk_mul_f32 v[38:39], v[12:13], v[6:7] op_sel:[0,1] op_sel_hi:[1,1]
  v_pk_mul_f32 v[32:33], v[12:13], v[4:5] op_sel:[0,0] op_sel_hi:[1,0]
  v_pk_mul_f32 v[34:35], v[12:13], v[4:5] op_sel:[0,1] op_sel_hi:[1,1]
  v_pk_mul_f32 v[36:37], v[12:13], v[6:7] op_sel:[0,0] op_sel_hi:[1,0]
  v_fract_f32 v39, v39
  v_fract_f32 v33, v33
  v_fract_f32 v35, v35
  v_fract_f32 v37, v37
  v_exp_f32 v38, v38
  v_cos_f32 v46, v39
  v_sin_f32 v47, v39
  v_exp_f32 v32, v32
  v_cos_f32 v40, v33
  v_sin_f32 v41, v33
  v_exp_f32 v34, v34
  v_cos_f32 v42, v35
  v_sin_f32 v43, v35
  v_exp_f32 v36, v36
  v_cos_f32 v44, v37
  v_sin_f32 v45, v37
  v_pk_mul_f32 v[46:47], v[46:47], v[38:39] op_sel_hi:[1,0]
  v_pk_mul_f32 v[40:41], v[40:41], v[32:33] op_sel_hi:[1,0]
  v_pk_mul_f32 v[42:43], v[42:43], v[34:35] op_sel_hi:[1,0]
  v_pk_mul_f32 v[44:45], v[44:45], v[36:37] op_sel_hi:[1,0]
  v_pk_mul_f32 v[32:33], v[46:47], v[14:15] op_sel_hi:[1,0] neg_hi:[1,0]
  v_cvt_pk_f16_f32 v17, v40, v41
  v_pk_fma_f32 v[32:33], v[46:47], v[14:15], v[32:33] op_sel:[1,1,0] op_sel_hi:[0,1,1] neg_lo:[1,0,0] neg_hi:[1,0,0]
  v_cvt_pk_f16_f32 v21, v42, v43
  v_cvt_pk_f16_f32 v25, v44, v45
  v_cvt_pk_f16_f32 v29, v32, v33
  s_waitcnt lgkmcnt(0)
  ds_read_b128 v[12:15], v3 offset:48
  v_pk_mul_f32 v[38:39], v[8:9], v[6:7] op_sel:[0,1] op_sel_hi:[1,1]
  v_pk_mul_f32 v[32:33], v[8:9], v[4:5] op_sel:[0,0] op_sel_hi:[1,0]
  v_pk_mul_f32 v[34:35], v[8:9], v[4:5] op_sel:[0,1] op_sel_hi:[1,1]
  v_pk_mul_f32 v[36:37], v[8:9], v[6:7] op_sel:[0,0] op_sel_hi:[1,0]
  v_fract_f32 v39, v39
  v_fract_f32 v33, v33
  v_fract_f32 v35, v35
  v_fract_f32 v37, v37
  v_exp_f32 v38, v38
  v_cos_f32 v46, v39
  v_sin_f32 v47, v39
  v_exp_f32 v32, v32
  v_cos_f32 v40, v33
  v_sin_f32 v41, v33
  v_exp_f32 v34, v34
  v_cos_f32 v42, v35
  v_sin_f32 v43, v35
  v_exp_f32 v36, v36
  v_cos_f32 v44, v37
  v_sin_f32 v45, v37
  v_pk_mul_f32 v[46:47], v[46:47], v[38:39] op_sel_hi:[1,0]
  v_pk_mul_f32 v[40:41], v[40:41], v[32:33] op_sel_hi:[1,0]
  v_pk_mul_f32 v[42:43], v[42:43], v[34:35] op_sel_hi:[1,0]
  v_pk_mul_f32 v[44:45], v[44:45], v[36:37] op_sel_hi:[1,0]
  v_pk_mul_f32 v[32:33], v[46:47], v[10:11] op_sel_hi:[1,0] neg_hi:[1,0]
  v_cvt_pk_f16_f32 v18, v40, v41
  v_pk_fma_f32 v[32:33], v[46:47], v[10:11], v[32:33] op_sel:[1,1,0] op_sel_hi:[0,1,1] neg_lo:[1,0,0] neg_hi:[1,0,0]
  v_cvt_pk_f16_f32 v22, v42, v43
  v_cvt_pk_f16_f32 v26, v44, v45
  v_cvt_pk_f16_f32 v30, v32, v33
  s_waitcnt lgkmcnt(0)
  ds_read_b128 v[8:11], v3 offset:256
  v_pk_mul_f32 v[38:39], v[12:13], v[6:7] op_sel:[0,1] op_sel_hi:[1,1]
  v_pk_mul_f32 v[32:33], v[12:13], v[4:5] op_sel:[0,0] op_sel_hi:[1,0]
  v_pk_mul_f32 v[34:35], v[12:13], v[4:5] op_sel:[0,1] op_sel_hi:[1,1]
  v_pk_mul_f32 v[36:37], v[12:13], v[6:7] op_sel:[0,0] op_sel_hi:[1,0]
  v_fract_f32 v39, v39
  v_fract_f32 v33, v33
  v_fract_f32 v35, v35
  v_fract_f32 v37, v37
  v_exp_f32 v38, v38
  v_cos_f32 v46, v39
  v_sin_f32 v47, v39
  v_exp_f32 v32, v32
  v_cos_f32 v40, v33
  v_sin_f32 v41, v33
  v_exp_f32 v34, v34
  v_cos_f32 v42, v35
  v_sin_f32 v43, v35
  v_exp_f32 v36, v36
  v_cos_f32 v44, v37
  v_sin_f32 v45, v37
  v_pk_mul_f32 v[46:47], v[46:47], v[38:39] op_sel_hi:[1,0]
  v_pk_mul_f32 v[40:41], v[40:41], v[32:33] op_sel_hi:[1,0]
  v_pk_mul_f32 v[42:43], v[42:43], v[34:35] op_sel_hi:[1,0]
  v_pk_mul_f32 v[44:45], v[44:45], v[36:37] op_sel_hi:[1,0]
  v_pk_mul_f32 v[32:33], v[46:47], v[14:15] op_sel_hi:[1,0] neg_hi:[1,0]
  v_cvt_pk_f16_f32 v19, v40, v41
  v_pk_fma_f32 v[32:33], v[46:47], v[14:15], v[32:33] op_sel:[1,1,0] op_sel_hi:[0,1,1] neg_lo:[1,0,0] neg_hi:[1,0,0]
  v_cvt_pk_f16_f32 v23, v42, v43
  v_cvt_pk_f16_f32 v27, v44, v45
  v_cvt_pk_f16_f32 v31, v32, v33
  v_add_u32 v3, 256, v3
  s_sub_u32 s6, s6, 1
  s_cmp_lg_u32 s6, 0
  s_cbranch_scc1 L_kg_105
  s_mov_b32 s6, 2
L_kg_106:
  s_waitcnt lgkmcnt(0)
  ds_read_b128 v[12:15], v3 offset:16
  v_mfma_f32_16x16x32_f16 v[48:51], v[16:19], v[28:31], v[48:51]
  v_pk_mul_f32 v[38:39], v[8:9], v[6:7] op_sel:[0,1] op_sel_hi:[1,1]
  v_mfma_f32_16x16x32_f16 v[52:55], v[20:23], v[28:31], v[52:55]
  v_pk_mul_f32 v[32:33], v[8:9], v[4:5] op_sel:[0,0] op_sel_hi:[1,0]
  v_mfma_f32_16x16x32_f16 v[56:59], v[24:27], v[28:31], v[56:59]
  v_pk_mul_f32 v[34:35], v[8:9], v[4:5] op_sel:[0,1] op_sel_hi:[1,1]
  v_pk_mul_f32 v[36:37], v[8:9], v[6:7] op_sel:[0,0] op_sel_hi:[1,0]
  v_fract_f32 v39, v39
  v_fract_f32 v33, v33
  v_fract_f32 v35, v35
  v_fract_f32 v37, v37
  v_exp_f32 v38, v38
  v_cos_f32 v46, v39
  v_sin_f32 v47, v39
  v_exp_f32 v32, v32
  v_cos_f32 v40, v33
  v_sin_f32 v41, v33
  v_exp_f32 v34, v34
  v_cos_f32 v42, v35
  v_sin_f32 v43, v35
  v_exp_f32 v36, v36
  v_cos_f32 v44, v37
  v_sin_f32 v45, v37
  v_pk_mul_f32 v[46:47], v[46:47], v[38:39] op_sel_hi:[1,0]
  v_pk_mul_f32 v[40:41], v[40:41], v[32:33] op_sel_hi:[1,0]
  v_pk_mul_f32 v[42:43], v[42:43], v[34:35] op_sel_hi:[1,0]
  v_pk_mul_f32 v[44:45], v[44:45], v[36:37] op_sel_hi:[1,0]
  v_pk_mul_f32 v[32:33], v[46:47], v[10:11] op_sel_hi:[1,0] neg_hi:[1,0]
  v_cvt_pk_f16_f32 v16, v40, v41
  v_pk_fma_f32 v[32:33], v[46:47], v[10:11], v[32:33] op_sel:[1,1,0] op_sel_hi:[0,1,1] neg_lo:[1,0,0] neg_hi:[1,0,0]
  v_cvt_pk_f16_f32 v20, v42, v43
  v_cvt_pk_f16_f32 v24, v44, v45
  v_cvt_pk_f16_f32 v28, v32, v33
  s_waitcnt lgkmcnt(0)
  ds_read_b128 v[8:11], v3 offset:32
  v_pk_mul_f32 v[38:39], v[12:13], v[6:7] op_sel:[0,1] op_sel_hi:[1,1]
  v_pk_mul_f32 v[32:33], v[12:13], v[4:5] op_sel:[0,0] op_sel_hi:[1,0]
  v_pk_mul_f32 v[34:35], v[12:13], v[4:5] op_sel:[0,1] op_sel_hi:[1,1]
  v_pk_mul_f32 v[36:37], v[12:13], v[6:7] op_sel:[0,0] op_sel_hi:[1,0]
  v_fract_f32 v39, v39
  v_fract_f32 v33, v33
  v_fract_f32 v35, v35
  v_fract_f32 v37, v37
  v_exp_f32 v38, v38
  v_cos_f32 v46, v39
  v_sin_f32 v47, v39
  v_exp_f32 v32, v32
  v_cos_f32 v40, v33
  v_sin_f32 v41, v33
  v_exp_f32 v34, v34
  v_cos_f32 v42, v35
  v_sin_f32 v43, v35
  v_exp_f32 v36, v36
  v_cos_f32 v44, v37
  v_sin_f32 v45, v37
  v_pk_mul_f32 v[46:47], v[46:47], v[38:39] op_sel_hi:[1,0]
  v_pk_mul_f32 v[40:41], v[40:41], v[32:33] op_sel_hi:[1,0]
  v_pk_mul_f32 v[42:43], v[42:43], v[34:35] op_sel_hi:[1,0]
  v_pk_mul_f32 v[44:45], v[44:45], v[36:37] op_sel_hi:[1,0]
  v_pk_mul_f32 v[32:33], v[46:47], v[14:15] op_sel_hi:[1,0] neg_hi:[1,0]
  v_cvt_pk_f16_f32 v17, v40, v41
  v_pk_fma_f32 v[32:33], v[46:47], v[14:15], v[32:33] op_sel:[1,1,0] op_sel_hi:[0,1,1] neg_lo:[1,0,0] neg_hi:[1,0,0]
  v_cvt_pk_f16_f32 v21, v42, v43
  v_cvt_pk_f16_f32 v25, v44, v45
  v_cvt_pk_f16_f32 v29, v32, v33
  s_waitcnt lgkmcnt(0)
  ds_read_b128 v[12:15], v3 offset:48
  v_pk_mul_f32 v[38:39], v[8:9], v[6:7] op_sel:[0,1] op_sel_hi:[1,1]
  v_pk_mul_f32 v[32:33], v[8:9], v[4:5] op_sel:[0,0] op_sel_hi:[1,0]
  v_pk_mul_f32 v[34:35], v[8:9], v[4:5] op_sel:[0,1] op_sel_hi:[1,1]
  v_pk_mul_f32 v[36:37], v[8:9], v[6:7] op_sel:[0,0] op_sel_hi:[1,0]
  v_fract_f32 v39, v39
  v_fract_f32 v33, v33
  v_fract_f32 v35, v35
  v_fract_f32 v37, v37
  v_exp_f32 v38, v38
  v_cos_f32 v46, v39
  v_sin_f32 v47, v39
  v_exp_f32 v32, v32
  v_cos_f32 v40, v33
  v_sin_f32 v41, v33
  v_exp_f32 v34, v34
  v_cos_f32 v42, v35
  v_sin_f32 v43, v35
  v_exp_f32 v36, v36
  v_cos_f32 v44, v37
  v_sin_f32 v45, v37
  v_pk_mul_f32 v[46:47], v[46:47], v[38:39] op_sel_hi:[1,0]
  v_pk_mul_f32 v[40:41], v[40:41], v[32:33] op_sel_hi:[1,0]
  v_pk_mul_f32 v[42:43], v[42:43], v[34:35] op_sel_hi:[1,0]
  v_pk_mul_f32 v[44:45], v[44:45], v[36:37] op_sel_hi:[1,0]
  v_pk_mul_f32 v[32:33], v[46:47], v[10:11] op_sel_hi:[1,0] neg_hi:[1,0]
  v_cvt_pk_f16_f32 v18, v40, v41
  v_pk_fma_f32 v[32:33], v[46:47], v[10:11], v[32:33] op_sel:[1,1,0] op_sel_hi:[0,1,1] neg_lo:[1,0,0] neg_hi:[1,0,0]
  v_cvt_pk_f16_f32 v22, v42, v43
  v_cvt_pk_f16_f32 v26, v44, v45
  v_cvt_pk_f16_f32 v30, v32, v33
  s_waitcnt lgkmcnt(0)
  ds_read_b128 v[8:11], v3 offset:256
  v_pk_mul_f32 v[38:39], v[12:13], v[6:7] op_sel:[0,1] op_sel_hi:[1,1]
  v_pk_mul_f32 v[32:33], v[12:13], v[4:5] op_sel:[0,0] op_sel_hi:[1,0]
  v_pk_mul_f32 v[34:35], v[12:13], v[4:5] op_sel:[0,1] op_sel_hi:[1,1]
  v_pk_mul_f32 v[36:37], v[12:13], v[6:7] op_sel:[0,0] op_sel_hi:[1,0]
  v_fract_f32 v39, v39
  v_fract_f32 v33, v33
  v_fract_f32 v35, v35
  v_fract_f32 v37, v37
  v_exp_f32 v38, v38
  v_cos_f32 v46, v39
  v_sin_f32 v47, v39
  v_exp_f32 v32, v32
  v_cos_f32 v40, v33
  v_sin_f32 v41, v33
  v_exp_f32 v34, v34
  v_cos_f32 v42, v35
  v_sin_f32 v43, v35
  v_exp_f32 v36, v36
  v_cos_f32 v44, v37
  v_sin_f32 v45, v37
  v_pk_mul_f32 v[46:47], v[46:47], v[38:39] op_sel_hi:[1,0]
  v_pk_mul_f32 v[40:41], v[40:41], v[32:33] op_sel_hi:[1,0]
  v_pk_mul_f32 v[42:43], v[42:43], v[34:35] op_sel_hi:[1,0]
  v_pk_mul_f32 v[44:45], v[44:45], v[36:37] op_sel_hi:[1,0]
  v_pk_mul_f32 v[32:33], v[46:47], v[14:15] op_sel_hi:[1,0] neg_hi:[1,0]
  v_cvt_pk_f16_f32 v19, v40, v41
  v_pk_fma_f32 v[32:33], v[46:47], v[14:15], v[32:33] op_sel:[1,1,0] op_sel_hi:[0,1,1] neg_lo:[1,0,0] neg_hi:[1,0,0]
  v_cvt_pk_f16_f32 v23, v42, v43
  v_cvt_pk_f16_f32 v27, v44, v45
  v_cvt_pk_f16_f32 v31, v32, v33
  v_add_u32 v3, 256, v3
  s_sub_u32 s6, s6, 1
  s_cmp_lg_u32 s6, 0
  s_cbranch_scc1 L_kg_106
  s_mov_b32 s6, 2
L_kg_107:
  s_waitcnt lgkmcnt(0)
  ds_read_b128 v[12:15], v3 offset:16
  v_mfma_f32_16x16x32_f16 v[48:51], v[16:19], v[28:31], v[48:51]
  v_pk_mul_f32 v[38:39], v[8:9], v[6:7] op_sel:[0,1] op_sel_hi:[1,1]
  v_mfma_f32_16x16x32_f16 v[52:55], v[20:23], v[28:31], v[52:55]
  v_pk_mul_f32 v[32:33], v[8:9], v[4:5] op_sel:[0,0] op_sel_hi:[1,0]
  v_mfma_f32_16x16x32_f16 v[56:59], v[24:27], v[28:31], v[56:59]
  v_pk_mul_f32 v[34:35], v[8:9], v[4:5] op_sel:[0,1] op_sel_hi:[1,1]
  v_pk_mul_f32 v[36:37], v[8:9], v[6:7] op_sel:[0,0] op_sel_hi:[1,0]
  v_fract_f32 v39, v39
  v_fract_f32 v33, v33
  v_fract_f32 v35, v35
  v_fract_f32 v37, v37
  v_exp_f32 v38, v38
  v_cos_f32 v46, v39
  v_sin_f32 v47, v39
  v_exp_f32 v32, v32
  v_cos_f32 v40, v33
  v_sin_f32 v41, v33
  v_exp_f32 v34, v34
  v_cos_f32 v42, v35
  v_sin_f32 v43, v35
  v_exp_f32 v36, v36
  v_cos_f32 v44, v37
  v_sin_f32 v45, v37
  v_pk_mul_f32 v[46:47], v[46:47], v[38:39] op_sel_hi:[1,0]
  v_pk_mul_f32 v[40:41], v[40:41], v[32:33] op_sel_hi:[1,0]
  v_pk_mul_f32 v[42:43], v[42:43], v[34:35] op_sel_hi:[1,0]
  v_pk_mul_f32 v[44:45], v[44:45], v[36:37] op_sel_hi:[1,0]
  v_pk_mul_f32 v[32:33], v[46:47], v[10:11] op_sel_hi:[1,0] neg_hi:[1,0]
  v_cvt_pk_f16_f32 v16, v40, v41
  v_pk_fma_f32 v[32:33], v[46:47], v[10:11], v[32:33] op_sel:[1,1,0] op_sel_hi:[0,1,1] neg_lo:[1,0,0] neg_hi:[1,0,0]
  v_cvt_pk_f16_f32 v20, v42, v43
  v_cvt_pk_f16_f32 v24, v44, v45
  v_cvt_pk_f16_f32 v28, v32, v33
  s_waitcnt lgkmcnt(0)
  ds_read_b128 v[8:11], v3 offset:32
  v_pk_mul_f32 v[38:39], v[12:13], v[6:7] op_sel:[0,1] op_sel_hi:[1,1]
  v_pk_mul_f32 v[32:33], v[12:13], v[4:5] op_sel:[0,0] op_sel_hi:[1,0]
  v_pk_mul_f32 v[34:35], v[12:13], v[4:5] op_sel:[0,1] op_sel_hi:[1,1]
  v_pk_mul_f32 v[36:37], v[12:13], v[6:7] op_sel:[0,0] op_sel_hi:[1,0]
  v_fract_f32 v39, v39
  v_fract_f32 v33, v33
  v_fract_f32 v35, v35
  v_fract_f32 v37, v37
  v_exp_f32 v38, v38
  v_cos_f32 v46, v39
  v_sin_f32 v47, v39
  v_exp_f32 v32, v32
  v_cos_f32 v40, v33
  v_sin_f32 v41, v33
  v_exp_f32 v34, v34
  v_cos_f32 v42, v35
  v_sin_f32 v43, v35
  v_exp_f32 v36, v36
  v_cos_f32 v44, v37
  v_sin_f32 v45, v37
  v_pk_mul_f32 v[46:47], v[46:47], v[38:39] op_sel_hi:[1,0]
  v_pk_mul_f32 v[40:41], v[40:41], v[32:33] op_sel_hi:[1,0]
  v_pk_mul_f32 v[42:43], v[42:43], v[34:35] op_sel_hi:[1,0]
  v_pk_mul_f32 v[44:45], v[44:45], v[36:37] op_sel_hi:[1,0]
  v_pk_mul_f32 v[32:33], v[46:47], v[14:15] op_sel_hi:[1,0] neg_hi:[1,0]
  v_cvt_pk_f16_f32 v17, v40, v41
  v_pk_fma_f32 v[32:33], v[46:47], v[14:15], v[32:33] op_sel:[1,1,0] op_sel_hi:[0,1,1] neg_lo:[1,0,0] neg_hi:[1,0,0]
  v_cvt_pk_f16_f32 v21, v42, v43
  v_cvt_pk_f16_f32 v25, v44, v45
  v_cvt_pk_f16_f32 v29, v32, v33
  s_waitcnt lgkmcnt(0)
  ds_read_b128 v[12:15], v3 offset:48
  v_pk_mul_f32 v[38:39], v[8:9], v[6:7] op_sel:[0,1] op_sel_hi:[1,1]
  v_pk_mul_f32 v[32:33], v[8:9], v[4:5] op_sel:[0,0] op_sel_hi:[1,0]
  v_pk_mul_f32 v[34:35], v[8:9], v[4:5] op_sel:[0,1] op_sel_hi:[1,1]
  v_pk_mul_f32 v[36:37], v[8:9], v[6:7] op_sel:[0,0] op_sel_hi:[1,0]
  v_fract_f32 v39, v39
  v_fract_f32 v33, v33
  v_fract_f32 v35, v35
  v_fract_f32 v37, v37
  v_exp_f32 v38, v38
  v_cos_f32 v46, v39
  v_sin_f32 v47, v39
  v_exp_f32 v32, v32
  v_cos_f32 v40, v33
  v_sin_f32 v41, v33
  v_exp_f32 v34, v34
  v_cos_f32 v42, v35
  v_sin_f32 v43, v35
  v_exp_f32 v36, v36
  v_cos_f32 v44, v37
  v_sin_f32 v45, v37
  v_pk_mul_f32 v[46:47], v[46:47], v[38:39] op_sel_hi:[1,0]
  v_pk_mul_f32 v[40:41], v[40:41], v[32:33] op_sel_hi:[1,0]
  v_pk_mul_f32 v[42:43], v[42:43], v[34:35] op_sel_hi:[1,0]
  v_pk_mul_f32 v[44:45], v[44:45], v[36:37] op_sel_hi:[1,0]
  v_pk_mul_f32 v[32:33], v[46:47], v[10:11] op_sel_hi:[1,0] neg_hi:[1,0]
  v_cvt_pk_f16_f32 v18, v40, v41
  v_pk_fma_f32 v[32:33], v[46:47], v[10:11], v[32:33] op_sel:[1,1,0] op_sel_hi:[0,1,1] neg_lo:[1,0,0] neg_hi:[1,0,0]
  v_cvt_pk_f16_f32 v22, v42, v43
  v_cvt_pk_f16_f32 v26, v44, v45
  v_cvt_pk_f16_f32 v30, v32, v33
  s_waitcnt lgkmcnt(0)
  ds_read_b128 v[8:11], v3 offset:256
  v_pk_mul_f32 v[38:39], v[12:13], v[6:7] op_sel:[0,1] op_sel_hi:[1,1]
  v_pk_mul_f32 v[32:33], v[12:13], v[4:5] op_sel:[0,0] op_sel_hi:[1,0]
  v_pk_mul_f32 v[34:35], v[12:13], v[4:5] op_sel:[0,1] op_sel_hi:[1,1]
  v_pk_mul_f32 v[36:37], v[12:13], v[6:7] op_sel:[0,0] op_sel_hi:[1,0]
  v_fract_f32 v39, v39
  v_fract_f32 v33, v33
  v_fract_f32 v35, v35
  v_fract_f32 v37, v37
  v_exp_f32 v38, v38
  v_cos_f32 v46, v39
  v_sin_f32 v47, v39
  v_exp_f32 v32, v32
  v_cos_f32 v40, v33
  v_sin_f32 v41, v33
  v_exp_f32 v34, v34
  v_cos_f32 v42, v35
  v_sin_f32 v43, v35
  v_exp_f32 v36, v36
  v_cos_f32 v44, v37
  v_sin_f32 v45, v37
  v_pk_mul_f32 v[46:47], v[46:47], v[38:39] op_sel_hi:[1,0]
  v_pk_mul_f32 v[40:41], v[40:41], v[32:33] op_sel_hi:[1,0]
  v_pk_mul_f32 v[42:43], v[42:43], v[34:35] op_sel_hi:[1,0]
  v_pk_mul_f32 v[44:45], v[44:45], v[36:37] op_sel_hi:[1,0]
  v_pk_mul_f32 v[32:33], v[46:47], v[14:15] op_sel_hi:[1,0] neg_hi:[1,0]
  v_cvt_pk_f16_f32 v19, v40, v41
  v_pk_fma_f32 v[32:33], v[46:47], v[14:15], v[32:33] op_sel:[1,1,0] op_sel_hi:[0,1,1] neg_lo:[1,0,0] neg_hi:[1,0,0]
  v_cvt_pk_f16_f32 v23, v42, v43
  v_cvt_pk_f16_f32 v27, v44, v45
  v_cvt_pk_f16_f32 v31, v32, v33
  v_add_u32 v3, 256, v3
  s_sub_u32 s6, s6, 1
  s_cmp_lg_u32 s6, 0
  s_cbranch_scc1 L_kg_107
  s_cmp_lg_u32 s3, 0
  s_cbranch_scc1 L_wdo_109
  s_mov_b32 s7, 0
  v_mbcnt_lo_u32_b32 v216, -1, 0
  v_and_b32 v216, 3, v216
  v_lshlrev_b32 v216, 6, v216
L_wd_108:
  buffer_load_dword v217, v216, s[12:15], 0 offen offset:16 sc1
  s_waitcnt vmcnt(0)
  v_cmp_ne_u32 vcc, 64, v217
  s_cbranch_vccz L_wdo_109
  s_add_u32 s7, s7, 1
  s_cmp_lt_u32 s7, 131072
  s_cbranch_scc1 L_wd_108
  s_mov_b32 s6, 50
  s_branch L_err
L_wdo_109:
  s_barrier
  s_lshl_b32 s6, s3, 13
  s_add_u32 s6, s6, s62
  s_add_u32 s6, s6, 0xb000000
  s_lshl_b32 s7, s3, 10
  v_lshlrev_b32 v216, 7, v0
  s_add_u32 m0, s7, 44064
  s_nop 0
  buffer_load_dwordx4 v216, s[8:11], s6 offen lds
  s_add_u32 s6, s6, 16
  s_add_u32 m0, s7, 48192
  s_nop 0
  buffer_load_dwordx4 v216, s[8:11], s6 offen lds
  s_add_u32 s6, s6, 16
  s_add_u32 m0, s7, 52320
  s_nop 0
  buffer_load_dwordx4 v216, s[8:11], s6 offen lds
  s_add_u32 s6, s6, 16
  s_add_u32 m0, s7, 56448
  s_nop 0
  buffer_load_dwordx4 v216, s[8:11], s6 offen lds
  s_add_u32 s6, s6, 16
  s_add_u32 m0, s7, 60544
  s_nop 0
  buffer_load_dwordx4 v216, s[8:11], s6 offen lds
  s_add_u32 s6, s6, 16
  s_add_u32 m0, s7, 64640
  s_nop 0
  buffer_load_dwordx4 v216, s[8:11], s6 offen lds
  s_add_u32 s6, s6, 16
  s_add_u32 m0, s7, 68736
  s_nop 0
  buffer_load_dwordx4 v216, s[8:11], s6 offen lds
  s_add_u32 s6, s6, 16
  s_add_u32 m0, s7, 72832
  s_nop 0
  buffer_load_dwordx4 v216, s[8:11], s6 offen lds
  s_add_u32 s6, s6, 16
  s_mov_b32 s6, 2
L_kg_110:
  s_waitcnt lgkmcnt(0)
  ds_read_b128 v[12:15], v3 offset:16
  v_mfma_f32_16x16x32_f16 v[48:51], v[16:19], v[28:31], v[48:51]
  v_pk_mul_f32 v[38:39], v[8:9], v[6:7] op_sel:[0,1] op_sel_hi:[1,1]
  v_mfma_f32_16x16x32_f16 v[52:55], v[20:23], v[28:31], v[52:55]
  v_pk_mul_f32 v[32:33], v[8:9], v[4:5] op_sel:[0,0] op_sel_hi:[1,0]
  v_mfma_f32_16x16x32_f16 v[56:59], v[24:27], v[28:31], v[56:59]
  v_pk_mul_f32 v[34:35], v[8:9], v[4:5] op_sel:[0,1] op_sel_hi:[1,1]
  v_pk_mul_f32 v[36:37], v[8:9], v[6:7] op_sel:[0,0] op_sel_hi:[1,0]
  v_fract_f32 v39, v39
  v_fract_f32 v33, v33
  v_fract_f32 v35, v35
  v_fract_f32 v37, v37
  v_exp_f32 v38, v38
  v_cos_f32 v46, v39
  v_sin_f32 v47, v39
  v_exp_f32 v32, v32
  v_cos_f32 v40, v33
  v_sin_f32 v41, v33
  v_exp_f32 v34, v34
  v_cos_f32 v42, v35
  v_sin_f32 v43, v35
  v_exp_f32 v36, v36
  v_cos_f32 v44, v37
  v_sin_f32 v45, v37
  v_pk_mul_f32 v[46:47], v[46:47], v[38:39] op_sel_hi:[1,0]
  v_pk_mul_f32 v[40:41], v[40:41], v[32:33] op_sel_hi:[1,0]
  v_pk_mul_f32 v[42:43], v[42:43], v[34:35] op_sel_hi:[1,0]
  v_pk_mul_f32 v[44:45], v[44:45], v[36:37] op_sel_hi:[1,0]
  v_pk_mul_f32 v[32:33], v[46:47], v[10:11] op_sel_hi:[1,0] neg_hi:[1,0]
  v_cvt_pk_f16_f32 v16, v40, v41
  v_pk_fma_f32 v[32:33], v[46:47], v[10:11], v[32:33] op_sel:[1,1,0] op_sel_hi:[0,1,1] neg_lo:[1,0,0] neg_hi:[1,0,0]
  v_cvt_pk_f16_f32 v20, v42, v43
  v_cvt_pk_f16_f32 v24, v44, v45
  v_cvt_pk_f16_f32 v28, v32, v33
  s_waitcnt lgkmcnt(0)
  ds_read_b128 v[8:11], v3 offset:32
  v_pk_mul_f32 v[38:39], v[12:13], v[6:7] op_sel:[0,1] op_sel_hi:[1,1]
  v_pk_mul_f32 v[32:33], v[12:13], v[4:5] op_sel:[0,0] op_sel_hi:[1,0]
  v_pk_mul_f32 v[34:35], v[12:13], v[4:5] op_sel:[0,1] op_sel_hi:[1,1]
  v_pk_mul_f32 v[36:37], v[12:13], v[6:7] op_sel:[0,0] op_sel_hi:[1,0]
  v_fract_f32 v39, v39
  v_fract_f32 v33, v33
  v_fract_f32 v35, v35
  v_fract_f32 v37, v37
  v_exp_f32 v38, v38
  v_cos_f32 v46, v39
  v_sin_f32 v47, v39
  v_exp_f32 v32, v32
  v_cos_f32 v40, v33
  v_sin_f32 v41, v33
  v_exp_f32 v34, v34
  v_cos_f32 v42, v35
  v_sin_f32 v43, v35
  v_exp_f32 v36, v36
  v_cos_f32 v44, v37
  v_sin_f32 v45, v37
  v_pk_mul_f32 v[46:47], v[46:47], v[38:39] op_sel_hi:[1,0]
  v_pk_mul_f32 v[40:41], v[40:41], v[32:33] op_sel_hi:[1,0]
  v_pk_mul_f32 v[42:43], v[42:43], v[34:35] op_sel_hi:[1,0]
  v_pk_mul_f32 v[44:45], v[44:45], v[36:37] op_sel_hi:[1,0]
  v_pk_mul_f32 v[32:33], v[46:47], v[14:15] op_sel_hi:[1,0] neg_hi:[1,0]
  v_cvt_pk_f16_f32 v17, v40, v41
  v_pk_fma_f32 v[32:33], v[46:47], v[14:15], v[32:33] op_sel:[1,1,0] op_sel_hi:[0,1,1] neg_lo:[1,0,0] neg_hi:[1,0,0]
  v_cvt_pk_f16_f32 v21, v42, v43
  v_cvt_pk_f16_f32 v25, v44, v45
  v_cvt_pk_f16_f32 v29, v32, v33
  s_waitcnt lgkmcnt(0)
  ds_read_b128 v[12:15], v3 offset:48
  v_pk_mul_f32 v[38:39], v[8:9], v[6:7] op_sel:[0,1] op_sel_hi:[1,1]
  v_pk_mul_f32 v[32:33], v[8:9], v[4:5] op_sel:[0,0] op_sel_hi:[1,0]
  v_pk_mul_f32 v[34:35], v[8:9], v[4:5] op_sel:[0,1] op_sel_hi:[1,1]
  v_pk_mul_f32 v[36:37], v[8:9], v[6:7] op_sel:[0,0] op_sel_hi:[1,0]
  v_fract_f32 v39, v39
  v_fract_f32 v33, v33
  v_fract_f32 v35, v35
  v_fract_f32 v37, v37
  v_exp_f32 v38, v38
  v_cos_f32 v46, v39
  v_sin_f32 v47, v39
  v_exp_f32 v32, v32
  v_cos_f32 v40, v33
  v_sin_f32 v41, v33
  v_exp_f32 v34, v34
  v_cos_f32 v42, v35
  v_sin_f32 v43, v35
  v_exp_f32 v36, v36
  v_cos_f32 v44, v37
  v_sin_f32 v45, v37
  v_pk_mul_f32 v[46:47], v[46:47], v[38:39] op_sel_hi:[1,0]
  v_pk_mul_f32 v[40:41], v[40:41], v[32:33] op_sel_hi:[1,0]
  v_pk_mul_f32 v[42:43], v[42:43], v[34:35] op_sel_hi:[1,0]
  v_pk_mul_f32 v[44:45], v[44:45], v[36:37] op_sel_hi:[1,0]
  v_pk_mul_f32 v[32:33], v[46:47], v[10:11] op_sel_hi:[1,0] neg_hi:[1,0]
  v_cvt_pk_f16_f32 v18, v40, v41
  v_pk_fma_f32 v[32:33], v[46:47], v[10:11], v[32:33] op_sel:[1,1,0] op_sel_hi:[0,1,1] neg_lo:[1,0,0] neg_hi:[1,0,0]
  v_cvt_pk_f16_f32 v22, v42, v43
  v_cvt_pk_f16_f32 v26, v44, v45
  v_cvt_pk_f16_f32 v30, v32, v33
  s_waitcnt lgkmcnt(0)
  ds_read_b128 v[8:11], v3 offset:256
  v_pk_mul_f32 v[38:39], v[12:13], v[6:7] op_sel:[0,1] op_sel_hi:[1,1]
  v_pk_mul_f32 v[32:33], v[12:13], v[4:5] op_sel:[0,0] op_sel_hi:[1,0]
  v_pk_mul_f32 v[34:35], v[12:13], v[4:5] op_sel:[0,1] op_sel_hi:[1,1]
  v_pk_mul_f32 v[36:37], v[12:13], v[6:7] op_sel:[0,0] op_sel_hi:[1,0]
  v_fract_f32 v39, v39
  v_fract_f32 v33, v33
  v_fract_f32 v35, v35
  v_fract_f32 v37, v37
  v_exp_f32 v38, v38
  v_cos_f32 v46, v39
  v_sin_f32 v47, v39
  v_exp_f32 v32, v32
  v_cos_f32 v40, v33
  v_sin_f32 v41, v33
  v_exp_f32 v34, v34
  v_cos_f32 v42, v35
  v_sin_f32 v43, v35
  v_exp_f32 v36, v36
  v_cos_f32 v44, v37
  v_sin_f32 v45, v37
  v_pk_mul_f32 v[46:47], v[46:47], v[38:39] op_sel_hi:[1,0]
  v_pk_mul_f32 v[40:41], v[40:41], v[32:33] op_sel_hi:[1,0]
  v_pk_mul_f32 v[42:43], v[42:43], v[34:35] op_sel_hi:[1,0]
  v_pk_mul_f32 v[44:45], v[44:45], v[36:37] op_sel_hi:[1,0]
  v_pk_mul_f32 v[32:33], v[46:47], v[14:15] op_sel_hi:[1,0] neg_hi:[1,0]
  v_cvt_pk_f16_f32 v19, v40, v41
  v_pk_fma_f32 v[32:33], v[46:47], v[14:15], v[32:33] op_sel:[1,1,0] op_sel_hi:[0,1,1] neg_lo:[1,0,0] neg_hi:[1,0,0]
  v_cvt_pk_f16_f32 v23, v42, v43
  v_cvt_pk_f16_f32 v27, v44, v45
  v_cvt_pk_f16_f32 v31, v32, v33
  v_add_u32 v3, 256, v3
  s_sub_u32 s6, s6, 1
  s_cmp_lg_u32 s6, 0
  s_cbranch_scc1 L_kg_110
  v_mfma_f32_16x16x32_f16 v[48:51], v[16:19], v[28:31], v[48:51]
  v_mfma_f32_16x16x32_f16 v[52:55], v[20:23], v[28:31], v[52:55]
  v_mfma_f32_16x16x32_f16 v[56:59], v[24:27], v[28:31], v[56:59]
  s_waitcnt lgkmcnt(0)
  s_nop 4
  v_mul_f32 v48, v48, v233
  v_mul_f32 v49, v49, v233
  v_mul_f32 v50, v50, v233
  v_mul_f32 v51, v51, v233
  v_mul_f32 v52, v52, v233
  v_mul_f32 v53, v53, v233
  v_mul_f32 v54, v54, v233
  v_mul_f32 v55, v55, v233
  v_mul_f32 v56, v56, v233
  v_mul_f32 v57, v57, v233
  v_mul_f32 v58, v58, v233
  v_mul_f32 v59, v59, v233
  v_readlane_b32 s61, v52, 32
  v_lshrrev_b32 v16, 4, v0
  v_and_b32 v17, 15, v0
  v_lshlrev_b32 v17, 4, v17
  v_add_u32 v17, s63, v17
  v_lshrrev_b32 v18, 1, v16
  v_and_b32 v19, 1, v16
  v_lshlrev_b32 v20, 8, v18
  v_lshl_add_u32 v20, v19, 3, v20
  v_add3_u32 v20, v20, v17, 2
  v_lshlrev_b32 v21, 8, v19
  v_add_u32 v21, 516, v21
  v_cmp_eq_u32 vcc, 0, v18
  s_nop 1
  v_cndmask_b32 v21, 0, v21, vcc
  v_cndmask_b32 v22, 0, 4, vcc
  v_add_u32 v21, v21, v17
  v_lshlrev_b32 v23, 9, v19
  v_add_u32 v23, 1032, v23
  v_lshlrev_b32 v24, 10, v19
  v_add_u32 v24, 2064, v24
  v_cndmask_b32 v23, v24, v23, vcc
  v_add_u32 v23, v23, v17
  v_mov_b32 v24, 0x100
  v_cndmask_b32 v24, v24, 8, vcc
  v_mov_b32 v25, 0x200
  v_cndmask_b32 v25, v25, v24, vcc
  v_mov_b32 v26, 0x100
  v_cndmask_b32 v25, v25, v26, vcc
  v_cvt_pk_bf16_f32 v32, v48, v49
  v_cvt_pk_bf16_f32 v33, v50, v51
  v_cvt_pk_bf16_f32 v34, v52, v53
  v_cvt_pk_bf16_f32 v35, v54, v55
  v_cvt_pk_bf16_f32 v36, v56, v57
  v_cvt_pk_bf16_f32 v37, v58, v59
  ds_write_b16 v21, v34
  v_add_u32 v21, v21, v22
  ds_write_b16_d16_hi v21, v34
  v_add_u32 v21, v21, v22
  ds_write_b16 v21, v35
  v_add_u32 v21, v21, v22
  ds_write_b16_d16_hi v21, v35
  ds_write_b16 v20, v32 offset:0
  ds_write_b16_d16_hi v20, v32 offset:2
  ds_write_b16 v20, v33 offset:4
  ds_write_b16_d16_hi v20, v33 offset:6
  ds_write_b16 v23, v36
  v_add_u32 v26, v23, v24
  v_add_u32 v23, v23, v25
  ds_write_b16_d16_hi v26, v36
  ds_write_b16 v23, v37
  v_add_u32 v23, v23, v24
  ds_write_b16_d16_hi v23, v37
  ds_read_u16 v160, v160
  ds_read_u16 v161, v161
  ds_read_u16 v162, v162
  ds_read_u16 v163, v163
  ds_read_u16 v164, v164
  ds_read_u16 v165, v165
  ds_read_u16 v166, v166
  ds_read_u16 v167, v167
  ds_read_u16 v168, v168
  ds_read_u16 v169, v169
  ds_read_u16 v170, v170
  ds_read_u16 v171, v171
  ds_read_u16 v172, v172
  ds_read_u16 v173, v173
  ds_read_u16 v174, v174
  ds_read_u16 v175, v175
  ds_read_u16 v176, v176
  ds_read_u16 v177, v177
  ds_read_u16 v178, v178
  ds_read_u16 v179, v179
  ds_read_u16 v180, v180
  ds_read_u16 v181, v181
  ds_read_u16 v182, v182
  ds_read_u16 v183, v183
  ds_read_u16 v184, v184
  ds_read_u16 v185, v185
  ds_read_u16 v186, v186
  ds_read_u16 v187, v187
  ds_read_u16 v188, v188
  ds_read_u16 v189, v189
  ds_read_u16 v190, v190
  ds_read_u16 v191, v191
  s_mul_i32 s6, s3, 4608
  s_add_u32 s6, s6, 25600
  v_add_u32 v16, s6, v2
  s_mul_i32 s7, s60, 4608
  s_add_u32 s7, s7, 0x400000
  v_mov_b32 v21, 0
  v_mov_b32 v22, 0
  v_mov_b32 v23, 0
  v_mov_b32 v20, s61
  v_cmp_eq_u32 vcc, 30, v0
  s_nop 1
  v_cndmask_b32 v20, 0, v20, vcc
  s_mul_i32 s62, s3, 4128
  s_add_u32 s62, s62, 44032
  v_and_b32 v24, 16, v2
  v_add_u32 v24, s62, v24
  v_mov_b32 v28, 0
  v_mov_b32 v29, 0
  v_mov_b32 v30, 0
  v_mov_b32 v31, 0
  s_waitcnt lgkmcnt(15)
  v_lshl_or_b32 v160, v161, 16, v160
  v_lshl_or_b32 v161, v163, 16, v162
  v_lshl_or_b32 v162, v165, 16, v164
  v_lshl_or_b32 v163, v167, 16, v166
  ds_write_b128 v16, v[160:163] offset:0
  buffer_store_dwordx4 v[160:163], v2, s[8:11], s7 offen offset:0 sc1
  s_waitcnt lgkmcnt(15)
  s_waitcnt lgkmcnt(15)
  v_lshl_or_b32 v168, v169, 16, v168
  v_lshl_or_b32 v169, v171, 16, v170
  v_lshl_or_b32 v170, v173, 16, v172
  v_lshl_or_b32 v171, v175, 16, v174
  ds_write_b128 v16, v[168:171] offset:1024
  buffer_store_dwordx4 v[168:171], v2, s[8:11], s7 offen offset:1024 sc1
  s_waitcnt lgkmcnt(10)
  v_lshl_or_b32 v176, v177, 16, v176
  v_lshl_or_b32 v177, v179, 16, v178
  v_lshl_or_b32 v178, v181, 16, v180
  v_lshl_or_b32 v179, v183, 16, v182
  ds_write_b128 v16, v[176:179] offset:2048
  buffer_store_dwordx4 v[176:179], v2, s[8:11], s7 offen offset:2048 sc1
  s_waitcnt lgkmcnt(3)
  v_lshl_or_b32 v184, v185, 16, v184
  v_lshl_or_b32 v185, v187, 16, v186
  v_lshl_or_b32 v186, v189, 16, v188
  v_lshl_or_b32 v187, v191, 16, v190
  ds_write_b128 v16, v[184:187] offset:3072
  buffer_store_dwordx4 v[184:187], v2, s[8:11], s7 offen offset:3072 sc1
  s_add_u32 s7, s7, 4096
  ds_write_b128 v24, v[28:31]
  s_mov_b32 exec_hi, 0
  ds_write_b128 v16, v[20:23] offset:4096
  buffer_store_dwordx4 v[20:23], v2, s[8:11], s7 offen sc1
  s_mov_b32 exec_hi, -1
  v_and_b32 v16, 15, v0
  v_lshrrev_b32 v17, 4, v0
  v_lshlrev_b32 v18, 5, v16
  s_add_u32 s6, s6, 480
  v_sub_u32 v18, s6, v18
  v_lshl_add_u32 v4, v17, 4, v18
  v_lshlrev_b32 v18, 1, v16
  v_lshl_add_u32 v18, v17, 4, v18
  v_and_b32 v6, 2, v18
  v_and_b32 v18, -4, v18
  v_add_u32 v5, s62, v18
  v_lshlrev_b32 v18, 5, v16
  v_lshl_add_u32 v18, v17, 3, v18
  v_add3_u32 v7, v18, s62, 32
  s_lshl_b32 s7, s3, 12
  s_add_u32 s7, s7, 60544
  v_add_u32 v8, s7, v18
  v_lshrrev_b32 v18, 1, v16
  v_lshlrev_b32 v18, 15, v18
  v_and_b32 v19, 1, v16
  v_lshl_or_b32 v18, v19, 5, v18
  v_lshl_or_b32 v9, v17, 3, v18
  v_lshlrev_b32 v31, 16, v232
  v_add_u32 v60, 1024, v5
  v_add_u32 v61, 2048, v5
  v_add_u32 v62, 3072, v5
  s_lshl_b32 s62, s60, 6
  s_add_u32 s62, s62, 0x0
  s_waitcnt vmcnt(5) lgkmcnt(0)
  s_barrier
  ds_read_b128 a[32:35], v4 offset:4032
  ds_read_b128 a[36:39], v4 offset:3968
  ds_read_b128 a[40:43], v4 offset:3904
  ds_read2_b32 v[10:11], v5 offset0:112 offset1:113
  ds_read2_b32 v[12:13], v5 offset0:114 offset1:115
  ds_read_b32 v14, v5 offset:464
  ds_read2_b32 v[16:17], v5 offset0:96 offset1:97
  ds_read2_b32 v[18:19], v5 offset0:98 offset1:99
  ds_read_b32 v20, v5 offset:400
  ds_read2_b32 v[32:33], v5 offset0:80 offset1:81
  ds_read2_b32 v[34:35], v5 offset0:82 offset1:83
  ds_read_b32 v36, v5 offset:336
  ds_read2_b32 v[38:39], v5 offset0:64 offset1:65
  ds_read2_b32 v[40:41], v5 offset0:66 offset1:67
  ds_read_b32 v42, v5 offset:272
  ds_read2_b32 v[44:45], v5 offset0:48 offset1:49
  ds_read2_b32 v[46:47], v5 offset0:50 offset1:51
  ds_read_b32 v48, v5 offset:208
  s_waitcnt lgkmcnt(12)
  v_alignbyte_b32 v92, v11, v10, v6
  v_alignbyte_b32 v93, v12, v11, v6
  v_alignbyte_b32 v94, v13, v12, v6
  v_alignbyte_b32 v95, v14, v13, v6
  s_waitcnt lgkmcnt(9)
  v_alignbyte_b32 v88, v17, v16, v6
  v_alignbyte_b32 v89, v18, v17, v6
  v_alignbyte_b32 v90, v19, v18, v6
  v_alignbyte_b32 v91, v20, v19, v6
  v_mfma_f32_16x16x32_bf16 a[0:3], v[92:95], a[32:35], 0
  ds_read2_b32 v[10:11], v5 offset0:32 offset1:33
  ds_read2_b32 v[12:13], v5 offset0:34 offset1:35
  ds_read_b32 v14, v5 offset:144
  ds_read_b128 a[44:47], v4 offset:3840
  s_waitcnt lgkmcnt(10)
  v_alignbyte_b32 v84, v33, v32, v6
  v_alignbyte_b32 v85, v34, v33, v6
  v_alignbyte_b32 v86, v35, v34, v6
  v_alignbyte_b32 v87, v36, v35, v6
  v_mfma_f32_16x16x32_bf16 a[0:3], v[88:91], a[36:39], a[0:3]
  ds_read2_b32 v[16:17], v5 offset0:16 offset1:17
  ds_read2_b32 v[18:19], v5 offset0:18 offset1:19
  ds_read_b32 v20, v5 offset:80
  ds_read_b128 a[32:35], v4 offset:3776
  s_waitcnt lgkmcnt(11)
  v_alignbyte_b32 v80, v39, v38, v6
  v_alignbyte_b32 v81, v40, v39, v6
  v_alignbyte_b32 v82, v41, v40, v6
  v_alignbyte_b32 v83, v42, v41, v6
  v_mfma_f32_16x16x32_bf16 a[0:3], v[84:87], a[40:43], a[0:3]
  ds_read2_b32 v[32:33], v5 offset0:0 offset1:1
  ds_read2_b32 v[34:35], v5 offset0:2 offset1:3
  ds_read_b32 v36, v5 offset:16
  ds_read_b128 a[36:39], v4 offset:3712
  s_waitcnt lgkmcnt(12)
  v_alignbyte_b32 v76, v45, v44, v6
  v_alignbyte_b32 v77, v46, v45, v6
  v_alignbyte_b32 v78, v47, v46, v6
  v_alignbyte_b32 v79, v48, v47, v6
  s_waitcnt lgkmcnt(8)
  v_mfma_f32_16x16x32_bf16 a[0:3], v[80:83], a[44:47], a[0:3]
  ds_read2_b32 v[38:39], v62 offset0:240 offset1:241
  ds_read2_b32 v[40:41], v62 offset0:242 offset1:243
  ds_read_b32 v42, v62 offset:976
  ds_read_b128 a[40:43], v4 offset:3648
  v_alignbyte_b32 v72, v11, v10, v6
  v_alignbyte_b32 v73, v12, v11, v6
  v_alignbyte_b32 v74, v13, v12, v6
  v_alignbyte_b32 v75, v14, v13, v6
  s_waitcnt lgkmcnt(8)
  v_mfma_f32_16x16x32_bf16 a[0:3], v[76:79], a[32:35], a[0:3]
  ds_read2_b32 v[44:45], v62 offset0:112 offset1:113
  ds_read2_b32 v[46:47], v62 offset0:114 offset1:115
  ds_read_b32 v48, v62 offset:464
  ds_read_b128 a[44:47], v4 offset:3584
  v_alignbyte_b32 v68, v17, v16, v6
  v_alignbyte_b32 v69, v18, v17, v6
  v_alignbyte_b32 v70, v19, v18, v6
  v_alignbyte_b32 v71, v20, v19, v6
  s_waitcnt lgkmcnt(8)
  v_mfma_f32_16x16x32_bf16 a[0:3], v[72:75], a[36:39], a[0:3]
  ds_read2_b32 v[10:11], v61 offset0:240 offset1:241
  ds_read2_b32 v[12:13], v61 offset0:242 offset1:243
  ds_read_b32 v14, v61 offset:976
  ds_read_b128 a[32:35], v4 offset:4032
  v_alignbyte_b32 v64, v33, v32, v6
  v_alignbyte_b32 v65, v34, v33, v6
  v_alignbyte_b32 v66, v35, v34, v6
  v_alignbyte_b32 v67, v36, v35, v6
  s_waitcnt lgkmcnt(8)
  v_mfma_f32_16x16x32_bf16 a[0:3], v[68:71], a[40:43], a[0:3]
  ds_read2_b32 v[16:17], v61 offset0:112 offset1:113
  ds_read2_b32 v[18:19], v61 offset0:114 offset1:115
  ds_read_b32 v20, v61 offset:464
  ds_read_b128 a[36:39], v4 offset:3968
  v_alignbyte_b32 v26, v39, v38, v6
  v_alignbyte_b32 v27, v40, v39, v6
  v_alignbyte_b32 v28, v41, v40, v6
  v_alignbyte_b32 v29, v42, v41, v6
  s_waitcnt lgkmcnt(8)
  v_mfma_f32_16x16x32_bf16 a[0:3], v[64:67], a[44:47], a[0:3]
  ds_read2_b32 v[32:33], v60 offset0:240 offset1:241
  ds_read2_b32 v[34:35], v60 offset0:242 offset1:243
  ds_read_b32 v36, v60 offset:976
  ds_read_b128 a[40:43], v4 offset:3904
  v_alignbyte_b32 v56, v45, v44, v6
  v_alignbyte_b32 v57, v46, v45, v6
  v_alignbyte_b32 v58, v47, v46, v6
  v_alignbyte_b32 v59, v48, v47, v6
  v_accvgpr_write_b32 a92, v56
  v_accvgpr_write_b32 a93, v57
  v_accvgpr_write_b32 a94, v58
  v_accvgpr_write_b32 a95, v59
  s_waitcnt lgkmcnt(8)
  v_mfma_f32_16x16x32_bf16 a[28:31], v[26:29], a[32:35], 0
  ds_read2_b32 v[38:39], v60 offset0:112 offset1:113
  ds_read2_b32 v[40:41], v60 offset0:114 offset1:115
  ds_read_b32 v42, v60 offset:464
  ds_read_b128 a[44:47], v4 offset:3840
  ds_read_b64 v[224:225], v7 offset:0
  ds_read_b64 v[226:227], v8 offset:0
  v_accvgpr_read_b32 v96, a0
  v_accvgpr_read_b32 v97, a1
  v_accvgpr_read_b32 v98, a2
  v_accvgpr_read_b32 v99, a3
  s_waitcnt lgkmcnt(0)
  v_lshlrev_b32 v128, 16, v224
  v_and_b32 v129, 0xffff0000, v224
  v_lshlrev_b32 v130, 16, v225
  v_and_b32 v131, 0xffff0000, v225
  v_lshlrev_b32 v192, 16, v226
  v_and_b32 v193, 0xffff0000, v226
  v_lshlrev_b32 v194, 16, v227
  v_and_b32 v195, 0xffff0000, v227
  v_mul_f32 v160, v128, v31
  v_mul_f32 v161, v129, v31
  v_mul_f32 v162, v130, v31
  v_mul_f32 v163, v131, v31
  v_fmac_f32 v96, s61, v128
  v_fmac_f32 v97, s61, v129
  v_fmac_f32 v98, s61, v130
  v_fmac_f32 v99, s61, v131
  v_cvt_pk_bf16_f32 v224, v160, v161
  v_cvt_pk_bf16_f32 v225, v162, v163
  v_lshlrev_b32 v160, 16, v224
  v_and_b32 v161, 0xffff0000, v224
  v_lshlrev_b32 v162, 16, v225
  v_and_b32 v163, 0xffff0000, v225
  v_cvt_pk_bf16_f32 v224, v96, v97
  v_cvt_pk_bf16_f32 v225, v98, v99
  v_lshlrev_b32 v96, 16, v224
  v_and_b32 v97, 0xffff0000, v224
  v_lshlrev_b32 v98, 16, v225
  v_and_b32 v99, 0xffff0000, v225
  v_add_f32 v96, v96, v160
  v_add_f32 v97, v97, v161
  v_add_f32 v98, v98, v162
  v_add_f32 v99, v99, v163
  v_cvt_pk_bf16_f32 v224, v96, v97
  v_cvt_pk_bf16_f32 v225, v98, v99
  v_lshlrev_b32 v96, 16, v224
  v_and_b32 v97, 0xffff0000, v224
  v_lshlrev_b32 v98, 16, v225
  v_and_b32 v99, 0xffff0000, v225
  v_add_f32 v96, v96, v192
  v_add_f32 v97, v97, v193
  v_add_f32 v98, v98, v194
  v_add_f32 v99, v99, v195
  v_cvt_pk_bf16_f32 v224, v96, v97
  v_cvt_pk_bf16_f32 v225, v98, v99
  s_add_u32 s6, s62, 0
  buffer_store_dwordx2 v[224:225], v9, s[8:11], s6 offen sc1
  v_alignbyte_b32 v252, v11, v10, v6
  v_alignbyte_b32 v253, v12, v11, v6
  v_alignbyte_b32 v254, v13, v12, v6
  v_alignbyte_b32 v255, v14, v13, v6
  v_mfma_f32_16x16x32_bf16 a[24:27], a[92:95], a[32:35], 0
  ds_read2_b32 v[44:45], v5 offset0:240 offset1:241
  ds_read2_b32 v[46:47], v5 offset0:242 offset1:243
  ds_read_b32 v48, v5 offset:976
  v_alignbyte_b32 v220, v17, v16, v6
  v_alignbyte_b32 v221, v18, v17, v6
  v_alignbyte_b32 v222, v19, v18, v6
  v_alignbyte_b32 v223, v20, v19, v6
  v_mfma_f32_16x16x32_bf16 a[20:23], v[252:255], a[32:35], 0
  ds_read2_b32 v[10:11], v62 offset0:224 offset1:225
  ds_read2_b32 v[12:13], v62 offset0:226 offset1:227
  ds_read_b32 v14, v62 offset:912
  v_alignbyte_b32 v188, v33, v32, v6
  v_alignbyte_b32 v189, v34, v33, v6
  v_alignbyte_b32 v190, v35, v34, v6
  v_alignbyte_b32 v191, v36, v35, v6
  v_mfma_f32_16x16x32_bf16 a[16:19], v[220:223], a[32:35], 0
  ds_read2_b32 v[16:17], v62 offset0:96 offset1:97
  ds_read2_b32 v[18:19], v62 offset0:98 offset1:99
  ds_read_b32 v20, v62 offset:400
  v_alignbyte_b32 v156, v39, v38, v6
  v_alignbyte_b32 v157, v40, v39, v6
  v_alignbyte_b32 v158, v41, v40, v6
  v_alignbyte_b32 v159, v42, v41, v6
  v_mfma_f32_16x16x32_bf16 a[12:15], v[188:191], a[32:35], 0
  ds_read2_b32 v[32:33], v61 offset0:224 offset1:225
  ds_read2_b32 v[34:35], v61 offset0:226 offset1:227
  ds_read_b32 v36, v61 offset:912
  s_waitcnt lgkmcnt(9)
  v_alignbyte_b32 v124, v45, v44, v6
  v_alignbyte_b32 v125, v46, v45, v6
  v_alignbyte_b32 v126, v47, v46, v6
  v_alignbyte_b32 v127, v48, v47, v6
  v_mfma_f32_16x16x32_bf16 a[8:11], v[156:159], a[32:35], 0
  ds_read2_b32 v[38:39], v61 offset0:96 offset1:97
  ds_read2_b32 v[40:41], v61 offset0:98 offset1:99
  ds_read_b32 v42, v61 offset:400
  s_waitcnt lgkmcnt(9)
  v_alignbyte_b32 v22, v11, v10, v6
  v_alignbyte_b32 v23, v12, v11, v6
  v_alignbyte_b32 v24, v13, v12, v6
  v_alignbyte_b32 v25, v14, v13, v6
  v_mfma_f32_16x16x32_bf16 a[4:7], v[124:127], a[32:35], 0
  ds_read2_b32 v[44:45], v60 offset0:224 offset1:225
  ds_read2_b32 v[46:47], v60 offset0:226 offset1:227
  ds_read_b32 v48, v60 offset:912
  s_waitcnt lgkmcnt(9)
  v_alignbyte_b32 v56, v17, v16, v6
  v_alignbyte_b32 v57, v18, v17, v6
  v_alignbyte_b32 v58, v19, v18, v6
  v_alignbyte_b32 v59, v20, v19, v6
  v_accvgpr_write_b32 a88, v56
  v_accvgpr_write_b32 a89, v57
  v_accvgpr_write_b32 a90, v58
  v_accvgpr_write_b32 a91, v59
  v_mfma_f32_16x16x32_bf16 a[28:31], v[22:25], a[36:39], a[28:31]
  ds_read2_b32 v[10:11], v60 offset0:96 offset1:97
  ds_read2_b32 v[12:13], v60 offset0:98 offset1:99
  ds_read_b32 v14, v60 offset:400
  ds_read_b128 a[32:35], v4 offset:3776
  s_waitcnt lgkmcnt(10)
  v_alignbyte_b32 v248, v33, v32, v6
  v_alignbyte_b32 v249, v34, v33, v6
  v_alignbyte_b32 v250, v35, v34, v6
  v_alignbyte_b32 v251, v36, v35, v6
  v_mfma_f32_16x16x32_bf16 a[24:27], a[88:91], a[36:39], a[24:27]
  ds_read2_b32 v[16:17], v5 offset0:224 offset1:225
  ds_read2_b32 v[18:19], v5 offset0:226 offset1:227
  ds_read_b32 v20, v5 offset:912
  s_waitcnt lgkmcnt(10)
  v_alignbyte_b32 v216, v39, v38, v6
  v_alignbyte_b32 v217, v40, v39, v6
  v_alignbyte_b32 v218, v41, v40, v6
  v_alignbyte_b32 v219, v42, v41, v6
  v_mfma_f32_16x16x32_bf16 a[20:23], v[248:251], a[36:39], a[20:23]
  ds_read2_b32 v[32:33], v62 offset0:208 offset1:209
  ds_read2_b32 v[34:35], v62 offset0:210 offset1:211
  ds_read_b32 v36, v62 offset:848
  s_waitcnt lgkmcnt(10)
  v_alignbyte_b32 v184, v45, v44, v6
  v_alignbyte_b32 v185, v46, v45, v6
  v_alignbyte_b32 v186, v47, v46, v6
  v_alignbyte_b32 v187, v48, v47, v6
  v_mfma_f32_16x16x32_bf16 a[16:19], v[216:219], a[36:39], a[16:19]
  ds_read2_b32 v[38:39], v62 offset0:80 offset1:81
  ds_read2_b32 v[40:41], v62 offset0:82 offset1:83
  ds_read_b32 v42, v62 offset:336
  s_waitcnt lgkmcnt(10)
  v_alignbyte_b32 v152, v11, v10, v6
  v_alignbyte_b32 v153, v12, v11, v6
  v_alignbyte_b32 v154, v13, v12, v6
  v_alignbyte_b32 v155, v14, v13, v6
  v_mfma_f32_16x16x32_bf16 a[12:15], v[184:187], a[36:39], a[12:15]
  ds_read2_b32 v[44:45], v61 offset0:208 offset1:209
  ds_read2_b32 v[46:47], v61 offset0:210 offset1:211
  ds_read_b32 v48, v61 offset:848
  s_waitcnt lgkmcnt(9)
  v_alignbyte_b32 v120, v17, v16, v6
  v_alignbyte_b32 v121, v18, v17, v6
  v_alignbyte_b32 v122, v19, v18, v6
  v_alignbyte_b32 v123, v20, v19, v6
  v_mfma_f32_16x16x32_bf16 a[8:11], v[152:155], a[36:39], a[8:11]
  ds_read2_b32 v[10:11], v61 offset0:80 offset1:81
  ds_read2_b32 v[12:13], v61 offset0:82 offset1:83
  ds_read_b32 v14, v61 offset:336
  s_waitcnt lgkmcnt(9)
  v_alignbyte_b32 v26, v33, v32, v6
  v_alignbyte_b32 v27, v34, v33, v6
  v_alignbyte_b32 v28, v35, v34, v6
  v_alignbyte_b32 v29, v36, v35, v6
  v_mfma_f32_16x16x32_bf16 a[4:7], v[120:123], a[36:39], a[4:7]
  ds_read2_b32 v[16:17], v60 offset0:208 offset1:209
  ds_read2_b32 v[18:19], v60 offset0:210 offset1:211
  ds_read_b32 v20, v60 offset:848
  s_waitcnt lgkmcnt(9)
  v_alignbyte_b32 v56, v39, v38, v6
  v_alignbyte_b32 v57, v40, v39, v6
  v_alignbyte_b32 v58, v41, v40, v6
  v_alignbyte_b32 v59, v42, v41, v6
  v_accvgpr_write_b32 a84, v56
  v_accvgpr_write_b32 a85, v57
  v_accvgpr_write_b32 a86, v58
  v_accvgpr_write_b32 a87, v59
  v_mfma_f32_16x16x32_bf16 a[28:31], v[26:29], a[40:43], a[28:31]
  ds_read2_b32 v[32:33], v60 offset0:80 offset1:81
  ds_read2_b32 v[34:35], v60 offset0:82 offset1:83
  ds_read_b32 v36, v60 offset:336
  ds_read_b128 a[36:39], v4 offset:3712
  s_lshl_b32 s6, s60, 2
  s_add_u32 s6, s6, 0x710000
  v_mov_b32 v226, 8
  s_waitcnt vmcnt(0)
  s_mov_b64 exec, 1
  buffer_store_dword v226, v1, s[8:11], s6 offen sc1
  s_mov_b64 exec, -1
  s_waitcnt lgkmcnt(10)
  v_alignbyte_b32 v244, v45, v44, v6
  v_alignbyte_b32 v245, v46, v45, v6
  v_alignbyte_b32 v246, v47, v46, v6
  v_alignbyte_b32 v247, v48, v47, v6
  v_mfma_f32_16x16x32_bf16 a[24:27], a[84:87], a[40:43], a[24:27]
  ds_read2_b32 v[38:39], v5 offset0:208 offset1:209
  ds_read2_b32 v[40:41], v5 offset0:210 offset1:211
  ds_read_b32 v42, v5 offset:848
  s_waitcnt lgkmcnt(10)
  v_alignbyte_b32 v212, v11, v10, v6
  v_alignbyte_b32 v213, v12, v11, v6
  v_alignbyte_b32 v214, v13, v12, v6
  v_alignbyte_b32 v215, v14, v13, v6
  v_mfma_f32_16x16x32_bf16 a[20:23], v[244:247], a[40:43], a[20:23]
  ds_read2_b32 v[44:45], v62 offset0:192 offset1:193
  ds_read2_b32 v[46:47], v62 offset0:194 offset1:195
  ds_read_b32 v48, v62 offset:784
  s_waitcnt lgkmcnt(10)
  v_alignbyte_b32 v180, v17, v16, v6
  v_alignbyte_b32 v181, v18, v17, v6
  v_alignbyte_b32 v182, v19, v18, v6
  v_alignbyte_b32 v183, v20, v19, v6
  v_mfma_f32_16x16x32_bf16 a[16:19], v[212:215], a[40:43], a[16:19]
  ds_read2_b32 v[10:11], v62 offset0:64 offset1:65
  ds_read2_b32 v[12:13], v62 offset0:66 offset1:67
  ds_read_b32 v14, v62 offset:272
  s_waitcnt lgkmcnt(10)
  v_alignbyte_b32 v148, v33, v32, v6
  v_alignbyte_b32 v149, v34, v33, v6
  v_alignbyte_b32 v150, v35, v34, v6
  v_alignbyte_b32 v151, v36, v35, v6
  v_mfma_f32_16x16x32_bf16 a[12:15], v[180:183], a[40:43], a[12:15]
  ds_read2_b32 v[16:17], v61 offset0:192 offset1:193
  ds_read2_b32 v[18:19], v61 offset0:194 offset1:195
  ds_read_b32 v20, v61 offset:784
  s_waitcnt lgkmcnt(9)
  v_alignbyte_b32 v116, v39, v38, v6
  v_alignbyte_b32 v117, v40, v39, v6
  v_alignbyte_b32 v118, v41, v40, v6
  v_alignbyte_b32 v119, v42, v41, v6
  v_mfma_f32_16x16x32_bf16 a[8:11], v[148:151], a[40:43], a[8:11]
  ds_read2_b32 v[32:33], v61 offset0:64 offset1:65
  ds_read2_b32 v[34:35], v61 offset0:66 offset1:67
  ds_read_b32 v36, v61 offset:272
  s_waitcnt lgkmcnt(9)
  v_alignbyte_b32 v22, v45, v44, v6
  v_alignbyte_b32 v23, v46, v45, v6
  v_alignbyte_b32 v24, v47, v46, v6
  v_alignbyte_b32 v25, v48, v47, v6
  v_mfma_f32_16x16x32_bf16 a[4:7], v[116:119], a[40:43], a[4:7]
  ds_read2_b32 v[38:39], v60 offset0:192 offset1:193
  ds_read2_b32 v[40:41], v60 offset0:194 offset1:195
  ds_read_b32 v42, v60 offset:784
  s_waitcnt lgkmcnt(9)
  v_alignbyte_b32 v56, v11, v10, v6
  v_alignbyte_b32 v57, v12, v11, v6
  v_alignbyte_b32 v58, v13, v12, v6
  v_alignbyte_b32 v59, v14, v13, v6
  v_accvgpr_write_b32 a80, v56
  v_accvgpr_write_b32 a81, v57
  v_accvgpr_write_b32 a82, v58
  v_accvgpr_write_b32 a83, v59
  v_mfma_f32_16x16x32_bf16 a[28:31], v[22:25], a[44:47], a[28:31]
  ds_read2_b32 v[44:45], v60 offset0:64 offset1:65
  ds_read2_b32 v[46:47], v60 offset0:66 offset1:67
  ds_read_b32 v48, v60 offset:272
  ds_read_b128 a[40:43], v4 offset:3648
  s_waitcnt lgkmcnt(10)
  v_alignbyte_b32 v240, v17, v16, v6
  v_alignbyte_b32 v241, v18, v17, v6
  v_alignbyte_b32 v242, v19, v18, v6
  v_alignbyte_b32 v243, v20, v19, v6
  v_mfma_f32_16x16x32_bf16 a[24:27], a[80:83], a[44:47], a[24:27]
  ds_read2_b32 v[10:11], v5 offset0:192 offset1:193
  ds_read2_b32 v[12:13], v5 offset0:194 offset1:195
  ds_read_b32 v14, v5 offset:784
  s_waitcnt lgkmcnt(10)
  v_alignbyte_b32 v208, v33, v32, v6
  v_alignbyte_b32 v209, v34, v33, v6
  v_alignbyte_b32 v210, v35, v34, v6
  v_alignbyte_b32 v211, v36, v35, v6
  v_mfma_f32_16x16x32_bf16 a[20:23], v[240:243], a[44:47], a[20:23]
  ds_read2_b32 v[16:17], v62 offset0:176 offset1:177
  ds_read2_b32 v[18:19], v62 offset0:178 offset1:179
  ds_read_b32 v20, v62 offset:720
  s_waitcnt lgkmcnt(10)
  v_alignbyte_b32 v176, v39, v38, v6
  v_alignbyte_b32 v177, v40, v39, v6
  v_alignbyte_b32 v178, v41, v40, v6
  v_alignbyte_b32 v179, v42, v41, v6
  v_mfma_f32_16x16x32_bf16 a[16:19], v[208:211], a[44:47], a[16:19]
  ds_read2_b32 v[32:33], v62 offset0:48 offset1:49
  ds_read2_b32 v[34:35], v62 offset0:50 offset1:51
  ds_read_b32 v36, v62 offset:208
  s_waitcnt lgkmcnt(10)
  v_alignbyte_b32 v144, v45, v44, v6
  v_alignbyte_b32 v145, v46, v45, v6
  v_alignbyte_b32 v146, v47, v46, v6
  v_alignbyte_b32 v147, v48, v47, v6
  v_mfma_f32_16x16x32_bf16 a[12:15], v[176:179], a[44:47], a[12:15]
  ds_read2_b32 v[38:39], v61 offset0:176 offset1:177
  ds_read2_b32 v[40:41], v61 offset0:178 offset1:179
  ds_read_b32 v42, v61 offset:720
  s_waitcnt lgkmcnt(9)
  v_alignbyte_b32 v112, v11, v10, v6
  v_alignbyte_b32 v113, v12, v11, v6
  v_alignbyte_b32 v114, v13, v12, v6
  v_alignbyte_b32 v115, v14, v13, v6
  v_mfma_f32_16x16x32_bf16 a[8:11], v[144:147], a[44:47], a[8:11]
  ds_read2_b32 v[44:45], v61 offset0:48 offset1:49
  ds_read2_b32 v[46:47], v61 offset0:50 offset1:51
  ds_read_b32 v48, v61 offset:208
  s_waitcnt lgkmcnt(9)
  v_alignbyte_b32 v26, v17, v16, v6
  v_alignbyte_b32 v27, v18, v17, v6
  v_alignbyte_b32 v28, v19, v18, v6
  v_alignbyte_b32 v29, v20, v19, v6
  v_mfma_f32_16x16x32_bf16 a[4:7], v[112:115], a[44:47], a[4:7]
  ds_read2_b32 v[10:11], v60 offset0:176 offset1:177
  ds_read2_b32 v[12:13], v60 offset0:178 offset1:179
  ds_read_b32 v14, v60 offset:720
  s_waitcnt lgkmcnt(9)
  v_alignbyte_b32 v56, v33, v32, v6
  v_alignbyte_b32 v57, v34, v33, v6
  v_alignbyte_b32 v58, v35, v34, v6
  v_alignbyte_b32 v59, v36, v35, v6
  v_accvgpr_write_b32 a76, v56
  v_accvgpr_write_b32 a77, v57
  v_accvgpr_write_b32 a78, v58
  v_accvgpr_write_b32 a79, v59
  v_mfma_f32_16x16x32_bf16 a[28:31], v[26:29], a[32:35], a[28:31]
  ds_read2_b32 v[16:17], v60 offset0:48 offset1:49
  ds_read2_b32 v[18:19], v60 offset0:50 offset1:51
  ds_read_b32 v20, v60 offset:208
  ds_read_b128 a[44:47], v4 offset:3584
  s_waitcnt lgkmcnt(10)
  v_alignbyte_b32 v236, v39, v38, v6
  v_alignbyte_b32 v237, v40, v39, v6
  v_alignbyte_b32 v238, v41, v40, v6
  v_alignbyte_b32 v239, v42, v41, v6
  v_mfma_f32_16x16x32_bf16 a[24:27], a[76:79], a[32:35], a[24:27]
  ds_read2_b32 v[32:33], v5 offset0:176 offset1:177
  ds_read2_b32 v[34:35], v5 offset0:178 offset1:179
  ds_read_b32 v36, v5 offset:720
  s_waitcnt lgkmcnt(10)
  v_alignbyte_b32 v204, v45, v44, v6
  v_alignbyte_b32 v205, v46, v45, v6
  v_alignbyte_b32 v206, v47, v46, v6
  v_alignbyte_b32 v207, v48, v47, v6
  v_mfma_f32_16x16x32_bf16 a[20:23], v[236:239], a[32:35], a[20:23]
  ds_read2_b32 v[38:39], v62 offset0:160 offset1:161
  ds_read2_b32 v[40:41], v62 offset0:162 offset1:163
  ds_read_b32 v42, v62 offset:656
  s_waitcnt lgkmcnt(10)
  v_alignbyte_b32 v172, v11, v10, v6
  v_alignbyte_b32 v173, v12, v11, v6
  v_alignbyte_b32 v174, v13, v12, v6
  v_alignbyte_b32 v175, v14, v13, v6
  v_mfma_f32_16x16x32_bf16 a[16:19], v[204:207], a[32:35], a[16:19]
  ds_read2_b32 v[44:45], v62 offset0:32 offset1:33
  ds_read2_b32 v[46:47], v62 offset0:34 offset1:35
  ds_read_b32 v48, v62 offset:144
  s_waitcnt lgkmcnt(10)
  v_alignbyte_b32 v140, v17, v16, v6
  v_alignbyte_b32 v141, v18, v17, v6
  v_alignbyte_b32 v142, v19, v18, v6
  v_alignbyte_b32 v143, v20, v19, v6
  v_mfma_f32_16x16x32_bf16 a[12:15], v[172:175], a[32:35], a[12:15]
  ds_read2_b32 v[10:11], v61 offset0:160 offset1:161
  ds_read2_b32 v[12:13], v61 offset0:162 offset1:163
  ds_read_b32 v14, v61 offset:656
  s_waitcnt lgkmcnt(9)
  v_alignbyte_b32 v108, v33, v32, v6
  v_alignbyte_b32 v109, v34, v33, v6
  v_alignbyte_b32 v110, v35, v34, v6
  v_alignbyte_b32 v111, v36, v35, v6
  v_mfma_f32_16x16x32_bf16 a[8:11], v[140:143], a[32:35], a[8:11]
  ds_read2_b32 v[16:17], v61 offset0:32 offset1:33
  ds_read2_b32 v[18:19], v61 offset0:34 offset1:35
  ds_read_b32 v20, v61 offset:144
  s_waitcnt lgkmcnt(9)
  v_alignbyte_b32 v22, v39, v38, v6
  v_alignbyte_b32 v23, v40, v39, v6
  v_alignbyte_b32 v24, v41, v40, v6
  v_alignbyte_b32 v25, v42, v41, v6
  v_mfma_f32_16x16x32_bf16 a[4:7], v[108:111], a[32:35], a[4:7]
  ds_read2_b32 v[32:33], v60 offset0:160 offset1:161
  ds_read2_b32 v[34:35], v60 offset0:162 offset1:163
  ds_read_b32 v36, v60 offset:656
  s_waitcnt lgkmcnt(9)
  v_alignbyte_b32 v56, v45, v44, v6
  v_alignbyte_b32 v57, v46, v45, v6
  v_alignbyte_b32 v58, v47, v46, v6
  v_alignbyte_b32 v59, v48, v47, v6
  v_accvgpr_write_b32 a72, v56
  v_accvgpr_write_b32 a73, v57
  v_accvgpr_write_b32 a74, v58
  v_accvgpr_write_b32 a75, v59
  v_mfma_f32_16x16x32_bf16 a[28:31], v[22:25], a[36:39], a[28:31]
  ds_read2_b32 v[38:39], v60 offset0:32 offset1:33
  ds_read2_b32 v[40:41], v60 offset0:34 offset1:35
  ds_read_b32 v42, v60 offset:144
  ds_read_b128 a[32:35], v4 offset:3520
  s_waitcnt lgkmcnt(10)
  v_alignbyte_b32 v232, v11, v10, v6
  v_alignbyte_b32 v233, v12, v11, v6
  v_alignbyte_b32 v234, v13, v12, v6
  v_alignbyte_b32 v235, v14, v13, v6
  v_mfma_f32_16x16x32_bf16 a[24:27], a[72:75], a[36:39], a[24:27]
  ds_read2_b32 v[44:45], v5 offset0:160 offset1:161
  ds_read2_b32 v[46:47], v5 offset0:162 offset1:163
  ds_read_b32 v48, v5 offset:656
  s_waitcnt lgkmcnt(10)
  v_alignbyte_b32 v200, v17, v16, v6
  v_alignbyte_b32 v201, v18, v17, v6
  v_alignbyte_b32 v202, v19, v18, v6
  v_alignbyte_b32 v203, v20, v19, v6
  v_mfma_f32_16x16x32_bf16 a[20:23], v[232:235], a[36:39], a[20:23]
  ds_read2_b32 v[10:11], v62 offset0:144 offset1:145
  ds_read2_b32 v[12:13], v62 offset0:146 offset1:147
  ds_read_b32 v14, v62 offset:592
  s_waitcnt lgkmcnt(10)
  v_alignbyte_b32 v168, v33, v32, v6
  v_alignbyte_b32 v169, v34, v33, v6
  v_alignbyte_b32 v170, v35, v34, v6
  v_alignbyte_b32 v171, v36, v35, v6
  v_mfma_f32_16x16x32_bf16 a[16:19], v[200:203], a[36:39], a[16:19]
  ds_read2_b32 v[16:17], v62 offset0:16 offset1:17
  ds_read2_b32 v[18:19], v62 offset0:18 offset1:19
  ds_read_b32 v20, v62 offset:80
  s_waitcnt lgkmcnt(10)
  v_alignbyte_b32 v136, v39, v38, v6
  v_alignbyte_b32 v137, v40, v39, v6
  v_alignbyte_b32 v138, v41, v40, v6
  v_alignbyte_b32 v139, v42, v41, v6
  v_mfma_f32_16x16x32_bf16 a[12:15], v[168:171], a[36:39], a[12:15]
  ds_read2_b32 v[32:33], v61 offset0:144 offset1:145
  ds_read2_b32 v[34:35], v61 offset0:146 offset1:147
  ds_read_b32 v36, v61 offset:592
  s_waitcnt lgkmcnt(9)
  v_alignbyte_b32 v104, v45, v44, v6
  v_alignbyte_b32 v105, v46, v45, v6
  v_alignbyte_b32 v106, v47, v46, v6
  v_alignbyte_b32 v107, v48, v47, v6
  v_mfma_f32_16x16x32_bf16 a[8:11], v[136:139], a[36:39], a[8:11]
  ds_read2_b32 v[38:39], v61 offset0:16 offset1:17
  ds_read2_b32 v[40:41], v61 offset0:18 offset1:19
  ds_read_b32 v42, v61 offset:80
  s_waitcnt lgkmcnt(9)
  v_alignbyte_b32 v26, v11, v10, v6
  v_alignbyte_b32 v27, v12, v11, v6
  v_alignbyte_b32 v28, v13, v12, v6
  v_alignbyte_b32 v29, v14, v13, v6
  v_mfma_f32_16x16x32_bf16 a[4:7], v[104:107], a[36:39], a[4:7]
  ds_read2_b32 v[44:45], v60 offset0:144 offset1:145
  ds_read2_b32 v[46:47], v60 offset0:146 offset1:147
  ds_read_b32 v48, v60 offset:592
  s_waitcnt lgkmcnt(9)
  v_alignbyte_b32 v56, v17, v16, v6
  v_alignbyte_b32 v57, v18, v17, v6
  v_alignbyte_b32 v58, v19, v18, v6
  v_alignbyte_b32 v59, v20, v19, v6
  v_accvgpr_write_b32 a68, v56
  v_accvgpr_write_b32 a69, v57
  v_accvgpr_write_b32 a70, v58
  v_accvgpr_write_b32 a71, v59
  v_mfma_f32_16x16x32_bf16 a[28:31], v[26:29], a[40:43], a[28:31]
  ds_read2_b32 v[10:11], v60 offset0:16 offset1:17
  ds_read2_b32 v[12:13], v60 offset0:18 offset1:19
  ds_read_b32 v14, v60 offset:80
  ds_read_b128 a[36:39], v4 offset:3456
  s_waitcnt lgkmcnt(10)
  v_alignbyte_b32 v228, v33, v32, v6
  v_alignbyte_b32 v229, v34, v33, v6
  v_alignbyte_b32 v230, v35, v34, v6
  v_alignbyte_b32 v231, v36, v35, v6
  v_mfma_f32_16x16x32_bf16 a[24:27], a[68:71], a[40:43], a[24:27]
  ds_read2_b32 v[16:17], v5 offset0:144 offset1:145
  ds_read2_b32 v[18:19], v5 offset0:146 offset1:147
  ds_read_b32 v20, v5 offset:592
  s_waitcnt lgkmcnt(10)
  v_alignbyte_b32 v196, v39, v38, v6
  v_alignbyte_b32 v197, v40, v39, v6
  v_alignbyte_b32 v198, v41, v40, v6
  v_alignbyte_b32 v199, v42, v41, v6
  v_mfma_f32_16x16x32_bf16 a[20:23], v[228:231], a[40:43], a[20:23]
  ds_read2_b32 v[32:33], v62 offset0:128 offset1:129
  ds_read2_b32 v[34:35], v62 offset0:130 offset1:131
  ds_read_b32 v36, v62 offset:528
  s_waitcnt lgkmcnt(10)
  v_alignbyte_b32 v164, v45, v44, v6
  v_alignbyte_b32 v165, v46, v45, v6
  v_alignbyte_b32 v166, v47, v46, v6
  v_alignbyte_b32 v167, v48, v47, v6
  v_mfma_f32_16x16x32_bf16 a[16:19], v[196:199], a[40:43], a[16:19]
  ds_read2_b32 v[38:39], v62 offset0:0 offset1:1
  ds_read2_b32 v[40:41], v62 offset0:2 offset1:3
  ds_read_b32 v42, v62 offset:16
  s_waitcnt lgkmcnt(10)
  v_alignbyte_b32 v132, v11, v10, v6
  v_alignbyte_b32 v133, v12, v11, v6
  v_alignbyte_b32 v134, v13, v12, v6
  v_alignbyte_b32 v135, v14, v13, v6
  v_mfma_f32_16x16x32_bf16 a[12:15], v[164:167], a[40:43], a[12:15]
  ds_read2_b32 v[44:45], v61 offset0:128 offset1:129
  ds_read2_b32 v[46:47], v61 offset0:130 offset1:131
  ds_read_b32 v48, v61 offset:528
  s_waitcnt lgkmcnt(9)
  v_alignbyte_b32 v100, v17, v16, v6
  v_alignbyte_b32 v101, v18, v17, v6
  v_alignbyte_b32 v102, v19, v18, v6
  v_alignbyte_b32 v103, v20, v19, v6
  v_mfma_f32_16x16x32_bf16 a[8:11], v[132:135], a[40:43], a[8:11]
  ds_read2_b32 v[10:11], v61 offset0:0 offset1:1
  ds_read2_b32 v[12:13], v61 offset0:2 offset1:3
  ds_read_b32 v14, v61 offset:16
  s_waitcnt lgkmcnt(9)
  v_alignbyte_b32 v22, v33, v32, v6
  v_alignbyte_b32 v23, v34, v33, v6
  v_alignbyte_b32 v24, v35, v34, v6
  v_alignbyte_b32 v25, v36, v35, v6
  v_mfma_f32_16x16x32_bf16 a[4:7], v[100:103], a[40:43], a[4:7]
  ds_read2_b32 v[16:17], v60 offset0:128 offset1:129
  ds_read2_b32 v[18:19], v60 offset0:130 offset1:131
  ds_read_b32 v20, v60 offset:528
  s_waitcnt lgkmcnt(9)
  v_alignbyte_b32 v56, v39, v38, v6
  v_alignbyte_b32 v57, v40, v39, v6
  v_alignbyte_b32 v58, v41, v40, v6
  v_alignbyte_b32 v59, v42, v41, v6
  v_accvgpr_write_b32 a64, v56
  v_accvgpr_write_b32 a65, v57
  v_accvgpr_write_b32 a66, v58
  v_accvgpr_write_b32 a67, v59
  v_mfma_f32_16x16x32_bf16 a[28:31], v[22:25], a[44:47], a[28:31]
  ds_read2_b32 v[32:33], v60 offset0:0 offset1:1
  ds_read2_b32 v[34:35], v60 offset0:2 offset1:3
  ds_read_b32 v36, v60 offset:16
  ds_read_b128 a[40:43], v4 offset:3392
  s_waitcnt lgkmcnt(10)
  v_alignbyte_b32 v224, v45, v44, v6
  v_alignbyte_b32 v225, v46, v45, v6
  v_alignbyte_b32 v226, v47, v46, v6
  v_alignbyte_b32 v227, v48, v47, v6
  v_mfma_f32_16x16x32_bf16 a[24:27], a[64:67], a[44:47], a[24:27]
  ds_read2_b32 v[38:39], v5 offset0:128 offset1:129
  ds_read2_b32 v[40:41], v5 offset0:130 offset1:131
  ds_read_b32 v42, v5 offset:528
  s_waitcnt lgkmcnt(10)
  v_alignbyte_b32 v192, v11, v10, v6
  v_alignbyte_b32 v193, v12, v11, v6
  v_alignbyte_b32 v194, v13, v12, v6
  v_alignbyte_b32 v195, v14, v13, v6
  v_mfma_f32_16x16x32_bf16 a[20:23], v[224:227], a[44:47], a[20:23]
  s_waitcnt lgkmcnt(7)
  v_alignbyte_b32 v160, v17, v16, v6
  v_alignbyte_b32 v161, v18, v17, v6
  v_alignbyte_b32 v162, v19, v18, v6
  v_alignbyte_b32 v163, v20, v19, v6
  v_mfma_f32_16x16x32_bf16 a[16:19], v[192:195], a[44:47], a[16:19]
  s_waitcnt lgkmcnt(4)
  v_alignbyte_b32 v128, v33, v32, v6
  v_alignbyte_b32 v129, v34, v33, v6
  v_alignbyte_b32 v130, v35, v34, v6
  v_alignbyte_b32 v131, v36, v35, v6
  v_mfma_f32_16x16x32_bf16 a[12:15], v[160:163], a[44:47], a[12:15]
  s_waitcnt lgkmcnt(0)
  v_alignbyte_b32 v96, v39, v38, v6
  v_alignbyte_b32 v97, v40, v39, v6
  v_alignbyte_b32 v98, v41, v40, v6
  v_alignbyte_b32 v99, v42, v41, v6
  v_mfma_f32_16x16x32_bf16 a[8:11], v[128:131], a[44:47], a[8:11]
  s_nop 0
  v_mfma_f32_16x16x32_bf16 a[4:7], v[96:99], a[44:47], a[4:7]
  v_mfma_f32_16x16x32_bf16 a[28:31], a[92:95], a[32:35], a[28:31]
  ds_read_b128 a[44:47], v4 offset:3328
  v_mfma_f32_16x16x32_bf16 a[24:27], v[252:255], a[32:35], a[24:27]
  v_mfma_f32_16x16x32_bf16 a[20:23], v[220:223], a[32:35], a[20:23]
  v_mfma_f32_16x16x32_bf16 a[16:19], v[188:191], a[32:35], a[16:19]
  v_mfma_f32_16x16x32_bf16 a[12:15], v[156:159], a[32:35], a[12:15]
  v_mfma_f32_16x16x32_bf16 a[8:11], v[124:127], a[32:35], a[8:11]
  v_mfma_f32_16x16x32_bf16 a[4:7], v[92:95], a[32:35], a[4:7]
  v_mfma_f32_16x16x32_bf16 a[28:31], a[88:91], a[36:39], a[28:31]
  ds_read_b128 a[32:35], v4 offset:3264
  v_mfma_f32_16x16x32_bf16 a[24:27], v[248:251], a[36:39], a[24:27]
  v_mfma_f32_16x16x32_bf16 a[20:23], v[216:219], a[36:39], a[20:23]
  v_mfma_f32_16x16x32_bf16 a[16:19], v[184:187], a[36:39], a[16:19]
  v_mfma_f32_16x16x32_bf16 a[12:15], v[152:155], a[36:39], a[12:15]
  v_mfma_f32_16x16x32_bf16 a[8:11], v[120:123], a[36:39], a[8:11]
  v_mfma_f32_16x16x32_bf16 a[4:7], v[88:91], a[36:39], a[4:7]
  v_mfma_f32_16x16x32_bf16 a[28:31], a[84:87], a[40:43], a[28:31]
  ds_read_b128 a[36:39], v4 offset:3200
  v_mfma_f32_16x16x32_bf16 a[24:27], v[244:247], a[40:43], a[24:27]
  v_mfma_f32_16x16x32_bf16 a[20:23], v[212:215], a[40:43], a[20:23]
  v_mfma_f32_16x16x32_bf16 a[16:19], v[180:183], a[40:43], a[16:19]
  v_mfma_f32_16x16x32_bf16 a[12:15], v[148:151], a[40:43], a[12:15]
  v_mfma_f32_16x16x32_bf16 a[8:11], v[116:119], a[40:43], a[8:11]
  v_mfma_f32_16x16x32_bf16 a[4:7], v[84:87], a[40:43], a[4:7]
  s_waitcnt lgkmcnt(2)
  v_mfma_f32_16x16x32_bf16 a[28:31], a[80:83], a[44:47], a[28:31]
  ds_read_b128 a[40:43], v4 offset:3136
  v_mfma_f32_16x16x32_bf16 a[24:27], v[240:243], a[44:47], a[24:27]
  v_mfma_f32_16x16x32_bf16 a[20:23], v[208:211], a[44:47], a[20:23]
  v_mfma_f32_16x16x32_bf16 a[16:19], v[176:179], a[44:47], a[16:19]
  v_mfma_f32_16x16x32_bf16 a[12:15], v[144:147], a[44:47], a[12:15]
  v_mfma_f32_16x16x32_bf16 a[8:11], v[112:115], a[44:47], a[8:11]
  v_mfma_f32_16x16x32_bf16 a[4:7], v[80:83], a[44:47], a[4:7]
  s_waitcnt lgkmcnt(2)
  v_mfma_f32_16x16x32_bf16 a[28:31], a[76:79], a[32:35], a[28:31]
  ds_read_b128 a[44:47], v4 offset:3072
  v_mfma_f32_16x16x32_bf16 a[24:27], v[236:239], a[32:35], a[24:27]
  v_mfma_f32_16x16x32_bf16 a[20:23], v[204:207], a[32:35], a[20:23]
  v_mfma_f32_16x16x32_bf16 a[16:19], v[172:175], a[32:35], a[16:19]
  v_mfma_f32_16x16x32_bf16 a[12:15], v[140:143], a[32:35], a[12:15]
  v_mfma_f32_16x16x32_bf16 a[8:11], v[108:111], a[32:35], a[8:11]
  v_mfma_f32_16x16x32_bf16 a[4:7], v[76:79], a[32:35], a[4:7]
  s_waitcnt lgkmcnt(2)
  v_mfma_f32_16x16x32_bf16 a[28:31], a[72:75], a[36:39], a[28:31]
  ds_read_b128 a[32:35], v4 offset:3008
  v_mfma_f32_16x16x32_bf16 a[24:27], v[232:235], a[36:39], a[24:27]
  v_mfma_f32_16x16x32_bf16 a[20:23], v[200:203], a[36:39], a[20:23]
  v_mfma_f32_16x16x32_bf16 a[16:19], v[168:171], a[36:39], a[16:19]
  v_mfma_f32_16x16x32_bf16 a[12:15], v[136:139], a[36:39], a[12:15]
  v_mfma_f32_16x16x32_bf16 a[8:11], v[104:107], a[36:39], a[8:11]
  v_mfma_f32_16x16x32_bf16 a[4:7], v[72:75], a[36:39], a[4:7]
  s_waitcnt lgkmcnt(2)
  v_mfma_f32_16x16x32_bf16 a[28:31], a[68:71], a[40:43], a[28:31]
  ds_read_b128 a[36:39], v4 offset:2944
  v_mfma_f32_16x16x32_bf16 a[24:27], v[228:231], a[40:43], a[24:27]
  v_mfma_f32_16x16x32_bf16 a[20:23], v[196:199], a[40:43], a[20:23]
  v_mfma_f32_16x16x32_bf16 a[16:19], v[164:167], a[40:43], a[16:19]
  v_mfma_f32_16x16x32_bf16 a[12:15], v[132:135], a[40:43], a[12:15]
  v_mfma_f32_16x16x32_bf16 a[8:11], v[100:103], a[40:43], a[8:11]
  v_mfma_f32_16x16x32_bf16 a[4:7], v[68:71], a[40:43], a[4:7]
  s_waitcnt lgkmcnt(2)
  v_mfma_f32_16x16x32_bf16 a[28:31], a[64:67], a[44:47], a[28:31]
  ds_read_b128 a[40:43], v4 offset:2880
  v_mfma_f32_16x16x32_bf16 a[24:27], v[224:227], a[44:47], a[24:27]
  v_mfma_f32_16x16x32_bf16 a[20:23], v[192:195], a[44:47], a[20:23]
  v_mfma_f32_16x16x32_bf16 a[16:19], v[160:163], a[44:47], a[16:19]
  v_mfma_f32_16x16x32_bf16 a[12:15], v[128:131], a[44:47], a[12:15]
  v_mfma_f32_16x16x32_bf16 a[8:11], v[96:99], a[44:47], a[8:11]
  v_mfma_f32_16x16x32_bf16 a[4:7], v[64:67], a[44:47], a[4:7]
  s_waitcnt lgkmcnt(2)
  v_mfma_f32_16x16x32_bf16 a[28:31], v[252:255], a[32:35], a[28:31]
  ds_read_b128 a[44:47], v4 offset:2816
  ds_read_b64 v[36:37], v7 offset:512
  ds_read_b64 v[38:39], v8 offset:512
  s_nop 2
  v_accvgpr_read_b32 v44, a4
  v_accvgpr_read_b32 v45, a5
  v_mfma_f32_16x16x32_bf16 a[24:27], v[220:223], a[32:35], a[24:27]
  v_accvgpr_read_b32 v46, a6
  v_accvgpr_read_b32 v47, a7
  v_mfma_f32_16x16x32_bf16 a[20:23], v[188:191], a[32:35], a[20:23]
  s_waitcnt lgkmcnt(0)
  v_lshlrev_b32 v48, 16, v36
  v_and_b32 v49, 0xffff0000, v36
  v_mfma_f32_16x16x32_bf16 a[16:19], v[156:159], a[32:35], a[16:19]
  v_lshlrev_b32 v50, 16, v37
  v_and_b32 v51, 0xffff0000, v37
  v_mfma_f32_16x16x32_bf16 a[12:15], v[124:127], a[32:35], a[12:15]
  v_lshlrev_b32 v32, 16, v38
  v_and_b32 v33, 0xffff0000, v38
  v_mfma_f32_16x16x32_bf16 a[8:11], v[92:95], a[32:35], a[8:11]
  v_lshlrev_b32 v34, 16, v39
  v_and_b32 v35, 0xffff0000, v39
  v_mfma_f32_16x16x32_bf16 a[28:31], v[248:251], a[36:39], a[28:31]
  ds_read_b128 a[32:35], v4 offset:2752
  v_mul_f32 v52, v48, v31
  v_mul_f32 v53, v49, v31
  v_mfma_f32_16x16x32_bf16 a[24:27], v[216:219], a[36:39], a[24:27]
  v_mul_f32 v54, v50, v31
  v_mul_f32 v55, v51, v31
  v_mfma_f32_16x16x32_bf16 a[20:23], v[184:187], a[36:39], a[20:23]
  v_fmac_f32 v44, s61, v48
  v_fmac_f32 v45, s61, v49
  v_mfma_f32_16x16x32_bf16 a[16:19], v[152:155], a[36:39], a[16:19]
  v_fmac_f32 v46, s61, v50
  v_fmac_f32 v47, s61, v51
  v_mfma_f32_16x16x32_bf16 a[12:15], v[120:123], a[36:39], a[12:15]
  v_cvt_pk_bf16_f32 v36, v52, v53
  v_cvt_pk_bf16_f32 v37, v54, v55
  v_mfma_f32_16x16x32_bf16 a[8:11], v[88:91], a[36:39], a[8:11]
  v_lshlrev_b32 v52, 16, v36
  v_and_b32 v53, 0xffff0000, v36
  v_mfma_f32_16x16x32_bf16 a[28:31], v[244:247], a[40:43], a[28:31]
  ds_read_b128 a[36:39], v4 offset:2688
  v_lshlrev_b32 v54, 16, v37
  v_and_b32 v55, 0xffff0000, v37
  v_mfma_f32_16x16x32_bf16 a[24:27], v[212:215], a[40:43], a[24:27]
  v_cvt_pk_bf16_f32 v36, v44, v45
  v_cvt_pk_bf16_f32 v37, v46, v47
  v_mfma_f32_16x16x32_bf16 a[20:23], v[180:183], a[40:43], a[20:23]
  v_lshlrev_b32 v44, 16, v36
  v_and_b32 v45, 0xffff0000, v36
  v_mfma_f32_16x16x32_bf16 a[16:19], v[148:151], a[40:43], a[16:19]
  v_lshlrev_b32 v46, 16, v37
  v_and_b32 v47, 0xffff0000, v37
  v_mfma_f32_16x16x32_bf16 a[12:15], v[116:119], a[40:43], a[12:15]
  v_add_f32 v44, v44, v52
  v_add_f32 v45, v45, v53
  v_mfma_f32_16x16x32_bf16 a[8:11], v[84:87], a[40:43], a[8:11]
  v_add_f32 v46, v46, v54
  v_add_f32 v47, v47, v55
  v_mfma_f32_16x16x32_bf16 a[28:31], v[240:243], a[44:47], a[28:31]
  ds_read_b128 a[40:43], v4 offset:2624
  v_cvt_pk_bf16_f32 v36, v44, v45
  v_cvt_pk_bf16_f32 v37, v46, v47
  v_mfma_f32_16x16x32_bf16 a[24:27], v[208:211], a[44:47], a[24:27]
  v_lshlrev_b32 v44, 16, v36
  v_and_b32 v45, 0xffff0000, v36
  v_mfma_f32_16x16x32_bf16 a[20:23], v[176:179], a[44:47], a[20:23]
  v_lshlrev_b32 v46, 16, v37
  v_and_b32 v47, 0xffff0000, v37
  v_mfma_f32_16x16x32_bf16 a[16:19], v[144:147], a[44:47], a[16:19]
  v_add_f32 v44, v44, v32
  v_add_f32 v45, v45, v33
  v_mfma_f32_16x16x32_bf16 a[12:15], v[112:115], a[44:47], a[12:15]
  v_add_f32 v46, v46, v34
  v_add_f32 v47, v47, v35
  v_mfma_f32_16x16x32_bf16 a[8:11], v[80:83], a[44:47], a[8:11]
  v_cvt_pk_bf16_f32 v36, v44, v45
  v_cvt_pk_bf16_f32 v37, v46, v47
  s_waitcnt lgkmcnt(2)
  v_mfma_f32_16x16x32_bf16 a[28:31], v[236:239], a[32:35], a[28:31]
  ds_read_b128 a[44:47], v4 offset:2560
  s_add_u32 s6, s62, 262144
  buffer_store_dwordx2 v[36:37], v9, s[8:11], s6 offen sc1
  v_mfma_f32_16x16x32_bf16 a[24:27], v[204:207], a[32:35], a[24:27]
  v_mfma_f32_16x16x32_bf16 a[20:23], v[172:175], a[32:35], a[20:23]
  v_mfma_f32_16x16x32_bf16 a[16:19], v[140:143], a[32:35], a[16:19]
  v_mfma_f32_16x16x32_bf16 a[12:15], v[108:111], a[32:35], a[12:15]
  v_mfma_f32_16x16x32_bf16 a[8:11], v[76:79], a[32:35], a[8:11]
  s_waitcnt lgkmcnt(2)
  v_mfma_f32_16x16x32_bf16 a[28:31], v[232:235], a[36:39], a[28:31]
  ds_read_b128 a[32:35], v4 offset:2496
  v_mfma_f32_16x16x32_bf16 a[24:27], v[200:203], a[36:39], a[24:27]
  v_mfma_f32_16x16x32_bf16 a[20:23], v[168:171], a[36:39], a[20:23]
  v_mfma_f32_16x16x32_bf16 a[16:19], v[136:139], a[36:39], a[16:19]
  v_mfma_f32_16x16x32_bf16 a[12:15], v[104:107], a[36:39], a[12:15]
  v_mfma_f32_16x16x32_bf16 a[8:11], v[72:75], a[36:39], a[8:11]
  s_waitcnt lgkmcnt(2)
  v_mfma_f32_16x16x32_bf16 a[28:31], v[228:231], a[40:43], a[28:31]
  ds_read_b128 a[36:39], v4 offset:2432
  v_mfma_f32_16x16x32_bf16 a[24:27], v[196:199], a[40:43], a[24:27]
  v_mfma_f32_16x16x32_bf16 a[20:23], v[164:167], a[40:43], a[20:23]
  v_mfma_f32_16x16x32_bf16 a[16:19], v[132:135], a[40:43], a[16:19]
  v_mfma_f32_16x16x32_bf16 a[12:15], v[100:103], a[40:43], a[12:15]
  v_mfma_f32_16x16x32_bf16 a[8:11], v[68:71], a[40:43], a[8:11]
  s_waitcnt lgkmcnt(2)
  v_mfma_f32_16x16x32_bf16 a[28:31], v[224:227], a[44:47], a[28:31]
  ds_read_b128 a[40:43], v4 offset:2368
  v_mfma_f32_16x16x32_bf16 a[24:27], v[192:195], a[44:47], a[24:27]
  v_mfma_f32_16x16x32_bf16 a[20:23], v[160:163], a[44:47], a[20:23]
  v_mfma_f32_16x16x32_bf16 a[16:19], v[128:131], a[44:47], a[16:19]
  v_mfma_f32_16x16x32_bf16 a[12:15], v[96:99], a[44:47], a[12:15]
  v_mfma_f32_16x16x32_bf16 a[8:11], v[64:67], a[44:47], a[8:11]
  s_waitcnt lgkmcnt(2)
  v_mfma_f32_16x16x32_bf16 a[28:31], v[220:223], a[32:35], a[28:31]
  ds_read_b128 a[44:47], v4 offset:2304
  ds_read_b64 v[36:37], v7 offset:1024
  ds_read_b64 v[38:39], v8 offset:1024
  s_nop 2
  v_accvgpr_read_b32 v44, a8
  v_accvgpr_read_b32 v45, a9
  v_mfma_f32_16x16x32_bf16 a[24:27], v[188:191], a[32:35], a[24:27]
  v_accvgpr_read_b32 v46, a10
  v_accvgpr_read_b32 v47, a11
  v_mfma_f32_16x16x32_bf16 a[20:23], v[156:159], a[32:35], a[20:23]
  s_waitcnt lgkmcnt(0)
  v_lshlrev_b32 v48, 16, v36
  v_and_b32 v49, 0xffff0000, v36
  v_mfma_f32_16x16x32_bf16 a[16:19], v[124:127], a[32:35], a[16:19]
  v_lshlrev_b32 v50, 16, v37
  v_and_b32 v51, 0xffff0000, v37
  v_mfma_f32_16x16x32_bf16 a[12:15], v[92:95], a[32:35], a[12:15]
  v_lshlrev_b32 v32, 16, v38
  v_and_b32 v33, 0xffff0000, v38
  v_mfma_f32_16x16x32_bf16 a[28:31], v[216:219], a[36:39], a[28:31]
  ds_read_b128 a[32:35], v4 offset:2240
  v_lshlrev_b32 v34, 16, v39
  v_and_b32 v35, 0xffff0000, v39
  v_mfma_f32_16x16x32_bf16 a[24:27], v[184:187], a[36:39], a[24:27]
  v_mul_f32 v52, v48, v31
  v_mul_f32 v53, v49, v31
  v_mfma_f32_16x16x32_bf16 a[20:23], v[152:155], a[36:39], a[20:23]
  v_mul_f32 v54, v50, v31
  v_mul_f32 v55, v51, v31
  v_mfma_f32_16x16x32_bf16 a[16:19], v[120:123], a[36:39], a[16:19]
  v_fmac_f32 v44, s61, v48
  v_fmac_f32 v45, s61, v49
  v_mfma_f32_16x16x32_bf16 a[12:15], v[88:91], a[36:39], a[12:15]
  v_fmac_f32 v46, s61, v50
  v_fmac_f32 v47, s61, v51
  v_mfma_f32_16x16x32_bf16 a[28:31], v[212:215], a[40:43], a[28:31]
  ds_read_b128 a[36:39], v4 offset:2176
  v_cvt_pk_bf16_f32 v36, v52, v53
  v_cvt_pk_bf16_f32 v37, v54, v55
  v_mfma_f32_16x16x32_bf16 a[24:27], v[180:183], a[40:43], a[24:27]
  v_lshlrev_b32 v52, 16, v36
  v_and_b32 v53, 0xffff0000, v36
  v_mfma_f32_16x16x32_bf16 a[20:23], v[148:151], a[40:43], a[20:23]
  v_lshlrev_b32 v54, 16, v37
  v_and_b32 v55, 0xffff0000, v37
  v_mfma_f32_16x16x32_bf16 a[16:19], v[116:119], a[40:43], a[16:19]
  v_cvt_pk_bf16_f32 v36, v44, v45
  v_cvt_pk_bf16_f32 v37, v46, v47
  v_mfma_f32_16x16x32_bf16 a[12:15], v[84:87], a[40:43], a[12:15]
  v_lshlrev_b32 v44, 16, v36
  v_and_b32 v45, 0xffff0000, v36
  v_mfma_f32_16x16x32_bf16 a[28:31], v[208:211], a[44:47], a[28:31]
  ds_read_b128 a[40:43], v4 offset:2112
  v_lshlrev_b32 v46, 16, v37
  v_and_b32 v47, 0xffff0000, v37
  v_mfma_f32_16x16x32_bf16 a[24:27], v[176:179], a[44:47], a[24:27]
  v_add_f32 v44, v44, v52
  v_add_f32 v45, v45, v53
  v_mfma_f32_16x16x32_bf16 a[20:23], v[144:147], a[44:47], a[20:23]
  v_add_f32 v46, v46, v54
  v_add_f32 v47, v47, v55
  v_mfma_f32_16x16x32_bf16 a[16:19], v[112:115], a[44:47], a[16:19]
  v_cvt_pk_bf16_f32 v36, v44, v45
  v_cvt_pk_bf16_f32 v37, v46, v47
  v_mfma_f32_16x16x32_bf16 a[12:15], v[80:83], a[44:47], a[12:15]
  v_lshlrev_b32 v44, 16, v36
  v_and_b32 v45, 0xffff0000, v36
  s_waitcnt lgkmcnt(2)
  v_mfma_f32_16x16x32_bf16 a[28:31], v[204:207], a[32:35], a[28:31]
  ds_read_b128 a[44:47], v4 offset:2048
  v_lshlrev_b32 v46, 16, v37
  v_and_b32 v47, 0xffff0000, v37
  v_mfma_f32_16x16x32_bf16 a[24:27], v[172:175], a[32:35], a[24:27]
  v_add_f32 v44, v44, v32
  v_add_f32 v45, v45, v33
  v_mfma_f32_16x16x32_bf16 a[20:23], v[140:143], a[32:35], a[20:23]
  v_add_f32 v46, v46, v34
  v_add_f32 v47, v47, v35
  v_mfma_f32_16x16x32_bf16 a[16:19], v[108:111], a[32:35], a[16:19]
  v_cvt_pk_bf16_f32 v36, v44, v45
  v_cvt_pk_bf16_f32 v37, v46, v47
  v_mfma_f32_16x16x32_bf16 a[12:15], v[76:79], a[32:35], a[12:15]
  s_add_u32 s6, s62, 524288
  buffer_store_dwordx2 v[36:37], v9, s[8:11], s6 offen sc1
  s_waitcnt lgkmcnt(2)
  v_mfma_f32_16x16x32_bf16 a[28:31], v[200:203], a[36:39], a[28:31]
  ds_read_b128 a[32:35], v4 offset:1984
  v_mfma_f32_16x16x32_bf16 a[24:27], v[168:171], a[36:39], a[24:27]
  v_mfma_f32_16x16x32_bf16 a[20:23], v[136:139], a[36:39], a[20:23]
  v_mfma_f32_16x16x32_bf16 a[16:19], v[104:107], a[36:39], a[16:19]
  v_mfma_f32_16x16x32_bf16 a[12:15], v[72:75], a[36:39], a[12:15]
  s_waitcnt lgkmcnt(2)
  v_mfma_f32_16x16x32_bf16 a[28:31], v[196:199], a[40:43], a[28:31]
  ds_read_b128 a[36:39], v4 offset:1920
  v_mfma_f32_16x16x32_bf16 a[24:27], v[164:167], a[40:43], a[24:27]
  v_mfma_f32_16x16x32_bf16 a[20:23], v[132:135], a[40:43], a[20:23]
  v_mfma_f32_16x16x32_bf16 a[16:19], v[100:103], a[40:43], a[16:19]
  v_mfma_f32_16x16x32_bf16 a[12:15], v[68:71], a[40:43], a[12:15]
  s_waitcnt lgkmcnt(2)
  v_mfma_f32_16x16x32_bf16 a[28:31], v[192:195], a[44:47], a[28:31]
  ds_read_b128 a[40:43], v4 offset:1856
  v_mfma_f32_16x16x32_bf16 a[24:27], v[160:163], a[44:47], a[24:27]
  v_mfma_f32_16x16x32_bf16 a[20:23], v[128:131], a[44:47], a[20:23]
  v_mfma_f32_16x16x32_bf16 a[16:19], v[96:99], a[44:47], a[16:19]
  v_mfma_f32_16x16x32_bf16 a[12:15], v[64:67], a[44:47], a[12:15]
  s_waitcnt lgkmcnt(2)
  v_mfma_f32_16x16x32_bf16 a[28:31], v[188:191], a[32:35], a[28:31]
  ds_read_b128 a[44:47], v4 offset:1792
  ds_read_b64 v[36:37], v7 offset:1536
  ds_read_b64 v[38:39], v8 offset:1536
  s_nop 2
  v_accvgpr_read_b32 v44, a12
  v_accvgpr_read_b32 v45, a13
  v_mfma_f32_16x16x32_bf16 a[24:27], v[156:159], a[32:35], a[24:27]
  v_accvgpr_read_b32 v46, a14
  v_accvgpr_read_b32 v47, a15
  v_mfma_f32_16x16x32_bf16 a[20:23], v[124:127], a[32:35], a[20:23]
  s_waitcnt lgkmcnt(0)
  v_lshlrev_b32 v48, 16, v36
  v_and_b32 v49, 0xffff0000, v36
  v_mfma_f32_16x16x32_bf16 a[16:19], v[92:95], a[32:35], a[16:19]
  v_lshlrev_b32 v50, 16, v37
  v_and_b32 v51, 0xffff0000, v37
  v_mfma_f32_16x16x32_bf16 a[28:31], v[184:187], a[36:39], a[28:31]
  ds_read_b128 a[32:35], v4 offset:1728
  v_lshlrev_b32 v32, 16, v38
  v_and_b32 v33, 0xffff0000, v38
  v_mfma_f32_16x16x32_bf16 a[24:27], v[152:155], a[36:39], a[24:27]
  v_lshlrev_b32 v34, 16, v39
  v_and_b32 v35, 0xffff0000, v39
  v_mfma_f32_16x16x32_bf16 a[20:23], v[120:123], a[36:39], a[20:23]
  v_mul_f32 v52, v48, v31
  v_mul_f32 v53, v49, v31
  v_mfma_f32_16x16x32_bf16 a[16:19], v[88:91], a[36:39], a[16:19]
  v_mul_f32 v54, v50, v31
  v_mul_f32 v55, v51, v31
  v_mfma_f32_16x16x32_bf16 a[28:31], v[180:183], a[40:43], a[28:31]
  ds_read_b128 a[36:39], v4 offset:1664
  v_fmac_f32 v44, s61, v48
  v_fmac_f32 v45, s61, v49
  v_mfma_f32_16x16x32_bf16 a[24:27], v[148:151], a[40:43], a[24:27]
  v_fmac_f32 v46, s61, v50
  v_fmac_f32 v47, s61, v51
  v_mfma_f32_16x16x32_bf16 a[20:23], v[116:119], a[40:43], a[20:23]
  v_cvt_pk_bf16_f32 v36, v52, v53
  v_cvt_pk_bf16_f32 v37, v54, v55
  v_mfma_f32_16x16x32_bf16 a[16:19], v[84:87], a[40:43], a[16:19]
  v_lshlrev_b32 v52, 16, v36
  v_and_b32 v53, 0xffff0000, v36
  v_mfma_f32_16x16x32_bf16 a[28:31], v[176:179], a[44:47], a[28:31]
  ds_read_b128 a[40:43], v4 offset:1600
  v_lshlrev_b32 v54, 16, v37
  v_and_b32 v55, 0xffff0000, v37
  v_mfma_f32_16x16x32_bf16 a[24:27], v[144:147], a[44:47], a[24:27]
  v_cvt_pk_bf16_f32 v36, v44, v45
  v_cvt_pk_bf16_f32 v37, v46, v47
  v_mfma_f32_16x16x32_bf16 a[20:23], v[112:115], a[44:47], a[20:23]
  v_lshlrev_b32 v44, 16, v36
  v_and_b32 v45, 0xffff0000, v36
  v_mfma_f32_16x16x32_bf16 a[16:19], v[80:83], a[44:47], a[16:19]
  v_lshlrev_b32 v46, 16, v37
  v_and_b32 v47, 0xffff0000, v37
  s_waitcnt lgkmcnt(2)
  v_mfma_f32_16x16x32_bf16 a[28:31], v[172:175], a[32:35], a[28:31]
  ds_read_b128 a[44:47], v4 offset:1536
  v_add_f32 v44, v44, v52
  v_add_f32 v45, v45, v53
  v_mfma_f32_16x16x32_bf16 a[24:27], v[140:143], a[32:35], a[24:27]
  v_add_f32 v46, v46, v54
  v_add_f32 v47, v47, v55
  v_mfma_f32_16x16x32_bf16 a[20:23], v[108:111], a[32:35], a[20:23]
  v_cvt_pk_bf16_f32 v36, v44, v45
  v_cvt_pk_bf16_f32 v37, v46, v47
  v_mfma_f32_16x16x32_bf16 a[16:19], v[76:79], a[32:35], a[16:19]
  v_lshlrev_b32 v44, 16, v36
  v_and_b32 v45, 0xffff0000, v36
  s_waitcnt lgkmcnt(2)
  v_mfma_f32_16x16x32_bf16 a[28:31], v[168:171], a[36:39], a[28:31]
  ds_read_b128 a[32:35], v4 offset:1472
  v_lshlrev_b32 v46, 16, v37
  v_and_b32 v47, 0xffff0000, v37
  v_mfma_f32_16x16x32_bf16 a[24:27], v[136:139], a[36:39], a[24:27]
  v_add_f32 v44, v44, v32
  v_add_f32 v45, v45, v33
  v_mfma_f32_16x16x32_bf16 a[20:23], v[104:107], a[36:39], a[20:23]
  v_add_f32 v46, v46, v34
  v_add_f32 v47, v47, v35
  v_mfma_f32_16x16x32_bf16 a[16:19], v[72:75], a[36:39], a[16:19]
  v_cvt_pk_bf16_f32 v36, v44, v45
  v_cvt_pk_bf16_f32 v37, v46, v47
  s_waitcnt lgkmcnt(2)
  v_mfma_f32_16x16x32_bf16 a[28:31], v[164:167], a[40:43], a[28:31]
  ds_read_b128 a[36:39], v4 offset:1408
  s_add_u32 s6, s62, 786432
  buffer_store_dwordx2 v[36:37], v9, s[8:11], s6 offen sc1
  v_mfma_f32_16x16x32_bf16 a[24:27], v[132:135], a[40:43], a[24:27]
  v_mfma_f32_16x16x32_bf16 a[20:23], v[100:103], a[40:43], a[20:23]
  v_mfma_f32_16x16x32_bf16 a[16:19], v[68:71], a[40:43], a[16:19]
  s_waitcnt lgkmcnt(2)
  v_mfma_f32_16x16x32_bf16 a[28:31], v[160:163], a[44:47], a[28:31]
  ds_read_b128 a[40:43], v4 offset:1344
  v_mfma_f32_16x16x32_bf16 a[24:27], v[128:131], a[44:47], a[24:27]
  v_mfma_f32_16x16x32_bf16 a[20:23], v[96:99], a[44:47], a[20:23]
  v_mfma_f32_16x16x32_bf16 a[16:19], v[64:67], a[44:47], a[16:19]
  s_waitcnt lgkmcnt(2)
  v_mfma_f32_16x16x32_bf16 a[28:31], v[156:159], a[32:35], a[28:31]
  ds_read_b128 a[44:47], v4 offset:1280
  ds_read_b64 v[36:37], v7 offset:2048
  ds_read_b64 v[38:39], v8 offset:2048
  s_nop 2
  v_accvgpr_read_b32 v44, a16
  v_accvgpr_read_b32 v45, a17
  v_mfma_f32_16x16x32_bf16 a[24:27], v[124:127], a[32:35], a[24:27]
  v_accvgpr_read_b32 v46, a18
  v_accvgpr_read_b32 v47, a19
  v_mfma_f32_16x16x32_bf16 a[20:23], v[92:95], a[32:35], a[20:23]
  s_waitcnt lgkmcnt(0)
  v_lshlrev_b32 v48, 16, v36
  v_and_b32 v49, 0xffff0000, v36
  v_mfma_f32_16x16x32_bf16 a[28:31], v[152:155], a[36:39], a[28:31]
  ds_read_b128 a[32:35], v4 offset:1216
  v_lshlrev_b32 v50, 16, v37
  v_and_b32 v51, 0xffff0000, v37
  v_mfma_f32_16x16x32_bf16 a[24:27], v[120:123], a[36:39], a[24:27]
  v_lshlrev_b32 v32, 16, v38
  v_and_b32 v33, 0xffff0000, v38
  v_mfma_f32_16x16x32_bf16 a[20:23], v[88:91], a[36:39], a[20:23]
  v_lshlrev_b32 v34, 16, v39
  v_and_b32 v35, 0xffff0000, v39
  v_mfma_f32_16x16x32_bf16 a[28:31], v[148:151], a[40:43], a[28:31]
  ds_read_b128 a[36:39], v4 offset:1152
  v_mul_f32 v52, v48, v31
  v_mul_f32 v53, v49, v31
  v_mfma_f32_16x16x32_bf16 a[24:27], v[116:119], a[40:43], a[24:27]
  v_mul_f32 v54, v50, v31
  v_mul_f32 v55, v51, v31
  v_mfma_f32_16x16x32_bf16 a[20:23], v[84:87], a[40:43], a[20:23]
  v_fmac_f32 v44, s61, v48
  v_fmac_f32 v45, s61, v49
  v_mfma_f32_16x16x32_bf16 a[28:31], v[144:147], a[44:47], a[28:31]
  ds_read_b128 a[40:43], v4 offset:1088
  v_fmac_f32 v46, s61, v50
  v_fmac_f32 v47, s61, v51
  v_mfma_f32_16x16x32_bf16 a[24:27], v[112:115], a[44:47], a[24:27]
  v_cvt_pk_bf16_f32 v36, v52, v53
  v_cvt_pk_bf16_f32 v37, v54, v55
  v_mfma_f32_16x16x32_bf16 a[20:23], v[80:83], a[44:47], a[20:23]
  v_lshlrev_b32 v52, 16, v36
  v_and_b32 v53, 0xffff0000, v36
  s_waitcnt lgkmcnt(2)
  v_mfma_f32_16x16x32_bf16 a[28:31], v[140:143], a[32:35], a[28:31]
  ds_read_b128 a[44:47], v4 offset:1024
  v_lshlrev_b32 v54, 16, v37
  v_and_b32 v55, 0xffff0000, v37
  v_mfma_f32_16x16x32_bf16 a[24:27], v[108:111], a[32:35], a[24:27]
  v_cvt_pk_bf16_f32 v36, v44, v45
  v_cvt_pk_bf16_f32 v37, v46, v47
  v_mfma_f32_16x16x32_bf16 a[20:23], v[76:79], a[32:35], a[20:23]
  v_lshlrev_b32 v44, 16, v36
  v_and_b32 v45, 0xffff0000, v36
  s_waitcnt lgkmcnt(2)
  v_mfma_f32_16x16x32_bf16 a[28:31], v[136:139], a[36:39], a[28:31]
  ds_read_b128 a[32:35], v4 offset:960
  v_lshlrev_b32 v46, 16, v37
  v_and_b32 v47, 0xffff0000, v37
  v_mfma_f32_16x16x32_bf16 a[24:27], v[104:107], a[36:39], a[24:27]
  v_add_f32 v44, v44, v52
  v_add_f32 v45, v45, v53
  v_mfma_f32_16x16x32_bf16 a[20:23], v[72:75], a[36:39], a[20:23]
  v_add_f32 v46, v46, v54
  v_add_f32 v47, v47, v55
  s_waitcnt lgkmcnt(2)
  v_mfma_f32_16x16x32_bf16 a[28:31], v[132:135], a[40:43], a[28:31]
  ds_read_b128 a[36:39], v4 offset:896
  v_cvt_pk_bf16_f32 v36, v44, v45
  v_cvt_pk_bf16_f32 v37, v46, v47
  v_mfma_f32_16x16x32_bf16 a[24:27], v[100:103], a[40:43], a[24:27]
  v_lshlrev_b32 v44, 16, v36
  v_and_b32 v45, 0xffff0000, v36
  v_mfma_f32_16x16x32_bf16 a[20:23], v[68:71], a[40:43], a[20:23]
  v_lshlrev_b32 v46, 16, v37
  v_and_b32 v47, 0xffff0000, v37
  s_waitcnt lgkmcnt(2)
  v_mfma_f32_16x16x32_bf16 a[28:31], v[128:131], a[44:47], a[28:31]
  ds_read_b128 a[40:43], v4 offset:832
  v_add_f32 v44, v44, v32
  v_add_f32 v45, v45, v33
  v_mfma_f32_16x16x32_bf16 a[24:27], v[96:99], a[44:47], a[24:27]
  v_add_f32 v46, v46, v34
  v_add_f32 v47, v47, v35
  v_mfma_f32_16x16x32_bf16 a[20:23], v[64:67], a[44:47], a[20:23]
  v_cvt_pk_bf16_f32 v36, v44, v45
  v_cvt_pk_bf16_f32 v37, v46, v47
  s_waitcnt lgkmcnt(2)
  v_mfma_f32_16x16x32_bf16 a[28:31], v[124:127], a[32:35], a[28:31]
  ds_read_b128 a[44:47], v4 offset:768
  s_add_u32 s6, s62, 1048576
  buffer_store_dwordx2 v[36:37], v9, s[8:11], s6 offen sc1
  v_mfma_f32_16x16x32_bf16 a[24:27], v[92:95], a[32:35], a[24:27]
  ds_read_b64 v[36:37], v7 offset:2560
  ds_read_b64 v[38:39], v8 offset:2560
  v_accvgpr_read_b32 v44, a20
  v_accvgpr_read_b32 v45, a21
  s_waitcnt lgkmcnt(4)
  v_mfma_f32_16x16x32_bf16 a[28:31], v[120:123], a[36:39], a[28:31]
  ds_read_b128 a[32:35], v4 offset:704
  v_accvgpr_read_b32 v46, a22
  v_accvgpr_read_b32 v47, a23
  v_mfma_f32_16x16x32_bf16 a[24:27], v[88:91], a[36:39], a[24:27]
  s_waitcnt lgkmcnt(1)
  v_lshlrev_b32 v48, 16, v36
  v_and_b32 v49, 0xffff0000, v36
  v_mfma_f32_16x16x32_bf16 a[28:31], v[116:119], a[40:43], a[28:31]
  ds_read_b128 a[36:39], v4 offset:640
  v_lshlrev_b32 v50, 16, v37
  v_and_b32 v51, 0xffff0000, v37
  v_mfma_f32_16x16x32_bf16 a[24:27], v[84:87], a[40:43], a[24:27]
  v_lshlrev_b32 v32, 16, v38
  v_and_b32 v33, 0xffff0000, v38
  v_mfma_f32_16x16x32_bf16 a[28:31], v[112:115], a[44:47], a[28:31]
  ds_read_b128 a[40:43], v4 offset:576
  v_lshlrev_b32 v34, 16, v39
  v_and_b32 v35, 0xffff0000, v39
  v_mfma_f32_16x16x32_bf16 a[24:27], v[80:83], a[44:47], a[24:27]
  v_mul_f32 v52, v48, v31
  v_mul_f32 v53, v49, v31
  s_waitcnt lgkmcnt(2)
  v_mfma_f32_16x16x32_bf16 a[28:31], v[108:111], a[32:35], a[28:31]
  ds_read_b128 a[44:47], v4 offset:512
  v_mul_f32 v54, v50, v31
  v_mul_f32 v55, v51, v31
  v_mfma_f32_16x16x32_bf16 a[24:27], v[76:79], a[32:35], a[24:27]
  v_fmac_f32 v44, s61, v48
  v_fmac_f32 v45, s61, v49
  s_waitcnt lgkmcnt(2)
  v_mfma_f32_16x16x32_bf16 a[28:31], v[104:107], a[36:39], a[28:31]
  ds_read_b128 a[32:35], v4 offset:448
  v_fmac_f32 v46, s61, v50
  v_fmac_f32 v47, s61, v51
  v_mfma_f32_16x16x32_bf16 a[24:27], v[72:75], a[36:39], a[24:27]
  v_cvt_pk_bf16_f32 v36, v52, v53
  v_cvt_pk_bf16_f32 v37, v54, v55
  s_waitcnt lgkmcnt(2)
  v_mfma_f32_16x16x32_bf16 a[28:31], v[100:103], a[40:43], a[28:31]
  ds_read_b128 a[36:39], v4 offset:384
  v_lshlrev_b32 v52, 16, v36
  v_and_b32 v53, 0xffff0000, v36
  v_mfma_f32_16x16x32_bf16 a[24:27], v[68:71], a[40:43], a[24:27]
  v_lshlrev_b32 v54, 16, v37
  v_and_b32 v55, 0xffff0000, v37
  s_waitcnt lgkmcnt(2)
  v_mfma_f32_16x16x32_bf16 a[28:31], v[96:99], a[44:47], a[28:31]
  ds_read_b128 a[40:43], v4 offset:320
  v_cvt_pk_bf16_f32 v36, v44, v45
  v_cvt_pk_bf16_f32 v37, v46, v47
  v_mfma_f32_16x16x32_bf16 a[24:27], v[64:67], a[44:47], a[24:27]
  v_lshlrev_b32 v44, 16, v36
  v_and_b32 v45, 0xffff0000, v36
  s_waitcnt lgkmcnt(2)
  v_mfma_f32_16x16x32_bf16 a[28:31], v[92:95], a[32:35], a[28:31]
  ds_read_b128 a[44:47], v4 offset:256
  v_lshlrev_b32 v46, 16, v37
  v_and_b32 v47, 0xffff0000, v37
  s_waitcnt lgkmcnt(2)
  v_mfma_f32_16x16x32_bf16 a[28:31], v[88:91], a[36:39], a[28:31]
  ds_read_b128 a[32:35], v4 offset:192
  v_add_f32 v44, v44, v52
  v_add_f32 v45, v45, v53
  s_waitcnt lgkmcnt(2)
  v_mfma_f32_16x16x32_bf16 a[28:31], v[84:87], a[40:43], a[28:31]
  ds_read_b128 a[36:39], v4 offset:128
  v_add_f32 v46, v46, v54
  v_add_f32 v47, v47, v55
  s_waitcnt lgkmcnt(2)
  v_mfma_f32_16x16x32_bf16 a[28:31], v[80:83], a[44:47], a[28:31]
  ds_read_b128 a[40:43], v4 offset:64
  v_cvt_pk_bf16_f32 v36, v44, v45
  v_cvt_pk_bf16_f32 v37, v46, v47
  s_waitcnt lgkmcnt(2)
  v_mfma_f32_16x16x32_bf16 a[28:31], v[76:79], a[32:35], a[28:31]
  ds_read_b128 a[44:47], v4 offset:0
  v_lshlrev_b32 v44, 16, v36
  v_and_b32 v45, 0xffff0000, v36
  s_waitcnt lgkmcnt(2)
  v_mfma_f32_16x16x32_bf16 a[28:31], v[72:75], a[36:39], a[28:31]
  v_lshlrev_b32 v46, 16, v37
  v_and_b32 v47, 0xffff0000, v37
  s_waitcnt lgkmcnt(1)
  v_mfma_f32_16x16x32_bf16 a[28:31], v[68:71], a[40:43], a[28:31]
  v_add_f32 v44, v44, v32
  v_add_f32 v45, v45, v33
  s_waitcnt lgkmcnt(0)
  v_mfma_f32_16x16x32_bf16 a[28:31], v[64:67], a[44:47], a[28:31]
  v_add_f32 v46, v46, v34
  v_add_f32 v47, v47, v35
  v_cvt_pk_bf16_f32 v36, v44, v45
  v_cvt_pk_bf16_f32 v37, v46, v47
  s_add_u32 s6, s62, 1310720
  buffer_store_dwordx2 v[36:37], v9, s[8:11], s6 offen sc1
  ds_read_b64 v[36:37], v7 offset:3072
  ds_read_b64 v[38:39], v8 offset:3072
  v_accvgpr_read_b32 v44, a24
  v_accvgpr_read_b32 v45, a25
  v_accvgpr_read_b32 v46, a26
  v_accvgpr_read_b32 v47, a27
  s_waitcnt lgkmcnt(0)
  v_lshlrev_b32 v48, 16, v36
  v_and_b32 v49, 0xffff0000, v36
  v_lshlrev_b32 v50, 16, v37
  v_and_b32 v51, 0xffff0000, v37
  v_lshlrev_b32 v32, 16, v38
  v_and_b32 v33, 0xffff0000, v38
  v_lshlrev_b32 v34, 16, v39
  v_and_b32 v35, 0xffff0000, v39
  v_mul_f32 v52, v48, v31
  v_mul_f32 v53, v49, v31
  v_mul_f32 v54, v50, v31
  v_mul_f32 v55, v51, v31
  v_fmac_f32 v44, s61, v48
  v_fmac_f32 v45, s61, v49
  v_fmac_f32 v46, s61, v50
  v_fmac_f32 v47, s61, v51
  v_cvt_pk_bf16_f32 v36, v52, v53
  v_cvt_pk_bf16_f32 v37, v54, v55
  v_lshlrev_b32 v52, 16, v36
  v_and_b32 v53, 0xffff0000, v36
  v_lshlrev_b32 v54, 16, v37
  v_and_b32 v55, 0xffff0000, v37
  v_cvt_pk_bf16_f32 v36, v44, v45
  v_cvt_pk_bf16_f32 v37, v46, v47
  v_lshlrev_b32 v44, 16, v36
  v_and_b32 v45, 0xffff0000, v36
  v_lshlrev_b32 v46, 16, v37
  v_and_b32 v47, 0xffff0000, v37
  v_add_f32 v44, v44, v52
  v_add_f32 v45, v45, v53
  v_add_f32 v46, v46, v54
  v_add_f32 v47, v47, v55
  v_cvt_pk_bf16_f32 v36, v44, v45
  v_cvt_pk_bf16_f32 v37, v46, v47
  v_lshlrev_b32 v44, 16, v36
  v_and_b32 v45, 0xffff0000, v36
  v_lshlrev_b32 v46, 16, v37
  v_and_b32 v47, 0xffff0000, v37
  v_add_f32 v44, v44, v32
  v_add_f32 v45, v45, v33
  v_add_f32 v46, v46, v34
  v_add_f32 v47, v47, v35
  v_cvt_pk_bf16_f32 v36, v44, v45
  v_cvt_pk_bf16_f32 v37, v46, v47
  s_add_u32 s6, s62, 1572864
  buffer_store_dwordx2 v[36:37], v9, s[8:11], s6 offen sc1
  ds_read_b64 v[36:37], v7 offset:3584
  ds_read_b64 v[38:39], v8 offset:3584
  v_accvgpr_read_b32 v44, a28
  v_accvgpr_read_b32 v45, a29
  v_accvgpr_read_b32 v46, a30
  v_accvgpr_read_b32 v47, a31
  s_waitcnt lgkmcnt(0)
  v_lshlrev_b32 v48, 16, v36
  v_and_b32 v49, 0xffff0000, v36
  v_lshlrev_b32 v50, 16, v37
  v_and_b32 v51, 0xffff0000, v37
  v_lshlrev_b32 v32, 16, v38
  v_and_b32 v33, 0xffff0000, v38
  v_lshlrev_b32 v34, 16, v39
  v_and_b32 v35, 0xffff0000, v39
  v_mul_f32 v52, v48, v31
  v_mul_f32 v53, v49, v31
  v_mul_f32 v54, v50, v31
  v_mul_f32 v55, v51, v31
  v_fmac_f32 v44, s61, v48
  v_fmac_f32 v45, s61, v49
  v_fmac_f32 v46, s61, v50
  v_fmac_f32 v47, s61, v51
  v_cvt_pk_bf16_f32 v36, v52, v53
  v_cvt_pk_bf16_f32 v37, v54, v55
  v_lshlrev_b32 v52, 16, v36
  v_and_b32 v53, 0xffff0000, v36
  v_lshlrev_b32 v54, 16, v37
  v_and_b32 v55, 0xffff0000, v37
  v_cvt_pk_bf16_f32 v36, v44, v45
  v_cvt_pk_bf16_f32 v37, v46, v47
  v_lshlrev_b32 v44, 16, v36
  v_and_b32 v45, 0xffff0000, v36
  v_lshlrev_b32 v46, 16, v37
  v_and_b32 v47, 0xffff0000, v37
  v_add_f32 v44, v44, v52
  v_add_f32 v45, v45, v53
  v_add_f32 v46, v46, v54
  v_add_f32 v47, v47, v55
  v_cvt_pk_bf16_f32 v36, v44, v45
  v_cvt_pk_bf16_f32 v37, v46, v47
  v_lshlrev_b32 v44, 16, v36
  v_and_b32 v45, 0xffff0000, v36
  v_lshlrev_b32 v46, 16, v37
  v_and_b32 v47, 0xffff0000, v37
  v_add_f32 v44, v44, v32
  v_add_f32 v45, v45, v33
  v_add_f32 v46, v46, v34
  v_add_f32 v47, v47, v35
  v_cvt_pk_bf16_f32 v36, v44, v45
  v_cvt_pk_bf16_f32 v37, v46, v47
  s_add_u32 s6, s62, 1835008
  buffer_store_dwordx2 v[36:37], v9, s[8:11], s6 offen sc1
  s_lshl_b32 s6, s60, 2
  s_add_u32 s6, s6, 0x710000
  v_mov_b32 v16, 127
  s_waitcnt vmcnt(0)
  s_mov_b64 exec, 1
  buffer_store_dword v16, v1, s[8:11], s6 offen sc1
  s_mov_b64 exec, -1
  s_barrier
  s_cmp_eq_u32 s4, 1
  s_cbranch_scc1 L_rec2
  s_cmp_eq_u32 s4, 6
  s_cbranch_scc1 L_o2
  s_branch L_p2
L_c:
  v_lshlrev_b32 v4, 2, v0
  v_lshlrev_b32 v0, 4, v0
  v_mov_b32 v1, 0
  v_mov_b32 v2, 150016
  s_lshl_b32 s6, s5, 8
  s_add_u32 s6, s6, 0x704000
  s_add_u32 s7, s6, 0x2000
  buffer_store_dword v1, v4, s[8:11], s6 offen sc1
  buffer_store_dword v1, v4, s[8:11], s7 offen sc1
  s_lshl_b32 s6, s5, 3
  s_add_u32 s6, s6, 0x710800
  s_mov_b64 exec, 3
  buffer_store_dword v1, v4, s[8:11], s6 offen sc1
  buffer_store_dword v1, v4, s[8:11], s6 offen offset:256 sc1
  s_mov_b64 exec, -1
  s_lshl_b32 s6, s5, 10
  s_lshl_b32 s7, s3, 15
  s_add_u32 s6, s6, s7
  s_add_u32 s6, s6, 0x8800000
  v_mov_b32 v8, 0
  v_mov_b32 v9, 0
  v_mov_b32 v10, 0
  v_mov_b32 v11, 0
  buffer_store_dwordx4 v[8:11], v0, s[8:11], s6 offen sc1
  s_add_u32 s6, s6, 0x20000
  buffer_store_dwordx4 v[8:11], v0, s[8:11], s6 offen sc1
  s_add_u32 s6, s6, 0x20000
  buffer_store_dwordx4 v[8:11], v0, s[8:11], s6 offen sc1
  s_add_u32 s6, s6, 0x20000
  buffer_store_dwordx4 v[8:11], v0, s[8:11], s6 offen sc1
  s_add_u32 s6, s6, 0x7a0000
  buffer_store_dwordx4 v[8:11], v0, s[8:11], s6 offen sc1
  s_add_u32 s6, s6, 0x20000
  buffer_store_dwordx4 v[8:11], v0, s[8:11], s6 offen sc1
  s_add_u32 s6, s6, 0x20000
  buffer_store_dwordx4 v[8:11], v0, s[8:11], s6 offen sc1
  s_add_u32 s6, s6, 0x20000
  buffer_store_dwordx4 v[8:11], v0, s[8:11], s6 offen sc1
  s_waitcnt vmcnt(0)
  s_barrier
  s_cmp_lg_u32 s3, 0
  s_cbranch_scc1 L_sd_111
  s_mov_b64 exec, 1
  s_and_b32 s6, s4, 3
  s_lshl_b32 s6, s6, 6
  v_mov_b32 v6, 16
  v_mov_b32 v7, 1
  buffer_atomic_add v7, v6, s[12:15], s6 offen sc1
  s_mov_b64 exec, -1
L_sd_111:
  v_bfe_u32 v5, v0, 5, 4
  v_mul_u32_u24 v5, 4128, v5
  v_and_b32 v6, 16, v0
  v_add3_u32 v5, v5, v6, v1
  v_add_u32 v5, 73728, v5
  ds_write_b128 v5, v[8:11]
  ds_write_b128 v2, v[8:11]
  ds_write_b128 v2, v[8:11] offset:16
  v_accvgpr_write_b32 a0, 0
  v_accvgpr_write_b32 a1, 0
  v_accvgpr_write_b32 a2, 0
  v_accvgpr_write_b32 a3, 0
  v_accvgpr_write_b32 a4, 0
  v_accvgpr_write_b32 a5, 0
  v_accvgpr_write_b32 a6, 0
  v_accvgpr_write_b32 a7, 0
  v_accvgpr_write_b32 a8, 0
  v_accvgpr_write_b32 a9, 0
  v_accvgpr_write_b32 a10, 0
  v_accvgpr_write_b32 a11, 0
  v_accvgpr_write_b32 a12, 0
  v_accvgpr_write_b32 a13, 0
  v_accvgpr_write_b32 a14, 0
  v_accvgpr_write_b32 a15, 0
  v_accvgpr_write_b32 a16, 0
  v_accvgpr_write_b32 a17, 0
  v_accvgpr_write_b32 a18, 0
  v_accvgpr_write_b32 a19, 0
  v_accvgpr_write_b32 a20, 0
  v_accvgpr_write_b32 a21, 0
  v_accvgpr_write_b32 a22, 0
  v_accvgpr_write_b32 a23, 0
  v_accvgpr_write_b32 a24, 0
  v_accvgpr_write_b32 a25, 0
  v_accvgpr_write_b32 a26, 0
  v_accvgpr_write_b32 a27, 0
  v_accvgpr_write_b32 a28, 0
  v_accvgpr_write_b32 a29, 0
  v_accvgpr_write_b32 a30, 0
  v_accvgpr_write_b32 a31, 0
  v_accvgpr_write_b32 a32, 0
  v_accvgpr_write_b32 a33, 0
  v_accvgpr_write_b32 a34, 0
  v_accvgpr_write_b32 a35, 0
  v_accvgpr_write_b32 a36, 0
  v_accvgpr_write_b32 a37, 0
  v_accvgpr_write_b32 a38, 0
  v_accvgpr_write_b32 a39, 0
  v_accvgpr_write_b32 a40, 0
  v_accvgpr_write_b32 a41, 0
  v_accvgpr_write_b32 a42, 0
  v_accvgpr_write_b32 a43, 0
  v_accvgpr_write_b32 a44, 0
  v_accvgpr_write_b32 a45, 0
  v_accvgpr_write_b32 a46, 0
  v_accvgpr_write_b32 a47, 0
  v_accvgpr_write_b32 a48, 0
  v_accvgpr_write_b32 a49, 0
  v_accvgpr_write_b32 a50, 0
  v_accvgpr_write_b32 a51, 0
  v_accvgpr_write_b32 a52, 0
  v_accvgpr_write_b32 a53, 0
  v_accvgpr_write_b32 a54, 0
  v_accvgpr_write_b32 a55, 0
  v_accvgpr_write_b32 a56, 0
  v_accvgpr_write_b32 a57, 0
  v_accvgpr_write_b32 a58, 0
  v_accvgpr_write_b32 a59, 0
  v_accvgpr_write_b32 a60, 0
  v_accvgpr_write_b32 a61, 0
  v_accvgpr_write_b32 a62, 0
  v_accvgpr_write_b32 a63, 0
  v_accvgpr_write_b32 a64, 0
  v_accvgpr_write_b32 a65, 0
  v_accvgpr_write_b32 a66, 0
  v_accvgpr_write_b32 a67, 0
  v_accvgpr_write_b32 a68, 0
  v_accvgpr_write_b32 a69, 0
  v_accvgpr_write_b32 a70, 0
  v_accvgpr_write_b32 a71, 0
  v_accvgpr_write_b32 a72, 0
  v_accvgpr_write_b32 a73, 0
  v_accvgpr_write_b32 a74, 0
  v_accvgpr_write_b32 a75, 0
  v_accvgpr_write_b32 a76, 0
  v_accvgpr_write_b32 a77, 0
  v_accvgpr_write_b32 a78, 0
  v_accvgpr_write_b32 a79, 0
  v_accvgpr_write_b32 a80, 0
  v_accvgpr_write_b32 a81, 0
  v_accvgpr_write_b32 a82, 0
  v_accvgpr_write_b32 a83, 0
  v_accvgpr_write_b32 a84, 0
  v_accvgpr_write_b32 a85, 0
  v_accvgpr_write_b32 a86, 0
  v_accvgpr_write_b32 a87, 0
  v_accvgpr_write_b32 a88, 0
  v_accvgpr_write_b32 a89, 0
  v_accvgpr_write_b32 a90, 0
  v_accvgpr_write_b32 a91, 0
  v_accvgpr_write_b32 a92, 0
  v_accvgpr_write_b32 a93, 0
  v_accvgpr_write_b32 a94, 0
  v_accvgpr_write_b32 a95, 0
  v_accvgpr_write_b32 a96, 0
  v_accvgpr_write_b32 a97, 0
  v_accvgpr_write_b32 a98, 0
  v_accvgpr_write_b32 a99, 0
  v_accvgpr_write_b32 a100, 0
  v_accvgpr_write_b32 a101, 0
  v_accvgpr_write_b32 a102, 0
  v_accvgpr_write_b32 a103, 0
  v_accvgpr_write_b32 a104, 0
  v_accvgpr_write_b32 a105, 0
  v_accvgpr_write_b32 a106, 0
  v_accvgpr_write_b32 a107, 0
  v_accvgpr_write_b32 a108, 0
  v_accvgpr_write_b32 a109, 0
  v_accvgpr_write_b32 a110, 0
  v_accvgpr_write_b32 a111, 0
  v_accvgpr_write_b32 a112, 0
  v_accvgpr_write_b32 a113, 0
  v_accvgpr_write_b32 a114, 0
  v_accvgpr_write_b32 a115, 0
  v_accvgpr_write_b32 a116, 0
  v_accvgpr_write_b32 a117, 0
  v_accvgpr_write_b32 a118, 0
  v_accvgpr_write_b32 a119, 0
  v_accvgpr_write_b32 a120, 0
  v_accvgpr_write_b32 a121, 0
  v_accvgpr_write_b32 a122, 0
  v_accvgpr_write_b32 a123, 0
  v_accvgpr_write_b32 a124, 0
  v_accvgpr_write_b32 a125, 0
  v_accvgpr_write_b32 a126, 0
  v_accvgpr_write_b32 a127, 0
  v_accvgpr_write_b32 a128, 0
  v_accvgpr_write_b32 a129, 0
  v_accvgpr_write_b32 a130, 0
  v_accvgpr_write_b32 a131, 0
  v_accvgpr_write_b32 a132, 0
  v_accvgpr_write_b32 a133, 0
  v_accvgpr_write_b32 a134, 0
  v_accvgpr_write_b32 a135, 0
  v_accvgpr_write_b32 a136, 0
  v_accvgpr_write_b32 a137, 0
  v_accvgpr_write_b32 a138, 0
  v_accvgpr_write_b32 a139, 0
  v_accvgpr_write_b32 a140, 0
  v_accvgpr_write_b32 a141, 0
  v_accvgpr_write_b32 a142, 0
  v_accvgpr_write_b32 a143, 0
  v_accvgpr_write_b32 a144, 0
  v_accvgpr_write_b32 a145, 0
  v_accvgpr_write_b32 a146, 0
  v_accvgpr_write_b32 a147, 0
  v_accvgpr_write_b32 a148, 0
  v_accvgpr_write_b32 a149, 0
  v_accvgpr_write_b32 a150, 0
  v_accvgpr_write_b32 a151, 0
  v_accvgpr_write_b32 a152, 0
  v_accvgpr_write_b32 a153, 0
  v_accvgpr_write_b32 a154, 0
  v_accvgpr_write_b32 a155, 0
  v_accvgpr_write_b32 a156, 0
  v_accvgpr_write_b32 a157, 0
  v_accvgpr_write_b32 a158, 0
  v_accvgpr_write_b32 a159, 0
  v_accvgpr_write_b32 a160, 0
  v_accvgpr_write_b32 a161, 0
  v_accvgpr_write_b32 a162, 0
  v_accvgpr_write_b32 a163, 0
  v_accvgpr_write_b32 a164, 0
  v_accvgpr_write_b32 a165, 0
  v_accvgpr_write_b32 a166, 0
  v_accvgpr_write_b32 a167, 0
  v_accvgpr_write_b32 a168, 0
  v_accvgpr_write_b32 a169, 0
  v_accvgpr_write_b32 a170, 0
  v_accvgpr_write_b32 a171, 0
  v_accvgpr_write_b32 a172, 0
  v_accvgpr_write_b32 a173, 0
  v_accvgpr_write_b32 a174, 0
  v_accvgpr_write_b32 a175, 0
  v_accvgpr_write_b32 a176, 0
  v_accvgpr_write_b32 a177, 0
  v_accvgpr_write_b32 a178, 0
  v_accvgpr_write_b32 a179, 0
  v_accvgpr_write_b32 a180, 0
  v_accvgpr_write_b32 a181, 0
  v_accvgpr_write_b32 a182, 0
  v_accvgpr_write_b32 a183, 0
  v_accvgpr_write_b32 a184, 0
  v_accvgpr_write_b32 a185, 0
  v_accvgpr_write_b32 a186, 0
  v_accvgpr_write_b32 a187, 0
  v_accvgpr_write_b32 a188, 0
  v_accvgpr_write_b32 a189, 0
  v_accvgpr_write_b32 a190, 0
  v_accvgpr_write_b32 a191, 0
  v_accvgpr_write_b32 a192, 0
  v_accvgpr_write_b32 a193, 0
  v_accvgpr_write_b32 a194, 0
  v_accvgpr_write_b32 a195, 0
  v_accvgpr_write_b32 a196, 0
  v_accvgpr_write_b32 a197, 0
  v_accvgpr_write_b32 a198, 0
  v_accvgpr_write_b32 a199, 0
  v_accvgpr_write_b32 a200, 0
  v_accvgpr_write_b32 a201, 0
  v_accvgpr_write_b32 a202, 0
  v_accvgpr_write_b32 a203, 0
  v_accvgpr_write_b32 a204, 0
  v_accvgpr_write_b32 a205, 0
  v_accvgpr_write_b32 a206, 0
  v_accvgpr_write_b32 a207, 0
  v_accvgpr_write_b32 a208, 0
  v_accvgpr_write_b32 a209, 0
  v_accvgpr_write_b32 a210, 0
  v_accvgpr_write_b32 a211, 0
  v_accvgpr_write_b32 a212, 0
  v_accvgpr_write_b32 a213, 0
  v_accvgpr_write_b32 a214, 0
  v_accvgpr_write_b32 a215, 0
  v_accvgpr_write_b32 a216, 0
  v_accvgpr_write_b32 a217, 0
  v_accvgpr_write_b32 a218, 0
  v_accvgpr_write_b32 a219, 0
  v_accvgpr_write_b32 a220, 0
  v_accvgpr_write_b32 a221, 0
  v_accvgpr_write_b32 a222, 0
  v_accvgpr_write_b32 a223, 0
  v_accvgpr_write_b32 a224, 0
  v_accvgpr_write_b32 a225, 0
  v_accvgpr_write_b32 a226, 0
  v_accvgpr_write_b32 a227, 0
  v_accvgpr_write_b32 a228, 0
  v_accvgpr_write_b32 a229, 0
  v_accvgpr_write_b32 a230, 0
  v_accvgpr_write_b32 a231, 0
  v_accvgpr_write_b32 a232, 0
  v_accvgpr_write_b32 a233, 0
  v_accvgpr_write_b32 a234, 0
  v_accvgpr_write_b32 a235, 0
  v_accvgpr_write_b32 a236, 0
  v_accvgpr_write_b32 a237, 0
  v_accvgpr_write_b32 a238, 0
  v_accvgpr_write_b32 a239, 0
  v_accvgpr_write_b32 a240, 0
  v_accvgpr_write_b32 a241, 0
  v_accvgpr_write_b32 a242, 0
  v_accvgpr_write_b32 a243, 0
  v_accvgpr_write_b32 a244, 0
  v_accvgpr_write_b32 a245, 0
  v_accvgpr_write_b32 a246, 0
  v_accvgpr_write_b32 a247, 0
  v_accvgpr_write_b32 a248, 0
  v_accvgpr_write_b32 a249, 0
  v_accvgpr_write_b32 a250, 0
  v_accvgpr_write_b32 a251, 0
  v_accvgpr_write_b32 a252, 0
  v_accvgpr_write_b32 a253, 0
  v_accvgpr_write_b32 a254, 0
  v_accvgpr_write_b32 a255, 0
  s_cmp_lg_u32 s3, 0
  s_cbranch_scc1 L_wdo_113
  s_mov_b32 s7, 0
  v_mbcnt_lo_u32_b32 v8, -1, 0
  v_and_b32 v8, 3, v8
  v_lshlrev_b32 v8, 6, v8
L_wd_112:
  buffer_load_dword v9, v8, s[12:15], 0 offen offset:16 sc1
  s_waitcnt vmcnt(0)
  v_cmp_ne_u32 vcc, 64, v9
  s_cbranch_vccz L_wdo_113
  s_add_u32 s7, s7, 1
  s_cmp_lt_u32 s7, 131072
  s_cbranch_scc1 L_wd_112
  s_mov_b32 s6, 40
  s_branch L_err
L_wdo_113:
  s_barrier
  v_and_b32 v4, 60, v4
  s_lshl_b32 s6, s5, 6
  s_add_u32 s34, s6, 0x710000
  s_mov_b32 s33, 127
  s_mov_b32 s7, 0
L_pl_114:
  buffer_load_dword v8, v4, s[8:11], s34 offen offset:0 sc1
  s_waitcnt vmcnt(0)
  v_cmp_gt_u32 vcc, s33, v8
  s_cbranch_vccz L_plo_115
  s_add_u32 s7, s7, 1
  s_cmp_lt_u32 s7, 131072
  s_cbranch_scc1 L_pl_114
  s_mov_b32 s6, 41
  s_branch L_err
L_plo_115:
  s_mul_i32 s34, s5, 73728
  s_mul_i32 s35, s3, 18432
  s_add_u32 s34, s34, s35
  s_add_u32 s34, s34, 0x400000
  s_add_u32 m0, s35, 0
  s_add_u32 s6, s34, 0
  buffer_load_dwordx4 v0, s[8:11], s6 offen offset:0 lds
  buffer_load_dwordx4 v0, s[8:11], s6 offen offset:1024 lds
  buffer_load_dwordx4 v0, s[8:11], s6 offen offset:2048 lds
  buffer_load_dwordx4 v0, s[8:11], s6 offen offset:3072 lds
  s_add_u32 m0, s35, 4096
  s_add_u32 s6, s34, 4096
  buffer_load_dwordx4 v0, s[8:11], s6 offen offset:0 lds
  buffer_load_dwordx4 v0, s[8:11], s6 offen offset:1024 lds
  buffer_load_dwordx4 v0, s[8:11], s6 offen offset:2048 lds
  buffer_load_dwordx4 v0, s[8:11], s6 offen offset:3072 lds
  s_add_u32 m0, s35, 8192
  s_add_u32 s6, s34, 8192
  buffer_load_dwordx4 v0, s[8:11], s6 offen offset:0 lds
  buffer_load_dwordx4 v0, s[8:11], s6 offen offset:1024 lds
  buffer_load_dwordx4 v0, s[8:11], s6 offen offset:2048 lds
  buffer_load_dwordx4 v0, s[8:11], s6 offen offset:3072 lds
  s_add_u32 m0, s35, 12288
  s_add_u32 s6, s34, 12288
  buffer_load_dwordx4 v0, s[8:11], s6 offen offset:0 lds
  buffer_load_dwordx4 v0, s[8:11], s6 offen offset:1024 lds
  buffer_load_dwordx4 v0, s[8:11], s6 offen offset:2048 lds
  buffer_load_dwordx4 v0, s[8:11], s6 offen offset:3072 lds
  s_add_u32 m0, s35, 16384
  s_add_u32 s6, s34, 16384
  buffer_load_dwordx4 v0, s[8:11], s6 offen offset:0 lds
  buffer_load_dwordx4 v0, s[8:11], s6 offen offset:1024 lds
  s_mov_b32 s32, 0
  s_waitcnt vmcnt(0) lgkmcnt(0)
  s_barrier
  s_cmp_ge_u32 s3, 2
  s_cbranch_scc1 L_c_res
  s_mov_b32 s16, s76
  s_mov_b32 s17, s77
  s_mov_b32 s18, 0x400
  s_mov_b32 s19, 0x20000
  v_bfe_u32 v16, v0, 4, 4
  v_lshrrev_b32 v17, 8, v0
  v_lshrrev_b32 v18, 7, v0
  s_lshl_b32 s6, s5, 5
  s_lshl_b32 s7, s3, 4
  s_add_u32 s6, s6, s7
  v_lshlrev_b32 v19, 1, v18
  buffer_load_ushort v12, v19, s[16:19], s6 offen
  s_mul_i32 s6, s3, 36864
  v_mul_u32_u24 v19, 4608, v18
  v_add_u32 v19, s6, v19
  ds_read_b32 v11, v19 offset:4576
  s_add_u32 s6, s6, 480
  v_lshlrev_b32 v19, 5, v16
  v_sub_u32 v19, s6, v19
  v_lshl_add_u32 v4, v17, 4, v19
  s_mul_i32 s6, s3, 33024
  s_add_u32 s6, s6, 73728
  v_lshlrev_b32 v19, 1, v16
  v_lshl_add_u32 v19, v17, 4, v19
  v_add_u32 v5, s6, v19
  v_mul_u32_u24 v19, 4128, v18
  v_bfe_u32 v20, v0, 1, 6
  v_add3_u32 v19, v19, v20, s6
  v_add_u32 v8, 32, v19
  s_lshl_b32 s6, s3, 10
  s_add_u32 s6, s6, 147968
  v_add_u32 v7, s6, v0
  v_and_b32 v19, 1, v16
  v_lshlrev_b32 v19, 6, v19
  v_lshl_add_u32 v19, v17, 4, v19
  v_add_u32 v6, s6, v19
  v_lshrrev_b32 v10, 1, v0
  s_lshl_b32 s6, s3, 9
  s_add_u32 s35, s6, 139776
  s_lshl_b32 s7, s5, 10
  s_add_u32 s6, s6, s7
  s_add_u32 s40, s6, 0x200000
  s_lshl_b32 s6, s5, 3
  s_lshl_b32 s7, s3, 2
  s_add_u32 s6, s6, s7
  s_add_u32 s39, s6, 0x710800
  v_add_u32 v14, s7, v2
  s_waitcnt vmcnt(0) lgkmcnt(0)
  v_lshlrev_b32 v12, 16, v12
  v_and_b32 v15, 2, v5
  v_and_b32 v5, -4, v5
  v_add_u32 v104, 0, v5
  v_add_u32 v105, 4128, v5
  v_add_u32 v106, 8256, v5
  v_add_u32 v107, 12384, v5
  v_add_u32 v108, 16512, v5
  v_add_u32 v109, 20640, v5
  v_add_u32 v110, 24768, v5
  v_add_u32 v111, 28896, v5
L_c_conv0:
  s_add_u32 s33, s32, 1
  s_and_b32 s6, s32, 7
  s_lshl_b32 s7, s6, 10
  s_add_u32 s7, s7, s35
  v_add_u32 v9, s7, v10
  s_lshl_b32 s6, s6, 1
  s_lshl_b32 s42, 0x30003, s6
  v_mov_b32 v13, s33
  ds_read_b128 v[48:51], v4 offset:3584
  ds_read_b128 v[52:55], v4 offset:8192
  ds_read_b128 v[56:59], v4 offset:12800
  ds_read_b128 v[60:63], v4 offset:17408
  ds_read_b128 v[64:67], v4 offset:22016
  ds_read_b128 v[68:71], v4 offset:26624
  ds_read_b128 v[72:75], v4 offset:31232
  ds_read_b128 v[76:79], v4 offset:35840
  s_mov_b32 s7, 0
L_lw_116:
  ds_read_b32 v88, v2 offset:0
  s_waitcnt lgkmcnt(0)
  v_cmp_gt_i32 vcc, s33, v88
  s_cbranch_vccz L_lwo_117
  s_add_u32 s7, s7, 1
  s_cmp_lt_u32 s7, 131072
  s_cbranch_scc1 L_lw_116
  s_mov_b32 s6, 42
  s_branch L_err
L_lwo_117:
  ds_read2_b32 v[112:113], v104 offset0:0 offset1:1
  ds_read2_b32 v[114:115], v104 offset0:2 offset1:3
  ds_read_b32 v116, v104 offset:16
  ds_read2_b32 v[118:119], v105 offset0:0 offset1:1
  ds_read2_b32 v[120:121], v105 offset0:2 offset1:3
  ds_read_b32 v122, v105 offset:16
  ds_read2_b32 v[124:125], v106 offset0:0 offset1:1
  ds_read2_b32 v[126:127], v106 offset0:2 offset1:3
  ds_read_b32 v128, v106 offset:16
  ds_read2_b32 v[130:131], v107 offset0:0 offset1:1
  ds_read2_b32 v[132:133], v107 offset0:2 offset1:3
  ds_read_b32 v134, v107 offset:16
  s_waitcnt lgkmcnt(9)
  v_alignbyte_b32 v16, v113, v112, v15
  v_alignbyte_b32 v17, v114, v113, v15
  v_alignbyte_b32 v18, v115, v114, v15
  v_alignbyte_b32 v19, v116, v115, v15
  ds_read2_b32 v[112:113], v108 offset0:0 offset1:1
  ds_read2_b32 v[114:115], v108 offset0:2 offset1:3
  ds_read_b32 v116, v108 offset:16
  s_waitcnt lgkmcnt(9)
  v_alignbyte_b32 v20, v119, v118, v15
  v_alignbyte_b32 v21, v120, v119, v15
  v_alignbyte_b32 v22, v121, v120, v15
  v_alignbyte_b32 v23, v122, v121, v15
  ds_read2_b32 v[118:119], v109 offset0:0 offset1:1
  ds_read2_b32 v[120:121], v109 offset0:2 offset1:3
  ds_read_b32 v122, v109 offset:16
  v_mfma_f32_16x16x32_bf16 a[0:3], v[16:19], v[48:51], a[0:3]
  s_waitcnt lgkmcnt(9)
  v_alignbyte_b32 v24, v125, v124, v15
  v_alignbyte_b32 v25, v126, v125, v15
  v_alignbyte_b32 v26, v127, v126, v15
  v_alignbyte_b32 v27, v128, v127, v15
  ds_read2_b32 v[124:125], v110 offset0:0 offset1:1
  ds_read2_b32 v[126:127], v110 offset0:2 offset1:3
  ds_read_b32 v128, v110 offset:16
  v_mfma_f32_16x16x32_bf16 a[32:35], v[20:23], v[52:55], a[32:35]
  s_waitcnt lgkmcnt(9)
  v_alignbyte_b32 v28, v131, v130, v15
  v_alignbyte_b32 v29, v132, v131, v15
  v_alignbyte_b32 v30, v133, v132, v15
  v_alignbyte_b32 v31, v134, v133, v15
  ds_read2_b32 v[130:131], v111 offset0:0 offset1:1
  ds_read2_b32 v[132:133], v111 offset0:2 offset1:3
  ds_read_b32 v134, v111 offset:16
  v_mfma_f32_16x16x32_bf16 a[64:67], v[24:27], v[56:59], a[64:67]
  s_waitcnt lgkmcnt(9)
  v_alignbyte_b32 v32, v113, v112, v15
  v_alignbyte_b32 v33, v114, v113, v15
  v_alignbyte_b32 v34, v115, v114, v15
  v_alignbyte_b32 v35, v116, v115, v15
  ds_read_b64 v[84:85], v8
  ds_read_b64 v[86:87], v9
  v_mfma_f32_16x16x32_bf16 a[96:99], v[28:31], v[60:63], a[96:99]
  s_waitcnt lgkmcnt(8)
  v_alignbyte_b32 v36, v119, v118, v15
  v_alignbyte_b32 v37, v120, v119, v15
  v_alignbyte_b32 v38, v121, v120, v15
  v_alignbyte_b32 v39, v122, v121, v15
  v_mfma_f32_16x16x32_bf16 a[128:131], v[32:35], v[64:67], a[128:131]
  s_waitcnt lgkmcnt(5)
  v_alignbyte_b32 v40, v125, v124, v15
  v_alignbyte_b32 v41, v126, v125, v15
  v_alignbyte_b32 v42, v127, v126, v15
  v_alignbyte_b32 v43, v128, v127, v15
  v_mfma_f32_16x16x32_bf16 a[160:163], v[36:39], v[68:71], a[160:163]
  s_waitcnt lgkmcnt(2)
  v_alignbyte_b32 v44, v131, v130, v15
  v_alignbyte_b32 v45, v132, v131, v15
  v_alignbyte_b32 v46, v133, v132, v15
  v_alignbyte_b32 v47, v134, v133, v15
  v_mfma_f32_16x16x32_bf16 a[192:195], v[40:43], v[72:75], a[192:195]
  s_nop 0
  v_mfma_f32_16x16x32_bf16 a[224:227], v[44:47], v[76:79], a[224:227]
  s_waitcnt lgkmcnt(0)
  ds_read_b128 v[48:51], v4 offset:3072
  ds_read_b128 v[52:55], v4 offset:7680
  ds_read_b128 v[56:59], v4 offset:12288
  ds_read_b128 v[60:63], v4 offset:16896
  ds_read_b128 v[64:67], v4 offset:21504
  ds_read_b128 v[68:71], v4 offset:26112
  ds_read_b128 v[72:75], v4 offset:30720
  ds_read_b128 v[76:79], v4 offset:35328
  s_mov_b32 exec_lo, s42
  s_mov_b32 exec_hi, s42
  ds_write_b128 v6, a[0:3] offset:0
  ds_write_b128 v6, a[32:35] offset:128
  ds_write_b128 v6, a[64:67] offset:256
  ds_write_b128 v6, a[96:99] offset:384
  ds_write_b128 v6, a[128:131] offset:512
  ds_write_b128 v6, a[160:163] offset:640
  ds_write_b128 v6, a[192:195] offset:768
  ds_write_b128 v6, a[224:227] offset:896
  s_mov_b64 exec, -1
  ds_read_b128 v[80:83], v7
  ds_write_b32 v14, v13 offset:8
  v_lshlrev_b32 v88, 16, v84
  v_and_b32 v89, 0xffff0000, v84
  v_lshlrev_b32 v90, 16, v85
  v_and_b32 v91, 0xffff0000, v85
  v_lshlrev_b32 v96, 16, v86
  v_and_b32 v97, 0xffff0000, v86
  v_lshlrev_b32 v98, 16, v87
  v_and_b32 v99, 0xffff0000, v87
  v_mul_f32 v92, v88, v12
  v_mul_f32 v93, v89, v12
  v_mul_f32 v94, v90, v12
  v_mul_f32 v95, v91, v12
  v_cvt_pk_bf16_f32 v84, v92, v93
  v_cvt_pk_bf16_f32 v85, v94, v95
  v_lshlrev_b32 v92, 16, v84
  v_and_b32 v93, 0xffff0000, v84
  v_lshlrev_b32 v94, 16, v85
  v_and_b32 v95, 0xffff0000, v85
  s_waitcnt lgkmcnt(1)
  v_fmac_f32 v80, v88, v11
  v_fmac_f32 v81, v89, v11
  v_fmac_f32 v82, v90, v11
  v_fmac_f32 v83, v91, v11
  v_cvt_pk_bf16_f32 v84, v80, v81
  v_cvt_pk_bf16_f32 v85, v82, v83
  v_lshlrev_b32 v80, 16, v84
  v_and_b32 v81, 0xffff0000, v84
  v_lshlrev_b32 v82, 16, v85
  v_and_b32 v83, 0xffff0000, v85
  v_add_f32 v80, v80, v92
  v_add_f32 v81, v81, v93
  v_add_f32 v82, v82, v94
  v_add_f32 v83, v83, v95
  v_cvt_pk_bf16_f32 v84, v80, v81
  v_cvt_pk_bf16_f32 v85, v82, v83
  v_lshlrev_b32 v80, 16, v84
  v_and_b32 v81, 0xffff0000, v84
  v_lshlrev_b32 v82, 16, v85
  v_and_b32 v83, 0xffff0000, v85
  v_add_f32 v80, v80, v96
  v_add_f32 v81, v81, v97
  v_add_f32 v82, v82, v98
  v_add_f32 v83, v83, v99
  v_cvt_pk_bf16_f32 v84, v80, v81
  v_cvt_pk_bf16_f32 v85, v82, v83
  buffer_store_dwordx2 v[84:85], v10, s[8:11], s40 offen sc1
  v_mfma_f32_16x16x32_bf16 a[4:7], v[16:19], v[48:51], a[4:7]
  ds_read_b128 v[48:51], v4 offset:2560
  v_mfma_f32_16x16x32_bf16 a[36:39], v[20:23], v[52:55], a[36:39]
  ds_read_b128 v[52:55], v4 offset:7168
  v_mfma_f32_16x16x32_bf16 a[68:71], v[24:27], v[56:59], a[68:71]
  ds_read_b128 v[56:59], v4 offset:11776
  v_mfma_f32_16x16x32_bf16 a[100:103], v[28:31], v[60:63], a[100:103]
  ds_read_b128 v[60:63], v4 offset:16384
  v_mfma_f32_16x16x32_bf16 a[132:135], v[32:35], v[64:67], a[132:135]
  ds_read_b128 v[64:67], v4 offset:20992
  v_mfma_f32_16x16x32_bf16 a[164:167], v[36:39], v[68:71], a[164:167]
  ds_read_b128 v[68:71], v4 offset:25600
  v_mfma_f32_16x16x32_bf16 a[196:199], v[40:43], v[72:75], a[196:199]
  ds_read_b128 v[72:75], v4 offset:30208
  v_mfma_f32_16x16x32_bf16 a[228:231], v[44:47], v[76:79], a[228:231]
  ds_read_b128 v[76:79], v4 offset:34816
  s_waitcnt lgkmcnt(7)
  v_mfma_f32_16x16x32_bf16 a[8:11], v[16:19], v[48:51], a[8:11]
  ds_read_b128 v[48:51], v4 offset:2048
  s_waitcnt lgkmcnt(7)
  v_mfma_f32_16x16x32_bf16 a[40:43], v[20:23], v[52:55], a[40:43]
  ds_read_b128 v[52:55], v4 offset:6656
  s_waitcnt lgkmcnt(7)
  v_mfma_f32_16x16x32_bf16 a[72:75], v[24:27], v[56:59], a[72:75]
  ds_read_b128 v[56:59], v4 offset:11264
  s_waitcnt lgkmcnt(7)
  v_mfma_f32_16x16x32_bf16 a[104:107], v[28:31], v[60:63], a[104:107]
  ds_read_b128 v[60:63], v4 offset:15872
  s_waitcnt lgkmcnt(7)
  v_mfma_f32_16x16x32_bf16 a[136:139], v[32:35], v[64:67], a[136:139]
  ds_read_b128 v[64:67], v4 offset:20480
  s_waitcnt lgkmcnt(7)
  v_mfma_f32_16x16x32_bf16 a[168:171], v[36:39], v[68:71], a[168:171]
  ds_read_b128 v[68:71], v4 offset:25088
  s_waitcnt lgkmcnt(7)
  v_mfma_f32_16x16x32_bf16 a[200:203], v[40:43], v[72:75], a[200:203]
  ds_read_b128 v[72:75], v4 offset:29696
  s_waitcnt lgkmcnt(7)
  v_mfma_f32_16x16x32_bf16 a[232:235], v[44:47], v[76:79], a[232:235]
  ds_read_b128 v[76:79], v4 offset:34304
  s_waitcnt lgkmcnt(7)
  v_mfma_f32_16x16x32_bf16 a[12:15], v[16:19], v[48:51], a[12:15]
  ds_read_b128 v[48:51], v4 offset:1536
  s_waitcnt lgkmcnt(7)
  v_mfma_f32_16x16x32_bf16 a[44:47], v[20:23], v[52:55], a[44:47]
  ds_read_b128 v[52:55], v4 offset:6144
  s_waitcnt lgkmcnt(7)
  v_mfma_f32_16x16x32_bf16 a[76:79], v[24:27], v[56:59], a[76:79]
  ds_read_b128 v[56:59], v4 offset:10752
  s_waitcnt lgkmcnt(7)
  v_mfma_f32_16x16x32_bf16 a[108:111], v[28:31], v[60:63], a[108:111]
  ds_read_b128 v[60:63], v4 offset:15360
  s_waitcnt lgkmcnt(7)
  v_mfma_f32_16x16x32_bf16 a[140:143], v[32:35], v[64:67], a[140:143]
  ds_read_b128 v[64:67], v4 offset:19968
  s_waitcnt lgkmcnt(7)
  v_mfma_f32_16x16x32_bf16 a[172:175], v[36:39], v[68:71], a[172:175]
  ds_read_b128 v[68:71], v4 offset:24576
  s_waitcnt lgkmcnt(7)
  v_mfma_f32_16x16x32_bf16 a[204:207], v[40:43], v[72:75], a[204:207]
  ds_read_b128 v[72:75], v4 offset:29184
  s_waitcnt lgkmcnt(7)
  v_mfma_f32_16x16x32_bf16 a[236:239], v[44:47], v[76:79], a[236:239]
  ds_read_b128 v[76:79], v4 offset:33792
  s_waitcnt lgkmcnt(7)
  v_mfma_f32_16x16x32_bf16 a[16:19], v[16:19], v[48:51], a[16:19]
  ds_read_b128 v[48:51], v4 offset:1024
  s_waitcnt lgkmcnt(7)
  v_mfma_f32_16x16x32_bf16 a[48:51], v[20:23], v[52:55], a[48:51]
  ds_read_b128 v[52:55], v4 offset:5632
  s_waitcnt lgkmcnt(7)
  v_mfma_f32_16x16x32_bf16 a[80:83], v[24:27], v[56:59], a[80:83]
  ds_read_b128 v[56:59], v4 offset:10240
  s_waitcnt lgkmcnt(7)
  v_mfma_f32_16x16x32_bf16 a[112:115], v[28:31], v[60:63], a[112:115]
  ds_read_b128 v[60:63], v4 offset:14848
  s_waitcnt lgkmcnt(7)
  v_mfma_f32_16x16x32_bf16 a[144:147], v[32:35], v[64:67], a[144:147]
  ds_read_b128 v[64:67], v4 offset:19456
  s_waitcnt lgkmcnt(7)
  v_mfma_f32_16x16x32_bf16 a[176:179], v[36:39], v[68:71], a[176:179]
  ds_read_b128 v[68:71], v4 offset:24064
  s_waitcnt lgkmcnt(7)
  v_mfma_f32_16x16x32_bf16 a[208:211], v[40:43], v[72:75], a[208:211]
  ds_read_b128 v[72:75], v4 offset:28672
  s_waitcnt lgkmcnt(7)
  v_mfma_f32_16x16x32_bf16 a[240:243], v[44:47], v[76:79], a[240:243]
  ds_read_b128 v[76:79], v4 offset:33280
  s_waitcnt lgkmcnt(7)
  v_mfma_f32_16x16x32_bf16 a[20:23], v[16:19], v[48:51], a[20:23]
  ds_read_b128 v[48:51], v4 offset:512
  s_waitcnt lgkmcnt(7)
  v_mfma_f32_16x16x32_bf16 a[52:55], v[20:23], v[52:55], a[52:55]
  ds_read_b128 v[52:55], v4 offset:5120
  s_waitcnt lgkmcnt(7)
  v_mfma_f32_16x16x32_bf16 a[84:87], v[24:27], v[56:59], a[84:87]
  ds_read_b128 v[56:59], v4 offset:9728
  s_waitcnt lgkmcnt(7)
  v_mfma_f32_16x16x32_bf16 a[116:119], v[28:31], v[60:63], a[116:119]
  ds_read_b128 v[60:63], v4 offset:14336
  s_waitcnt lgkmcnt(7)
  v_mfma_f32_16x16x32_bf16 a[148:151], v[32:35], v[64:67], a[148:151]
  ds_read_b128 v[64:67], v4 offset:18944
  s_waitcnt lgkmcnt(7)
  v_mfma_f32_16x16x32_bf16 a[180:183], v[36:39], v[68:71], a[180:183]
  ds_read_b128 v[68:71], v4 offset:23552
  s_waitcnt lgkmcnt(7)
  v_mfma_f32_16x16x32_bf16 a[212:215], v[40:43], v[72:75], a[212:215]
  ds_read_b128 v[72:75], v4 offset:28160
  s_waitcnt lgkmcnt(7)
  v_mfma_f32_16x16x32_bf16 a[244:247], v[44:47], v[76:79], a[244:247]
  ds_read_b128 v[76:79], v4 offset:32768
  s_waitcnt lgkmcnt(7)
  v_mfma_f32_16x16x32_bf16 a[24:27], v[16:19], v[48:51], a[24:27]
  ds_read_b128 v[48:51], v4 offset:0
  s_waitcnt lgkmcnt(7)
  v_mfma_f32_16x16x32_bf16 a[56:59], v[20:23], v[52:55], a[56:59]
  ds_read_b128 v[52:55], v4 offset:4608
  s_waitcnt lgkmcnt(7)
  v_mfma_f32_16x16x32_bf16 a[88:91], v[24:27], v[56:59], a[88:91]
  ds_read_b128 v[56:59], v4 offset:9216
  s_waitcnt lgkmcnt(7)
  v_mfma_f32_16x16x32_bf16 a[120:123], v[28:31], v[60:63], a[120:123]
  ds_read_b128 v[60:63], v4 offset:13824
  s_waitcnt lgkmcnt(7)
  v_mfma_f32_16x16x32_bf16 a[152:155], v[32:35], v[64:67], a[152:155]
  ds_read_b128 v[64:67], v4 offset:18432
  s_waitcnt lgkmcnt(7)
  v_mfma_f32_16x16x32_bf16 a[184:187], v[36:39], v[68:71], a[184:187]
  ds_read_b128 v[68:71], v4 offset:23040
  s_waitcnt lgkmcnt(7)
  v_mfma_f32_16x16x32_bf16 a[216:219], v[40:43], v[72:75], a[216:219]
  ds_read_b128 v[72:75], v4 offset:27648
  s_waitcnt lgkmcnt(7)
  v_mfma_f32_16x16x32_bf16 a[248:251], v[44:47], v[76:79], a[248:251]
  ds_read_b128 v[76:79], v4 offset:32256
  s_waitcnt lgkmcnt(7)
  v_mfma_f32_16x16x32_bf16 a[28:31], v[16:19], v[48:51], a[28:31]
  s_waitcnt lgkmcnt(6)
  v_mfma_f32_16x16x32_bf16 a[60:63], v[20:23], v[52:55], a[60:63]
  s_waitcnt lgkmcnt(5)
  v_mfma_f32_16x16x32_bf16 a[92:95], v[24:27], v[56:59], a[92:95]
  s_waitcnt lgkmcnt(4)
  v_mfma_f32_16x16x32_bf16 a[124:127], v[28:31], v[60:63], a[124:127]
  s_waitcnt lgkmcnt(3)
  v_mfma_f32_16x16x32_bf16 a[156:159], v[32:35], v[64:67], a[156:159]
  s_waitcnt lgkmcnt(2)
  v_mfma_f32_16x16x32_bf16 a[188:191], v[36:39], v[68:71], a[188:191]
  s_waitcnt lgkmcnt(1)
  v_mfma_f32_16x16x32_bf16 a[220:223], v[40:43], v[72:75], a[220:223]
  s_waitcnt lgkmcnt(0)
  v_mfma_f32_16x16x32_bf16 a[252:255], v[44:47], v[76:79], a[252:255]
  v_add_u32 v104, 64, v104
  v_add_u32 v105, 64, v105
  v_add_u32 v106, 64, v106
  v_add_u32 v107, 64, v107
  v_add_u32 v108, 64, v108
  v_add_u32 v109, 64, v109
  v_add_u32 v110, 64, v110
  v_add_u32 v111, 64, v111
  v_add_u32 v4, 64, v4
  v_add_u32 v8, 64, v8
  s_add_u32 s40, s40, 0x8000
  s_waitcnt vmcnt(0)
  s_mov_b64 exec, 1
  buffer_store_dword v13, v1, s[8:11], s39 offen sc1
  s_mov_b64 exec, -1
  ds_write_b32 v14, v13 offset:16
  s_add_u32 s32, s32, 1
  s_and_b32 s6, s32, 7
  s_cbranch_scc1 L_c_conv0
L_c_conv1:
  s_add_u32 s33, s32, 1
  s_and_b32 s6, s32, 7
  s_lshl_b32 s7, s6, 10
  s_add_u32 s7, s7, s35
  v_add_u32 v9, s7, v10
  s_lshl_b32 s6, s6, 1
  s_lshl_b32 s42, 0x30003, s6
  v_mov_b32 v13, s33
  ds_read_b128 v[48:51], v4 offset:3072
  ds_read_b128 v[52:55], v4 offset:7680
  ds_read_b128 v[56:59], v4 offset:12288
  ds_read_b128 v[60:63], v4 offset:16896
  ds_read_b128 v[64:67], v4 offset:21504
  ds_read_b128 v[68:71], v4 offset:26112
  ds_read_b128 v[72:75], v4 offset:30720
  ds_read_b128 v[76:79], v4 offset:35328
  s_mov_b32 s7, 0
L_lw_118:
  ds_read_b32 v88, v2 offset:0
  s_waitcnt lgkmcnt(0)
  v_cmp_gt_i32 vcc, s33, v88
  s_cbranch_vccz L_lwo_119
  s_add_u32 s7, s7, 1
  s_cmp_lt_u32 s7, 131072
  s_cbranch_scc1 L_lw_118
  s_mov_b32 s6, 42
  s_branch L_err
L_lwo_119:
  ds_read2_b32 v[112:113], v104 offset0:0 offset1:1
  ds_read2_b32 v[114:115], v104 offset0:2 offset1:3
  ds_read_b32 v116, v104 offset:16
  ds_read2_b32 v[118:119], v105 offset0:0 offset1:1
  ds_read2_b32 v[120:121], v105 offset0:2 offset1:3
  ds_read_b32 v122, v105 offset:16
  ds_read2_b32 v[124:125], v106 offset0:0 offset1:1
  ds_read2_b32 v[126:127], v106 offset0:2 offset1:3
  ds_read_b32 v128, v106 offset:16
  ds_read2_b32 v[130:131], v107 offset0:0 offset1:1
  ds_read2_b32 v[132:133], v107 offset0:2 offset1:3
  ds_read_b32 v134, v107 offset:16
  s_waitcnt lgkmcnt(9)
  v_alignbyte_b32 v16, v113, v112, v15
  v_alignbyte_b32 v17, v114, v113, v15
  v_alignbyte_b32 v18, v115, v114, v15
  v_alignbyte_b32 v19, v116, v115, v15
  ds_read2_b32 v[112:113], v108 offset0:0 offset1:1
  ds_read2_b32 v[114:115], v108 offset0:2 offset1:3
  ds_read_b32 v116, v108 offset:16
  s_waitcnt lgkmcnt(9)
  v_alignbyte_b32 v20, v119, v118, v15
  v_alignbyte_b32 v21, v120, v119, v15
  v_alignbyte_b32 v22, v121, v120, v15
  v_alignbyte_b32 v23, v122, v121, v15
  ds_read2_b32 v[118:119], v109 offset0:0 offset1:1
  ds_read2_b32 v[120:121], v109 offset0:2 offset1:3
  ds_read_b32 v122, v109 offset:16
  v_mfma_f32_16x16x32_bf16 a[4:7], v[16:19], v[48:51], a[4:7]
  s_waitcnt lgkmcnt(9)
  v_alignbyte_b32 v24, v125, v124, v15
  v_alignbyte_b32 v25, v126, v125, v15
  v_alignbyte_b32 v26, v127, v126, v15
  v_alignbyte_b32 v27, v128, v127, v15
  ds_read2_b32 v[124:125], v110 offset0:0 offset1:1
  ds_read2_b32 v[126:127], v110 offset0:2 offset1:3
  ds_read_b32 v128, v110 offset:16
  v_mfma_f32_16x16x32_bf16 a[36:39], v[20:23], v[52:55], a[36:39]
  s_waitcnt lgkmcnt(9)
  v_alignbyte_b32 v28, v131, v130, v15
  v_alignbyte_b32 v29, v132, v131, v15
  v_alignbyte_b32 v30, v133, v132, v15
  v_alignbyte_b32 v31, v134, v133, v15
  ds_read2_b32 v[130:131], v111 offset0:0 offset1:1
  ds_read2_b32 v[132:133], v111 offset0:2 offset1:3
  ds_read_b32 v134, v111 offset:16
  v_mfma_f32_16x16x32_bf16 a[68:71], v[24:27], v[56:59], a[68:71]
  s_waitcnt lgkmcnt(9)
  v_alignbyte_b32 v32, v113, v112, v15
  v_alignbyte_b32 v33, v114, v113, v15
  v_alignbyte_b32 v34, v115, v114, v15
  v_alignbyte_b32 v35, v116, v115, v15
  ds_read_b64 v[84:85], v8
  ds_read_b64 v[86:87], v9
  v_mfma_f32_16x16x32_bf16 a[100:103], v[28:31], v[60:63], a[100:103]
  s_waitcnt lgkmcnt(8)
  v_alignbyte_b32 v36, v119, v118, v15
  v_alignbyte_b32 v37, v120, v119, v15
  v_alignbyte_b32 v38, v121, v120, v15
  v_alignbyte_b32 v39, v122, v121, v15
  v_mfma_f32_16x16x32_bf16 a[132:135], v[32:35], v[64:67], a[132:135]
  s_waitcnt lgkmcnt(5)
  v_alignbyte_b32 v40, v125, v124, v15
  v_alignbyte_b32 v41, v126, v125, v15
  v_alignbyte_b32 v42, v127, v126, v15
  v_alignbyte_b32 v43, v128, v127, v15
  v_mfma_f32_16x16x32_bf16 a[164:167], v[36:39], v[68:71], a[164:167]
  s_waitcnt lgkmcnt(2)
  v_alignbyte_b32 v44, v131, v130, v15
  v_alignbyte_b32 v45, v132, v131, v15
  v_alignbyte_b32 v46, v133, v132, v15
  v_alignbyte_b32 v47, v134, v133, v15
  v_mfma_f32_16x16x32_bf16 a[196:199], v[40:43], v[72:75], a[196:199]
  s_nop 0
  v_mfma_f32_16x16x32_bf16 a[228:231], v[44:47], v[76:79], a[228:231]
  s_waitcnt lgkmcnt(0)
  ds_read_b128 v[48:51], v4 offset:2560
  ds_read_b128 v[52:55], v4 offset:7168
  ds_read_b128 v[56:59], v4 offset:11776
  ds_read_b128 v[60:63], v4 offset:16384
  ds_read_b128 v[64:67], v4 offset:20992
  ds_read_b128 v[68:71], v4 offset:25600
  ds_read_b128 v[72:75], v4 offset:30208
  ds_read_b128 v[76:79], v4 offset:34816
  s_mov_b32 exec_lo, s42
  s_mov_b32 exec_hi, s42
  ds_write_b128 v6, a[4:7] offset:0
  ds_write_b128 v6, a[36:39] offset:128
  ds_write_b128 v6, a[68:71] offset:256
  ds_write_b128 v6, a[100:103] offset:384
  ds_write_b128 v6, a[132:135] offset:512
  ds_write_b128 v6, a[164:167] offset:640
  ds_write_b128 v6, a[196:199] offset:768
  ds_write_b128 v6, a[228:231] offset:896
  s_mov_b64 exec, -1
  ds_read_b128 v[80:83], v7
  ds_write_b32 v14, v13 offset:8
  v_lshlrev_b32 v88, 16, v84
  v_and_b32 v89, 0xffff0000, v84
  v_lshlrev_b32 v90, 16, v85
  v_and_b32 v91, 0xffff0000, v85
  v_lshlrev_b32 v96, 16, v86
  v_and_b32 v97, 0xffff0000, v86
  v_lshlrev_b32 v98, 16, v87
  v_and_b32 v99, 0xffff0000, v87
  v_mul_f32 v92, v88, v12
  v_mul_f32 v93, v89, v12
  v_mul_f32 v94, v90, v12
  v_mul_f32 v95, v91, v12
  v_cvt_pk_bf16_f32 v84, v92, v93
  v_cvt_pk_bf16_f32 v85, v94, v95
  v_lshlrev_b32 v92, 16, v84
  v_and_b32 v93, 0xffff0000, v84
  v_lshlrev_b32 v94, 16, v85
  v_and_b32 v95, 0xffff0000, v85
  s_waitcnt lgkmcnt(1)
  v_fmac_f32 v80, v88, v11
  v_fmac_f32 v81, v89, v11
  v_fmac_f32 v82, v90, v11
  v_fmac_f32 v83, v91, v11
  v_cvt_pk_bf16_f32 v84, v80, v81
  v_cvt_pk_bf16_f32 v85, v82, v83
  v_lshlrev_b32 v80, 16, v84
  v_and_b32 v81, 0xffff0000, v84
  v_lshlrev_b32 v82, 16, v85
  v_and_b32 v83, 0xffff0000, v85
  v_add_f32 v80, v80, v92
  v_add_f32 v81, v81, v93
  v_add_f32 v82, v82, v94
  v_add_f32 v83, v83, v95
  v_cvt_pk_bf16_f32 v84, v80, v81
  v_cvt_pk_bf16_f32 v85, v82, v83
  v_lshlrev_b32 v80, 16, v84
  v_and_b32 v81, 0xffff0000, v84
  v_lshlrev_b32 v82, 16, v85
  v_and_b32 v83, 0xffff0000, v85
  v_add_f32 v80, v80, v96
  v_add_f32 v81, v81, v97
  v_add_f32 v82, v82, v98
  v_add_f32 v83, v83, v99
  v_cvt_pk_bf16_f32 v84, v80, v81
  v_cvt_pk_bf16_f32 v85, v82, v83
  buffer_store_dwordx2 v[84:85], v10, s[8:11], s40 offen sc1
  v_mfma_f32_16x16x32_bf16 a[8:11], v[16:19], v[48:51], a[8:11]
  ds_read_b128 v[48:51], v4 offset:2048
  v_mfma_f32_16x16x32_bf16 a[40:43], v[20:23], v[52:55], a[40:43]
  ds_read_b128 v[52:55], v4 offset:6656
  v_mfma_f32_16x16x32_bf16 a[72:75], v[24:27], v[56:59], a[72:75]
  ds_read_b128 v[56:59], v4 offset:11264
  v_mfma_f32_16x16x32_bf16 a[104:107], v[28:31], v[60:63], a[104:107]
  ds_read_b128 v[60:63], v4 offset:15872
  v_mfma_f32_16x16x32_bf16 a[136:139], v[32:35], v[64:67], a[136:139]
  ds_read_b128 v[64:67], v4 offset:20480
  v_mfma_f32_16x16x32_bf16 a[168:171], v[36:39], v[68:71], a[168:171]
  ds_read_b128 v[68:71], v4 offset:25088
  v_mfma_f32_16x16x32_bf16 a[200:203], v[40:43], v[72:75], a[200:203]
  ds_read_b128 v[72:75], v4 offset:29696
  v_mfma_f32_16x16x32_bf16 a[232:235], v[44:47], v[76:79], a[232:235]
  ds_read_b128 v[76:79], v4 offset:34304
  s_waitcnt lgkmcnt(7)
  v_mfma_f32_16x16x32_bf16 a[12:15], v[16:19], v[48:51], a[12:15]
  ds_read_b128 v[48:51], v4 offset:1536
  s_waitcnt lgkmcnt(7)
  v_mfma_f32_16x16x32_bf16 a[44:47], v[20:23], v[52:55], a[44:47]
  ds_read_b128 v[52:55], v4 offset:6144
  s_waitcnt lgkmcnt(7)
  v_mfma_f32_16x16x32_bf16 a[76:79], v[24:27], v[56:59], a[76:79]
  ds_read_b128 v[56:59], v4 offset:10752
  s_waitcnt lgkmcnt(7)
  v_mfma_f32_16x16x32_bf16 a[108:111], v[28:31], v[60:63], a[108:111]
  ds_read_b128 v[60:63], v4 offset:15360
  s_waitcnt lgkmcnt(7)
  v_mfma_f32_16x16x32_bf16 a[140:143], v[32:35], v[64:67], a[140:143]
  ds_read_b128 v[64:67], v4 offset:19968
  s_waitcnt lgkmcnt(7)
  v_mfma_f32_16x16x32_bf16 a[172:175], v[36:39], v[68:71], a[172:175]
  ds_read_b128 v[68:71], v4 offset:24576
  s_waitcnt lgkmcnt(7)
  v_mfma_f32_16x16x32_bf16 a[204:207], v[40:43], v[72:75], a[204:207]
  ds_read_b128 v[72:75], v4 offset:29184
  s_waitcnt lgkmcnt(7)
  v_mfma_f32_16x16x32_bf16 a[236:239], v[44:47], v[76:79], a[236:239]
  ds_read_b128 v[76:79], v4 offset:33792
  s_waitcnt lgkmcnt(7)
  v_mfma_f32_16x16x32_bf16 a[16:19], v[16:19], v[48:51], a[16:19]
  ds_read_b128 v[48:51], v4 offset:1024
  s_waitcnt lgkmcnt(7)
  v_mfma_f32_16x16x32_bf16 a[48:51], v[20:23], v[52:55], a[48:51]
  ds_read_b128 v[52:55], v4 offset:5632
  s_waitcnt lgkmcnt(7)
  v_mfma_f32_16x16x32_bf16 a[80:83], v[24:27], v[56:59], a[80:83]
  ds_read_b128 v[56:59], v4 offset:10240
  s_waitcnt lgkmcnt(7)
  v_mfma_f32_16x16x32_bf16 a[112:115], v[28:31], v[60:63], a[112:115]
  ds_read_b128 v[60:63], v4 offset:14848
  s_waitcnt lgkmcnt(7)
  v_mfma_f32_16x16x32_bf16 a[144:147], v[32:35], v[64:67], a[144:147]
  ds_read_b128 v[64:67], v4 offset:19456
  s_waitcnt lgkmcnt(7)
  v_mfma_f32_16x16x32_bf16 a[176:179], v[36:39], v[68:71], a[176:179]
  ds_read_b128 v[68:71], v4 offset:24064
  s_waitcnt lgkmcnt(7)
  v_mfma_f32_16x16x32_bf16 a[208:211], v[40:43], v[72:75], a[208:211]
  ds_read_b128 v[72:75], v4 offset:28672
  s_waitcnt lgkmcnt(7)
  v_mfma_f32_16x16x32_bf16 a[240:243], v[44:47], v[76:79], a[240:243]
  ds_read_b128 v[76:79], v4 offset:33280
  s_waitcnt lgkmcnt(7)
  v_mfma_f32_16x16x32_bf16 a[20:23], v[16:19], v[48:51], a[20:23]
  ds_read_b128 v[48:51], v4 offset:512
  s_waitcnt lgkmcnt(7)
  v_mfma_f32_16x16x32_bf16 a[52:55], v[20:23], v[52:55], a[52:55]
  ds_read_b128 v[52:55], v4 offset:5120
  s_waitcnt lgkmcnt(7)
  v_mfma_f32_16x16x32_bf16 a[84:87], v[24:27], v[56:59], a[84:87]
  ds_read_b128 v[56:59], v4 offset:9728
  s_waitcnt lgkmcnt(7)
  v_mfma_f32_16x16x32_bf16 a[116:119], v[28:31], v[60:63], a[116:119]
  ds_read_b128 v[60:63], v4 offset:14336
  s_waitcnt lgkmcnt(7)
  v_mfma_f32_16x16x32_bf16 a[148:151], v[32:35], v[64:67], a[148:151]
  ds_read_b128 v[64:67], v4 offset:18944
  s_waitcnt lgkmcnt(7)
  v_mfma_f32_16x16x32_bf16 a[180:183], v[36:39], v[68:71], a[180:183]
  ds_read_b128 v[68:71], v4 offset:23552
  s_waitcnt lgkmcnt(7)
  v_mfma_f32_16x16x32_bf16 a[212:215], v[40:43], v[72:75], a[212:215]
  ds_read_b128 v[72:75], v4 offset:28160
  s_waitcnt lgkmcnt(7)
  v_mfma_f32_16x16x32_bf16 a[244:247], v[44:47], v[76:79], a[244:247]
  ds_read_b128 v[76:79], v4 offset:32768
  s_waitcnt lgkmcnt(7)
  v_mfma_f32_16x16x32_bf16 a[24:27], v[16:19], v[48:51], a[24:27]
  ds_read_b128 v[48:51], v4 offset:0
  s_waitcnt lgkmcnt(7)
  v_mfma_f32_16x16x32_bf16 a[56:59], v[20:23], v[52:55], a[56:59]
  ds_read_b128 v[52:55], v4 offset:4608
  s_waitcnt lgkmcnt(7)
  v_mfma_f32_16x16x32_bf16 a[88:91], v[24:27], v[56:59], a[88:91]
  ds_read_b128 v[56:59], v4 offset:9216
  s_waitcnt lgkmcnt(7)
  v_mfma_f32_16x16x32_bf16 a[120:123], v[28:31], v[60:63], a[120:123]
  ds_read_b128 v[60:63], v4 offset:13824
  s_waitcnt lgkmcnt(7)
  v_mfma_f32_16x16x32_bf16 a[152:155], v[32:35], v[64:67], a[152:155]
  ds_read_b128 v[64:67], v4 offset:18432
  s_waitcnt lgkmcnt(7)
  v_mfma_f32_16x16x32_bf16 a[184:187], v[36:39], v[68:71], a[184:187]
  ds_read_b128 v[68:71], v4 offset:23040
  s_waitcnt lgkmcnt(7)
  v_mfma_f32_16x16x32_bf16 a[216:219], v[40:43], v[72:75], a[216:219]
  ds_read_b128 v[72:75], v4 offset:27648
  s_waitcnt lgkmcnt(7)
  v_mfma_f32_16x16x32_bf16 a[248:251], v[44:47], v[76:79], a[248:251]
  ds_read_b128 v[76:79], v4 offset:32256
  s_waitcnt lgkmcnt(7)
  v_mfma_f32_16x16x32_bf16 a[28:31], v[16:19], v[48:51], a[28:31]
  s_waitcnt lgkmcnt(6)
  v_mfma_f32_16x16x32_bf16 a[60:63], v[20:23], v[52:55], a[60:63]
  s_waitcnt lgkmcnt(5)
  v_mfma_f32_16x16x32_bf16 a[92:95], v[24:27], v[56:59], a[92:95]
  s_waitcnt lgkmcnt(4)
  v_mfma_f32_16x16x32_bf16 a[124:127], v[28:31], v[60:63], a[124:127]
  s_waitcnt lgkmcnt(3)
  v_mfma_f32_16x16x32_bf16 a[156:159], v[32:35], v[64:67], a[156:159]
  s_waitcnt lgkmcnt(2)
  v_mfma_f32_16x16x32_bf16 a[188:191], v[36:39], v[68:71], a[188:191]
  s_waitcnt lgkmcnt(1)
  v_mfma_f32_16x16x32_bf16 a[220:223], v[40:43], v[72:75], a[220:223]
  s_waitcnt lgkmcnt(0)
  v_mfma_f32_16x16x32_bf16 a[252:255], v[44:47], v[76:79], a[252:255]
  v_add_u32 v104, 64, v104
  v_add_u32 v105, 64, v105
  v_add_u32 v106, 64, v106
  v_add_u32 v107, 64, v107
  v_add_u32 v108, 64, v108
  v_add_u32 v109, 64, v109
  v_add_u32 v110, 64, v110
  v_add_u32 v111, 64, v111
  v_add_u32 v4, 64, v4
  v_add_u32 v8, 64, v8
  s_add_u32 s40, s40, 0x8000
  s_waitcnt vmcnt(0)
  s_mov_b64 exec, 1
  buffer_store_dword v13, v1, s[8:11], s39 offen sc1
  s_mov_b64 exec, -1
  ds_write_b32 v14, v13 offset:16
  s_add_u32 s32, s32, 1
  s_and_b32 s6, s32, 7
  s_cbranch_scc1 L_c_conv1
L_c_conv2:
  s_add_u32 s33, s32, 1
  s_and_b32 s6, s32, 7
  s_lshl_b32 s7, s6, 10
  s_add_u32 s7, s7, s35
  v_add_u32 v9, s7, v10
  s_lshl_b32 s6, s6, 1
  s_lshl_b32 s42, 0x30003, s6
  v_mov_b32 v13, s33
  ds_read_b128 v[48:51], v4 offset:2560
  ds_read_b128 v[52:55], v4 offset:7168
  ds_read_b128 v[56:59], v4 offset:11776
  ds_read_b128 v[60:63], v4 offset:16384
  ds_read_b128 v[64:67], v4 offset:20992
  ds_read_b128 v[68:71], v4 offset:25600
  ds_read_b128 v[72:75], v4 offset:30208
  ds_read_b128 v[76:79], v4 offset:34816
  s_mov_b32 s7, 0
L_lw_120:
  ds_read_b32 v88, v2 offset:0
  s_waitcnt lgkmcnt(0)
  v_cmp_gt_i32 vcc, s33, v88
  s_cbranch_vccz L_lwo_121
  s_add_u32 s7, s7, 1
  s_cmp_lt_u32 s7, 131072
  s_cbranch_scc1 L_lw_120
  s_mov_b32 s6, 42
  s_branch L_err
L_lwo_121:
  ds_read2_b32 v[112:113], v104 offset0:0 offset1:1
  ds_read2_b32 v[114:115], v104 offset0:2 offset1:3
  ds_read_b32 v116, v104 offset:16
  ds_read2_b32 v[118:119], v105 offset0:0 offset1:1
  ds_read2_b32 v[120:121], v105 offset0:2 offset1:3
  ds_read_b32 v122, v105 offset:16
  ds_read2_b32 v[124:125], v106 offset0:0 offset1:1
  ds_read2_b32 v[126:127], v106 offset0:2 offset1:3
  ds_read_b32 v128, v106 offset:16
  ds_read2_b32 v[130:131], v107 offset0:0 offset1:1
  ds_read2_b32 v[132:133], v107 offset0:2 offset1:3
  ds_read_b32 v134, v107 offset:16
  s_waitcnt lgkmcnt(9)
  v_alignbyte_b32 v16, v113, v112, v15
  v_alignbyte_b32 v17, v114, v113, v15
  v_alignbyte_b32 v18, v115, v114, v15
  v_alignbyte_b32 v19, v116, v115, v15
  ds_read2_b32 v[112:113], v108 offset0:0 offset1:1
  ds_read2_b32 v[114:115], v108 offset0:2 offset1:3
  ds_read_b32 v116, v108 offset:16
  s_waitcnt lgkmcnt(9)
  v_alignbyte_b32 v20, v119, v118, v15
  v_alignbyte_b32 v21, v120, v119, v15
  v_alignbyte_b32 v22, v121, v120, v15
  v_alignbyte_b32 v23, v122, v121, v15
  ds_read2_b32 v[118:119], v109 offset0:0 offset1:1
  ds_read2_b32 v[120:121], v109 offset0:2 offset1:3
  ds_read_b32 v122, v109 offset:16
  v_mfma_f32_16x16x32_bf16 a[8:11], v[16:19], v[48:51], a[8:11]
  s_waitcnt lgkmcnt(9)
  v_alignbyte_b32 v24, v125, v124, v15
  v_alignbyte_b32 v25, v126, v125, v15
  v_alignbyte_b32 v26, v127, v126, v15
  v_alignbyte_b32 v27, v128, v127, v15
  ds_read2_b32 v[124:125], v110 offset0:0 offset1:1
  ds_read2_b32 v[126:127], v110 offset0:2 offset1:3
  ds_read_b32 v128, v110 offset:16
  v_mfma_f32_16x16x32_bf16 a[40:43], v[20:23], v[52:55], a[40:43]
  s_waitcnt lgkmcnt(9)
  v_alignbyte_b32 v28, v131, v130, v15
  v_alignbyte_b32 v29, v132, v131, v15
  v_alignbyte_b32 v30, v133, v132, v15
  v_alignbyte_b32 v31, v134, v133, v15
  ds_read2_b32 v[130:131], v111 offset0:0 offset1:1
  ds_read2_b32 v[132:133], v111 offset0:2 offset1:3
  ds_read_b32 v134, v111 offset:16
  v_mfma_f32_16x16x32_bf16 a[72:75], v[24:27], v[56:59], a[72:75]
  s_waitcnt lgkmcnt(9)
  v_alignbyte_b32 v32, v113, v112, v15
  v_alignbyte_b32 v33, v114, v113, v15
  v_alignbyte_b32 v34, v115, v114, v15
  v_alignbyte_b32 v35, v116, v115, v15
  ds_read_b64 v[84:85], v8
  ds_read_b64 v[86:87], v9
  v_mfma_f32_16x16x32_bf16 a[104:107], v[28:31], v[60:63], a[104:107]
  s_waitcnt lgkmcnt(8)
  v_alignbyte_b32 v36, v119, v118, v15
  v_alignbyte_b32 v37, v120, v119, v15
  v_alignbyte_b32 v38, v121, v120, v15
  v_alignbyte_b32 v39, v122, v121, v15
  v_mfma_f32_16x16x32_bf16 a[136:139], v[32:35], v[64:67], a[136:139]
  s_waitcnt lgkmcnt(5)
  v_alignbyte_b32 v40, v125, v124, v15
  v_alignbyte_b32 v41, v126, v125, v15
  v_alignbyte_b32 v42, v127, v126, v15
  v_alignbyte_b32 v43, v128, v127, v15
  v_mfma_f32_16x16x32_bf16 a[168:171], v[36:39], v[68:71], a[168:171]
  s_waitcnt lgkmcnt(2)
  v_alignbyte_b32 v44, v131, v130, v15
  v_alignbyte_b32 v45, v132, v131, v15
  v_alignbyte_b32 v46, v133, v132, v15
  v_alignbyte_b32 v47, v134, v133, v15
  v_mfma_f32_16x16x32_bf16 a[200:203], v[40:43], v[72:75], a[200:203]
  s_nop 0
  v_mfma_f32_16x16x32_bf16 a[232:235], v[44:47], v[76:79], a[232:235]
  s_waitcnt lgkmcnt(0)
  ds_read_b128 v[48:51], v4 offset:2048
  ds_read_b128 v[52:55], v4 offset:6656
  ds_read_b128 v[56:59], v4 offset:11264
  ds_read_b128 v[60:63], v4 offset:15872
  ds_read_b128 v[64:67], v4 offset:20480
  ds_read_b128 v[68:71], v4 offset:25088
  ds_read_b128 v[72:75], v4 offset:29696
  ds_read_b128 v[76:79], v4 offset:34304
  s_mov_b32 exec_lo, s42
  s_mov_b32 exec_hi, s42
  ds_write_b128 v6, a[8:11] offset:0
  ds_write_b128 v6, a[40:43] offset:128
  ds_write_b128 v6, a[72:75] offset:256
  ds_write_b128 v6, a[104:107] offset:384
  ds_write_b128 v6, a[136:139] offset:512
  ds_write_b128 v6, a[168:171] offset:640
  ds_write_b128 v6, a[200:203] offset:768
  ds_write_b128 v6, a[232:235] offset:896
  s_mov_b64 exec, -1
  ds_read_b128 v[80:83], v7
  ds_write_b32 v14, v13 offset:8
  v_lshlrev_b32 v88, 16, v84
  v_and_b32 v89, 0xffff0000, v84
  v_lshlrev_b32 v90, 16, v85
  v_and_b32 v91, 0xffff0000, v85
  v_lshlrev_b32 v96, 16, v86
  v_and_b32 v97, 0xffff0000, v86
  v_lshlrev_b32 v98, 16, v87
  v_and_b32 v99, 0xffff0000, v87
  v_mul_f32 v92, v88, v12
  v_mul_f32 v93, v89, v12
  v_mul_f32 v94, v90, v12
  v_mul_f32 v95, v91, v12
  v_cvt_pk_bf16_f32 v84, v92, v93
  v_cvt_pk_bf16_f32 v85, v94, v95
  v_lshlrev_b32 v92, 16, v84
  v_and_b32 v93, 0xffff0000, v84
  v_lshlrev_b32 v94, 16, v85
  v_and_b32 v95, 0xffff0000, v85
  s_waitcnt lgkmcnt(1)
  v_fmac_f32 v80, v88, v11
  v_fmac_f32 v81, v89, v11
  v_fmac_f32 v82, v90, v11
  v_fmac_f32 v83, v91, v11
  v_cvt_pk_bf16_f32 v84, v80, v81
  v_cvt_pk_bf16_f32 v85, v82, v83
  v_lshlrev_b32 v80, 16, v84
  v_and_b32 v81, 0xffff0000, v84
  v_lshlrev_b32 v82, 16, v85
  v_and_b32 v83, 0xffff0000, v85
  v_add_f32 v80, v80, v92
  v_add_f32 v81, v81, v93
  v_add_f32 v82, v82, v94
  v_add_f32 v83, v83, v95
  v_cvt_pk_bf16_f32 v84, v80, v81
  v_cvt_pk_bf16_f32 v85, v82, v83
  v_lshlrev_b32 v80, 16, v84
  v_and_b32 v81, 0xffff0000, v84
  v_lshlrev_b32 v82, 16, v85
  v_and_b32 v83, 0xffff0000, v85
  v_add_f32 v80, v80, v96
  v_add_f32 v81, v81, v97
  v_add_f32 v82, v82, v98
  v_add_f32 v83, v83, v99
  v_cvt_pk_bf16_f32 v84, v80, v81
  v_cvt_pk_bf16_f32 v85, v82, v83
  buffer_store_dwordx2 v[84:85], v10, s[8:11], s40 offen sc1
  v_mfma_f32_16x16x32_bf16 a[12:15], v[16:19], v[48:51], a[12:15]
  ds_read_b128 v[48:51], v4 offset:1536
  v_mfma_f32_16x16x32_bf16 a[44:47], v[20:23], v[52:55], a[44:47]
  ds_read_b128 v[52:55], v4 offset:6144
  v_mfma_f32_16x16x32_bf16 a[76:79], v[24:27], v[56:59], a[76:79]
  ds_read_b128 v[56:59], v4 offset:10752
  v_mfma_f32_16x16x32_bf16 a[108:111], v[28:31], v[60:63], a[108:111]
  ds_read_b128 v[60:63], v4 offset:15360
  v_mfma_f32_16x16x32_bf16 a[140:143], v[32:35], v[64:67], a[140:143]
  ds_read_b128 v[64:67], v4 offset:19968
  v_mfma_f32_16x16x32_bf16 a[172:175], v[36:39], v[68:71], a[172:175]
  ds_read_b128 v[68:71], v4 offset:24576
  v_mfma_f32_16x16x32_bf16 a[204:207], v[40:43], v[72:75], a[204:207]
  ds_read_b128 v[72:75], v4 offset:29184
  v_mfma_f32_16x16x32_bf16 a[236:239], v[44:47], v[76:79], a[236:239]
  ds_read_b128 v[76:79], v4 offset:33792
  s_waitcnt lgkmcnt(7)
  v_mfma_f32_16x16x32_bf16 a[16:19], v[16:19], v[48:51], a[16:19]
  ds_read_b128 v[48:51], v4 offset:1024
  s_waitcnt lgkmcnt(7)
  v_mfma_f32_16x16x32_bf16 a[48:51], v[20:23], v[52:55], a[48:51]
  ds_read_b128 v[52:55], v4 offset:5632
  s_waitcnt lgkmcnt(7)
  v_mfma_f32_16x16x32_bf16 a[80:83], v[24:27], v[56:59], a[80:83]
  ds_read_b128 v[56:59], v4 offset:10240
  s_waitcnt lgkmcnt(7)
  v_mfma_f32_16x16x32_bf16 a[112:115], v[28:31], v[60:63], a[112:115]
  ds_read_b128 v[60:63], v4 offset:14848
  s_waitcnt lgkmcnt(7)
  v_mfma_f32_16x16x32_bf16 a[144:147], v[32:35], v[64:67], a[144:147]
  ds_read_b128 v[64:67], v4 offset:19456
  s_waitcnt lgkmcnt(7)
  v_mfma_f32_16x16x32_bf16 a[176:179], v[36:39], v[68:71], a[176:179]
  ds_read_b128 v[68:71], v4 offset:24064
  s_waitcnt lgkmcnt(7)
  v_mfma_f32_16x16x32_bf16 a[208:211], v[40:43], v[72:75], a[208:211]
  ds_read_b128 v[72:75], v4 offset:28672
  s_waitcnt lgkmcnt(7)
  v_mfma_f32_16x16x32_bf16 a[240:243], v[44:47], v[76:79], a[240:243]
  ds_read_b128 v[76:79], v4 offset:33280
  s_waitcnt lgkmcnt(7)
  v_mfma_f32_16x16x32_bf16 a[20:23], v[16:19], v[48:51], a[20:23]
  ds_read_b128 v[48:51], v4 offset:512
  s_waitcnt lgkmcnt(7)
  v_mfma_f32_16x16x32_bf16 a[52:55], v[20:23], v[52:55], a[52:55]
  ds_read_b128 v[52:55], v4 offset:5120
  s_waitcnt lgkmcnt(7)
  v_mfma_f32_16x16x32_bf16 a[84:87], v[24:27], v[56:59], a[84:87]
  ds_read_b128 v[56:59], v4 offset:9728
  s_waitcnt lgkmcnt(7)
  v_mfma_f32_16x16x32_bf16 a[116:119], v[28:31], v[60:63], a[116:119]
  ds_read_b128 v[60:63], v4 offset:14336
  s_waitcnt lgkmcnt(7)
  v_mfma_f32_16x16x32_bf16 a[148:151], v[32:35], v[64:67], a[148:151]
  ds_read_b128 v[64:67], v4 offset:18944
  s_waitcnt lgkmcnt(7)
  v_mfma_f32_16x16x32_bf16 a[180:183], v[36:39], v[68:71], a[180:183]
  ds_read_b128 v[68:71], v4 offset:23552
  s_waitcnt lgkmcnt(7)
  v_mfma_f32_16x16x32_bf16 a[212:215], v[40:43], v[72:75], a[212:215]
  ds_read_b128 v[72:75], v4 offset:28160
  s_waitcnt lgkmcnt(7)
  v_mfma_f32_16x16x32_bf16 a[244:247], v[44:47], v[76:79], a[244:247]
  ds_read_b128 v[76:79], v4 offset:32768
  s_waitcnt lgkmcnt(7)
  v_mfma_f32_16x16x32_bf16 a[24:27], v[16:19], v[48:51], a[24:27]
  ds_read_b128 v[48:51], v4 offset:0
  s_waitcnt lgkmcnt(7)
  v_mfma_f32_16x16x32_bf16 a[56:59], v[20:23], v[52:55], a[56:59]
  ds_read_b128 v[52:55], v4 offset:4608
  s_waitcnt lgkmcnt(7)
  v_mfma_f32_16x16x32_bf16 a[88:91], v[24:27], v[56:59], a[88:91]
  ds_read_b128 v[56:59], v4 offset:9216
  s_waitcnt lgkmcnt(7)
  v_mfma_f32_16x16x32_bf16 a[120:123], v[28:31], v[60:63], a[120:123]
  ds_read_b128 v[60:63], v4 offset:13824
  s_waitcnt lgkmcnt(7)
  v_mfma_f32_16x16x32_bf16 a[152:155], v[32:35], v[64:67], a[152:155]
  ds_read_b128 v[64:67], v4 offset:18432
  s_waitcnt lgkmcnt(7)
  v_mfma_f32_16x16x32_bf16 a[184:187], v[36:39], v[68:71], a[184:187]
  ds_read_b128 v[68:71], v4 offset:23040
  s_waitcnt lgkmcnt(7)
  v_mfma_f32_16x16x32_bf16 a[216:219], v[40:43], v[72:75], a[216:219]
  ds_read_b128 v[72:75], v4 offset:27648
  s_waitcnt lgkmcnt(7)
  v_mfma_f32_16x16x32_bf16 a[248:251], v[44:47], v[76:79], a[248:251]
  ds_read_b128 v[76:79], v4 offset:32256
  s_waitcnt lgkmcnt(7)
  v_mfma_f32_16x16x32_bf16 a[28:31], v[16:19], v[48:51], a[28:31]
  s_waitcnt lgkmcnt(6)
  v_mfma_f32_16x16x32_bf16 a[60:63], v[20:23], v[52:55], a[60:63]
  s_waitcnt lgkmcnt(5)
  v_mfma_f32_16x16x32_bf16 a[92:95], v[24:27], v[56:59], a[92:95]
  s_waitcnt lgkmcnt(4)
  v_mfma_f32_16x16x32_bf16 a[124:127], v[28:31], v[60:63], a[124:127]
  s_waitcnt lgkmcnt(3)
  v_mfma_f32_16x16x32_bf16 a[156:159], v[32:35], v[64:67], a[156:159]
  s_waitcnt lgkmcnt(2)
  v_mfma_f32_16x16x32_bf16 a[188:191], v[36:39], v[68:71], a[188:191]
  s_waitcnt lgkmcnt(1)
  v_mfma_f32_16x16x32_bf16 a[220:223], v[40:43], v[72:75], a[220:223]
  s_waitcnt lgkmcnt(0)
  v_mfma_f32_16x16x32_bf16 a[252:255], v[44:47], v[76:79], a[252:255]
  v_add_u32 v104, 64, v104
  v_add_u32 v105, 64, v105
  v_add_u32 v106, 64, v106
  v_add_u32 v107, 64, v107
  v_add_u32 v108, 64, v108
  v_add_u32 v109, 64, v109
  v_add_u32 v110, 64, v110
  v_add_u32 v111, 64, v111
  v_add_u32 v4, 64, v4
  v_add_u32 v8, 64, v8
  s_add_u32 s40, s40, 0x8000
  s_waitcnt vmcnt(0)
  s_mov_b64 exec, 1
  buffer_store_dword v13, v1, s[8:11], s39 offen sc1
  s_mov_b64 exec, -1
  ds_write_b32 v14, v13 offset:16
  s_add_u32 s32, s32, 1
  s_and_b32 s6, s32, 7
  s_cbranch_scc1 L_c_conv2
L_c_conv3:
  s_add_u32 s33, s32, 1
  s_and_b32 s6, s32, 7
  s_lshl_b32 s7, s6, 10
  s_add_u32 s7, s7, s35
  v_add_u32 v9, s7, v10
  s_lshl_b32 s6, s6, 1
  s_lshl_b32 s42, 0x30003, s6
  v_mov_b32 v13, s33
  ds_read_b128 v[48:51], v4 offset:2048
  ds_read_b128 v[52:55], v4 offset:6656
  ds_read_b128 v[56:59], v4 offset:11264
  ds_read_b128 v[60:63], v4 offset:15872
  ds_read_b128 v[64:67], v4 offset:20480
  ds_read_b128 v[68:71], v4 offset:25088
  ds_read_b128 v[72:75], v4 offset:29696
  ds_read_b128 v[76:79], v4 offset:34304
  s_mov_b32 s7, 0
L_lw_122:
  ds_read_b32 v88, v2 offset:0
  s_waitcnt lgkmcnt(0)
  v_cmp_gt_i32 vcc, s33, v88
  s_cbranch_vccz L_lwo_123
  s_add_u32 s7, s7, 1
  s_cmp_lt_u32 s7, 131072
  s_cbranch_scc1 L_lw_122
  s_mov_b32 s6, 42
  s_branch L_err
L_lwo_123:
  ds_read2_b32 v[112:113], v104 offset0:0 offset1:1
  ds_read2_b32 v[114:115], v104 offset0:2 offset1:3
  ds_read_b32 v116, v104 offset:16
  ds_read2_b32 v[118:119], v105 offset0:0 offset1:1
  ds_read2_b32 v[120:121], v105 offset0:2 offset1:3
  ds_read_b32 v122, v105 offset:16
  ds_read2_b32 v[124:125], v106 offset0:0 offset1:1
  ds_read2_b32 v[126:127], v106 offset0:2 offset1:3
  ds_read_b32 v128, v106 offset:16
  ds_read2_b32 v[130:131], v107 offset0:0 offset1:1
  ds_read2_b32 v[132:133], v107 offset0:2 offset1:3
  ds_read_b32 v134, v107 offset:16
  s_waitcnt lgkmcnt(9)
  v_alignbyte_b32 v16, v113, v112, v15
  v_alignbyte_b32 v17, v114, v113, v15
  v_alignbyte_b32 v18, v115, v114, v15
  v_alignbyte_b32 v19, v116, v115, v15
  ds_read2_b32 v[112:113], v108 offset0:0 offset1:1
  ds_read2_b32 v[114:115], v108 offset0:2 offset1:3
  ds_read_b32 v116, v108 offset:16
  s_waitcnt lgkmcnt(9)
  v_alignbyte_b32 v20, v119, v118, v15
  v_alignbyte_b32 v21, v120, v119, v15
  v_alignbyte_b32 v22, v121, v120, v15
  v_alignbyte_b32 v23, v122, v121, v15
  ds_read2_b32 v[118:119], v109 offset0:0 offset1:1
  ds_read2_b32 v[120:121], v109 offset0:2 offset1:3
  ds_read_b32 v122, v109 offset:16
  v_mfma_f32_16x16x32_bf16 a[12:15], v[16:19], v[48:51], a[12:15]
  s_waitcnt lgkmcnt(9)
  v_alignbyte_b32 v24, v125, v124, v15
  v_alignbyte_b32 v25, v126, v125, v15
  v_alignbyte_b32 v26, v127, v126, v15
  v_alignbyte_b32 v27, v128, v127, v15
  ds_read2_b32 v[124:125], v110 offset0:0 offset1:1
  ds_read2_b32 v[126:127], v110 offset0:2 offset1:3
  ds_read_b32 v128, v110 offset:16
  v_mfma_f32_16x16x32_bf16 a[44:47], v[20:23], v[52:55], a[44:47]
  s_waitcnt lgkmcnt(9)
  v_alignbyte_b32 v28, v131, v130, v15
  v_alignbyte_b32 v29, v132, v131, v15
  v_alignbyte_b32 v30, v133, v132, v15
  v_alignbyte_b32 v31, v134, v133, v15
  ds_read2_b32 v[130:131], v111 offset0:0 offset1:1
  ds_read2_b32 v[132:133], v111 offset0:2 offset1:3
  ds_read_b32 v134, v111 offset:16
  v_mfma_f32_16x16x32_bf16 a[76:79], v[24:27], v[56:59], a[76:79]
  s_waitcnt lgkmcnt(9)
  v_alignbyte_b32 v32, v113, v112, v15
  v_alignbyte_b32 v33, v114, v113, v15
  v_alignbyte_b32 v34, v115, v114, v15
  v_alignbyte_b32 v35, v116, v115, v15
  ds_read_b64 v[84:85], v8
  ds_read_b64 v[86:87], v9
  v_mfma_f32_16x16x32_bf16 a[108:111], v[28:31], v[60:63], a[108:111]
  s_waitcnt lgkmcnt(8)
  v_alignbyte_b32 v36, v119, v118, v15
  v_alignbyte_b32 v37, v120, v119, v15
  v_alignbyte_b32 v38, v121, v120, v15
  v_alignbyte_b32 v39, v122, v121, v15
  v_mfma_f32_16x16x32_bf16 a[140:143], v[32:35], v[64:67], a[140:143]
  s_waitcnt lgkmcnt(5)
  v_alignbyte_b32 v40, v125, v124, v15
  v_alignbyte_b32 v41, v126, v125, v15
  v_alignbyte_b32 v42, v127, v126, v15
  v_alignbyte_b32 v43, v128, v127, v15
  v_mfma_f32_16x16x32_bf16 a[172:175], v[36:39], v[68:71], a[172:175]
  s_waitcnt lgkmcnt(2)
  v_alignbyte_b32 v44, v131, v130, v15
  v_alignbyte_b32 v45, v132, v131, v15
  v_alignbyte_b32 v46, v133, v132, v15
  v_alignbyte_b32 v47, v134, v133, v15
  v_mfma_f32_16x16x32_bf16 a[204:207], v[40:43], v[72:75], a[204:207]
  s_nop 0
  v_mfma_f32_16x16x32_bf16 a[236:239], v[44:47], v[76:79], a[236:239]
  s_waitcnt lgkmcnt(0)
  ds_read_b128 v[48:51], v4 offset:1536
  ds_read_b128 v[52:55], v4 offset:6144
  ds_read_b128 v[56:59], v4 offset:10752
  ds_read_b128 v[60:63], v4 offset:15360
  ds_read_b128 v[64:67], v4 offset:19968
  ds_read_b128 v[68:71], v4 offset:24576
  ds_read_b128 v[72:75], v4 offset:29184
  ds_read_b128 v[76:79], v4 offset:33792
  s_mov_b32 exec_lo, s42
  s_mov_b32 exec_hi, s42
  ds_write_b128 v6, a[12:15] offset:0
  ds_write_b128 v6, a[44:47] offset:128
  ds_write_b128 v6, a[76:79] offset:256
  ds_write_b128 v6, a[108:111] offset:384
  ds_write_b128 v6, a[140:143] offset:512
  ds_write_b128 v6, a[172:175] offset:640
  ds_write_b128 v6, a[204:207] offset:768
  ds_write_b128 v6, a[236:239] offset:896
  s_mov_b64 exec, -1
  ds_read_b128 v[80:83], v7
  ds_write_b32 v14, v13 offset:8
  v_lshlrev_b32 v88, 16, v84
  v_and_b32 v89, 0xffff0000, v84
  v_lshlrev_b32 v90, 16, v85
  v_and_b32 v91, 0xffff0000, v85
  v_lshlrev_b32 v96, 16, v86
  v_and_b32 v97, 0xffff0000, v86
  v_lshlrev_b32 v98, 16, v87
  v_and_b32 v99, 0xffff0000, v87
  v_mul_f32 v92, v88, v12
  v_mul_f32 v93, v89, v12
  v_mul_f32 v94, v90, v12
  v_mul_f32 v95, v91, v12
  v_cvt_pk_bf16_f32 v84, v92, v93
  v_cvt_pk_bf16_f32 v85, v94, v95
  v_lshlrev_b32 v92, 16, v84
  v_and_b32 v93, 0xffff0000, v84
  v_lshlrev_b32 v94, 16, v85
  v_and_b32 v95, 0xffff0000, v85
  s_waitcnt lgkmcnt(1)
  v_fmac_f32 v80, v88, v11
  v_fmac_f32 v81, v89, v11
  v_fmac_f32 v82, v90, v11
  v_fmac_f32 v83, v91, v11
  v_cvt_pk_bf16_f32 v84, v80, v81
  v_cvt_pk_bf16_f32 v85, v82, v83
  v_lshlrev_b32 v80, 16, v84
  v_and_b32 v81, 0xffff0000, v84
  v_lshlrev_b32 v82, 16, v85
  v_and_b32 v83, 0xffff0000, v85
  v_add_f32 v80, v80, v92
  v_add_f32 v81, v81, v93
  v_add_f32 v82, v82, v94
  v_add_f32 v83, v83, v95
  v_cvt_pk_bf16_f32 v84, v80, v81
  v_cvt_pk_bf16_f32 v85, v82, v83
  v_lshlrev_b32 v80, 16, v84
  v_and_b32 v81, 0xffff0000, v84
  v_lshlrev_b32 v82, 16, v85
  v_and_b32 v83, 0xffff0000, v85
  v_add_f32 v80, v80, v96
  v_add_f32 v81, v81, v97
  v_add_f32 v82, v82, v98
  v_add_f32 v83, v83, v99
  v_cvt_pk_bf16_f32 v84, v80, v81
  v_cvt_pk_bf16_f32 v85, v82, v83
  buffer_store_dwordx2 v[84:85], v10, s[8:11], s40 offen sc1
  v_mfma_f32_16x16x32_bf16 a[16:19], v[16:19], v[48:51], a[16:19]
  ds_read_b128 v[48:51], v4 offset:1024
  v_mfma_f32_16x16x32_bf16 a[48:51], v[20:23], v[52:55], a[48:51]
  ds_read_b128 v[52:55], v4 offset:5632
  v_mfma_f32_16x16x32_bf16 a[80:83], v[24:27], v[56:59], a[80:83]
  ds_read_b128 v[56:59], v4 offset:10240
  v_mfma_f32_16x16x32_bf16 a[112:115], v[28:31], v[60:63], a[112:115]
  ds_read_b128 v[60:63], v4 offset:14848
  v_mfma_f32_16x16x32_bf16 a[144:147], v[32:35], v[64:67], a[144:147]
  ds_read_b128 v[64:67], v4 offset:19456
  v_mfma_f32_16x16x32_bf16 a[176:179], v[36:39], v[68:71], a[176:179]
  ds_read_b128 v[68:71], v4 offset:24064
  v_mfma_f32_16x16x32_bf16 a[208:211], v[40:43], v[72:75], a[208:211]
  ds_read_b128 v[72:75], v4 offset:28672
  v_mfma_f32_16x16x32_bf16 a[240:243], v[44:47], v[76:79], a[240:243]
  ds_read_b128 v[76:79], v4 offset:33280
  s_waitcnt lgkmcnt(7)
  v_mfma_f32_16x16x32_bf16 a[20:23], v[16:19], v[48:51], a[20:23]
  ds_read_b128 v[48:51], v4 offset:512
  s_waitcnt lgkmcnt(7)
  v_mfma_f32_16x16x32_bf16 a[52:55], v[20:23], v[52:55], a[52:55]
  ds_read_b128 v[52:55], v4 offset:5120
  s_waitcnt lgkmcnt(7)
  v_mfma_f32_16x16x32_bf16 a[84:87], v[24:27], v[56:59], a[84:87]
  ds_read_b128 v[56:59], v4 offset:9728
  s_waitcnt lgkmcnt(7)
  v_mfma_f32_16x16x32_bf16 a[116:119], v[28:31], v[60:63], a[116:119]
  ds_read_b128 v[60:63], v4 offset:14336
  s_waitcnt lgkmcnt(7)
  v_mfma_f32_16x16x32_bf16 a[148:151], v[32:35], v[64:67], a[148:151]
  ds_read_b128 v[64:67], v4 offset:18944
  s_waitcnt lgkmcnt(7)
  v_mfma_f32_16x16x32_bf16 a[180:183], v[36:39], v[68:71], a[180:183]
  ds_read_b128 v[68:71], v4 offset:23552
  s_waitcnt lgkmcnt(7)
  v_mfma_f32_16x16x32_bf16 a[212:215], v[40:43], v[72:75], a[212:215]
  ds_read_b128 v[72:75], v4 offset:28160
  s_waitcnt lgkmcnt(7)
  v_mfma_f32_16x16x32_bf16 a[244:247], v[44:47], v[76:79], a[244:247]
  ds_read_b128 v[76:79], v4 offset:32768
  s_waitcnt lgkmcnt(7)
  v_mfma_f32_16x16x32_bf16 a[24:27], v[16:19], v[48:51], a[24:27]
  ds_read_b128 v[48:51], v4 offset:0
  s_waitcnt lgkmcnt(7)
  v_mfma_f32_16x16x32_bf16 a[56:59], v[20:23], v[52:55], a[56:59]
  ds_read_b128 v[52:55], v4 offset:4608
  s_waitcnt lgkmcnt(7)
  v_mfma_f32_16x16x32_bf16 a[88:91], v[24:27], v[56:59], a[88:91]
  ds_read_b128 v[56:59], v4 offset:9216
  s_waitcnt lgkmcnt(7)
  v_mfma_f32_16x16x32_bf16 a[120:123], v[28:31], v[60:63], a[120:123]
  ds_read_b128 v[60:63], v4 offset:13824
  s_waitcnt lgkmcnt(7)
  v_mfma_f32_16x16x32_bf16 a[152:155], v[32:35], v[64:67], a[152:155]
  ds_read_b128 v[64:67], v4 offset:18432
  s_waitcnt lgkmcnt(7)
  v_mfma_f32_16x16x32_bf16 a[184:187], v[36:39], v[68:71], a[184:187]
  ds_read_b128 v[68:71], v4 offset:23040
  s_waitcnt lgkmcnt(7)
  v_mfma_f32_16x16x32_bf16 a[216:219], v[40:43], v[72:75], a[216:219]
  ds_read_b128 v[72:75], v4 offset:27648
  s_waitcnt lgkmcnt(7)
  v_mfma_f32_16x16x32_bf16 a[248:251], v[44:47], v[76:79], a[248:251]
  ds_read_b128 v[76:79], v4 offset:32256
  s_waitcnt lgkmcnt(7)
  v_mfma_f32_16x16x32_bf16 a[28:31], v[16:19], v[48:51], a[28:31]
  s_waitcnt lgkmcnt(6)
  v_mfma_f32_16x16x32_bf16 a[60:63], v[20:23], v[52:55], a[60:63]
  s_waitcnt lgkmcnt(5)
  v_mfma_f32_16x16x32_bf16 a[92:95], v[24:27], v[56:59], a[92:95]
  s_waitcnt lgkmcnt(4)
  v_mfma_f32_16x16x32_bf16 a[124:127], v[28:31], v[60:63], a[124:127]
  s_waitcnt lgkmcnt(3)
  v_mfma_f32_16x16x32_bf16 a[156:159], v[32:35], v[64:67], a[156:159]
  s_waitcnt lgkmcnt(2)
  v_mfma_f32_16x16x32_bf16 a[188:191], v[36:39], v[68:71], a[188:191]
  s_waitcnt lgkmcnt(1)
  v_mfma_f32_16x16x32_bf16 a[220:223], v[40:43], v[72:75], a[220:223]
  s_waitcnt lgkmcnt(0)
  v_mfma_f32_16x16x32_bf16 a[252:255], v[44:47], v[76:79], a[252:255]
  v_add_u32 v104, 64, v104
  v_add_u32 v105, 64, v105
  v_add_u32 v106, 64, v106
  v_add_u32 v107, 64, v107
  v_add_u32 v108, 64, v108
  v_add_u32 v109, 64, v109
  v_add_u32 v110, 64, v110
  v_add_u32 v111, 64, v111
  v_add_u32 v4, 64, v4
  v_add_u32 v8, 64, v8
  s_add_u32 s40, s40, 0x8000
  s_waitcnt vmcnt(0)
  s_mov_b64 exec, 1
  buffer_store_dword v13, v1, s[8:11], s39 offen sc1
  s_mov_b64 exec, -1
  ds_write_b32 v14, v13 offset:16
  s_add_u32 s32, s32, 1
  s_and_b32 s6, s32, 7
  s_cbranch_scc1 L_c_conv3
L_c_conv4:
  s_add_u32 s33, s32, 1
  s_and_b32 s6, s32, 7
  s_lshl_b32 s7, s6, 10
  s_add_u32 s7, s7, s35
  v_add_u32 v9, s7, v10
  s_lshl_b32 s6, s6, 1
  s_lshl_b32 s42, 0x30003, s6
  v_mov_b32 v13, s33
  ds_read_b128 v[48:51], v4 offset:1536
  ds_read_b128 v[52:55], v4 offset:6144
  ds_read_b128 v[56:59], v4 offset:10752
  ds_read_b128 v[60:63], v4 offset:15360
  ds_read_b128 v[64:67], v4 offset:19968
  ds_read_b128 v[68:71], v4 offset:24576
  ds_read_b128 v[72:75], v4 offset:29184
  ds_read_b128 v[76:79], v4 offset:33792
  s_mov_b32 s7, 0
L_lw_124:
  ds_read_b32 v88, v2 offset:0
  s_waitcnt lgkmcnt(0)
  v_cmp_gt_i32 vcc, s33, v88
  s_cbranch_vccz L_lwo_125
  s_add_u32 s7, s7, 1
  s_cmp_lt_u32 s7, 131072
  s_cbranch_scc1 L_lw_124
  s_mov_b32 s6, 42
  s_branch L_err
L_lwo_125:
  ds_read2_b32 v[112:113], v104 offset0:0 offset1:1
  ds_read2_b32 v[114:115], v104 offset0:2 offset1:3
  ds_read_b32 v116, v104 offset:16
  ds_read2_b32 v[118:119], v105 offset0:0 offset1:1
  ds_read2_b32 v[120:121], v105 offset0:2 offset1:3
  ds_read_b32 v122, v105 offset:16
  ds_read2_b32 v[124:125], v106 offset0:0 offset1:1
  ds_read2_b32 v[126:127], v106 offset0:2 offset1:3
  ds_read_b32 v128, v106 offset:16
  ds_read2_b32 v[130:131], v107 offset0:0 offset1:1
  ds_read2_b32 v[132:133], v107 offset0:2 offset1:3
  ds_read_b32 v134, v107 offset:16
  s_waitcnt lgkmcnt(9)
  v_alignbyte_b32 v16, v113, v112, v15
  v_alignbyte_b32 v17, v114, v113, v15
  v_alignbyte_b32 v18, v115, v114, v15
  v_alignbyte_b32 v19, v116, v115, v15
  ds_read2_b32 v[112:113], v108 offset0:0 offset1:1
  ds_read2_b32 v[114:115], v108 offset0:2 offset1:3
  ds_read_b32 v116, v108 offset:16
  s_waitcnt lgkmcnt(9)
  v_alignbyte_b32 v20, v119, v118, v15
  v_alignbyte_b32 v21, v120, v119, v15
  v_alignbyte_b32 v22, v121, v120, v15
  v_alignbyte_b32 v23, v122, v121, v15
  ds_read2_b32 v[118:119], v109 offset0:0 offset1:1
  ds_read2_b32 v[120:121], v109 offset0:2 offset1:3
  ds_read_b32 v122, v109 offset:16
  v_mfma_f32_16x16x32_bf16 a[16:19], v[16:19], v[48:51], a[16:19]
  s_waitcnt lgkmcnt(9)
  v_alignbyte_b32 v24, v125, v124, v15
  v_alignbyte_b32 v25, v126, v125, v15
  v_alignbyte_b32 v26, v127, v126, v15
  v_alignbyte_b32 v27, v128, v127, v15
  ds_read2_b32 v[124:125], v110 offset0:0 offset1:1
  ds_read2_b32 v[126:127], v110 offset0:2 offset1:3
  ds_read_b32 v128, v110 offset:16
  v_mfma_f32_16x16x32_bf16 a[48:51], v[20:23], v[52:55], a[48:51]
  s_waitcnt lgkmcnt(9)
  v_alignbyte_b32 v28, v131, v130, v15
  v_alignbyte_b32 v29, v132, v131, v15
  v_alignbyte_b32 v30, v133, v132, v15
  v_alignbyte_b32 v31, v134, v133, v15
  ds_read2_b32 v[130:131], v111 offset0:0 offset1:1
  ds_read2_b32 v[132:133], v111 offset0:2 offset1:3
  ds_read_b32 v134, v111 offset:16
  v_mfma_f32_16x16x32_bf16 a[80:83], v[24:27], v[56:59], a[80:83]
  s_waitcnt lgkmcnt(9)
  v_alignbyte_b32 v32, v113, v112, v15
  v_alignbyte_b32 v33, v114, v113, v15
  v_alignbyte_b32 v34, v115, v114, v15
  v_alignbyte_b32 v35, v116, v115, v15
  ds_read_b64 v[84:85], v8
  ds_read_b64 v[86:87], v9
  v_mfma_f32_16x16x32_bf16 a[112:115], v[28:31], v[60:63], a[112:115]
  s_waitcnt lgkmcnt(8)
  v_alignbyte_b32 v36, v119, v118, v15
  v_alignbyte_b32 v37, v120, v119, v15
  v_alignbyte_b32 v38, v121, v120, v15
  v_alignbyte_b32 v39, v122, v121, v15
  v_mfma_f32_16x16x32_bf16 a[144:147], v[32:35], v[64:67], a[144:147]
  s_waitcnt lgkmcnt(5)
  v_alignbyte_b32 v40, v125, v124, v15
  v_alignbyte_b32 v41, v126, v125, v15
  v_alignbyte_b32 v42, v127, v126, v15
  v_alignbyte_b32 v43, v128, v127, v15
  v_mfma_f32_16x16x32_bf16 a[176:179], v[36:39], v[68:71], a[176:179]
  s_waitcnt lgkmcnt(2)
  v_alignbyte_b32 v44, v131, v130, v15
  v_alignbyte_b32 v45, v132, v131, v15
  v_alignbyte_b32 v46, v133, v132, v15
  v_alignbyte_b32 v47, v134, v133, v15
  v_mfma_f32_16x16x32_bf16 a[208:211], v[40:43], v[72:75], a[208:211]
  s_nop 0
  v_mfma_f32_16x16x32_bf16 a[240:243], v[44:47], v[76:79], a[240:243]
  s_waitcnt lgkmcnt(0)
  ds_read_b128 v[48:51], v4 offset:1024
  ds_read_b128 v[52:55], v4 offset:5632
  ds_read_b128 v[56:59], v4 offset:10240
  ds_read_b128 v[60:63], v4 offset:14848
  ds_read_b128 v[64:67], v4 offset:19456
  ds_read_b128 v[68:71], v4 offset:24064
  ds_read_b128 v[72:75], v4 offset:28672
  ds_read_b128 v[76:79], v4 offset:33280
  s_mov_b32 exec_lo, s42
  s_mov_b32 exec_hi, s42
  ds_write_b128 v6, a[16:19] offset:0
  ds_write_b128 v6, a[48:51] offset:128
  ds_write_b128 v6, a[80:83] offset:256
  ds_write_b128 v6, a[112:115] offset:384
  ds_write_b128 v6, a[144:147] offset:512
  ds_write_b128 v6, a[176:179] offset:640
  ds_write_b128 v6, a[208:211] offset:768
  ds_write_b128 v6, a[240:243] offset:896
  s_mov_b64 exec, -1
  ds_read_b128 v[80:83], v7
  ds_write_b32 v14, v13 offset:8
  v_lshlrev_b32 v88, 16, v84
  v_and_b32 v89, 0xffff0000, v84
  v_lshlrev_b32 v90, 16, v85
  v_and_b32 v91, 0xffff0000, v85
  v_lshlrev_b32 v96, 16, v86
  v_and_b32 v97, 0xffff0000, v86
  v_lshlrev_b32 v98, 16, v87
  v_and_b32 v99, 0xffff0000, v87
  v_mul_f32 v92, v88, v12
  v_mul_f32 v93, v89, v12
  v_mul_f32 v94, v90, v12
  v_mul_f32 v95, v91, v12
  v_cvt_pk_bf16_f32 v84, v92, v93
  v_cvt_pk_bf16_f32 v85, v94, v95
  v_lshlrev_b32 v92, 16, v84
  v_and_b32 v93, 0xffff0000, v84
  v_lshlrev_b32 v94, 16, v85
  v_and_b32 v95, 0xffff0000, v85
  s_waitcnt lgkmcnt(1)
  v_fmac_f32 v80, v88, v11
  v_fmac_f32 v81, v89, v11
  v_fmac_f32 v82, v90, v11
  v_fmac_f32 v83, v91, v11
  v_cvt_pk_bf16_f32 v84, v80, v81
  v_cvt_pk_bf16_f32 v85, v82, v83
  v_lshlrev_b32 v80, 16, v84
  v_and_b32 v81, 0xffff0000, v84
  v_lshlrev_b32 v82, 16, v85
  v_and_b32 v83, 0xffff0000, v85
  v_add_f32 v80, v80, v92
  v_add_f32 v81, v81, v93
  v_add_f32 v82, v82, v94
  v_add_f32 v83, v83, v95
  v_cvt_pk_bf16_f32 v84, v80, v81
  v_cvt_pk_bf16_f32 v85, v82, v83
  v_lshlrev_b32 v80, 16, v84
  v_and_b32 v81, 0xffff0000, v84
  v_lshlrev_b32 v82, 16, v85
  v_and_b32 v83, 0xffff0000, v85
  v_add_f32 v80, v80, v96
  v_add_f32 v81, v81, v97
  v_add_f32 v82, v82, v98
  v_add_f32 v83, v83, v99
  v_cvt_pk_bf16_f32 v84, v80, v81
  v_cvt_pk_bf16_f32 v85, v82, v83
  buffer_store_dwordx2 v[84:85], v10, s[8:11], s40 offen sc1
  v_mfma_f32_16x16x32_bf16 a[20:23], v[16:19], v[48:51], a[20:23]
  ds_read_b128 v[48:51], v4 offset:512
  v_mfma_f32_16x16x32_bf16 a[52:55], v[20:23], v[52:55], a[52:55]
  ds_read_b128 v[52:55], v4 offset:5120
  v_mfma_f32_16x16x32_bf16 a[84:87], v[24:27], v[56:59], a[84:87]
  ds_read_b128 v[56:59], v4 offset:9728
  v_mfma_f32_16x16x32_bf16 a[116:119], v[28:31], v[60:63], a[116:119]
  ds_read_b128 v[60:63], v4 offset:14336
  v_mfma_f32_16x16x32_bf16 a[148:151], v[32:35], v[64:67], a[148:151]
  ds_read_b128 v[64:67], v4 offset:18944
  v_mfma_f32_16x16x32_bf16 a[180:183], v[36:39], v[68:71], a[180:183]
  ds_read_b128 v[68:71], v4 offset:23552
  v_mfma_f32_16x16x32_bf16 a[212:215], v[40:43], v[72:75], a[212:215]
  ds_read_b128 v[72:75], v4 offset:28160
  v_mfma_f32_16x16x32_bf16 a[244:247], v[44:47], v[76:79], a[244:247]
  ds_read_b128 v[76:79], v4 offset:32768
  s_waitcnt lgkmcnt(7)
  v_mfma_f32_16x16x32_bf16 a[24:27], v[16:19], v[48:51], a[24:27]
  ds_read_b128 v[48:51], v4 offset:0
  s_waitcnt lgkmcnt(7)
  v_mfma_f32_16x16x32_bf16 a[56:59], v[20:23], v[52:55], a[56:59]
  ds_read_b128 v[52:55], v4 offset:4608
  s_waitcnt lgkmcnt(7)
  v_mfma_f32_16x16x32_bf16 a[88:91], v[24:27], v[56:59], a[88:91]
  ds_read_b128 v[56:59], v4 offset:9216
  s_waitcnt lgkmcnt(7)
  v_mfma_f32_16x16x32_bf16 a[120:123], v[28:31], v[60:63], a[120:123]
  ds_read_b128 v[60:63], v4 offset:13824
  s_waitcnt lgkmcnt(7)
  v_mfma_f32_16x16x32_bf16 a[152:155], v[32:35], v[64:67], a[152:155]
  ds_read_b128 v[64:67], v4 offset:18432
  s_waitcnt lgkmcnt(7)
  v_mfma_f32_16x16x32_bf16 a[184:187], v[36:39], v[68:71], a[184:187]
  ds_read_b128 v[68:71], v4 offset:23040
  s_waitcnt lgkmcnt(7)
  v_mfma_f32_16x16x32_bf16 a[216:219], v[40:43], v[72:75], a[216:219]
  ds_read_b128 v[72:75], v4 offset:27648
  s_waitcnt lgkmcnt(7)
  v_mfma_f32_16x16x32_bf16 a[248:251], v[44:47], v[76:79], a[248:251]
  ds_read_b128 v[76:79], v4 offset:32256
  s_waitcnt lgkmcnt(7)
  v_mfma_f32_16x16x32_bf16 a[28:31], v[16:19], v[48:51], a[28:31]
  s_waitcnt lgkmcnt(6)
  v_mfma_f32_16x16x32_bf16 a[60:63], v[20:23], v[52:55], a[60:63]
  s_waitcnt lgkmcnt(5)
  v_mfma_f32_16x16x32_bf16 a[92:95], v[24:27], v[56:59], a[92:95]
  s_waitcnt lgkmcnt(4)
  v_mfma_f32_16x16x32_bf16 a[124:127], v[28:31], v[60:63], a[124:127]
  s_waitcnt lgkmcnt(3)
  v_mfma_f32_16x16x32_bf16 a[156:159], v[32:35], v[64:67], a[156:159]
  s_waitcnt lgkmcnt(2)
  v_mfma_f32_16x16x32_bf16 a[188:191], v[36:39], v[68:71], a[188:191]
  s_waitcnt lgkmcnt(1)
  v_mfma_f32_16x16x32_bf16 a[220:223], v[40:43], v[72:75], a[220:223]
  s_waitcnt lgkmcnt(0)
  v_mfma_f32_16x16x32_bf16 a[252:255], v[44:47], v[76:79], a[252:255]
  v_add_u32 v104, 64, v104
  v_add_u32 v105, 64, v105
  v_add_u32 v106, 64, v106
  v_add_u32 v107, 64, v107
  v_add_u32 v108, 64, v108
  v_add_u32 v109, 64, v109
  v_add_u32 v110, 64, v110
  v_add_u32 v111, 64, v111
  v_add_u32 v4, 64, v4
  v_add_u32 v8, 64, v8
  s_add_u32 s40, s40, 0x8000
  s_waitcnt vmcnt(0)
  s_mov_b64 exec, 1
  buffer_store_dword v13, v1, s[8:11], s39 offen sc1
  s_mov_b64 exec, -1
  ds_write_b32 v14, v13 offset:16
  s_add_u32 s32, s32, 1
  s_and_b32 s6, s32, 7
  s_cbranch_scc1 L_c_conv4
L_c_conv5:
  s_add_u32 s33, s32, 1
  s_and_b32 s6, s32, 7
  s_lshl_b32 s7, s6, 10
  s_add_u32 s7, s7, s35
  v_add_u32 v9, s7, v10
  s_lshl_b32 s6, s6, 1
  s_lshl_b32 s42, 0x30003, s6
  v_mov_b32 v13, s33
  ds_read_b128 v[48:51], v4 offset:1024
  ds_read_b128 v[52:55], v4 offset:5632
  ds_read_b128 v[56:59], v4 offset:10240
  ds_read_b128 v[60:63], v4 offset:14848
  ds_read_b128 v[64:67], v4 offset:19456
  ds_read_b128 v[68:71], v4 offset:24064
  ds_read_b128 v[72:75], v4 offset:28672
  ds_read_b128 v[76:79], v4 offset:33280
  s_mov_b32 s7, 0
L_lw_126:
  ds_read_b32 v88, v2 offset:0
  s_waitcnt lgkmcnt(0)
  v_cmp_gt_i32 vcc, s33, v88
  s_cbranch_vccz L_lwo_127
  s_add_u32 s7, s7, 1
  s_cmp_lt_u32 s7, 131072
  s_cbranch_scc1 L_lw_126
  s_mov_b32 s6, 42
  s_branch L_err
L_lwo_127:
  ds_read2_b32 v[112:113], v104 offset0:0 offset1:1
  ds_read2_b32 v[114:115], v104 offset0:2 offset1:3
  ds_read_b32 v116, v104 offset:16
  ds_read2_b32 v[118:119], v105 offset0:0 offset1:1
  ds_read2_b32 v[120:121], v105 offset0:2 offset1:3
  ds_read_b32 v122, v105 offset:16
  ds_read2_b32 v[124:125], v106 offset0:0 offset1:1
  ds_read2_b32 v[126:127], v106 offset0:2 offset1:3
  ds_read_b32 v128, v106 offset:16
  ds_read2_b32 v[130:131], v107 offset0:0 offset1:1
  ds_read2_b32 v[132:133], v107 offset0:2 offset1:3
  ds_read_b32 v134, v107 offset:16
  s_waitcnt lgkmcnt(9)
  v_alignbyte_b32 v16, v113, v112, v15
  v_alignbyte_b32 v17, v114, v113, v15
  v_alignbyte_b32 v18, v115, v114, v15
  v_alignbyte_b32 v19, v116, v115, v15
  ds_read2_b32 v[112:113], v108 offset0:0 offset1:1
  ds_read2_b32 v[114:115], v108 offset0:2 offset1:3
  ds_read_b32 v116, v108 offset:16
  s_waitcnt lgkmcnt(9)
  v_alignbyte_b32 v20, v119, v118, v15
  v_alignbyte_b32 v21, v120, v119, v15
  v_alignbyte_b32 v22, v121, v120, v15
  v_alignbyte_b32 v23, v122, v121, v15
  ds_read2_b32 v[118:119], v109 offset0:0 offset1:1
  ds_read2_b32 v[120:121], v109 offset0:2 offset1:3
  ds_read_b32 v122, v109 offset:16
  v_mfma_f32_16x16x32_bf16 a[20:23], v[16:19], v[48:51], a[20:23]
  s_waitcnt lgkmcnt(9)
  v_alignbyte_b32 v24, v125, v124, v15
  v_alignbyte_b32 v25, v126, v125, v15
  v_alignbyte_b32 v26, v127, v126, v15
  v_alignbyte_b32 v27, v128, v127, v15
  ds_read2_b32 v[124:125], v110 offset0:0 offset1:1
  ds_read2_b32 v[126:127], v110 offset0:2 offset1:3
  ds_read_b32 v128, v110 offset:16
  v_mfma_f32_16x16x32_bf16 a[52:55], v[20:23], v[52:55], a[52:55]
  s_waitcnt lgkmcnt(9)
  v_alignbyte_b32 v28, v131, v130, v15
  v_alignbyte_b32 v29, v132, v131, v15
  v_alignbyte_b32 v30, v133, v132, v15
  v_alignbyte_b32 v31, v134, v133, v15
  ds_read2_b32 v[130:131], v111 offset0:0 offset1:1
  ds_read2_b32 v[132:133], v111 offset0:2 offset1:3
  ds_read_b32 v134, v111 offset:16
  v_mfma_f32_16x16x32_bf16 a[84:87], v[24:27], v[56:59], a[84:87]
  s_waitcnt lgkmcnt(9)
  v_alignbyte_b32 v32, v113, v112, v15
  v_alignbyte_b32 v33, v114, v113, v15
  v_alignbyte_b32 v34, v115, v114, v15
  v_alignbyte_b32 v35, v116, v115, v15
  ds_read_b64 v[84:85], v8
  ds_read_b64 v[86:87], v9
  v_mfma_f32_16x16x32_bf16 a[116:119], v[28:31], v[60:63], a[116:119]
  s_waitcnt lgkmcnt(8)
  v_alignbyte_b32 v36, v119, v118, v15
  v_alignbyte_b32 v37, v120, v119, v15
  v_alignbyte_b32 v38, v121, v120, v15
  v_alignbyte_b32 v39, v122, v121, v15
  v_mfma_f32_16x16x32_bf16 a[148:151], v[32:35], v[64:67], a[148:151]
  s_waitcnt lgkmcnt(5)
  v_alignbyte_b32 v40, v125, v124, v15
  v_alignbyte_b32 v41, v126, v125, v15
  v_alignbyte_b32 v42, v127, v126, v15
  v_alignbyte_b32 v43, v128, v127, v15
  v_mfma_f32_16x16x32_bf16 a[180:183], v[36:39], v[68:71], a[180:183]
  s_waitcnt lgkmcnt(2)
  v_alignbyte_b32 v44, v131, v130, v15
  v_alignbyte_b32 v45, v132, v131, v15
  v_alignbyte_b32 v46, v133, v132, v15
  v_alignbyte_b32 v47, v134, v133, v15
  v_mfma_f32_16x16x32_bf16 a[212:215], v[40:43], v[72:75], a[212:215]
  s_nop 0
  v_mfma_f32_16x16x32_bf16 a[244:247], v[44:47], v[76:79], a[244:247]
  s_waitcnt lgkmcnt(0)
  ds_read_b128 v[48:51], v4 offset:512
  ds_read_b128 v[52:55], v4 offset:5120
  ds_read_b128 v[56:59], v4 offset:9728
  ds_read_b128 v[60:63], v4 offset:14336
  ds_read_b128 v[64:67], v4 offset:18944
  ds_read_b128 v[68:71], v4 offset:23552
  ds_read_b128 v[72:75], v4 offset:28160
  ds_read_b128 v[76:79], v4 offset:32768
  s_mov_b32 exec_lo, s42
  s_mov_b32 exec_hi, s42
  ds_write_b128 v6, a[20:23] offset:0
  ds_write_b128 v6, a[52:55] offset:128
  ds_write_b128 v6, a[84:87] offset:256
  ds_write_b128 v6, a[116:119] offset:384
  ds_write_b128 v6, a[148:151] offset:512
  ds_write_b128 v6, a[180:183] offset:640
  ds_write_b128 v6, a[212:215] offset:768
  ds_write_b128 v6, a[244:247] offset:896
  s_mov_b64 exec, -1
  ds_read_b128 v[80:83], v7
  ds_write_b32 v14, v13 offset:8
  v_lshlrev_b32 v88, 16, v84
  v_and_b32 v89, 0xffff0000, v84
  v_lshlrev_b32 v90, 16, v85
  v_and_b32 v91, 0xffff0000, v85
  v_lshlrev_b32 v96, 16, v86
  v_and_b32 v97, 0xffff0000, v86
  v_lshlrev_b32 v98, 16, v87
  v_and_b32 v99, 0xffff0000, v87
  v_mul_f32 v92, v88, v12
  v_mul_f32 v93, v89, v12
  v_mul_f32 v94, v90, v12
  v_mul_f32 v95, v91, v12
  v_cvt_pk_bf16_f32 v84, v92, v93
  v_cvt_pk_bf16_f32 v85, v94, v95
  v_lshlrev_b32 v92, 16, v84
  v_and_b32 v93, 0xffff0000, v84
  v_lshlrev_b32 v94, 16, v85
  v_and_b32 v95, 0xffff0000, v85
  s_waitcnt lgkmcnt(1)
  v_fmac_f32 v80, v88, v11
  v_fmac_f32 v81, v89, v11
  v_fmac_f32 v82, v90, v11
  v_fmac_f32 v83, v91, v11
  v_cvt_pk_bf16_f32 v84, v80, v81
  v_cvt_pk_bf16_f32 v85, v82, v83
  v_lshlrev_b32 v80, 16, v84
  v_and_b32 v81, 0xffff0000, v84
  v_lshlrev_b32 v82, 16, v85
  v_and_b32 v83, 0xffff0000, v85
  v_add_f32 v80, v80, v92
  v_add_f32 v81, v81, v93
  v_add_f32 v82, v82, v94
  v_add_f32 v83, v83, v95
  v_cvt_pk_bf16_f32 v84, v80, v81
  v_cvt_pk_bf16_f32 v85, v82, v83
  v_lshlrev_b32 v80, 16, v84
  v_and_b32 v81, 0xffff0000, v84
  v_lshlrev_b32 v82, 16, v85
  v_and_b32 v83, 0xffff0000, v85
  v_add_f32 v80, v80, v96
  v_add_f32 v81, v81, v97
  v_add_f32 v82, v82, v98
  v_add_f32 v83, v83, v99
  v_cvt_pk_bf16_f32 v84, v80, v81
  v_cvt_pk_bf16_f32 v85, v82, v83
  buffer_store_dwordx2 v[84:85], v10, s[8:11], s40 offen sc1
  v_mfma_f32_16x16x32_bf16 a[24:27], v[16:19], v[48:51], a[24:27]
  ds_read_b128 v[48:51], v4 offset:0
  v_mfma_f32_16x16x32_bf16 a[56:59], v[20:23], v[52:55], a[56:59]
  ds_read_b128 v[52:55], v4 offset:4608
  v_mfma_f32_16x16x32_bf16 a[88:91], v[24:27], v[56:59], a[88:91]
  ds_read_b128 v[56:59], v4 offset:9216
  v_mfma_f32_16x16x32_bf16 a[120:123], v[28:31], v[60:63], a[120:123]
  ds_read_b128 v[60:63], v4 offset:13824
  v_mfma_f32_16x16x32_bf16 a[152:155], v[32:35], v[64:67], a[152:155]
  ds_read_b128 v[64:67], v4 offset:18432
  v_mfma_f32_16x16x32_bf16 a[184:187], v[36:39], v[68:71], a[184:187]
  ds_read_b128 v[68:71], v4 offset:23040
  v_mfma_f32_16x16x32_bf16 a[216:219], v[40:43], v[72:75], a[216:219]
  ds_read_b128 v[72:75], v4 offset:27648
  v_mfma_f32_16x16x32_bf16 a[248:251], v[44:47], v[76:79], a[248:251]
  ds_read_b128 v[76:79], v4 offset:32256
  s_waitcnt lgkmcnt(7)
  v_mfma_f32_16x16x32_bf16 a[28:31], v[16:19], v[48:51], a[28:31]
  s_waitcnt lgkmcnt(6)
  v_mfma_f32_16x16x32_bf16 a[60:63], v[20:23], v[52:55], a[60:63]
  s_waitcnt lgkmcnt(5)
  v_mfma_f32_16x16x32_bf16 a[92:95], v[24:27], v[56:59], a[92:95]
  s_waitcnt lgkmcnt(4)
  v_mfma_f32_16x16x32_bf16 a[124:127], v[28:31], v[60:63], a[124:127]
  s_waitcnt lgkmcnt(3)
  v_mfma_f32_16x16x32_bf16 a[156:159], v[32:35], v[64:67], a[156:159]
  s_waitcnt lgkmcnt(2)
  v_mfma_f32_16x16x32_bf16 a[188:191], v[36:39], v[68:71], a[188:191]
  s_waitcnt lgkmcnt(1)
  v_mfma_f32_16x16x32_bf16 a[220:223], v[40:43], v[72:75], a[220:223]
  s_waitcnt lgkmcnt(0)
  v_mfma_f32_16x16x32_bf16 a[252:255], v[44:47], v[76:79], a[252:255]
  v_add_u32 v104, 64, v104
  v_add_u32 v105, 64, v105
  v_add_u32 v106, 64, v106
  v_add_u32 v107, 64, v107
  v_add_u32 v108, 64, v108
  v_add_u32 v109, 64, v109
  v_add_u32 v110, 64, v110
  v_add_u32 v111, 64, v111
  v_add_u32 v4, 64, v4
  v_add_u32 v8, 64, v8
  s_add_u32 s40, s40, 0x8000
  s_waitcnt vmcnt(0)
  s_mov_b64 exec, 1
  buffer_store_dword v13, v1, s[8:11], s39 offen sc1
  s_mov_b64 exec, -1
  ds_write_b32 v14, v13 offset:16
  s_add_u32 s32, s32, 1
  s_and_b32 s6, s32, 7
  s_cbranch_scc1 L_c_conv5
L_c_conv6:
  s_add_u32 s33, s32, 1
  s_and_b32 s6, s32, 7
  s_lshl_b32 s7, s6, 10
  s_add_u32 s7, s7, s35
  v_add_u32 v9, s7, v10
  s_lshl_b32 s6, s6, 1
  s_lshl_b32 s42, 0x30003, s6
  v_mov_b32 v13, s33
  ds_read_b128 v[48:51], v4 offset:512
  ds_read_b128 v[52:55], v4 offset:5120
  ds_read_b128 v[56:59], v4 offset:9728
  ds_read_b128 v[60:63], v4 offset:14336
  ds_read_b128 v[64:67], v4 offset:18944
  ds_read_b128 v[68:71], v4 offset:23552
  ds_read_b128 v[72:75], v4 offset:28160
  ds_read_b128 v[76:79], v4 offset:32768
  s_mov_b32 s7, 0
L_lw_128:
  ds_read_b32 v88, v2 offset:0
  s_waitcnt lgkmcnt(0)
  v_cmp_gt_i32 vcc, s33, v88
  s_cbranch_vccz L_lwo_129
  s_add_u32 s7, s7, 1
  s_cmp_lt_u32 s7, 131072
  s_cbranch_scc1 L_lw_128
  s_mov_b32 s6, 42
  s_branch L_err
L_lwo_129:
  ds_read2_b32 v[112:113], v104 offset0:0 offset1:1
  ds_read2_b32 v[114:115], v104 offset0:2 offset1:3
  ds_read_b32 v116, v104 offset:16
  ds_read2_b32 v[118:119], v105 offset0:0 offset1:1
  ds_read2_b32 v[120:121], v105 offset0:2 offset1:3
  ds_read_b32 v122, v105 offset:16
  ds_read2_b32 v[124:125], v106 offset0:0 offset1:1
  ds_read2_b32 v[126:127], v106 offset0:2 offset1:3
  ds_read_b32 v128, v106 offset:16
  ds_read2_b32 v[130:131], v107 offset0:0 offset1:1
  ds_read2_b32 v[132:133], v107 offset0:2 offset1:3
  ds_read_b32 v134, v107 offset:16
  s_waitcnt lgkmcnt(9)
  v_alignbyte_b32 v16, v113, v112, v15
  v_alignbyte_b32 v17, v114, v113, v15
  v_alignbyte_b32 v18, v115, v114, v15
  v_alignbyte_b32 v19, v116, v115, v15
  ds_read2_b32 v[112:113], v108 offset0:0 offset1:1
  ds_read2_b32 v[114:115], v108 offset0:2 offset1:3
  ds_read_b32 v116, v108 offset:16
  s_waitcnt lgkmcnt(9)
  v_alignbyte_b32 v20, v119, v118, v15
  v_alignbyte_b32 v21, v120, v119, v15
  v_alignbyte_b32 v22, v121, v120, v15
  v_alignbyte_b32 v23, v122, v121, v15
  ds_read2_b32 v[118:119], v109 offset0:0 offset1:1
  ds_read2_b32 v[120:121], v109 offset0:2 offset1:3
  ds_read_b32 v122, v109 offset:16
  v_mfma_f32_16x16x32_bf16 a[24:27], v[16:19], v[48:51], a[24:27]
  s_waitcnt lgkmcnt(9)
  v_alignbyte_b32 v24, v125, v124, v15
  v_alignbyte_b32 v25, v126, v125, v15
  v_alignbyte_b32 v26, v127, v126, v15
  v_alignbyte_b32 v27, v128, v127, v15
  ds_read2_b32 v[124:125], v110 offset0:0 offset1:1
  ds_read2_b32 v[126:127], v110 offset0:2 offset1:3
  ds_read_b32 v128, v110 offset:16
  v_mfma_f32_16x16x32_bf16 a[56:59], v[20:23], v[52:55], a[56:59]
  s_waitcnt lgkmcnt(9)
  v_alignbyte_b32 v28, v131, v130, v15
  v_alignbyte_b32 v29, v132, v131, v15
  v_alignbyte_b32 v30, v133, v132, v15
  v_alignbyte_b32 v31, v134, v133, v15
  ds_read2_b32 v[130:131], v111 offset0:0 offset1:1
  ds_read2_b32 v[132:133], v111 offset0:2 offset1:3
  ds_read_b32 v134, v111 offset:16
  v_mfma_f32_16x16x32_bf16 a[88:91], v[24:27], v[56:59], a[88:91]
  s_waitcnt lgkmcnt(9)
  v_alignbyte_b32 v32, v113, v112, v15
  v_alignbyte_b32 v33, v114, v113, v15
  v_alignbyte_b32 v34, v115, v114, v15
  v_alignbyte_b32 v35, v116, v115, v15
  ds_read_b64 v[84:85], v8
  ds_read_b64 v[86:87], v9
  v_mfma_f32_16x16x32_bf16 a[120:123], v[28:31], v[60:63], a[120:123]
  s_waitcnt lgkmcnt(8)
  v_alignbyte_b32 v36, v119, v118, v15
  v_alignbyte_b32 v37, v120, v119, v15
  v_alignbyte_b32 v38, v121, v120, v15
  v_alignbyte_b32 v39, v122, v121, v15
  v_mfma_f32_16x16x32_bf16 a[152:155], v[32:35], v[64:67], a[152:155]
  s_waitcnt lgkmcnt(5)
  v_alignbyte_b32 v40, v125, v124, v15
  v_alignbyte_b32 v41, v126, v125, v15
  v_alignbyte_b32 v42, v127, v126, v15
  v_alignbyte_b32 v43, v128, v127, v15
  v_mfma_f32_16x16x32_bf16 a[184:187], v[36:39], v[68:71], a[184:187]
  s_waitcnt lgkmcnt(2)
  v_alignbyte_b32 v44, v131, v130, v15
  v_alignbyte_b32 v45, v132, v131, v15
  v_alignbyte_b32 v46, v133, v132, v15
  v_alignbyte_b32 v47, v134, v133, v15
  v_mfma_f32_16x16x32_bf16 a[216:219], v[40:43], v[72:75], a[216:219]
  s_nop 0
  v_mfma_f32_16x16x32_bf16 a[248:251], v[44:47], v[76:79], a[248:251]
  s_waitcnt lgkmcnt(0)
  ds_read_b128 v[48:51], v4 offset:0
  ds_read_b128 v[52:55], v4 offset:4608
  ds_read_b128 v[56:59], v4 offset:9216
  ds_read_b128 v[60:63], v4 offset:13824
  ds_read_b128 v[64:67], v4 offset:18432
  ds_read_b128 v[68:71], v4 offset:23040
  ds_read_b128 v[72:75], v4 offset:27648
  ds_read_b128 v[76:79], v4 offset:32256
  s_mov_b32 exec_lo, s42
  s_mov_b32 exec_hi, s42
  ds_write_b128 v6, a[24:27] offset:0
  ds_write_b128 v6, a[56:59] offset:128
  ds_write_b128 v6, a[88:91] offset:256
  ds_write_b128 v6, a[120:123] offset:384
  ds_write_b128 v6, a[152:155] offset:512
  ds_write_b128 v6, a[184:187] offset:640
  ds_write_b128 v6, a[216:219] offset:768
  ds_write_b128 v6, a[248:251] offset:896
  s_mov_b64 exec, -1
  ds_read_b128 v[80:83], v7
  ds_write_b32 v14, v13 offset:8
  v_lshlrev_b32 v88, 16, v84
  v_and_b32 v89, 0xffff0000, v84
  v_lshlrev_b32 v90, 16, v85
  v_and_b32 v91, 0xffff0000, v85
  v_lshlrev_b32 v96, 16, v86
  v_and_b32 v97, 0xffff0000, v86
  v_lshlrev_b32 v98, 16, v87
  v_and_b32 v99, 0xffff0000, v87
  v_mul_f32 v92, v88, v12
  v_mul_f32 v93, v89, v12
  v_mul_f32 v94, v90, v12
  v_mul_f32 v95, v91, v12
  v_cvt_pk_bf16_f32 v84, v92, v93
  v_cvt_pk_bf16_f32 v85, v94, v95
  v_lshlrev_b32 v92, 16, v84
  v_and_b32 v93, 0xffff0000, v84
  v_lshlrev_b32 v94, 16, v85
  v_and_b32 v95, 0xffff0000, v85
  s_waitcnt lgkmcnt(1)
  v_fmac_f32 v80, v88, v11
  v_fmac_f32 v81, v89, v11
  v_fmac_f32 v82, v90, v11
  v_fmac_f32 v83, v91, v11
  v_cvt_pk_bf16_f32 v84, v80, v81
  v_cvt_pk_bf16_f32 v85, v82, v83
  v_lshlrev_b32 v80, 16, v84
  v_and_b32 v81, 0xffff0000, v84
  v_lshlrev_b32 v82, 16, v85
  v_and_b32 v83, 0xffff0000, v85
  v_add_f32 v80, v80, v92
  v_add_f32 v81, v81, v93
  v_add_f32 v82, v82, v94
  v_add_f32 v83, v83, v95
  v_cvt_pk_bf16_f32 v84, v80, v81
  v_cvt_pk_bf16_f32 v85, v82, v83
  v_lshlrev_b32 v80, 16, v84
  v_and_b32 v81, 0xffff0000, v84
  v_lshlrev_b32 v82, 16, v85
  v_and_b32 v83, 0xffff0000, v85
  v_add_f32 v80, v80, v96
  v_add_f32 v81, v81, v97
  v_add_f32 v82, v82, v98
  v_add_f32 v83, v83, v99
  v_cvt_pk_bf16_f32 v84, v80, v81
  v_cvt_pk_bf16_f32 v85, v82, v83
  buffer_store_dwordx2 v[84:85], v10, s[8:11], s40 offen sc1
  v_mfma_f32_16x16x32_bf16 a[28:31], v[16:19], v[48:51], a[28:31]
  v_mfma_f32_16x16x32_bf16 a[60:63], v[20:23], v[52:55], a[60:63]
  v_mfma_f32_16x16x32_bf16 a[92:95], v[24:27], v[56:59], a[92:95]
  v_mfma_f32_16x16x32_bf16 a[124:127], v[28:31], v[60:63], a[124:127]
  v_mfma_f32_16x16x32_bf16 a[156:159], v[32:35], v[64:67], a[156:159]
  v_mfma_f32_16x16x32_bf16 a[188:191], v[36:39], v[68:71], a[188:191]
  v_mfma_f32_16x16x32_bf16 a[220:223], v[40:43], v[72:75], a[220:223]
  v_mfma_f32_16x16x32_bf16 a[252:255], v[44:47], v[76:79], a[252:255]
  v_add_u32 v104, 64, v104
  v_add_u32 v105, 64, v105
  v_add_u32 v106, 64, v106
  v_add_u32 v107, 64, v107
  v_add_u32 v108, 64, v108
  v_add_u32 v109, 64, v109
  v_add_u32 v110, 64, v110
  v_add_u32 v111, 64, v111
  v_add_u32 v4, 64, v4
  v_add_u32 v8, 64, v8
  s_add_u32 s40, s40, 0x8000
  s_waitcnt vmcnt(0)
  s_mov_b64 exec, 1
  buffer_store_dword v13, v1, s[8:11], s39 offen sc1
  s_mov_b64 exec, -1
  ds_write_b32 v14, v13 offset:16
  s_add_u32 s32, s32, 1
  s_and_b32 s6, s32, 7
  s_cbranch_scc1 L_c_conv6
L_c_conv7:
  s_add_u32 s33, s32, 1
  s_and_b32 s6, s32, 7
  s_lshl_b32 s7, s6, 10
  s_add_u32 s7, s7, s35
  v_add_u32 v9, s7, v10
  s_lshl_b32 s6, s6, 1
  s_lshl_b32 s42, 0x30003, s6
  v_mov_b32 v13, s33
  ds_read_b128 v[48:51], v4 offset:0
  ds_read_b128 v[52:55], v4 offset:4608
  ds_read_b128 v[56:59], v4 offset:9216
  ds_read_b128 v[60:63], v4 offset:13824
  ds_read_b128 v[64:67], v4 offset:18432
  ds_read_b128 v[68:71], v4 offset:23040
  ds_read_b128 v[72:75], v4 offset:27648
  ds_read_b128 v[76:79], v4 offset:32256
  s_mov_b32 s7, 0
L_lw_130:
  ds_read_b32 v88, v2 offset:0
  s_waitcnt lgkmcnt(0)
  v_cmp_gt_i32 vcc, s33, v88
  s_cbranch_vccz L_lwo_131
  s_add_u32 s7, s7, 1
  s_cmp_lt_u32 s7, 131072
  s_cbranch_scc1 L_lw_130
  s_mov_b32 s6, 42
  s_branch L_err
L_lwo_131:
  ds_read2_b32 v[112:113], v104 offset0:0 offset1:1
  ds_read2_b32 v[114:115], v104 offset0:2 offset1:3
  ds_read_b32 v116, v104 offset:16
  ds_read2_b32 v[118:119], v105 offset0:0 offset1:1
  ds_read2_b32 v[120:121], v105 offset0:2 offset1:3
  ds_read_b32 v122, v105 offset:16
  ds_read2_b32 v[124:125], v106 offset0:0 offset1:1
  ds_read2_b32 v[126:127], v106 offset0:2 offset1:3
  ds_read_b32 v128, v106 offset:16
  ds_read2_b32 v[130:131], v107 offset0:0 offset1:1
  ds_read2_b32 v[132:133], v107 offset0:2 offset1:3
  ds_read_b32 v134, v107 offset:16
  s_waitcnt lgkmcnt(9)
  v_alignbyte_b32 v16, v113, v112, v15
  v_alignbyte_b32 v17, v114, v113, v15
  v_alignbyte_b32 v18, v115, v114, v15
  v_alignbyte_b32 v19, v116, v115, v15
  ds_read2_b32 v[112:113], v108 offset0:0 offset1:1
  ds_read2_b32 v[114:115], v108 offset0:2 offset1:3
  ds_read_b32 v116, v108 offset:16
  s_waitcnt lgkmcnt(9)
  v_alignbyte_b32 v20, v119, v118, v15
  v_alignbyte_b32 v21, v120, v119, v15
  v_alignbyte_b32 v22, v121, v120, v15
  v_alignbyte_b32 v23, v122, v121, v15
  ds_read2_b32 v[118:119], v109 offset0:0 offset1:1
  ds_read2_b32 v[120:121], v109 offset0:2 offset1:3
  ds_read_b32 v122, v109 offset:16
  v_mfma_f32_16x16x32_bf16 a[28:31], v[16:19], v[48:51], a[28:31]
  s_waitcnt lgkmcnt(9)
  v_alignbyte_b32 v24, v125, v124, v15
  v_alignbyte_b32 v25, v126, v125, v15
  v_alignbyte_b32 v26, v127, v126, v15
  v_alignbyte_b32 v27, v128, v127, v15
  ds_read2_b32 v[124:125], v110 offset0:0 offset1:1
  ds_read2_b32 v[126:127], v110 offset0:2 offset1:3
  ds_read_b32 v128, v110 offset:16
  v_mfma_f32_16x16x32_bf16 a[60:63], v[20:23], v[52:55], a[60:63]
  s_waitcnt lgkmcnt(9)
  v_alignbyte_b32 v28, v131, v130, v15
  v_alignbyte_b32 v29, v132, v131, v15
  v_alignbyte_b32 v30, v133, v132, v15
  v_alignbyte_b32 v31, v134, v133, v15
  ds_read2_b32 v[130:131], v111 offset0:0 offset1:1
  ds_read2_b32 v[132:133], v111 offset0:2 offset1:3
  ds_read_b32 v134, v111 offset:16
  v_mfma_f32_16x16x32_bf16 a[92:95], v[24:27], v[56:59], a[92:95]
  s_waitcnt lgkmcnt(9)
  v_alignbyte_b32 v32, v113, v112, v15
  v_alignbyte_b32 v33, v114, v113, v15
  v_alignbyte_b32 v34, v115, v114, v15
  v_alignbyte_b32 v35, v116, v115, v15
  ds_read_b64 v[84:85], v8
  ds_read_b64 v[86:87], v9
  v_mfma_f32_16x16x32_bf16 a[124:127], v[28:31], v[60:63], a[124:127]
  s_waitcnt lgkmcnt(8)
  v_alignbyte_b32 v36, v119, v118, v15
  v_alignbyte_b32 v37, v120, v119, v15
  v_alignbyte_b32 v38, v121, v120, v15
  v_alignbyte_b32 v39, v122, v121, v15
  v_mfma_f32_16x16x32_bf16 a[156:159], v[32:35], v[64:67], a[156:159]
  s_waitcnt lgkmcnt(5)
  v_alignbyte_b32 v40, v125, v124, v15
  v_alignbyte_b32 v41, v126, v125, v15
  v_alignbyte_b32 v42, v127, v126, v15
  v_alignbyte_b32 v43, v128, v127, v15
  v_mfma_f32_16x16x32_bf16 a[188:191], v[36:39], v[68:71], a[188:191]
  s_waitcnt lgkmcnt(2)
  v_alignbyte_b32 v44, v131, v130, v15
  v_alignbyte_b32 v45, v132, v131, v15
  v_alignbyte_b32 v46, v133, v132, v15
  v_alignbyte_b32 v47, v134, v133, v15
  v_mfma_f32_16x16x32_bf16 a[220:223], v[40:43], v[72:75], a[220:223]
  s_nop 0
  v_mfma_f32_16x16x32_bf16 a[252:255], v[44:47], v[76:79], a[252:255]
  s_waitcnt lgkmcnt(0)
  s_mov_b32 exec_lo, s42
  s_mov_b32 exec_hi, s42
  ds_write_b128 v6, a[28:31] offset:0
  ds_write_b128 v6, a[60:63] offset:128
  ds_write_b128 v6, a[92:95] offset:256
  ds_write_b128 v6, a[124:127] offset:384
  ds_write_b128 v6, a[156:159] offset:512
  ds_write_b128 v6, a[188:191] offset:640
  ds_write_b128 v6, a[220:223] offset:768
  ds_write_b128 v6, a[252:255] offset:896
  s_mov_b64 exec, -1
  ds_read_b128 v[80:83], v7
  ds_write_b32 v14, v13 offset:8
  v_lshlrev_b32 v88, 16, v84
  v_and_b32 v89, 0xffff0000, v84
  v_lshlrev_b32 v90, 16, v85
  v_and_b32 v91, 0xffff0000, v85
  v_lshlrev_b32 v96, 16, v86
  v_and_b32 v97, 0xffff0000, v86
  v_lshlrev_b32 v98, 16, v87
  v_and_b32 v99, 0xffff0000, v87
  v_mul_f32 v92, v88, v12
  v_mul_f32 v93, v89, v12
  v_mul_f32 v94, v90, v12
  v_mul_f32 v95, v91, v12
  v_cvt_pk_bf16_f32 v84, v92, v93
  v_cvt_pk_bf16_f32 v85, v94, v95
  v_lshlrev_b32 v92, 16, v84
  v_and_b32 v93, 0xffff0000, v84
  v_lshlrev_b32 v94, 16, v85
  v_and_b32 v95, 0xffff0000, v85
  s_waitcnt lgkmcnt(1)
  v_fmac_f32 v80, v88, v11
  v_fmac_f32 v81, v89, v11
  v_fmac_f32 v82, v90, v11
  v_fmac_f32 v83, v91, v11
  v_cvt_pk_bf16_f32 v84, v80, v81
  v_cvt_pk_bf16_f32 v85, v82, v83
  v_lshlrev_b32 v80, 16, v84
  v_and_b32 v81, 0xffff0000, v84
  v_lshlrev_b32 v82, 16, v85
  v_and_b32 v83, 0xffff0000, v85
  v_add_f32 v80, v80, v92
  v_add_f32 v81, v81, v93
  v_add_f32 v82, v82, v94
  v_add_f32 v83, v83, v95
  v_cvt_pk_bf16_f32 v84, v80, v81
  v_cvt_pk_bf16_f32 v85, v82, v83
  v_lshlrev_b32 v80, 16, v84
  v_and_b32 v81, 0xffff0000, v84
  v_lshlrev_b32 v82, 16, v85
  v_and_b32 v83, 0xffff0000, v85
  v_add_f32 v80, v80, v96
  v_add_f32 v81, v81, v97
  v_add_f32 v82, v82, v98
  v_add_f32 v83, v83, v99
  v_cvt_pk_bf16_f32 v84, v80, v81
  v_cvt_pk_bf16_f32 v85, v82, v83
  buffer_store_dwordx2 v[84:85], v10, s[8:11], s40 offen sc1
  v_add_u32 v104, 64, v104
  v_add_u32 v105, 64, v105
  v_add_u32 v106, 64, v106
  v_add_u32 v107, 64, v107
  v_add_u32 v108, 64, v108
  v_add_u32 v109, 64, v109
  v_add_u32 v110, 64, v110
  v_add_u32 v111, 64, v111
  v_add_u32 v4, 64, v4
  v_add_u32 v8, 64, v8
  s_add_u32 s40, s40, 0x8000
  s_waitcnt vmcnt(0)
  s_mov_b64 exec, 1
  buffer_store_dword v13, v1, s[8:11], s39 offen sc1
  s_mov_b64 exec, -1
  ds_write_b32 v14, v13 offset:16
  s_add_u32 s32, s32, 1
  s_and_b32 s6, s32, 7
  s_cbranch_scc1 L_c_conv7
  s_waitcnt vmcnt(0)
  s_endpgm
L_c_res:
  s_mov_b32 s16, s92
  s_mov_b32 s17, s93
  s_mov_b32 s18, 0x200000
  s_mov_b32 s19, 0x20000
  s_and_b32 s6, s3, 1
  s_mul_i32 s37, s6, 0x200000
  s_mul_i32 s38, s6, 0x800000
  s_lshl_b32 s7, s5, 10
  s_add_u32 s37, s37, s7
  s_add_u32 s37, s37, 0x0
  s_add_u32 s38, s38, s7
  s_add_u32 s38, s38, 0x8800000
  s_lshl_b32 s6, s5, 3
  s_add_u32 s39, s6, 0x710900
  s_lshl_b32 s41, s5, 5
  v_bfe_u32 v16, v0, 4, 5
  v_lshrrev_b32 v17, 9, v0
  v_lshlrev_b32 v18, 1, v16
  v_lshl_or_b32 v4, v17, 8, v18
  v_add_u32 v8, 139776, v4
  v_mul_u32_u24 v19, 16512, v17
  v_add_u32 v19, v19, v18
  v_add_u32 v7, 73760, v19
  v_bfe_u32 v5, v0, 2, 3
  v_bfe_u32 v6, v0, 8, 1
  v_lshlrev_b32 v6, 3, v6
  v_and_b32 v19, 0xf0, v0
  v_or_b32 v6, v19, v6
  v_lshlrev_b32 v19, 10, v16
  v_lshl_or_b32 v9, v17, 3, v19
  s_mov_b32 s43, 0
  s_mov_b32 s46, 0
  s_mov_b32 s20, 0x3f80
  s_mov_b32 s21, 0x3f800000
  s_mov_b32 s22, 0x3f803f80
  v_bfe_u32 v10, v0, 4, 2
  v_lshlrev_b32 v10, 15, v10
  v_mov_b32 v32, 0
  v_mov_b32 v33, 0
  v_mov_b32 v34, 0
  v_mov_b32 v35, 0
  v_mov_b32 v36, 0
  v_mov_b32 v37, 0
  v_mov_b32 v38, 0
  v_mov_b32 v39, 0
  s_cmp_eq_u32 s3, 2
  s_cbranch_scc0 L_c_r5
L_c_rf:
  s_cmp_eq_u32 s3, 2
  s_cbranch_scc1 L_ga_132
  s_mov_b32 s47, 0
L_gl_134:
  ds_read_b32 v52, v2 offset:24
  s_waitcnt lgkmcnt(0)
  v_readfirstlane_b32 s6, v52
  s_cmp_gt_i32 s6, s46
  s_cbranch_scc1 L_gb_133
  s_add_u32 s47, s47, 1
  s_cmp_lt_u32 s47, 131072
  s_cbranch_scc1 L_gl_134
  s_mov_b32 s6, 47
  s_branch L_err
L_ga_132:
  s_add_u32 s6, s46, 1
  v_mov_b32 v52, s6
  ds_write_b32 v2, v52 offset:24
L_gb_133:
  s_min_i32 s46, s6, 0x7ffffffe
  buffer_load_short_d16_hi v32, v4, s[8:11], s37 offen offset:0
  buffer_load_short_d16_hi v33, v4, s[8:11], s37 offen offset:64
  buffer_load_short_d16_hi v34, v4, s[8:11], s37 offen offset:128
  buffer_load_short_d16_hi v35, v4, s[8:11], s37 offen offset:192
  buffer_load_short_d16_hi v36, v4, s[8:11], s37 offen offset:512
  buffer_load_short_d16_hi v37, v4, s[8:11], s37 offen offset:576
  buffer_load_short_d16_hi v38, v4, s[8:11], s37 offen offset:640
  buffer_load_short_d16_hi v39, v4, s[8:11], s37 offen offset:704
  s_and_b32 s6, s43, 3
  s_lshl_b32 s6, s6, 17
  s_add_u32 s44, s38, s6
  s_lshr_b32 s6, s43, 2
  s_andn2_b32 s45, 1, s6
  s_add_u32 s6, s44, 0
  buffer_load_dwordx4 v[16:19], v0, s[8:11], s6 offen sc1
  s_add_u32 s6, s44, 32768
  buffer_load_dwordx4 v[20:23], v0, s[8:11], s6 offen sc1
  s_add_u32 s6, s44, 65536
  buffer_load_dwordx4 v[24:27], v0, s[8:11], s6 offen sc1
  s_add_u32 s6, s44, 98304
  buffer_load_dwordx4 v[28:31], v0, s[8:11], s6 offen sc1
  s_add_u32 s37, s37, 0x8000
  s_add_u32 s43, s43, 1
L_c_rloop:
  s_mov_b32 s7, 0
L_c_rp:
  s_waitcnt vmcnt(0)
  v_bitop3_b32 v52, v16, v20, s45 bitop3:0x7e
  v_bitop3_b32 v53, v24, v28, s45 bitop3:0x7e
  v_bitop3_b32 v52, v52, v53, 1 bitop3:0xa8
  v_cmp_ne_u32 vcc, 0, v52
  s_cbranch_vccz L_c_rok
  s_cmp_eq_u32 s3, 2
  s_cbranch_scc1 L_ga_135
  s_mov_b32 s47, 0
L_gl_137:
  ds_read_b32 v52, v2 offset:24
  s_waitcnt lgkmcnt(0)
  v_readfirstlane_b32 s6, v52
  s_cmp_gt_i32 s6, s46
  s_cbranch_scc1 L_gb_136
  s_add_u32 s47, s47, 1
  s_cmp_lt_u32 s47, 131072
  s_cbranch_scc1 L_gl_137
  s_mov_b32 s6, 47
  s_branch L_err
L_gb_136:
  s_min_i32 s46, s6, 0x7ffffffe
L_ga_135:
  s_add_u32 s6, s44, 0
  s_nop 0
  buffer_load_dwordx4 v[16:19], v0, s[8:11], s6 offen sc1
  s_add_u32 s6, s44, 32768
  buffer_load_dwordx4 v[20:23], v0, s[8:11], s6 offen sc1
  s_add_u32 s6, s44, 65536
  buffer_load_dwordx4 v[24:27], v0, s[8:11], s6 offen sc1
  s_add_u32 s6, s44, 98304
  buffer_load_dwordx4 v[28:31], v0, s[8:11], s6 offen sc1
  s_add_u32 s7, s7, 1
  s_cmp_lt_u32 s7, 131072
  s_cbranch_scc1 L_c_rp
  s_mov_b32 s6, 43
  s_branch L_err
L_c_rok:
  v_dot2_f32_bf16 v40, v16, s20, 0
  v_dot2_f32_bf16 v41, v16, s21, 0
  v_dot2_f32_bf16 v42, v17, s20, 0
  v_dot2_f32_bf16 v43, v17, s21, 0
  v_dot2_f32_bf16 v44, v18, s20, 0
  v_dot2_f32_bf16 v45, v18, s21, 0
  v_dot2_f32_bf16 v46, v19, s20, 0
  v_dot2_f32_bf16 v47, v19, s21, 0
  v_dot2_f32_bf16 v40, v20, s20, v40
  v_dot2_f32_bf16 v41, v20, s21, v41
  v_dot2_f32_bf16 v42, v21, s20, v42
  v_dot2_f32_bf16 v43, v21, s21, v43
  v_dot2_f32_bf16 v44, v22, s20, v44
  v_dot2_f32_bf16 v45, v22, s21, v45
  v_dot2_f32_bf16 v46, v23, s20, v46
  v_dot2_f32_bf16 v47, v23, s21, v47
  v_dot2_f32_bf16 v40, v24, s20, v40
  v_dot2_f32_bf16 v41, v24, s21, v41
  v_dot2_f32_bf16 v42, v25, s20, v42
  v_dot2_f32_bf16 v43, v25, s21, v43
  v_dot2_f32_bf16 v44, v26, s20, v44
  v_dot2_f32_bf16 v45, v26, s21, v45
  v_dot2_f32_bf16 v46, v27, s20, v46
  v_dot2_f32_bf16 v47, v27, s21, v47
  v_dot2_f32_bf16 v40, v28, s20, v40
  v_dot2_f32_bf16 v41, v28, s21, v41
  v_dot2_f32_bf16 v42, v29, s20, v42
  v_dot2_f32_bf16 v43, v29, s21, v43
  v_dot2_f32_bf16 v44, v30, s20, v44
  v_dot2_f32_bf16 v45, v30, s21, v45
  v_dot2_f32_bf16 v46, v31, s20, v46
  v_dot2_f32_bf16 v47, v31, s21, v47
  v_cvt_pk_bf16_f32 v48, v40, v41
  v_cvt_pk_bf16_f32 v49, v42, v43
  v_cvt_pk_bf16_f32 v50, v44, v45
  v_cvt_pk_bf16_f32 v51, v46, v47
  v_dot2_f32_bf16 v40, v48, s20, v32
  v_dot2_f32_bf16 v41, v48, s21, v33
  v_dot2_f32_bf16 v42, v49, s20, v34
  v_dot2_f32_bf16 v43, v49, s21, v35
  v_dot2_f32_bf16 v44, v50, s20, v36
  v_dot2_f32_bf16 v45, v50, s21, v37
  v_dot2_f32_bf16 v46, v51, s20, v38
  v_dot2_f32_bf16 v47, v51, s21, v39
  v_cvt_pk_bf16_f32 v48, v40, v41
  v_cvt_pk_bf16_f32 v49, v42, v43
  v_cvt_pk_bf16_f32 v50, v44, v45
  v_cvt_pk_bf16_f32 v51, v46, v47
  s_cmp_eq_u32 s3, 2
  s_cbranch_scc1 L_c_ln
  buffer_store_dwordx2 v[48:49], v9, s[16:19], s41 offen
  buffer_store_dwordx2 v[50:51], v9, s[16:19], s41 offen offset:16
  s_add_u32 s41, s41, 0x8000
  v_mov_b32 v52, s43
  s_mov_b64 exec, 3
  buffer_store_dword v52, v5, s[8:11], s39 offen sc1
  s_mov_b64 exec, -1
  s_add_u32 s32, s32, 1
  s_cmp_eq_u32 s32, 64
  s_cbranch_scc1 L_c_rend
L_c_r5:
  s_add_u32 s33, s32, 1
  s_mov_b32 s7, 0
L_lw_138:
  ds_read_b64 v[52:53], v2 offset:16
  s_waitcnt lgkmcnt(0)
  v_min_i32 v52, v52, v53
  v_cmp_gt_i32 vcc, s33, v52
  s_cbranch_vccz L_lwo_139
  s_add_u32 s7, s7, 1
  s_cmp_lt_u32 s7, 131072
  s_cbranch_scc1 L_lw_138
  s_mov_b32 s6, 46
  s_branch L_err
L_lwo_139:
  s_branch L_c_rf
L_c_ln:
  s_cmp_eq_u32 s32, 63
  s_cbranch_scc0 L_c_f
  v_mov_b32 v52, 0x7fffffff
  ds_write_b32 v2, v52 offset:24
  s_branch L_c_nf
L_c_f:
L_ga_140:
  s_add_u32 s6, s46, 1
  v_mov_b32 v52, s6
  ds_write_b32 v2, v52 offset:24
L_gb_141:
  s_min_i32 s46, s6, 0x7ffffffe
  buffer_load_short_d16_hi v32, v4, s[8:11], s37 offen offset:0
  buffer_load_short_d16_hi v33, v4, s[8:11], s37 offen offset:64
  buffer_load_short_d16_hi v34, v4, s[8:11], s37 offen offset:128
  buffer_load_short_d16_hi v35, v4, s[8:11], s37 offen offset:192
  buffer_load_short_d16_hi v36, v4, s[8:11], s37 offen offset:512
  buffer_load_short_d16_hi v37, v4, s[8:11], s37 offen offset:576
  buffer_load_short_d16_hi v38, v4, s[8:11], s37 offen offset:640
  buffer_load_short_d16_hi v39, v4, s[8:11], s37 offen offset:704
  s_and_b32 s6, s43, 3
  s_lshl_b32 s6, s6, 17
  s_add_u32 s44, s38, s6
  s_lshr_b32 s6, s43, 2
  s_andn2_b32 s45, 1, s6
  s_add_u32 s6, s44, 0
  buffer_load_dwordx4 v[16:19], v0, s[8:11], s6 offen sc1
  s_add_u32 s6, s44, 32768
  buffer_load_dwordx4 v[20:23], v0, s[8:11], s6 offen sc1
  s_add_u32 s6, s44, 65536
  buffer_load_dwordx4 v[24:27], v0, s[8:11], s6 offen sc1
  s_add_u32 s6, s44, 98304
  buffer_load_dwordx4 v[28:31], v0, s[8:11], s6 offen sc1
  s_add_u32 s37, s37, 0x8000
  s_add_u32 s43, s43, 1
L_c_nf:
  v_dot2_f32_bf16 v52, v48, s22, 0
  v_dot2_f32_bf16 v53, v48, v48, 0
  v_dot2_f32_bf16 v52, v49, s22, v52
  v_dot2_f32_bf16 v53, v49, v49, v53
  v_dot2_f32_bf16 v52, v50, s22, v52
  v_dot2_f32_bf16 v53, v50, v50, v53
  v_dot2_f32_bf16 v52, v51, s22, v52
  v_dot2_f32_bf16 v53, v51, v51, v53
  s_lshr_b32 s6, s32, 1
  s_andn2_b32 s36, 1, s6
  s_and_b32 s6, s32, 1
  s_lshl_b32 s6, s6, 13
  s_add_u32 s34, s6, 0x704000
  s_add_u32 s35, s34, 4096
  s_lshl_b32 s6, s5, 8
  s_add_u32 s6, s6, s34
  v_mov_b32 v54, v52
  v_mov_b32 v55, v53
  s_nop 0
  v_permlane32_swap_b32 v52, v54
  v_permlane32_swap_b32 v53, v55
  v_add_f32 v52, v52, v54
  v_add_f32 v53, v53, v55
  v_bfi_b32 v53, 1, s36, v53
  s_mov_b32 exec_hi, 0
  buffer_store_dwordx2 v[52:53], v6, s[8:11], s6 offen
  s_cmp_lg_u32 s32, 63
  s_cbranch_scc1 L_c_nl
  buffer_store_dwordx2 v[52:53], v6, s[8:11], s6 offen sc1
L_c_nl:
  s_mov_b32 exec_hi, -1
  s_sub_u32 s33, s32, 7
  s_mov_b32 s7, 0
L_lw_143:
  ds_read_b64 v[52:53], v2 offset:8
  s_waitcnt lgkmcnt(0)
  v_min_i32 v52, v52, v53
  v_cmp_gt_i32 vcc, s33, v52
  s_cbranch_vccz L_lwo_144
  s_add_u32 s7, s7, 1
  s_cmp_lt_u32 s7, 131072
  s_cbranch_scc1 L_lw_143
  s_mov_b32 s6, 44
  s_branch L_err
L_lwo_144:
  s_and_b32 s6, s32, 7
  s_lshl_b32 s6, s6, 10
  v_add_u32 v52, s6, v8
  ds_write_b16 v52, v48 offset:0
  ds_write_b16_d16_hi v52, v48 offset:64
  ds_write_b16 v52, v49 offset:128
  ds_write_b16_d16_hi v52, v49 offset:192
  ds_write_b16 v52, v50 offset:512
  ds_write_b16_d16_hi v52, v50 offset:576
  ds_write_b16 v52, v51 offset:640
  ds_write_b16_d16_hi v52, v51 offset:704
  buffer_load_dwordx4 v[64:67], v0, s[8:11], s34 offen offset:0 sc1
  buffer_load_dwordx4 v[68:71], v0, s[8:11], s34 offen offset:1024 sc1
  buffer_load_dwordx4 v[72:75], v0, s[8:11], s34 offen offset:2048 sc1
  buffer_load_dwordx4 v[76:79], v0, s[8:11], s34 offen offset:3072 sc1
  buffer_load_dwordx4 v[80:83], v0, s[8:11], s35 offen offset:0 sc1
  buffer_load_dwordx4 v[84:87], v0, s[8:11], s35 offen offset:1024 sc1
  buffer_load_dwordx4 v[88:91], v0, s[8:11], s35 offen offset:2048 sc1
  buffer_load_dwordx4 v[92:95], v0, s[8:11], s35 offen offset:3072 sc1
  s_mov_b32 s7, 0
L_c_g:
  s_waitcnt vmcnt(0)
  v_bitop3_b32 v56, v65, v67, s36 bitop3:0x7e
  v_bitop3_b32 v57, v69, v71, s36 bitop3:0x7e
  v_bitop3_b32 v58, v73, v75, s36 bitop3:0x7e
  v_bitop3_b32 v59, v77, v79, s36 bitop3:0x7e
  v_bitop3_b32 v60, v81, v83, s36 bitop3:0x7e
  v_bitop3_b32 v61, v85, v87, s36 bitop3:0x7e
  v_bitop3_b32 v62, v89, v91, s36 bitop3:0x7e
  v_bitop3_b32 v63, v93, v95, s36 bitop3:0x7e
  v_or3_b32 v52, v56, v57, v58
  v_or3_b32 v53, v59, v60, v61
  v_or3_b32 v52, v52, v62, v63
  v_bitop3_b32 v52, v52, v53, 1 bitop3:0xa8
  v_cmp_ne_u32 vcc, 0, v52
  s_cbranch_vccz L_c_gok0
  v_and_b32 v56, 1, v56
  v_and_b32 v57, 1, v57
  v_and_b32 v58, 1, v58
  v_and_b32 v59, 1, v59
  v_and_b32 v60, 1, v60
  v_and_b32 v61, 1, v61
  v_and_b32 v62, 1, v62
  v_and_b32 v63, 1, v63
  v_cmp_ne_u32 s[48:49], 0, v56
  v_cmp_ne_u32 s[50:51], 0, v57
  v_cmp_ne_u32 s[52:53], 0, v58
  v_cmp_ne_u32 s[54:55], 0, v59
  v_cmp_ne_u32 s[56:57], 0, v60
  v_cmp_ne_u32 s[58:59], 0, v61
  v_cmp_ne_u32 s[60:61], 0, v62
  v_cmp_ne_u32 s[62:63], 0, v63
  s_or_b64 exec, s[48:49], 1
  buffer_load_dwordx4 v[64:67], v0, s[8:11], s34 offen offset:0 sc1
  s_or_b64 exec, s[50:51], 1
  buffer_load_dwordx4 v[68:71], v0, s[8:11], s34 offen offset:1024 sc1
  s_or_b64 exec, s[52:53], 1
  buffer_load_dwordx4 v[72:75], v0, s[8:11], s34 offen offset:2048 sc1
  s_or_b64 exec, s[54:55], 1
  buffer_load_dwordx4 v[76:79], v0, s[8:11], s34 offen offset:3072 sc1
  s_or_b64 exec, s[56:57], 1
  buffer_load_dwordx4 v[80:83], v0, s[8:11], s35 offen offset:0 sc1
  s_or_b64 exec, s[58:59], 1
  buffer_load_dwordx4 v[84:87], v0, s[8:11], s35 offen offset:1024 sc1
  s_or_b64 exec, s[60:61], 1
  buffer_load_dwordx4 v[88:91], v0, s[8:11], s35 offen offset:2048 sc1
  s_or_b64 exec, s[62:63], 1
  buffer_load_dwordx4 v[92:95], v0, s[8:11], s35 offen offset:3072 sc1
  s_mov_b64 exec, -1
  s_and_b32 s6, s7, 31
  s_cmp_lg_u32 s6, 31
  s_cbranch_scc1 L_tf_145
  buffer_wbl2 sc1
  s_waitcnt vmcnt(0)
  buffer_inv sc1
  s_waitcnt vmcnt(0)
L_tf_145:
  s_add_u32 s7, s7, 1
  s_cmp_lt_u32 s7, 131072
  s_cbranch_scc1 L_c_g
  s_mov_b32 s6, 45
  s_branch L_err
L_c_gok0:
  v_pk_add_f32 v[64:65], v[64:65], v[80:81]
  v_pk_add_f32 v[66:67], v[66:67], v[82:83]
  v_pk_add_f32 v[68:69], v[68:69], v[84:85]
  v_pk_add_f32 v[70:71], v[70:71], v[86:87]
  v_pk_add_f32 v[72:73], v[72:73], v[88:89]
  v_pk_add_f32 v[74:75], v[74:75], v[90:91]
  v_pk_add_f32 v[76:77], v[76:77], v[92:93]
  v_pk_add_f32 v[78:79], v[78:79], v[94:95]
L_c_gok:
  v_pk_add_f32 v[64:65], v[64:65], v[72:73]
  v_pk_add_f32 v[66:67], v[66:67], v[74:75]
  v_pk_add_f32 v[68:69], v[68:69], v[76:77]
  v_pk_add_f32 v[70:71], v[70:71], v[78:79]
  v_pk_add_f32 v[64:65], v[64:65], v[68:69]
  v_pk_add_f32 v[66:67], v[66:67], v[70:71]
  s_nop 1
  v_permlane16_swap_b32 v64, v66
  v_permlane16_swap_b32 v65, v67
  v_pk_add_f32 v[52:53], v[64:65], v[66:67]
  v_mov_b32 v54, v52
  v_mov_b32 v55, v53
  s_nop 0
  v_permlane32_swap_b32 v52, v54
  v_permlane32_swap_b32 v53, v55
  v_add_f32 v52, v52, v54
  v_add_f32 v53, v53, v55
  v_mul_f32 v52, 0x3b000000, v52
  v_mul_f32 v54, v52, v52
  v_mul_f32 v53, 0x3b000000, v53
  v_sub_f32 v53, v53, v54
  v_max_f32 v53, 0, v53
  v_cvt_pk_bf16_f32 v53, v53, v53
  v_and_b32 v53, 0xffff0000, v53
  v_add_f32 v53, 0x3727c5ac, v53
  v_cvt_pk_bf16_f32 v53, v53, v53
  v_and_b32 v53, 0xffff0000, v53
  v_sqrt_f32 v53, v53
  v_cvt_pk_bf16_f32 v52, v52, v52
  v_and_b32 v52, 0xffff0000, v52
  v_cvt_pk_bf16_f32 v53, v53, v53
  v_and_b32 v53, 0xffff0000, v53
  v_rcp_f32 v53, v53
  v_dot2_f32_bf16 v40, v48, s20, v52 neg_lo:[0,0,1]
  v_dot2_f32_bf16 v41, v48, s21, v52 neg_lo:[0,0,1]
  v_dot2_f32_bf16 v42, v49, s20, v52 neg_lo:[0,0,1]
  v_dot2_f32_bf16 v43, v49, s21, v52 neg_lo:[0,0,1]
  v_dot2_f32_bf16 v44, v50, s20, v52 neg_lo:[0,0,1]
  v_dot2_f32_bf16 v45, v50, s21, v52 neg_lo:[0,0,1]
  v_dot2_f32_bf16 v46, v51, s20, v52 neg_lo:[0,0,1]
  v_dot2_f32_bf16 v47, v51, s21, v52 neg_lo:[0,0,1]
  v_cvt_pk_bf16_f32 v48, v40, v41
  v_cvt_pk_bf16_f32 v49, v42, v43
  v_cvt_pk_bf16_f32 v50, v44, v45
  v_cvt_pk_bf16_f32 v51, v46, v47
  v_lshlrev_b32 v40, 16, v48
  v_and_b32 v41, 0xffff0000, v48
  v_lshlrev_b32 v42, 16, v49
  v_and_b32 v43, 0xffff0000, v49
  v_lshlrev_b32 v44, 16, v50
  v_and_b32 v45, 0xffff0000, v50
  v_lshlrev_b32 v46, 16, v51
  v_and_b32 v47, 0xffff0000, v51
  v_mul_f32 v40, v40, v53
  v_mul_f32 v41, v41, v53
  v_mul_f32 v42, v42, v53
  v_mul_f32 v43, v43, v53
  v_mul_f32 v44, v44, v53
  v_mul_f32 v45, v45, v53
  v_mul_f32 v46, v46, v53
  v_mul_f32 v47, v47, v53
  v_cvt_pk_bf16_f32 v48, v40, v41
  v_cvt_pk_bf16_f32 v49, v42, v43
  v_cvt_pk_bf16_f32 v50, v44, v45
  v_cvt_pk_bf16_f32 v51, v46, v47
  s_add_u32 s6, s32, 1
  v_mov_b32 v52, s6
  ds_write_b16 v7, v48 offset:0
  ds_write_b16_d16_hi v7, v48 offset:4128
  ds_write_b16 v7, v49 offset:8256
  ds_write_b16_d16_hi v7, v49 offset:12384
  ds_write_b16 v7, v50 offset:33024
  ds_write_b16_d16_hi v7, v50 offset:37152
  ds_write_b16 v7, v51 offset:41280
  ds_write_b16_d16_hi v7, v51 offset:45408
  ds_write_b32 v2, v52
  v_add_u32 v7, 64, v7
  s_add_u32 s32, s32, 1
  s_cmp_lt_u32 s32, 64
  s_cbranch_scc1 L_c_rloop
L_c_rend:
  s_waitcnt vmcnt(0)
  s_endpgm
.section .rodata,"a"
.p2align 6
.amdhsa_kernel interleave_layers__ssm_conv_s4d__memory_aug_recurrent_mem_tr__prompt_kernel
  .amdhsa_next_free_vgpr 512
  .amdhsa_next_free_sgpr 102
  .amdhsa_accum_offset 256
  .amdhsa_group_segment_fixed_size 0
  .amdhsa_kernarg_size 136
  .amdhsa_user_sgpr_count 2
  .amdhsa_user_sgpr_kernarg_segment_ptr 1
  .amdhsa_system_sgpr_workgroup_id_x 1
.end_amdhsa_kernel
```

```asm
; @launch grid=(256,1,1) block=(256,1,1) lds=163840
.amdgcn_target "amdgcn-amd-amdhsa--gfx950"
.text
.globl interleave_layers__ssm_conv_s4d__memory_aug_recurrent_mem_tr__prompt_kernel
.p2align 8
.type interleave_layers__ssm_conv_s4d__memory_aug_recurrent_mem_tr__prompt_kernel,@function
interleave_layers__ssm_conv_s4d__memory_aug_recurrent_mem_tr__prompt_kernel:
  s_cmp_ge_u32 s2, 256
  s_cbranch_scc1 L_end
  s_load_dwordx16 s[64:79], s[0:1], 0
  s_load_dwordx16 s[80:95], s[0:1], 64
  s_load_dwordx2 s[96:97], s[0:1], 128
  s_getreg_b32 s4, hwreg(HW_REG_XCC_ID,0,4)
  v_lshrrev_b32 v1, 6, v0
  v_and_b32 v0, 63, v0
  s_and_b32 s4, s4, 7
  v_readfirstlane_b32 s3, v1
  s_lshl_b32 s4, s4, 2
  s_lshr_b32 s4, 0x10765432, s4
  s_and_b32 s4, s4, 7
  s_waitcnt lgkmcnt(0)
  s_mov_b32 s12, s94
  s_mov_b32 s13, s95
  s_mov_b32 s14, 0x100
  s_mov_b32 s15, 0x20000
  s_mov_b32 s8, s96
  s_mov_b32 s9, s97
  s_mov_b32 s10, 0x10000000
  s_mov_b32 s11, 0x20000
  s_mov_b32 s16, s64
  s_mov_b32 s17, s65
  s_mov_b32 s18, 0x200000
  s_mov_b32 s19, 0x20000
  s_lshl_b32 s6, s2, 3
  s_lshl_b32 s7, s3, 1
  s_add_u32 s32, s6, s7
  s_lshl_b32 s6, s32, 10
  v_lshlrev_b32 v4, 5, v0
  buffer_load_dwordx4 v[40:43], v4, s[16:19], s6 offen
  buffer_load_dwordx4 v[44:47], v4, s[16:19], s6 offen offset:16
  s_cmp_lg_u32 s3, 0
  s_cbranch_scc1 L_tk_1
  s_and_b32 s6, s4, 3
  s_lshl_b32 s6, s6, 6
  s_and_b32 s7, s4, 4
  s_add_u32 s6, s6, s7
  s_mov_b64 exec, 1
  v_mov_b32 v2, s6
  v_mov_b32 v3, 1
  buffer_atomic_add v3, v2, s[12:15], 0 offen sc0 sc1
  s_mov_b64 exec, -1
L_tk_1:
  s_cmp_lg_u32 s3, 0
  s_waitcnt vmcnt(1)
  s_cbranch_scc0 L_xw_2
  s_waitcnt vmcnt(0)
L_xw_2:
  v_mov_b32 v5, 0
  v_mov_b32 v6, 0
  v_mov_b32 v7, 0x3f803f80
  v_dot2c_f32_bf16 v5, v40, v7
  v_dot2c_f32_bf16 v6, v40, v40
  v_dot2c_f32_bf16 v5, v41, v7
  v_dot2c_f32_bf16 v6, v41, v41
  v_dot2c_f32_bf16 v5, v42, v7
  v_dot2c_f32_bf16 v6, v42, v42
  v_dot2c_f32_bf16 v5, v43, v7
  v_dot2c_f32_bf16 v6, v43, v43
  v_dot2c_f32_bf16 v5, v44, v7
  v_dot2c_f32_bf16 v6, v44, v44
  v_dot2c_f32_bf16 v5, v45, v7
  v_dot2c_f32_bf16 v6, v45, v45
  v_dot2c_f32_bf16 v5, v46, v7
  v_dot2c_f32_bf16 v6, v46, v46
  v_dot2c_f32_bf16 v5, v47, v7
  v_dot2c_f32_bf16 v6, v47, v47
  s_nop 1
  v_add_f32_dpp v5, v5, v5 quad_perm:[1,0,3,2] row_mask:0xf bank_mask:0xf
  v_add_f32_dpp v6, v6, v6 quad_perm:[1,0,3,2] row_mask:0xf bank_mask:0xf
  s_nop 0
  v_add_f32_dpp v5, v5, v5 quad_perm:[2,3,0,1] row_mask:0xf bank_mask:0xf
  v_add_f32_dpp v6, v6, v6 quad_perm:[2,3,0,1] row_mask:0xf bank_mask:0xf
  s_nop 0
  v_add_f32_dpp v5, v5, v5 row_half_mirror row_mask:0xf bank_mask:0xf
  v_add_f32_dpp v6, v6, v6 row_half_mirror row_mask:0xf bank_mask:0xf
  s_nop 0
  v_add_f32_dpp v5, v5, v5 row_mirror row_mask:0xf bank_mask:0xf
  v_add_f32_dpp v6, v6, v6 row_mirror row_mask:0xf bank_mask:0xf
  v_mov_b32 v8, v5
  v_mov_b32 v9, v6
  s_nop 0
  v_permlane16_swap_b32 v5, v8
  v_permlane16_swap_b32 v6, v9
  v_add_f32 v8, v5, v8
  v_add_f32 v9, v6, v9
  v_mul_f32 v8, 0x3b000000, v8
  v_mul_f32 v10, v8, v8
  v_mul_f32 v9, 0x3b000000, v9
  v_sub_f32 v9, v9, v10
  v_max_f32 v9, 0, v9
  v_cvt_pk_bf16_f32 v9, v9, v9
  v_and_b32 v9, 0xffff0000, v9
  v_add_f32 v9, 0x3727c5ac, v9
  v_cvt_pk_bf16_f32 v9, v9, v9
  v_and_b32 v9, 0xffff0000, v9
  v_sqrt_f32 v9, v9
  v_cvt_pk_bf16_f32 v8, v8, v8
  v_and_b32 v8, 0xffff0000, v8
  v_cvt_pk_bf16_f32 v9, v9, v9
  v_and_b32 v9, 0xffff0000, v9
  v_rcp_f32 v9, v9
  v_lshlrev_b32 v16, 16, v40
  v_and_b32 v17, 0xffff0000, v40
  v_lshlrev_b32 v18, 16, v41
  v_and_b32 v19, 0xffff0000, v41
  v_lshlrev_b32 v20, 16, v42
  v_and_b32 v21, 0xffff0000, v42
  v_lshlrev_b32 v22, 16, v43
  v_and_b32 v23, 0xffff0000, v43
  v_lshlrev_b32 v24, 16, v44
  v_and_b32 v25, 0xffff0000, v44
  v_lshlrev_b32 v26, 16, v45
  v_and_b32 v27, 0xffff0000, v45
  v_lshlrev_b32 v28, 16, v46
  v_and_b32 v29, 0xffff0000, v46
  v_lshlrev_b32 v30, 16, v47
  v_and_b32 v31, 0xffff0000, v47
  v_sub_f32 v16, v16, v8
  v_sub_f32 v17, v17, v8
  v_sub_f32 v18, v18, v8
  v_sub_f32 v19, v19, v8
  v_sub_f32 v20, v20, v8
  v_sub_f32 v21, v21, v8
  v_sub_f32 v22, v22, v8
  v_sub_f32 v23, v23, v8
  v_sub_f32 v24, v24, v8
  v_sub_f32 v25, v25, v8
  v_sub_f32 v26, v26, v8
  v_sub_f32 v27, v27, v8
  v_sub_f32 v28, v28, v8
  v_sub_f32 v29, v29, v8
  v_sub_f32 v30, v30, v8
  v_sub_f32 v31, v31, v8
  v_cvt_pk_bf16_f32 v32, v16, v17
  v_cvt_pk_bf16_f32 v33, v18, v19
  v_cvt_pk_bf16_f32 v34, v20, v21
  v_cvt_pk_bf16_f32 v35, v22, v23
  v_cvt_pk_bf16_f32 v36, v24, v25
  v_cvt_pk_bf16_f32 v37, v26, v27
  v_cvt_pk_bf16_f32 v38, v28, v29
  v_cvt_pk_bf16_f32 v39, v30, v31
  v_lshlrev_b32 v16, 16, v32
  v_and_b32 v17, 0xffff0000, v32
  v_lshlrev_b32 v18, 16, v33
  v_and_b32 v19, 0xffff0000, v33
  v_lshlrev_b32 v20, 16, v34
  v_and_b32 v21, 0xffff0000, v34
  v_lshlrev_b32 v22, 16, v35
  v_and_b32 v23, 0xffff0000, v35
  v_lshlrev_b32 v24, 16, v36
  v_and_b32 v25, 0xffff0000, v36
  v_lshlrev_b32 v26, 16, v37
  v_and_b32 v27, 0xffff0000, v37
  v_lshlrev_b32 v28, 16, v38
  v_and_b32 v29, 0xffff0000, v38
  v_lshlrev_b32 v30, 16, v39
  v_and_b32 v31, 0xffff0000, v39
  v_mul_f32 v16, v16, v9
  v_mul_f32 v17, v17, v9
  v_mul_f32 v18, v18, v9
  v_mul_f32 v19, v19, v9
  v_mul_f32 v20, v20, v9
  v_mul_f32 v21, v21, v9
  v_mul_f32 v22, v22, v9
  v_mul_f32 v23, v23, v9
  v_mul_f32 v24, v24, v9
  v_mul_f32 v25, v25, v9
  v_mul_f32 v26, v26, v9
  v_mul_f32 v27, v27, v9
  v_mul_f32 v28, v28, v9
  v_mul_f32 v29, v29, v9
  v_mul_f32 v30, v30, v9
  v_mul_f32 v31, v31, v9
  v_cvt_pk_bf16_f32 v32, v16, v17
  v_cvt_pk_bf16_f32 v33, v18, v19
  v_cvt_pk_bf16_f32 v34, v20, v21
  v_cvt_pk_bf16_f32 v35, v22, v23
  v_cvt_pk_bf16_f32 v36, v24, v25
  v_cvt_pk_bf16_f32 v37, v26, v27
  v_cvt_pk_bf16_f32 v38, v28, v29
  v_cvt_pk_bf16_f32 v39, v30, v31
  s_mov_b32 s6, 0x05040100
  s_mov_b32 s7, 0x07060302
  v_and_b32 v4, 31, v0
  v_mul_u32_u24 v4, 528, v4
  v_lshrrev_b32 v5, 5, v0
  v_lshl_add_u32 v4, v5, 8, v4
  s_lshl_b32 s34, s3, 2
  s_add_u32 s34, s34, 64
  v_add_u32 v4, s34, v4
  v_permlane32_swap_b32 v32, v36
  v_permlane32_swap_b32 v33, v37
  v_permlane32_swap_b32 v34, v38
  v_permlane32_swap_b32 v35, v39
  v_perm_b32 v16, v36, v32, s6
  ds_write_b32 v4, v16 offset:0
  v_perm_b32 v17, v36, v32, s7
  ds_write_b32 v4, v17 offset:16
  v_perm_b32 v18, v37, v33, s6
  ds_write_b32 v4, v18 offset:32
  v_perm_b32 v19, v37, v33, s7
  ds_write_b32 v4, v19 offset:48
  v_perm_b32 v20, v38, v34, s6
  ds_write_b32 v4, v20 offset:128
  v_perm_b32 v21, v38, v34, s7
  ds_write_b32 v4, v21 offset:144
  v_perm_b32 v22, v39, v35, s6
  ds_write_b32 v4, v22 offset:160
  v_perm_b32 v23, v39, v35, s7
  ds_write_b32 v4, v23 offset:176
  v_permlane32_swap_b32 v40, v44
  v_permlane32_swap_b32 v41, v45
  v_permlane32_swap_b32 v42, v46
  v_permlane32_swap_b32 v43, v47
  v_perm_b32 v24, v44, v40, s6
  ds_write_b32 v4, v24 offset:64
  v_perm_b32 v25, v44, v40, s7
  ds_write_b32 v4, v25 offset:80
  v_perm_b32 v26, v45, v41, s6
  ds_write_b32 v4, v26 offset:96
  v_perm_b32 v27, v45, v41, s7
  ds_write_b32 v4, v27 offset:112
  v_perm_b32 v28, v46, v42, s6
  ds_write_b32 v4, v28 offset:192
  v_perm_b32 v29, v46, v42, s7
  ds_write_b32 v4, v29 offset:208
  v_perm_b32 v30, v47, v43, s6
  ds_write_b32 v4, v30 offset:224
  v_perm_b32 v31, v47, v43, s7
  ds_write_b32 v4, v31 offset:240
  s_cmp_lg_u32 s3, 0
  s_cbranch_scc1 L_rl_3
  s_waitcnt vmcnt(0)
  v_readfirstlane_b32 s5, v3
  s_cmp_lt_u32 s5, 32
  s_cbranch_scc1 L_rok_4
  s_mov_b64 exec, 1
  v_mov_b32 v2, 32
  v_mov_b32 v3, 1
  buffer_atomic_add v3, v2, s[12:15], 0 offen sc0 sc1
  s_waitcnt vmcnt(0)
  v_readfirstlane_b32 s33, v3
  s_mov_b64 exec, -1
  s_mov_b32 s7, 0
  v_lshlrev_b32 v2, 2, v0
L_row_5:
  buffer_load_dword v3, v2, s[12:15], 0 offen sc1
  s_waitcnt vmcnt(0)
  s_mov_b32 s34, 0
  v_readlane_b32 s40, v3, 0
  v_readlane_b32 s41, v3, 16
  v_readlane_b32 s42, v3, 32
  v_readlane_b32 s43, v3, 48
  v_readlane_b32 s44, v3, 1
  v_readlane_b32 s45, v3, 17
  v_readlane_b32 s46, v3, 33
  v_readlane_b32 s47, v3, 49
  s_add_u32 s34, s34, s40
  s_add_u32 s34, s34, s41
  s_add_u32 s34, s34, s42
  s_add_u32 s34, s34, s43
  s_add_u32 s34, s34, s44
  s_add_u32 s34, s34, s45
  s_add_u32 s34, s34, s46
  s_add_u32 s34, s34, s47
  s_cmp_eq_u32 s34, 256
  s_cbranch_scc1 L_row2_6
  s_add_u32 s7, s7, 1
  s_cmp_lt_u32 s7, 131072
  s_cbranch_scc1 L_row_5
  s_mov_b32 s6, 1
  s_branch L_err
L_row2_6:
  s_min_u32 s5, s40, 32
  s_sub_u32 s35, 32, s5
  s_cmp_ge_u32 s33, s35
  s_cbranch_scc1 L_ovn_7
  s_add_u32 s5, s5, s33
  s_mov_b32 s4, 0
  s_branch L_rok_4
L_ovn_7:
  s_sub_u32 s33, s33, s35
  s_min_u32 s5, s41, 32
  s_sub_u32 s35, 32, s5
  s_cmp_ge_u32 s33, s35
  s_cbranch_scc1 L_ovn_8
  s_add_u32 s5, s5, s33
  s_mov_b32 s4, 1
  s_branch L_rok_4
L_ovn_8:
  s_sub_u32 s33, s33, s35
  s_min_u32 s5, s42, 32
  s_sub_u32 s35, 32, s5
  s_cmp_ge_u32 s33, s35
  s_cbranch_scc1 L_ovn_9
  s_add_u32 s5, s5, s33
  s_mov_b32 s4, 2
  s_branch L_rok_4
L_ovn_9:
  s_sub_u32 s33, s33, s35
  s_min_u32 s5, s43, 32
  s_sub_u32 s35, 32, s5
  s_cmp_ge_u32 s33, s35
  s_cbranch_scc1 L_ovn_10
  s_add_u32 s5, s5, s33
  s_mov_b32 s4, 3
  s_branch L_rok_4
L_ovn_10:
  s_sub_u32 s33, s33, s35
  s_min_u32 s5, s44, 32
  s_sub_u32 s35, 32, s5
  s_cmp_ge_u32 s33, s35
  s_cbranch_scc1 L_ovn_11
  s_add_u32 s5, s5, s33
  s_mov_b32 s4, 4
  s_branch L_rok_4
L_ovn_11:
  s_sub_u32 s33, s33, s35
  s_min_u32 s5, s45, 32
  s_sub_u32 s35, 32, s5
  s_cmp_ge_u32 s33, s35
  s_cbranch_scc1 L_ovn_12
  s_add_u32 s5, s5, s33
  s_mov_b32 s4, 5
  s_branch L_rok_4
L_ovn_12:
  s_sub_u32 s33, s33, s35
  s_min_u32 s5, s46, 32
  s_sub_u32 s35, 32, s5
  s_cmp_ge_u32 s33, s35
  s_cbranch_scc1 L_ovn_13
  s_add_u32 s5, s5, s33
  s_mov_b32 s4, 6
  s_branch L_rok_4
L_ovn_13:
  s_sub_u32 s33, s33, s35
  s_min_u32 s5, s47, 32
  s_sub_u32 s35, 32, s5
  s_cmp_ge_u32 s33, s35
  s_cbranch_scc1 L_ovn_14
  s_add_u32 s5, s5, s33
  s_mov_b32 s4, 7
  s_branch L_rok_4
L_ovn_14:
  s_sub_u32 s33, s33, s35
  s_mov_b32 s6, 2
  s_branch L_err
L_rok_4:
  s_lshl_b32 s6, s4, 5
  s_add_u32 s6, s6, s5
  v_mov_b32 v2, 0
  v_mov_b32 v3, s6
  ds_write_b32 v2, v3
L_rl_3:
  v_lshrrev_b32 v4, 5, v0
  s_lshl_b32 s6, s3, 1
  v_add_u32 v4, s6, v4
  v_mul_u32_u24 v4, 528, v4
  v_and_b32 v5, 31, v0
  v_lshl_add_u32 v4, v5, 4, v4
  v_lshrrev_b32 v5, 3, v0
  v_lshlrev_b32 v5, 15, v5
  v_and_b32 v6, 7, v0
  v_lshl_or_b32 v5, v6, 4, v5
  s_lshl_b32 s6, s3, 18
  s_lshl_b32 s7, s2, 7
  s_add_u32 s6, s6, s7
  s_add_u32 s6, s6, 0xb000000
  s_waitcnt lgkmcnt(0)
  s_barrier
  ds_read_b128 v[16:19], v4 offset:64
  ds_read_b128 v[20:23], v4 offset:4288
  ds_read_b128 v[24:27], v4 offset:8512
  ds_read_b128 v[28:31], v4 offset:12736
  s_waitcnt lgkmcnt(3)
  buffer_store_dwordx4 v[16:19], v5, s[8:11], s6 offen sc1
  s_add_u32 s6, s6, 1048576
  s_waitcnt lgkmcnt(2)
  buffer_store_dwordx4 v[20:23], v5, s[8:11], s6 offen sc1
  s_add_u32 s6, s6, 1048576
  s_waitcnt lgkmcnt(1)
  buffer_store_dwordx4 v[24:27], v5, s[8:11], s6 offen sc1
  s_add_u32 s6, s6, 1048576
  s_waitcnt lgkmcnt(0)
  buffer_store_dwordx4 v[28:31], v5, s[8:11], s6 offen sc1
  s_add_u32 s6, s6, 1048576
  v_mov_b32 v2, 0
  ds_read_b32 v3, v2
  s_waitcnt lgkmcnt(0)
  v_readfirstlane_b32 s6, v3
  s_barrier
  s_lshr_b32 s4, s6, 5
  s_and_b32 s4, s4, 7
  s_and_b32 s5, s6, 31
  s_cmp_eq_u32 s4, 0
  s_cbranch_scc1 L_rec
  s_cmp_eq_u32 s4, 1
  s_cbranch_scc1 L_rec
  s_cmp_eq_u32 s4, 2
  s_cbranch_scc1 L_p
  s_cmp_eq_u32 s4, 3
  s_cbranch_scc1 L_p
  s_cmp_eq_u32 s4, 4
  s_cbranch_scc1 L_p
  s_cmp_eq_u32 s4, 5
  s_cbranch_scc1 L_p
  s_cmp_eq_u32 s4, 6
  s_cbranch_scc1 L_o
  s_cmp_eq_u32 s4, 7
  s_cbranch_scc1 L_c
  s_waitcnt vmcnt(0)
  s_barrier
  s_cmp_lg_u32 s3, 0
  s_cbranch_scc1 L_sd_15
  s_mov_b64 exec, 1
  s_and_b32 s6, s4, 3
  s_lshl_b32 s6, s6, 6
  v_mov_b32 v2, 16
  v_mov_b32 v3, 1
  buffer_atomic_add v3, v2, s[12:15], s6 offen sc1
  s_mov_b64 exec, -1
L_sd_15:
  s_waitcnt vmcnt(0)
  s_endpgm
L_err:
  s_mov_b64 exec, 1
  s_lshl_b32 s7, s4, 2
  s_add_u32 s7, s7, 160
  v_mov_b32 v2, s7
  v_mov_b32 v3, s6
  buffer_store_dword v3, v2, s[12:15], 0 offen sc1
  s_waitcnt vmcnt(0)
L_end:
  s_endpgm
L_rec:
  s_and_b32 s58, s4, 1
  s_mul_i32 s35, s58, 0x2000000
  s_add_u32 s35, s35, 0x800000
  s_mul_i32 s36, s58, 0x1000000
  s_add_u32 s36, s36, 0x4800000
  s_mul_i32 s39, s58, 0x40000
  s_add_u32 s39, s39, 0x740000
  s_mul_i32 s44, s58, 0x2000
  s_add_u32 s44, s44, 0x708000
  s_lshl_b32 s6, s5, 14
  s_lshl_b32 s7, s3, 11
  s_add_u32 s35, s35, s6
  s_add_u32 s35, s35, s7
  s_mov_b32 s48, s7
  s_lshl_b32 s6, s5, 8
  s_add_u32 s43, s44, s6
  s_add_u32 s44, s44, s7
  s_lshl_b32 s7, s5, 13
  s_add_u32 s41, s39, s7
  s_add_u32 s42, s41, 4096
  s_add_u32 s39, s39, s6
  s_add_u32 s40, s39, 32768
  s_lshl_b32 s7, s5, 12
  s_add_u32 s36, s36, s7
  s_lshl_b32 s7, s3, 10
  s_add_u32 s36, s36, s7
  s_add_u32 s53, s48, 8192
  s_add_u32 s37, s48, 16384
  s_lshl_b32 s6, s58, 13
  s_lshl_b32 s7, s5, 7
  s_add_u32 s38, s6, s7
  s_add_u32 s38, s38, 0x714000
  s_mov_b32 s54, 0x00ff00ff
  s_mov_b32 s55, 0x00ff00ff
  s_mov_b32 s56, 0x33333333
  s_mov_b32 s57, 0x33333333
  s_mov_b32 s34, 0x3e0293ee
  s_add_u32 s6, s3, 1
  s_and_b32 s6, s6, 3
  s_lshl_b32 s45, s6, 11
  s_add_u32 s6, s3, 2
  s_and_b32 s6, s6, 3
  s_lshl_b32 s46, s6, 11
  s_add_u32 s6, s3, 3
  s_and_b32 s6, s6, 3
  s_lshl_b32 s47, s6, 11
  v_and_b32 v16, 15, v0
  v_lshrrev_b32 v17, 4, v0
  v_lshlrev_b32 v1, 4, v0
  s_lshl_b32 s6, s3, 8
  s_add_u32 s6, s6, 24576
  v_mul_u32_u24 v18, 1088, v17
  v_lshl_add_u32 v18, v16, 3, v18
  v_add_u32 v2, s6, v18
  v_and_b32 v18, 3, v0
  v_mul_u32_u24 v18, 1088, v18
  v_bfe_u32 v19, v0, 2, 3
  v_lshl_add_u32 v18, v19, 3, v18
  v_lshrrev_b32 v19, 5, v0
  v_lshl_add_u32 v18, v19, 7, v18
  v_add_u32 v3, 24576, v18
  v_and_b32 v18, 7, v0
  v_bfe_u32 v19, v0, 3, 1
  v_lshl_or_b32 v18, v19, 4, v18
  v_lshlrev_b32 v18, 4, v18
  v_lshl_add_u32 v18, v17, 9, v18
  v_add_u32 v4, 8192, v18
  v_lshrrev_b32 v18, 2, v16
  v_and_b32 v19, 1, v0
  v_lshl_or_b32 v18, v18, 1, v19
  v_mul_u32_u24 v18, 288, v18
  v_lshl_add_u32 v18, v17, 2, v18
  s_lshl_b32 s6, s3, 6
  s_add_u32 s6, s6, 28928
  v_add_u32 v5, s6, v18
  v_lshrrev_b32 v18, 1, v16
  v_mul_u32_u24 v18, 288, v18
  v_lshl_add_u32 v18, v17, 5, v18
  v_lshl_add_u32 v18, v19, 4, v18
  v_add_u32 v6, 28928, v18
  s_lshl_b32 s6, s3, 15
  s_add_u32 s6, s6, 32768
  v_add_u32 v7, s6, v1
  v_lshrrev_b32 v18, 2, v16
  v_lshlrev_b32 v18, 13, v18
  v_and_b32 v19, 3, v0
  v_lshl_or_b32 v19, v17, 2, v19
  v_lshl_or_b32 v18, v19, 4, v18
  s_lshl_b32 s6, s3, 16
  v_add_u32 v8, s6, v18
  v_lshlrev_b32 v18, 4, v16
  v_lshl_or_b32 v18, v17, 9, v18
  v_add_u32 v9, s37, v18
  v_mov_b32 v10, 0x3f803f80
  v_mov_b32 v11, 0x3f803f80
  v_mov_b32 v12, 0
  v_mov_b32 v13, 0
  v_mov_b32 v14, 0
  v_mov_b32 v15, 0
  buffer_store_dwordx4 v[12:15], v8, s[8:11], s39 offen sc1
  buffer_store_dwordx4 v[12:15], v8, s[8:11], s40 offen sc1
  s_add_u32 s6, s36, 0
  buffer_store_dwordx4 v[12:15], v1, s[8:11], s6 offen sc1
  s_add_u32 s6, s36, 131072
  buffer_store_dwordx4 v[12:15], v1, s[8:11], s6 offen sc1
  s_add_u32 s6, s36, 262144
  buffer_store_dwordx4 v[12:15], v1, s[8:11], s6 offen sc1
  s_add_u32 s6, s36, 393216
  buffer_store_dwordx4 v[12:15], v1, s[8:11], s6 offen sc1
  s_mov_b64 exec, 0xffff
  buffer_store_dwordx4 v[12:15], v1, s[8:11], s43 offen sc1
  s_mov_b64 exec, -1
  s_cmp_eq_u32 s4, 1
  s_cbranch_scc1 L_pro
  s_branch L_rec3
L_rec2:
  v_and_b32 v16, 15, v0
  v_lshrrev_b32 v17, 4, v0
  v_lshlrev_b32 v1, 4, v0
  s_lshl_b32 s6, s3, 8
  s_add_u32 s6, s6, 24576
  v_mul_u32_u24 v18, 1088, v17
  v_lshl_add_u32 v18, v16, 3, v18
  v_add_u32 v2, s6, v18
  v_and_b32 v18, 3, v0
  v_mul_u32_u24 v18, 1088, v18
  v_bfe_u32 v19, v0, 2, 3
  v_lshl_add_u32 v18, v19, 3, v18
  v_lshrrev_b32 v19, 5, v0
  v_lshl_add_u32 v18, v19, 7, v18
  v_add_u32 v3, 24576, v18
  v_and_b32 v18, 7, v0
  v_bfe_u32 v19, v0, 3, 1
  v_lshl_or_b32 v18, v19, 4, v18
  v_lshlrev_b32 v18, 4, v18
  v_lshl_add_u32 v18, v17, 9, v18
  v_add_u32 v4, 8192, v18
  v_lshrrev_b32 v18, 2, v16
  v_and_b32 v19, 1, v0
  v_lshl_or_b32 v18, v18, 1, v19
  v_mul_u32_u24 v18, 288, v18
  v_lshl_add_u32 v18, v17, 2, v18
  s_lshl_b32 s6, s3, 6
  s_add_u32 s6, s6, 28928
  v_add_u32 v5, s6, v18
  v_lshrrev_b32 v18, 1, v16
  v_mul_u32_u24 v18, 288, v18
  v_lshl_add_u32 v18, v17, 5, v18
  v_lshl_add_u32 v18, v19, 4, v18
  v_add_u32 v6, 28928, v18
  s_lshl_b32 s6, s3, 15
  s_add_u32 s6, s6, 32768
  v_add_u32 v7, s6, v1
  v_lshrrev_b32 v18, 2, v16
  v_lshlrev_b32 v18, 13, v18
  v_and_b32 v19, 3, v0
  v_lshl_or_b32 v19, v17, 2, v19
  v_lshl_or_b32 v18, v19, 4, v18
  s_lshl_b32 s6, s3, 16
  v_add_u32 v8, s6, v18
  v_lshlrev_b32 v18, 4, v16
  v_lshl_or_b32 v18, v17, 9, v18
  v_add_u32 v9, s37, v18
  v_mov_b32 v10, 0x3f803f80
  v_mov_b32 v11, 0x3f803f80
  v_mov_b32 v12, 0
  v_mov_b32 v13, 0
  v_mov_b32 v14, 0
  v_mov_b32 v15, 0
L_rec3:
  s_mov_b32 s16, s82
  s_mov_b32 s17, s83
  s_mov_b32 s18, 0x400000
  s_mov_b32 s19, 0x20000
  s_mov_b32 s20, s84
  s_mov_b32 s21, s85
  s_mov_b32 s22, 0x400000
  s_mov_b32 s23, 0x20000
  s_mov_b32 s24, s86
  s_mov_b32 s25, s87
  s_mov_b32 s26, 0x400000
  s_mov_b32 s27, 0x20000
  s_mov_b32 s28, s88
  s_mov_b32 s29, s89
  s_mov_b32 s30, 0x400000
  s_mov_b32 s31, 0x20000
  s_lshr_b32 s6, 0x72, s4
  s_bitcmp1_b32 s6, 0
  s_cbranch_scc1 L_rdn_16
  s_waitcnt vmcnt(0)
  s_barrier
  s_cmp_lg_u32 s3, 0
  s_cbranch_scc1 L_sd_17
  s_mov_b64 exec, 1
  s_and_b32 s6, s4, 3
  s_lshl_b32 s6, s6, 6
  v_mov_b32 v18, 16
  v_mov_b32 v19, 1
  buffer_atomic_add v19, v18, s[12:15], s6 offen sc1
  s_mov_b64 exec, -1
L_sd_17:
L_rdn_16:
  v_bfe_u32 v16, v0, 4, 1
  v_lshrrev_b32 v17, 5, v0
  v_lshl_or_b32 v18, v17, 5, v16
  s_and_b32 s6, s3, 1
  s_lshr_b32 s7, s3, 1
  s_lshl_b32 s60, s6, 4
  s_lshl_b32 s7, s7, 6
  s_add_u32 s7, s7, s60
  v_add_u32 v18, s7, v18
  v_lshlrev_b32 v18, 13, v18
  v_lshrrev_b32 v19, 4, v0
  s_lshl_b32 s6, s6, 2
  v_or_b32 v19, s6, v19
  v_lshlrev_b32 v19, 1, v19
  v_and_b32 v116, 15, v0
  v_xor_b32 v19, v19, v116
  v_lshl_or_b32 v116, v19, 4, v18
  v_bfe_u32 v18, v0, 2, 2
  v_lshl_or_b32 v19, v16, 2, v18
  v_lshl_or_b32 v18, v17, 3, v18
  v_lshl_or_b32 v18, v16, 5, v18
  v_lshlrev_b32 v18, 8, v18
  s_lshl_b32 s6, s3, 1
  v_xor_b32 v19, s6, v19
  v_lshl_or_b32 v18, v19, 5, v18
  v_and_b32 v19, 3, v0
  v_lshl_or_b32 v18, v19, 3, v18
  v_add_u32 v120, 32768, v18
  v_xor_b32 v121, 32, v120
  v_add_u32 v122, 0x10000, v120
  v_add_u32 v123, 0x10000, v121
  v_lshrrev_b32 v16, 4, v0
  v_and_b32 v17, 15, v0
  v_lshlrev_b32 v18, 1, v16
  v_xor_b32 v17, v17, v18
  v_lshlrev_b32 v17, 4, v17
  v_lshl_or_b32 v118, v16, 10, v17
  v_xor_b32 v119, 0x80, v118
  s_lshl_b32 s60, s3, 13
  s_add_u32 s60, s60, 32768
  v_bfe_u32 v17, v0, 2, 2
  v_bfe_u32 v18, v0, 4, 1
  v_lshl_or_b32 v18, v18, 2, v17
  v_lshl_or_b32 v17, v16, 3, v17
  v_lshlrev_b32 v17, 8, v17
  v_lshl_or_b32 v17, v18, 5, v17
  v_lshl_or_b32 v17, v19, 3, v17
  v_add_u32 v124, s60, v17
  v_add_u32 v127, s60, v1
  s_lshl_b32 s63, s5, 8
  s_add_u32 s61, s63, 0
  s_add_u32 m0, s60, 0
  s_add_u32 s62, s61, 0
  buffer_load_dwordx4 v116, s[16:19], s62 offen lds
  s_add_u32 m0, s60, 1024
  s_add_u32 s62, s61, 16384
  buffer_load_dwordx4 v116, s[16:19], s62 offen lds
  s_add_u32 m0, s60, 2048
  s_add_u32 s62, s61, 32768
  buffer_load_dwordx4 v116, s[16:19], s62 offen lds
  s_add_u32 m0, s60, 3072
  s_add_u32 s62, s61, 49152
  buffer_load_dwordx4 v116, s[16:19], s62 offen lds
  s_add_u32 m0, s60, 4096
  s_add_u32 s62, s61, 65536
  buffer_load_dwordx4 v116, s[16:19], s62 offen lds
  s_add_u32 m0, s60, 5120
  s_add_u32 s62, s61, 81920
  buffer_load_dwordx4 v116, s[16:19], s62 offen lds
  s_add_u32 m0, s60, 6144
  s_add_u32 s62, s61, 98304
  buffer_load_dwordx4 v116, s[16:19], s62 offen lds
  s_add_u32 m0, s60, 7168
  s_add_u32 s62, s61, 114688
  buffer_load_dwordx4 v116, s[16:19], s62 offen lds
  s_add_u32 s61, s63, 1048576
  s_add_u32 m0, s60, 32768
  s_add_u32 s62, s61, 0
  buffer_load_dwordx4 v116, s[16:19], s62 offen lds
  s_add_u32 m0, s60, 33792
  s_add_u32 s62, s61, 16384
  buffer_load_dwordx4 v116, s[16:19], s62 offen lds
  s_add_u32 m0, s60, 34816
  s_add_u32 s62, s61, 32768
  buffer_load_dwordx4 v116, s[16:19], s62 offen lds
  s_add_u32 m0, s60, 35840
  s_add_u32 s62, s61, 49152
  buffer_load_dwordx4 v116, s[16:19], s62 offen lds
  s_add_u32 m0, s60, 36864
  s_add_u32 s62, s61, 65536
  buffer_load_dwordx4 v116, s[16:19], s62 offen lds
  s_add_u32 m0, s60, 37888
  s_add_u32 s62, s61, 81920
  buffer_load_dwordx4 v116, s[16:19], s62 offen lds
  s_add_u32 m0, s60, 38912
  s_add_u32 s62, s61, 98304
  buffer_load_dwordx4 v116, s[16:19], s62 offen lds
  s_add_u32 m0, s60, 39936
  s_add_u32 s62, s61, 114688
  buffer_load_dwordx4 v116, s[16:19], s62 offen lds
  s_add_u32 s61, s63, 2097152
  s_add_u32 m0, s60, 65536
  s_add_u32 s62, s61, 0
  buffer_load_dwordx4 v116, s[16:19], s62 offen lds
  s_add_u32 m0, s60, 66560
  s_add_u32 s62, s61, 16384
  buffer_load_dwordx4 v116, s[16:19], s62 offen lds
  s_add_u32 m0, s60, 67584
  s_add_u32 s62, s61, 32768
  buffer_load_dwordx4 v116, s[16:19], s62 offen lds
  s_add_u32 m0, s60, 68608
  s_add_u32 s62, s61, 49152
  buffer_load_dwordx4 v116, s[16:19], s62 offen lds
  s_add_u32 m0, s60, 69632
  s_add_u32 s62, s61, 65536
  buffer_load_dwordx4 v116, s[16:19], s62 offen lds
  s_add_u32 m0, s60, 70656
  s_add_u32 s62, s61, 81920
  buffer_load_dwordx4 v116, s[16:19], s62 offen lds
  s_add_u32 m0, s60, 71680
  s_add_u32 s62, s61, 98304
  buffer_load_dwordx4 v116, s[16:19], s62 offen lds
  s_add_u32 m0, s60, 72704
  s_add_u32 s62, s61, 114688
  buffer_load_dwordx4 v116, s[16:19], s62 offen lds
  s_waitcnt vmcnt(16)
  s_barrier
  s_add_u32 s61, s63, 3145728
  s_add_u32 m0, s60, 98304
  s_add_u32 s62, s61, 0
  buffer_load_dwordx4 v116, s[16:19], s62 offen lds
  s_add_u32 m0, s60, 99328
  s_add_u32 s62, s61, 16384
  buffer_load_dwordx4 v116, s[16:19], s62 offen lds
  s_add_u32 m0, s60, 100352
  s_add_u32 s62, s61, 32768
  buffer_load_dwordx4 v116, s[16:19], s62 offen lds
  s_add_u32 m0, s60, 101376
  s_add_u32 s62, s61, 49152
  buffer_load_dwordx4 v116, s[16:19], s62 offen lds
  s_add_u32 m0, s60, 102400
  s_add_u32 s62, s61, 65536
  buffer_load_dwordx4 v116, s[16:19], s62 offen lds
  s_add_u32 m0, s60, 103424
  s_add_u32 s62, s61, 81920
  buffer_load_dwordx4 v116, s[16:19], s62 offen lds
  s_add_u32 m0, s60, 104448
  s_add_u32 s62, s61, 98304
  buffer_load_dwordx4 v116, s[16:19], s62 offen lds
  s_add_u32 m0, s60, 105472
  s_add_u32 s62, s61, 114688
  buffer_load_dwordx4 v116, s[16:19], s62 offen lds
  s_cmp_eq_u32 s3, 1
  s_cbranch_scc1 L_lv_20
  s_cmp_eq_u32 s3, 2
  s_cbranch_scc1 L_lv_21
  s_cmp_eq_u32 s3, 3
  s_cbranch_scc1 L_lv_22
L_lv_19:
  ds_read_b64_tr_b16 a[0:1], v120 offset:0
  ds_read_b64_tr_b16 a[2:3], v120 offset:1024
  ds_read_b64_tr_b16 a[4:5], v120 offset:4096
  ds_read_b64_tr_b16 a[6:7], v120 offset:5120
  ds_read_b64_tr_b16 a[8:9], v121 offset:0
  ds_read_b64_tr_b16 a[10:11], v121 offset:1024
  ds_read_b64_tr_b16 a[12:13], v121 offset:4096
  ds_read_b64_tr_b16 a[14:15], v121 offset:5120
  ds_read_b64_tr_b16 a[16:17], v120 offset:16384
  ds_read_b64_tr_b16 a[18:19], v120 offset:17408
  ds_read_b64_tr_b16 a[20:21], v120 offset:20480
  ds_read_b64_tr_b16 a[22:23], v120 offset:21504
  ds_read_b64_tr_b16 a[24:25], v121 offset:16384
  ds_read_b64_tr_b16 a[26:27], v121 offset:17408
  ds_read_b64_tr_b16 a[28:29], v121 offset:20480
  ds_read_b64_tr_b16 a[30:31], v121 offset:21504
  s_branch L_lw_18
L_lv_20:
  ds_read_b64_tr_b16 a[96:97], v120 offset:0
  ds_read_b64_tr_b16 a[98:99], v120 offset:1024
  ds_read_b64_tr_b16 a[100:101], v120 offset:4096
  ds_read_b64_tr_b16 a[102:103], v120 offset:5120
  ds_read_b64_tr_b16 a[104:105], v121 offset:0
  ds_read_b64_tr_b16 a[106:107], v121 offset:1024
  ds_read_b64_tr_b16 a[108:109], v121 offset:4096
  ds_read_b64_tr_b16 a[110:111], v121 offset:5120
  ds_read_b64_tr_b16 a[112:113], v120 offset:16384
  ds_read_b64_tr_b16 a[114:115], v120 offset:17408
  ds_read_b64_tr_b16 a[116:117], v120 offset:20480
  ds_read_b64_tr_b16 a[118:119], v120 offset:21504
  ds_read_b64_tr_b16 a[120:121], v121 offset:16384
  ds_read_b64_tr_b16 a[122:123], v121 offset:17408
  ds_read_b64_tr_b16 a[124:125], v121 offset:20480
  ds_read_b64_tr_b16 a[126:127], v121 offset:21504
  s_branch L_lw_18
L_lv_21:
  ds_read_b64_tr_b16 a[64:65], v120 offset:0
  ds_read_b64_tr_b16 a[66:67], v120 offset:1024
  ds_read_b64_tr_b16 a[68:69], v120 offset:4096
  ds_read_b64_tr_b16 a[70:71], v120 offset:5120
  ds_read_b64_tr_b16 a[72:73], v121 offset:0
  ds_read_b64_tr_b16 a[74:75], v121 offset:1024
  ds_read_b64_tr_b16 a[76:77], v121 offset:4096
  ds_read_b64_tr_b16 a[78:79], v121 offset:5120
  ds_read_b64_tr_b16 a[80:81], v120 offset:16384
  ds_read_b64_tr_b16 a[82:83], v120 offset:17408
  ds_read_b64_tr_b16 a[84:85], v120 offset:20480
  ds_read_b64_tr_b16 a[86:87], v120 offset:21504
  ds_read_b64_tr_b16 a[88:89], v121 offset:16384
  ds_read_b64_tr_b16 a[90:91], v121 offset:17408
  ds_read_b64_tr_b16 a[92:93], v121 offset:20480
  ds_read_b64_tr_b16 a[94:95], v121 offset:21504
  s_branch L_lw_18
L_lv_22:
  ds_read_b64_tr_b16 a[32:33], v120 offset:0
  ds_read_b64_tr_b16 a[34:35], v120 offset:1024
  ds_read_b64_tr_b16 a[36:37], v120 offset:4096
  ds_read_b64_tr_b16 a[38:39], v120 offset:5120
  ds_read_b64_tr_b16 a[40:41], v121 offset:0
  ds_read_b64_tr_b16 a[42:43], v121 offset:1024
  ds_read_b64_tr_b16 a[44:45], v121 offset:4096
  ds_read_b64_tr_b16 a[46:47], v121 offset:5120
  ds_read_b64_tr_b16 a[48:49], v120 offset:16384
  ds_read_b64_tr_b16 a[50:51], v120 offset:17408
  ds_read_b64_tr_b16 a[52:53], v120 offset:20480
  ds_read_b64_tr_b16 a[54:55], v120 offset:21504
  ds_read_b64_tr_b16 a[56:57], v121 offset:16384
  ds_read_b64_tr_b16 a[58:59], v121 offset:17408
  ds_read_b64_tr_b16 a[60:61], v121 offset:20480
  ds_read_b64_tr_b16 a[62:63], v121 offset:21504
L_lw_18:
  s_waitcnt lgkmcnt(0)
  s_waitcnt vmcnt(16)
  s_barrier
  s_add_u32 s61, s63, 0
  s_add_u32 m0, s60, 0
  s_add_u32 s62, s61, 0
  buffer_load_dwordx4 v116, s[20:23], s62 offen lds
  s_add_u32 m0, s60, 1024
  s_add_u32 s62, s61, 16384
  buffer_load_dwordx4 v116, s[20:23], s62 offen lds
  s_add_u32 m0, s60, 2048
  s_add_u32 s62, s61, 32768
  buffer_load_dwordx4 v116, s[20:23], s62 offen lds
  s_add_u32 m0, s60, 3072
  s_add_u32 s62, s61, 49152
  buffer_load_dwordx4 v116, s[20:23], s62 offen lds
  s_add_u32 m0, s60, 4096
  s_add_u32 s62, s61, 65536
  buffer_load_dwordx4 v116, s[20:23], s62 offen lds
  s_add_u32 m0, s60, 5120
  s_add_u32 s62, s61, 81920
  buffer_load_dwordx4 v116, s[20:23], s62 offen lds
  s_add_u32 m0, s60, 6144
  s_add_u32 s62, s61, 98304
  buffer_load_dwordx4 v116, s[20:23], s62 offen lds
  s_add_u32 m0, s60, 7168
  s_add_u32 s62, s61, 114688
  buffer_load_dwordx4 v116, s[20:23], s62 offen lds
  s_cmp_eq_u32 s3, 1
  s_cbranch_scc1 L_lv_25
  s_cmp_eq_u32 s3, 2
  s_cbranch_scc1 L_lv_26
  s_cmp_eq_u32 s3, 3
  s_cbranch_scc1 L_lv_27
L_lv_24:
  ds_read_b64_tr_b16 a[32:33], v120 offset:32768
  ds_read_b64_tr_b16 a[34:35], v120 offset:33792
  ds_read_b64_tr_b16 a[36:37], v120 offset:36864
  ds_read_b64_tr_b16 a[38:39], v120 offset:37888
  ds_read_b64_tr_b16 a[40:41], v121 offset:32768
  ds_read_b64_tr_b16 a[42:43], v121 offset:33792
  ds_read_b64_tr_b16 a[44:45], v121 offset:36864
  ds_read_b64_tr_b16 a[46:47], v121 offset:37888
  ds_read_b64_tr_b16 a[48:49], v120 offset:49152
  ds_read_b64_tr_b16 a[50:51], v120 offset:50176
  ds_read_b64_tr_b16 a[52:53], v120 offset:53248
  ds_read_b64_tr_b16 a[54:55], v120 offset:54272
  ds_read_b64_tr_b16 a[56:57], v121 offset:49152
  ds_read_b64_tr_b16 a[58:59], v121 offset:50176
  ds_read_b64_tr_b16 a[60:61], v121 offset:53248
  ds_read_b64_tr_b16 a[62:63], v121 offset:54272
  s_branch L_lw_23
L_lv_25:
  ds_read_b64_tr_b16 a[0:1], v120 offset:32768
  ds_read_b64_tr_b16 a[2:3], v120 offset:33792
  ds_read_b64_tr_b16 a[4:5], v120 offset:36864
  ds_read_b64_tr_b16 a[6:7], v120 offset:37888
  ds_read_b64_tr_b16 a[8:9], v121 offset:32768
  ds_read_b64_tr_b16 a[10:11], v121 offset:33792
  ds_read_b64_tr_b16 a[12:13], v121 offset:36864
  ds_read_b64_tr_b16 a[14:15], v121 offset:37888
  ds_read_b64_tr_b16 a[16:17], v120 offset:49152
  ds_read_b64_tr_b16 a[18:19], v120 offset:50176
  ds_read_b64_tr_b16 a[20:21], v120 offset:53248
  ds_read_b64_tr_b16 a[22:23], v120 offset:54272
  ds_read_b64_tr_b16 a[24:25], v121 offset:49152
  ds_read_b64_tr_b16 a[26:27], v121 offset:50176
  ds_read_b64_tr_b16 a[28:29], v121 offset:53248
  ds_read_b64_tr_b16 a[30:31], v121 offset:54272
  s_branch L_lw_23
L_lv_26:
  ds_read_b64_tr_b16 a[96:97], v120 offset:32768
  ds_read_b64_tr_b16 a[98:99], v120 offset:33792
  ds_read_b64_tr_b16 a[100:101], v120 offset:36864
  ds_read_b64_tr_b16 a[102:103], v120 offset:37888
  ds_read_b64_tr_b16 a[104:105], v121 offset:32768
  ds_read_b64_tr_b16 a[106:107], v121 offset:33792
  ds_read_b64_tr_b16 a[108:109], v121 offset:36864
  ds_read_b64_tr_b16 a[110:111], v121 offset:37888
  ds_read_b64_tr_b16 a[112:113], v120 offset:49152
  ds_read_b64_tr_b16 a[114:115], v120 offset:50176
  ds_read_b64_tr_b16 a[116:117], v120 offset:53248
  ds_read_b64_tr_b16 a[118:119], v120 offset:54272
  ds_read_b64_tr_b16 a[120:121], v121 offset:49152
  ds_read_b64_tr_b16 a[122:123], v121 offset:50176
  ds_read_b64_tr_b16 a[124:125], v121 offset:53248
  ds_read_b64_tr_b16 a[126:127], v121 offset:54272
  s_branch L_lw_23
L_lv_27:
  ds_read_b64_tr_b16 a[64:65], v120 offset:32768
  ds_read_b64_tr_b16 a[66:67], v120 offset:33792
  ds_read_b64_tr_b16 a[68:69], v120 offset:36864
  ds_read_b64_tr_b16 a[70:71], v120 offset:37888
  ds_read_b64_tr_b16 a[72:73], v121 offset:32768
  ds_read_b64_tr_b16 a[74:75], v121 offset:33792
  ds_read_b64_tr_b16 a[76:77], v121 offset:36864
  ds_read_b64_tr_b16 a[78:79], v121 offset:37888
  ds_read_b64_tr_b16 a[80:81], v120 offset:49152
  ds_read_b64_tr_b16 a[82:83], v120 offset:50176
  ds_read_b64_tr_b16 a[84:85], v120 offset:53248
  ds_read_b64_tr_b16 a[86:87], v120 offset:54272
  ds_read_b64_tr_b16 a[88:89], v121 offset:49152
  ds_read_b64_tr_b16 a[90:91], v121 offset:50176
  ds_read_b64_tr_b16 a[92:93], v121 offset:53248
  ds_read_b64_tr_b16 a[94:95], v121 offset:54272
L_lw_23:
  s_waitcnt lgkmcnt(0)
  s_waitcnt vmcnt(16)
  s_barrier
  s_add_u32 s61, s63, 1048576
  s_add_u32 m0, s60, 32768
  s_add_u32 s62, s61, 0
  buffer_load_dwordx4 v116, s[20:23], s62 offen lds
  s_add_u32 m0, s60, 33792
  s_add_u32 s62, s61, 16384
  buffer_load_dwordx4 v116, s[20:23], s62 offen lds
  s_add_u32 m0, s60, 34816
  s_add_u32 s62, s61, 32768
  buffer_load_dwordx4 v116, s[20:23], s62 offen lds
  s_add_u32 m0, s60, 35840
  s_add_u32 s62, s61, 49152
  buffer_load_dwordx4 v116, s[20:23], s62 offen lds
  s_add_u32 m0, s60, 36864
  s_add_u32 s62, s61, 65536
  buffer_load_dwordx4 v116, s[20:23], s62 offen lds
  s_add_u32 m0, s60, 37888
  s_add_u32 s62, s61, 81920
  buffer_load_dwordx4 v116, s[20:23], s62 offen lds
  s_add_u32 m0, s60, 38912
  s_add_u32 s62, s61, 98304
  buffer_load_dwordx4 v116, s[20:23], s62 offen lds
  s_add_u32 m0, s60, 39936
  s_add_u32 s62, s61, 114688
  buffer_load_dwordx4 v116, s[20:23], s62 offen lds
  s_cmp_eq_u32 s3, 1
  s_cbranch_scc1 L_lv_30
  s_cmp_eq_u32 s3, 2
  s_cbranch_scc1 L_lv_31
  s_cmp_eq_u32 s3, 3
  s_cbranch_scc1 L_lv_32
L_lv_29:
  ds_read_b64_tr_b16 a[64:65], v122 offset:0
  ds_read_b64_tr_b16 a[66:67], v122 offset:1024
  ds_read_b64_tr_b16 a[68:69], v122 offset:4096
  ds_read_b64_tr_b16 a[70:71], v122 offset:5120
  ds_read_b64_tr_b16 a[72:73], v123 offset:0
  ds_read_b64_tr_b16 a[74:75], v123 offset:1024
  ds_read_b64_tr_b16 a[76:77], v123 offset:4096
  ds_read_b64_tr_b16 a[78:79], v123 offset:5120
  ds_read_b64_tr_b16 a[80:81], v122 offset:16384
  ds_read_b64_tr_b16 a[82:83], v122 offset:17408
  ds_read_b64_tr_b16 a[84:85], v122 offset:20480
  ds_read_b64_tr_b16 a[86:87], v122 offset:21504
  ds_read_b64_tr_b16 a[88:89], v123 offset:16384
  ds_read_b64_tr_b16 a[90:91], v123 offset:17408
  ds_read_b64_tr_b16 a[92:93], v123 offset:20480
  ds_read_b64_tr_b16 a[94:95], v123 offset:21504
  s_branch L_lw_28
L_lv_30:
  ds_read_b64_tr_b16 a[32:33], v122 offset:0
  ds_read_b64_tr_b16 a[34:35], v122 offset:1024
  ds_read_b64_tr_b16 a[36:37], v122 offset:4096
  ds_read_b64_tr_b16 a[38:39], v122 offset:5120
  ds_read_b64_tr_b16 a[40:41], v123 offset:0
  ds_read_b64_tr_b16 a[42:43], v123 offset:1024
  ds_read_b64_tr_b16 a[44:45], v123 offset:4096
  ds_read_b64_tr_b16 a[46:47], v123 offset:5120
  ds_read_b64_tr_b16 a[48:49], v122 offset:16384
  ds_read_b64_tr_b16 a[50:51], v122 offset:17408
  ds_read_b64_tr_b16 a[52:53], v122 offset:20480
  ds_read_b64_tr_b16 a[54:55], v122 offset:21504
  ds_read_b64_tr_b16 a[56:57], v123 offset:16384
  ds_read_b64_tr_b16 a[58:59], v123 offset:17408
  ds_read_b64_tr_b16 a[60:61], v123 offset:20480
  ds_read_b64_tr_b16 a[62:63], v123 offset:21504
  s_branch L_lw_28
L_lv_31:
  ds_read_b64_tr_b16 a[0:1], v122 offset:0
  ds_read_b64_tr_b16 a[2:3], v122 offset:1024
  ds_read_b64_tr_b16 a[4:5], v122 offset:4096
  ds_read_b64_tr_b16 a[6:7], v122 offset:5120
  ds_read_b64_tr_b16 a[8:9], v123 offset:0
  ds_read_b64_tr_b16 a[10:11], v123 offset:1024
  ds_read_b64_tr_b16 a[12:13], v123 offset:4096
  ds_read_b64_tr_b16 a[14:15], v123 offset:5120
  ds_read_b64_tr_b16 a[16:17], v122 offset:16384
  ds_read_b64_tr_b16 a[18:19], v122 offset:17408
  ds_read_b64_tr_b16 a[20:21], v122 offset:20480
  ds_read_b64_tr_b16 a[22:23], v122 offset:21504
  ds_read_b64_tr_b16 a[24:25], v123 offset:16384
  ds_read_b64_tr_b16 a[26:27], v123 offset:17408
  ds_read_b64_tr_b16 a[28:29], v123 offset:20480
  ds_read_b64_tr_b16 a[30:31], v123 offset:21504
  s_branch L_lw_28
L_lv_32:
  ds_read_b64_tr_b16 a[96:97], v122 offset:0
  ds_read_b64_tr_b16 a[98:99], v122 offset:1024
  ds_read_b64_tr_b16 a[100:101], v122 offset:4096
  ds_read_b64_tr_b16 a[102:103], v122 offset:5120
  ds_read_b64_tr_b16 a[104:105], v123 offset:0
  ds_read_b64_tr_b16 a[106:107], v123 offset:1024
  ds_read_b64_tr_b16 a[108:109], v123 offset:4096
  ds_read_b64_tr_b16 a[110:111], v123 offset:5120
  ds_read_b64_tr_b16 a[112:113], v122 offset:16384
  ds_read_b64_tr_b16 a[114:115], v122 offset:17408
  ds_read_b64_tr_b16 a[116:117], v122 offset:20480
  ds_read_b64_tr_b16 a[118:119], v122 offset:21504
  ds_read_b64_tr_b16 a[120:121], v123 offset:16384
  ds_read_b64_tr_b16 a[122:123], v123 offset:17408
  ds_read_b64_tr_b16 a[124:125], v123 offset:20480
  ds_read_b64_tr_b16 a[126:127], v123 offset:21504
L_lw_28:
  s_waitcnt lgkmcnt(0)
  s_waitcnt vmcnt(16)
  s_barrier
  s_add_u32 s61, s63, 2097152
  s_add_u32 m0, s60, 65536
  s_add_u32 s62, s61, 0
  buffer_load_dwordx4 v116, s[20:23], s62 offen lds
  s_add_u32 m0, s60, 66560
  s_add_u32 s62, s61, 16384
  buffer_load_dwordx4 v116, s[20:23], s62 offen lds
  s_add_u32 m0, s60, 67584
  s_add_u32 s62, s61, 32768
  buffer_load_dwordx4 v116, s[20:23], s62 offen lds
  s_add_u32 m0, s60, 68608
  s_add_u32 s62, s61, 49152
  buffer_load_dwordx4 v116, s[20:23], s62 offen lds
  s_add_u32 m0, s60, 69632
  s_add_u32 s62, s61, 65536
  buffer_load_dwordx4 v116, s[20:23], s62 offen lds
  s_add_u32 m0, s60, 70656
  s_add_u32 s62, s61, 81920
  buffer_load_dwordx4 v116, s[20:23], s62 offen lds
  s_add_u32 m0, s60, 71680
  s_add_u32 s62, s61, 98304
  buffer_load_dwordx4 v116, s[20:23], s62 offen lds
  s_add_u32 m0, s60, 72704
  s_add_u32 s62, s61, 114688
  buffer_load_dwordx4 v116, s[20:23], s62 offen lds
  s_cmp_eq_u32 s3, 1
  s_cbranch_scc1 L_lv_35
  s_cmp_eq_u32 s3, 2
  s_cbranch_scc1 L_lv_36
  s_cmp_eq_u32 s3, 3
  s_cbranch_scc1 L_lv_37
L_lv_34:
  ds_read_b64_tr_b16 a[96:97], v122 offset:32768
  ds_read_b64_tr_b16 a[98:99], v122 offset:33792
  ds_read_b64_tr_b16 a[100:101], v122 offset:36864
  ds_read_b64_tr_b16 a[102:103], v122 offset:37888
  ds_read_b64_tr_b16 a[104:105], v123 offset:32768
  ds_read_b64_tr_b16 a[106:107], v123 offset:33792
  ds_read_b64_tr_b16 a[108:109], v123 offset:36864
  ds_read_b64_tr_b16 a[110:111], v123 offset:37888
  ds_read_b64_tr_b16 a[112:113], v122 offset:49152
  ds_read_b64_tr_b16 a[114:115], v122 offset:50176
  ds_read_b64_tr_b16 a[116:117], v122 offset:53248
  ds_read_b64_tr_b16 a[118:119], v122 offset:54272
  ds_read_b64_tr_b16 a[120:121], v123 offset:49152
  ds_read_b64_tr_b16 a[122:123], v123 offset:50176
  ds_read_b64_tr_b16 a[124:125], v123 offset:53248
  ds_read_b64_tr_b16 a[126:127], v123 offset:54272
  s_branch L_lw_33
L_lv_35:
  ds_read_b64_tr_b16 a[64:65], v122 offset:32768
  ds_read_b64_tr_b16 a[66:67], v122 offset:33792
  ds_read_b64_tr_b16 a[68:69], v122 offset:36864
  ds_read_b64_tr_b16 a[70:71], v122 offset:37888
  ds_read_b64_tr_b16 a[72:73], v123 offset:32768
  ds_read_b64_tr_b16 a[74:75], v123 offset:33792
  ds_read_b64_tr_b16 a[76:77], v123 offset:36864
  ds_read_b64_tr_b16 a[78:79], v123 offset:37888
  ds_read_b64_tr_b16 a[80:81], v122 offset:49152
  ds_read_b64_tr_b16 a[82:83], v122 offset:50176
  ds_read_b64_tr_b16 a[84:85], v122 offset:53248
  ds_read_b64_tr_b16 a[86:87], v122 offset:54272
  ds_read_b64_tr_b16 a[88:89], v123 offset:49152
  ds_read_b64_tr_b16 a[90:91], v123 offset:50176
  ds_read_b64_tr_b16 a[92:93], v123 offset:53248
  ds_read_b64_tr_b16 a[94:95], v123 offset:54272
  s_branch L_lw_33
L_lv_36:
  ds_read_b64_tr_b16 a[32:33], v122 offset:32768
  ds_read_b64_tr_b16 a[34:35], v122 offset:33792
  ds_read_b64_tr_b16 a[36:37], v122 offset:36864
  ds_read_b64_tr_b16 a[38:39], v122 offset:37888
  ds_read_b64_tr_b16 a[40:41], v123 offset:32768
  ds_read_b64_tr_b16 a[42:43], v123 offset:33792
  ds_read_b64_tr_b16 a[44:45], v123 offset:36864
  ds_read_b64_tr_b16 a[46:47], v123 offset:37888
  ds_read_b64_tr_b16 a[48:49], v122 offset:49152
  ds_read_b64_tr_b16 a[50:51], v122 offset:50176
  ds_read_b64_tr_b16 a[52:53], v122 offset:53248
  ds_read_b64_tr_b16 a[54:55], v122 offset:54272
  ds_read_b64_tr_b16 a[56:57], v123 offset:49152
  ds_read_b64_tr_b16 a[58:59], v123 offset:50176
  ds_read_b64_tr_b16 a[60:61], v123 offset:53248
  ds_read_b64_tr_b16 a[62:63], v123 offset:54272
  s_branch L_lw_33
L_lv_37:
  ds_read_b64_tr_b16 a[0:1], v122 offset:32768
  ds_read_b64_tr_b16 a[2:3], v122 offset:33792
  ds_read_b64_tr_b16 a[4:5], v122 offset:36864
  ds_read_b64_tr_b16 a[6:7], v122 offset:37888
  ds_read_b64_tr_b16 a[8:9], v123 offset:32768
  ds_read_b64_tr_b16 a[10:11], v123 offset:33792
  ds_read_b64_tr_b16 a[12:13], v123 offset:36864
  ds_read_b64_tr_b16 a[14:15], v123 offset:37888
  ds_read_b64_tr_b16 a[16:17], v122 offset:49152
  ds_read_b64_tr_b16 a[18:19], v122 offset:50176
  ds_read_b64_tr_b16 a[20:21], v122 offset:53248
  ds_read_b64_tr_b16 a[22:23], v122 offset:54272
  ds_read_b64_tr_b16 a[24:25], v123 offset:49152
  ds_read_b64_tr_b16 a[26:27], v123 offset:50176
  ds_read_b64_tr_b16 a[28:29], v123 offset:53248
  ds_read_b64_tr_b16 a[30:31], v123 offset:54272
L_lw_33:
  s_waitcnt lgkmcnt(0)
  s_waitcnt vmcnt(16)
  s_barrier
  s_add_u32 s61, s63, 3145728
  s_add_u32 m0, s60, 98304
  s_add_u32 s62, s61, 0
  buffer_load_dwordx4 v116, s[20:23], s62 offen lds
  s_add_u32 m0, s60, 99328
  s_add_u32 s62, s61, 16384
  buffer_load_dwordx4 v116, s[20:23], s62 offen lds
  s_add_u32 m0, s60, 100352
  s_add_u32 s62, s61, 32768
  buffer_load_dwordx4 v116, s[20:23], s62 offen lds
  s_add_u32 m0, s60, 101376
  s_add_u32 s62, s61, 49152
  buffer_load_dwordx4 v116, s[20:23], s62 offen lds
  s_add_u32 m0, s60, 102400
  s_add_u32 s62, s61, 65536
  buffer_load_dwordx4 v116, s[20:23], s62 offen lds
  s_add_u32 m0, s60, 103424
  s_add_u32 s62, s61, 81920
  buffer_load_dwordx4 v116, s[20:23], s62 offen lds
  s_add_u32 m0, s60, 104448
  s_add_u32 s62, s61, 98304
  buffer_load_dwordx4 v116, s[20:23], s62 offen lds
  s_add_u32 m0, s60, 105472
  s_add_u32 s62, s61, 114688
  buffer_load_dwordx4 v116, s[20:23], s62 offen lds
  s_cmp_eq_u32 s3, 1
  s_cbranch_scc1 L_lv_40
  s_cmp_eq_u32 s3, 2
  s_cbranch_scc1 L_lv_41
  s_cmp_eq_u32 s3, 3
  s_cbranch_scc1 L_lv_42
L_lv_39:
  ds_read_b64_tr_b16 a[128:129], v120 offset:0
  ds_read_b64_tr_b16 a[130:131], v120 offset:1024
  ds_read_b64_tr_b16 a[132:133], v120 offset:4096
  ds_read_b64_tr_b16 a[134:135], v120 offset:5120
  ds_read_b64_tr_b16 a[136:137], v121 offset:0
  ds_read_b64_tr_b16 a[138:139], v121 offset:1024
  ds_read_b64_tr_b16 a[140:141], v121 offset:4096
  ds_read_b64_tr_b16 a[142:143], v121 offset:5120
  ds_read_b64_tr_b16 a[144:145], v120 offset:16384
  ds_read_b64_tr_b16 a[146:147], v120 offset:17408
  ds_read_b64_tr_b16 a[148:149], v120 offset:20480
  ds_read_b64_tr_b16 a[150:151], v120 offset:21504
  ds_read_b64_tr_b16 a[152:153], v121 offset:16384
  ds_read_b64_tr_b16 a[154:155], v121 offset:17408
  ds_read_b64_tr_b16 a[156:157], v121 offset:20480
  ds_read_b64_tr_b16 a[158:159], v121 offset:21504
  s_branch L_lw_38
L_lv_40:
  ds_read_b64_tr_b16 a[224:225], v120 offset:0
  ds_read_b64_tr_b16 a[226:227], v120 offset:1024
  ds_read_b64_tr_b16 a[228:229], v120 offset:4096
  ds_read_b64_tr_b16 a[230:231], v120 offset:5120
  ds_read_b64_tr_b16 a[232:233], v121 offset:0
  ds_read_b64_tr_b16 a[234:235], v121 offset:1024
  ds_read_b64_tr_b16 a[236:237], v121 offset:4096
  ds_read_b64_tr_b16 a[238:239], v121 offset:5120
  ds_read_b64_tr_b16 a[240:241], v120 offset:16384
  ds_read_b64_tr_b16 a[242:243], v120 offset:17408
  ds_read_b64_tr_b16 a[244:245], v120 offset:20480
  ds_read_b64_tr_b16 a[246:247], v120 offset:21504
  ds_read_b64_tr_b16 a[248:249], v121 offset:16384
  ds_read_b64_tr_b16 a[250:251], v121 offset:17408
  ds_read_b64_tr_b16 a[252:253], v121 offset:20480
  ds_read_b64_tr_b16 a[254:255], v121 offset:21504
  s_branch L_lw_38
L_lv_41:
  ds_read_b64_tr_b16 a[192:193], v120 offset:0
  ds_read_b64_tr_b16 a[194:195], v120 offset:1024
  ds_read_b64_tr_b16 a[196:197], v120 offset:4096
  ds_read_b64_tr_b16 a[198:199], v120 offset:5120
  ds_read_b64_tr_b16 a[200:201], v121 offset:0
  ds_read_b64_tr_b16 a[202:203], v121 offset:1024
  ds_read_b64_tr_b16 a[204:205], v121 offset:4096
  ds_read_b64_tr_b16 a[206:207], v121 offset:5120
  ds_read_b64_tr_b16 a[208:209], v120 offset:16384
  ds_read_b64_tr_b16 a[210:211], v120 offset:17408
  ds_read_b64_tr_b16 a[212:213], v120 offset:20480
  ds_read_b64_tr_b16 a[214:215], v120 offset:21504
  ds_read_b64_tr_b16 a[216:217], v121 offset:16384
  ds_read_b64_tr_b16 a[218:219], v121 offset:17408
  ds_read_b64_tr_b16 a[220:221], v121 offset:20480
  ds_read_b64_tr_b16 a[222:223], v121 offset:21504
  s_branch L_lw_38
L_lv_42:
  ds_read_b64_tr_b16 a[160:161], v120 offset:0
  ds_read_b64_tr_b16 a[162:163], v120 offset:1024
  ds_read_b64_tr_b16 a[164:165], v120 offset:4096
  ds_read_b64_tr_b16 a[166:167], v120 offset:5120
  ds_read_b64_tr_b16 a[168:169], v121 offset:0
  ds_read_b64_tr_b16 a[170:171], v121 offset:1024
  ds_read_b64_tr_b16 a[172:173], v121 offset:4096
  ds_read_b64_tr_b16 a[174:175], v121 offset:5120
  ds_read_b64_tr_b16 a[176:177], v120 offset:16384
  ds_read_b64_tr_b16 a[178:179], v120 offset:17408
  ds_read_b64_tr_b16 a[180:181], v120 offset:20480
  ds_read_b64_tr_b16 a[182:183], v120 offset:21504
  ds_read_b64_tr_b16 a[184:185], v121 offset:16384
  ds_read_b64_tr_b16 a[186:187], v121 offset:17408
  ds_read_b64_tr_b16 a[188:189], v121 offset:20480
  ds_read_b64_tr_b16 a[190:191], v121 offset:21504
L_lw_38:
  s_waitcnt lgkmcnt(0)
  s_waitcnt vmcnt(16)
  s_barrier
  s_add_u32 s61, s63, 0
  s_add_u32 m0, s60, 0
  s_add_u32 s62, s61, 0
  buffer_load_dwordx4 v116, s[24:27], s62 offen lds
  s_add_u32 m0, s60, 1024
  s_add_u32 s62, s61, 16384
  buffer_load_dwordx4 v116, s[24:27], s62 offen lds
  s_add_u32 m0, s60, 2048
  s_add_u32 s62, s61, 32768
  buffer_load_dwordx4 v116, s[24:27], s62 offen lds
  s_add_u32 m0, s60, 3072
  s_add_u32 s62, s61, 49152
  buffer_load_dwordx4 v116, s[24:27], s62 offen lds
  s_add_u32 m0, s60, 4096
  s_add_u32 s62, s61, 65536
  buffer_load_dwordx4 v116, s[24:27], s62 offen lds
  s_add_u32 m0, s60, 5120
  s_add_u32 s62, s61, 81920
  buffer_load_dwordx4 v116, s[24:27], s62 offen lds
  s_add_u32 m0, s60, 6144
  s_add_u32 s62, s61, 98304
  buffer_load_dwordx4 v116, s[24:27], s62 offen lds
  s_add_u32 m0, s60, 7168
  s_add_u32 s62, s61, 114688
  buffer_load_dwordx4 v116, s[24:27], s62 offen lds
  s_cmp_eq_u32 s3, 1
  s_cbranch_scc1 L_lv_45
  s_cmp_eq_u32 s3, 2
  s_cbranch_scc1 L_lv_46
  s_cmp_eq_u32 s3, 3
  s_cbranch_scc1 L_lv_47
L_lv_44:
  ds_read_b64_tr_b16 a[160:161], v120 offset:32768
  ds_read_b64_tr_b16 a[162:163], v120 offset:33792
  ds_read_b64_tr_b16 a[164:165], v120 offset:36864
  ds_read_b64_tr_b16 a[166:167], v120 offset:37888
  ds_read_b64_tr_b16 a[168:169], v121 offset:32768
  ds_read_b64_tr_b16 a[170:171], v121 offset:33792
  ds_read_b64_tr_b16 a[172:173], v121 offset:36864
  ds_read_b64_tr_b16 a[174:175], v121 offset:37888
  ds_read_b64_tr_b16 a[176:177], v120 offset:49152
  ds_read_b64_tr_b16 a[178:179], v120 offset:50176
  ds_read_b64_tr_b16 a[180:181], v120 offset:53248
  ds_read_b64_tr_b16 a[182:183], v120 offset:54272
  ds_read_b64_tr_b16 a[184:185], v121 offset:49152
  ds_read_b64_tr_b16 a[186:187], v121 offset:50176
  ds_read_b64_tr_b16 a[188:189], v121 offset:53248
  ds_read_b64_tr_b16 a[190:191], v121 offset:54272
  s_branch L_lw_43
L_lv_45:
  ds_read_b64_tr_b16 a[128:129], v120 offset:32768
  ds_read_b64_tr_b16 a[130:131], v120 offset:33792
  ds_read_b64_tr_b16 a[132:133], v120 offset:36864
  ds_read_b64_tr_b16 a[134:135], v120 offset:37888
  ds_read_b64_tr_b16 a[136:137], v121 offset:32768
  ds_read_b64_tr_b16 a[138:139], v121 offset:33792
  ds_read_b64_tr_b16 a[140:141], v121 offset:36864
  ds_read_b64_tr_b16 a[142:143], v121 offset:37888
  ds_read_b64_tr_b16 a[144:145], v120 offset:49152
  ds_read_b64_tr_b16 a[146:147], v120 offset:50176
  ds_read_b64_tr_b16 a[148:149], v120 offset:53248
  ds_read_b64_tr_b16 a[150:151], v120 offset:54272
  ds_read_b64_tr_b16 a[152:153], v121 offset:49152
  ds_read_b64_tr_b16 a[154:155], v121 offset:50176
  ds_read_b64_tr_b16 a[156:157], v121 offset:53248
  ds_read_b64_tr_b16 a[158:159], v121 offset:54272
  s_branch L_lw_43
L_lv_46:
  ds_read_b64_tr_b16 a[224:225], v120 offset:32768
  ds_read_b64_tr_b16 a[226:227], v120 offset:33792
  ds_read_b64_tr_b16 a[228:229], v120 offset:36864
  ds_read_b64_tr_b16 a[230:231], v120 offset:37888
  ds_read_b64_tr_b16 a[232:233], v121 offset:32768
  ds_read_b64_tr_b16 a[234:235], v121 offset:33792
  ds_read_b64_tr_b16 a[236:237], v121 offset:36864
  ds_read_b64_tr_b16 a[238:239], v121 offset:37888
  ds_read_b64_tr_b16 a[240:241], v120 offset:49152
  ds_read_b64_tr_b16 a[242:243], v120 offset:50176
  ds_read_b64_tr_b16 a[244:245], v120 offset:53248
  ds_read_b64_tr_b16 a[246:247], v120 offset:54272
  ds_read_b64_tr_b16 a[248:249], v121 offset:49152
  ds_read_b64_tr_b16 a[250:251], v121 offset:50176
  ds_read_b64_tr_b16 a[252:253], v121 offset:53248
  ds_read_b64_tr_b16 a[254:255], v121 offset:54272
  s_branch L_lw_43
L_lv_47:
  ds_read_b64_tr_b16 a[192:193], v120 offset:32768
  ds_read_b64_tr_b16 a[194:195], v120 offset:33792
  ds_read_b64_tr_b16 a[196:197], v120 offset:36864
  ds_read_b64_tr_b16 a[198:199], v120 offset:37888
  ds_read_b64_tr_b16 a[200:201], v121 offset:32768
  ds_read_b64_tr_b16 a[202:203], v121 offset:33792
  ds_read_b64_tr_b16 a[204:205], v121 offset:36864
  ds_read_b64_tr_b16 a[206:207], v121 offset:37888
  ds_read_b64_tr_b16 a[208:209], v120 offset:49152
  ds_read_b64_tr_b16 a[210:211], v120 offset:50176
  ds_read_b64_tr_b16 a[212:213], v120 offset:53248
  ds_read_b64_tr_b16 a[214:215], v120 offset:54272
  ds_read_b64_tr_b16 a[216:217], v121 offset:49152
  ds_read_b64_tr_b16 a[218:219], v121 offset:50176
  ds_read_b64_tr_b16 a[220:221], v121 offset:53248
  ds_read_b64_tr_b16 a[222:223], v121 offset:54272
L_lw_43:
  s_waitcnt lgkmcnt(0)
  s_waitcnt vmcnt(16)
  s_barrier
  s_add_u32 s61, s63, 1048576
  s_add_u32 m0, s60, 32768
  s_add_u32 s62, s61, 0
  buffer_load_dwordx4 v116, s[24:27], s62 offen lds
  s_add_u32 m0, s60, 33792
  s_add_u32 s62, s61, 16384
  buffer_load_dwordx4 v116, s[24:27], s62 offen lds
  s_add_u32 m0, s60, 34816
  s_add_u32 s62, s61, 32768
  buffer_load_dwordx4 v116, s[24:27], s62 offen lds
  s_add_u32 m0, s60, 35840
  s_add_u32 s62, s61, 49152
  buffer_load_dwordx4 v116, s[24:27], s62 offen lds
  s_add_u32 m0, s60, 36864
  s_add_u32 s62, s61, 65536
  buffer_load_dwordx4 v116, s[24:27], s62 offen lds
  s_add_u32 m0, s60, 37888
  s_add_u32 s62, s61, 81920
  buffer_load_dwordx4 v116, s[24:27], s62 offen lds
  s_add_u32 m0, s60, 38912
  s_add_u32 s62, s61, 98304
  buffer_load_dwordx4 v116, s[24:27], s62 offen lds
  s_add_u32 m0, s60, 39936
  s_add_u32 s62, s61, 114688
  buffer_load_dwordx4 v116, s[24:27], s62 offen lds
  s_cmp_eq_u32 s3, 1
  s_cbranch_scc1 L_lv_50
  s_cmp_eq_u32 s3, 2
  s_cbranch_scc1 L_lv_51
  s_cmp_eq_u32 s3, 3
  s_cbranch_scc1 L_lv_52
L_lv_49:
  ds_read_b64_tr_b16 a[192:193], v122 offset:0
  ds_read_b64_tr_b16 a[194:195], v122 offset:1024
  ds_read_b64_tr_b16 a[196:197], v122 offset:4096
  ds_read_b64_tr_b16 a[198:199], v122 offset:5120
  ds_read_b64_tr_b16 a[200:201], v123 offset:0
  ds_read_b64_tr_b16 a[202:203], v123 offset:1024
  ds_read_b64_tr_b16 a[204:205], v123 offset:4096
  ds_read_b64_tr_b16 a[206:207], v123 offset:5120
  ds_read_b64_tr_b16 a[208:209], v122 offset:16384
  ds_read_b64_tr_b16 a[210:211], v122 offset:17408
  ds_read_b64_tr_b16 a[212:213], v122 offset:20480
  ds_read_b64_tr_b16 a[214:215], v122 offset:21504
  ds_read_b64_tr_b16 a[216:217], v123 offset:16384
  ds_read_b64_tr_b16 a[218:219], v123 offset:17408
  ds_read_b64_tr_b16 a[220:221], v123 offset:20480
  ds_read_b64_tr_b16 a[222:223], v123 offset:21504
  s_branch L_lw_48
L_lv_50:
  ds_read_b64_tr_b16 a[160:161], v122 offset:0
  ds_read_b64_tr_b16 a[162:163], v122 offset:1024
  ds_read_b64_tr_b16 a[164:165], v122 offset:4096
  ds_read_b64_tr_b16 a[166:167], v122 offset:5120
  ds_read_b64_tr_b16 a[168:169], v123 offset:0
  ds_read_b64_tr_b16 a[170:171], v123 offset:1024
  ds_read_b64_tr_b16 a[172:173], v123 offset:4096
  ds_read_b64_tr_b16 a[174:175], v123 offset:5120
  ds_read_b64_tr_b16 a[176:177], v122 offset:16384
  ds_read_b64_tr_b16 a[178:179], v122 offset:17408
  ds_read_b64_tr_b16 a[180:181], v122 offset:20480
  ds_read_b64_tr_b16 a[182:183], v122 offset:21504
  ds_read_b64_tr_b16 a[184:185], v123 offset:16384
  ds_read_b64_tr_b16 a[186:187], v123 offset:17408
  ds_read_b64_tr_b16 a[188:189], v123 offset:20480
  ds_read_b64_tr_b16 a[190:191], v123 offset:21504
  s_branch L_lw_48
L_lv_51:
  ds_read_b64_tr_b16 a[128:129], v122 offset:0
  ds_read_b64_tr_b16 a[130:131], v122 offset:1024
  ds_read_b64_tr_b16 a[132:133], v122 offset:4096
  ds_read_b64_tr_b16 a[134:135], v122 offset:5120
  ds_read_b64_tr_b16 a[136:137], v123 offset:0
  ds_read_b64_tr_b16 a[138:139], v123 offset:1024
  ds_read_b64_tr_b16 a[140:141], v123 offset:4096
  ds_read_b64_tr_b16 a[142:143], v123 offset:5120
  ds_read_b64_tr_b16 a[144:145], v122 offset:16384
  ds_read_b64_tr_b16 a[146:147], v122 offset:17408
  ds_read_b64_tr_b16 a[148:149], v122 offset:20480
  ds_read_b64_tr_b16 a[150:151], v122 offset:21504
  ds_read_b64_tr_b16 a[152:153], v123 offset:16384
  ds_read_b64_tr_b16 a[154:155], v123 offset:17408
  ds_read_b64_tr_b16 a[156:157], v123 offset:20480
  ds_read_b64_tr_b16 a[158:159], v123 offset:21504
  s_branch L_lw_48
L_lv_52:
  ds_read_b64_tr_b16 a[224:225], v122 offset:0
  ds_read_b64_tr_b16 a[226:227], v122 offset:1024
  ds_read_b64_tr_b16 a[228:229], v122 offset:4096
  ds_read_b64_tr_b16 a[230:231], v122 offset:5120
  ds_read_b64_tr_b16 a[232:233], v123 offset:0
  ds_read_b64_tr_b16 a[234:235], v123 offset:1024
  ds_read_b64_tr_b16 a[236:237], v123 offset:4096
  ds_read_b64_tr_b16 a[238:239], v123 offset:5120
  ds_read_b64_tr_b16 a[240:241], v122 offset:16384
  ds_read_b64_tr_b16 a[242:243], v122 offset:17408
  ds_read_b64_tr_b16 a[244:245], v122 offset:20480
  ds_read_b64_tr_b16 a[246:247], v122 offset:21504
  ds_read_b64_tr_b16 a[248:249], v123 offset:16384
  ds_read_b64_tr_b16 a[250:251], v123 offset:17408
  ds_read_b64_tr_b16 a[252:253], v123 offset:20480
  ds_read_b64_tr_b16 a[254:255], v123 offset:21504
L_lw_48:
  s_waitcnt lgkmcnt(0)
  s_waitcnt vmcnt(16)
  s_barrier
  s_add_u32 s61, s63, 2097152
  s_add_u32 m0, s60, 65536
  s_add_u32 s62, s61, 0
  buffer_load_dwordx4 v116, s[24:27], s62 offen lds
  s_add_u32 m0, s60, 66560
  s_add_u32 s62, s61, 16384
  buffer_load_dwordx4 v116, s[24:27], s62 offen lds
  s_add_u32 m0, s60, 67584
  s_add_u32 s62, s61, 32768
  buffer_load_dwordx4 v116, s[24:27], s62 offen lds
  s_add_u32 m0, s60, 68608
  s_add_u32 s62, s61, 49152
  buffer_load_dwordx4 v116, s[24:27], s62 offen lds
  s_add_u32 m0, s60, 69632
  s_add_u32 s62, s61, 65536
  buffer_load_dwordx4 v116, s[24:27], s62 offen lds
  s_add_u32 m0, s60, 70656
  s_add_u32 s62, s61, 81920
  buffer_load_dwordx4 v116, s[24:27], s62 offen lds
  s_add_u32 m0, s60, 71680
  s_add_u32 s62, s61, 98304
  buffer_load_dwordx4 v116, s[24:27], s62 offen lds
  s_add_u32 m0, s60, 72704
  s_add_u32 s62, s61, 114688
  buffer_load_dwordx4 v116, s[24:27], s62 offen lds
  s_cmp_eq_u32 s3, 1
  s_cbranch_scc1 L_lv_55
  s_cmp_eq_u32 s3, 2
  s_cbranch_scc1 L_lv_56
  s_cmp_eq_u32 s3, 3
  s_cbranch_scc1 L_lv_57
L_lv_54:
  ds_read_b64_tr_b16 a[224:225], v122 offset:32768
  ds_read_b64_tr_b16 a[226:227], v122 offset:33792
  ds_read_b64_tr_b16 a[228:229], v122 offset:36864
  ds_read_b64_tr_b16 a[230:231], v122 offset:37888
  ds_read_b64_tr_b16 a[232:233], v123 offset:32768
  ds_read_b64_tr_b16 a[234:235], v123 offset:33792
  ds_read_b64_tr_b16 a[236:237], v123 offset:36864
  ds_read_b64_tr_b16 a[238:239], v123 offset:37888
  ds_read_b64_tr_b16 a[240:241], v122 offset:49152
  ds_read_b64_tr_b16 a[242:243], v122 offset:50176
  ds_read_b64_tr_b16 a[244:245], v122 offset:53248
  ds_read_b64_tr_b16 a[246:247], v122 offset:54272
  ds_read_b64_tr_b16 a[248:249], v123 offset:49152
  ds_read_b64_tr_b16 a[250:251], v123 offset:50176
  ds_read_b64_tr_b16 a[252:253], v123 offset:53248
  ds_read_b64_tr_b16 a[254:255], v123 offset:54272
  s_branch L_lw_53
L_lv_55:
  ds_read_b64_tr_b16 a[192:193], v122 offset:32768
  ds_read_b64_tr_b16 a[194:195], v122 offset:33792
  ds_read_b64_tr_b16 a[196:197], v122 offset:36864
  ds_read_b64_tr_b16 a[198:199], v122 offset:37888
  ds_read_b64_tr_b16 a[200:201], v123 offset:32768
  ds_read_b64_tr_b16 a[202:203], v123 offset:33792
  ds_read_b64_tr_b16 a[204:205], v123 offset:36864
  ds_read_b64_tr_b16 a[206:207], v123 offset:37888
  ds_read_b64_tr_b16 a[208:209], v122 offset:49152
  ds_read_b64_tr_b16 a[210:211], v122 offset:50176
  ds_read_b64_tr_b16 a[212:213], v122 offset:53248
  ds_read_b64_tr_b16 a[214:215], v122 offset:54272
  ds_read_b64_tr_b16 a[216:217], v123 offset:49152
  ds_read_b64_tr_b16 a[218:219], v123 offset:50176
  ds_read_b64_tr_b16 a[220:221], v123 offset:53248
  ds_read_b64_tr_b16 a[222:223], v123 offset:54272
  s_branch L_lw_53
L_lv_56:
  ds_read_b64_tr_b16 a[160:161], v122 offset:32768
  ds_read_b64_tr_b16 a[162:163], v122 offset:33792
  ds_read_b64_tr_b16 a[164:165], v122 offset:36864
  ds_read_b64_tr_b16 a[166:167], v122 offset:37888
  ds_read_b64_tr_b16 a[168:169], v123 offset:32768
  ds_read_b64_tr_b16 a[170:171], v123 offset:33792
  ds_read_b64_tr_b16 a[172:173], v123 offset:36864
  ds_read_b64_tr_b16 a[174:175], v123 offset:37888
  ds_read_b64_tr_b16 a[176:177], v122 offset:49152
  ds_read_b64_tr_b16 a[178:179], v122 offset:50176
  ds_read_b64_tr_b16 a[180:181], v122 offset:53248
  ds_read_b64_tr_b16 a[182:183], v122 offset:54272
  ds_read_b64_tr_b16 a[184:185], v123 offset:49152
  ds_read_b64_tr_b16 a[186:187], v123 offset:50176
  ds_read_b64_tr_b16 a[188:189], v123 offset:53248
  ds_read_b64_tr_b16 a[190:191], v123 offset:54272
  s_branch L_lw_53
L_lv_57:
  ds_read_b64_tr_b16 a[128:129], v122 offset:32768
  ds_read_b64_tr_b16 a[130:131], v122 offset:33792
  ds_read_b64_tr_b16 a[132:133], v122 offset:36864
  ds_read_b64_tr_b16 a[134:135], v122 offset:37888
  ds_read_b64_tr_b16 a[136:137], v123 offset:32768
  ds_read_b64_tr_b16 a[138:139], v123 offset:33792
  ds_read_b64_tr_b16 a[140:141], v123 offset:36864
  ds_read_b64_tr_b16 a[142:143], v123 offset:37888
  ds_read_b64_tr_b16 a[144:145], v122 offset:49152
  ds_read_b64_tr_b16 a[146:147], v122 offset:50176
  ds_read_b64_tr_b16 a[148:149], v122 offset:53248
  ds_read_b64_tr_b16 a[150:151], v122 offset:54272
  ds_read_b64_tr_b16 a[152:153], v123 offset:49152
  ds_read_b64_tr_b16 a[154:155], v123 offset:50176
  ds_read_b64_tr_b16 a[156:157], v123 offset:53248
  ds_read_b64_tr_b16 a[158:159], v123 offset:54272
L_lw_53:
  s_waitcnt lgkmcnt(0)
  s_waitcnt vmcnt(16)
  s_barrier
  s_add_u32 s61, s63, 3145728
  s_add_u32 m0, s60, 98304
  s_add_u32 s62, s61, 0
  buffer_load_dwordx4 v116, s[24:27], s62 offen lds
  s_add_u32 m0, s60, 99328
  s_add_u32 s62, s61, 16384
  buffer_load_dwordx4 v116, s[24:27], s62 offen lds
  s_add_u32 m0, s60, 100352
  s_add_u32 s62, s61, 32768
  buffer_load_dwordx4 v116, s[24:27], s62 offen lds
  s_add_u32 m0, s60, 101376
  s_add_u32 s62, s61, 49152
  buffer_load_dwordx4 v116, s[24:27], s62 offen lds
  s_add_u32 m0, s60, 102400
  s_add_u32 s62, s61, 65536
  buffer_load_dwordx4 v116, s[24:27], s62 offen lds
  s_add_u32 m0, s60, 103424
  s_add_u32 s62, s61, 81920
  buffer_load_dwordx4 v116, s[24:27], s62 offen lds
  s_add_u32 m0, s60, 104448
  s_add_u32 s62, s61, 98304
  buffer_load_dwordx4 v116, s[24:27], s62 offen lds
  s_add_u32 m0, s60, 105472
  s_add_u32 s62, s61, 114688
  buffer_load_dwordx4 v116, s[24:27], s62 offen lds
  s_cmp_eq_u32 s3, 1
  s_cbranch_scc1 L_lv_60
  s_cmp_eq_u32 s3, 2
  s_cbranch_scc1 L_lv_61
  s_cmp_eq_u32 s3, 3
  s_cbranch_scc1 L_lv_62
L_lv_59:
  ds_read_b64_tr_b16 v[128:129], v120 offset:0
  ds_read_b64_tr_b16 v[130:131], v120 offset:1024
  ds_read_b64_tr_b16 v[132:133], v120 offset:4096
  ds_read_b64_tr_b16 v[134:135], v120 offset:5120
  ds_read_b64_tr_b16 v[136:137], v121 offset:0
  ds_read_b64_tr_b16 v[138:139], v121 offset:1024
  ds_read_b64_tr_b16 v[140:141], v121 offset:4096
  ds_read_b64_tr_b16 v[142:143], v121 offset:5120
  ds_read_b64_tr_b16 v[144:145], v120 offset:16384
  ds_read_b64_tr_b16 v[146:147], v120 offset:17408
  ds_read_b64_tr_b16 v[148:149], v120 offset:20480
  ds_read_b64_tr_b16 v[150:151], v120 offset:21504
  ds_read_b64_tr_b16 v[152:153], v121 offset:16384
  ds_read_b64_tr_b16 v[154:155], v121 offset:17408
  ds_read_b64_tr_b16 v[156:157], v121 offset:20480
  ds_read_b64_tr_b16 v[158:159], v121 offset:21504
  s_branch L_lw_58
L_lv_60:
  ds_read_b64_tr_b16 v[224:225], v120 offset:0
  ds_read_b64_tr_b16 v[226:227], v120 offset:1024
  ds_read_b64_tr_b16 v[228:229], v120 offset:4096
  ds_read_b64_tr_b16 v[230:231], v120 offset:5120
  ds_read_b64_tr_b16 v[232:233], v121 offset:0
  ds_read_b64_tr_b16 v[234:235], v121 offset:1024
  ds_read_b64_tr_b16 v[236:237], v121 offset:4096
  ds_read_b64_tr_b16 v[238:239], v121 offset:5120
  ds_read_b64_tr_b16 v[240:241], v120 offset:16384
  ds_read_b64_tr_b16 v[242:243], v120 offset:17408
  ds_read_b64_tr_b16 v[244:245], v120 offset:20480
  ds_read_b64_tr_b16 v[246:247], v120 offset:21504
  ds_read_b64_tr_b16 v[248:249], v121 offset:16384
  ds_read_b64_tr_b16 v[250:251], v121 offset:17408
  ds_read_b64_tr_b16 v[252:253], v121 offset:20480
  ds_read_b64_tr_b16 v[254:255], v121 offset:21504
  s_branch L_lw_58
L_lv_61:
  ds_read_b64_tr_b16 v[192:193], v120 offset:0
  ds_read_b64_tr_b16 v[194:195], v120 offset:1024
  ds_read_b64_tr_b16 v[196:197], v120 offset:4096
  ds_read_b64_tr_b16 v[198:199], v120 offset:5120
  ds_read_b64_tr_b16 v[200:201], v121 offset:0
  ds_read_b64_tr_b16 v[202:203], v121 offset:1024
  ds_read_b64_tr_b16 v[204:205], v121 offset:4096
  ds_read_b64_tr_b16 v[206:207], v121 offset:5120
  ds_read_b64_tr_b16 v[208:209], v120 offset:16384
  ds_read_b64_tr_b16 v[210:211], v120 offset:17408
  ds_read_b64_tr_b16 v[212:213], v120 offset:20480
  ds_read_b64_tr_b16 v[214:215], v120 offset:21504
  ds_read_b64_tr_b16 v[216:217], v121 offset:16384
  ds_read_b64_tr_b16 v[218:219], v121 offset:17408
  ds_read_b64_tr_b16 v[220:221], v121 offset:20480
  ds_read_b64_tr_b16 v[222:223], v121 offset:21504
  s_branch L_lw_58
L_lv_62:
  ds_read_b64_tr_b16 v[160:161], v120 offset:0
  ds_read_b64_tr_b16 v[162:163], v120 offset:1024
  ds_read_b64_tr_b16 v[164:165], v120 offset:4096
  ds_read_b64_tr_b16 v[166:167], v120 offset:5120
  ds_read_b64_tr_b16 v[168:169], v121 offset:0
  ds_read_b64_tr_b16 v[170:171], v121 offset:1024
  ds_read_b64_tr_b16 v[172:173], v121 offset:4096
  ds_read_b64_tr_b16 v[174:175], v121 offset:5120
  ds_read_b64_tr_b16 v[176:177], v120 offset:16384
  ds_read_b64_tr_b16 v[178:179], v120 offset:17408
  ds_read_b64_tr_b16 v[180:181], v120 offset:20480
  ds_read_b64_tr_b16 v[182:183], v120 offset:21504
  ds_read_b64_tr_b16 v[184:185], v121 offset:16384
  ds_read_b64_tr_b16 v[186:187], v121 offset:17408
  ds_read_b64_tr_b16 v[188:189], v121 offset:20480
  ds_read_b64_tr_b16 v[190:191], v121 offset:21504
L_lw_58:
  s_waitcnt lgkmcnt(0)
  s_waitcnt vmcnt(16)
  s_barrier
  s_lshl_b32 s61, s5, 17
  s_lshl_b32 s62, s3, 15
  s_add_u32 s61, s61, s62
  s_add_u32 s61, s61, 0
  s_add_u32 m0, s60, 0
  s_add_u32 s62, s61, 0
  buffer_load_dwordx4 v118, s[28:31], s62 offen lds
  s_add_u32 m0, s60, 1024
  s_add_u32 s62, s61, 4096
  buffer_load_dwordx4 v118, s[28:31], s62 offen lds
  s_add_u32 m0, s60, 2048
  s_add_u32 s62, s61, 8192
  buffer_load_dwordx4 v119, s[28:31], s62 offen lds
  s_add_u32 m0, s60, 3072
  s_add_u32 s62, s61, 12288
  buffer_load_dwordx4 v119, s[28:31], s62 offen lds
  s_add_u32 m0, s60, 4096
  s_add_u32 s62, s61, 16384
  buffer_load_dwordx4 v118, s[28:31], s62 offen lds
  s_add_u32 m0, s60, 5120
  s_add_u32 s62, s61, 20480
  buffer_load_dwordx4 v118, s[28:31], s62 offen lds
  s_add_u32 m0, s60, 6144
  s_add_u32 s62, s61, 24576
  buffer_load_dwordx4 v119, s[28:31], s62 offen lds
  s_add_u32 m0, s60, 7168
  s_add_u32 s62, s61, 28672
  buffer_load_dwordx4 v119, s[28:31], s62 offen lds
  s_cmp_eq_u32 s3, 1
  s_cbranch_scc1 L_lv_65
  s_cmp_eq_u32 s3, 2
  s_cbranch_scc1 L_lv_66
  s_cmp_eq_u32 s3, 3
  s_cbranch_scc1 L_lv_67
L_lv_64:
  ds_read_b64_tr_b16 v[160:161], v120 offset:32768
  ds_read_b64_tr_b16 v[162:163], v120 offset:33792
  ds_read_b64_tr_b16 v[164:165], v120 offset:36864
  ds_read_b64_tr_b16 v[166:167], v120 offset:37888
  ds_read_b64_tr_b16 v[168:169], v121 offset:32768
  ds_read_b64_tr_b16 v[170:171], v121 offset:33792
  ds_read_b64_tr_b16 v[172:173], v121 offset:36864
  ds_read_b64_tr_b16 v[174:175], v121 offset:37888
  ds_read_b64_tr_b16 v[176:177], v120 offset:49152
  ds_read_b64_tr_b16 v[178:179], v120 offset:50176
  ds_read_b64_tr_b16 v[180:181], v120 offset:53248
  ds_read_b64_tr_b16 v[182:183], v120 offset:54272
  ds_read_b64_tr_b16 v[184:185], v121 offset:49152
  ds_read_b64_tr_b16 v[186:187], v121 offset:50176
  ds_read_b64_tr_b16 v[188:189], v121 offset:53248
  ds_read_b64_tr_b16 v[190:191], v121 offset:54272
  s_branch L_lw_63
L_lv_65:
  ds_read_b64_tr_b16 v[128:129], v120 offset:32768
  ds_read_b64_tr_b16 v[130:131], v120 offset:33792
  ds_read_b64_tr_b16 v[132:133], v120 offset:36864
  ds_read_b64_tr_b16 v[134:135], v120 offset:37888
  ds_read_b64_tr_b16 v[136:137], v121 offset:32768
  ds_read_b64_tr_b16 v[138:139], v121 offset:33792
  ds_read_b64_tr_b16 v[140:141], v121 offset:36864
  ds_read_b64_tr_b16 v[142:143], v121 offset:37888
  ds_read_b64_tr_b16 v[144:145], v120 offset:49152
  ds_read_b64_tr_b16 v[146:147], v120 offset:50176
  ds_read_b64_tr_b16 v[148:149], v120 offset:53248
  ds_read_b64_tr_b16 v[150:151], v120 offset:54272
  ds_read_b64_tr_b16 v[152:153], v121 offset:49152
  ds_read_b64_tr_b16 v[154:155], v121 offset:50176
  ds_read_b64_tr_b16 v[156:157], v121 offset:53248
  ds_read_b64_tr_b16 v[158:159], v121 offset:54272
  s_branch L_lw_63
L_lv_66:
  ds_read_b64_tr_b16 v[224:225], v120 offset:32768
  ds_read_b64_tr_b16 v[226:227], v120 offset:33792
  ds_read_b64_tr_b16 v[228:229], v120 offset:36864
  ds_read_b64_tr_b16 v[230:231], v120 offset:37888
  ds_read_b64_tr_b16 v[232:233], v121 offset:32768
  ds_read_b64_tr_b16 v[234:235], v121 offset:33792
  ds_read_b64_tr_b16 v[236:237], v121 offset:36864
  ds_read_b64_tr_b16 v[238:239], v121 offset:37888
  ds_read_b64_tr_b16 v[240:241], v120 offset:49152
  ds_read_b64_tr_b16 v[242:243], v120 offset:50176
  ds_read_b64_tr_b16 v[244:245], v120 offset:53248
  ds_read_b64_tr_b16 v[246:247], v120 offset:54272
  ds_read_b64_tr_b16 v[248:249], v121 offset:49152
  ds_read_b64_tr_b16 v[250:251], v121 offset:50176
  ds_read_b64_tr_b16 v[252:253], v121 offset:53248
  ds_read_b64_tr_b16 v[254:255], v121 offset:54272
  s_branch L_lw_63
L_lv_67:
  ds_read_b64_tr_b16 v[192:193], v120 offset:32768
  ds_read_b64_tr_b16 v[194:195], v120 offset:33792
  ds_read_b64_tr_b16 v[196:197], v120 offset:36864
  ds_read_b64_tr_b16 v[198:199], v120 offset:37888
  ds_read_b64_tr_b16 v[200:201], v121 offset:32768
  ds_read_b64_tr_b16 v[202:203], v121 offset:33792
  ds_read_b64_tr_b16 v[204:205], v121 offset:36864
  ds_read_b64_tr_b16 v[206:207], v121 offset:37888
  ds_read_b64_tr_b16 v[208:209], v120 offset:49152
  ds_read_b64_tr_b16 v[210:211], v120 offset:50176
  ds_read_b64_tr_b16 v[212:213], v120 offset:53248
  ds_read_b64_tr_b16 v[214:215], v120 offset:54272
  ds_read_b64_tr_b16 v[216:217], v121 offset:49152
  ds_read_b64_tr_b16 v[218:219], v121 offset:50176
  ds_read_b64_tr_b16 v[220:221], v121 offset:53248
  ds_read_b64_tr_b16 v[222:223], v121 offset:54272
L_lw_63:
  s_waitcnt lgkmcnt(0)
  s_waitcnt vmcnt(16)
  s_barrier
  s_lshl_b32 s61, s5, 17
  s_lshl_b32 s62, s3, 15
  s_add_u32 s61, s61, s62
  s_add_u32 s61, s61, 256
  s_add_u32 m0, s60, 32768
  s_add_u32 s62, s61, 0
  buffer_load_dwordx4 v118, s[28:31], s62 offen lds
  s_add_u32 m0, s60, 33792
  s_add_u32 s62, s61, 4096
  buffer_load_dwordx4 v118, s[28:31], s62 offen lds
  s_add_u32 m0, s60, 34816
  s_add_u32 s62, s61, 8192
  buffer_load_dwordx4 v119, s[28:31], s62 offen lds
  s_add_u32 m0, s60, 35840
  s_add_u32 s62, s61, 12288
  buffer_load_dwordx4 v119, s[28:31], s62 offen lds
  s_add_u32 m0, s60, 36864
  s_add_u32 s62, s61, 16384
  buffer_load_dwordx4 v118, s[28:31], s62 offen lds
  s_add_u32 m0, s60, 37888
  s_add_u32 s62, s61, 20480
  buffer_load_dwordx4 v118, s[28:31], s62 offen lds
  s_add_u32 m0, s60, 38912
  s_add_u32 s62, s61, 24576
  buffer_load_dwordx4 v119, s[28:31], s62 offen lds
  s_add_u32 m0, s60, 39936
  s_add_u32 s62, s61, 28672
  buffer_load_dwordx4 v119, s[28:31], s62 offen lds
  s_cmp_eq_u32 s3, 1
  s_cbranch_scc1 L_lv_70
  s_cmp_eq_u32 s3, 2
  s_cbranch_scc1 L_lv_71
  s_cmp_eq_u32 s3, 3
  s_cbranch_scc1 L_lv_72
L_lv_69:
  ds_read_b64_tr_b16 v[192:193], v122 offset:0
  ds_read_b64_tr_b16 v[194:195], v122 offset:1024
  ds_read_b64_tr_b16 v[196:197], v122 offset:4096
  ds_read_b64_tr_b16 v[198:199], v122 offset:5120
  ds_read_b64_tr_b16 v[200:201], v123 offset:0
  ds_read_b64_tr_b16 v[202:203], v123 offset:1024
  ds_read_b64_tr_b16 v[204:205], v123 offset:4096
  ds_read_b64_tr_b16 v[206:207], v123 offset:5120
  ds_read_b64_tr_b16 v[208:209], v122 offset:16384
  ds_read_b64_tr_b16 v[210:211], v122 offset:17408
  ds_read_b64_tr_b16 v[212:213], v122 offset:20480
  ds_read_b64_tr_b16 v[214:215], v122 offset:21504
  ds_read_b64_tr_b16 v[216:217], v123 offset:16384
  ds_read_b64_tr_b16 v[218:219], v123 offset:17408
  ds_read_b64_tr_b16 v[220:221], v123 offset:20480
  ds_read_b64_tr_b16 v[222:223], v123 offset:21504
  s_branch L_lw_68
L_lv_70:
  ds_read_b64_tr_b16 v[160:161], v122 offset:0
  ds_read_b64_tr_b16 v[162:163], v122 offset:1024
  ds_read_b64_tr_b16 v[164:165], v122 offset:4096
  ds_read_b64_tr_b16 v[166:167], v122 offset:5120
  ds_read_b64_tr_b16 v[168:169], v123 offset:0
  ds_read_b64_tr_b16 v[170:171], v123 offset:1024
  ds_read_b64_tr_b16 v[172:173], v123 offset:4096
  ds_read_b64_tr_b16 v[174:175], v123 offset:5120
  ds_read_b64_tr_b16 v[176:177], v122 offset:16384
  ds_read_b64_tr_b16 v[178:179], v122 offset:17408
  ds_read_b64_tr_b16 v[180:181], v122 offset:20480
  ds_read_b64_tr_b16 v[182:183], v122 offset:21504
  ds_read_b64_tr_b16 v[184:185], v123 offset:16384
  ds_read_b64_tr_b16 v[186:187], v123 offset:17408
  ds_read_b64_tr_b16 v[188:189], v123 offset:20480
  ds_read_b64_tr_b16 v[190:191], v123 offset:21504
  s_branch L_lw_68
L_lv_71:
  ds_read_b64_tr_b16 v[128:129], v122 offset:0
  ds_read_b64_tr_b16 v[130:131], v122 offset:1024
  ds_read_b64_tr_b16 v[132:133], v122 offset:4096
  ds_read_b64_tr_b16 v[134:135], v122 offset:5120
  ds_read_b64_tr_b16 v[136:137], v123 offset:0
  ds_read_b64_tr_b16 v[138:139], v123 offset:1024
  ds_read_b64_tr_b16 v[140:141], v123 offset:4096
  ds_read_b64_tr_b16 v[142:143], v123 offset:5120
  ds_read_b64_tr_b16 v[144:145], v122 offset:16384
  ds_read_b64_tr_b16 v[146:147], v122 offset:17408
  ds_read_b64_tr_b16 v[148:149], v122 offset:20480
  ds_read_b64_tr_b16 v[150:151], v122 offset:21504
  ds_read_b64_tr_b16 v[152:153], v123 offset:16384
  ds_read_b64_tr_b16 v[154:155], v123 offset:17408
  ds_read_b64_tr_b16 v[156:157], v123 offset:20480
  ds_read_b64_tr_b16 v[158:159], v123 offset:21504
  s_branch L_lw_68
L_lv_72:
  ds_read_b64_tr_b16 v[224:225], v122 offset:0
  ds_read_b64_tr_b16 v[226:227], v122 offset:1024
  ds_read_b64_tr_b16 v[228:229], v122 offset:4096
  ds_read_b64_tr_b16 v[230:231], v122 offset:5120
  ds_read_b64_tr_b16 v[232:233], v123 offset:0
  ds_read_b64_tr_b16 v[234:235], v123 offset:1024
  ds_read_b64_tr_b16 v[236:237], v123 offset:4096
  ds_read_b64_tr_b16 v[238:239], v123 offset:5120
  ds_read_b64_tr_b16 v[240:241], v122 offset:16384
  ds_read_b64_tr_b16 v[242:243], v122 offset:17408
  ds_read_b64_tr_b16 v[244:245], v122 offset:20480
  ds_read_b64_tr_b16 v[246:247], v122 offset:21504
  ds_read_b64_tr_b16 v[248:249], v123 offset:16384
  ds_read_b64_tr_b16 v[250:251], v123 offset:17408
  ds_read_b64_tr_b16 v[252:253], v123 offset:20480
  ds_read_b64_tr_b16 v[254:255], v123 offset:21504
L_lw_68:
  s_waitcnt lgkmcnt(0)
  s_waitcnt vmcnt(16)
  s_barrier
  s_lshl_b32 s61, s5, 17
  s_lshl_b32 s62, s3, 15
  s_add_u32 s61, s61, s62
  s_add_u32 s61, s61, 512
  s_add_u32 m0, s60, 65536
  s_add_u32 s62, s61, 0
  buffer_load_dwordx4 v118, s[28:31], s62 offen lds
  s_add_u32 m0, s60, 66560
  s_add_u32 s62, s61, 4096
  buffer_load_dwordx4 v118, s[28:31], s62 offen lds
  s_add_u32 m0, s60, 67584
  s_add_u32 s62, s61, 8192
  buffer_load_dwordx4 v119, s[28:31], s62 offen lds
  s_add_u32 m0, s60, 68608
  s_add_u32 s62, s61, 12288
  buffer_load_dwordx4 v119, s[28:31], s62 offen lds
  s_add_u32 m0, s60, 69632
  s_add_u32 s62, s61, 16384
  buffer_load_dwordx4 v118, s[28:31], s62 offen lds
  s_add_u32 m0, s60, 70656
  s_add_u32 s62, s61, 20480
  buffer_load_dwordx4 v118, s[28:31], s62 offen lds
  s_add_u32 m0, s60, 71680
  s_add_u32 s62, s61, 24576
  buffer_load_dwordx4 v119, s[28:31], s62 offen lds
  s_add_u32 m0, s60, 72704
  s_add_u32 s62, s61, 28672
  buffer_load_dwordx4 v119, s[28:31], s62 offen lds
  s_cmp_eq_u32 s3, 1
  s_cbranch_scc1 L_lv_75
  s_cmp_eq_u32 s3, 2
  s_cbranch_scc1 L_lv_76
  s_cmp_eq_u32 s3, 3
  s_cbranch_scc1 L_lv_77
L_lv_74:
  ds_read_b64_tr_b16 v[224:225], v122 offset:32768
  ds_read_b64_tr_b16 v[226:227], v122 offset:33792
  ds_read_b64_tr_b16 v[228:229], v122 offset:36864
  ds_read_b64_tr_b16 v[230:231], v122 offset:37888
  ds_read_b64_tr_b16 v[232:233], v123 offset:32768
  ds_read_b64_tr_b16 v[234:235], v123 offset:33792
  ds_read_b64_tr_b16 v[236:237], v123 offset:36864
  ds_read_b64_tr_b16 v[238:239], v123 offset:37888
  ds_read_b64_tr_b16 v[240:241], v122 offset:49152
  ds_read_b64_tr_b16 v[242:243], v122 offset:50176
  ds_read_b64_tr_b16 v[244:245], v122 offset:53248
  ds_read_b64_tr_b16 v[246:247], v122 offset:54272
  ds_read_b64_tr_b16 v[248:249], v123 offset:49152
  ds_read_b64_tr_b16 v[250:251], v123 offset:50176
  ds_read_b64_tr_b16 v[252:253], v123 offset:53248
  ds_read_b64_tr_b16 v[254:255], v123 offset:54272
  s_branch L_lw_73
L_lv_75:
  ds_read_b64_tr_b16 v[192:193], v122 offset:32768
  ds_read_b64_tr_b16 v[194:195], v122 offset:33792
  ds_read_b64_tr_b16 v[196:197], v122 offset:36864
  ds_read_b64_tr_b16 v[198:199], v122 offset:37888
  ds_read_b64_tr_b16 v[200:201], v123 offset:32768
  ds_read_b64_tr_b16 v[202:203], v123 offset:33792
  ds_read_b64_tr_b16 v[204:205], v123 offset:36864
  ds_read_b64_tr_b16 v[206:207], v123 offset:37888
  ds_read_b64_tr_b16 v[208:209], v122 offset:49152
  ds_read_b64_tr_b16 v[210:211], v122 offset:50176
  ds_read_b64_tr_b16 v[212:213], v122 offset:53248
  ds_read_b64_tr_b16 v[214:215], v122 offset:54272
  ds_read_b64_tr_b16 v[216:217], v123 offset:49152
  ds_read_b64_tr_b16 v[218:219], v123 offset:50176
  ds_read_b64_tr_b16 v[220:221], v123 offset:53248
  ds_read_b64_tr_b16 v[222:223], v123 offset:54272
  s_branch L_lw_73
L_lv_76:
  ds_read_b64_tr_b16 v[160:161], v122 offset:32768
  ds_read_b64_tr_b16 v[162:163], v122 offset:33792
  ds_read_b64_tr_b16 v[164:165], v122 offset:36864
  ds_read_b64_tr_b16 v[166:167], v122 offset:37888
  ds_read_b64_tr_b16 v[168:169], v123 offset:32768
  ds_read_b64_tr_b16 v[170:171], v123 offset:33792
  ds_read_b64_tr_b16 v[172:173], v123 offset:36864
  ds_read_b64_tr_b16 v[174:175], v123 offset:37888
  ds_read_b64_tr_b16 v[176:177], v122 offset:49152
  ds_read_b64_tr_b16 v[178:179], v122 offset:50176
  ds_read_b64_tr_b16 v[180:181], v122 offset:53248
  ds_read_b64_tr_b16 v[182:183], v122 offset:54272
  ds_read_b64_tr_b16 v[184:185], v123 offset:49152
  ds_read_b64_tr_b16 v[186:187], v123 offset:50176
  ds_read_b64_tr_b16 v[188:189], v123 offset:53248
  ds_read_b64_tr_b16 v[190:191], v123 offset:54272
  s_branch L_lw_73
L_lv_77:
  ds_read_b64_tr_b16 v[128:129], v122 offset:32768
  ds_read_b64_tr_b16 v[130:131], v122 offset:33792
  ds_read_b64_tr_b16 v[132:133], v122 offset:36864
  ds_read_b64_tr_b16 v[134:135], v122 offset:37888
  ds_read_b64_tr_b16 v[136:137], v123 offset:32768
  ds_read_b64_tr_b16 v[138:139], v123 offset:33792
  ds_read_b64_tr_b16 v[140:141], v123 offset:36864
  ds_read_b64_tr_b16 v[142:143], v123 offset:37888
  ds_read_b64_tr_b16 v[144:145], v122 offset:49152
  ds_read_b64_tr_b16 v[146:147], v122 offset:50176
  ds_read_b64_tr_b16 v[148:149], v122 offset:53248
  ds_read_b64_tr_b16 v[150:151], v122 offset:54272
  ds_read_b64_tr_b16 v[152:153], v123 offset:49152
  ds_read_b64_tr_b16 v[154:155], v123 offset:50176
  ds_read_b64_tr_b16 v[156:157], v123 offset:53248
  ds_read_b64_tr_b16 v[158:159], v123 offset:54272
L_lw_73:
  s_waitcnt lgkmcnt(0)
  s_waitcnt vmcnt(16)
  s_barrier
  s_lshl_b32 s61, s5, 17
  s_lshl_b32 s62, s3, 15
  s_add_u32 s61, s61, s62
  s_add_u32 s61, s61, 768
  s_add_u32 m0, s60, 98304
  s_add_u32 s62, s61, 0
  buffer_load_dwordx4 v118, s[28:31], s62 offen lds
  s_add_u32 m0, s60, 99328
  s_add_u32 s62, s61, 4096
  buffer_load_dwordx4 v118, s[28:31], s62 offen lds
  s_add_u32 m0, s60, 100352
  s_add_u32 s62, s61, 8192
  buffer_load_dwordx4 v119, s[28:31], s62 offen lds
  s_add_u32 m0, s60, 101376
  s_add_u32 s62, s61, 12288
  buffer_load_dwordx4 v119, s[28:31], s62 offen lds
  s_add_u32 m0, s60, 102400
  s_add_u32 s62, s61, 16384
  buffer_load_dwordx4 v118, s[28:31], s62 offen lds
  s_add_u32 m0, s60, 103424
  s_add_u32 s62, s61, 20480
  buffer_load_dwordx4 v118, s[28:31], s62 offen lds
  s_add_u32 m0, s60, 104448
  s_add_u32 s62, s61, 24576
  buffer_load_dwordx4 v119, s[28:31], s62 offen lds
  s_add_u32 m0, s60, 105472
  s_add_u32 s62, s61, 28672
  buffer_load_dwordx4 v119, s[28:31], s62 offen lds
  v_xor_b32 v126, 0, v124
  ds_read_b64_tr_b16 v[20:21], v126 offset:0
  ds_read_b64_tr_b16 v[22:23], v126 offset:1024
  v_xor_b32 v126, 32, v124
  ds_read_b64_tr_b16 v[24:25], v126 offset:0
  ds_read_b64_tr_b16 v[26:27], v126 offset:1024
  v_xor_b32 v126, 64, v124
  ds_read_b64_tr_b16 v[28:29], v126 offset:0
  ds_read_b64_tr_b16 v[30:31], v126 offset:1024
  v_xor_b32 v126, 96, v124
  ds_read_b64_tr_b16 v[32:33], v126 offset:0
  ds_read_b64_tr_b16 v[34:35], v126 offset:1024
  v_xor_b32 v126, 128, v124
  ds_read_b64_tr_b16 v[36:37], v126 offset:0
  ds_read_b64_tr_b16 v[38:39], v126 offset:1024
  v_xor_b32 v126, 160, v124
  ds_read_b64_tr_b16 v[40:41], v126 offset:0
  ds_read_b64_tr_b16 v[42:43], v126 offset:1024
  v_xor_b32 v126, 192, v124
  ds_read_b64_tr_b16 v[44:45], v126 offset:0
  ds_read_b64_tr_b16 v[46:47], v126 offset:1024
  v_xor_b32 v126, 224, v124
  ds_read_b64_tr_b16 v[48:49], v126 offset:0
  ds_read_b64_tr_b16 v[50:51], v126 offset:1024
  s_waitcnt lgkmcnt(0)
  ds_write_b128 v127, v[20:23] offset:0
  ds_write_b128 v127, v[24:27] offset:1024
  ds_write_b128 v127, v[28:31] offset:2048
  ds_write_b128 v127, v[32:35] offset:3072
  ds_write_b128 v127, v[36:39] offset:4096
  ds_write_b128 v127, v[40:43] offset:5120
  ds_write_b128 v127, v[44:47] offset:6144
  ds_write_b128 v127, v[48:51] offset:7168
  s_waitcnt lgkmcnt(0)
  v_add_u32 v124, 0x8000, v124
  v_add_u32 v127, 0x8000, v127
  s_waitcnt vmcnt(16)
  v_xor_b32 v126, 0, v124
  ds_read_b64_tr_b16 v[20:21], v126 offset:0
  ds_read_b64_tr_b16 v[22:23], v126 offset:1024
  v_xor_b32 v126, 32, v124
  ds_read_b64_tr_b16 v[24:25], v126 offset:0
  ds_read_b64_tr_b16 v[26:27], v126 offset:1024
  v_xor_b32 v126, 64, v124
  ds_read_b64_tr_b16 v[28:29], v126 offset:0
  ds_read_b64_tr_b16 v[30:31], v126 offset:1024
  v_xor_b32 v126, 96, v124
  ds_read_b64_tr_b16 v[32:33], v126 offset:0
  ds_read_b64_tr_b16 v[34:35], v126 offset:1024
  v_xor_b32 v126, 128, v124
  ds_read_b64_tr_b16 v[36:37], v126 offset:0
  ds_read_b64_tr_b16 v[38:39], v126 offset:1024
  v_xor_b32 v126, 160, v124
  ds_read_b64_tr_b16 v[40:41], v126 offset:0
  ds_read_b64_tr_b16 v[42:43], v126 offset:1024
  v_xor_b32 v126, 192, v124
  ds_read_b64_tr_b16 v[44:45], v126 offset:0
  ds_read_b64_tr_b16 v[46:47], v126 offset:1024
  v_xor_b32 v126, 224, v124
  ds_read_b64_tr_b16 v[48:49], v126 offset:0
  ds_read_b64_tr_b16 v[50:51], v126 offset:1024
  s_waitcnt lgkmcnt(0)
  ds_write_b128 v127, v[20:23] offset:0
  ds_write_b128 v127, v[24:27] offset:1024
  ds_write_b128 v127, v[28:31] offset:2048
  ds_write_b128 v127, v[32:35] offset:3072
  ds_write_b128 v127, v[36:39] offset:4096
  ds_write_b128 v127, v[40:43] offset:5120
  ds_write_b128 v127, v[44:47] offset:6144
  ds_write_b128 v127, v[48:51] offset:7168
  s_waitcnt lgkmcnt(0)
  v_add_u32 v124, 0x8000, v124
  v_add_u32 v127, 0x8000, v127
  s_waitcnt vmcnt(8)
  v_xor_b32 v126, 0, v124
  ds_read_b64_tr_b16 v[20:21], v126 offset:0
  ds_read_b64_tr_b16 v[22:23], v126 offset:1024
  v_xor_b32 v126, 32, v124
  ds_read_b64_tr_b16 v[24:25], v126 offset:0
  ds_read_b64_tr_b16 v[26:27], v126 offset:1024
  v_xor_b32 v126, 64, v124
  ds_read_b64_tr_b16 v[28:29], v126 offset:0
  ds_read_b64_tr_b16 v[30:31], v126 offset:1024
  v_xor_b32 v126, 96, v124
  ds_read_b64_tr_b16 v[32:33], v126 offset:0
  ds_read_b64_tr_b16 v[34:35], v126 offset:1024
  v_xor_b32 v126, 128, v124
  ds_read_b64_tr_b16 v[36:37], v126 offset:0
  ds_read_b64_tr_b16 v[38:39], v126 offset:1024
  v_xor_b32 v126, 160, v124
  ds_read_b64_tr_b16 v[40:41], v126 offset:0
  ds_read_b64_tr_b16 v[42:43], v126 offset:1024
  v_xor_b32 v126, 192, v124
  ds_read_b64_tr_b16 v[44:45], v126 offset:0
  ds_read_b64_tr_b16 v[46:47], v126 offset:1024
  v_xor_b32 v126, 224, v124
  ds_read_b64_tr_b16 v[48:49], v126 offset:0
  ds_read_b64_tr_b16 v[50:51], v126 offset:1024
  s_waitcnt lgkmcnt(0)
  ds_write_b128 v127, v[20:23] offset:0
  ds_write_b128 v127, v[24:27] offset:1024
  ds_write_b128 v127, v[28:31] offset:2048
  ds_write_b128 v127, v[32:35] offset:3072
  ds_write_b128 v127, v[36:39] offset:4096
  ds_write_b128 v127, v[40:43] offset:5120
  ds_write_b128 v127, v[44:47] offset:6144
  ds_write_b128 v127, v[48:51] offset:7168
  s_waitcnt lgkmcnt(0)
  v_add_u32 v124, 0x8000, v124
  v_add_u32 v127, 0x8000, v127
  s_waitcnt vmcnt(0)
  v_xor_b32 v126, 0, v124
  ds_read_b64_tr_b16 v[20:21], v126 offset:0
  ds_read_b64_tr_b16 v[22:23], v126 offset:1024
  v_xor_b32 v126, 32, v124
  ds_read_b64_tr_b16 v[24:25], v126 offset:0
  ds_read_b64_tr_b16 v[26:27], v126 offset:1024
  v_xor_b32 v126, 64, v124
  ds_read_b64_tr_b16 v[28:29], v126 offset:0
  ds_read_b64_tr_b16 v[30:31], v126 offset:1024
  v_xor_b32 v126, 96, v124
  ds_read_b64_tr_b16 v[32:33], v126 offset:0
  ds_read_b64_tr_b16 v[34:35], v126 offset:1024
  v_xor_b32 v126, 128, v124
  ds_read_b64_tr_b16 v[36:37], v126 offset:0
  ds_read_b64_tr_b16 v[38:39], v126 offset:1024
  v_xor_b32 v126, 160, v124
  ds_read_b64_tr_b16 v[40:41], v126 offset:0
  ds_read_b64_tr_b16 v[42:43], v126 offset:1024
  v_xor_b32 v126, 192, v124
  ds_read_b64_tr_b16 v[44:45], v126 offset:0
  ds_read_b64_tr_b16 v[46:47], v126 offset:1024
  v_xor_b32 v126, 224, v124
  ds_read_b64_tr_b16 v[48:49], v126 offset:0
  ds_read_b64_tr_b16 v[50:51], v126 offset:1024
  s_waitcnt lgkmcnt(0)
  ds_write_b128 v127, v[20:23] offset:0
  ds_write_b128 v127, v[24:27] offset:1024
  ds_write_b128 v127, v[28:31] offset:2048
  ds_write_b128 v127, v[32:35] offset:3072
  ds_write_b128 v127, v[36:39] offset:4096
  ds_write_b128 v127, v[40:43] offset:5120
  ds_write_b128 v127, v[44:47] offset:6144
  ds_write_b128 v127, v[48:51] offset:7168
  s_waitcnt lgkmcnt(0)
  v_add_u32 v124, 0x8000, v124
  v_add_u32 v127, 0x8000, v127
  s_mov_b32 s16, s80
  s_mov_b32 s17, s81
  s_mov_b32 s18, 0x2000
  s_mov_b32 s19, 0x20000
  v_and_b32 v16, 15, v0
  v_lshrrev_b32 v17, 1, v16
  v_lshlrev_b32 v17, 10, v17
  v_and_b32 v18, 1, v0
  v_lshl_or_b32 v17, v18, 6, v17
  v_lshrrev_b32 v19, 4, v0
  v_lshl_or_b32 v17, v19, 3, v17
  s_lshl_b32 s6, s3, 8
  buffer_load_dwordx2 v[20:21], v17, s[16:19], s6 offen offset:0
  buffer_load_dwordx2 v[22:23], v17, s[16:19], s6 offen offset:32
  buffer_load_dwordx2 v[24:25], v17, s[16:19], s6 offen offset:128
  buffer_load_dwordx2 v[26:27], v17, s[16:19], s6 offen offset:160
  v_mov_b32 v19, 0x4444
  v_mov_b32 v16, 0xeeee
  v_cmp_eq_u32 vcc, 0, v18
  s_nop 1
  v_cndmask_b32 v0, v16, v19, vcc
  s_mov_b32 s7, 0
  v_mbcnt_lo_u32_b32 v16, -1, 0
  v_and_b32 v16, 3, v16
  v_lshlrev_b32 v16, 6, v16
L_wd_78:
  buffer_load_dword v17, v16, s[12:15], 0 offen offset:16 sc1
  s_waitcnt vmcnt(0)
  v_cmp_ne_u32 vcc, 64, v17
  s_cbranch_vccz L_wdo_79
  s_add_u32 s7, s7, 1
  s_cmp_lt_u32 s7, 131072
  s_cbranch_scc1 L_wd_78
  s_mov_b32 s6, 10
  s_branch L_err
L_wdo_79:
  s_mov_b32 s32, 0
  s_mov_b32 s49, 1
  s_mov_b32 s33, 1
  s_mov_b32 s59, 1
  s_and_b32 s6, s32, 3
  s_lshl_b32 s6, s6, 19
  s_add_u32 s6, s6, s35
  s_sub_u32 s60, s6, s53
  s_add_u32 s61, s60, 4096
  s_mov_b32 s7, 0
L_kvs_80:
  buffer_load_dwordx4 v[52:55], v4, s[8:11], s60 offen offset:0 sc1
  buffer_load_dwordx4 v[68:71], v4, s[8:11], s60 offen offset:128 sc1
  buffer_load_dwordx4 v[56:59], v4, s[8:11], s60 offen offset:2048 sc1
  buffer_load_dwordx4 v[72:75], v4, s[8:11], s60 offen offset:2176 sc1
  buffer_load_dwordx4 v[60:63], v4, s[8:11], s61 offen offset:0 sc1
  buffer_load_dwordx4 v[76:79], v4, s[8:11], s61 offen offset:128 sc1
  buffer_load_dwordx4 v[64:67], v4, s[8:11], s61 offen offset:2048 sc1
  buffer_load_dwordx4 v[80:83], v4, s[8:11], s61 offen offset:2176 sc1
  buffer_load_dwordx4 v[108:111], v9, s[8:11], s60 offen offset:0 sc1
  buffer_load_dwordx4 v[112:115], v9, s[8:11], s60 offen offset:256 sc1
  s_waitcnt vmcnt(0)
  v_bitop3_b32 v16, v52, v56, s59 bitop3:0x7e
  v_bitop3_b32 v17, v60, v64, s59 bitop3:0x7e
  v_bitop3_b32 v18, v68, v72, s59 bitop3:0x7e
  v_bitop3_b32 v19, v76, v80, s59 bitop3:0x7e
  v_or3_b32 v16, v16, v17, v18
  v_bitop3_b32 v17, v108, v112, s59 bitop3:0x7e
  v_or3_b32 v16, v16, v17, v19
  v_and_b32 v16, 1, v16
  v_cmp_ne_u32 vcc, 0, v16
  s_cbranch_vccz L_rec_go
  s_add_u32 s7, s7, 1
  s_cmp_lt_u32 s7, 131072
  s_cbranch_scc1 L_kvs_80
  s_mov_b32 s6, 13
  s_branch L_err
L_rec_go:
  s_add_u32 s6, s32, 1
  s_and_b32 s6, s6, 3
  s_lshl_b32 s6, s6, 19
  s_add_u32 s50, s35, s6
  s_add_u32 s51, s50, 0x2000
  v_add_u32 v116, s48, v1
  v_add_u32 v117, s45, v1
  v_add_u32 v118, s46, v1
  v_add_u32 v119, s47, v1
  v_mov_b64 v[84:85], 0
  v_mov_b64 v[86:87], 0
  v_mov_b64 v[88:89], 0
  v_mov_b64 v[90:91], 0
  v_mov_b64 v[92:93], 0
  v_mov_b64 v[94:95], 0
  v_mov_b64 v[96:97], 0
  v_mov_b64 v[98:99], 0
  v_mov_b64 v[100:101], 0
  v_mov_b64 v[102:103], 0
  v_mov_b64 v[104:105], 0
  v_mov_b64 v[106:107], 0
  s_mov_b64 s[60:61], 0
  s_branch L_rec_step
L_rec_loop:
  buffer_load_dwordx4 v[20:23], v1, s[8:11], s44 offen sc1
  buffer_load_dwordx4 v[24:27], v1, s[8:11], s44 offen offset:1024 sc1
  s_mov_b32 s7, 0
  v_add_u32 v116, s48, v1
  v_add_u32 v117, s45, v1
  v_add_u32 v118, s46, v1
  v_add_u32 v119, s47, v1
  v_mov_b64 v[84:85], 0
  v_mov_b64 v[86:87], 0
  v_mov_b64 v[88:89], 0
  v_mov_b64 v[90:91], 0
  v_mov_b64 v[92:93], 0
  v_mov_b64 v[94:95], 0
  v_mov_b64 v[96:97], 0
  v_mov_b64 v[98:99], 0
  v_mov_b64 v[100:101], 0
  v_mov_b64 v[102:103], 0
  v_mov_b64 v[104:105], 0
  v_mov_b64 v[106:107], 0
  buffer_load_dwordx4 v[120:123], v1, s[8:11], s44 offen sc1
  buffer_load_dwordx4 v[124:127], v1, s[8:11], s44 offen offset:1024 sc1
  s_branch L_rec_gather1
L_rec_gather:
  buffer_load_dwordx4 v[120:123], v1, s[8:11], s44 offen sc1
  buffer_load_dwordx4 v[124:127], v1, s[8:11], s44 offen offset:1024 sc1
L_rec_gather1:
  s_waitcnt vmcnt(2)
  v_bitop3_b32 v16, v20, v22, s33 bitop3:0x7e
  v_bitop3_b32 v17, v24, v26, s33 bitop3:0x7e
  v_bitop3_b32 v16, v16, v17, 1 bitop3:0xa8
  v_cmp_ne_u32 vcc, 0, v16
  s_cbranch_vccz L_rec_got
  buffer_load_dwordx4 v[20:23], v1, s[8:11], s44 offen sc1
  buffer_load_dwordx4 v[24:27], v1, s[8:11], s44 offen offset:1024 sc1
  s_waitcnt vmcnt(2)
  v_bitop3_b32 v16, v120, v122, s33 bitop3:0x7e
  v_bitop3_b32 v17, v124, v126, s33 bitop3:0x7e
  v_bitop3_b32 v16, v16, v17, 1 bitop3:0xa8
  v_cmp_ne_u32 vcc, 0, v16
  s_cbranch_vccz L_rec_got1
  s_and_b32 s6, s7, 31
  s_cmp_lg_u32 s6, 31
  s_cbranch_scc1 L_tf_81
  buffer_wbl2 sc1
  s_waitcnt vmcnt(0)
  buffer_inv sc1
  s_waitcnt vmcnt(0)
L_tf_81:
  s_add_u32 s7, s7, 1
  s_cmp_lt_u32 s7, 131072
  s_cbranch_scc1 L_rec_gather
  s_mov_b32 s6, 12
  s_branch L_err
L_rec_got1:
  v_mov_b64 v[20:21], v[120:121]
  v_mov_b64 v[22:23], v[122:123]
  v_mov_b64 v[24:25], v[124:125]
  v_mov_b64 v[26:27], v[126:127]
L_rec_got:
  s_mov_b32 s63, s7
  s_xor_b32 s33, s33, 1
L_rec_step:
  ds_write_b128 v116, v[20:23]
  ds_write_b128 v116, v[24:27] offset:1024
  v_smfmac_f32_16x16x64_bf16 v[84:87], v[20:23], a[0:7], v0
  s_and_b32 s6, s32, 3
  v_smfmac_f32_16x16x64_bf16 v[88:91], v[20:23], a[8:15], v0
  s_lshl_b32 s6, s6, 17
  v_smfmac_f32_16x16x64_bf16 v[84:87], v[24:27], a[16:23], v0
  s_add_u32 s52, s36, s6
  v_smfmac_f32_16x16x64_bf16 v[88:91], v[24:27], a[24:31], v0
  s_cmp_lg_u64 s[60:61], 0
  s_waitcnt lgkmcnt(0)
  s_barrier
  ds_read_b128 v[28:31], v117 offset:0
  ds_read_b128 v[32:35], v117 offset:1024
  v_smfmac_f32_16x16x64_bf16 v[92:95], v[20:23], a[128:135], v0
  ds_read_b128 v[36:39], v118 offset:0
  ds_read_b128 v[40:43], v118 offset:1024
  v_smfmac_f32_16x16x64_bf16 v[96:99], v[20:23], a[136:143], v0
  ds_read_b128 v[44:47], v119 offset:0
  ds_read_b128 v[48:51], v119 offset:1024
  v_smfmac_f32_16x16x64_bf16 v[92:95], v[24:27], a[144:151], v0
  v_smfmac_f32_16x16x64_bf16 v[96:99], v[24:27], a[152:159], v0
  v_smfmac_f32_16x16x64_bf16 v[100:103], v[20:23], v[128:135], v0
  v_smfmac_f32_16x16x64_bf16 v[104:107], v[20:23], v[136:143], v0
  v_smfmac_f32_16x16x64_bf16 v[100:103], v[24:27], v[144:151], v0
  v_smfmac_f32_16x16x64_bf16 v[104:107], v[24:27], v[152:159], v0
  s_cbranch_scc1 L_rec_kvwait
L_rec_kvok:
  s_waitcnt lgkmcnt(5)
  v_smfmac_f32_16x16x64_bf16 v[84:87], v[28:31], a[32:39], v0
  v_smfmac_f32_16x16x64_bf16 v[88:91], v[28:31], a[40:47], v0
  s_mov_b32 m0, s53
  s_waitcnt lgkmcnt(4)
  v_smfmac_f32_16x16x64_bf16 v[84:87], v[32:35], a[48:55], v0
  v_smfmac_f32_16x16x64_bf16 v[88:91], v[32:35], a[56:63], v0
  buffer_load_dwordx4 v1, s[8:11], s50 offen sc1 lds
  s_waitcnt lgkmcnt(3)
  v_smfmac_f32_16x16x64_bf16 v[84:87], v[36:39], a[64:71], v0
  v_smfmac_f32_16x16x64_bf16 v[88:91], v[36:39], a[72:79], v0
  buffer_load_dwordx4 v1, s[8:11], s50 offen offset:1024 sc1 lds
  s_waitcnt lgkmcnt(2)
  v_smfmac_f32_16x16x64_bf16 v[84:87], v[40:43], a[80:87], v0
  v_smfmac_f32_16x16x64_bf16 v[88:91], v[40:43], a[88:95], v0
  s_mov_b32 m0, s37
  s_waitcnt lgkmcnt(1)
  v_smfmac_f32_16x16x64_bf16 v[84:87], v[44:47], a[96:103], v0
  v_smfmac_f32_16x16x64_bf16 v[88:91], v[44:47], a[104:111], v0
  buffer_load_dwordx4 v1, s[8:11], s51 offen sc1 lds
  s_waitcnt lgkmcnt(0)
  v_smfmac_f32_16x16x64_bf16 v[84:87], v[48:51], a[112:119], v0
  v_smfmac_f32_16x16x64_bf16 v[88:91], v[48:51], a[120:127], v0
  buffer_load_dwordx4 v1, s[8:11], s51 offen offset:1024 sc1 lds
  v_smfmac_f32_16x16x64_bf16 v[92:95], v[28:31], a[160:167], v0
  v_smfmac_f32_16x16x64_bf16 v[92:95], v[32:35], a[176:183], v0
  v_smfmac_f32_16x16x64_bf16 v[92:95], v[36:39], a[192:199], v0
  v_smfmac_f32_16x16x64_bf16 v[92:95], v[40:43], a[208:215], v0
  v_smfmac_f32_16x16x64_bf16 v[92:95], v[44:47], a[224:231], v0
  s_nop 0
  v_add_f32 v84, v84, v85
  v_add_f32 v86, v86, v87
  v_smfmac_f32_16x16x64_bf16 v[92:95], v[48:51], a[240:247], v0
  v_cvt_pk_bf16_f32 v16, v84, v86
  v_add_f32 v88, v88, v89
  v_smfmac_f32_16x16x64_bf16 v[96:99], v[28:31], a[168:175], v0
  v_add_f32 v90, v90, v91
  v_cvt_pk_bf16_f32 v18, v88, v90
  v_smfmac_f32_16x16x64_bf16 v[96:99], v[32:35], a[184:191], v0
  v_smfmac_f32_16x16x64_bf16 v[96:99], v[36:39], a[200:207], v0
  s_nop 0
  v_add_f32 v92, v92, v93
  v_smfmac_f32_16x16x64_bf16 v[96:99], v[40:43], a[216:223], v0
  v_add_f32 v94, v94, v95
  v_smfmac_f32_16x16x64_bf16 v[96:99], v[44:47], a[232:239], v0
  v_cvt_pk_bf16_f32 v17, v92, v94
  v_smfmac_f32_16x16x64_bf16 v[96:99], v[48:51], a[248:255], v0
  ds_write_b64 v2, v[16:17]
  v_smfmac_f32_16x16x64_bf16 v[100:103], v[28:31], v[160:167], v0
  v_smfmac_f32_16x16x64_bf16 v[104:107], v[28:31], v[168:175], v0
  s_nop 4
  v_add_f32 v96, v96, v97
  v_add_f32 v98, v98, v99
  v_cvt_pk_bf16_f32 v19, v96, v98
  ds_write_b64 v2, v[18:19] offset:128
  v_smfmac_f32_16x16x64_bf16 v[100:103], v[32:35], v[176:183], v0
  v_smfmac_f32_16x16x64_bf16 v[104:107], v[32:35], v[184:191], v0
  s_waitcnt lgkmcnt(0)
  s_barrier
  ds_read_b64_tr_b16 v[84:85], v3 offset:0
  ds_read_b64_tr_b16 v[86:87], v3 offset:64
  v_smfmac_f32_16x16x64_bf16 v[100:103], v[36:39], v[192:199], v0
  ds_read_b64_tr_b16 v[88:89], v3 offset:256
  ds_read_b64_tr_b16 v[90:91], v3 offset:320
  v_smfmac_f32_16x16x64_bf16 v[104:107], v[36:39], v[200:207], v0
  ds_read_b64_tr_b16 v[92:93], v3 offset:512
  ds_read_b64_tr_b16 v[94:95], v3 offset:576
  v_smfmac_f32_16x16x64_bf16 v[100:103], v[40:43], v[208:215], v0
  ds_read_b64_tr_b16 v[96:97], v3 offset:768
  ds_read_b64_tr_b16 v[98:99], v3 offset:832
  v_smfmac_f32_16x16x64_bf16 v[104:107], v[40:43], v[216:223], v0
  s_waitcnt vmcnt(4)
  s_waitcnt lgkmcnt(6)
  v_mfma_f32_16x16x32_bf16 v[116:119], v[52:55], v[84:87], 0
  v_mfma_f32_16x16x32_bf16 v[120:123], v[68:71], v[84:87], 0
  v_mfma_f32_16x16x32_bf16 v[124:127], v[84:87], v[84:87], 0
  s_waitcnt lgkmcnt(4)
  v_mfma_f32_16x16x32_bf16 v[116:119], v[56:59], v[88:91], v[116:119]
  v_mfma_f32_16x16x32_bf16 v[120:123], v[72:75], v[88:91], v[120:123]
  v_mfma_f32_16x16x32_bf16 v[124:127], v[88:91], v[88:91], v[124:127]
  s_waitcnt lgkmcnt(2)
  v_mfma_f32_16x16x32_bf16 v[116:119], v[60:63], v[92:95], v[116:119]
  v_mfma_f32_16x16x32_bf16 v[120:123], v[76:79], v[92:95], v[120:123]
  v_mfma_f32_16x16x32_bf16 v[124:127], v[92:95], v[92:95], v[124:127]
  s_waitcnt lgkmcnt(0)
  v_mfma_f32_16x16x32_bf16 v[116:119], v[64:67], v[96:99], v[116:119]
  v_mfma_f32_16x16x32_bf16 v[120:123], v[80:83], v[96:99], v[120:123]
  v_mfma_f32_16x16x32_bf16 v[124:127], v[96:99], v[96:99], v[124:127]
  v_smfmac_f32_16x16x64_bf16 v[100:103], v[44:47], v[224:231], v0
  ds_read_b128 v[52:55], v7 offset:0
  ds_read_b128 v[56:59], v7 offset:8192
  s_nop 2
  v_max3_f32 v88, v116, v117, v118
  v_max3_f32 v89, v120, v121, v122
  v_max3_f32 v88, v88, v119, v123
  v_max3_f32 v89, v89, v126, v127
  v_max_f32 v88, v88, v89
  v_max_f32 v89, v88, v89
  v_smfmac_f32_16x16x64_bf16 v[104:107], v[44:47], v[232:239], v0
  ds_read_b128 v[60:63], v7 offset:1024
  v_permlane32_swap_b32 v88, v89
  v_max_f32 v88, v88, v89
  v_max_f32 v89, v88, v89
  v_smfmac_f32_16x16x64_bf16 v[100:103], v[48:51], v[240:247], v0
  ds_read_b128 v[64:67], v7 offset:9216
  v_permlane16_swap_b32 v88, v89
  v_max_f32 v88, v88, v89
  v_mul_f32 v88, s34, v88
  v_smfmac_f32_16x16x64_bf16 v[104:107], v[48:51], v[248:255], v0
  v_fma_f32 v126, v126, s34, -v88
  v_fma_f32 v127, v127, s34, -v88
  v_exp_f32 v126, v126
  ds_read_b128 v[68:71], v7 offset:16384
  v_exp_f32 v127, v127
  ds_read_b128 v[72:75], v7 offset:24576
  v_fma_f32 v116, v116, s34, -v88
  v_fma_f32 v117, v117, s34, -v88
  v_fma_f32 v118, v118, s34, -v88
  v_fma_f32 v119, v119, s34, -v88
  v_cvt_pk_bf16_f32 v12, v126, v127
  v_exp_f32 v116, v116
  ds_read_b128 v[76:79], v7 offset:17408
  v_exp_f32 v117, v117
  ds_read_b128 v[80:83], v7 offset:25600
  v_mfma_f32_16x16x16_bf16 v[124:127], v[10:11], v[12:13], 0
  v_exp_f32 v118, v118
  ds_read_b128 v[20:23], v7 offset:2048
  v_exp_f32 v119, v119
  ds_read_b128 v[24:27], v7 offset:10240
  v_add_f32 v100, v100, v101
  v_add_f32 v102, v102, v103
  v_cvt_pk_bf16_f32 v16, v100, v102
  v_cvt_pk_bf16_f32 v92, v116, v117
  v_cvt_pk_bf16_f32 v93, v118, v119
  v_add_f32 v104, v104, v105
  v_add_f32 v106, v106, v107
  v_cvt_pk_bf16_f32 v18, v104, v106
  v_mfma_f32_16x16x16_bf16 v[124:127], v[10:11], v[92:93], v[124:127]
  v_bfi_b32 v16, 1, s59, v16
  v_fma_f32 v120, v120, s34, -v88
  v_fma_f32 v121, v121, s34, -v88
  buffer_store_dwordx4 v[16:19], v1, s[8:11], s52 offen sc1
  v_mfma_f32_16x16x16_bf16 v[100:103], v[16:17], v[12:13], 0
  v_fma_f32 v122, v122, s34, -v88
  v_fma_f32 v123, v123, s34, -v88
  v_mfma_f32_16x16x16_bf16 v[104:107], v[18:19], v[12:13], 0
  v_exp_f32 v120, v120
  ds_read_b128 v[28:31], v7 offset:3072
  v_exp_f32 v121, v121
  ds_read_b128 v[32:35], v7 offset:11264
  v_exp_f32 v122, v122
  ds_read_b128 v[36:39], v7 offset:18432
  v_exp_f32 v123, v123
  ds_read_b128 v[40:43], v7 offset:26624
  s_cmp_eq_u32 s32, 63
  v_cvt_pk_bf16_f32 v94, v120, v121
  v_cvt_pk_bf16_f32 v95, v122, v123
  s_cbranch_scc1 L_rec_last
  s_nop 0
  v_mfma_f32_16x16x16_bf16 v[124:127], v[10:11], v[94:95], v[124:127]
  v_mfma_f32_16x16x32_bf16 v[100:103], v[108:111], v[92:95], v[100:103]
  v_mfma_f32_16x16x32_bf16 v[104:107], v[112:115], v[92:95], v[104:107]
  ds_read_b128 v[44:47], v7 offset:19456
  ds_read_b128 v[48:51], v7 offset:27648
  s_nop 3
  v_rcp_f32 v124, v124
  s_nop 0
  v_pk_mul_f32 v[100:101], v[100:101], v[124:125] op_sel_hi:[1,0]
  v_pk_mul_f32 v[102:103], v[102:103], v[124:125] op_sel_hi:[1,0]
  v_cvt_pk_bf16_f32 v116, v100, v101
  v_cvt_pk_bf16_f32 v117, v102, v103
  v_pk_mul_f32 v[104:105], v[104:105], v[124:125] op_sel_hi:[1,0]
  v_pk_mul_f32 v[106:107], v[106:107], v[124:125] op_sel_hi:[1,0]
  v_cvt_pk_bf16_f32 v118, v104, v105
  v_cvt_pk_bf16_f32 v119, v106, v107
  s_mov_b64 exec, s[56:57]
  ds_write2_b32 v5, v116, v117 offset0:0 offset1:4
  ds_write2_b32 v5, v118, v119 offset0:8 offset1:12
  s_mov_b64 exec, -1
  v_mfma_f32_32x32x8_bf16 v[84:99], v[12:13], v[14:15], 0
  v_mfma_f32_32x32x8_bf16 v[100:115], v[12:13], v[14:15], 0
  s_waitcnt vmcnt(1) lgkmcnt(0)
  s_barrier
  ds_read_b128 v[116:119], v6
  ds_read_b128 v[120:123], v6 offset:128
  s_waitcnt lgkmcnt(1)
  s_nop 3
  v_smfmac_f32_16x16x64_bf16 v[84:87], v[116:119], v[52:59], v0
  ds_read_b128 v[52:55], v7 offset:4096
  ds_read_b128 v[56:59], v7 offset:12288
  v_smfmac_f32_16x16x64_bf16 v[88:91], v[116:119], v[60:67], v0
  ds_read_b128 v[60:63], v7 offset:5120
  ds_read_b128 v[64:67], v7 offset:13312
  s_waitcnt lgkmcnt(4)
  v_smfmac_f32_16x16x64_bf16 v[84:87], v[120:123], v[68:75], v0
  ds_read_b128 v[68:71], v7 offset:20480
  ds_read_b128 v[72:75], v7 offset:28672
  v_smfmac_f32_16x16x64_bf16 v[88:91], v[120:123], v[76:83], v0
  ds_read_b128 v[76:79], v7 offset:21504
  ds_read_b128 v[80:83], v7 offset:29696
  v_smfmac_f32_16x16x64_bf16 v[92:95], v[116:119], v[20:27], v0
  ds_read_b128 v[20:23], v7 offset:6144
  ds_read_b128 v[24:27], v7 offset:14336
  v_smfmac_f32_16x16x64_bf16 v[96:99], v[116:119], v[28:35], v0
  ds_read_b128 v[28:31], v7 offset:7168
  ds_read_b128 v[32:35], v7 offset:15360
  v_add_f32 v84, v84, v85
  v_smfmac_f32_16x16x64_bf16 v[92:95], v[120:123], v[36:43], v0
  ds_read_b128 v[36:39], v7 offset:22528
  ds_read_b128 v[40:43], v7 offset:30720
  v_add_f32 v86, v86, v87
  v_smfmac_f32_16x16x64_bf16 v[96:99], v[120:123], v[44:51], v0
  ds_read_b128 v[44:47], v7 offset:23552
  ds_read_b128 v[48:51], v7 offset:31744
  v_cvt_pk_bf16_f32 v124, v84, v86
  s_waitcnt lgkmcnt(14)
  v_smfmac_f32_16x16x64_bf16 v[100:103], v[116:119], v[52:59], v0
  v_add_f32 v88, v88, v89
  v_add_f32 v90, v90, v91
  s_waitcnt lgkmcnt(12)
  v_smfmac_f32_16x16x64_bf16 v[104:107], v[116:119], v[60:67], v0
  v_cvt_pk_bf16_f32 v125, v88, v90
  v_add_f32 v92, v92, v93
  s_waitcnt lgkmcnt(10)
  v_smfmac_f32_16x16x64_bf16 v[100:103], v[120:123], v[68:75], v0
  v_add_f32 v94, v94, v95
  v_cvt_pk_bf16_f32 v126, v92, v94
  s_waitcnt lgkmcnt(8)
  v_smfmac_f32_16x16x64_bf16 v[104:107], v[120:123], v[76:83], v0
  v_add_f32 v96, v96, v97
  v_add_f32 v98, v98, v99
  s_waitcnt lgkmcnt(6)
  v_smfmac_f32_16x16x64_bf16 v[108:111], v[116:119], v[20:27], v0
  v_cvt_pk_bf16_f32 v127, v96, v98
  v_bfi_b32 v124, 1, s33, v124
  s_waitcnt lgkmcnt(4)
  v_smfmac_f32_16x16x64_bf16 v[112:115], v[116:119], v[28:35], v0
  buffer_store_dwordx4 v[124:127], v8, s[8:11], s39 offen
  v_add_f32 v100, v100, v101
  s_waitcnt lgkmcnt(2)
  v_smfmac_f32_16x16x64_bf16 v[108:111], v[120:123], v[36:43], v0
  v_add_f32 v102, v102, v103
  v_cvt_pk_bf16_f32 v16, v100, v102
  s_waitcnt lgkmcnt(0)
  v_smfmac_f32_16x16x64_bf16 v[112:115], v[120:123], v[44:51], v0
  v_add_f32 v104, v104, v105
  v_add_f32 v106, v106, v107
  v_cvt_pk_bf16_f32 v17, v104, v106
  s_nop 0
  v_add_f32 v108, v108, v109
  v_add_f32 v110, v110, v111
  v_cvt_pk_bf16_f32 v18, v108, v110
  s_nop 0
  v_add_f32 v112, v112, v113
  v_add_f32 v114, v114, v115
  v_cvt_pk_bf16_f32 v19, v112, v114
  v_bfi_b32 v16, 1, s33, v16
  buffer_store_dwordx4 v[16:19], v8, s[8:11], s40 offen
  s_add_u32 s32, s32, 1
  ds_read_b128 v[52:55], v4 offset:0
  ds_read_b128 v[68:71], v4 offset:128
  ds_read_b128 v[56:59], v4 offset:2048
  ds_read_b128 v[72:75], v4 offset:2176
  ds_read_b128 v[60:63], v4 offset:4096
  ds_read_b128 v[76:79], v4 offset:4224
  ds_read_b128 v[64:67], v4 offset:6144
  ds_read_b128 v[80:83], v4 offset:6272
  ds_read_b128 v[108:111], v9
  ds_read_b128 v[112:115], v9 offset:256
  s_lshr_b32 s6, s32, 2
  s_andn2_b32 s59, 1, s6
  s_add_u32 s6, s32, 1
  s_and_b32 s6, s6, 3
  s_lshl_b32 s6, s6, 19
  s_add_u32 s50, s35, s6
  s_add_u32 s51, s50, 0x2000
  v_bfe_u32 v19, v1, 4, 4
  v_and_b32 v16, 1, v19
  v_lshlrev_b32 v17, 4, v16
  v_mov_b32 v18, 0x3f80
  v_lshlrev_b32 v17, v17, v18
  v_lshrrev_b32 v18, 1, v19
  v_cmp_eq_u32 vcc, 0, v18
  s_nop 1
  v_cndmask_b32 v120, 0, v17, vcc
  v_cmp_eq_u32 vcc, 1, v18
  s_nop 1
  v_cndmask_b32 v121, 0, v17, vcc
  v_cmp_eq_u32 vcc, 2, v18
  s_nop 1
  v_cndmask_b32 v122, 0, v17, vcc
  v_cmp_eq_u32 vcc, 3, v18
  s_nop 1
  v_cndmask_b32 v123, 0, v17, vcc
  v_lshlrev_b32 v16, 5, v16
  v_bfe_u32 v17, v19, 2, 1
  v_lshl_or_b32 v16, v17, 4, v16
  v_bfe_u32 v17, v19, 1, 1
  v_lshl_or_b32 v16, v17, 3, v16
  v_lshrrev_b32 v17, 8, v1
  v_lshl_or_b32 v124, v17, 6, v16
  s_waitcnt lgkmcnt(0)
  v_bitop3_b32 v16, v52, v56, s59 bitop3:0x7e
  v_bitop3_b32 v17, v60, v64, s59 bitop3:0x7e
  v_bitop3_b32 v18, v68, v72, s59 bitop3:0x7e
  v_bitop3_b32 v19, v76, v80, s59 bitop3:0x7e
  v_or3_b32 v16, v16, v17, v18
  v_bitop3_b32 v17, v108, v112, s59 bitop3:0x7e
  v_or3_b32 v16, v16, v17, v19
  v_and_b32 v16, 1, v16
  v_cmp_ne_u32 s[60:61], 0, v16
  v_mov_b32 v19, v124
  s_cmp_lg_u32 s3, 0
  s_cbranch_scc1 L_rec_nored
  s_mov_b32 s7, 0
L_rec_rr:
  buffer_load_dwordx4 v[20:23], v1, s[8:11], s41 offen offset:0 sc1
  buffer_load_dwordx4 v[24:27], v1, s[8:11], s41 offen offset:1024 sc1
  buffer_load_dwordx4 v[28:31], v1, s[8:11], s41 offen offset:2048 sc1
  buffer_load_dwordx4 v[32:35], v1, s[8:11], s41 offen offset:3072 sc1
  buffer_load_dwordx4 v[36:39], v1, s[8:11], s42 offen offset:0 sc1
  buffer_load_dwordx4 v[40:43], v1, s[8:11], s42 offen offset:1024 sc1
  buffer_load_dwordx4 v[44:47], v1, s[8:11], s42 offen offset:2048 sc1
  buffer_load_dwordx4 v[48:51], v1, s[8:11], s42 offen offset:3072 sc1
  s_waitcnt vmcnt(7)
  v_mfma_f32_16x16x32_bf16 v[124:127], v[20:23], v[120:123], 0
  s_waitcnt vmcnt(6)
  v_mfma_f32_16x16x32_bf16 v[124:127], v[24:27], v[120:123], v[124:127]
  v_bitop3_b32 v16, v20, v24, s33 bitop3:0x7e
  s_waitcnt vmcnt(5)
  v_mfma_f32_16x16x32_bf16 v[124:127], v[28:31], v[120:123], v[124:127]
  s_waitcnt vmcnt(4)
  v_mfma_f32_16x16x32_bf16 v[124:127], v[32:35], v[120:123], v[124:127]
  v_bitop3_b32 v17, v28, v32, s33 bitop3:0x7e
  s_waitcnt vmcnt(3)
  v_mfma_f32_16x16x32_bf16 v[124:127], v[36:39], v[120:123], v[124:127]
  s_waitcnt vmcnt(2)
  v_mfma_f32_16x16x32_bf16 v[124:127], v[40:43], v[120:123], v[124:127]
  v_bitop3_b32 v18, v36, v40, s33 bitop3:0x7e
  s_waitcnt vmcnt(1)
  v_mfma_f32_16x16x32_bf16 v[124:127], v[44:47], v[120:123], v[124:127]
  v_or3_b32 v16, v16, v17, v18
  s_waitcnt vmcnt(0)
  v_mfma_f32_16x16x32_bf16 v[124:127], v[48:51], v[120:123], v[124:127]
  v_bitop3_b32 v17, v44, v48, s33 bitop3:0x7e
  v_bitop3_b32 v16, v16, v17, 1 bitop3:0xa8
  v_cmp_ne_u32 vcc, 0, v16
  s_cbranch_vccz L_rec_red
  s_and_b32 s6, s7, 31
  s_cmp_lg_u32 s6, 31
  s_cbranch_scc1 L_tf_82
  buffer_wbl2 sc1
  s_waitcnt vmcnt(0)
  buffer_inv sc1
  s_waitcnt vmcnt(0)
L_tf_82:
  s_add_u32 s7, s7, 1
  s_cmp_lt_u32 s7, 131072
  s_cbranch_scc1 L_rec_rr
  s_mov_b32 s6, 14
  s_branch L_err
L_rec_red:
  s_nop 3
  v_cvt_pk_bf16_f32 v124, v124, v125
  v_cvt_pk_bf16_f32 v125, v126, v127
  v_bfi_b32 v124, 1, s33, v124
  s_mov_b64 exec, s[54:55]
  buffer_store_dwordx2 v[124:125], v19, s[8:11], s43 offen
  s_cmp_lg_u32 s32, 63
  s_cbranch_scc1 L_rec_nl
  buffer_store_dwordx2 v[124:125], v19, s[8:11], s43 offen sc1
L_rec_nl:
  s_mov_b64 exec, -1
  s_barrier
  s_branch L_rec_loop
L_rec_nored:
  s_barrier
  s_branch L_rec_loop
L_rec_kvwait:
  s_and_b32 s6, s32, 3
  s_lshl_b32 s6, s6, 19
  s_add_u32 s6, s6, s35
  s_sub_u32 s60, s6, s53
  s_add_u32 s61, s60, 4096
  s_mov_b32 s7, 0
L_kvs_83:
  buffer_load_dwordx4 v[52:55], v4, s[8:11], s60 offen offset:0 sc1
  buffer_load_dwordx4 v[68:71], v4, s[8:11], s60 offen offset:128 sc1
  buffer_load_dwordx4 v[56:59], v4, s[8:11], s60 offen offset:2048 sc1
  buffer_load_dwordx4 v[72:75], v4, s[8:11], s60 offen offset:2176 sc1
  buffer_load_dwordx4 v[60:63], v4, s[8:11], s61 offen offset:0 sc1
  buffer_load_dwordx4 v[76:79], v4, s[8:11], s61 offen offset:128 sc1
  buffer_load_dwordx4 v[64:67], v4, s[8:11], s61 offen offset:2048 sc1
  buffer_load_dwordx4 v[80:83], v4, s[8:11], s61 offen offset:2176 sc1
  buffer_load_dwordx4 v[108:111], v9, s[8:11], s60 offen offset:0 sc1
  buffer_load_dwordx4 v[112:115], v9, s[8:11], s60 offen offset:256 sc1
  s_waitcnt vmcnt(0)
  v_bitop3_b32 v16, v52, v56, s59 bitop3:0x7e
  v_bitop3_b32 v17, v60, v64, s59 bitop3:0x7e
  v_bitop3_b32 v18, v68, v72, s59 bitop3:0x7e
  v_bitop3_b32 v19, v76, v80, s59 bitop3:0x7e
  v_or3_b32 v16, v16, v17, v18
  v_bitop3_b32 v17, v108, v112, s59 bitop3:0x7e
  v_or3_b32 v16, v16, v17, v19
  v_and_b32 v16, 1, v16
  v_cmp_ne_u32 vcc, 0, v16
  s_cbranch_vccz L_rec_kvok
  s_add_u32 s7, s7, 1
  s_cmp_lt_u32 s7, 131072
  s_cbranch_scc1 L_kvs_83
  s_mov_b32 s6, 13
  s_branch L_err
L_rec_last:
  s_waitcnt vmcnt(0)
  s_endpgm
L_p:
  s_sub_u32 s35, s4, 2
  s_lshr_b32 s35, s35, 1
  s_and_b32 s6, s4, 1
  s_lshl_b32 s6, s6, 4
  s_and_b32 s36, s5, 15
  s_add_u32 s36, s36, s6
  s_lshr_b32 s37, s5, 4
  s_mul_i32 s38, s35, 0x200000
  s_add_u32 s38, s38, 0x0
  s_mul_i32 s39, s35, 0x2000000
  s_add_u32 s39, s39, 0x800000
  s_mul_i32 s40, s35, 0x1000000
  s_add_u32 s40, s40, 0x4800000
  s_mul_i32 s41, s35, 0x1000000
  s_add_u32 s41, s41, 0x6800000
  s_mul_i32 s44, s35, 0x800
  s_add_u32 s44, s44, 0x710000
  s_lshl_b32 s6, s3, 13
  s_add_u32 s38, s38, s6
  s_add_u32 s53, s6, 0
  s_lshl_b32 s6, s36, 14
  s_lshl_b32 s7, s3, 11
  s_add_u32 s39, s39, s6
  s_add_u32 s39, s39, s7
  s_lshl_b32 s6, s36, 12
  s_lshl_b32 s7, s3, 10
  s_add_u32 s40, s40, s6
  s_add_u32 s40, s40, s7
  s_lshl_b32 s6, s36, 13
  s_lshr_b32 s7, s3, 1
  s_lshl_b32 s7, s7, 12
  s_add_u32 s41, s41, s6
  s_add_u32 s41, s41, s7
  s_lshl_b32 s6, s35, 13
  s_lshl_b32 s7, s37, 12
  s_add_u32 s6, s6, s7
  s_lshl_b32 s7, s36, 7
  s_add_u32 s6, s6, s7
  s_lshl_b32 s7, s3, 2
  s_add_u32 s6, s6, s7
  s_add_u32 s43, s6, 0x718000
  s_mov_b32 s34, 0x3e0293ee
  v_mov_b32 v12, 0
  v_mov_b32 v13, 0
  v_mov_b32 v14, 0
  v_mov_b32 v15, 0
  v_lshlrev_b32 v16, 4, v0
  s_lshl_b32 s6, s37, 19
  s_add_u32 s6, s6, s39
  s_mov_b64 exec, 1
  buffer_store_dword v12, v12, s[8:11], s43 offen sc1
  s_mov_b64 exec, -1
  buffer_store_dwordx4 v[12:15], v16, s[8:11], s6 offen offset:0 sc1
  buffer_store_dwordx4 v[12:15], v16, s[8:11], s6 offen offset:1024 sc1
  s_add_u32 s6, s6, 8192
  buffer_store_dwordx4 v[12:15], v16, s[8:11], s6 offen offset:0 sc1
  buffer_store_dwordx4 v[12:15], v16, s[8:11], s6 offen offset:1024 sc1
  s_add_u32 s6, s6, 1040384
  buffer_store_dwordx4 v[12:15], v16, s[8:11], s6 offen offset:0 sc1
  buffer_store_dwordx4 v[12:15], v16, s[8:11], s6 offen offset:1024 sc1
  s_add_u32 s6, s6, 8192
  buffer_store_dwordx4 v[12:15], v16, s[8:11], s6 offen offset:0 sc1
  buffer_store_dwordx4 v[12:15], v16, s[8:11], s6 offen offset:1024 sc1
  s_cmp_ge_u32 s4, 4
  s_cbranch_scc1 L_pro
L_p2:
  v_mov_b32 v12, 0
  v_mov_b32 v13, 0
  v_lshlrev_b32 v0, 4, v0
  s_mov_b32 s16, s82
  s_mov_b32 s17, s83
  s_mov_b32 s18, 0x400000
  s_mov_b32 s19, 0x20000
  s_mov_b32 s20, s84
  s_mov_b32 s21, s85
  s_mov_b32 s22, 0x400000
  s_mov_b32 s23, 0x20000
  s_mov_b32 s24, s86
  s_mov_b32 s25, s87
  s_mov_b32 s26, 0x400000
  s_mov_b32 s27, 0x20000
  v_mov_b32 v80, 0x3f803f80
  v_mov_b32 v81, 0x3f803f80
  v_mov_b32 v82, 0x3f803f80
  v_mov_b32 v83, 0x3f803f80
  v_lshrrev_b32 v104, 4, v0
  v_lshrrev_b32 v100, 8, v0
  v_lshlrev_b32 v105, 2, v100
  v_and_b32 v104, 15, v104
  v_xor_b32 v104, v104, v105
  v_mul_u32_u24 v100, 8192, v100
  v_lshl_add_u32 v100, v104, 4, v100
  v_bfe_u32 v104, v0, 6, 2
  v_lshlrev_b32 v105, 2, v104
  v_bfe_u32 v106, v0, 8, 1
  v_lshlrev_b32 v106, 1, v106
  v_bfe_u32 v107, v0, 5, 1
  v_or_b32 v106, v106, v107
  s_lshl_b32 s6, s3, 2
  v_or_b32 v106, s6, v106
  v_xor_b32 v106, v106, v105
  v_lshlrev_b32 v106, 4, v106
  v_bfe_u32 v107, v0, 4, 1
  v_lshl_or_b32 v106, v107, 3, v106
  v_bfe_u32 v107, v0, 9, 1
  v_lshl_or_b32 v104, v107, 3, v104
  v_lshl_or_b32 v104, v104, 8, v106
  v_add_u32 v105, 0x10000, v104
  s_lshl_b32 s60, s3, 13
  s_mul_i32 s63, s3, 262144
  s_lshr_b32 s6, 0x72, s4
  s_bitcmp1_b32 s6, 0
  s_cbranch_scc1 L_rdn_84
  s_waitcnt vmcnt(0)
  s_barrier
  s_cmp_lg_u32 s3, 0
  s_cbranch_scc1 L_sd_85
  s_mov_b64 exec, 1
  s_and_b32 s6, s4, 3
  s_lshl_b32 s6, s6, 6
  v_mov_b32 v18, 16
  v_mov_b32 v19, 1
  buffer_atomic_add v19, v18, s[12:15], s6 offen sc1
  s_mov_b64 exec, -1
L_sd_85:
L_rdn_84:
  s_lshl_b32 s61, s36, 8
  s_add_u32 s61, s61, 0
  s_add_u32 s61, s61, s63
  s_add_u32 m0, s60, 0
  s_add_u32 s62, s61, 0
  buffer_load_dwordx4 v100, s[16:19], s62 offen lds
  s_add_u32 m0, s60, 1024
  s_add_u32 s62, s61, 32768
  buffer_load_dwordx4 v100, s[16:19], s62 offen lds
  s_add_u32 m0, s60, 2048
  s_add_u32 s62, s61, 65536
  buffer_load_dwordx4 v100, s[16:19], s62 offen lds
  s_add_u32 m0, s60, 3072
  s_add_u32 s62, s61, 98304
  buffer_load_dwordx4 v100, s[16:19], s62 offen lds
  s_add_u32 m0, s60, 4096
  s_add_u32 s62, s61, 131072
  buffer_load_dwordx4 v100, s[16:19], s62 offen lds
  s_add_u32 m0, s60, 5120
  s_add_u32 s62, s61, 163840
  buffer_load_dwordx4 v100, s[16:19], s62 offen lds
  s_add_u32 m0, s60, 6144
  s_add_u32 s62, s61, 196608
  buffer_load_dwordx4 v100, s[16:19], s62 offen lds
  s_add_u32 m0, s60, 7168
  s_add_u32 s62, s61, 229376
  buffer_load_dwordx4 v100, s[16:19], s62 offen lds
  s_lshl_b32 s61, s36, 8
  s_add_u32 s61, s61, 1048576
  s_add_u32 s61, s61, s63
  s_add_u32 m0, s60, 32768
  s_add_u32 s62, s61, 0
  buffer_load_dwordx4 v100, s[16:19], s62 offen lds
  s_add_u32 m0, s60, 33792
  s_add_u32 s62, s61, 32768
  buffer_load_dwordx4 v100, s[16:19], s62 offen lds
  s_add_u32 m0, s60, 34816
  s_add_u32 s62, s61, 65536
  buffer_load_dwordx4 v100, s[16:19], s62 offen lds
  s_add_u32 m0, s60, 35840
  s_add_u32 s62, s61, 98304
  buffer_load_dwordx4 v100, s[16:19], s62 offen lds
  s_add_u32 m0, s60, 36864
  s_add_u32 s62, s61, 131072
  buffer_load_dwordx4 v100, s[16:19], s62 offen lds
  s_add_u32 m0, s60, 37888
  s_add_u32 s62, s61, 163840
  buffer_load_dwordx4 v100, s[16:19], s62 offen lds
  s_add_u32 m0, s60, 38912
  s_add_u32 s62, s61, 196608
  buffer_load_dwordx4 v100, s[16:19], s62 offen lds
  s_add_u32 m0, s60, 39936
  s_add_u32 s62, s61, 229376
  buffer_load_dwordx4 v100, s[16:19], s62 offen lds
  s_lshl_b32 s61, s36, 8
  s_add_u32 s61, s61, 2097152
  s_add_u32 s61, s61, s63
  s_add_u32 m0, s60, 65536
  s_add_u32 s62, s61, 0
  buffer_load_dwordx4 v100, s[16:19], s62 offen lds
  s_add_u32 m0, s60, 66560
  s_add_u32 s62, s61, 32768
  buffer_load_dwordx4 v100, s[16:19], s62 offen lds
  s_add_u32 m0, s60, 67584
  s_add_u32 s62, s61, 65536
  buffer_load_dwordx4 v100, s[16:19], s62 offen lds
  s_add_u32 m0, s60, 68608
  s_add_u32 s62, s61, 98304
  buffer_load_dwordx4 v100, s[16:19], s62 offen lds
  s_add_u32 m0, s60, 69632
  s_add_u32 s62, s61, 131072
  buffer_load_dwordx4 v100, s[16:19], s62 offen lds
  s_add_u32 m0, s60, 70656
  s_add_u32 s62, s61, 163840
  buffer_load_dwordx4 v100, s[16:19], s62 offen lds
  s_add_u32 m0, s60, 71680
  s_add_u32 s62, s61, 196608
  buffer_load_dwordx4 v100, s[16:19], s62 offen lds
  s_add_u32 m0, s60, 72704
  s_add_u32 s62, s61, 229376
  buffer_load_dwordx4 v100, s[16:19], s62 offen lds
  s_waitcnt vmcnt(16)
  s_barrier
  s_lshl_b32 s61, s36, 8
  s_add_u32 s61, s61, 3145728
  s_add_u32 s61, s61, s63
  s_add_u32 m0, s60, 98304
  s_add_u32 s62, s61, 0
  buffer_load_dwordx4 v100, s[16:19], s62 offen lds
  s_add_u32 m0, s60, 99328
  s_add_u32 s62, s61, 32768
  buffer_load_dwordx4 v100, s[16:19], s62 offen lds
  s_add_u32 m0, s60, 100352
  s_add_u32 s62, s61, 65536
  buffer_load_dwordx4 v100, s[16:19], s62 offen lds
  s_add_u32 m0, s60, 101376
  s_add_u32 s62, s61, 98304
  buffer_load_dwordx4 v100, s[16:19], s62 offen lds
  s_add_u32 m0, s60, 102400
  s_add_u32 s62, s61, 131072
  buffer_load_dwordx4 v100, s[16:19], s62 offen lds
  s_add_u32 m0, s60, 103424
  s_add_u32 s62, s61, 163840
  buffer_load_dwordx4 v100, s[16:19], s62 offen lds
  s_add_u32 m0, s60, 104448
  s_add_u32 s62, s61, 196608
  buffer_load_dwordx4 v100, s[16:19], s62 offen lds
  s_add_u32 m0, s60, 105472
  s_add_u32 s62, s61, 229376
  buffer_load_dwordx4 v100, s[16:19], s62 offen lds
  ds_read_b64_tr_b16 a[0:1], v104 offset:0
  ds_read_b64_tr_b16 a[2:3], v104 offset:1024
  ds_read_b64_tr_b16 a[4:5], v104 offset:4096
  ds_read_b64_tr_b16 a[6:7], v104 offset:5120
  ds_read_b64_tr_b16 a[8:9], v104 offset:8192
  ds_read_b64_tr_b16 a[10:11], v104 offset:9216
  ds_read_b64_tr_b16 a[12:13], v104 offset:12288
  ds_read_b64_tr_b16 a[14:15], v104 offset:13312
  ds_read_b64_tr_b16 a[16:17], v104 offset:16384
  ds_read_b64_tr_b16 a[18:19], v104 offset:17408
  ds_read_b64_tr_b16 a[20:21], v104 offset:20480
  ds_read_b64_tr_b16 a[22:23], v104 offset:21504
  ds_read_b64_tr_b16 a[24:25], v104 offset:24576
  ds_read_b64_tr_b16 a[26:27], v104 offset:25600
  ds_read_b64_tr_b16 a[28:29], v104 offset:28672
  ds_read_b64_tr_b16 a[30:31], v104 offset:29696
  s_waitcnt lgkmcnt(0)
  v_mfma_f32_32x32x16_bf16 v[32:47], v[80:83], a[0:3], 0
  v_mfma_f32_32x32x16_bf16 v[32:47], v[80:83], a[4:7], v[32:47]
  v_mfma_f32_32x32x16_bf16 v[32:47], v[80:83], a[8:11], v[32:47]
  v_mfma_f32_32x32x16_bf16 v[32:47], v[80:83], a[12:15], v[32:47]
  v_mfma_f32_32x32x16_bf16 v[32:47], v[80:83], a[16:19], v[32:47]
  v_mfma_f32_32x32x16_bf16 v[32:47], v[80:83], a[20:23], v[32:47]
  v_mfma_f32_32x32x16_bf16 v[32:47], v[80:83], a[24:27], v[32:47]
  v_mfma_f32_32x32x16_bf16 v[32:47], v[80:83], a[28:31], v[32:47]
  s_waitcnt vmcnt(16)
  s_barrier
  s_lshl_b32 s61, s36, 8
  s_add_u32 s61, s61, 0
  s_add_u32 s61, s61, s63
  s_add_u32 m0, s60, 0
  s_add_u32 s62, s61, 0
  buffer_load_dwordx4 v100, s[20:23], s62 offen lds
  s_add_u32 m0, s60, 1024
  s_add_u32 s62, s61, 32768
  buffer_load_dwordx4 v100, s[20:23], s62 offen lds
  s_add_u32 m0, s60, 2048
  s_add_u32 s62, s61, 65536
  buffer_load_dwordx4 v100, s[20:23], s62 offen lds
  s_add_u32 m0, s60, 3072
  s_add_u32 s62, s61, 98304
  buffer_load_dwordx4 v100, s[20:23], s62 offen lds
  s_add_u32 m0, s60, 4096
  s_add_u32 s62, s61, 131072
  buffer_load_dwordx4 v100, s[20:23], s62 offen lds
  s_add_u32 m0, s60, 5120
  s_add_u32 s62, s61, 163840
  buffer_load_dwordx4 v100, s[20:23], s62 offen lds
  s_add_u32 m0, s60, 6144
  s_add_u32 s62, s61, 196608
  buffer_load_dwordx4 v100, s[20:23], s62 offen lds
  s_add_u32 m0, s60, 7168
  s_add_u32 s62, s61, 229376
  buffer_load_dwordx4 v100, s[20:23], s62 offen lds
  ds_read_b64_tr_b16 a[32:33], v104 offset:32768
  ds_read_b64_tr_b16 a[34:35], v104 offset:33792
  ds_read_b64_tr_b16 a[36:37], v104 offset:36864
  ds_read_b64_tr_b16 a[38:39], v104 offset:37888
  ds_read_b64_tr_b16 a[40:41], v104 offset:40960
  ds_read_b64_tr_b16 a[42:43], v104 offset:41984
  ds_read_b64_tr_b16 a[44:45], v104 offset:45056
  ds_read_b64_tr_b16 a[46:47], v104 offset:46080
  ds_read_b64_tr_b16 a[48:49], v104 offset:49152
  ds_read_b64_tr_b16 a[50:51], v104 offset:50176
  ds_read_b64_tr_b16 a[52:53], v104 offset:53248
  ds_read_b64_tr_b16 a[54:55], v104 offset:54272
  ds_read_b64_tr_b16 a[56:57], v104 offset:57344
  ds_read_b64_tr_b16 a[58:59], v104 offset:58368
  ds_read_b64_tr_b16 a[60:61], v104 offset:61440
  ds_read_b64_tr_b16 a[62:63], v104 offset:62464
  s_waitcnt lgkmcnt(0)
  v_mfma_f32_32x32x16_bf16 v[32:47], v[80:83], a[32:35], v[32:47]
  v_mfma_f32_32x32x16_bf16 v[32:47], v[80:83], a[36:39], v[32:47]
  v_mfma_f32_32x32x16_bf16 v[32:47], v[80:83], a[40:43], v[32:47]
  v_mfma_f32_32x32x16_bf16 v[32:47], v[80:83], a[44:47], v[32:47]
  v_mfma_f32_32x32x16_bf16 v[32:47], v[80:83], a[48:51], v[32:47]
  v_mfma_f32_32x32x16_bf16 v[32:47], v[80:83], a[52:55], v[32:47]
  v_mfma_f32_32x32x16_bf16 v[32:47], v[80:83], a[56:59], v[32:47]
  v_mfma_f32_32x32x16_bf16 v[32:47], v[80:83], a[60:63], v[32:47]
  s_waitcnt vmcnt(16)
  s_barrier
  s_lshl_b32 s61, s36, 8
  s_add_u32 s61, s61, 1048576
  s_add_u32 s61, s61, s63
  s_add_u32 m0, s60, 32768
  s_add_u32 s62, s61, 0
  buffer_load_dwordx4 v100, s[20:23], s62 offen lds
  s_add_u32 m0, s60, 33792
  s_add_u32 s62, s61, 32768
  buffer_load_dwordx4 v100, s[20:23], s62 offen lds
  s_add_u32 m0, s60, 34816
  s_add_u32 s62, s61, 65536
  buffer_load_dwordx4 v100, s[20:23], s62 offen lds
  s_add_u32 m0, s60, 35840
  s_add_u32 s62, s61, 98304
  buffer_load_dwordx4 v100, s[20:23], s62 offen lds
  s_add_u32 m0, s60, 36864
  s_add_u32 s62, s61, 131072
  buffer_load_dwordx4 v100, s[20:23], s62 offen lds
  s_add_u32 m0, s60, 37888
  s_add_u32 s62, s61, 163840
  buffer_load_dwordx4 v100, s[20:23], s62 offen lds
  s_add_u32 m0, s60, 38912
  s_add_u32 s62, s61, 196608
  buffer_load_dwordx4 v100, s[20:23], s62 offen lds
  s_add_u32 m0, s60, 39936
  s_add_u32 s62, s61, 229376
  buffer_load_dwordx4 v100, s[20:23], s62 offen lds
  ds_read_b64_tr_b16 a[64:65], v105 offset:0
  ds_read_b64_tr_b16 a[66:67], v105 offset:1024
  ds_read_b64_tr_b16 a[68:69], v105 offset:4096
  ds_read_b64_tr_b16 a[70:71], v105 offset:5120
  ds_read_b64_tr_b16 a[72:73], v105 offset:8192
  ds_read_b64_tr_b16 a[74:75], v105 offset:9216
  ds_read_b64_tr_b16 a[76:77], v105 offset:12288
  ds_read_b64_tr_b16 a[78:79], v105 offset:13312
  ds_read_b64_tr_b16 a[80:81], v105 offset:16384
  ds_read_b64_tr_b16 a[82:83], v105 offset:17408
  ds_read_b64_tr_b16 a[84:85], v105 offset:20480
  ds_read_b64_tr_b16 a[86:87], v105 offset:21504
  ds_read_b64_tr_b16 a[88:89], v105 offset:24576
  ds_read_b64_tr_b16 a[90:91], v105 offset:25600
  ds_read_b64_tr_b16 a[92:93], v105 offset:28672
  ds_read_b64_tr_b16 a[94:95], v105 offset:29696
  s_waitcnt lgkmcnt(0)
  v_mfma_f32_32x32x16_bf16 v[32:47], v[80:83], a[64:67], v[32:47]
  v_mfma_f32_32x32x16_bf16 v[32:47], v[80:83], a[68:71], v[32:47]
  v_mfma_f32_32x32x16_bf16 v[32:47], v[80:83], a[72:75], v[32:47]
  v_mfma_f32_32x32x16_bf16 v[32:47], v[80:83], a[76:79], v[32:47]
  v_mfma_f32_32x32x16_bf16 v[32:47], v[80:83], a[80:83], v[32:47]
  v_mfma_f32_32x32x16_bf16 v[32:47], v[80:83], a[84:87], v[32:47]
  v_mfma_f32_32x32x16_bf16 v[32:47], v[80:83], a[88:91], v[32:47]
  v_mfma_f32_32x32x16_bf16 v[32:47], v[80:83], a[92:95], v[32:47]
  s_waitcnt vmcnt(16)
  s_barrier
  s_lshl_b32 s61, s36, 8
  s_add_u32 s61, s61, 2097152
  s_add_u32 s61, s61, s63
  s_add_u32 m0, s60, 65536
  s_add_u32 s62, s61, 0
  buffer_load_dwordx4 v100, s[20:23], s62 offen lds
  s_add_u32 m0, s60, 66560
  s_add_u32 s62, s61, 32768
  buffer_load_dwordx4 v100, s[20:23], s62 offen lds
  s_add_u32 m0, s60, 67584
  s_add_u32 s62, s61, 65536
  buffer_load_dwordx4 v100, s[20:23], s62 offen lds
  s_add_u32 m0, s60, 68608
  s_add_u32 s62, s61, 98304
  buffer_load_dwordx4 v100, s[20:23], s62 offen lds
  s_add_u32 m0, s60, 69632
  s_add_u32 s62, s61, 131072
  buffer_load_dwordx4 v100, s[20:23], s62 offen lds
  s_add_u32 m0, s60, 70656
  s_add_u32 s62, s61, 163840
  buffer_load_dwordx4 v100, s[20:23], s62 offen lds
  s_add_u32 m0, s60, 71680
  s_add_u32 s62, s61, 196608
  buffer_load_dwordx4 v100, s[20:23], s62 offen lds
  s_add_u32 m0, s60, 72704
  s_add_u32 s62, s61, 229376
  buffer_load_dwordx4 v100, s[20:23], s62 offen lds
  ds_read_b64_tr_b16 a[96:97], v105 offset:32768
  ds_read_b64_tr_b16 a[98:99], v105 offset:33792
  ds_read_b64_tr_b16 a[100:101], v105 offset:36864
  ds_read_b64_tr_b16 a[102:103], v105 offset:37888
  ds_read_b64_tr_b16 a[104:105], v105 offset:40960
  ds_read_b64_tr_b16 a[106:107], v105 offset:41984
  ds_read_b64_tr_b16 a[108:109], v105 offset:45056
  ds_read_b64_tr_b16 a[110:111], v105 offset:46080
  ds_read_b64_tr_b16 a[112:113], v105 offset:49152
  ds_read_b64_tr_b16 a[114:115], v105 offset:50176
  ds_read_b64_tr_b16 a[116:117], v105 offset:53248
  ds_read_b64_tr_b16 a[118:119], v105 offset:54272
  ds_read_b64_tr_b16 a[120:121], v105 offset:57344
  ds_read_b64_tr_b16 a[122:123], v105 offset:58368
  ds_read_b64_tr_b16 a[124:125], v105 offset:61440
  ds_read_b64_tr_b16 a[126:127], v105 offset:62464
  s_waitcnt lgkmcnt(0)
  v_mfma_f32_32x32x16_bf16 v[32:47], v[80:83], a[96:99], v[32:47]
  v_mfma_f32_32x32x16_bf16 v[32:47], v[80:83], a[100:103], v[32:47]
  v_mfma_f32_32x32x16_bf16 v[32:47], v[80:83], a[104:107], v[32:47]
  v_mfma_f32_32x32x16_bf16 v[32:47], v[80:83], a[108:111], v[32:47]
  v_mfma_f32_32x32x16_bf16 v[32:47], v[80:83], a[112:115], v[32:47]
  v_mfma_f32_32x32x16_bf16 v[32:47], v[80:83], a[116:119], v[32:47]
  v_mfma_f32_32x32x16_bf16 v[32:47], v[80:83], a[120:123], v[32:47]
  v_mfma_f32_32x32x16_bf16 v[32:47], v[80:83], a[124:127], v[32:47]
  s_waitcnt vmcnt(16)
  s_barrier
  s_lshl_b32 s61, s36, 8
  s_add_u32 s61, s61, 3145728
  s_add_u32 s61, s61, s63
  s_add_u32 m0, s60, 98304
  s_add_u32 s62, s61, 0
  buffer_load_dwordx4 v100, s[20:23], s62 offen lds
  s_add_u32 m0, s60, 99328
  s_add_u32 s62, s61, 32768
  buffer_load_dwordx4 v100, s[20:23], s62 offen lds
  s_add_u32 m0, s60, 100352
  s_add_u32 s62, s61, 65536
  buffer_load_dwordx4 v100, s[20:23], s62 offen lds
  s_add_u32 m0, s60, 101376
  s_add_u32 s62, s61, 98304
  buffer_load_dwordx4 v100, s[20:23], s62 offen lds
  s_add_u32 m0, s60, 102400
  s_add_u32 s62, s61, 131072
  buffer_load_dwordx4 v100, s[20:23], s62 offen lds
  s_add_u32 m0, s60, 103424
  s_add_u32 s62, s61, 163840
  buffer_load_dwordx4 v100, s[20:23], s62 offen lds
  s_add_u32 m0, s60, 104448
  s_add_u32 s62, s61, 196608
  buffer_load_dwordx4 v100, s[20:23], s62 offen lds
  s_add_u32 m0, s60, 105472
  s_add_u32 s62, s61, 229376
  buffer_load_dwordx4 v100, s[20:23], s62 offen lds
  ds_read_b64_tr_b16 a[128:129], v104 offset:0
  ds_read_b64_tr_b16 a[130:131], v104 offset:1024
  ds_read_b64_tr_b16 a[132:133], v104 offset:4096
  ds_read_b64_tr_b16 a[134:135], v104 offset:5120
  ds_read_b64_tr_b16 a[136:137], v104 offset:8192
  ds_read_b64_tr_b16 a[138:139], v104 offset:9216
  ds_read_b64_tr_b16 a[140:141], v104 offset:12288
  ds_read_b64_tr_b16 a[142:143], v104 offset:13312
  ds_read_b64_tr_b16 a[144:145], v104 offset:16384
  ds_read_b64_tr_b16 a[146:147], v104 offset:17408
  ds_read_b64_tr_b16 a[148:149], v104 offset:20480
  ds_read_b64_tr_b16 a[150:151], v104 offset:21504
  ds_read_b64_tr_b16 a[152:153], v104 offset:24576
  ds_read_b64_tr_b16 a[154:155], v104 offset:25600
  ds_read_b64_tr_b16 a[156:157], v104 offset:28672
  ds_read_b64_tr_b16 a[158:159], v104 offset:29696
  s_waitcnt lgkmcnt(0)
  v_mfma_f32_32x32x16_bf16 v[48:63], v[80:83], a[128:131], 0
  v_mfma_f32_32x32x16_bf16 v[48:63], v[80:83], a[132:135], v[48:63]
  v_mfma_f32_32x32x16_bf16 v[48:63], v[80:83], a[136:139], v[48:63]
  v_mfma_f32_32x32x16_bf16 v[48:63], v[80:83], a[140:143], v[48:63]
  v_mfma_f32_32x32x16_bf16 v[48:63], v[80:83], a[144:147], v[48:63]
  v_mfma_f32_32x32x16_bf16 v[48:63], v[80:83], a[148:151], v[48:63]
  v_mfma_f32_32x32x16_bf16 v[48:63], v[80:83], a[152:155], v[48:63]
  v_mfma_f32_32x32x16_bf16 v[48:63], v[80:83], a[156:159], v[48:63]
  s_waitcnt vmcnt(16)
  s_barrier
  s_lshl_b32 s61, s36, 8
  s_add_u32 s61, s61, 0
  s_add_u32 s61, s61, s63
  s_add_u32 m0, s60, 0
  s_add_u32 s62, s61, 0
  buffer_load_dwordx4 v100, s[24:27], s62 offen lds
  s_add_u32 m0, s60, 1024
  s_add_u32 s62, s61, 32768
  buffer_load_dwordx4 v100, s[24:27], s62 offen lds
  s_add_u32 m0, s60, 2048
  s_add_u32 s62, s61, 65536
  buffer_load_dwordx4 v100, s[24:27], s62 offen lds
  s_add_u32 m0, s60, 3072
  s_add_u32 s62, s61, 98304
  buffer_load_dwordx4 v100, s[24:27], s62 offen lds
  s_add_u32 m0, s60, 4096
  s_add_u32 s62, s61, 131072
  buffer_load_dwordx4 v100, s[24:27], s62 offen lds
  s_add_u32 m0, s60, 5120
  s_add_u32 s62, s61, 163840
  buffer_load_dwordx4 v100, s[24:27], s62 offen lds
  s_add_u32 m0, s60, 6144
  s_add_u32 s62, s61, 196608
  buffer_load_dwordx4 v100, s[24:27], s62 offen lds
  s_add_u32 m0, s60, 7168
  s_add_u32 s62, s61, 229376
  buffer_load_dwordx4 v100, s[24:27], s62 offen lds
  ds_read_b64_tr_b16 a[160:161], v104 offset:32768
  ds_read_b64_tr_b16 a[162:163], v104 offset:33792
  ds_read_b64_tr_b16 a[164:165], v104 offset:36864
  ds_read_b64_tr_b16 a[166:167], v104 offset:37888
  ds_read_b64_tr_b16 a[168:169], v104 offset:40960
  ds_read_b64_tr_b16 a[170:171], v104 offset:41984
  ds_read_b64_tr_b16 a[172:173], v104 offset:45056
  ds_read_b64_tr_b16 a[174:175], v104 offset:46080
  ds_read_b64_tr_b16 a[176:177], v104 offset:49152
  ds_read_b64_tr_b16 a[178:179], v104 offset:50176
  ds_read_b64_tr_b16 a[180:181], v104 offset:53248
  ds_read_b64_tr_b16 a[182:183], v104 offset:54272
  ds_read_b64_tr_b16 a[184:185], v104 offset:57344
  ds_read_b64_tr_b16 a[186:187], v104 offset:58368
  ds_read_b64_tr_b16 a[188:189], v104 offset:61440
  ds_read_b64_tr_b16 a[190:191], v104 offset:62464
  s_waitcnt lgkmcnt(0)
  v_mfma_f32_32x32x16_bf16 v[48:63], v[80:83], a[160:163], v[48:63]
  v_mfma_f32_32x32x16_bf16 v[48:63], v[80:83], a[164:167], v[48:63]
  v_mfma_f32_32x32x16_bf16 v[48:63], v[80:83], a[168:171], v[48:63]
  v_mfma_f32_32x32x16_bf16 v[48:63], v[80:83], a[172:175], v[48:63]
  v_mfma_f32_32x32x16_bf16 v[48:63], v[80:83], a[176:179], v[48:63]
  v_mfma_f32_32x32x16_bf16 v[48:63], v[80:83], a[180:183], v[48:63]
  v_mfma_f32_32x32x16_bf16 v[48:63], v[80:83], a[184:187], v[48:63]
  v_mfma_f32_32x32x16_bf16 v[48:63], v[80:83], a[188:191], v[48:63]
  s_waitcnt vmcnt(16)
  s_barrier
  s_lshl_b32 s61, s36, 8
  s_add_u32 s61, s61, 1048576
  s_add_u32 s61, s61, s63
  s_add_u32 m0, s60, 32768
  s_add_u32 s62, s61, 0
  buffer_load_dwordx4 v100, s[24:27], s62 offen lds
  s_add_u32 m0, s60, 33792
  s_add_u32 s62, s61, 32768
  buffer_load_dwordx4 v100, s[24:27], s62 offen lds
  s_add_u32 m0, s60, 34816
  s_add_u32 s62, s61, 65536
  buffer_load_dwordx4 v100, s[24:27], s62 offen lds
  s_add_u32 m0, s60, 35840
  s_add_u32 s62, s61, 98304
  buffer_load_dwordx4 v100, s[24:27], s62 offen lds
  s_add_u32 m0, s60, 36864
  s_add_u32 s62, s61, 131072
  buffer_load_dwordx4 v100, s[24:27], s62 offen lds
  s_add_u32 m0, s60, 37888
  s_add_u32 s62, s61, 163840
  buffer_load_dwordx4 v100, s[24:27], s62 offen lds
  s_add_u32 m0, s60, 38912
  s_add_u32 s62, s61, 196608
  buffer_load_dwordx4 v100, s[24:27], s62 offen lds
  s_add_u32 m0, s60, 39936
  s_add_u32 s62, s61, 229376
  buffer_load_dwordx4 v100, s[24:27], s62 offen lds
  ds_read_b64_tr_b16 a[192:193], v105 offset:0
  ds_read_b64_tr_b16 a[194:195], v105 offset:1024
  ds_read_b64_tr_b16 a[196:197], v105 offset:4096
  ds_read_b64_tr_b16 a[198:199], v105 offset:5120
  ds_read_b64_tr_b16 a[200:201], v105 offset:8192
  ds_read_b64_tr_b16 a[202:203], v105 offset:9216
  ds_read_b64_tr_b16 a[204:205], v105 offset:12288
  ds_read_b64_tr_b16 a[206:207], v105 offset:13312
  ds_read_b64_tr_b16 a[208:209], v105 offset:16384
  ds_read_b64_tr_b16 a[210:211], v105 offset:17408
  ds_read_b64_tr_b16 a[212:213], v105 offset:20480
  ds_read_b64_tr_b16 a[214:215], v105 offset:21504
  ds_read_b64_tr_b16 a[216:217], v105 offset:24576
  ds_read_b64_tr_b16 a[218:219], v105 offset:25600
  ds_read_b64_tr_b16 a[220:221], v105 offset:28672
  ds_read_b64_tr_b16 a[222:223], v105 offset:29696
  s_waitcnt lgkmcnt(0)
  v_mfma_f32_32x32x16_bf16 v[48:63], v[80:83], a[192:195], v[48:63]
  v_mfma_f32_32x32x16_bf16 v[48:63], v[80:83], a[196:199], v[48:63]
  v_mfma_f32_32x32x16_bf16 v[48:63], v[80:83], a[200:203], v[48:63]
  v_mfma_f32_32x32x16_bf16 v[48:63], v[80:83], a[204:207], v[48:63]
  v_mfma_f32_32x32x16_bf16 v[48:63], v[80:83], a[208:211], v[48:63]
  v_mfma_f32_32x32x16_bf16 v[48:63], v[80:83], a[212:215], v[48:63]
  v_mfma_f32_32x32x16_bf16 v[48:63], v[80:83], a[216:219], v[48:63]
  v_mfma_f32_32x32x16_bf16 v[48:63], v[80:83], a[220:223], v[48:63]
  s_waitcnt vmcnt(16)
  s_barrier
  s_lshl_b32 s61, s36, 8
  s_add_u32 s61, s61, 2097152
  s_add_u32 s61, s61, s63
  s_add_u32 m0, s60, 65536
  s_add_u32 s62, s61, 0
  buffer_load_dwordx4 v100, s[24:27], s62 offen lds
  s_add_u32 m0, s60, 66560
  s_add_u32 s62, s61, 32768
  buffer_load_dwordx4 v100, s[24:27], s62 offen lds
  s_add_u32 m0, s60, 67584
  s_add_u32 s62, s61, 65536
  buffer_load_dwordx4 v100, s[24:27], s62 offen lds
  s_add_u32 m0, s60, 68608
  s_add_u32 s62, s61, 98304
  buffer_load_dwordx4 v100, s[24:27], s62 offen lds
  s_add_u32 m0, s60, 69632
  s_add_u32 s62, s61, 131072
  buffer_load_dwordx4 v100, s[24:27], s62 offen lds
  s_add_u32 m0, s60, 70656
  s_add_u32 s62, s61, 163840
  buffer_load_dwordx4 v100, s[24:27], s62 offen lds
  s_add_u32 m0, s60, 71680
  s_add_u32 s62, s61, 196608
  buffer_load_dwordx4 v100, s[24:27], s62 offen lds
  s_add_u32 m0, s60, 72704
  s_add_u32 s62, s61, 229376
  buffer_load_dwordx4 v100, s[24:27], s62 offen lds
  ds_read_b64_tr_b16 a[224:225], v105 offset:32768
  ds_read_b64_tr_b16 a[226:227], v105 offset:33792
  ds_read_b64_tr_b16 a[228:229], v105 offset:36864
  ds_read_b64_tr_b16 a[230:231], v105 offset:37888
  ds_read_b64_tr_b16 a[232:233], v105 offset:40960
  ds_read_b64_tr_b16 a[234:235], v105 offset:41984
  ds_read_b64_tr_b16 a[236:237], v105 offset:45056
  ds_read_b64_tr_b16 a[238:239], v105 offset:46080
  ds_read_b64_tr_b16 a[240:241], v105 offset:49152
  ds_read_b64_tr_b16 a[242:243], v105 offset:50176
  ds_read_b64_tr_b16 a[244:245], v105 offset:53248
  ds_read_b64_tr_b16 a[246:247], v105 offset:54272
  ds_read_b64_tr_b16 a[248:249], v105 offset:57344
  ds_read_b64_tr_b16 a[250:251], v105 offset:58368
  ds_read_b64_tr_b16 a[252:253], v105 offset:61440
  ds_read_b64_tr_b16 a[254:255], v105 offset:62464
  s_waitcnt lgkmcnt(0)
  v_mfma_f32_32x32x16_bf16 v[48:63], v[80:83], a[224:227], v[48:63]
  v_mfma_f32_32x32x16_bf16 v[48:63], v[80:83], a[228:231], v[48:63]
  v_mfma_f32_32x32x16_bf16 v[48:63], v[80:83], a[232:235], v[48:63]
  v_mfma_f32_32x32x16_bf16 v[48:63], v[80:83], a[236:239], v[48:63]
  v_mfma_f32_32x32x16_bf16 v[48:63], v[80:83], a[240:243], v[48:63]
  v_mfma_f32_32x32x16_bf16 v[48:63], v[80:83], a[244:247], v[48:63]
  v_mfma_f32_32x32x16_bf16 v[48:63], v[80:83], a[248:251], v[48:63]
  v_mfma_f32_32x32x16_bf16 v[48:63], v[80:83], a[252:255], v[48:63]
  s_waitcnt vmcnt(16)
  s_barrier
  s_lshl_b32 s61, s36, 8
  s_add_u32 s61, s61, 3145728
  s_add_u32 s61, s61, s63
  s_add_u32 m0, s60, 98304
  s_add_u32 s62, s61, 0
  buffer_load_dwordx4 v100, s[24:27], s62 offen lds
  s_add_u32 m0, s60, 99328
  s_add_u32 s62, s61, 32768
  buffer_load_dwordx4 v100, s[24:27], s62 offen lds
  s_add_u32 m0, s60, 100352
  s_add_u32 s62, s61, 65536
  buffer_load_dwordx4 v100, s[24:27], s62 offen lds
  s_add_u32 m0, s60, 101376
  s_add_u32 s62, s61, 98304
  buffer_load_dwordx4 v100, s[24:27], s62 offen lds
  s_add_u32 m0, s60, 102400
  s_add_u32 s62, s61, 131072
  buffer_load_dwordx4 v100, s[24:27], s62 offen lds
  s_add_u32 m0, s60, 103424
  s_add_u32 s62, s61, 163840
  buffer_load_dwordx4 v100, s[24:27], s62 offen lds
  s_add_u32 m0, s60, 104448
  s_add_u32 s62, s61, 196608
  buffer_load_dwordx4 v100, s[24:27], s62 offen lds
  s_add_u32 m0, s60, 105472
  s_add_u32 s62, s61, 229376
  buffer_load_dwordx4 v100, s[24:27], s62 offen lds
  ds_read_b64_tr_b16 v[128:129], v104 offset:0
  ds_read_b64_tr_b16 v[130:131], v104 offset:1024
  ds_read_b64_tr_b16 v[132:133], v104 offset:4096
  ds_read_b64_tr_b16 v[134:135], v104 offset:5120
  ds_read_b64_tr_b16 v[136:137], v104 offset:8192
  ds_read_b64_tr_b16 v[138:139], v104 offset:9216
  ds_read_b64_tr_b16 v[140:141], v104 offset:12288
  ds_read_b64_tr_b16 v[142:143], v104 offset:13312
  ds_read_b64_tr_b16 v[144:145], v104 offset:16384
  ds_read_b64_tr_b16 v[146:147], v104 offset:17408
  ds_read_b64_tr_b16 v[148:149], v104 offset:20480
  ds_read_b64_tr_b16 v[150:151], v104 offset:21504
  ds_read_b64_tr_b16 v[152:153], v104 offset:24576
  ds_read_b64_tr_b16 v[154:155], v104 offset:25600
  ds_read_b64_tr_b16 v[156:157], v104 offset:28672
  ds_read_b64_tr_b16 v[158:159], v104 offset:29696
  s_waitcnt lgkmcnt(0)
  v_mfma_f32_32x32x16_bf16 v[64:79], v[80:83], v[128:131], 0
  v_mfma_f32_32x32x16_bf16 v[64:79], v[80:83], v[132:135], v[64:79]
  v_mfma_f32_32x32x16_bf16 v[64:79], v[80:83], v[136:139], v[64:79]
  v_mfma_f32_32x32x16_bf16 v[64:79], v[80:83], v[140:143], v[64:79]
  v_mfma_f32_32x32x16_bf16 v[64:79], v[80:83], v[144:147], v[64:79]
  v_mfma_f32_32x32x16_bf16 v[64:79], v[80:83], v[148:151], v[64:79]
  v_mfma_f32_32x32x16_bf16 v[64:79], v[80:83], v[152:155], v[64:79]
  v_mfma_f32_32x32x16_bf16 v[64:79], v[80:83], v[156:159], v[64:79]
  s_waitcnt vmcnt(16)
  s_barrier
  ds_read_b64_tr_b16 v[160:161], v104 offset:32768
  ds_read_b64_tr_b16 v[162:163], v104 offset:33792
  ds_read_b64_tr_b16 v[164:165], v104 offset:36864
  ds_read_b64_tr_b16 v[166:167], v104 offset:37888
  ds_read_b64_tr_b16 v[168:169], v104 offset:40960
  ds_read_b64_tr_b16 v[170:171], v104 offset:41984
  ds_read_b64_tr_b16 v[172:173], v104 offset:45056
  ds_read_b64_tr_b16 v[174:175], v104 offset:46080
  ds_read_b64_tr_b16 v[176:177], v104 offset:49152
  ds_read_b64_tr_b16 v[178:179], v104 offset:50176
  ds_read_b64_tr_b16 v[180:181], v104 offset:53248
  ds_read_b64_tr_b16 v[182:183], v104 offset:54272
  ds_read_b64_tr_b16 v[184:185], v104 offset:57344
  ds_read_b64_tr_b16 v[186:187], v104 offset:58368
  ds_read_b64_tr_b16 v[188:189], v104 offset:61440
  ds_read_b64_tr_b16 v[190:191], v104 offset:62464
  s_waitcnt lgkmcnt(0)
  v_mfma_f32_32x32x16_bf16 v[64:79], v[80:83], v[160:163], v[64:79]
  v_mfma_f32_32x32x16_bf16 v[64:79], v[80:83], v[164:167], v[64:79]
  v_mfma_f32_32x32x16_bf16 v[64:79], v[80:83], v[168:171], v[64:79]
  v_mfma_f32_32x32x16_bf16 v[64:79], v[80:83], v[172:175], v[64:79]
  v_mfma_f32_32x32x16_bf16 v[64:79], v[80:83], v[176:179], v[64:79]
  v_mfma_f32_32x32x16_bf16 v[64:79], v[80:83], v[180:183], v[64:79]
  v_mfma_f32_32x32x16_bf16 v[64:79], v[80:83], v[184:187], v[64:79]
  v_mfma_f32_32x32x16_bf16 v[64:79], v[80:83], v[188:191], v[64:79]
  s_waitcnt vmcnt(8)
  s_barrier
  ds_read_b64_tr_b16 v[192:193], v105 offset:0
  ds_read_b64_tr_b16 v[194:195], v105 offset:1024
  ds_read_b64_tr_b16 v[196:197], v105 offset:4096
  ds_read_b64_tr_b16 v[198:199], v105 offset:5120
  ds_read_b64_tr_b16 v[200:201], v105 offset:8192
  ds_read_b64_tr_b16 v[202:203], v105 offset:9216
  ds_read_b64_tr_b16 v[204:205], v105 offset:12288
  ds_read_b64_tr_b16 v[206:207], v105 offset:13312
  ds_read_b64_tr_b16 v[208:209], v105 offset:16384
  ds_read_b64_tr_b16 v[210:211], v105 offset:17408
  ds_read_b64_tr_b16 v[212:213], v105 offset:20480
  ds_read_b64_tr_b16 v[214:215], v105 offset:21504
  ds_read_b64_tr_b16 v[216:217], v105 offset:24576
  ds_read_b64_tr_b16 v[218:219], v105 offset:25600
  ds_read_b64_tr_b16 v[220:221], v105 offset:28672
  ds_read_b64_tr_b16 v[222:223], v105 offset:29696
  s_waitcnt lgkmcnt(0)
  v_mfma_f32_32x32x16_bf16 v[64:79], v[80:83], v[192:195], v[64:79]
  v_mfma_f32_32x32x16_bf16 v[64:79], v[80:83], v[196:199], v[64:79]
  v_mfma_f32_32x32x16_bf16 v[64:79], v[80:83], v[200:203], v[64:79]
  v_mfma_f32_32x32x16_bf16 v[64:79], v[80:83], v[204:207], v[64:79]
  v_mfma_f32_32x32x16_bf16 v[64:79], v[80:83], v[208:211], v[64:79]
  v_mfma_f32_32x32x16_bf16 v[64:79], v[80:83], v[212:215], v[64:79]
  v_mfma_f32_32x32x16_bf16 v[64:79], v[80:83], v[216:219], v[64:79]
  v_mfma_f32_32x32x16_bf16 v[64:79], v[80:83], v[220:223], v[64:79]
  s_waitcnt vmcnt(0)
  s_barrier
  ds_read_b64_tr_b16 v[224:225], v105 offset:32768
  ds_read_b64_tr_b16 v[226:227], v105 offset:33792
  ds_read_b64_tr_b16 v[228:229], v105 offset:36864
  ds_read_b64_tr_b16 v[230:231], v105 offset:37888
  ds_read_b64_tr_b16 v[232:233], v105 offset:40960
  ds_read_b64_tr_b16 v[234:235], v105 offset:41984
  ds_read_b64_tr_b16 v[236:237], v105 offset:45056
  ds_read_b64_tr_b16 v[238:239], v105 offset:46080
  ds_read_b64_tr_b16 v[240:241], v105 offset:49152
  ds_read_b64_tr_b16 v[242:243], v105 offset:50176
  ds_read_b64_tr_b16 v[244:245], v105 offset:53248
  ds_read_b64_tr_b16 v[246:247], v105 offset:54272
  ds_read_b64_tr_b16 v[248:249], v105 offset:57344
  ds_read_b64_tr_b16 v[250:251], v105 offset:58368
  ds_read_b64_tr_b16 v[252:253], v105 offset:61440
  ds_read_b64_tr_b16 v[254:255], v105 offset:62464
  s_waitcnt lgkmcnt(0)
  v_mfma_f32_32x32x16_bf16 v[64:79], v[80:83], v[224:227], v[64:79]
  v_mfma_f32_32x32x16_bf16 v[64:79], v[80:83], v[228:231], v[64:79]
  v_mfma_f32_32x32x16_bf16 v[64:79], v[80:83], v[232:235], v[64:79]
  v_mfma_f32_32x32x16_bf16 v[64:79], v[80:83], v[236:239], v[64:79]
  v_mfma_f32_32x32x16_bf16 v[64:79], v[80:83], v[240:243], v[64:79]
  v_mfma_f32_32x32x16_bf16 v[64:79], v[80:83], v[244:247], v[64:79]
  v_mfma_f32_32x32x16_bf16 v[64:79], v[80:83], v[248:251], v[64:79]
  v_mfma_f32_32x32x16_bf16 v[64:79], v[80:83], v[252:255], v[64:79]
  s_barrier
  v_bfe_u32 v16, v0, 4, 4
  v_lshrrev_b32 v17, 8, v0
  v_lshrrev_b32 v114, 2, v0
  v_bfe_u32 v18, v0, 6, 2
  v_lshrrev_b32 v19, 9, v0
  v_lshl_or_b32 v18, v19, 3, v18
  v_lshlrev_b32 v18, 6, v18
  v_and_b32 v20, 1, v17
  v_lshl_or_b32 v18, v20, 5, v18
  v_and_b32 v20, 3, v16
  v_lshl_or_b32 v1, v20, 3, v18
  v_and_b32 v18, 7, v16
  v_lshrrev_b32 v20, 3, v16
  v_lshl_or_b32 v18, v20, 4, v18
  v_lshlrev_b32 v18, 4, v18
  v_lshl_add_u32 v18, v17, 9, v18
  v_add_u32 v2, 73728, v18
  s_and_b32 s6, s3, 1
  s_lshl_b32 s6, s6, 8
  v_lshlrev_b32 v18, 4, v16
  v_lshl_or_b32 v18, v17, 9, v18
  v_add_u32 v113, s6, v18
  v_add_u32 v3, 65536, v113
  s_lshr_b32 s7, s3, 1
  s_lshl_b32 s6, s7, 12
  s_add_u32 s6, s6, 81920
  v_add_u32 v4, s6, v18
  s_lshl_b32 s6, s3, 11
  s_add_u32 s6, s6, 32768
  v_add_u32 v112, s6, v0
  v_mul_u32_u24 v18, 1088, v17
  v_lshl_add_u32 v18, v16, 3, v18
  s_lshl_b32 s6, s3, 8
  s_add_u32 s6, s6, 57344
  v_add_u32 v5, s6, v18
  s_lshl_b32 s6, s7, 9
  s_add_u32 s6, s6, 57344
  v_add_u32 v7, s6, v18
  v_and_b32 v18, 3, v16
  v_mul_u32_u24 v18, 1088, v18
  v_bfe_u32 v20, v0, 6, 3
  v_lshl_add_u32 v18, v20, 3, v18
  v_lshl_add_u32 v18, v19, 7, v18
  v_add_u32 v6, 57344, v18
  s_lshl_b32 s6, s3, 7
  s_add_u32 s6, s6, 61952
  v_lshlrev_b32 v18, 4, v19
  v_add_u32 v8, s6, v18
  v_and_b32 v18, 0x7c, v114
  v_add_u32 v9, s6, v18
  v_lshlrev_b32 v18, 1, v18
  v_add_u32 v15, 62464, v18
  s_lshl_b32 s6, s3, 13
  v_add_u32 v14, s6, v1
  v_mov_b32 v10, 0x3f803f80
  v_mov_b32 v11, 0x3f803f80
  s_and_b32 s6, s3, 1
  s_lshl_b32 s6, s6, 4
  v_add_u32 v16, s6, v16
  v_lshlrev_b32 v18, 4, v19
  v_and_b32 v20, 1, v17
  v_lshl_or_b32 v18, v20, 2, v18
  v_sub_u32 v16, v16, v18
  v_mov_b32 v17, 0xf149f2ca
  v_cmp_gt_i32 vcc, 0, v16
  s_nop 1
  v_cndmask_b32 v24, 0, v17, vcc
  v_cmp_gt_i32 vcc, 1, v16
  s_nop 1
  v_cndmask_b32 v25, 0, v17, vcc
  v_cmp_gt_i32 vcc, 2, v16
  s_nop 1
  v_cndmask_b32 v26, 0, v17, vcc
  v_cmp_gt_i32 vcc, 3, v16
  s_nop 1
  v_cndmask_b32 v27, 0, v17, vcc
  v_cmp_gt_i32 vcc, 8, v16
  s_nop 1
  v_cndmask_b32 v28, 0, v17, vcc
  v_cmp_gt_i32 vcc, 9, v16
  s_nop 1
  v_cndmask_b32 v29, 0, v17, vcc
  v_cmp_gt_i32 vcc, 10, v16
  s_nop 1
  v_cndmask_b32 v30, 0, v17, vcc
  v_cmp_gt_i32 vcc, 11, v16
  s_nop 1
  v_cndmask_b32 v31, 0, v17, vcc
  v_cmp_gt_u32 vcc, 512, v0
  v_cvt_pk_bf16_f32 v33, v32, v32
  v_and_b32 v33, 0xffff0000, v33
  v_sub_f32 v32, v32, v33
  v_cvt_pk_bf16_f32 v32, v32, v33
  v_cndmask_b32 v16, 0, v32, vcc
  v_cvt_pk_bf16_f32 v49, v48, v48
  v_and_b32 v49, 0xffff0000, v49
  v_sub_f32 v48, v48, v49
  v_cvt_pk_bf16_f32 v48, v48, v49
  v_cndmask_b32 v17, 0, v48, vcc
  v_cvt_pk_bf16_f32 v65, v64, v64
  v_and_b32 v65, 0xffff0000, v65
  v_sub_f32 v64, v64, v65
  v_cvt_pk_bf16_f32 v64, v64, v65
  v_cndmask_b32 v18, 0, v64, vcc
  v_mov_b32 v19, 0
  v_mov_b32 v21, 0
  v_mov_b32 v22, 0
  s_mov_b32 s7, 0
  v_mbcnt_lo_u32_b32 v92, -1, 0
  v_and_b32 v92, 3, v92
  v_lshlrev_b32 v92, 6, v92
L_wd_86:
  buffer_load_dword v93, v92, s[12:15], 0 offen offset:16 sc1
  s_waitcnt vmcnt(0)
  v_cmp_ne_u32 vcc, 64, v93
  s_cbranch_vccz L_wdo_87
  s_add_u32 s7, s7, 1
  s_cmp_lt_u32 s7, 131072
  s_cbranch_scc1 L_wd_86
  s_mov_b32 s6, 20
  s_branch L_err
L_wdo_87:
  s_mov_b32 s32, 0
  s_mov_b32 s52, 0
  s_mov_b32 s33, s37
  s_add_u32 s49, s33, 1
  s_cmp_lg_u32 s35, 0
  s_cbranch_scc1 L_p1_88
  s_mov_b32 s7, 0
L_pl_89:
  buffer_load_dwordx4 v[32:35], v0, s[8:11], s44 offen offset:0 sc1
  buffer_load_dwordx4 v[36:39], v0, s[8:11], s44 offen offset:1024 sc1
  s_waitcnt vmcnt(0)
  v_min3_u32 v32, v32, v33, v34
  v_min3_u32 v35, v35, v36, v37
  v_min3_u32 v32, v32, v38, v39
  v_min_u32 v32, v32, v35
  v_cmp_gt_u32 vcc, s49, v32
  s_cbranch_vccz L_plo_90
  s_add_u32 s7, s7, 1
  s_cmp_lt_u32 s7, 131072
  s_cbranch_scc1 L_pl_89
  s_mov_b32 s6, 21
  s_branch L_err
L_plo_90:
L_p1_88:
L_p_xwait:
  s_mov_b32 s7, 0
L_pl_91:
  buffer_load_dword v92, v114, s[8:11], s44 offen offset:0 sc1
  s_waitcnt vmcnt(0)
  v_cmp_gt_u32 vcc, s49, v92
  s_cbranch_vccz L_plo_92
  s_add_u32 s7, s7, 1
  s_cmp_lt_u32 s7, 131072
  s_cbranch_scc1 L_pl_91
  s_mov_b32 s6, 22
  s_branch L_err
L_plo_92:
  s_sub_u32 s6, s49, 1
  s_lshl_b32 s6, s6, 15
  s_add_u32 s45, s38, s6
  s_mov_b32 m0, s53
  s_add_u32 s6, s45, 4096
  buffer_load_dwordx4 v0, s[8:11], s45 offen offset:0 lds
  buffer_load_dwordx4 v0, s[8:11], s45 offen offset:1024 lds
  buffer_load_dwordx4 v0, s[8:11], s45 offen offset:2048 lds
  buffer_load_dwordx4 v0, s[8:11], s45 offen offset:3072 lds
  s_add_u32 m0, s53, 4096
  s_nop 0
  buffer_load_dwordx4 v0, s[8:11], s6 offen offset:0 lds
  buffer_load_dwordx4 v0, s[8:11], s6 offen offset:1024 lds
  buffer_load_dwordx4 v0, s[8:11], s6 offen offset:2048 lds
  buffer_load_dwordx4 v0, s[8:11], s6 offen offset:3072 lds
  s_waitcnt vmcnt(0)
L_p_loop:
  s_barrier
  s_and_b32 s6, s33, 3
  s_lshl_b32 s6, s6, 19
  s_add_u32 s46, s39, s6
  s_lshr_b32 s6, s33, 2
  s_andn2_b32 s42, 1, s6
  s_add_u32 s49, s33, 3
  s_lshl_b32 s7, s3, 8
  ds_read_b64_tr_b16 v[80:81], v1 offset:0
  ds_read_b64_tr_b16 v[82:83], v1 offset:256
  ds_read_b64_tr_b16 v[84:85], v1 offset:1024
  ds_read_b64_tr_b16 v[86:87], v1 offset:1280
  ds_read_b64_tr_b16 v[96:97], v14 offset:0
  ds_read_b64_tr_b16 v[98:99], v14 offset:256
  v_mov_b32 v92, 0
  v_mov_b32 v93, 0
  v_add_u32 v108, s7, v15
  s_waitcnt lgkmcnt(4)
  v_mfma_f32_32x32x16_bf16 v[48:63], a[128:131], v[80:83], 0
  ds_read_b64_tr_b16 v[88:89], v1 offset:2048
  ds_read_b64_tr_b16 v[90:91], v1 offset:2304
  s_waitcnt lgkmcnt(2)
  ds_read_b64_tr_b16 v[100:101], v14 offset:1024
  ds_read_b64_tr_b16 v[102:103], v14 offset:1280
  v_lshlrev_b32 v104, 16, v96
  v_mfma_f32_32x32x16_bf16 v[64:79], v[80:83], v[128:131], 0
  v_and_b32 v105, 0xffff0000, v96
  v_add_f32 v92, v92, v104
  v_fmac_f32 v93, v104, v104
  v_add_f32 v92, v92, v105
  v_mfma_f32_32x32x16_bf16 v[32:47], a[0:3], v[80:83], 0
  v_fmac_f32 v93, v105, v105
  v_lshlrev_b32 v106, 16, v97
  v_and_b32 v107, 0xffff0000, v97
  v_mfma_f32_32x32x16_bf16 v[48:63], a[132:135], v[84:87], v[48:63]
  ds_read_b64_tr_b16 v[80:81], v1 offset:3072
  ds_read_b64_tr_b16 v[82:83], v1 offset:3328
  v_add_f32 v92, v92, v106
  v_mfma_f32_32x32x16_bf16 v[64:79], v[84:87], v[132:135], v[64:79]
  v_fmac_f32 v93, v106, v106
  v_add_f32 v92, v92, v107
  v_fmac_f32 v93, v107, v107
  v_lshlrev_b32 v104, 16, v98
  v_mfma_f32_32x32x16_bf16 v[32:47], a[4:7], v[84:87], v[32:47]
  v_and_b32 v105, 0xffff0000, v98
  v_add_f32 v92, v92, v104
  v_fmac_f32 v93, v104, v104
  s_waitcnt lgkmcnt(4)
  v_mfma_f32_32x32x16_bf16 v[48:63], a[136:139], v[88:91], v[48:63]
  ds_read_b64_tr_b16 v[84:85], v1 offset:4096
  ds_read_b64_tr_b16 v[86:87], v1 offset:4352
  v_add_f32 v92, v92, v105
  v_mfma_f32_32x32x16_bf16 v[64:79], v[88:91], v[136:139], v[64:79]
  v_fmac_f32 v93, v105, v105
  v_lshlrev_b32 v106, 16, v99
  v_and_b32 v107, 0xffff0000, v99
  v_add_f32 v92, v92, v106
  v_mfma_f32_32x32x16_bf16 v[32:47], a[8:11], v[88:91], v[32:47]
  v_fmac_f32 v93, v106, v106
  v_add_f32 v92, v92, v107
  v_fmac_f32 v93, v107, v107
  s_waitcnt lgkmcnt(2)
  v_mfma_f32_32x32x16_bf16 v[48:63], a[140:143], v[80:83], v[48:63]
  ds_read_b64_tr_b16 v[88:89], v1 offset:5120
  ds_read_b64_tr_b16 v[90:91], v1 offset:5376
  ds_read_b64_tr_b16 v[96:97], v14 offset:2048
  ds_read_b64_tr_b16 v[98:99], v14 offset:2304
  v_lshlrev_b32 v104, 16, v100
  v_mfma_f32_32x32x16_bf16 v[64:79], v[80:83], v[140:143], v[64:79]
  v_and_b32 v105, 0xffff0000, v100
  v_add_f32 v92, v92, v104
  v_fmac_f32 v93, v104, v104
  v_add_f32 v92, v92, v105
  v_mfma_f32_32x32x16_bf16 v[32:47], a[12:15], v[80:83], v[32:47]
  v_fmac_f32 v93, v105, v105
  v_lshlrev_b32 v106, 16, v101
  v_and_b32 v107, 0xffff0000, v101
  s_waitcnt lgkmcnt(4)
  v_mfma_f32_32x32x16_bf16 v[48:63], a[144:147], v[84:87], v[48:63]
  ds_read_b64_tr_b16 v[80:81], v1 offset:6144
  ds_read_b64_tr_b16 v[82:83], v1 offset:6400
  v_add_f32 v92, v92, v106
  v_mfma_f32_32x32x16_bf16 v[64:79], v[84:87], v[144:147], v[64:79]
  v_fmac_f32 v93, v106, v106
  v_add_f32 v92, v92, v107
  v_fmac_f32 v93, v107, v107
  v_lshlrev_b32 v104, 16, v102
  v_mfma_f32_32x32x16_bf16 v[32:47], a[16:19], v[84:87], v[32:47]
  v_and_b32 v105, 0xffff0000, v102
  v_add_f32 v92, v92, v104
  v_fmac_f32 v93, v104, v104
  s_cmp_eq_u32 s52, 2
  s_cbranch_scc0 L_p_nof
  s_waitcnt vmcnt(0)
  s_mov_b64 exec, 1
  buffer_store_dword v126, v13, s[8:11], s43 offen sc1
  s_mov_b64 exec, -1
L_p_nof:
  s_waitcnt lgkmcnt(4)
  v_mfma_f32_32x32x16_bf16 v[48:63], a[148:151], v[88:91], v[48:63]
  ds_read_b64_tr_b16 v[84:85], v1 offset:7168
  ds_read_b64_tr_b16 v[86:87], v1 offset:7424
  v_add_f32 v92, v92, v105
  v_mfma_f32_32x32x16_bf16 v[64:79], v[88:91], v[148:151], v[64:79]
  v_fmac_f32 v93, v105, v105
  v_lshlrev_b32 v106, 16, v103
  v_and_b32 v107, 0xffff0000, v103
  v_add_f32 v92, v92, v106
  v_mfma_f32_32x32x16_bf16 v[32:47], a[20:23], v[88:91], v[32:47]
  v_fmac_f32 v93, v106, v106
  v_add_f32 v92, v92, v107
  v_fmac_f32 v93, v107, v107
  s_waitcnt lgkmcnt(2)
  v_mfma_f32_32x32x16_bf16 v[48:63], a[152:155], v[80:83], v[48:63]
  ds_read_b64_tr_b16 v[88:89], v1 offset:8192
  ds_read_b64_tr_b16 v[90:91], v1 offset:8448
  ds_read_b64_tr_b16 v[100:101], v14 offset:3072
  ds_read_b64_tr_b16 v[102:103], v14 offset:3328
  v_lshlrev_b32 v104, 16, v96
  v_mfma_f32_32x32x16_bf16 v[64:79], v[80:83], v[152:155], v[64:79]
  v_and_b32 v105, 0xffff0000, v96
  v_add_f32 v92, v92, v104
  v_fmac_f32 v93, v104, v104
  v_add_f32 v92, v92, v105
  v_mfma_f32_32x32x16_bf16 v[32:47], a[24:27], v[80:83], v[32:47]
  v_fmac_f32 v93, v105, v105
  v_lshlrev_b32 v106, 16, v97
  v_and_b32 v107, 0xffff0000, v97
  s_waitcnt lgkmcnt(4)
  v_mfma_f32_32x32x16_bf16 v[48:63], a[156:159], v[84:87], v[48:63]
  ds_read_b64_tr_b16 v[80:81], v1 offset:9216
  ds_read_b64_tr_b16 v[82:83], v1 offset:9472
  v_add_f32 v92, v92, v106
  v_mfma_f32_32x32x16_bf16 v[64:79], v[84:87], v[156:159], v[64:79]
  v_fmac_f32 v93, v106, v106
  v_add_f32 v92, v92, v107
  v_fmac_f32 v93, v107, v107
  v_lshlrev_b32 v104, 16, v98
  v_mfma_f32_32x32x16_bf16 v[32:47], a[28:31], v[84:87], v[32:47]
  v_and_b32 v105, 0xffff0000, v98
  v_add_f32 v92, v92, v104
  v_fmac_f32 v93, v104, v104
  s_waitcnt lgkmcnt(4)
  v_mfma_f32_32x32x16_bf16 v[48:63], a[160:163], v[88:91], v[48:63]
  ds_read_b64_tr_b16 v[84:85], v1 offset:10240
  ds_read_b64_tr_b16 v[86:87], v1 offset:10496
  v_add_f32 v92, v92, v105
  v_mfma_f32_32x32x16_bf16 v[64:79], v[88:91], v[160:163], v[64:79]
  v_fmac_f32 v93, v105, v105
  v_lshlrev_b32 v106, 16, v99
  v_and_b32 v107, 0xffff0000, v99
  v_add_f32 v92, v92, v106
  v_mfma_f32_32x32x16_bf16 v[32:47], a[32:35], v[88:91], v[32:47]
  v_fmac_f32 v93, v106, v106
  v_add_f32 v92, v92, v107
  v_fmac_f32 v93, v107, v107
  s_waitcnt lgkmcnt(2)
  v_mfma_f32_32x32x16_bf16 v[48:63], a[164:167], v[80:83], v[48:63]
  ds_read_b64_tr_b16 v[88:89], v1 offset:11264
  ds_read_b64_tr_b16 v[90:91], v1 offset:11520
  ds_read_b64_tr_b16 v[96:97], v14 offset:4096
  ds_read_b64_tr_b16 v[98:99], v14 offset:4352
  v_lshlrev_b32 v104, 16, v100
  v_mfma_f32_32x32x16_bf16 v[64:79], v[80:83], v[164:167], v[64:79]
  v_and_b32 v105, 0xffff0000, v100
  v_add_f32 v92, v92, v104
  v_fmac_f32 v93, v104, v104
  v_add_f32 v92, v92, v105
  v_mfma_f32_32x32x16_bf16 v[32:47], a[36:39], v[80:83], v[32:47]
  v_fmac_f32 v93, v105, v105
  v_lshlrev_b32 v106, 16, v101
  v_and_b32 v107, 0xffff0000, v101
  s_waitcnt lgkmcnt(4)
  v_mfma_f32_32x32x16_bf16 v[48:63], a[168:171], v[84:87], v[48:63]
  ds_read_b64_tr_b16 v[80:81], v1 offset:12288
  ds_read_b64_tr_b16 v[82:83], v1 offset:12544
  v_add_f32 v92, v92, v106
  v_mfma_f32_32x32x16_bf16 v[64:79], v[84:87], v[168:171], v[64:79]
  v_fmac_f32 v93, v106, v106
  v_add_f32 v92, v92, v107
  v_fmac_f32 v93, v107, v107
  v_lshlrev_b32 v104, 16, v102
  v_mfma_f32_32x32x16_bf16 v[32:47], a[40:43], v[84:87], v[32:47]
  v_and_b32 v105, 0xffff0000, v102
  v_add_f32 v92, v92, v104
  v_fmac_f32 v93, v104, v104
  s_waitcnt lgkmcnt(4)
  v_mfma_f32_32x32x16_bf16 v[48:63], a[172:175], v[88:91], v[48:63]
  ds_read_b64_tr_b16 v[84:85], v1 offset:13312
  ds_read_b64_tr_b16 v[86:87], v1 offset:13568
  v_add_f32 v92, v92, v105
  v_mfma_f32_32x32x16_bf16 v[64:79], v[88:91], v[172:175], v[64:79]
  v_fmac_f32 v93, v105, v105
  v_lshlrev_b32 v106, 16, v103
  v_and_b32 v107, 0xffff0000, v103
  v_add_f32 v92, v92, v106
  v_mfma_f32_32x32x16_bf16 v[32:47], a[44:47], v[88:91], v[32:47]
  v_fmac_f32 v93, v106, v106
  v_add_f32 v92, v92, v107
  v_fmac_f32 v93, v107, v107
  s_waitcnt lgkmcnt(2)
  v_mfma_f32_32x32x16_bf16 v[48:63], a[176:179], v[80:83], v[48:63]
  ds_read_b64_tr_b16 v[88:89], v1 offset:14336
  ds_read_b64_tr_b16 v[90:91], v1 offset:14592
  ds_read_b64_tr_b16 v[100:101], v14 offset:5120
  ds_read_b64_tr_b16 v[102:103], v14 offset:5376
  v_lshlrev_b32 v104, 16, v96
  v_mfma_f32_32x32x16_bf16 v[64:79], v[80:83], v[176:179], v[64:79]
  v_and_b32 v105, 0xffff0000, v96
  v_add_f32 v92, v92, v104
  v_fmac_f32 v93, v104, v104
  v_add_f32 v92, v92, v105
  v_mfma_f32_32x32x16_bf16 v[32:47], a[48:51], v[80:83], v[32:47]
  v_fmac_f32 v93, v105, v105
  v_lshlrev_b32 v106, 16, v97
  v_and_b32 v107, 0xffff0000, v97
  s_waitcnt lgkmcnt(4)
  v_mfma_f32_32x32x16_bf16 v[48:63], a[180:183], v[84:87], v[48:63]
  ds_read_b64_tr_b16 v[80:81], v1 offset:15360
  ds_read_b64_tr_b16 v[82:83], v1 offset:15616
  v_add_f32 v92, v92, v106
  v_mfma_f32_32x32x16_bf16 v[64:79], v[84:87], v[180:183], v[64:79]
  v_fmac_f32 v93, v106, v106
  v_add_f32 v92, v92, v107
  v_fmac_f32 v93, v107, v107
  v_lshlrev_b32 v104, 16, v98
  v_mfma_f32_32x32x16_bf16 v[32:47], a[52:55], v[84:87], v[32:47]
  v_and_b32 v105, 0xffff0000, v98
  v_add_f32 v92, v92, v104
  v_fmac_f32 v93, v104, v104
  s_waitcnt lgkmcnt(4)
  v_mfma_f32_32x32x16_bf16 v[48:63], a[184:187], v[88:91], v[48:63]
  ds_read_b64_tr_b16 v[84:85], v1 offset:16384
  ds_read_b64_tr_b16 v[86:87], v1 offset:16640
  v_add_f32 v92, v92, v105
  v_mfma_f32_32x32x16_bf16 v[64:79], v[88:91], v[184:187], v[64:79]
  v_fmac_f32 v93, v105, v105
  v_lshlrev_b32 v106, 16, v99
  v_and_b32 v107, 0xffff0000, v99
  v_add_f32 v92, v92, v106
  v_mfma_f32_32x32x16_bf16 v[32:47], a[56:59], v[88:91], v[32:47]
  v_fmac_f32 v93, v106, v106
  v_add_f32 v92, v92, v107
  v_fmac_f32 v93, v107, v107
  s_waitcnt lgkmcnt(2)
  v_mfma_f32_32x32x16_bf16 v[48:63], a[188:191], v[80:83], v[48:63]
  ds_read_b64_tr_b16 v[88:89], v1 offset:17408
  ds_read_b64_tr_b16 v[90:91], v1 offset:17664
  ds_read_b64_tr_b16 v[96:97], v14 offset:6144
  ds_read_b64_tr_b16 v[98:99], v14 offset:6400
  v_lshlrev_b32 v104, 16, v100
  v_mfma_f32_32x32x16_bf16 v[64:79], v[80:83], v[188:191], v[64:79]
  v_and_b32 v105, 0xffff0000, v100
  v_add_f32 v92, v92, v104
  v_fmac_f32 v93, v104, v104
  v_add_f32 v92, v92, v105
  v_mfma_f32_32x32x16_bf16 v[32:47], a[60:63], v[80:83], v[32:47]
  v_fmac_f32 v93, v105, v105
  v_lshlrev_b32 v106, 16, v101
  v_and_b32 v107, 0xffff0000, v101
  s_waitcnt lgkmcnt(4)
  v_mfma_f32_32x32x16_bf16 v[48:63], a[192:195], v[84:87], v[48:63]
  ds_read_b64_tr_b16 v[80:81], v1 offset:18432
  ds_read_b64_tr_b16 v[82:83], v1 offset:18688
  v_add_f32 v92, v92, v106
  v_mfma_f32_32x32x16_bf16 v[64:79], v[84:87], v[192:195], v[64:79]
  v_fmac_f32 v93, v106, v106
  v_add_f32 v92, v92, v107
  v_fmac_f32 v93, v107, v107
  v_lshlrev_b32 v104, 16, v102
  v_mfma_f32_32x32x16_bf16 v[32:47], a[64:67], v[84:87], v[32:47]
  v_and_b32 v105, 0xffff0000, v102
  v_add_f32 v92, v92, v104
  v_fmac_f32 v93, v104, v104
  s_waitcnt lgkmcnt(4)
  v_mfma_f32_32x32x16_bf16 v[48:63], a[196:199], v[88:91], v[48:63]
  ds_read_b64_tr_b16 v[84:85], v1 offset:19456
  ds_read_b64_tr_b16 v[86:87], v1 offset:19712
  v_add_f32 v92, v92, v105
  v_mfma_f32_32x32x16_bf16 v[64:79], v[88:91], v[196:199], v[64:79]
  v_fmac_f32 v93, v105, v105
  v_lshlrev_b32 v106, 16, v103
  v_and_b32 v107, 0xffff0000, v103
  v_add_f32 v92, v92, v106
  v_mfma_f32_32x32x16_bf16 v[32:47], a[68:71], v[88:91], v[32:47]
  v_fmac_f32 v93, v106, v106
  v_add_f32 v92, v92, v107
  v_fmac_f32 v93, v107, v107
  s_waitcnt lgkmcnt(2)
  v_mfma_f32_32x32x16_bf16 v[48:63], a[200:203], v[80:83], v[48:63]
  ds_read_b64_tr_b16 v[88:89], v1 offset:20480
  ds_read_b64_tr_b16 v[90:91], v1 offset:20736
  ds_read_b64_tr_b16 v[100:101], v14 offset:7168
  ds_read_b64_tr_b16 v[102:103], v14 offset:7424
  v_lshlrev_b32 v104, 16, v96
  v_mfma_f32_32x32x16_bf16 v[64:79], v[80:83], v[200:203], v[64:79]
  v_and_b32 v105, 0xffff0000, v96
  v_add_f32 v92, v92, v104
  v_fmac_f32 v93, v104, v104
  v_add_f32 v92, v92, v105
  v_mfma_f32_32x32x16_bf16 v[32:47], a[72:75], v[80:83], v[32:47]
  v_fmac_f32 v93, v105, v105
  v_lshlrev_b32 v106, 16, v97
  v_and_b32 v107, 0xffff0000, v97
  s_waitcnt lgkmcnt(4)
  v_mfma_f32_32x32x16_bf16 v[48:63], a[204:207], v[84:87], v[48:63]
  ds_read_b64_tr_b16 v[80:81], v1 offset:21504
  ds_read_b64_tr_b16 v[82:83], v1 offset:21760
  v_add_f32 v92, v92, v106
  v_mfma_f32_32x32x16_bf16 v[64:79], v[84:87], v[204:207], v[64:79]
  v_fmac_f32 v93, v106, v106
  v_add_f32 v92, v92, v107
  v_fmac_f32 v93, v107, v107
  v_lshlrev_b32 v104, 16, v98
  v_mfma_f32_32x32x16_bf16 v[32:47], a[76:79], v[84:87], v[32:47]
  v_and_b32 v105, 0xffff0000, v98
  v_add_f32 v92, v92, v104
  v_fmac_f32 v93, v104, v104
  s_waitcnt lgkmcnt(4)
  v_mfma_f32_32x32x16_bf16 v[48:63], a[208:211], v[88:91], v[48:63]
  ds_read_b64_tr_b16 v[84:85], v1 offset:22528
  ds_read_b64_tr_b16 v[86:87], v1 offset:22784
  v_add_f32 v92, v92, v105
  v_mfma_f32_32x32x16_bf16 v[64:79], v[88:91], v[208:211], v[64:79]
  v_fmac_f32 v93, v105, v105
  v_lshlrev_b32 v106, 16, v99
  v_and_b32 v107, 0xffff0000, v99
  v_add_f32 v92, v92, v106
  v_mfma_f32_32x32x16_bf16 v[32:47], a[80:83], v[88:91], v[32:47]
  v_fmac_f32 v93, v106, v106
  v_add_f32 v92, v92, v107
  v_fmac_f32 v93, v107, v107
  s_waitcnt lgkmcnt(2)
  v_mfma_f32_32x32x16_bf16 v[48:63], a[212:215], v[80:83], v[48:63]
  ds_read_b64_tr_b16 v[88:89], v1 offset:23552
  ds_read_b64_tr_b16 v[90:91], v1 offset:23808
  v_mfma_f32_32x32x16_bf16 v[64:79], v[80:83], v[212:215], v[64:79]
  v_lshlrev_b32 v104, 16, v100
  v_and_b32 v105, 0xffff0000, v100
  v_add_f32 v92, v92, v104
  v_fmac_f32 v93, v104, v104
  v_mfma_f32_32x32x16_bf16 v[32:47], a[84:87], v[80:83], v[32:47]
  v_add_f32 v92, v92, v105
  v_fmac_f32 v93, v105, v105
  v_lshlrev_b32 v106, 16, v101
  v_and_b32 v107, 0xffff0000, v101
  s_waitcnt lgkmcnt(2)
  v_mfma_f32_32x32x16_bf16 v[48:63], a[216:219], v[84:87], v[48:63]
  ds_read_b64_tr_b16 v[80:81], v1 offset:24576
  ds_read_b64_tr_b16 v[82:83], v1 offset:24832
  v_add_f32 v92, v92, v106
  v_mfma_f32_32x32x16_bf16 v[64:79], v[84:87], v[216:219], v[64:79]
  v_fmac_f32 v93, v106, v106
  v_add_f32 v92, v92, v107
  v_fmac_f32 v93, v107, v107
  v_lshlrev_b32 v104, 16, v102
  v_mfma_f32_32x32x16_bf16 v[32:47], a[88:91], v[84:87], v[32:47]
  v_and_b32 v105, 0xffff0000, v102
  v_add_f32 v92, v92, v104
  v_fmac_f32 v93, v104, v104
  s_waitcnt lgkmcnt(2)
  v_mfma_f32_32x32x16_bf16 v[48:63], a[220:223], v[88:91], v[48:63]
  ds_read_b64_tr_b16 v[84:85], v1 offset:25600
  ds_read_b64_tr_b16 v[86:87], v1 offset:25856
  v_add_f32 v92, v92, v105
  v_mfma_f32_32x32x16_bf16 v[64:79], v[88:91], v[220:223], v[64:79]
  v_fmac_f32 v93, v105, v105
  v_lshlrev_b32 v106, 16, v103
  v_and_b32 v107, 0xffff0000, v103
  v_add_f32 v92, v92, v106
  v_mfma_f32_32x32x16_bf16 v[32:47], a[92:95], v[88:91], v[32:47]
  v_fmac_f32 v93, v106, v106
  v_add_f32 v92, v92, v107
  v_fmac_f32 v93, v107, v107
  s_waitcnt lgkmcnt(2)
  v_mfma_f32_32x32x16_bf16 v[48:63], a[224:227], v[80:83], v[48:63]
  ds_read_b64_tr_b16 v[88:89], v1 offset:26624
  ds_read_b64_tr_b16 v[90:91], v1 offset:26880
  v_mov_b32 v94, v92
  v_mfma_f32_32x32x16_bf16 v[64:79], v[80:83], v[224:227], v[64:79]
  v_mov_b32 v95, v93
  v_permlane32_swap_b32 v92, v94
  s_nop 0
  v_permlane32_swap_b32 v93, v95
  v_add_f32 v92, v92, v94
  v_mfma_f32_32x32x16_bf16 v[32:47], a[96:99], v[80:83], v[32:47]
  v_add_f32 v93, v93, v95
  ds_write_b64 v108, v[92:93]
  s_waitcnt lgkmcnt(3)
  v_mfma_f32_32x32x16_bf16 v[48:63], a[228:231], v[84:87], v[48:63]
  ds_read_b64_tr_b16 v[80:81], v1 offset:27648
  ds_read_b64_tr_b16 v[82:83], v1 offset:27904
  v_mfma_f32_32x32x16_bf16 v[64:79], v[84:87], v[228:231], v[64:79]
  s_waitcnt lgkmcnt(2)
  s_barrier
  ds_read_b64 v[96:97], v15 offset:0
  ds_read_b64 v[98:99], v15 offset:256
  v_mfma_f32_32x32x16_bf16 v[32:47], a[100:103], v[84:87], v[32:47]
  ds_read_b64 v[100:101], v15 offset:512
  ds_read_b64 v[102:103], v15 offset:768
  v_mfma_f32_32x32x16_bf16 v[48:63], a[232:235], v[88:91], v[48:63]
  ds_read_b64_tr_b16 v[84:85], v1 offset:28672
  ds_read_b64_tr_b16 v[86:87], v1 offset:28928
  v_mfma_f32_32x32x16_bf16 v[64:79], v[88:91], v[232:235], v[64:79]
  v_mfma_f32_32x32x16_bf16 v[32:47], a[104:107], v[88:91], v[32:47]
  s_waitcnt lgkmcnt(6)
  v_mfma_f32_32x32x16_bf16 v[48:63], a[236:239], v[80:83], v[48:63]
  ds_read_b64_tr_b16 v[88:89], v1 offset:29696
  ds_read_b64_tr_b16 v[90:91], v1 offset:29952
  s_waitcnt lgkmcnt(4)
  v_mfma_f32_32x32x16_bf16 v[64:79], v[80:83], v[236:239], v[64:79]
  v_add_f32 v92, v96, v98
  v_add_f32 v93, v97, v99
  v_add_f32 v94, v100, v102
  v_add_f32 v95, v101, v103
  v_mfma_f32_32x32x16_bf16 v[32:47], a[108:111], v[80:83], v[32:47]
  v_add_f32 v92, v92, v94
  v_add_f32 v93, v93, v95
  v_mul_f32 v92, 0x3b000000, v92
  s_waitcnt lgkmcnt(2)
  v_mfma_f32_32x32x16_bf16 v[48:63], a[240:243], v[84:87], v[48:63]
  ds_read_b64_tr_b16 v[80:81], v1 offset:30720
  ds_read_b64_tr_b16 v[82:83], v1 offset:30976
  v_mul_f32 v94, v92, v92
  v_mfma_f32_32x32x16_bf16 v[64:79], v[84:87], v[240:243], v[64:79]
  v_mul_f32 v93, 0x3b000000, v93
  v_sub_f32 v93, v93, v94
  v_max_f32 v93, 0, v93
  v_cvt_pk_bf16_f32 v93, v93, v93
  v_mfma_f32_32x32x16_bf16 v[32:47], a[112:115], v[84:87], v[32:47]
  v_and_b32 v93, 0xffff0000, v93
  v_add_f32 v93, 0x3727c5ac, v93
  v_cvt_pk_bf16_f32 v93, v93, v93
  s_waitcnt lgkmcnt(2)
  v_mfma_f32_32x32x16_bf16 v[48:63], a[244:247], v[88:91], v[48:63]
  ds_read_b64_tr_b16 v[84:85], v1 offset:31744
  ds_read_b64_tr_b16 v[86:87], v1 offset:32000
  v_and_b32 v93, 0xffff0000, v93
  v_mfma_f32_32x32x16_bf16 v[64:79], v[88:91], v[244:247], v[64:79]
  v_sqrt_f32 v93, v93
  v_cvt_pk_bf16_f32 v92, v92, v92
  v_and_b32 v92, 0xffff0000, v92
  v_cvt_pk_bf16_f32 v93, v93, v93
  v_mfma_f32_32x32x16_bf16 v[32:47], a[116:119], v[88:91], v[32:47]
  v_and_b32 v93, 0xffff0000, v93
  v_rcp_f32 v93, v93
  v_xor_b32 v92, 0x80000000, v92
  s_waitcnt lgkmcnt(2)
  v_mfma_f32_32x32x16_bf16 v[48:63], a[248:251], v[80:83], v[48:63]
  v_lshrrev_b32 v94, 16, v92
  v_mfma_f32_32x32x16_bf16 v[64:79], v[80:83], v[248:251], v[64:79]
  v_or_b32 v20, v92, v94
  v_or_b32 v23, v92, v94
  v_mov_b32 v92, v93
  ds_write_b32 v9, v93
  v_mfma_f32_32x32x16_bf16 v[32:47], a[120:123], v[80:83], v[32:47]
  s_waitcnt lgkmcnt(1)
  v_mfma_f32_32x32x16_bf16 v[48:63], a[252:255], v[84:87], v[48:63]
  ds_read_b128 v[96:99], v8 offset:0
  v_mfma_f32_32x32x16_bf16 v[64:79], v[84:87], v[252:255], v[64:79]
  ds_read_b128 v[100:103], v8 offset:32
  ds_read_b128 v[104:107], v8 offset:64
  ds_read_b128 v[108:111], v8 offset:96
  v_mfma_f32_32x32x16_bf16 v[32:47], a[124:127], v[84:87], v[32:47]
  s_sub_u32 s51, s33, 2
  s_and_b32 s6, s51, 3
  s_lshl_b32 s6, s6, 17
  s_add_u32 s47, s40, s6
  s_lshr_b32 s6, s51, 2
  s_andn2_b32 s50, 1, s6
  s_lshl_b32 s6, s51, 18
  s_add_u32 s48, s41, s6
  s_add_u32 s51, s51, 1
  buffer_load_dwordx4 v[116:119], v0, s[8:11], s47 offen sc1
  buffer_load_dword v115, v114, s[8:11], s44 offen sc1
  v_mfma_f32_32x32x8_bf16 v[48:63], v[16:17], v[22:23], v[48:63]
  v_mfma_f32_32x32x8_bf16 v[64:79], v[20:21], v[18:19], v[64:79]
  v_mfma_f32_32x32x8_bf16 v[32:47], v[16:17], v[20:21], v[32:47]
  s_add_u32 s7, s46, 0x2000
  s_nop 8
  v_pk_mul_f32 v[48:49], v[48:49], v[92:93]
  v_pk_mul_f32 v[50:51], v[50:51], v[92:93]
  v_pk_mul_f32 v[52:53], v[52:53], v[92:93]
  v_pk_mul_f32 v[54:55], v[54:55], v[92:93]
  v_pk_mul_f32 v[56:57], v[56:57], v[92:93]
  v_pk_mul_f32 v[58:59], v[58:59], v[92:93]
  v_pk_mul_f32 v[60:61], v[60:61], v[92:93]
  v_pk_mul_f32 v[62:63], v[62:63], v[92:93]
  v_cvt_pk_bf16_f32 v48, v48, v49
  v_cvt_pk_bf16_f32 v49, v50, v51
  v_cvt_pk_bf16_f32 v50, v52, v53
  v_cvt_pk_bf16_f32 v51, v54, v55
  v_cvt_pk_bf16_f32 v52, v56, v57
  v_cvt_pk_bf16_f32 v53, v58, v59
  v_cvt_pk_bf16_f32 v54, v60, v61
  v_cvt_pk_bf16_f32 v55, v62, v63
  v_bfi_b32 v48, 1, s42, v48
  v_bfi_b32 v52, 1, s42, v52
  buffer_store_dwordx4 v[48:51], v0, s[8:11], s46 offen offset:0 sc1
  ds_write_b128 v112, v[48:51] offset:8192
  buffer_store_dwordx4 v[52:55], v0, s[8:11], s46 offen offset:1024 sc1
  ds_write_b128 v112, v[52:55] offset:9216
  s_waitcnt lgkmcnt(2)
  v_pk_mul_f32 v[64:65], v[64:65], v[96:97]
  v_pk_mul_f32 v[66:67], v[66:67], v[98:99]
  v_pk_mul_f32 v[68:69], v[68:69], v[100:101]
  v_pk_mul_f32 v[70:71], v[70:71], v[102:103]
  v_pk_mul_f32 v[72:73], v[72:73], v[104:105]
  v_pk_mul_f32 v[74:75], v[74:75], v[106:107]
  v_pk_mul_f32 v[76:77], v[76:77], v[108:109]
  v_pk_mul_f32 v[78:79], v[78:79], v[110:111]
  v_cvt_pk_bf16_f32 v64, v64, v65
  v_cvt_pk_bf16_f32 v65, v66, v67
  v_cvt_pk_bf16_f32 v66, v68, v69
  v_cvt_pk_bf16_f32 v67, v70, v71
  v_cvt_pk_bf16_f32 v68, v72, v73
  v_cvt_pk_bf16_f32 v69, v74, v75
  v_cvt_pk_bf16_f32 v70, v76, v77
  v_cvt_pk_bf16_f32 v71, v78, v79
  v_bfi_b32 v64, 1, s42, v64
  v_bfi_b32 v68, 1, s42, v68
  buffer_store_dwordx4 v[64:67], v0, s[8:11], s7 offen offset:0 sc1
  ds_write_b128 v112, v[64:67] offset:16384
  buffer_store_dwordx4 v[68:71], v0, s[8:11], s7 offen offset:1024 sc1
  ds_write_b128 v112, v[68:71] offset:17408
  v_pk_mul_f32 v[32:33], v[32:33], v[92:93]
  v_pk_mul_f32 v[34:35], v[34:35], v[92:93]
  v_pk_mul_f32 v[36:37], v[36:37], v[92:93]
  v_pk_mul_f32 v[38:39], v[38:39], v[92:93]
  v_pk_mul_f32 v[40:41], v[40:41], v[92:93]
  v_pk_mul_f32 v[42:43], v[42:43], v[92:93]
  v_pk_mul_f32 v[44:45], v[44:45], v[92:93]
  v_pk_mul_f32 v[46:47], v[46:47], v[92:93]
  v_cvt_pk_bf16_f32 v32, v32, v33
  v_cvt_pk_bf16_f32 v33, v34, v35
  v_cvt_pk_bf16_f32 v34, v36, v37
  v_cvt_pk_bf16_f32 v35, v38, v39
  v_cvt_pk_bf16_f32 v36, v40, v41
  v_cvt_pk_bf16_f32 v37, v42, v43
  v_cvt_pk_bf16_f32 v38, v44, v45
  v_cvt_pk_bf16_f32 v39, v46, v47
  ds_write_b128 v112, v[32:35] offset:0
  ds_write_b128 v112, v[36:39] offset:1024
  s_cmp_eq_u32 s32, 0
  s_cbranch_scc1 L_p_first
L_p_att:
  ds_read_b128 v[64:67], v3 offset:0
  ds_read_b128 v[32:35], v2 offset:0
  ds_read_b128 v[48:51], v2 offset:128
  ds_read_b128 v[68:71], v3 offset:2048
  ds_read_b128 v[36:39], v2 offset:2048
  ds_read_b128 v[52:55], v2 offset:2176
  ds_read_b128 v[72:75], v3 offset:4096
  ds_read_b128 v[40:43], v2 offset:4096
  ds_read_b128 v[56:59], v2 offset:4224
  ds_read_b128 v[76:79], v3 offset:6144
  ds_read_b128 v[44:47], v2 offset:6144
  ds_read_b128 v[60:63], v2 offset:6272
  s_waitcnt lgkmcnt(9)
  v_mfma_f32_16x16x32_bf16 v[96:99], v[32:35], v[64:67], v[24:27]
  v_mfma_f32_16x16x32_bf16 v[100:103], v[48:51], v[64:67], v[28:31]
  s_waitcnt lgkmcnt(6)
  v_mfma_f32_16x16x32_bf16 v[96:99], v[36:39], v[68:71], v[96:99]
  v_mfma_f32_16x16x32_bf16 v[100:103], v[52:55], v[68:71], v[100:103]
  s_waitcnt lgkmcnt(3)
  v_mfma_f32_16x16x32_bf16 v[96:99], v[40:43], v[72:75], v[96:99]
  v_mfma_f32_16x16x32_bf16 v[100:103], v[56:59], v[72:75], v[100:103]
  s_waitcnt lgkmcnt(0)
  v_mfma_f32_16x16x32_bf16 v[96:99], v[44:47], v[76:79], v[96:99]
  v_mfma_f32_16x16x32_bf16 v[100:103], v[60:63], v[76:79], v[100:103]
  ds_read_b128 v[80:83], v4 offset:0
  ds_read_b128 v[84:87], v4 offset:256
  ds_read_b128 v[88:91], v4 offset:2048
  ds_read_b128 v[92:95], v4 offset:2304
  s_mov_b32 s52, 0
  s_barrier
  s_mov_b32 s7, 0
  s_waitcnt vmcnt(4)
L_p_km:
  v_bitop3_b32 v126, v116, s50, 1 bitop3:0x28
  v_cmp_ne_u32 vcc, 0, v126
  s_cbranch_vccz L_p_kmok
  buffer_load_dwordx4 v[116:119], v0, s[8:11], s47 offen sc1
  s_cmp_lg_u32 s52, 0
  s_cbranch_scc1 L_p_k0
  s_cmp_ge_u32 s32, 31
  s_cbranch_scc1 L_p_k0
  v_cmp_gt_u32 vcc, s49, v115
  s_cbranch_vccnz L_p_k1
  s_mov_b32 s52, 1
  s_sub_u32 s6, s49, 1
  s_lshl_b32 s6, s6, 15
  s_add_u32 s45, s38, s6
  s_mov_b32 m0, s53
  s_add_u32 s6, s45, 4096
  buffer_load_dwordx4 v0, s[8:11], s45 offen offset:0 lds
  buffer_load_dwordx4 v0, s[8:11], s45 offen offset:1024 lds
  buffer_load_dwordx4 v0, s[8:11], s45 offen offset:2048 lds
  buffer_load_dwordx4 v0, s[8:11], s45 offen offset:3072 lds
  s_add_u32 m0, s53, 4096
  s_nop 0
  buffer_load_dwordx4 v0, s[8:11], s6 offen offset:0 lds
  buffer_load_dwordx4 v0, s[8:11], s6 offen offset:1024 lds
  buffer_load_dwordx4 v0, s[8:11], s6 offen offset:2048 lds
  buffer_load_dwordx4 v0, s[8:11], s6 offen offset:3072 lds
  s_waitcnt vmcnt(8)
  s_branch L_p_k2
L_p_k1:
  buffer_load_dword v115, v114, s[8:11], s44 offen sc1
L_p_k0:
  s_waitcnt vmcnt(0)
L_p_k2:
  s_add_u32 s7, s7, 1
  s_cmp_lt_u32 s7, 131072
  s_cbranch_scc1 L_p_km
  s_mov_b32 s6, 23
  s_branch L_err
L_p_kmok:
  s_cmp_lg_u32 s52, 0
  s_cbranch_scc1 L_nx_93
  s_cmp_ge_u32 s32, 31
  s_cbranch_scc1 L_nx_93
  v_cmp_gt_u32 vcc, s49, v115
  s_cbranch_vccnz L_nx_94
  s_mov_b32 s52, 1
  s_sub_u32 s6, s49, 1
  s_lshl_b32 s6, s6, 15
  s_add_u32 s45, s38, s6
  s_mov_b32 m0, s53
  s_add_u32 s6, s45, 4096
  buffer_load_dwordx4 v0, s[8:11], s45 offen offset:0 lds
  buffer_load_dwordx4 v0, s[8:11], s45 offen offset:1024 lds
  buffer_load_dwordx4 v0, s[8:11], s45 offen offset:2048 lds
  buffer_load_dwordx4 v0, s[8:11], s45 offen offset:3072 lds
  s_add_u32 m0, s53, 4096
  s_nop 0
  buffer_load_dwordx4 v0, s[8:11], s6 offen offset:0 lds
  buffer_load_dwordx4 v0, s[8:11], s6 offen offset:1024 lds
  buffer_load_dwordx4 v0, s[8:11], s6 offen offset:2048 lds
  buffer_load_dwordx4 v0, s[8:11], s6 offen offset:3072 lds
  s_branch L_nx_93
L_nx_94:
  buffer_load_dword v115, v114, s[8:11], s44 offen sc1
L_nx_93:
  ds_write_b64 v5, v[116:117]
  ds_write_b64 v5, v[118:119] offset:128
  v_max3_f32 v124, v96, v97, v98
  v_max3_f32 v125, v100, v101, v102
  v_max3_f32 v124, v124, v99, v103
  s_waitcnt lgkmcnt(0)
  s_barrier
  ds_read_b64_tr_b16 v[32:33], v6 offset:0
  ds_read_b64_tr_b16 v[34:35], v6 offset:64
  ds_read_b64_tr_b16 v[36:37], v6 offset:256
  ds_read_b64_tr_b16 v[38:39], v6 offset:320
  ds_read_b64_tr_b16 v[40:41], v6 offset:512
  ds_read_b64_tr_b16 v[42:43], v6 offset:576
  ds_read_b64_tr_b16 v[44:45], v6 offset:768
  ds_read_b64_tr_b16 v[46:47], v6 offset:832
  ds_read_b64 v[48:49], v7 offset:0
  ds_read_b64 v[50:51], v7 offset:128
  ds_read_b64 v[52:53], v7 offset:256
  ds_read_b64 v[54:55], v7 offset:384
  s_waitcnt lgkmcnt(10)
  v_mfma_f32_16x16x32_bf16 v[104:107], v[32:35], v[64:67], 0
  s_waitcnt lgkmcnt(8)
  v_mfma_f32_16x16x32_bf16 v[104:107], v[36:39], v[68:71], v[104:107]
  s_waitcnt lgkmcnt(6)
  v_mfma_f32_16x16x32_bf16 v[104:107], v[40:43], v[72:75], v[104:107]
  s_waitcnt lgkmcnt(4)
  v_mfma_f32_16x16x32_bf16 v[104:107], v[44:47], v[76:79], v[104:107]
  v_max_f32 v124, v124, v125
  s_nop 6
  v_max3_f32 v124, v124, v106, v107
  v_mov_b32 v125, v124
  s_nop 1
  v_permlane32_swap_b32 v124, v125
  v_max_f32 v124, v124, v125
  v_max_f32 v125, v124, v125
  s_nop 1
  v_permlane16_swap_b32 v124, v125
  v_max_f32 v124, v124, v125
  v_mul_f32 v124, s34, v124
  v_fma_f32 v106, v106, s34, -v124
  v_fma_f32 v107, v107, s34, -v124
  v_fma_f32 v96, v96, s34, -v124
  v_fma_f32 v97, v97, s34, -v124
  v_fma_f32 v98, v98, s34, -v124
  v_fma_f32 v99, v99, s34, -v124
  v_fma_f32 v100, v100, s34, -v124
  v_fma_f32 v101, v101, s34, -v124
  v_fma_f32 v102, v102, s34, -v124
  v_fma_f32 v103, v103, s34, -v124
  v_exp_f32 v106, v106
  v_exp_f32 v107, v107
  v_exp_f32 v96, v96
  v_cvt_pk_bf16_f32 v12, v106, v107
  v_exp_f32 v97, v97
  s_waitcnt lgkmcnt(0)
  v_mfma_f32_16x16x16_bf16 v[108:111], v[10:11], v[12:13], 0
  v_mfma_f32_16x16x16_bf16 v[56:59], v[48:49], v[12:13], 0
  v_exp_f32 v98, v98
  v_exp_f32 v99, v99
  v_mfma_f32_16x16x16_bf16 v[60:63], v[50:51], v[12:13], 0
  v_exp_f32 v100, v100
  v_exp_f32 v101, v101
  v_mfma_f32_16x16x16_bf16 v[64:67], v[52:53], v[12:13], 0
  v_exp_f32 v102, v102
  v_exp_f32 v103, v103
  v_mfma_f32_16x16x16_bf16 v[68:71], v[54:55], v[12:13], 0
  v_cvt_pk_bf16_f32 v120, v96, v97
  v_cvt_pk_bf16_f32 v121, v98, v99
  v_cvt_pk_bf16_f32 v122, v100, v101
  v_cvt_pk_bf16_f32 v123, v102, v103
  v_mfma_f32_16x16x16_bf16 v[108:111], v[10:11], v[120:121], v[108:111]
  s_nop 0
  v_mfma_f32_16x16x16_bf16 v[108:111], v[10:11], v[122:123], v[108:111]
  v_mfma_f32_16x16x32_bf16 v[56:59], v[80:83], v[120:123], v[56:59]
  v_mfma_f32_16x16x32_bf16 v[60:63], v[84:87], v[120:123], v[60:63]
  v_mfma_f32_16x16x32_bf16 v[64:67], v[88:91], v[120:123], v[64:67]
  v_mfma_f32_16x16x32_bf16 v[68:71], v[92:95], v[120:123], v[68:71]
  s_nop 3
  v_rcp_f32 v108, v108
  v_mov_b32 v126, s51
  v_pk_mul_f32 v[56:57], v[56:57], v[108:109] op_sel_hi:[1,0]
  v_pk_mul_f32 v[58:59], v[58:59], v[108:109] op_sel_hi:[1,0]
  v_pk_mul_f32 v[60:61], v[60:61], v[108:109] op_sel_hi:[1,0]
  v_pk_mul_f32 v[62:63], v[62:63], v[108:109] op_sel_hi:[1,0]
  v_cvt_pk_bf16_f32 v56, v56, v57
  v_cvt_pk_bf16_f32 v57, v58, v59
  v_cvt_pk_bf16_f32 v58, v60, v61
  v_cvt_pk_bf16_f32 v59, v62, v63
  buffer_store_dwordx4 v[56:59], v113, s[8:11], s48 offen offset:0 sc1
  v_pk_mul_f32 v[64:65], v[64:65], v[108:109] op_sel_hi:[1,0]
  v_pk_mul_f32 v[66:67], v[66:67], v[108:109] op_sel_hi:[1,0]
  v_pk_mul_f32 v[68:69], v[68:69], v[108:109] op_sel_hi:[1,0]
  v_pk_mul_f32 v[70:71], v[70:71], v[108:109] op_sel_hi:[1,0]
  v_cvt_pk_bf16_f32 v64, v64, v65
  v_cvt_pk_bf16_f32 v65, v66, v67
  v_cvt_pk_bf16_f32 v66, v68, v69
  v_cvt_pk_bf16_f32 v67, v70, v71
  buffer_store_dwordx4 v[64:67], v113, s[8:11], s48 offen offset:2048 sc1
  s_cmp_ge_u32 s32, 31
  s_cbranch_scc1 L_p_of
  s_cmp_lg_u32 s52, 0
  s_cbranch_scc1 L_p_of3
  s_waitcnt vmcnt(2)
  v_cmp_gt_u32 vcc, s49, v115
  s_cbranch_vccnz L_p_of
  s_mov_b32 s52, 1
  s_sub_u32 s6, s49, 1
  s_lshl_b32 s6, s6, 15
  s_add_u32 s45, s38, s6
  s_mov_b32 m0, s53
  s_add_u32 s6, s45, 4096
  buffer_load_dwordx4 v0, s[8:11], s45 offen offset:0 lds
  buffer_load_dwordx4 v0, s[8:11], s45 offen offset:1024 lds
  buffer_load_dwordx4 v0, s[8:11], s45 offen offset:2048 lds
  buffer_load_dwordx4 v0, s[8:11], s45 offen offset:3072 lds
  s_add_u32 m0, s53, 4096
  s_nop 0
  buffer_load_dwordx4 v0, s[8:11], s6 offen offset:0 lds
  buffer_load_dwordx4 v0, s[8:11], s6 offen offset:1024 lds
  buffer_load_dwordx4 v0, s[8:11], s6 offen offset:2048 lds
  buffer_load_dwordx4 v0, s[8:11], s6 offen offset:3072 lds
  s_waitcnt vmcnt(8)
  s_mov_b64 exec, 1
  buffer_store_dword v126, v13, s[8:11], s43 offen sc1
  s_mov_b64 exec, -1
  s_waitcnt vmcnt(1)
  s_branch L_p_of2
L_p_of3:
  s_mov_b32 s52, 2
  s_waitcnt vmcnt(2)
  s_branch L_p_of2
L_p_of:
  s_waitcnt vmcnt(0)
  s_mov_b64 exec, 1
  buffer_store_dword v126, v13, s[8:11], s43 offen sc1
  s_mov_b64 exec, -1
L_p_of2:
L_p_next:
  v_xor_b32 v2, 0x18000, v2
  v_xor_b32 v3, 0x18000, v3
  v_xor_b32 v4, 0x18000, v4
  v_xor_b32 v112, 0x18000, v112
  s_add_u32 s32, s32, 1
  s_add_u32 s33, s33, 2
  s_cmp_gt_u32 s32, 32
  s_cbranch_scc1 L_p_end
  s_cmp_eq_u32 s32, 32
  s_cbranch_scc1 L_p_tail
  s_cmp_eq_u32 s52, 0
  s_cbranch_scc1 L_p_xwait
  s_branch L_p_loop
L_p_tail:
  s_sub_u32 s51, s33, 2
  s_and_b32 s6, s51, 3
  s_lshl_b32 s6, s6, 17
  s_add_u32 s47, s40, s6
  s_lshr_b32 s6, s51, 2
  s_andn2_b32 s50, 1, s6
  s_lshl_b32 s6, s51, 18
  s_add_u32 s48, s41, s6
  s_add_u32 s51, s51, 1
  buffer_load_dwordx4 v[116:119], v0, s[8:11], s47 offen sc1
  s_waitcnt vmcnt(0) lgkmcnt(0)
  s_barrier
  s_branch L_p_att
L_p_first:
  s_waitcnt vmcnt(0) lgkmcnt(0)
  s_barrier
  s_mov_b32 s52, 0
  s_cmp_ge_u32 s32, 31
  s_cbranch_scc1 L_nx_95
  v_cmp_gt_u32 vcc, s49, v115
  s_cbranch_vccnz L_nx_95
  s_mov_b32 s52, 1
  s_sub_u32 s6, s49, 1
  s_lshl_b32 s6, s6, 15
  s_add_u32 s45, s38, s6
  s_mov_b32 m0, s53
  s_add_u32 s6, s45, 4096
  buffer_load_dwordx4 v0, s[8:11], s45 offen offset:0 lds
  buffer_load_dwordx4 v0, s[8:11], s45 offen offset:1024 lds
  buffer_load_dwordx4 v0, s[8:11], s45 offen offset:2048 lds
  buffer_load_dwordx4 v0, s[8:11], s45 offen offset:3072 lds
  s_add_u32 m0, s53, 4096
  s_nop 0
  buffer_load_dwordx4 v0, s[8:11], s6 offen offset:0 lds
  buffer_load_dwordx4 v0, s[8:11], s6 offen offset:1024 lds
  buffer_load_dwordx4 v0, s[8:11], s6 offen offset:2048 lds
  buffer_load_dwordx4 v0, s[8:11], s6 offen offset:3072 lds
L_nx_95:
  s_cmp_lg_u32 s35, 0
  s_cbranch_scc1 L_p_f2
  s_mov_b32 s51, 127
  s_mov_b32 s7, 0
L_pl_97:
  buffer_load_dwordx4 v[32:35], v0, s[8:11], s44 offen offset:0 sc1
  buffer_load_dwordx4 v[36:39], v0, s[8:11], s44 offen offset:1024 sc1
  s_waitcnt vmcnt(0)
  v_min3_u32 v32, v32, v33, v34
  v_min3_u32 v35, v35, v36, v37
  v_min3_u32 v32, v32, v38, v39
  v_min_u32 v32, v32, v35
  v_cmp_gt_u32 vcc, s51, v32
  s_cbranch_vccz L_plo_98
  s_add_u32 s7, s7, 1
  s_cmp_lt_u32 s7, 131072
  s_cbranch_scc1 L_pl_97
  s_mov_b32 s6, 24
  s_branch L_err
L_plo_98:
L_p_f2:
  s_waitcnt vmcnt(0)
  s_branch L_p_next
L_p_end:
  s_waitcnt vmcnt(0)
  s_endpgm
L_o:
  s_lshr_b32 s33, s5, 4
  s_bfe_u32 s34, s5, 0x20002
  s_and_b32 s35, s5, 3
  s_mul_i32 s36, s33, 0x1000000
  s_add_u32 s36, s36, 0x6800000
  s_lshl_b32 s6, s34, 3
  s_lshl_b32 s7, s3, 1
  s_add_u32 s6, s6, s7
  s_lshl_b32 s7, s6, 13
  s_add_u32 s36, s36, s7
  s_lshl_b32 s6, s6, 7
  s_lshl_b32 s7, s33, 13
  s_add_u32 s6, s6, s7
  s_add_u32 s38, s6, 0x718000
  s_mul_i32 s37, s33, 0x800000
  s_add_u32 s37, s37, 0x8800000
  s_lshl_b32 s6, s34, 15
  s_add_u32 s37, s37, s6
  s_lshl_b32 s6, s35, 13
  s_add_u32 s37, s37, s6
  s_lshl_b32 s6, s3, 11
  s_add_u32 s37, s37, s6
  s_lshl_b32 s6, s35, 6
  s_lshl_b32 s7, s3, 4
  s_add_u32 s6, s6, s7
  s_lshl_b32 s7, s33, 8
  s_add_u32 s6, s6, s7
  s_add_u32 s39, s6, 0x710800
  s_lshl_b32 s42, s3, 14
  s_branch L_pro
L_o2:
  v_lshlrev_b32 v0, 4, v0
  s_mov_b32 s16, s88
  s_mov_b32 s17, s89
  s_mov_b32 s18, 0x400000
  s_mov_b32 s19, 0x20000
  v_lshrrev_b32 v104, 4, v0
  v_lshrrev_b32 v100, 8, v0
  v_lshlrev_b32 v105, 2, v100
  v_and_b32 v104, 15, v104
  v_xor_b32 v104, v104, v105
  v_mul_u32_u24 v100, 1024, v100
  v_lshl_add_u32 v100, v104, 4, v100
  v_bfe_u32 v104, v0, 6, 2
  v_lshlrev_b32 v105, 2, v104
  v_bfe_u32 v106, v0, 8, 1
  v_lshlrev_b32 v106, 1, v106
  v_bfe_u32 v107, v0, 5, 1
  v_or_b32 v106, v106, v107
  s_lshl_b32 s6, s3, 2
  v_or_b32 v106, s6, v106
  v_xor_b32 v106, v106, v105
  v_lshlrev_b32 v106, 4, v106
  v_bfe_u32 v107, v0, 4, 1
  v_lshl_or_b32 v106, v107, 3, v106
  v_bfe_u32 v107, v0, 9, 1
  v_lshl_or_b32 v104, v107, 2, v104
  v_lshl_or_b32 v104, v104, 8, v106
  v_add_u32 v105, 0x10000, v104
  s_lshl_b32 s60, s3, 13
  s_mul_i32 s63, s3, 32768
  s_lshl_b32 s61, s34, 20
  s_lshl_b32 s62, s35, 8
  s_add_u32 s61, s61, s62
  s_add_u32 s61, s61, 0
  s_add_u32 s61, s61, s63
  s_add_u32 m0, s60, 0
  s_add_u32 s62, s61, 0
  buffer_load_dwordx4 v100, s[16:19], s62 offen lds
  s_add_u32 m0, s60, 1024
  s_add_u32 s62, s61, 4096
  buffer_load_dwordx4 v100, s[16:19], s62 offen lds
  s_add_u32 m0, s60, 2048
  s_add_u32 s62, s61, 8192
  buffer_load_dwordx4 v100, s[16:19], s62 offen lds
  s_add_u32 m0, s60, 3072
  s_add_u32 s62, s61, 12288
  buffer_load_dwordx4 v100, s[16:19], s62 offen lds
  s_add_u32 m0, s60, 4096
  s_add_u32 s62, s61, 16384
  buffer_load_dwordx4 v100, s[16:19], s62 offen lds
  s_add_u32 m0, s60, 5120
  s_add_u32 s62, s61, 20480
  buffer_load_dwordx4 v100, s[16:19], s62 offen lds
  s_add_u32 m0, s60, 6144
  s_add_u32 s62, s61, 24576
  buffer_load_dwordx4 v100, s[16:19], s62 offen lds
  s_add_u32 m0, s60, 7168
  s_add_u32 s62, s61, 28672
  buffer_load_dwordx4 v100, s[16:19], s62 offen lds
  s_lshl_b32 s61, s34, 20
  s_lshl_b32 s62, s35, 8
  s_add_u32 s61, s61, s62
  s_add_u32 s61, s61, 131072
  s_add_u32 s61, s61, s63
  s_add_u32 m0, s60, 32768
  s_add_u32 s62, s61, 0
  buffer_load_dwordx4 v100, s[16:19], s62 offen lds
  s_add_u32 m0, s60, 33792
  s_add_u32 s62, s61, 4096
  buffer_load_dwordx4 v100, s[16:19], s62 offen lds
  s_add_u32 m0, s60, 34816
  s_add_u32 s62, s61, 8192
  buffer_load_dwordx4 v100, s[16:19], s62 offen lds
  s_add_u32 m0, s60, 35840
  s_add_u32 s62, s61, 12288
  buffer_load_dwordx4 v100, s[16:19], s62 offen lds
  s_add_u32 m0, s60, 36864
  s_add_u32 s62, s61, 16384
  buffer_load_dwordx4 v100, s[16:19], s62 offen lds
  s_add_u32 m0, s60, 37888
  s_add_u32 s62, s61, 20480
  buffer_load_dwordx4 v100, s[16:19], s62 offen lds
  s_add_u32 m0, s60, 38912
  s_add_u32 s62, s61, 24576
  buffer_load_dwordx4 v100, s[16:19], s62 offen lds
  s_add_u32 m0, s60, 39936
  s_add_u32 s62, s61, 28672
  buffer_load_dwordx4 v100, s[16:19], s62 offen lds
  s_lshl_b32 s61, s34, 20
  s_lshl_b32 s62, s35, 8
  s_add_u32 s61, s61, s62
  s_add_u32 s61, s61, 262144
  s_add_u32 s61, s61, s63
  s_add_u32 m0, s60, 65536
  s_add_u32 s62, s61, 0
  buffer_load_dwordx4 v100, s[16:19], s62 offen lds
  s_add_u32 m0, s60, 66560
  s_add_u32 s62, s61, 4096
  buffer_load_dwordx4 v100, s[16:19], s62 offen lds
  s_add_u32 m0, s60, 67584
  s_add_u32 s62, s61, 8192
  buffer_load_dwordx4 v100, s[16:19], s62 offen lds
  s_add_u32 m0, s60, 68608
  s_add_u32 s62, s61, 12288
  buffer_load_dwordx4 v100, s[16:19], s62 offen lds
  s_add_u32 m0, s60, 69632
  s_add_u32 s62, s61, 16384
  buffer_load_dwordx4 v100, s[16:19], s62 offen lds
  s_add_u32 m0, s60, 70656
  s_add_u32 s62, s61, 20480
  buffer_load_dwordx4 v100, s[16:19], s62 offen lds
  s_add_u32 m0, s60, 71680
  s_add_u32 s62, s61, 24576
  buffer_load_dwordx4 v100, s[16:19], s62 offen lds
  s_add_u32 m0, s60, 72704
  s_add_u32 s62, s61, 28672
  buffer_load_dwordx4 v100, s[16:19], s62 offen lds
  s_waitcnt vmcnt(16)
  s_barrier
  s_lshl_b32 s61, s34, 20
  s_lshl_b32 s62, s35, 8
  s_add_u32 s61, s61, s62
  s_add_u32 s61, s61, 393216
  s_add_u32 s61, s61, s63
  s_add_u32 m0, s60, 98304
  s_add_u32 s62, s61, 0
  buffer_load_dwordx4 v100, s[16:19], s62 offen lds
  s_add_u32 m0, s60, 99328
  s_add_u32 s62, s61, 4096
  buffer_load_dwordx4 v100, s[16:19], s62 offen lds
  s_add_u32 m0, s60, 100352
  s_add_u32 s62, s61, 8192
  buffer_load_dwordx4 v100, s[16:19], s62 offen lds
  s_add_u32 m0, s60, 101376
  s_add_u32 s62, s61, 12288
  buffer_load_dwordx4 v100, s[16:19], s62 offen lds
  s_add_u32 m0, s60, 102400
  s_add_u32 s62, s61, 16384
  buffer_load_dwordx4 v100, s[16:19], s62 offen lds
  s_add_u32 m0, s60, 103424
  s_add_u32 s62, s61, 20480
  buffer_load_dwordx4 v100, s[16:19], s62 offen lds
  s_add_u32 m0, s60, 104448
  s_add_u32 s62, s61, 24576
  buffer_load_dwordx4 v100, s[16:19], s62 offen lds
  s_add_u32 m0, s60, 105472
  s_add_u32 s62, s61, 28672
  buffer_load_dwordx4 v100, s[16:19], s62 offen lds
  ds_read_b64_tr_b16 a[0:1], v104 offset:0
  ds_read_b64_tr_b16 a[2:3], v104 offset:4096
  ds_read_b64_tr_b16 a[4:5], v104 offset:2048
  ds_read_b64_tr_b16 a[6:7], v104 offset:6144
  ds_read_b64_tr_b16 a[8:9], v104 offset:8192
  ds_read_b64_tr_b16 a[10:11], v104 offset:12288
  ds_read_b64_tr_b16 a[12:13], v104 offset:10240
  ds_read_b64_tr_b16 a[14:15], v104 offset:14336
  ds_read_b64_tr_b16 a[16:17], v104 offset:16384
  ds_read_b64_tr_b16 a[18:19], v104 offset:20480
  ds_read_b64_tr_b16 a[20:21], v104 offset:18432
  ds_read_b64_tr_b16 a[22:23], v104 offset:22528
  ds_read_b64_tr_b16 a[24:25], v104 offset:24576
  ds_read_b64_tr_b16 a[26:27], v104 offset:28672
  ds_read_b64_tr_b16 a[28:29], v104 offset:26624
  ds_read_b64_tr_b16 a[30:31], v104 offset:30720
  s_waitcnt lgkmcnt(0)
  s_waitcnt vmcnt(16)
  s_barrier
  s_lshl_b32 s61, s34, 20
  s_lshl_b32 s62, s35, 8
  s_add_u32 s61, s61, s62
  s_add_u32 s61, s61, 524288
  s_add_u32 s61, s61, s63
  s_add_u32 m0, s60, 0
  s_add_u32 s62, s61, 0
  buffer_load_dwordx4 v100, s[16:19], s62 offen lds
  s_add_u32 m0, s60, 1024
  s_add_u32 s62, s61, 4096
  buffer_load_dwordx4 v100, s[16:19], s62 offen lds
  s_add_u32 m0, s60, 2048
  s_add_u32 s62, s61, 8192
  buffer_load_dwordx4 v100, s[16:19], s62 offen lds
  s_add_u32 m0, s60, 3072
  s_add_u32 s62, s61, 12288
  buffer_load_dwordx4 v100, s[16:19], s62 offen lds
  s_add_u32 m0, s60, 4096
  s_add_u32 s62, s61, 16384
  buffer_load_dwordx4 v100, s[16:19], s62 offen lds
  s_add_u32 m0, s60, 5120
  s_add_u32 s62, s61, 20480
  buffer_load_dwordx4 v100, s[16:19], s62 offen lds
  s_add_u32 m0, s60, 6144
  s_add_u32 s62, s61, 24576
  buffer_load_dwordx4 v100, s[16:19], s62 offen lds
  s_add_u32 m0, s60, 7168
  s_add_u32 s62, s61, 28672
  buffer_load_dwordx4 v100, s[16:19], s62 offen lds
  ds_read_b64_tr_b16 a[32:33], v104 offset:32768
  ds_read_b64_tr_b16 a[34:35], v104 offset:36864
  ds_read_b64_tr_b16 a[36:37], v104 offset:34816
  ds_read_b64_tr_b16 a[38:39], v104 offset:38912
  ds_read_b64_tr_b16 a[40:41], v104 offset:40960
  ds_read_b64_tr_b16 a[42:43], v104 offset:45056
  ds_read_b64_tr_b16 a[44:45], v104 offset:43008
  ds_read_b64_tr_b16 a[46:47], v104 offset:47104
  ds_read_b64_tr_b16 a[48:49], v104 offset:49152
  ds_read_b64_tr_b16 a[50:51], v104 offset:53248
  ds_read_b64_tr_b16 a[52:53], v104 offset:51200
  ds_read_b64_tr_b16 a[54:55], v104 offset:55296
  ds_read_b64_tr_b16 a[56:57], v104 offset:57344
  ds_read_b64_tr_b16 a[58:59], v104 offset:61440
  ds_read_b64_tr_b16 a[60:61], v104 offset:59392
  ds_read_b64_tr_b16 a[62:63], v104 offset:63488
  s_waitcnt lgkmcnt(0)
  s_waitcnt vmcnt(16)
  s_barrier
  s_lshl_b32 s61, s34, 20
  s_lshl_b32 s62, s35, 8
  s_add_u32 s61, s61, s62
  s_add_u32 s61, s61, 655360
  s_add_u32 s61, s61, s63
  s_add_u32 m0, s60, 32768
  s_add_u32 s62, s61, 0
  buffer_load_dwordx4 v100, s[16:19], s62 offen lds
  s_add_u32 m0, s60, 33792
  s_add_u32 s62, s61, 4096
  buffer_load_dwordx4 v100, s[16:19], s62 offen lds
  s_add_u32 m0, s60, 34816
  s_add_u32 s62, s61, 8192
  buffer_load_dwordx4 v100, s[16:19], s62 offen lds
  s_add_u32 m0, s60, 35840
  s_add_u32 s62, s61, 12288
  buffer_load_dwordx4 v100, s[16:19], s62 offen lds
  s_add_u32 m0, s60, 36864
  s_add_u32 s62, s61, 16384
  buffer_load_dwordx4 v100, s[16:19], s62 offen lds
  s_add_u32 m0, s60, 37888
  s_add_u32 s62, s61, 20480
  buffer_load_dwordx4 v100, s[16:19], s62 offen lds
  s_add_u32 m0, s60, 38912
  s_add_u32 s62, s61, 24576
  buffer_load_dwordx4 v100, s[16:19], s62 offen lds
  s_add_u32 m0, s60, 39936
  s_add_u32 s62, s61, 28672
  buffer_load_dwordx4 v100, s[16:19], s62 offen lds
  ds_read_b64_tr_b16 a[64:65], v105 offset:0
  ds_read_b64_tr_b16 a[66:67], v105 offset:4096
  ds_read_b64_tr_b16 a[68:69], v105 offset:2048
  ds_read_b64_tr_b16 a[70:71], v105 offset:6144
  ds_read_b64_tr_b16 a[72:73], v105 offset:8192
  ds_read_b64_tr_b16 a[74:75], v105 offset:12288
  ds_read_b64_tr_b16 a[76:77], v105 offset:10240
  ds_read_b64_tr_b16 a[78:79], v105 offset:14336
  ds_read_b64_tr_b16 a[80:81], v105 offset:16384
  ds_read_b64_tr_b16 a[82:83], v105 offset:20480
  ds_read_b64_tr_b16 a[84:85], v105 offset:18432
  ds_read_b64_tr_b16 a[86:87], v105 offset:22528
  ds_read_b64_tr_b16 a[88:89], v105 offset:24576
  ds_read_b64_tr_b16 a[90:91], v105 offset:28672
  ds_read_b64_tr_b16 a[92:93], v105 offset:26624
  ds_read_b64_tr_b16 a[94:95], v105 offset:30720
  s_waitcnt lgkmcnt(0)
  s_waitcnt vmcnt(16)
  s_barrier
  s_lshl_b32 s61, s34, 20
  s_lshl_b32 s62, s35, 8
  s_add_u32 s61, s61, s62
  s_add_u32 s61, s61, 786432
  s_add_u32 s61, s61, s63
  s_add_u32 m0, s60, 65536
  s_add_u32 s62, s61, 0
  buffer_load_dwordx4 v100, s[16:19], s62 offen lds
  s_add_u32 m0, s60, 66560
  s_add_u32 s62, s61, 4096
  buffer_load_dwordx4 v100, s[16:19], s62 offen lds
  s_add_u32 m0, s60, 67584
  s_add_u32 s62, s61, 8192
  buffer_load_dwordx4 v100, s[16:19], s62 offen lds
  s_add_u32 m0, s60, 68608
  s_add_u32 s62, s61, 12288
  buffer_load_dwordx4 v100, s[16:19], s62 offen lds
  s_add_u32 m0, s60, 69632
  s_add_u32 s62, s61, 16384
  buffer_load_dwordx4 v100, s[16:19], s62 offen lds
  s_add_u32 m0, s60, 70656
  s_add_u32 s62, s61, 20480
  buffer_load_dwordx4 v100, s[16:19], s62 offen lds
  s_add_u32 m0, s60, 71680
  s_add_u32 s62, s61, 24576
  buffer_load_dwordx4 v100, s[16:19], s62 offen lds
  s_add_u32 m0, s60, 72704
  s_add_u32 s62, s61, 28672
  buffer_load_dwordx4 v100, s[16:19], s62 offen lds
  ds_read_b64_tr_b16 a[96:97], v105 offset:32768
  ds_read_b64_tr_b16 a[98:99], v105 offset:36864
  ds_read_b64_tr_b16 a[100:101], v105 offset:34816
  ds_read_b64_tr_b16 a[102:103], v105 offset:38912
  ds_read_b64_tr_b16 a[104:105], v105 offset:40960
  ds_read_b64_tr_b16 a[106:107], v105 offset:45056
  ds_read_b64_tr_b16 a[108:109], v105 offset:43008
  ds_read_b64_tr_b16 a[110:111], v105 offset:47104
  ds_read_b64_tr_b16 a[112:113], v105 offset:49152
  ds_read_b64_tr_b16 a[114:115], v105 offset:53248
  ds_read_b64_tr_b16 a[116:117], v105 offset:51200
  ds_read_b64_tr_b16 a[118:119], v105 offset:55296
  ds_read_b64_tr_b16 a[120:121], v105 offset:57344
  ds_read_b64_tr_b16 a[122:123], v105 offset:61440
  ds_read_b64_tr_b16 a[124:125], v105 offset:59392
  ds_read_b64_tr_b16 a[126:127], v105 offset:63488
  s_waitcnt lgkmcnt(0)
  s_waitcnt vmcnt(16)
  s_barrier
  s_lshl_b32 s61, s34, 20
  s_lshl_b32 s62, s35, 8
  s_add_u32 s61, s61, s62
  s_add_u32 s61, s61, 917504
  s_add_u32 s61, s61, s63
  s_add_u32 m0, s60, 98304
  s_add_u32 s62, s61, 0
  buffer_load_dwordx4 v100, s[16:19], s62 offen lds
  s_add_u32 m0, s60, 99328
  s_add_u32 s62, s61, 4096
  buffer_load_dwordx4 v100, s[16:19], s62 offen lds
  s_add_u32 m0, s60, 100352
  s_add_u32 s62, s61, 8192
  buffer_load_dwordx4 v100, s[16:19], s62 offen lds
  s_add_u32 m0, s60, 101376
  s_add_u32 s62, s61, 12288
  buffer_load_dwordx4 v100, s[16:19], s62 offen lds
  s_add_u32 m0, s60, 102400
  s_add_u32 s62, s61, 16384
  buffer_load_dwordx4 v100, s[16:19], s62 offen lds
  s_add_u32 m0, s60, 103424
  s_add_u32 s62, s61, 20480
  buffer_load_dwordx4 v100, s[16:19], s62 offen lds
  s_add_u32 m0, s60, 104448
  s_add_u32 s62, s61, 24576
  buffer_load_dwordx4 v100, s[16:19], s62 offen lds
  s_add_u32 m0, s60, 105472
  s_add_u32 s62, s61, 28672
  buffer_load_dwordx4 v100, s[16:19], s62 offen lds
  ds_read_b64_tr_b16 a[128:129], v104 offset:0
  ds_read_b64_tr_b16 a[130:131], v104 offset:4096
  ds_read_b64_tr_b16 a[132:133], v104 offset:2048
  ds_read_b64_tr_b16 a[134:135], v104 offset:6144
  ds_read_b64_tr_b16 a[136:137], v104 offset:8192
  ds_read_b64_tr_b16 a[138:139], v104 offset:12288
  ds_read_b64_tr_b16 a[140:141], v104 offset:10240
  ds_read_b64_tr_b16 a[142:143], v104 offset:14336
  ds_read_b64_tr_b16 a[144:145], v104 offset:16384
  ds_read_b64_tr_b16 a[146:147], v104 offset:20480
  ds_read_b64_tr_b16 a[148:149], v104 offset:18432
  ds_read_b64_tr_b16 a[150:151], v104 offset:22528
  ds_read_b64_tr_b16 a[152:153], v104 offset:24576
  ds_read_b64_tr_b16 a[154:155], v104 offset:28672
  ds_read_b64_tr_b16 a[156:157], v104 offset:26624
  ds_read_b64_tr_b16 a[158:159], v104 offset:30720
  s_waitcnt lgkmcnt(0)
  s_waitcnt vmcnt(16)
  s_barrier
  ds_read_b64_tr_b16 a[160:161], v104 offset:32768
  ds_read_b64_tr_b16 a[162:163], v104 offset:36864
  ds_read_b64_tr_b16 a[164:165], v104 offset:34816
  ds_read_b64_tr_b16 a[166:167], v104 offset:38912
  ds_read_b64_tr_b16 a[168:169], v104 offset:40960
  ds_read_b64_tr_b16 a[170:171], v104 offset:45056
  ds_read_b64_tr_b16 a[172:173], v104 offset:43008
  ds_read_b64_tr_b16 a[174:175], v104 offset:47104
  ds_read_b64_tr_b16 a[176:177], v104 offset:49152
  ds_read_b64_tr_b16 a[178:179], v104 offset:53248
  ds_read_b64_tr_b16 a[180:181], v104 offset:51200
  ds_read_b64_tr_b16 a[182:183], v104 offset:55296
  ds_read_b64_tr_b16 a[184:185], v104 offset:57344
  ds_read_b64_tr_b16 a[186:187], v104 offset:61440
  ds_read_b64_tr_b16 a[188:189], v104 offset:59392
  ds_read_b64_tr_b16 a[190:191], v104 offset:63488
  s_waitcnt lgkmcnt(0)
  s_waitcnt vmcnt(8)
  s_barrier
  ds_read_b64_tr_b16 a[192:193], v105 offset:0
  ds_read_b64_tr_b16 a[194:195], v105 offset:4096
  ds_read_b64_tr_b16 a[196:197], v105 offset:2048
  ds_read_b64_tr_b16 a[198:199], v105 offset:6144
  ds_read_b64_tr_b16 a[200:201], v105 offset:8192
  ds_read_b64_tr_b16 a[202:203], v105 offset:12288
  ds_read_b64_tr_b16 a[204:205], v105 offset:10240
  ds_read_b64_tr_b16 a[206:207], v105 offset:14336
  ds_read_b64_tr_b16 a[208:209], v105 offset:16384
  ds_read_b64_tr_b16 a[210:211], v105 offset:20480
  ds_read_b64_tr_b16 a[212:213], v105 offset:18432
  ds_read_b64_tr_b16 a[214:215], v105 offset:22528
  ds_read_b64_tr_b16 a[216:217], v105 offset:24576
  ds_read_b64_tr_b16 a[218:219], v105 offset:28672
  ds_read_b64_tr_b16 a[220:221], v105 offset:26624
  ds_read_b64_tr_b16 a[222:223], v105 offset:30720
  s_waitcnt lgkmcnt(0)
  s_waitcnt vmcnt(0)
  s_barrier
  ds_read_b64_tr_b16 a[224:225], v105 offset:32768
  ds_read_b64_tr_b16 a[226:227], v105 offset:36864
  ds_read_b64_tr_b16 a[228:229], v105 offset:34816
  ds_read_b64_tr_b16 a[230:231], v105 offset:38912
  ds_read_b64_tr_b16 a[232:233], v105 offset:40960
  ds_read_b64_tr_b16 a[234:235], v105 offset:45056
  ds_read_b64_tr_b16 a[236:237], v105 offset:43008
  ds_read_b64_tr_b16 a[238:239], v105 offset:47104
  ds_read_b64_tr_b16 a[240:241], v105 offset:49152
  ds_read_b64_tr_b16 a[242:243], v105 offset:53248
  ds_read_b64_tr_b16 a[244:245], v105 offset:51200
  ds_read_b64_tr_b16 a[246:247], v105 offset:55296
  ds_read_b64_tr_b16 a[248:249], v105 offset:57344
  ds_read_b64_tr_b16 a[250:251], v105 offset:61440
  ds_read_b64_tr_b16 a[252:253], v105 offset:59392
  ds_read_b64_tr_b16 a[254:255], v105 offset:63488
  s_waitcnt lgkmcnt(0)
  s_barrier
  v_mov_b32 v3, 0
  v_mov_b32 v1, v0
  v_bfe_u32 v2, v0, 6, 1
  v_lshlrev_b32 v2, 7, v2
  v_bfe_u32 v4, v0, 2, 4
  v_or_b32 v2, v2, v4
  v_bfe_u32 v6, v0, 2, 4
  v_and_b32 v6, 12, v6
  s_mov_b32 s7, 0
  v_mbcnt_lo_u32_b32 v16, -1, 0
  v_and_b32 v16, 3, v16
  v_lshlrev_b32 v16, 6, v16
L_wd_99:
  buffer_load_dword v17, v16, s[12:15], 0 offen offset:16 sc1
  s_waitcnt vmcnt(0)
  v_cmp_ne_u32 vcc, 64, v17
  s_cbranch_vccz L_wdo_100
  s_add_u32 s7, s7, 1
  s_cmp_lt_u32 s7, 131072
  s_cbranch_scc1 L_wd_99
  s_mov_b32 s6, 30
  s_branch L_err
L_wdo_100:
  s_mov_b32 s32, 0
  s_mov_b32 s41, 1
  s_mov_b32 s40, s38
L_o_wait:
  s_mov_b32 s7, 0
L_pl_101:
  buffer_load_dword v4, v2, s[8:11], s40 offen offset:0 sc1
  s_waitcnt vmcnt(0)
  v_cmp_gt_u32 vcc, s41, v4
  s_cbranch_vccz L_plo_102
  s_add_u32 s7, s7, 1
  s_cmp_lt_u32 s7, 131072
  s_cbranch_scc1 L_pl_101
  s_mov_b32 s6, 31
  s_branch L_err
L_plo_102:
L_o_go:
  s_sub_u32 s6, s41, 1
  s_lshl_b32 s6, s6, 18
  s_add_u32 s44, s36, s6
  s_add_u32 m0, s42, 0
  s_add_u32 s45, s44, 0
  buffer_load_dwordx4 v0, s[8:11], s45 offen offset:0 lds
  buffer_load_dwordx4 v0, s[8:11], s45 offen offset:1024 lds
  buffer_load_dwordx4 v0, s[8:11], s45 offen offset:2048 lds
  buffer_load_dwordx4 v0, s[8:11], s45 offen offset:3072 lds
  s_add_u32 m0, s42, 4096
  s_add_u32 s45, s44, 4096
  buffer_load_dwordx4 v0, s[8:11], s45 offen offset:0 lds
  buffer_load_dwordx4 v0, s[8:11], s45 offen offset:1024 lds
  buffer_load_dwordx4 v0, s[8:11], s45 offen offset:2048 lds
  buffer_load_dwordx4 v0, s[8:11], s45 offen offset:3072 lds
  s_add_u32 m0, s42, 8192
  s_add_u32 s45, s44, 8192
  buffer_load_dwordx4 v0, s[8:11], s45 offen offset:0 lds
  buffer_load_dwordx4 v0, s[8:11], s45 offen offset:1024 lds
  buffer_load_dwordx4 v0, s[8:11], s45 offen offset:2048 lds
  buffer_load_dwordx4 v0, s[8:11], s45 offen offset:3072 lds
  s_add_u32 m0, s42, 12288
  s_add_u32 s45, s44, 12288
  buffer_load_dwordx4 v0, s[8:11], s45 offen offset:0 lds
  buffer_load_dwordx4 v0, s[8:11], s45 offen offset:1024 lds
  buffer_load_dwordx4 v0, s[8:11], s45 offen offset:2048 lds
  buffer_load_dwordx4 v0, s[8:11], s45 offen offset:3072 lds
  s_xor_b32 s42, s42, 0x10000
  s_mov_b32 s43, 0
  s_waitcnt vmcnt(8)
L_o_loop:
  s_barrier
  ds_read_b128 v[32:35], v1 offset:0
  ds_read_b128 v[36:39], v1 offset:1024
  ds_read_b128 v[40:43], v1 offset:2048
  s_add_u32 s41, s32, 2
  s_xor_b32 s40, s40, 0x1000
  buffer_load_dword v4, v2, s[8:11], s40 offen sc1
  buffer_load_dword v5, v6, s[8:11], s39 offen sc1
  s_waitcnt lgkmcnt(2)
  v_mfma_f32_32x32x16_bf16 v[16:31], a[0:3], v[32:35], 0
  ds_read_b128 v[44:47], v1 offset:3072
  s_waitcnt lgkmcnt(2)
  v_mfma_f32_32x32x16_bf16 v[16:31], a[4:7], v[36:39], v[16:31]
  ds_read_b128 v[32:35], v1 offset:4096
  s_waitcnt lgkmcnt(2)
  v_mfma_f32_32x32x16_bf16 v[16:31], a[8:11], v[40:43], v[16:31]
  ds_read_b128 v[36:39], v1 offset:5120
  s_waitcnt lgkmcnt(2)
  v_mfma_f32_32x32x16_bf16 v[16:31], a[12:15], v[44:47], v[16:31]
  ds_read_b128 v[40:43], v1 offset:6144
  s_waitcnt lgkmcnt(2)
  v_mfma_f32_32x32x16_bf16 v[16:31], a[16:19], v[32:35], v[16:31]
  ds_read_b128 v[44:47], v1 offset:7168
  s_waitcnt lgkmcnt(2)
  v_mfma_f32_32x32x16_bf16 v[16:31], a[20:23], v[36:39], v[16:31]
  ds_read_b128 v[32:35], v1 offset:16384
  s_waitcnt lgkmcnt(2)
  v_mfma_f32_32x32x16_bf16 v[16:31], a[24:27], v[40:43], v[16:31]
  ds_read_b128 v[36:39], v1 offset:17408
  s_waitcnt lgkmcnt(2)
  v_mfma_f32_32x32x16_bf16 v[16:31], a[28:31], v[44:47], v[16:31]
  ds_read_b128 v[40:43], v1 offset:18432
  s_waitcnt lgkmcnt(2)
  v_mfma_f32_32x32x16_bf16 v[16:31], a[64:67], v[32:35], v[16:31]
  ds_read_b128 v[44:47], v1 offset:19456
  s_waitcnt lgkmcnt(2)
  v_mfma_f32_32x32x16_bf16 v[16:31], a[68:71], v[36:39], v[16:31]
  ds_read_b128 v[32:35], v1 offset:20480
  s_waitcnt lgkmcnt(2)
  v_mfma_f32_32x32x16_bf16 v[16:31], a[72:75], v[40:43], v[16:31]
  ds_read_b128 v[36:39], v1 offset:21504
  s_waitcnt lgkmcnt(2)
  v_mfma_f32_32x32x16_bf16 v[16:31], a[76:79], v[44:47], v[16:31]
  ds_read_b128 v[40:43], v1 offset:22528
  s_waitcnt lgkmcnt(2)
  v_mfma_f32_32x32x16_bf16 v[16:31], a[80:83], v[32:35], v[16:31]
  ds_read_b128 v[44:47], v1 offset:23552
  s_waitcnt lgkmcnt(2)
  v_mfma_f32_32x32x16_bf16 v[16:31], a[84:87], v[36:39], v[16:31]
  ds_read_b128 v[32:35], v1 offset:32768
  s_waitcnt lgkmcnt(2)
  v_mfma_f32_32x32x16_bf16 v[16:31], a[88:91], v[40:43], v[16:31]
  ds_read_b128 v[36:39], v1 offset:33792
  s_waitcnt lgkmcnt(2)
  v_mfma_f32_32x32x16_bf16 v[16:31], a[92:95], v[44:47], v[16:31]
  ds_read_b128 v[40:43], v1 offset:34816
  s_waitcnt lgkmcnt(2)
  v_mfma_f32_32x32x16_bf16 v[16:31], a[128:131], v[32:35], v[16:31]
  ds_read_b128 v[44:47], v1 offset:35840
  s_waitcnt lgkmcnt(2)
  v_mfma_f32_32x32x16_bf16 v[16:31], a[132:135], v[36:39], v[16:31]
  ds_read_b128 v[32:35], v1 offset:36864
  s_waitcnt lgkmcnt(2)
  v_mfma_f32_32x32x16_bf16 v[16:31], a[136:139], v[40:43], v[16:31]
  ds_read_b128 v[36:39], v1 offset:37888
  s_waitcnt lgkmcnt(2)
  v_mfma_f32_32x32x16_bf16 v[16:31], a[140:143], v[44:47], v[16:31]
  ds_read_b128 v[40:43], v1 offset:38912
  s_waitcnt lgkmcnt(2)
  v_mfma_f32_32x32x16_bf16 v[16:31], a[144:147], v[32:35], v[16:31]
  ds_read_b128 v[44:47], v1 offset:39936
  s_waitcnt lgkmcnt(2)
  v_mfma_f32_32x32x16_bf16 v[16:31], a[148:151], v[36:39], v[16:31]
  ds_read_b128 v[32:35], v1 offset:49152
  s_waitcnt lgkmcnt(2)
  v_mfma_f32_32x32x16_bf16 v[16:31], a[152:155], v[40:43], v[16:31]
  ds_read_b128 v[36:39], v1 offset:50176
  s_waitcnt lgkmcnt(2)
  v_mfma_f32_32x32x16_bf16 v[16:31], a[156:159], v[44:47], v[16:31]
  ds_read_b128 v[40:43], v1 offset:51200
  s_waitcnt lgkmcnt(2)
  v_mfma_f32_32x32x16_bf16 v[16:31], a[192:195], v[32:35], v[16:31]
  ds_read_b128 v[44:47], v1 offset:52224
  s_waitcnt lgkmcnt(2)
  v_mfma_f32_32x32x16_bf16 v[16:31], a[196:199], v[36:39], v[16:31]
  ds_read_b128 v[32:35], v1 offset:53248
  s_waitcnt lgkmcnt(2)
  v_mfma_f32_32x32x16_bf16 v[16:31], a[200:203], v[40:43], v[16:31]
  ds_read_b128 v[36:39], v1 offset:54272
  s_waitcnt lgkmcnt(2)
  v_mfma_f32_32x32x16_bf16 v[16:31], a[204:207], v[44:47], v[16:31]
  ds_read_b128 v[40:43], v1 offset:55296
  s_waitcnt lgkmcnt(2)
  v_mfma_f32_32x32x16_bf16 v[16:31], a[208:211], v[32:35], v[16:31]
  ds_read_b128 v[44:47], v1 offset:56320
  s_waitcnt lgkmcnt(2)
  v_mfma_f32_32x32x16_bf16 v[16:31], a[212:215], v[36:39], v[16:31]
  s_waitcnt lgkmcnt(1)
  v_mfma_f32_32x32x16_bf16 v[16:31], a[216:219], v[40:43], v[16:31]
  s_waitcnt lgkmcnt(0)
  v_mfma_f32_32x32x16_bf16 v[16:31], a[220:223], v[44:47], v[16:31]
  s_waitcnt vmcnt(0)
  s_barrier
  ds_read_b128 v[32:35], v1 offset:8192
  ds_read_b128 v[36:39], v1 offset:9216
  ds_read_b128 v[40:43], v1 offset:10240
  s_mov_b32 s43, 0
  s_cmp_eq_u32 s32, 63
  s_cbranch_scc1 L_on_103
  v_cmp_gt_u32 vcc, s41, v4
  s_cbranch_vccnz L_on_103
  s_mov_b32 s43, 1
  s_waitcnt lgkmcnt(2)
  v_mfma_f32_32x32x16_bf16 v[16:31], a[32:35], v[32:35], v[16:31]
  ds_read_b128 v[44:47], v1 offset:11264
  s_sub_u32 s6, s41, 1
  s_lshl_b32 s6, s6, 18
  s_add_u32 s44, s36, s6
  s_waitcnt lgkmcnt(2)
  v_mfma_f32_32x32x16_bf16 v[16:31], a[36:39], v[36:39], v[16:31]
  ds_read_b128 v[32:35], v1 offset:12288
  s_add_u32 m0, s42, 0
  s_add_u32 s45, s44, 0
  buffer_load_dwordx4 v0, s[8:11], s45 offen offset:0 lds
  s_waitcnt lgkmcnt(2)
  v_mfma_f32_32x32x16_bf16 v[16:31], a[40:43], v[40:43], v[16:31]
  ds_read_b128 v[36:39], v1 offset:13312
  buffer_load_dwordx4 v0, s[8:11], s45 offen offset:1024 lds
  s_waitcnt lgkmcnt(2)
  v_mfma_f32_32x32x16_bf16 v[16:31], a[44:47], v[44:47], v[16:31]
  ds_read_b128 v[40:43], v1 offset:14336
  buffer_load_dwordx4 v0, s[8:11], s45 offen offset:2048 lds
  s_waitcnt lgkmcnt(2)
  v_mfma_f32_32x32x16_bf16 v[16:31], a[48:51], v[32:35], v[16:31]
  ds_read_b128 v[44:47], v1 offset:15360
  buffer_load_dwordx4 v0, s[8:11], s45 offen offset:3072 lds
  s_waitcnt lgkmcnt(2)
  v_mfma_f32_32x32x16_bf16 v[16:31], a[52:55], v[36:39], v[16:31]
  ds_read_b128 v[32:35], v1 offset:24576
  s_waitcnt lgkmcnt(2)
  v_mfma_f32_32x32x16_bf16 v[16:31], a[56:59], v[40:43], v[16:31]
  ds_read_b128 v[36:39], v1 offset:25600
  s_add_u32 m0, s42, 4096
  s_add_u32 s45, s44, 4096
  buffer_load_dwordx4 v0, s[8:11], s45 offen offset:0 lds
  s_waitcnt lgkmcnt(2)
  v_mfma_f32_32x32x16_bf16 v[16:31], a[60:63], v[44:47], v[16:31]
  ds_read_b128 v[40:43], v1 offset:26624
  s_waitcnt lgkmcnt(2)
  v_mfma_f32_32x32x16_bf16 v[16:31], a[96:99], v[32:35], v[16:31]
  ds_read_b128 v[44:47], v1 offset:27648
  buffer_load_dwordx4 v0, s[8:11], s45 offen offset:1024 lds
  s_waitcnt lgkmcnt(2)
  v_mfma_f32_32x32x16_bf16 v[16:31], a[100:103], v[36:39], v[16:31]
  ds_read_b128 v[32:35], v1 offset:28672
  s_waitcnt lgkmcnt(2)
  v_mfma_f32_32x32x16_bf16 v[16:31], a[104:107], v[40:43], v[16:31]
  ds_read_b128 v[36:39], v1 offset:29696
  buffer_load_dwordx4 v0, s[8:11], s45 offen offset:2048 lds
  s_waitcnt lgkmcnt(2)
  v_mfma_f32_32x32x16_bf16 v[16:31], a[108:111], v[44:47], v[16:31]
  ds_read_b128 v[40:43], v1 offset:30720
  s_waitcnt lgkmcnt(2)
  v_mfma_f32_32x32x16_bf16 v[16:31], a[112:115], v[32:35], v[16:31]
  ds_read_b128 v[44:47], v1 offset:31744
  buffer_load_dwordx4 v0, s[8:11], s45 offen offset:3072 lds
  s_waitcnt lgkmcnt(2)
  v_mfma_f32_32x32x16_bf16 v[16:31], a[116:119], v[36:39], v[16:31]
  ds_read_b128 v[32:35], v1 offset:40960
  s_waitcnt lgkmcnt(2)
  v_mfma_f32_32x32x16_bf16 v[16:31], a[120:123], v[40:43], v[16:31]
  ds_read_b128 v[36:39], v1 offset:41984
  s_add_u32 m0, s42, 8192
  s_add_u32 s45, s44, 8192
  buffer_load_dwordx4 v0, s[8:11], s45 offen offset:0 lds
  s_waitcnt lgkmcnt(2)
  v_mfma_f32_32x32x16_bf16 v[16:31], a[124:127], v[44:47], v[16:31]
  ds_read_b128 v[40:43], v1 offset:43008
  s_waitcnt lgkmcnt(2)
  v_mfma_f32_32x32x16_bf16 v[16:31], a[160:163], v[32:35], v[16:31]
  ds_read_b128 v[44:47], v1 offset:44032
  buffer_load_dwordx4 v0, s[8:11], s45 offen offset:1024 lds
  s_waitcnt lgkmcnt(2)
  v_mfma_f32_32x32x16_bf16 v[16:31], a[164:167], v[36:39], v[16:31]
  ds_read_b128 v[32:35], v1 offset:45056
  s_waitcnt lgkmcnt(2)
  v_mfma_f32_32x32x16_bf16 v[16:31], a[168:171], v[40:43], v[16:31]
  ds_read_b128 v[36:39], v1 offset:46080
  buffer_load_dwordx4 v0, s[8:11], s45 offen offset:2048 lds
  s_waitcnt lgkmcnt(2)
  v_mfma_f32_32x32x16_bf16 v[16:31], a[172:175], v[44:47], v[16:31]
  ds_read_b128 v[40:43], v1 offset:47104
  s_waitcnt lgkmcnt(2)
  v_mfma_f32_32x32x16_bf16 v[16:31], a[176:179], v[32:35], v[16:31]
  ds_read_b128 v[44:47], v1 offset:48128
  buffer_load_dwordx4 v0, s[8:11], s45 offen offset:3072 lds
  s_waitcnt lgkmcnt(2)
  v_mfma_f32_32x32x16_bf16 v[16:31], a[180:183], v[36:39], v[16:31]
  ds_read_b128 v[32:35], v1 offset:57344
  s_waitcnt lgkmcnt(2)
  v_mfma_f32_32x32x16_bf16 v[16:31], a[184:187], v[40:43], v[16:31]
  ds_read_b128 v[36:39], v1 offset:58368
  s_add_u32 m0, s42, 12288
  s_add_u32 s45, s44, 12288
  buffer_load_dwordx4 v0, s[8:11], s45 offen offset:0 lds
  s_waitcnt lgkmcnt(2)
  v_mfma_f32_32x32x16_bf16 v[16:31], a[188:191], v[44:47], v[16:31]
  ds_read_b128 v[40:43], v1 offset:59392
  s_waitcnt lgkmcnt(2)
  v_mfma_f32_32x32x16_bf16 v[16:31], a[224:227], v[32:35], v[16:31]
  ds_read_b128 v[44:47], v1 offset:60416
  buffer_load_dwordx4 v0, s[8:11], s45 offen offset:1024 lds
  s_waitcnt lgkmcnt(2)
  v_mfma_f32_32x32x16_bf16 v[16:31], a[228:231], v[36:39], v[16:31]
  ds_read_b128 v[32:35], v1 offset:61440
  s_waitcnt lgkmcnt(2)
  v_mfma_f32_32x32x16_bf16 v[16:31], a[232:235], v[40:43], v[16:31]
  ds_read_b128 v[36:39], v1 offset:62464
  buffer_load_dwordx4 v0, s[8:11], s45 offen offset:2048 lds
  s_waitcnt lgkmcnt(2)
  v_mfma_f32_32x32x16_bf16 v[16:31], a[236:239], v[44:47], v[16:31]
  ds_read_b128 v[40:43], v1 offset:63488
  s_waitcnt lgkmcnt(2)
  v_mfma_f32_32x32x16_bf16 v[16:31], a[240:243], v[32:35], v[16:31]
  ds_read_b128 v[44:47], v1 offset:64512
  buffer_load_dwordx4 v0, s[8:11], s45 offen offset:3072 lds
  s_waitcnt lgkmcnt(2)
  v_mfma_f32_32x32x16_bf16 v[16:31], a[244:247], v[36:39], v[16:31]
  s_waitcnt lgkmcnt(1)
  v_mfma_f32_32x32x16_bf16 v[16:31], a[248:251], v[40:43], v[16:31]
  s_xor_b32 s42, s42, 0x10000
  s_waitcnt lgkmcnt(0)
  v_mfma_f32_32x32x16_bf16 v[16:31], a[252:255], v[44:47], v[16:31]
  s_branch L_o_h2
L_on_103:
  s_waitcnt lgkmcnt(2)
  v_mfma_f32_32x32x16_bf16 v[16:31], a[32:35], v[32:35], v[16:31]
  ds_read_b128 v[44:47], v1 offset:11264
  s_waitcnt lgkmcnt(2)
  v_mfma_f32_32x32x16_bf16 v[16:31], a[36:39], v[36:39], v[16:31]
  ds_read_b128 v[32:35], v1 offset:12288
  s_waitcnt lgkmcnt(2)
  v_mfma_f32_32x32x16_bf16 v[16:31], a[40:43], v[40:43], v[16:31]
  ds_read_b128 v[36:39], v1 offset:13312
  s_waitcnt lgkmcnt(2)
  v_mfma_f32_32x32x16_bf16 v[16:31], a[44:47], v[44:47], v[16:31]
  ds_read_b128 v[40:43], v1 offset:14336
  s_waitcnt lgkmcnt(2)
  v_mfma_f32_32x32x16_bf16 v[16:31], a[48:51], v[32:35], v[16:31]
  ds_read_b128 v[44:47], v1 offset:15360
  buffer_load_dword v4, v2, s[8:11], s40 offen sc1
  s_waitcnt lgkmcnt(2)
  v_mfma_f32_32x32x16_bf16 v[16:31], a[52:55], v[36:39], v[16:31]
  ds_read_b128 v[32:35], v1 offset:24576
  s_waitcnt lgkmcnt(2)
  v_mfma_f32_32x32x16_bf16 v[16:31], a[56:59], v[40:43], v[16:31]
  ds_read_b128 v[36:39], v1 offset:25600
  s_waitcnt lgkmcnt(2)
  v_mfma_f32_32x32x16_bf16 v[16:31], a[60:63], v[44:47], v[16:31]
  ds_read_b128 v[40:43], v1 offset:26624
  s_waitcnt lgkmcnt(2)
  v_mfma_f32_32x32x16_bf16 v[16:31], a[96:99], v[32:35], v[16:31]
  ds_read_b128 v[44:47], v1 offset:27648
  s_waitcnt lgkmcnt(2)
  v_mfma_f32_32x32x16_bf16 v[16:31], a[100:103], v[36:39], v[16:31]
  ds_read_b128 v[32:35], v1 offset:28672
  s_waitcnt lgkmcnt(2)
  v_mfma_f32_32x32x16_bf16 v[16:31], a[104:107], v[40:43], v[16:31]
  ds_read_b128 v[36:39], v1 offset:29696
  s_waitcnt lgkmcnt(2)
  v_mfma_f32_32x32x16_bf16 v[16:31], a[108:111], v[44:47], v[16:31]
  ds_read_b128 v[40:43], v1 offset:30720
  s_waitcnt lgkmcnt(2)
  v_mfma_f32_32x32x16_bf16 v[16:31], a[112:115], v[32:35], v[16:31]
  ds_read_b128 v[44:47], v1 offset:31744
  s_waitcnt lgkmcnt(2)
  v_mfma_f32_32x32x16_bf16 v[16:31], a[116:119], v[36:39], v[16:31]
  ds_read_b128 v[32:35], v1 offset:40960
  s_waitcnt lgkmcnt(2)
  v_mfma_f32_32x32x16_bf16 v[16:31], a[120:123], v[40:43], v[16:31]
  ds_read_b128 v[36:39], v1 offset:41984
  s_waitcnt lgkmcnt(2)
  v_mfma_f32_32x32x16_bf16 v[16:31], a[124:127], v[44:47], v[16:31]
  ds_read_b128 v[40:43], v1 offset:43008
  s_waitcnt lgkmcnt(2)
  v_mfma_f32_32x32x16_bf16 v[16:31], a[160:163], v[32:35], v[16:31]
  ds_read_b128 v[44:47], v1 offset:44032
  s_waitcnt lgkmcnt(2)
  v_mfma_f32_32x32x16_bf16 v[16:31], a[164:167], v[36:39], v[16:31]
  ds_read_b128 v[32:35], v1 offset:45056
  s_waitcnt lgkmcnt(2)
  v_mfma_f32_32x32x16_bf16 v[16:31], a[168:171], v[40:43], v[16:31]
  ds_read_b128 v[36:39], v1 offset:46080
  s_waitcnt lgkmcnt(2)
  v_mfma_f32_32x32x16_bf16 v[16:31], a[172:175], v[44:47], v[16:31]
  ds_read_b128 v[40:43], v1 offset:47104
  s_waitcnt lgkmcnt(2)
  v_mfma_f32_32x32x16_bf16 v[16:31], a[176:179], v[32:35], v[16:31]
  ds_read_b128 v[44:47], v1 offset:48128
  s_waitcnt lgkmcnt(2)
  v_mfma_f32_32x32x16_bf16 v[16:31], a[180:183], v[36:39], v[16:31]
  ds_read_b128 v[32:35], v1 offset:57344
  s_waitcnt lgkmcnt(2)
  v_mfma_f32_32x32x16_bf16 v[16:31], a[184:187], v[40:43], v[16:31]
  ds_read_b128 v[36:39], v1 offset:58368
  s_waitcnt lgkmcnt(2)
  v_mfma_f32_32x32x16_bf16 v[16:31], a[188:191], v[44:47], v[16:31]
  ds_read_b128 v[40:43], v1 offset:59392
  s_waitcnt lgkmcnt(2)
  v_mfma_f32_32x32x16_bf16 v[16:31], a[224:227], v[32:35], v[16:31]
  ds_read_b128 v[44:47], v1 offset:60416
  s_waitcnt lgkmcnt(2)
  v_mfma_f32_32x32x16_bf16 v[16:31], a[228:231], v[36:39], v[16:31]
  ds_read_b128 v[32:35], v1 offset:61440
  s_waitcnt lgkmcnt(2)
  v_mfma_f32_32x32x16_bf16 v[16:31], a[232:235], v[40:43], v[16:31]
  ds_read_b128 v[36:39], v1 offset:62464
  s_waitcnt lgkmcnt(2)
  v_mfma_f32_32x32x16_bf16 v[16:31], a[236:239], v[44:47], v[16:31]
  ds_read_b128 v[40:43], v1 offset:63488
  s_waitcnt lgkmcnt(2)
  v_mfma_f32_32x32x16_bf16 v[16:31], a[240:243], v[32:35], v[16:31]
  ds_read_b128 v[44:47], v1 offset:64512
  s_waitcnt lgkmcnt(2)
  v_mfma_f32_32x32x16_bf16 v[16:31], a[244:247], v[36:39], v[16:31]
  s_waitcnt lgkmcnt(1)
  v_mfma_f32_32x32x16_bf16 v[16:31], a[248:251], v[40:43], v[16:31]
  s_waitcnt lgkmcnt(0)
  v_mfma_f32_32x32x16_bf16 v[16:31], a[252:255], v[44:47], v[16:31]
L_o_h2:
  s_sub_u32 s45, s32, 3
  v_cmp_gt_i32 vcc, s45, v5
  s_cbranch_vccz L_o_free
  s_mov_b32 s7, 0
L_o_bp:
  buffer_load_dword v5, v6, s[8:11], s39 offen sc1
  s_waitcnt vmcnt(0)
  v_cmp_gt_i32 vcc, s45, v5
  s_cbranch_vccz L_o_free
  s_add_u32 s7, s7, 1
  s_cmp_lt_u32 s7, 131072
  s_cbranch_scc1 L_o_bp
  s_mov_b32 s6, 32
  s_branch L_err
L_o_free:
  s_and_b32 s6, s32, 3
  s_lshl_b32 s6, s6, 17
  s_add_u32 s44, s37, s6
  s_lshr_b32 s6, s32, 2
  s_andn2_b32 s45, 1, s6
  s_add_u32 s32, s32, 1
  v_xor_b32 v1, 0x10000, v1
  s_nop 1
  v_cvt_pk_bf16_f32 v48, v16, v17
  v_cvt_pk_bf16_f32 v49, v18, v19
  v_cvt_pk_bf16_f32 v50, v20, v21
  v_cvt_pk_bf16_f32 v51, v22, v23
  v_bfi_b32 v48, 1, s45, v48
  buffer_store_dwordx4 v[48:51], v0, s[8:11], s44 offen offset:0 sc1
  v_cvt_pk_bf16_f32 v52, v24, v25
  v_cvt_pk_bf16_f32 v53, v26, v27
  v_cvt_pk_bf16_f32 v54, v28, v29
  v_cvt_pk_bf16_f32 v55, v30, v31
  v_bfi_b32 v52, 1, s45, v52
  buffer_store_dwordx4 v[52:55], v0, s[8:11], s44 offen offset:1024 sc1
  s_cmp_eq_u32 s43, 0
  s_waitcnt vmcnt(10)
  s_cbranch_scc0 L_o_loop
  s_cmp_eq_u32 s32, 64
  s_cbranch_scc1 L_o_end
  s_waitcnt vmcnt(2)
  v_cmp_gt_u32 vcc, s41, v4
  s_cbranch_vccz L_o_go
  s_branch L_o_wait
L_o_end:
  s_waitcnt vmcnt(0)
  s_endpgm
L_pro:
  s_max_u32 s6, s4, 3
  s_sub_u32 s6, s6, 3
  s_lshl_b32 s6, s6, 5
  s_add_u32 s6, s6, s5
  s_lshl_b32 s62, s6, 15
  s_lshl_b32 s6, s6, 2
  s_add_u32 s60, s6, s3
  s_lshl_b32 s6, s60, 2
  s_add_u32 s6, s6, 0x710000
  v_mov_b32 v1, 0
  v_lshlrev_b32 v2, 4, v0
  s_mov_b64 exec, 1
  buffer_store_dword v1, v1, s[8:11], s6 offen sc1
  s_mov_b64 exec, -1
  v_lshlrev_b32 v16, 2, v0
  s_lshl_b32 s6, s60, 8
  s_lshl_b32 s7, s60, 1
  s_mov_b32 s16, s66
  s_mov_b32 s17, s67
  s_mov_b32 s18, 0x20000
  s_mov_b32 s19, 0x20000
  buffer_load_dword v20, v16, s[16:19], s6 offen
  s_mov_b32 s20, s68
  s_mov_b32 s21, s69
  s_mov_b32 s22, 0x20000
  s_mov_b32 s23, 0x20000
  buffer_load_dword v21, v16, s[20:23], s6 offen
  s_mov_b32 s24, s70
  s_mov_b32 s25, s71
  s_mov_b32 s26, 0x20000
  s_mov_b32 s27, 0x20000
  buffer_load_dword v22, v16, s[24:27], s6 offen
  s_mov_b32 s28, s72
  s_mov_b32 s29, s73
  s_mov_b32 s30, 0x20000
  s_mov_b32 s31, 0x20000
  buffer_load_dword v23, v16, s[28:31], s6 offen
  s_mov_b32 s16, s74
  s_mov_b32 s17, s75
  s_mov_b32 s18, 0x400
  s_mov_b32 s19, 0x20000
  buffer_load_ushort v24, v1, s[16:19], s7 offen
  s_mov_b32 s20, s76
  s_mov_b32 s21, s77
  s_mov_b32 s22, 0x400
  s_mov_b32 s23, 0x20000
  buffer_load_ushort v232, v1, s[20:23], s7 offen
  s_waitcnt vmcnt(6)
  s_barrier
  s_cmp_lg_u32 s3, 0
  s_cbranch_scc1 L_sd_104
  s_mov_b64 exec, 1
  s_and_b32 s6, s4, 3
  s_lshl_b32 s6, s6, 6
  v_mov_b32 v18, 16
  v_mov_b32 v19, 1
  buffer_atomic_add v19, v18, s[12:15], s6 offen sc1
  s_mov_b64 exec, -1
L_sd_104:
  v_and_b32 v16, 15, v0
  v_and_b32 v17, 7, v16
  v_lshrrev_b32 v18, 3, v16
  v_lshl_add_u32 v19, v18, 7, v17
  v_add_u32 v19, 1, v19
  v_cvt_f32_u32 v4, v19
  v_and_b32 v19, 3, v16
  v_lshrrev_b32 v25, 2, v16
  v_lshlrev_b32 v25, 6, v25
  v_add_u32 v19, v19, v25
  v_lshlrev_b32 v19, 1, v19
  v_add_u32 v19, 258, v19
  v_cmp_gt_u32 vcc, 8, v16
  s_nop 1
  v_cndmask_b32 v19, 0, v19, vcc
  v_cvt_f32_u32 v5, v19
  v_and_b32 v19, 1, v16
  v_lshrrev_b32 v25, 1, v17
  v_lshlrev_b32 v25, 7, v25
  v_lshl_add_u32 v19, v19, 2, v25
  v_add_u32 v19, 516, v19
  v_lshlrev_b32 v25, 7, v17
  v_add_u32 v25, 1032, v25
  v_cndmask_b32 v19, v25, v19, vcc
  v_cvt_f32_u32 v6, v19
  v_lshlrev_b32 v19, 3, v16
  v_cvt_f32_u32 v7, v19
  v_lshrrev_b32 v19, 4, v0
  s_lshl_b32 s6, s3, 11
  v_lshl_add_u32 v3, v19, 6, s6
  v_lshlrev_b32 v16, 4, v0
  v_cvt_f32_u32 v16, v16
  s_mul_i32 s63, s3, 4352
  s_add_u32 s63, s63, 8192
  v_sub_f32 v17, 0x45800000, v16
  v_sub_f32 v18, 0x457fe000, v16
  v_cvt_pk_bf16_f32 v17, v17, v18
  v_lshlrev_b32 v160, 16, v17
  v_and_b32 v161, 0xffff0000, v17
  v_cvt_u32_f32 v160, v160
  v_cvt_u32_f32 v161, v161
  v_add_u32 v160, s63, v160
  v_add_u32 v161, s63, v161
  v_sub_f32 v17, 0x457fc000, v16
  v_sub_f32 v18, 0x457fa000, v16
  v_cvt_pk_bf16_f32 v17, v17, v18
  v_lshlrev_b32 v162, 16, v17
  v_and_b32 v163, 0xffff0000, v17
  v_cvt_u32_f32 v162, v162
  v_cvt_u32_f32 v163, v163
  v_add_u32 v162, s63, v162
  v_add_u32 v163, s63, v163
  v_sub_f32 v17, 0x457f8000, v16
  v_sub_f32 v18, 0x457f6000, v16
  v_cvt_pk_bf16_f32 v17, v17, v18
  v_lshlrev_b32 v164, 16, v17
  v_and_b32 v165, 0xffff0000, v17
  v_cvt_u32_f32 v164, v164
  v_cvt_u32_f32 v165, v165
  v_add_u32 v164, s63, v164
  v_add_u32 v165, s63, v165
  v_sub_f32 v17, 0x457f4000, v16
  v_sub_f32 v18, 0x457f2000, v16
  v_cvt_pk_bf16_f32 v17, v17, v18
  v_lshlrev_b32 v166, 16, v17
  v_and_b32 v167, 0xffff0000, v17
  v_cvt_u32_f32 v166, v166
  v_cvt_u32_f32 v167, v167
  v_add_u32 v166, s63, v166
  v_add_u32 v167, s63, v167
  v_sub_f32 v17, 0x45400000, v16
  v_sub_f32 v18, 0x453fe000, v16
  v_cvt_pk_bf16_f32 v17, v17, v18
  v_lshlrev_b32 v168, 16, v17
  v_and_b32 v169, 0xffff0000, v17
  v_cvt_u32_f32 v168, v168
  v_cvt_u32_f32 v169, v169
  v_add_u32 v168, s63, v168
  v_add_u32 v169, s63, v169
  v_sub_f32 v17, 0x453fc000, v16
  v_sub_f32 v18, 0x453fa000, v16
  v_cvt_pk_bf16_f32 v17, v17, v18
  v_lshlrev_b32 v170, 16, v17
  v_and_b32 v171, 0xffff0000, v17
  v_cvt_u32_f32 v170, v170
  v_cvt_u32_f32 v171, v171
  v_add_u32 v170, s63, v170
  v_add_u32 v171, s63, v171
  v_sub_f32 v17, 0x453f8000, v16
  v_sub_f32 v18, 0x453f6000, v16
  v_cvt_pk_bf16_f32 v17, v17, v18
  v_lshlrev_b32 v172, 16, v17
  v_and_b32 v173, 0xffff0000, v17
  v_cvt_u32_f32 v172, v172
  v_cvt_u32_f32 v173, v173
  v_add_u32 v172, s63, v172
  v_add_u32 v173, s63, v173
  v_sub_f32 v17, 0x453f4000, v16
  v_sub_f32 v18, 0x453f2000, v16
  v_cvt_pk_bf16_f32 v17, v17, v18
  v_lshlrev_b32 v174, 16, v17
  v_and_b32 v175, 0xffff0000, v17
  v_cvt_u32_f32 v174, v174
  v_cvt_u32_f32 v175, v175
  v_add_u32 v174, s63, v174
  v_add_u32 v175, s63, v175
  v_sub_f32 v17, 0x45000000, v16
  v_sub_f32 v18, 0x44ffc000, v16
  v_cvt_pk_bf16_f32 v17, v17, v18
  v_lshlrev_b32 v176, 16, v17
  v_and_b32 v177, 0xffff0000, v17
  v_cvt_u32_f32 v176, v176
  v_cvt_u32_f32 v177, v177
  v_add_u32 v176, s63, v176
  v_add_u32 v177, s63, v177
  v_sub_f32 v17, 0x44ff8000, v16
  v_sub_f32 v18, 0x44ff4000, v16
  v_cvt_pk_bf16_f32 v17, v17, v18
  v_lshlrev_b32 v178, 16, v17
  v_and_b32 v179, 0xffff0000, v17
  v_cvt_u32_f32 v178, v178
  v_cvt_u32_f32 v179, v179
  v_add_u32 v178, s63, v178
  v_add_u32 v179, s63, v179
  v_sub_f32 v17, 0x44ff0000, v16
  v_sub_f32 v18, 0x44fec000, v16
  v_cvt_pk_bf16_f32 v17, v17, v18
  v_lshlrev_b32 v180, 16, v17
  v_and_b32 v181, 0xffff0000, v17
  v_cvt_u32_f32 v180, v180
  v_cvt_u32_f32 v181, v181
  v_add_u32 v180, s63, v180
  v_add_u32 v181, s63, v181
  v_sub_f32 v17, 0x44fe8000, v16
  v_sub_f32 v18, 0x44fe4000, v16
  v_cvt_pk_bf16_f32 v17, v17, v18
  v_lshlrev_b32 v182, 16, v17
  v_and_b32 v183, 0xffff0000, v17
  v_cvt_u32_f32 v182, v182
  v_cvt_u32_f32 v183, v183
  v_add_u32 v182, s63, v182
  v_add_u32 v183, s63, v183
  v_sub_f32 v17, 0x44800000, v16
  v_sub_f32 v18, 0x447f8000, v16
  v_cvt_pk_bf16_f32 v17, v17, v18
  v_lshlrev_b32 v184, 16, v17
  v_and_b32 v185, 0xffff0000, v17
  v_cvt_u32_f32 v184, v184
  v_cvt_u32_f32 v185, v185
  v_add_u32 v184, s63, v184
  v_add_u32 v185, s63, v185
  v_sub_f32 v17, 0x447f0000, v16
  v_sub_f32 v18, 0x447e8000, v16
  v_cvt_pk_bf16_f32 v17, v17, v18
  v_lshlrev_b32 v186, 16, v17
  v_and_b32 v187, 0xffff0000, v17
  v_cvt_u32_f32 v186, v186
  v_cvt_u32_f32 v187, v187
  v_add_u32 v186, s63, v186
  v_add_u32 v187, s63, v187
  v_sub_f32 v17, 0x447e0000, v16
  v_sub_f32 v18, 0x447d8000, v16
  v_cvt_pk_bf16_f32 v17, v17, v18
  v_lshlrev_b32 v188, 16, v17
  v_and_b32 v189, 0xffff0000, v17
  v_cvt_u32_f32 v188, v188
  v_cvt_u32_f32 v189, v189
  v_add_u32 v188, s63, v188
  v_add_u32 v189, s63, v189
  v_sub_f32 v17, 0x447d0000, v16
  v_sub_f32 v18, 0x447c8000, v16
  v_cvt_pk_bf16_f32 v17, v17, v18
  v_lshlrev_b32 v190, 16, v17
  v_and_b32 v191, 0xffff0000, v17
  v_cvt_u32_f32 v190, v190
  v_cvt_u32_f32 v191, v191
  v_add_u32 v190, s63, v190
  v_add_u32 v191, s63, v191
  s_waitcnt vmcnt(1)
  v_lshlrev_b32 v24, 16, v24
  v_mul_f32 v26, 0x3fb8aa3b, v24
  v_mov_b32 v27, 0x3fb8aa3b
  v_fma_f32 v27, v24, v27, -v26
  v_fmac_f32 v27, 0x32a57060, v24
  v_exp_f32 v26, v26
  v_mul_f32 v27, 0x3f317218, v27
  v_fma_f32 v24, v26, v27, v26
  v_cvt_pk_bf16_f32 v24, v24, v24
  v_and_b32 v24, 0xffff0000, v24
  v_lshlrev_b32 v32, 16, v20
  v_and_b32 v36, 0xffff0000, v20
  v_lshlrev_b32 v33, 16, v21
  v_and_b32 v37, 0xffff0000, v21
  v_lshlrev_b32 v34, 16, v22
  v_and_b32 v38, 0xffff0000, v22
  v_lshlrev_b32 v35, 16, v23
  v_and_b32 v39, 0xffff0000, v23
  v_max3_f32 v28, |v34|, |v35|, |v38|
  v_max_f32 v28, |v39|, v28
  s_nop 1
  v_max_f32_dpp v28, v28, v28 quad_perm:[1,0,3,2] row_mask:0xf bank_mask:0xf
  s_nop 1
  v_max_f32_dpp v28, v28, v28 quad_perm:[2,3,0,1] row_mask:0xf bank_mask:0xf
  s_nop 1
  v_max_f32_dpp v28, v28, v28 row_half_mirror row_mask:0xf bank_mask:0xf
  s_nop 1
  v_max_f32_dpp v28, v28, v28 row_mirror row_mask:0xf bank_mask:0xf
  v_mov_b32 v29, v28
  s_nop 1
  v_permlane16_swap_b32 v28, v29
  v_max_f32 v28, v28, v29
  v_mov_b32 v29, v28
  s_nop 1
  v_permlane32_swap_b32 v28, v29
  v_max_f32 v28, v28, v29
  v_frexp_exp_i32_f32 v28, v28
  v_sub_u32 v29, 0, v28
  v_mul_f32 v26, 0x3fb8aa3b, v32
  v_mov_b32 v27, 0x3fb8aa3b
  v_fma_f32 v27, v32, v27, -v26
  v_fmac_f32 v27, 0x32a57060, v32
  v_exp_f32 v26, v26
  v_mul_f32 v27, 0x3f317218, v27
  v_fma_f32 v32, v26, v27, v26
  v_cvt_pk_bf16_f32 v32, v32, v32
  v_and_b32 v32, 0xffff0000, v32
  v_mul_f32 v32, v32, v24
  v_mul_f32 v33, v33, v24
  v_ldexp_f32 v34, v34, v29
  v_ldexp_f32 v35, v35, v29
  v_mul_f32 v32, 0xbfb8aa3b, v32
  v_mul_f32 v33, 0x3e22f983, v33
  v_mul_f32 v26, 0x3fb8aa3b, v36
  v_mov_b32 v27, 0x3fb8aa3b
  v_fma_f32 v27, v36, v27, -v26
  v_fmac_f32 v27, 0x32a57060, v36
  v_exp_f32 v26, v26
  v_mul_f32 v27, 0x3f317218, v27
  v_fma_f32 v36, v26, v27, v26
  v_cvt_pk_bf16_f32 v36, v36, v36
  v_and_b32 v36, 0xffff0000, v36
  v_mul_f32 v36, v36, v24
  v_mul_f32 v37, v37, v24
  v_ldexp_f32 v38, v38, v29
  v_ldexp_f32 v39, v39, v29
  v_mul_f32 v36, 0xbfb8aa3b, v36
  v_mul_f32 v37, 0x3e22f983, v37
  v_add_f32 v24, v24, v24
  v_ldexp_f32 v233, v24, v28
  s_lshl_b32 s6, s3, 11
  v_lshl_add_u32 v16, v0, 5, s6
  ds_write_b128 v16, v[32:35] offset:0
  ds_write_b128 v16, v[36:39] offset:16
  ds_read_b128 v[8:11], v3 offset:0
  v_mov_b32 v48, 0
  v_mov_b32 v49, 0
  v_mov_b32 v50, 0
  v_mov_b32 v51, 0
  v_mov_b32 v52, 0
  v_mov_b32 v53, 0
  v_mov_b32 v54, 0
  v_mov_b32 v55, 0
  v_mov_b32 v56, 0
  v_mov_b32 v57, 0
  v_mov_b32 v58, 0
  v_mov_b32 v59, 0
  v_mov_b32 v16, 0
  v_mov_b32 v17, 0
  v_mov_b32 v18, 0
  v_mov_b32 v19, 0
  v_mov_b32 v20, 0
  v_mov_b32 v21, 0
  v_mov_b32 v22, 0
  v_mov_b32 v23, 0
  v_mov_b32 v24, 0
  v_mov_b32 v25, 0
  v_mov_b32 v26, 0
  v_mov_b32 v27, 0
  v_mov_b32 v28, 0
  v_mov_b32 v29, 0
  v_mov_b32 v30, 0
  v_mov_b32 v31, 0
  s_mov_b32 s6, 2
L_kg_105:
  s_waitcnt lgkmcnt(0)
  ds_read_b128 v[12:15], v3 offset:16
  v_mfma_f32_16x16x32_f16 v[48:51], v[16:19], v[28:31], v[48:51]
  v_pk_mul_f32 v[38:39], v[8:9], v[6:7] op_sel:[0,1] op_sel_hi:[1,1]
  v_mfma_f32_16x16x32_f16 v[52:55], v[20:23], v[28:31], v[52:55]
  v_pk_mul_f32 v[32:33], v[8:9], v[4:5] op_sel:[0,0] op_sel_hi:[1,0]
  v_mfma_f32_16x16x32_f16 v[56:59], v[24:27], v[28:31], v[56:59]
  v_pk_mul_f32 v[34:35], v[8:9], v[4:5] op_sel:[0,1] op_sel_hi:[1,1]
  v_pk_mul_f32 v[36:37], v[8:9], v[6:7] op_sel:[0,0] op_sel_hi:[1,0]
  v_fract_f32 v39, v39
  v_fract_f32 v33, v33
  v_fract_f32 v35, v35
  v_fract_f32 v37, v37
  v_exp_f32 v38, v38
  v_cos_f32 v46, v39
  v_sin_f32 v47, v39
  v_exp_f32 v32, v32
  v_cos_f32 v40, v33
  v_sin_f32 v41, v33
  v_exp_f32 v34, v34
  v_cos_f32 v42, v35
  v_sin_f32 v43, v35
  v_exp_f32 v36, v36
  v_cos_f32 v44, v37
  v_sin_f32 v45, v37
  v_pk_mul_f32 v[46:47], v[46:47], v[38:39] op_sel_hi:[1,0]
  v_pk_mul_f32 v[40:41], v[40:41], v[32:33] op_sel_hi:[1,0]
  v_pk_mul_f32 v[42:43], v[42:43], v[34:35] op_sel_hi:[1,0]
  v_pk_mul_f32 v[44:45], v[44:45], v[36:37] op_sel_hi:[1,0]
  v_pk_mul_f32 v[32:33], v[46:47], v[10:11] op_sel_hi:[1,0] neg_hi:[1,0]
  v_cvt_pk_f16_f32 v16, v40, v41
  v_pk_fma_f32 v[32:33], v[46:47], v[10:11], v[32:33] op_sel:[1,1,0] op_sel_hi:[0,1,1] neg_lo:[1,0,0] neg_hi:[1,0,0]
  v_cvt_pk_f16_f32 v20, v42, v43
  v_cvt_pk_f16_f32 v24, v44, v45
  v_cvt_pk_f16_f32 v28, v32, v33
  s_waitcnt lgkmcnt(0)
  ds_read_b128 v[8:11], v3 offset:32
  v_pk_mul_f32 v[38:39], v[12:13], v[6:7] op_sel:[0,1] op_sel_hi:[1,1]
  v_pk_mul_f32 v[32:33], v[12:13], v[4:5] op_sel:[0,0] op_sel_hi:[1,0]
  v_pk_mul_f32 v[34:35], v[12:13], v[4:5] op_sel:[0,1] op_sel_hi:[1,1]
  v_pk_mul_f32 v[36:37], v[12:13], v[6:7] op_sel:[0,0] op_sel_hi:[1,0]
  v_fract_f32 v39, v39
  v_fract_f32 v33, v33
  v_fract_f32 v35, v35
  v_fract_f32 v37, v37
  v_exp_f32 v38, v38
  v_cos_f32 v46, v39
  v_sin_f32 v47, v39
  v_exp_f32 v32, v32
  v_cos_f32 v40, v33
  v_sin_f32 v41, v33
  v_exp_f32 v34, v34
  v_cos_f32 v42, v35
  v_sin_f32 v43, v35
  v_exp_f32 v36, v36
  v_cos_f32 v44, v37
  v_sin_f32 v45, v37
  v_pk_mul_f32 v[46:47], v[46:47], v[38:39] op_sel_hi:[1,0]
  v_pk_mul_f32 v[40:41], v[40:41], v[32:33] op_sel_hi:[1,0]
  v_pk_mul_f32 v[42:43], v[42:43], v[34:35] op_sel_hi:[1,0]
  v_pk_mul_f32 v[44:45], v[44:45], v[36:37] op_sel_hi:[1,0]
  v_pk_mul_f32 v[32:33], v[46:47], v[14:15] op_sel_hi:[1,0] neg_hi:[1,0]
  v_cvt_pk_f16_f32 v17, v40, v41
  v_pk_fma_f32 v[32:33], v[46:47], v[14:15], v[32:33] op_sel:[1,1,0] op_sel_hi:[0,1,1] neg_lo:[1,0,0] neg_hi:[1,0,0]
  v_cvt_pk_f16_f32 v21, v42, v43
  v_cvt_pk_f16_f32 v25, v44, v45
  v_cvt_pk_f16_f32 v29, v32, v33
  s_waitcnt lgkmcnt(0)
  ds_read_b128 v[12:15], v3 offset:48
  v_pk_mul_f32 v[38:39], v[8:9], v[6:7] op_sel:[0,1] op_sel_hi:[1,1]
  v_pk_mul_f32 v[32:33], v[8:9], v[4:5] op_sel:[0,0] op_sel_hi:[1,0]
  v_pk_mul_f32 v[34:35], v[8:9], v[4:5] op_sel:[0,1] op_sel_hi:[1,1]
  v_pk_mul_f32 v[36:37], v[8:9], v[6:7] op_sel:[0,0] op_sel_hi:[1,0]
  v_fract_f32 v39, v39
  v_fract_f32 v33, v33
  v_fract_f32 v35, v35
  v_fract_f32 v37, v37
  v_exp_f32 v38, v38
  v_cos_f32 v46, v39
  v_sin_f32 v47, v39
  v_exp_f32 v32, v32
  v_cos_f32 v40, v33
  v_sin_f32 v41, v33
  v_exp_f32 v34, v34
  v_cos_f32 v42, v35
  v_sin_f32 v43, v35
  v_exp_f32 v36, v36
  v_cos_f32 v44, v37
  v_sin_f32 v45, v37
  v_pk_mul_f32 v[46:47], v[46:47], v[38:39] op_sel_hi:[1,0]
  v_pk_mul_f32 v[40:41], v[40:41], v[32:33] op_sel_hi:[1,0]
  v_pk_mul_f32 v[42:43], v[42:43], v[34:35] op_sel_hi:[1,0]
  v_pk_mul_f32 v[44:45], v[44:45], v[36:37] op_sel_hi:[1,0]
  v_pk_mul_f32 v[32:33], v[46:47], v[10:11] op_sel_hi:[1,0] neg_hi:[1,0]
  v_cvt_pk_f16_f32 v18, v40, v41
  v_pk_fma_f32 v[32:33], v[46:47], v[10:11], v[32:33] op_sel:[1,1,0] op_sel_hi:[0,1,1] neg_lo:[1,0,0] neg_hi:[1,0,0]
  v_cvt_pk_f16_f32 v22, v42, v43
  v_cvt_pk_f16_f32 v26, v44, v45
  v_cvt_pk_f16_f32 v30, v32, v33
  s_waitcnt lgkmcnt(0)
  ds_read_b128 v[8:11], v3 offset:256
  v_pk_mul_f32 v[38:39], v[12:13], v[6:7] op_sel:[0,1] op_sel_hi:[1,1]
  v_pk_mul_f32 v[32:33], v[12:13], v[4:5] op_sel:[0,0] op_sel_hi:[1,0]
  v_pk_mul_f32 v[34:35], v[12:13], v[4:5] op_sel:[0,1] op_sel_hi:[1,1]
  v_pk_mul_f32 v[36:37], v[12:13], v[6:7] op_sel:[0,0] op_sel_hi:[1,0]
  v_fract_f32 v39, v39
  v_fract_f32 v33, v33
  v_fract_f32 v35, v35
  v_fract_f32 v37, v37
  v_exp_f32 v38, v38
  v_cos_f32 v46, v39
  v_sin_f32 v47, v39
  v_exp_f32 v32, v32
  v_cos_f32 v40, v33
  v_sin_f32 v41, v33
  v_exp_f32 v34, v34
  v_cos_f32 v42, v35
  v_sin_f32 v43, v35
  v_exp_f32 v36, v36
  v_cos_f32 v44, v37
  v_sin_f32 v45, v37
  v_pk_mul_f32 v[46:47], v[46:47], v[38:39] op_sel_hi:[1,0]
  v_pk_mul_f32 v[40:41], v[40:41], v[32:33] op_sel_hi:[1,0]
  v_pk_mul_f32 v[42:43], v[42:43], v[34:35] op_sel_hi:[1,0]
  v_pk_mul_f32 v[44:45], v[44:45], v[36:37] op_sel_hi:[1,0]
  v_pk_mul_f32 v[32:33], v[46:47], v[14:15] op_sel_hi:[1,0] neg_hi:[1,0]
  v_cvt_pk_f16_f32 v19, v40, v41
  v_pk_fma_f32 v[32:33], v[46:47], v[14:15], v[32:33] op_sel:[1,1,0] op_sel_hi:[0,1,1] neg_lo:[1,0,0] neg_hi:[1,0,0]
  v_cvt_pk_f16_f32 v23, v42, v43
  v_cvt_pk_f16_f32 v27, v44, v45
  v_cvt_pk_f16_f32 v31, v32, v33
  v_add_u32 v3, 256, v3
  s_sub_u32 s6, s6, 1
  s_cmp_lg_u32 s6, 0
  s_cbranch_scc1 L_kg_105
  s_mov_b32 s6, 2
L_kg_106:
  s_waitcnt lgkmcnt(0)
  ds_read_b128 v[12:15], v3 offset:16
  v_mfma_f32_16x16x32_f16 v[48:51], v[16:19], v[28:31], v[48:51]
  v_pk_mul_f32 v[38:39], v[8:9], v[6:7] op_sel:[0,1] op_sel_hi:[1,1]
  v_mfma_f32_16x16x32_f16 v[52:55], v[20:23], v[28:31], v[52:55]
  v_pk_mul_f32 v[32:33], v[8:9], v[4:5] op_sel:[0,0] op_sel_hi:[1,0]
  v_mfma_f32_16x16x32_f16 v[56:59], v[24:27], v[28:31], v[56:59]
  v_pk_mul_f32 v[34:35], v[8:9], v[4:5] op_sel:[0,1] op_sel_hi:[1,1]
  v_pk_mul_f32 v[36:37], v[8:9], v[6:7] op_sel:[0,0] op_sel_hi:[1,0]
  v_fract_f32 v39, v39
  v_fract_f32 v33, v33
  v_fract_f32 v35, v35
  v_fract_f32 v37, v37
  v_exp_f32 v38, v38
  v_cos_f32 v46, v39
  v_sin_f32 v47, v39
  v_exp_f32 v32, v32
  v_cos_f32 v40, v33
  v_sin_f32 v41, v33
  v_exp_f32 v34, v34
  v_cos_f32 v42, v35
  v_sin_f32 v43, v35
  v_exp_f32 v36, v36
  v_cos_f32 v44, v37
  v_sin_f32 v45, v37
  v_pk_mul_f32 v[46:47], v[46:47], v[38:39] op_sel_hi:[1,0]
  v_pk_mul_f32 v[40:41], v[40:41], v[32:33] op_sel_hi:[1,0]
  v_pk_mul_f32 v[42:43], v[42:43], v[34:35] op_sel_hi:[1,0]
  v_pk_mul_f32 v[44:45], v[44:45], v[36:37] op_sel_hi:[1,0]
  v_pk_mul_f32 v[32:33], v[46:47], v[10:11] op_sel_hi:[1,0] neg_hi:[1,0]
  v_cvt_pk_f16_f32 v16, v40, v41
  v_pk_fma_f32 v[32:33], v[46:47], v[10:11], v[32:33] op_sel:[1,1,0] op_sel_hi:[0,1,1] neg_lo:[1,0,0] neg_hi:[1,0,0]
  v_cvt_pk_f16_f32 v20, v42, v43
  v_cvt_pk_f16_f32 v24, v44, v45
  v_cvt_pk_f16_f32 v28, v32, v33
  s_waitcnt lgkmcnt(0)
  ds_read_b128 v[8:11], v3 offset:32
  v_pk_mul_f32 v[38:39], v[12:13], v[6:7] op_sel:[0,1] op_sel_hi:[1,1]
  v_pk_mul_f32 v[32:33], v[12:13], v[4:5] op_sel:[0,0] op_sel_hi:[1,0]
  v_pk_mul_f32 v[34:35], v[12:13], v[4:5] op_sel:[0,1] op_sel_hi:[1,1]
  v_pk_mul_f32 v[36:37], v[12:13], v[6:7] op_sel:[0,0] op_sel_hi:[1,0]
  v_fract_f32 v39, v39
  v_fract_f32 v33, v33
  v_fract_f32 v35, v35
  v_fract_f32 v37, v37
  v_exp_f32 v38, v38
  v_cos_f32 v46, v39
  v_sin_f32 v47, v39
  v_exp_f32 v32, v32
  v_cos_f32 v40, v33
  v_sin_f32 v41, v33
  v_exp_f32 v34, v34
  v_cos_f32 v42, v35
  v_sin_f32 v43, v35
  v_exp_f32 v36, v36
  v_cos_f32 v44, v37
  v_sin_f32 v45, v37
  v_pk_mul_f32 v[46:47], v[46:47], v[38:39] op_sel_hi:[1,0]
  v_pk_mul_f32 v[40:41], v[40:41], v[32:33] op_sel_hi:[1,0]
  v_pk_mul_f32 v[42:43], v[42:43], v[34:35] op_sel_hi:[1,0]
  v_pk_mul_f32 v[44:45], v[44:45], v[36:37] op_sel_hi:[1,0]
  v_pk_mul_f32 v[32:33], v[46:47], v[14:15] op_sel_hi:[1,0] neg_hi:[1,0]
  v_cvt_pk_f16_f32 v17, v40, v41
  v_pk_fma_f32 v[32:33], v[46:47], v[14:15], v[32:33] op_sel:[1,1,0] op_sel_hi:[0,1,1] neg_lo:[1,0,0] neg_hi:[1,0,0]
  v_cvt_pk_f16_f32 v21, v42, v43
  v_cvt_pk_f16_f32 v25, v44, v45
  v_cvt_pk_f16_f32 v29, v32, v33
  s_waitcnt lgkmcnt(0)
  ds_read_b128 v[12:15], v3 offset:48
  v_pk_mul_f32 v[38:39], v[8:9], v[6:7] op_sel:[0,1] op_sel_hi:[1,1]
  v_pk_mul_f32 v[32:33], v[8:9], v[4:5] op_sel:[0,0] op_sel_hi:[1,0]
  v_pk_mul_f32 v[34:35], v[8:9], v[4:5] op_sel:[0,1] op_sel_hi:[1,1]
  v_pk_mul_f32 v[36:37], v[8:9], v[6:7] op_sel:[0,0] op_sel_hi:[1,0]
  v_fract_f32 v39, v39
  v_fract_f32 v33, v33
  v_fract_f32 v35, v35
  v_fract_f32 v37, v37
  v_exp_f32 v38, v38
  v_cos_f32 v46, v39
  v_sin_f32 v47, v39
  v_exp_f32 v32, v32
  v_cos_f32 v40, v33
  v_sin_f32 v41, v33
  v_exp_f32 v34, v34
  v_cos_f32 v42, v35
  v_sin_f32 v43, v35
  v_exp_f32 v36, v36
  v_cos_f32 v44, v37
  v_sin_f32 v45, v37
  v_pk_mul_f32 v[46:47], v[46:47], v[38:39] op_sel_hi:[1,0]
  v_pk_mul_f32 v[40:41], v[40:41], v[32:33] op_sel_hi:[1,0]
  v_pk_mul_f32 v[42:43], v[42:43], v[34:35] op_sel_hi:[1,0]
  v_pk_mul_f32 v[44:45], v[44:45], v[36:37] op_sel_hi:[1,0]
  v_pk_mul_f32 v[32:33], v[46:47], v[10:11] op_sel_hi:[1,0] neg_hi:[1,0]
  v_cvt_pk_f16_f32 v18, v40, v41
  v_pk_fma_f32 v[32:33], v[46:47], v[10:11], v[32:33] op_sel:[1,1,0] op_sel_hi:[0,1,1] neg_lo:[1,0,0] neg_hi:[1,0,0]
  v_cvt_pk_f16_f32 v22, v42, v43
  v_cvt_pk_f16_f32 v26, v44, v45
  v_cvt_pk_f16_f32 v30, v32, v33
  s_waitcnt lgkmcnt(0)
  ds_read_b128 v[8:11], v3 offset:256
  v_pk_mul_f32 v[38:39], v[12:13], v[6:7] op_sel:[0,1] op_sel_hi:[1,1]
  v_pk_mul_f32 v[32:33], v[12:13], v[4:5] op_sel:[0,0] op_sel_hi:[1,0]
  v_pk_mul_f32 v[34:35], v[12:13], v[4:5] op_sel:[0,1] op_sel_hi:[1,1]
  v_pk_mul_f32 v[36:37], v[12:13], v[6:7] op_sel:[0,0] op_sel_hi:[1,0]
  v_fract_f32 v39, v39
  v_fract_f32 v33, v33
  v_fract_f32 v35, v35
  v_fract_f32 v37, v37
  v_exp_f32 v38, v38
  v_cos_f32 v46, v39
  v_sin_f32 v47, v39
  v_exp_f32 v32, v32
  v_cos_f32 v40, v33
  v_sin_f32 v41, v33
  v_exp_f32 v34, v34
  v_cos_f32 v42, v35
  v_sin_f32 v43, v35
  v_exp_f32 v36, v36
  v_cos_f32 v44, v37
  v_sin_f32 v45, v37
  v_pk_mul_f32 v[46:47], v[46:47], v[38:39] op_sel_hi:[1,0]
  v_pk_mul_f32 v[40:41], v[40:41], v[32:33] op_sel_hi:[1,0]
  v_pk_mul_f32 v[42:43], v[42:43], v[34:35] op_sel_hi:[1,0]
  v_pk_mul_f32 v[44:45], v[44:45], v[36:37] op_sel_hi:[1,0]
  v_pk_mul_f32 v[32:33], v[46:47], v[14:15] op_sel_hi:[1,0] neg_hi:[1,0]
  v_cvt_pk_f16_f32 v19, v40, v41
  v_pk_fma_f32 v[32:33], v[46:47], v[14:15], v[32:33] op_sel:[1,1,0] op_sel_hi:[0,1,1] neg_lo:[1,0,0] neg_hi:[1,0,0]
  v_cvt_pk_f16_f32 v23, v42, v43
  v_cvt_pk_f16_f32 v27, v44, v45
  v_cvt_pk_f16_f32 v31, v32, v33
  v_add_u32 v3, 256, v3
  s_sub_u32 s6, s6, 1
  s_cmp_lg_u32 s6, 0
  s_cbranch_scc1 L_kg_106
  s_mov_b32 s6, 2
L_kg_107:
  s_waitcnt lgkmcnt(0)
  ds_read_b128 v[12:15], v3 offset:16
  v_mfma_f32_16x16x32_f16 v[48:51], v[16:19], v[28:31], v[48:51]
  v_pk_mul_f32 v[38:39], v[8:9], v[6:7] op_sel:[0,1] op_sel_hi:[1,1]
  v_mfma_f32_16x16x32_f16 v[52:55], v[20:23], v[28:31], v[52:55]
  v_pk_mul_f32 v[32:33], v[8:9], v[4:5] op_sel:[0,0] op_sel_hi:[1,0]
  v_mfma_f32_16x16x32_f16 v[56:59], v[24:27], v[28:31], v[56:59]
  v_pk_mul_f32 v[34:35], v[8:9], v[4:5] op_sel:[0,1] op_sel_hi:[1,1]
  v_pk_mul_f32 v[36:37], v[8:9], v[6:7] op_sel:[0,0] op_sel_hi:[1,0]
  v_fract_f32 v39, v39
  v_fract_f32 v33, v33
  v_fract_f32 v35, v35
  v_fract_f32 v37, v37
  v_exp_f32 v38, v38
  v_cos_f32 v46, v39
  v_sin_f32 v47, v39
  v_exp_f32 v32, v32
  v_cos_f32 v40, v33
  v_sin_f32 v41, v33
  v_exp_f32 v34, v34
  v_cos_f32 v42, v35
  v_sin_f32 v43, v35
  v_exp_f32 v36, v36
  v_cos_f32 v44, v37
  v_sin_f32 v45, v37
  v_pk_mul_f32 v[46:47], v[46:47], v[38:39] op_sel_hi:[1,0]
  v_pk_mul_f32 v[40:41], v[40:41], v[32:33] op_sel_hi:[1,0]
  v_pk_mul_f32 v[42:43], v[42:43], v[34:35] op_sel_hi:[1,0]
  v_pk_mul_f32 v[44:45], v[44:45], v[36:37] op_sel_hi:[1,0]
  v_pk_mul_f32 v[32:33], v[46:47], v[10:11] op_sel_hi:[1,0] neg_hi:[1,0]
  v_cvt_pk_f16_f32 v16, v40, v41
  v_pk_fma_f32 v[32:33], v[46:47], v[10:11], v[32:33] op_sel:[1,1,0] op_sel_hi:[0,1,1] neg_lo:[1,0,0] neg_hi:[1,0,0]
  v_cvt_pk_f16_f32 v20, v42, v43
  v_cvt_pk_f16_f32 v24, v44, v45
  v_cvt_pk_f16_f32 v28, v32, v33
  s_waitcnt lgkmcnt(0)
  ds_read_b128 v[8:11], v3 offset:32
  v_pk_mul_f32 v[38:39], v[12:13], v[6:7] op_sel:[0,1] op_sel_hi:[1,1]
  v_pk_mul_f32 v[32:33], v[12:13], v[4:5] op_sel:[0,0] op_sel_hi:[1,0]
  v_pk_mul_f32 v[34:35], v[12:13], v[4:5] op_sel:[0,1] op_sel_hi:[1,1]
  v_pk_mul_f32 v[36:37], v[12:13], v[6:7] op_sel:[0,0] op_sel_hi:[1,0]
  v_fract_f32 v39, v39
  v_fract_f32 v33, v33
  v_fract_f32 v35, v35
  v_fract_f32 v37, v37
  v_exp_f32 v38, v38
  v_cos_f32 v46, v39
  v_sin_f32 v47, v39
  v_exp_f32 v32, v32
  v_cos_f32 v40, v33
  v_sin_f32 v41, v33
  v_exp_f32 v34, v34
  v_cos_f32 v42, v35
  v_sin_f32 v43, v35
  v_exp_f32 v36, v36
  v_cos_f32 v44, v37
  v_sin_f32 v45, v37
  v_pk_mul_f32 v[46:47], v[46:47], v[38:39] op_sel_hi:[1,0]
  v_pk_mul_f32 v[40:41], v[40:41], v[32:33] op_sel_hi:[1,0]
  v_pk_mul_f32 v[42:43], v[42:43], v[34:35] op_sel_hi:[1,0]
  v_pk_mul_f32 v[44:45], v[44:45], v[36:37] op_sel_hi:[1,0]
  v_pk_mul_f32 v[32:33], v[46:47], v[14:15] op_sel_hi:[1,0] neg_hi:[1,0]
  v_cvt_pk_f16_f32 v17, v40, v41
  v_pk_fma_f32 v[32:33], v[46:47], v[14:15], v[32:33] op_sel:[1,1,0] op_sel_hi:[0,1,1] neg_lo:[1,0,0] neg_hi:[1,0,0]
  v_cvt_pk_f16_f32 v21, v42, v43
  v_cvt_pk_f16_f32 v25, v44, v45
  v_cvt_pk_f16_f32 v29, v32, v33
  s_waitcnt lgkmcnt(0)
  ds_read_b128 v[12:15], v3 offset:48
  v_pk_mul_f32 v[38:39], v[8:9], v[6:7] op_sel:[0,1] op_sel_hi:[1,1]
  v_pk_mul_f32 v[32:33], v[8:9], v[4:5] op_sel:[0,0] op_sel_hi:[1,0]
  v_pk_mul_f32 v[34:35], v[8:9], v[4:5] op_sel:[0,1] op_sel_hi:[1,1]
  v_pk_mul_f32 v[36:37], v[8:9], v[6:7] op_sel:[0,0] op_sel_hi:[1,0]
  v_fract_f32 v39, v39
  v_fract_f32 v33, v33
  v_fract_f32 v35, v35
  v_fract_f32 v37, v37
  v_exp_f32 v38, v38
  v_cos_f32 v46, v39
  v_sin_f32 v47, v39
  v_exp_f32 v32, v32
  v_cos_f32 v40, v33
  v_sin_f32 v41, v33
  v_exp_f32 v34, v34
  v_cos_f32 v42, v35
  v_sin_f32 v43, v35
  v_exp_f32 v36, v36
  v_cos_f32 v44, v37
  v_sin_f32 v45, v37
  v_pk_mul_f32 v[46:47], v[46:47], v[38:39] op_sel_hi:[1,0]
  v_pk_mul_f32 v[40:41], v[40:41], v[32:33] op_sel_hi:[1,0]
  v_pk_mul_f32 v[42:43], v[42:43], v[34:35] op_sel_hi:[1,0]
  v_pk_mul_f32 v[44:45], v[44:45], v[36:37] op_sel_hi:[1,0]
  v_pk_mul_f32 v[32:33], v[46:47], v[10:11] op_sel_hi:[1,0] neg_hi:[1,0]
  v_cvt_pk_f16_f32 v18, v40, v41
  v_pk_fma_f32 v[32:33], v[46:47], v[10:11], v[32:33] op_sel:[1,1,0] op_sel_hi:[0,1,1] neg_lo:[1,0,0] neg_hi:[1,0,0]
  v_cvt_pk_f16_f32 v22, v42, v43
  v_cvt_pk_f16_f32 v26, v44, v45
  v_cvt_pk_f16_f32 v30, v32, v33
  s_waitcnt lgkmcnt(0)
  ds_read_b128 v[8:11], v3 offset:256
  v_pk_mul_f32 v[38:39], v[12:13], v[6:7] op_sel:[0,1] op_sel_hi:[1,1]
  v_pk_mul_f32 v[32:33], v[12:13], v[4:5] op_sel:[0,0] op_sel_hi:[1,0]
  v_pk_mul_f32 v[34:35], v[12:13], v[4:5] op_sel:[0,1] op_sel_hi:[1,1]
  v_pk_mul_f32 v[36:37], v[12:13], v[6:7] op_sel:[0,0] op_sel_hi:[1,0]
  v_fract_f32 v39, v39
  v_fract_f32 v33, v33
  v_fract_f32 v35, v35
  v_fract_f32 v37, v37
  v_exp_f32 v38, v38
  v_cos_f32 v46, v39
  v_sin_f32 v47, v39
  v_exp_f32 v32, v32
  v_cos_f32 v40, v33
  v_sin_f32 v41, v33
  v_exp_f32 v34, v34
  v_cos_f32 v42, v35
  v_sin_f32 v43, v35
  v_exp_f32 v36, v36
  v_cos_f32 v44, v37
  v_sin_f32 v45, v37
  v_pk_mul_f32 v[46:47], v[46:47], v[38:39] op_sel_hi:[1,0]
  v_pk_mul_f32 v[40:41], v[40:41], v[32:33] op_sel_hi:[1,0]
  v_pk_mul_f32 v[42:43], v[42:43], v[34:35] op_sel_hi:[1,0]
  v_pk_mul_f32 v[44:45], v[44:45], v[36:37] op_sel_hi:[1,0]
  v_pk_mul_f32 v[32:33], v[46:47], v[14:15] op_sel_hi:[1,0] neg_hi:[1,0]
  v_cvt_pk_f16_f32 v19, v40, v41
  v_pk_fma_f32 v[32:33], v[46:47], v[14:15], v[32:33] op_sel:[1,1,0] op_sel_hi:[0,1,1] neg_lo:[1,0,0] neg_hi:[1,0,0]
  v_cvt_pk_f16_f32 v23, v42, v43
  v_cvt_pk_f16_f32 v27, v44, v45
  v_cvt_pk_f16_f32 v31, v32, v33
  v_add_u32 v3, 256, v3
  s_sub_u32 s6, s6, 1
  s_cmp_lg_u32 s6, 0
  s_cbranch_scc1 L_kg_107
  s_cmp_lg_u32 s3, 0
  s_cbranch_scc1 L_wdo_109
  s_mov_b32 s7, 0
  v_mbcnt_lo_u32_b32 v216, -1, 0
  v_and_b32 v216, 3, v216
  v_lshlrev_b32 v216, 6, v216
L_wd_108:
  buffer_load_dword v217, v216, s[12:15], 0 offen offset:16 sc1
  s_waitcnt vmcnt(0)
  v_cmp_ne_u32 vcc, 64, v217
  s_cbranch_vccz L_wdo_109
  s_add_u32 s7, s7, 1
  s_cmp_lt_u32 s7, 131072
  s_cbranch_scc1 L_wd_108
  s_mov_b32 s6, 50
  s_branch L_err
L_wdo_109:
  s_barrier
  s_lshl_b32 s6, s3, 13
  s_add_u32 s6, s6, s62
  s_add_u32 s6, s6, 0xb000000
  s_lshl_b32 s7, s3, 10
  v_lshlrev_b32 v216, 7, v0
  s_add_u32 m0, s7, 44064
  s_nop 0
  buffer_load_dwordx4 v216, s[8:11], s6 offen lds
  s_add_u32 s6, s6, 16
  s_add_u32 m0, s7, 48192
  s_nop 0
  buffer_load_dwordx4 v216, s[8:11], s6 offen lds
  s_add_u32 s6, s6, 16
  s_add_u32 m0, s7, 52320
  s_nop 0
  buffer_load_dwordx4 v216, s[8:11], s6 offen lds
  s_add_u32 s6, s6, 16
  s_add_u32 m0, s7, 56448
  s_nop 0
  buffer_load_dwordx4 v216, s[8:11], s6 offen lds
  s_add_u32 s6, s6, 16
  s_add_u32 m0, s7, 60544
  s_nop 0
  buffer_load_dwordx4 v216, s[8:11], s6 offen lds
  s_add_u32 s6, s6, 16
  s_add_u32 m0, s7, 64640
  s_nop 0
  buffer_load_dwordx4 v216, s[8:11], s6 offen lds
  s_add_u32 s6, s6, 16
  s_add_u32 m0, s7, 68736
  s_nop 0
  buffer_load_dwordx4 v216, s[8:11], s6 offen lds
  s_add_u32 s6, s6, 16
  s_add_u32 m0, s7, 72832
  s_nop 0
  buffer_load_dwordx4 v216, s[8:11], s6 offen lds
  s_add_u32 s6, s6, 16
  s_mov_b32 s6, 2
L_kg_110:
  s_waitcnt lgkmcnt(0)
  ds_read_b128 v[12:15], v3 offset:16
  v_mfma_f32_16x16x32_f16 v[48:51], v[16:19], v[28:31], v[48:51]
  v_pk_mul_f32 v[38:39], v[8:9], v[6:7] op_sel:[0,1] op_sel_hi:[1,1]
  v_mfma_f32_16x16x32_f16 v[52:55], v[20:23], v[28:31], v[52:55]
  v_pk_mul_f32 v[32:33], v[8:9], v[4:5] op_sel:[0,0] op_sel_hi:[1,0]
  v_mfma_f32_16x16x32_f16 v[56:59], v[24:27], v[28:31], v[56:59]
  v_pk_mul_f32 v[34:35], v[8:9], v[4:5] op_sel:[0,1] op_sel_hi:[1,1]
  v_pk_mul_f32 v[36:37], v[8:9], v[6:7] op_sel:[0,0] op_sel_hi:[1,0]
  v_fract_f32 v39, v39
  v_fract_f32 v33, v33
  v_fract_f32 v35, v35
  v_fract_f32 v37, v37
  v_exp_f32 v38, v38
  v_cos_f32 v46, v39
  v_sin_f32 v47, v39
  v_exp_f32 v32, v32
  v_cos_f32 v40, v33
  v_sin_f32 v41, v33
  v_exp_f32 v34, v34
  v_cos_f32 v42, v35
  v_sin_f32 v43, v35
  v_exp_f32 v36, v36
  v_cos_f32 v44, v37
  v_sin_f32 v45, v37
  v_pk_mul_f32 v[46:47], v[46:47], v[38:39] op_sel_hi:[1,0]
  v_pk_mul_f32 v[40:41], v[40:41], v[32:33] op_sel_hi:[1,0]
  v_pk_mul_f32 v[42:43], v[42:43], v[34:35] op_sel_hi:[1,0]
  v_pk_mul_f32 v[44:45], v[44:45], v[36:37] op_sel_hi:[1,0]
  v_pk_mul_f32 v[32:33], v[46:47], v[10:11] op_sel_hi:[1,0] neg_hi:[1,0]
  v_cvt_pk_f16_f32 v16, v40, v41
  v_pk_fma_f32 v[32:33], v[46:47], v[10:11], v[32:33] op_sel:[1,1,0] op_sel_hi:[0,1,1] neg_lo:[1,0,0] neg_hi:[1,0,0]
  v_cvt_pk_f16_f32 v20, v42, v43
  v_cvt_pk_f16_f32 v24, v44, v45
  v_cvt_pk_f16_f32 v28, v32, v33
  s_waitcnt lgkmcnt(0)
  ds_read_b128 v[8:11], v3 offset:32
  v_pk_mul_f32 v[38:39], v[12:13], v[6:7] op_sel:[0,1] op_sel_hi:[1,1]
  v_pk_mul_f32 v[32:33], v[12:13], v[4:5] op_sel:[0,0] op_sel_hi:[1,0]
  v_pk_mul_f32 v[34:35], v[12:13], v[4:5] op_sel:[0,1] op_sel_hi:[1,1]
  v_pk_mul_f32 v[36:37], v[12:13], v[6:7] op_sel:[0,0] op_sel_hi:[1,0]
  v_fract_f32 v39, v39
  v_fract_f32 v33, v33
  v_fract_f32 v35, v35
  v_fract_f32 v37, v37
  v_exp_f32 v38, v38
  v_cos_f32 v46, v39
  v_sin_f32 v47, v39
  v_exp_f32 v32, v32
  v_cos_f32 v40, v33
  v_sin_f32 v41, v33
  v_exp_f32 v34, v34
  v_cos_f32 v42, v35
  v_sin_f32 v43, v35
  v_exp_f32 v36, v36
  v_cos_f32 v44, v37
  v_sin_f32 v45, v37
  v_pk_mul_f32 v[46:47], v[46:47], v[38:39] op_sel_hi:[1,0]
  v_pk_mul_f32 v[40:41], v[40:41], v[32:33] op_sel_hi:[1,0]
  v_pk_mul_f32 v[42:43], v[42:43], v[34:35] op_sel_hi:[1,0]
  v_pk_mul_f32 v[44:45], v[44:45], v[36:37] op_sel_hi:[1,0]
  v_pk_mul_f32 v[32:33], v[46:47], v[14:15] op_sel_hi:[1,0] neg_hi:[1,0]
  v_cvt_pk_f16_f32 v17, v40, v41
  v_pk_fma_f32 v[32:33], v[46:47], v[14:15], v[32:33] op_sel:[1,1,0] op_sel_hi:[0,1,1] neg_lo:[1,0,0] neg_hi:[1,0,0]
  v_cvt_pk_f16_f32 v21, v42, v43
  v_cvt_pk_f16_f32 v25, v44, v45
  v_cvt_pk_f16_f32 v29, v32, v33
  s_waitcnt lgkmcnt(0)
  ds_read_b128 v[12:15], v3 offset:48
  v_pk_mul_f32 v[38:39], v[8:9], v[6:7] op_sel:[0,1] op_sel_hi:[1,1]
  v_pk_mul_f32 v[32:33], v[8:9], v[4:5] op_sel:[0,0] op_sel_hi:[1,0]
  v_pk_mul_f32 v[34:35], v[8:9], v[4:5] op_sel:[0,1] op_sel_hi:[1,1]
  v_pk_mul_f32 v[36:37], v[8:9], v[6:7] op_sel:[0,0] op_sel_hi:[1,0]
  v_fract_f32 v39, v39
  v_fract_f32 v33, v33
  v_fract_f32 v35, v35
  v_fract_f32 v37, v37
  v_exp_f32 v38, v38
  v_cos_f32 v46, v39
  v_sin_f32 v47, v39
  v_exp_f32 v32, v32
  v_cos_f32 v40, v33
  v_sin_f32 v41, v33
  v_exp_f32 v34, v34
  v_cos_f32 v42, v35
  v_sin_f32 v43, v35
  v_exp_f32 v36, v36
  v_cos_f32 v44, v37
  v_sin_f32 v45, v37
  v_pk_mul_f32 v[46:47], v[46:47], v[38:39] op_sel_hi:[1,0]
  v_pk_mul_f32 v[40:41], v[40:41], v[32:33] op_sel_hi:[1,0]
  v_pk_mul_f32 v[42:43], v[42:43], v[34:35] op_sel_hi:[1,0]
  v_pk_mul_f32 v[44:45], v[44:45], v[36:37] op_sel_hi:[1,0]
  v_pk_mul_f32 v[32:33], v[46:47], v[10:11] op_sel_hi:[1,0] neg_hi:[1,0]
  v_cvt_pk_f16_f32 v18, v40, v41
  v_pk_fma_f32 v[32:33], v[46:47], v[10:11], v[32:33] op_sel:[1,1,0] op_sel_hi:[0,1,1] neg_lo:[1,0,0] neg_hi:[1,0,0]
  v_cvt_pk_f16_f32 v22, v42, v43
  v_cvt_pk_f16_f32 v26, v44, v45
  v_cvt_pk_f16_f32 v30, v32, v33
  s_waitcnt lgkmcnt(0)
  ds_read_b128 v[8:11], v3 offset:256
  v_pk_mul_f32 v[38:39], v[12:13], v[6:7] op_sel:[0,1] op_sel_hi:[1,1]
  v_pk_mul_f32 v[32:33], v[12:13], v[4:5] op_sel:[0,0] op_sel_hi:[1,0]
  v_pk_mul_f32 v[34:35], v[12:13], v[4:5] op_sel:[0,1] op_sel_hi:[1,1]
  v_pk_mul_f32 v[36:37], v[12:13], v[6:7] op_sel:[0,0] op_sel_hi:[1,0]
  v_fract_f32 v39, v39
  v_fract_f32 v33, v33
  v_fract_f32 v35, v35
  v_fract_f32 v37, v37
  v_exp_f32 v38, v38
  v_cos_f32 v46, v39
  v_sin_f32 v47, v39
  v_exp_f32 v32, v32
  v_cos_f32 v40, v33
  v_sin_f32 v41, v33
  v_exp_f32 v34, v34
  v_cos_f32 v42, v35
  v_sin_f32 v43, v35
  v_exp_f32 v36, v36
  v_cos_f32 v44, v37
  v_sin_f32 v45, v37
  v_pk_mul_f32 v[46:47], v[46:47], v[38:39] op_sel_hi:[1,0]
  v_pk_mul_f32 v[40:41], v[40:41], v[32:33] op_sel_hi:[1,0]
  v_pk_mul_f32 v[42:43], v[42:43], v[34:35] op_sel_hi:[1,0]
  v_pk_mul_f32 v[44:45], v[44:45], v[36:37] op_sel_hi:[1,0]
  v_pk_mul_f32 v[32:33], v[46:47], v[14:15] op_sel_hi:[1,0] neg_hi:[1,0]
  v_cvt_pk_f16_f32 v19, v40, v41
  v_pk_fma_f32 v[32:33], v[46:47], v[14:15], v[32:33] op_sel:[1,1,0] op_sel_hi:[0,1,1] neg_lo:[1,0,0] neg_hi:[1,0,0]
  v_cvt_pk_f16_f32 v23, v42, v43
  v_cvt_pk_f16_f32 v27, v44, v45
  v_cvt_pk_f16_f32 v31, v32, v33
  v_add_u32 v3, 256, v3
  s_sub_u32 s6, s6, 1
  s_cmp_lg_u32 s6, 0
  s_cbranch_scc1 L_kg_110
  v_mfma_f32_16x16x32_f16 v[48:51], v[16:19], v[28:31], v[48:51]
  v_mfma_f32_16x16x32_f16 v[52:55], v[20:23], v[28:31], v[52:55]
  v_mfma_f32_16x16x32_f16 v[56:59], v[24:27], v[28:31], v[56:59]
  s_waitcnt lgkmcnt(0)
  s_nop 4
  v_mul_f32 v48, v48, v233
  v_mul_f32 v49, v49, v233
  v_mul_f32 v50, v50, v233
  v_mul_f32 v51, v51, v233
  v_mul_f32 v52, v52, v233
  v_mul_f32 v53, v53, v233
  v_mul_f32 v54, v54, v233
  v_mul_f32 v55, v55, v233
  v_mul_f32 v56, v56, v233
  v_mul_f32 v57, v57, v233
  v_mul_f32 v58, v58, v233
  v_mul_f32 v59, v59, v233
  v_readlane_b32 s61, v52, 32
  v_lshrrev_b32 v16, 4, v0
  v_and_b32 v17, 15, v0
  v_lshlrev_b32 v17, 4, v17
  v_add_u32 v17, s63, v17
  v_lshrrev_b32 v18, 1, v16
  v_and_b32 v19, 1, v16
  v_lshlrev_b32 v20, 8, v18
  v_lshl_add_u32 v20, v19, 3, v20
  v_add3_u32 v20, v20, v17, 2
  v_lshlrev_b32 v21, 8, v19
  v_add_u32 v21, 516, v21
  v_cmp_eq_u32 vcc, 0, v18
  s_nop 1
  v_cndmask_b32 v21, 0, v21, vcc
  v_cndmask_b32 v22, 0, 4, vcc
  v_add_u32 v21, v21, v17
  v_lshlrev_b32 v23, 9, v19
  v_add_u32 v23, 1032, v23
  v_lshlrev_b32 v24, 10, v19
  v_add_u32 v24, 2064, v24
  v_cndmask_b32 v23, v24, v23, vcc
  v_add_u32 v23, v23, v17
  v_mov_b32 v24, 0x100
  v_cndmask_b32 v24, v24, 8, vcc
  v_mov_b32 v25, 0x200
  v_cndmask_b32 v25, v25, v24, vcc
  v_mov_b32 v26, 0x100
  v_cndmask_b32 v25, v25, v26, vcc
  v_cvt_pk_bf16_f32 v32, v48, v49
  v_cvt_pk_bf16_f32 v33, v50, v51
  v_cvt_pk_bf16_f32 v34, v52, v53
  v_cvt_pk_bf16_f32 v35, v54, v55
  v_cvt_pk_bf16_f32 v36, v56, v57
  v_cvt_pk_bf16_f32 v37, v58, v59
  ds_write_b16 v21, v34
  v_add_u32 v21, v21, v22
  ds_write_b16_d16_hi v21, v34
  v_add_u32 v21, v21, v22
  ds_write_b16 v21, v35
  v_add_u32 v21, v21, v22
  ds_write_b16_d16_hi v21, v35
  ds_write_b16 v20, v32 offset:0
  ds_write_b16_d16_hi v20, v32 offset:2
  ds_write_b16 v20, v33 offset:4
  ds_write_b16_d16_hi v20, v33 offset:6
  ds_write_b16 v23, v36
  v_add_u32 v26, v23, v24
  v_add_u32 v23, v23, v25
  ds_write_b16_d16_hi v26, v36
  ds_write_b16 v23, v37
  v_add_u32 v23, v23, v24
  ds_write_b16_d16_hi v23, v37
  ds_read_u16 v160, v160
  ds_read_u16 v161, v161
  ds_read_u16 v162, v162
  ds_read_u16 v163, v163
  ds_read_u16 v164, v164
  ds_read_u16 v165, v165
  ds_read_u16 v166, v166
  ds_read_u16 v167, v167
  ds_read_u16 v168, v168
  ds_read_u16 v169, v169
  ds_read_u16 v170, v170
  ds_read_u16 v171, v171
  ds_read_u16 v172, v172
  ds_read_u16 v173, v173
  ds_read_u16 v174, v174
  ds_read_u16 v175, v175
  ds_read_u16 v176, v176
  ds_read_u16 v177, v177
  ds_read_u16 v178, v178
  ds_read_u16 v179, v179
  ds_read_u16 v180, v180
  ds_read_u16 v181, v181
  ds_read_u16 v182, v182
  ds_read_u16 v183, v183
  ds_read_u16 v184, v184
  ds_read_u16 v185, v185
  ds_read_u16 v186, v186
  ds_read_u16 v187, v187
  ds_read_u16 v188, v188
  ds_read_u16 v189, v189
  ds_read_u16 v190, v190
  ds_read_u16 v191, v191
  s_mul_i32 s6, s3, 4608
  s_add_u32 s6, s6, 25600
  v_add_u32 v16, s6, v2
  s_mul_i32 s7, s60, 4608
  s_add_u32 s7, s7, 0x400000
  v_mov_b32 v21, 0
  v_mov_b32 v22, 0
  v_mov_b32 v23, 0
  v_mov_b32 v20, s61
  v_cmp_eq_u32 vcc, 30, v0
  s_nop 1
  v_cndmask_b32 v20, 0, v20, vcc
  s_mul_i32 s62, s3, 4128
  s_add_u32 s62, s62, 44032
  v_and_b32 v24, 16, v2
  v_add_u32 v24, s62, v24
  v_mov_b32 v28, 0
  v_mov_b32 v29, 0
  v_mov_b32 v30, 0
  v_mov_b32 v31, 0
  s_waitcnt lgkmcnt(15)
  v_lshl_or_b32 v160, v161, 16, v160
  v_lshl_or_b32 v161, v163, 16, v162
  v_lshl_or_b32 v162, v165, 16, v164
  v_lshl_or_b32 v163, v167, 16, v166
  ds_write_b128 v16, v[160:163] offset:0
  buffer_store_dwordx4 v[160:163], v2, s[8:11], s7 offen offset:0 sc1
  s_waitcnt lgkmcnt(15)
  s_waitcnt lgkmcnt(15)
  v_lshl_or_b32 v168, v169, 16, v168
  v_lshl_or_b32 v169, v171, 16, v170
  v_lshl_or_b32 v170, v173, 16, v172
  v_lshl_or_b32 v171, v175, 16, v174
  ds_write_b128 v16, v[168:171] offset:1024
  buffer_store_dwordx4 v[168:171], v2, s[8:11], s7 offen offset:1024 sc1
  s_waitcnt lgkmcnt(10)
  v_lshl_or_b32 v176, v177, 16, v176
  v_lshl_or_b32 v177, v179, 16, v178
  v_lshl_or_b32 v178, v181, 16, v180
  v_lshl_or_b32 v179, v183, 16, v182
  ds_write_b128 v16, v[176:179] offset:2048
  buffer_store_dwordx4 v[176:179], v2, s[8:11], s7 offen offset:2048 sc1
  s_waitcnt lgkmcnt(3)
  v_lshl_or_b32 v184, v185, 16, v184
  v_lshl_or_b32 v185, v187, 16, v186
  v_lshl_or_b32 v186, v189, 16, v188
  v_lshl_or_b32 v187, v191, 16, v190
  ds_write_b128 v16, v[184:187] offset:3072
  buffer_store_dwordx4 v[184:187], v2, s[8:11], s7 offen offset:3072 sc1
  s_add_u32 s7, s7, 4096
  ds_write_b128 v24, v[28:31]
  s_mov_b32 exec_hi, 0
  ds_write_b128 v16, v[20:23] offset:4096
  buffer_store_dwordx4 v[20:23], v2, s[8:11], s7 offen sc1
  s_mov_b32 exec_hi, -1
  v_and_b32 v16, 15, v0
  v_lshrrev_b32 v17, 4, v0
  v_lshlrev_b32 v18, 5, v16
  s_add_u32 s6, s6, 480
  v_sub_u32 v18, s6, v18
  v_lshl_add_u32 v4, v17, 4, v18
  v_lshlrev_b32 v18, 1, v16
  v_lshl_add_u32 v18, v17, 4, v18
  v_and_b32 v6, 2, v18
  v_and_b32 v18, -4, v18
  v_add_u32 v5, s62, v18
  v_lshlrev_b32 v18, 5, v16
  v_lshl_add_u32 v18, v17, 3, v18
  v_add3_u32 v7, v18, s62, 32
  s_lshl_b32 s7, s3, 12
  s_add_u32 s7, s7, 60544
  v_add_u32 v8, s7, v18
  v_lshrrev_b32 v18, 1, v16
  v_lshlrev_b32 v18, 15, v18
  v_and_b32 v19, 1, v16
  v_lshl_or_b32 v18, v19, 5, v18
  v_lshl_or_b32 v9, v17, 3, v18
  v_lshlrev_b32 v31, 16, v232
  v_add_u32 v60, 1024, v5
  v_add_u32 v61, 2048, v5
  v_add_u32 v62, 3072, v5
  s_lshl_b32 s62, s60, 6
  s_add_u32 s62, s62, 0x0
  s_waitcnt vmcnt(5) lgkmcnt(0)
  s_barrier
  ds_read_b128 a[32:35], v4 offset:4032
  ds_read_b128 a[36:39], v4 offset:3968
  ds_read_b128 a[40:43], v4 offset:3904
  ds_read2_b32 v[10:11], v5 offset0:112 offset1:113
  ds_read2_b32 v[12:13], v5 offset0:114 offset1:115
  ds_read_b32 v14, v5 offset:464
  ds_read2_b32 v[16:17], v5 offset0:96 offset1:97
  ds_read2_b32 v[18:19], v5 offset0:98 offset1:99
  ds_read_b32 v20, v5 offset:400
  ds_read2_b32 v[32:33], v5 offset0:80 offset1:81
  ds_read2_b32 v[34:35], v5 offset0:82 offset1:83
  ds_read_b32 v36, v5 offset:336
  ds_read2_b32 v[38:39], v5 offset0:64 offset1:65
  ds_read2_b32 v[40:41], v5 offset0:66 offset1:67
  ds_read_b32 v42, v5 offset:272
  ds_read2_b32 v[44:45], v5 offset0:48 offset1:49
  ds_read2_b32 v[46:47], v5 offset0:50 offset1:51
  ds_read_b32 v48, v5 offset:208
  s_waitcnt lgkmcnt(12)
  v_alignbyte_b32 v92, v11, v10, v6
  v_alignbyte_b32 v93, v12, v11, v6
  v_alignbyte_b32 v94, v13, v12, v6
  v_alignbyte_b32 v95, v14, v13, v6
  s_waitcnt lgkmcnt(9)
  v_alignbyte_b32 v88, v17, v16, v6
  v_alignbyte_b32 v89, v18, v17, v6
  v_alignbyte_b32 v90, v19, v18, v6
  v_alignbyte_b32 v91, v20, v19, v6
  v_mfma_f32_16x16x32_bf16 a[0:3], v[92:95], a[32:35], 0
  ds_read2_b32 v[10:11], v5 offset0:32 offset1:33
  ds_read2_b32 v[12:13], v5 offset0:34 offset1:35
  ds_read_b32 v14, v5 offset:144
  ds_read_b128 a[44:47], v4 offset:3840
  s_waitcnt lgkmcnt(10)
  v_alignbyte_b32 v84, v33, v32, v6
  v_alignbyte_b32 v85, v34, v33, v6
  v_alignbyte_b32 v86, v35, v34, v6
  v_alignbyte_b32 v87, v36, v35, v6
  v_mfma_f32_16x16x32_bf16 a[0:3], v[88:91], a[36:39], a[0:3]
  ds_read2_b32 v[16:17], v5 offset0:16 offset1:17
  ds_read2_b32 v[18:19], v5 offset0:18 offset1:19
  ds_read_b32 v20, v5 offset:80
  ds_read_b128 a[32:35], v4 offset:3776
  s_waitcnt lgkmcnt(11)
  v_alignbyte_b32 v80, v39, v38, v6
  v_alignbyte_b32 v81, v40, v39, v6
  v_alignbyte_b32 v82, v41, v40, v6
  v_alignbyte_b32 v83, v42, v41, v6
  v_mfma_f32_16x16x32_bf16 a[0:3], v[84:87], a[40:43], a[0:3]
  ds_read2_b32 v[32:33], v5 offset0:0 offset1:1
  ds_read2_b32 v[34:35], v5 offset0:2 offset1:3
  ds_read_b32 v36, v5 offset:16
  ds_read_b128 a[36:39], v4 offset:3712
  s_waitcnt lgkmcnt(12)
  v_alignbyte_b32 v76, v45, v44, v6
  v_alignbyte_b32 v77, v46, v45, v6
  v_alignbyte_b32 v78, v47, v46, v6
  v_alignbyte_b32 v79, v48, v47, v6
  s_waitcnt lgkmcnt(8)
  v_mfma_f32_16x16x32_bf16 a[0:3], v[80:83], a[44:47], a[0:3]
  ds_read2_b32 v[38:39], v62 offset0:240 offset1:241
  ds_read2_b32 v[40:41], v62 offset0:242 offset1:243
  ds_read_b32 v42, v62 offset:976
  ds_read_b128 a[40:43], v4 offset:3648
  v_alignbyte_b32 v72, v11, v10, v6
  v_alignbyte_b32 v73, v12, v11, v6
  v_alignbyte_b32 v74, v13, v12, v6
  v_alignbyte_b32 v75, v14, v13, v6
  s_waitcnt lgkmcnt(8)
  v_mfma_f32_16x16x32_bf16 a[0:3], v[76:79], a[32:35], a[0:3]
  ds_read2_b32 v[44:45], v62 offset0:112 offset1:113
  ds_read2_b32 v[46:47], v62 offset0:114 offset1:115
  ds_read_b32 v48, v62 offset:464
  ds_read_b128 a[44:47], v4 offset:3584
  v_alignbyte_b32 v68, v17, v16, v6
  v_alignbyte_b32 v69, v18, v17, v6
  v_alignbyte_b32 v70, v19, v18, v6
  v_alignbyte_b32 v71, v20, v19, v6
  s_waitcnt lgkmcnt(8)
  v_mfma_f32_16x16x32_bf16 a[0:3], v[72:75], a[36:39], a[0:3]
  ds_read2_b32 v[10:11], v61 offset0:240 offset1:241
  ds_read2_b32 v[12:13], v61 offset0:242 offset1:243
  ds_read_b32 v14, v61 offset:976
  ds_read_b128 a[32:35], v4 offset:4032
  v_alignbyte_b32 v64, v33, v32, v6
  v_alignbyte_b32 v65, v34, v33, v6
  v_alignbyte_b32 v66, v35, v34, v6
  v_alignbyte_b32 v67, v36, v35, v6
  s_waitcnt lgkmcnt(8)
  v_mfma_f32_16x16x32_bf16 a[0:3], v[68:71], a[40:43], a[0:3]
  ds_read2_b32 v[16:17], v61 offset0:112 offset1:113
  ds_read2_b32 v[18:19], v61 offset0:114 offset1:115
  ds_read_b32 v20, v61 offset:464
  ds_read_b128 a[36:39], v4 offset:3968
  v_alignbyte_b32 v26, v39, v38, v6
  v_alignbyte_b32 v27, v40, v39, v6
  v_alignbyte_b32 v28, v41, v40, v6
  v_alignbyte_b32 v29, v42, v41, v6
  s_waitcnt lgkmcnt(8)
  v_mfma_f32_16x16x32_bf16 a[0:3], v[64:67], a[44:47], a[0:3]
  ds_read2_b32 v[32:33], v60 offset0:240 offset1:241
  ds_read2_b32 v[34:35], v60 offset0:242 offset1:243
  ds_read_b32 v36, v60 offset:976
  ds_read_b128 a[40:43], v4 offset:3904
  v_alignbyte_b32 v56, v45, v44, v6
  v_alignbyte_b32 v57, v46, v45, v6
  v_alignbyte_b32 v58, v47, v46, v6
  v_alignbyte_b32 v59, v48, v47, v6
  v_accvgpr_write_b32 a92, v56
  v_accvgpr_write_b32 a93, v57
  v_accvgpr_write_b32 a94, v58
  v_accvgpr_write_b32 a95, v59
  s_waitcnt lgkmcnt(8)
  v_mfma_f32_16x16x32_bf16 a[28:31], v[26:29], a[32:35], 0
  ds_read2_b32 v[38:39], v60 offset0:112 offset1:113
  ds_read2_b32 v[40:41], v60 offset0:114 offset1:115
  ds_read_b32 v42, v60 offset:464
  ds_read_b128 a[44:47], v4 offset:3840
  ds_read_b64 v[224:225], v7 offset:0
  ds_read_b64 v[226:227], v8 offset:0
  v_accvgpr_read_b32 v96, a0
  v_accvgpr_read_b32 v97, a1
  v_accvgpr_read_b32 v98, a2
  v_accvgpr_read_b32 v99, a3
  s_waitcnt lgkmcnt(0)
  v_lshlrev_b32 v128, 16, v224
  v_and_b32 v129, 0xffff0000, v224
  v_lshlrev_b32 v130, 16, v225
  v_and_b32 v131, 0xffff0000, v225
  v_lshlrev_b32 v192, 16, v226
  v_and_b32 v193, 0xffff0000, v226
  v_lshlrev_b32 v194, 16, v227
  v_and_b32 v195, 0xffff0000, v227
  v_mul_f32 v160, v128, v31
  v_mul_f32 v161, v129, v31
  v_mul_f32 v162, v130, v31
  v_mul_f32 v163, v131, v31
  v_fmac_f32 v96, s61, v128
  v_fmac_f32 v97, s61, v129
  v_fmac_f32 v98, s61, v130
  v_fmac_f32 v99, s61, v131
  v_cvt_pk_bf16_f32 v224, v160, v161
  v_cvt_pk_bf16_f32 v225, v162, v163
  v_lshlrev_b32 v160, 16, v224
  v_and_b32 v161, 0xffff0000, v224
  v_lshlrev_b32 v162, 16, v225
  v_and_b32 v163, 0xffff0000, v225
  v_cvt_pk_bf16_f32 v224, v96, v97
  v_cvt_pk_bf16_f32 v225, v98, v99
  v_lshlrev_b32 v96, 16, v224
  v_and_b32 v97, 0xffff0000, v224
  v_lshlrev_b32 v98, 16, v225
  v_and_b32 v99, 0xffff0000, v225
  v_add_f32 v96, v96, v160
  v_add_f32 v97, v97, v161
  v_add_f32 v98, v98, v162
  v_add_f32 v99, v99, v163
  v_cvt_pk_bf16_f32 v224, v96, v97
  v_cvt_pk_bf16_f32 v225, v98, v99
  v_lshlrev_b32 v96, 16, v224
  v_and_b32 v97, 0xffff0000, v224
  v_lshlrev_b32 v98, 16, v225
  v_and_b32 v99, 0xffff0000, v225
  v_add_f32 v96, v96, v192
  v_add_f32 v97, v97, v193
  v_add_f32 v98, v98, v194
  v_add_f32 v99, v99, v195
  v_cvt_pk_bf16_f32 v224, v96, v97
  v_cvt_pk_bf16_f32 v225, v98, v99
  s_add_u32 s6, s62, 0
  buffer_store_dwordx2 v[224:225], v9, s[8:11], s6 offen sc1
  v_alignbyte_b32 v252, v11, v10, v6
  v_alignbyte_b32 v253, v12, v11, v6
  v_alignbyte_b32 v254, v13, v12, v6
  v_alignbyte_b32 v255, v14, v13, v6
  v_mfma_f32_16x16x32_bf16 a[24:27], a[92:95], a[32:35], 0
  ds_read2_b32 v[44:45], v5 offset0:240 offset1:241
  ds_read2_b32 v[46:47], v5 offset0:242 offset1:243
  ds_read_b32 v48, v5 offset:976
  v_alignbyte_b32 v220, v17, v16, v6
  v_alignbyte_b32 v221, v18, v17, v6
  v_alignbyte_b32 v222, v19, v18, v6
  v_alignbyte_b32 v223, v20, v19, v6
  v_mfma_f32_16x16x32_bf16 a[20:23], v[252:255], a[32:35], 0
  ds_read2_b32 v[10:11], v62 offset0:224 offset1:225
  ds_read2_b32 v[12:13], v62 offset0:226 offset1:227
  ds_read_b32 v14, v62 offset:912
  v_alignbyte_b32 v188, v33, v32, v6
  v_alignbyte_b32 v189, v34, v33, v6
  v_alignbyte_b32 v190, v35, v34, v6
  v_alignbyte_b32 v191, v36, v35, v6
  v_mfma_f32_16x16x32_bf16 a[16:19], v[220:223], a[32:35], 0
  ds_read2_b32 v[16:17], v62 offset0:96 offset1:97
  ds_read2_b32 v[18:19], v62 offset0:98 offset1:99
  ds_read_b32 v20, v62 offset:400
  v_alignbyte_b32 v156, v39, v38, v6
  v_alignbyte_b32 v157, v40, v39, v6
  v_alignbyte_b32 v158, v41, v40, v6
  v_alignbyte_b32 v159, v42, v41, v6
  v_mfma_f32_16x16x32_bf16 a[12:15], v[188:191], a[32:35], 0
  ds_read2_b32 v[32:33], v61 offset0:224 offset1:225
  ds_read2_b32 v[34:35], v61 offset0:226 offset1:227
  ds_read_b32 v36, v61 offset:912
  s_waitcnt lgkmcnt(9)
  v_alignbyte_b32 v124, v45, v44, v6
  v_alignbyte_b32 v125, v46, v45, v6
  v_alignbyte_b32 v126, v47, v46, v6
  v_alignbyte_b32 v127, v48, v47, v6
  v_mfma_f32_16x16x32_bf16 a[8:11], v[156:159], a[32:35], 0
  ds_read2_b32 v[38:39], v61 offset0:96 offset1:97
  ds_read2_b32 v[40:41], v61 offset0:98 offset1:99
  ds_read_b32 v42, v61 offset:400
  s_waitcnt lgkmcnt(9)
  v_alignbyte_b32 v22, v11, v10, v6
  v_alignbyte_b32 v23, v12, v11, v6
  v_alignbyte_b32 v24, v13, v12, v6
  v_alignbyte_b32 v25, v14, v13, v6
  v_mfma_f32_16x16x32_bf16 a[4:7], v[124:127], a[32:35], 0
  ds_read2_b32 v[44:45], v60 offset0:224 offset1:225
  ds_read2_b32 v[46:47], v60 offset0:226 offset1:227
  ds_read_b32 v48, v60 offset:912
  s_waitcnt lgkmcnt(9)
  v_alignbyte_b32 v56, v17, v16, v6
  v_alignbyte_b32 v57, v18, v17, v6
  v_alignbyte_b32 v58, v19, v18, v6
  v_alignbyte_b32 v59, v20, v19, v6
  v_accvgpr_write_b32 a88, v56
  v_accvgpr_write_b32 a89, v57
  v_accvgpr_write_b32 a90, v58
  v_accvgpr_write_b32 a91, v59
  v_mfma_f32_16x16x32_bf16 a[28:31], v[22:25], a[36:39], a[28:31]
  ds_read2_b32 v[10:11], v60 offset0:96 offset1:97
  ds_read2_b32 v[12:13], v60 offset0:98 offset1:99
  ds_read_b32 v14, v60 offset:400
  ds_read_b128 a[32:35], v4 offset:3776
  s_waitcnt lgkmcnt(10)
  v_alignbyte_b32 v248, v33, v32, v6
  v_alignbyte_b32 v249, v34, v33, v6
  v_alignbyte_b32 v250, v35, v34, v6
  v_alignbyte_b32 v251, v36, v35, v6
  v_mfma_f32_16x16x32_bf16 a[24:27], a[88:91], a[36:39], a[24:27]
  ds_read2_b32 v[16:17], v5 offset0:224 offset1:225
  ds_read2_b32 v[18:19], v5 offset0:226 offset1:227
  ds_read_b32 v20, v5 offset:912
  s_waitcnt lgkmcnt(10)
  v_alignbyte_b32 v216, v39, v38, v6
  v_alignbyte_b32 v217, v40, v39, v6
  v_alignbyte_b32 v218, v41, v40, v6
  v_alignbyte_b32 v219, v42, v41, v6
  v_mfma_f32_16x16x32_bf16 a[20:23], v[248:251], a[36:39], a[20:23]
  ds_read2_b32 v[32:33], v62 offset0:208 offset1:209
  ds_read2_b32 v[34:35], v62 offset0:210 offset1:211
  ds_read_b32 v36, v62 offset:848
  s_waitcnt lgkmcnt(10)
  v_alignbyte_b32 v184, v45, v44, v6
  v_alignbyte_b32 v185, v46, v45, v6
  v_alignbyte_b32 v186, v47, v46, v6
  v_alignbyte_b32 v187, v48, v47, v6
  v_mfma_f32_16x16x32_bf16 a[16:19], v[216:219], a[36:39], a[16:19]
  ds_read2_b32 v[38:39], v62 offset0:80 offset1:81
  ds_read2_b32 v[40:41], v62 offset0:82 offset1:83
  ds_read_b32 v42, v62 offset:336
  s_waitcnt lgkmcnt(10)
  v_alignbyte_b32 v152, v11, v10, v6
  v_alignbyte_b32 v153, v12, v11, v6
  v_alignbyte_b32 v154, v13, v12, v6
  v_alignbyte_b32 v155, v14, v13, v6
  v_mfma_f32_16x16x32_bf16 a[12:15], v[184:187], a[36:39], a[12:15]
  ds_read2_b32 v[44:45], v61 offset0:208 offset1:209
  ds_read2_b32 v[46:47], v61 offset0:210 offset1:211
  ds_read_b32 v48, v61 offset:848
  s_waitcnt lgkmcnt(9)
  v_alignbyte_b32 v120, v17, v16, v6
  v_alignbyte_b32 v121, v18, v17, v6
  v_alignbyte_b32 v122, v19, v18, v6
  v_alignbyte_b32 v123, v20, v19, v6
  v_mfma_f32_16x16x32_bf16 a[8:11], v[152:155], a[36:39], a[8:11]
  ds_read2_b32 v[10:11], v61 offset0:80 offset1:81
  ds_read2_b32 v[12:13], v61 offset0:82 offset1:83
  ds_read_b32 v14, v61 offset:336
  s_waitcnt lgkmcnt(9)
  v_alignbyte_b32 v26, v33, v32, v6
  v_alignbyte_b32 v27, v34, v33, v6
  v_alignbyte_b32 v28, v35, v34, v6
  v_alignbyte_b32 v29, v36, v35, v6
  v_mfma_f32_16x16x32_bf16 a[4:7], v[120:123], a[36:39], a[4:7]
  ds_read2_b32 v[16:17], v60 offset0:208 offset1:209
  ds_read2_b32 v[18:19], v60 offset0:210 offset1:211
  ds_read_b32 v20, v60 offset:848
  s_waitcnt lgkmcnt(9)
  v_alignbyte_b32 v56, v39, v38, v6
  v_alignbyte_b32 v57, v40, v39, v6
  v_alignbyte_b32 v58, v41, v40, v6
  v_alignbyte_b32 v59, v42, v41, v6
  v_accvgpr_write_b32 a84, v56
  v_accvgpr_write_b32 a85, v57
  v_accvgpr_write_b32 a86, v58
  v_accvgpr_write_b32 a87, v59
  v_mfma_f32_16x16x32_bf16 a[28:31], v[26:29], a[40:43], a[28:31]
  ds_read2_b32 v[32:33], v60 offset0:80 offset1:81
  ds_read2_b32 v[34:35], v60 offset0:82 offset1:83
  ds_read_b32 v36, v60 offset:336
  ds_read_b128 a[36:39], v4 offset:3712
  s_lshl_b32 s6, s60, 2
  s_add_u32 s6, s6, 0x710000
  v_mov_b32 v226, 8
  s_waitcnt vmcnt(0)
  s_mov_b64 exec, 1
  buffer_store_dword v226, v1, s[8:11], s6 offen sc1
  s_mov_b64 exec, -1
  s_waitcnt lgkmcnt(10)
  v_alignbyte_b32 v244, v45, v44, v6
  v_alignbyte_b32 v245, v46, v45, v6
  v_alignbyte_b32 v246, v47, v46, v6
  v_alignbyte_b32 v247, v48, v47, v6
  v_mfma_f32_16x16x32_bf16 a[24:27], a[84:87], a[40:43], a[24:27]
  ds_read2_b32 v[38:39], v5 offset0:208 offset1:209
  ds_read2_b32 v[40:41], v5 offset0:210 offset1:211
  ds_read_b32 v42, v5 offset:848
  s_waitcnt lgkmcnt(10)
  v_alignbyte_b32 v212, v11, v10, v6
  v_alignbyte_b32 v213, v12, v11, v6
  v_alignbyte_b32 v214, v13, v12, v6
  v_alignbyte_b32 v215, v14, v13, v6
  v_mfma_f32_16x16x32_bf16 a[20:23], v[244:247], a[40:43], a[20:23]
  ds_read2_b32 v[44:45], v62 offset0:192 offset1:193
  ds_read2_b32 v[46:47], v62 offset0:194 offset1:195
  ds_read_b32 v48, v62 offset:784
  s_waitcnt lgkmcnt(10)
  v_alignbyte_b32 v180, v17, v16, v6
  v_alignbyte_b32 v181, v18, v17, v6
  v_alignbyte_b32 v182, v19, v18, v6
  v_alignbyte_b32 v183, v20, v19, v6
  v_mfma_f32_16x16x32_bf16 a[16:19], v[212:215], a[40:43], a[16:19]
  ds_read2_b32 v[10:11], v62 offset0:64 offset1:65
  ds_read2_b32 v[12:13], v62 offset0:66 offset1:67
  ds_read_b32 v14, v62 offset:272
  s_waitcnt lgkmcnt(10)
  v_alignbyte_b32 v148, v33, v32, v6
  v_alignbyte_b32 v149, v34, v33, v6
  v_alignbyte_b32 v150, v35, v34, v6
  v_alignbyte_b32 v151, v36, v35, v6
  v_mfma_f32_16x16x32_bf16 a[12:15], v[180:183], a[40:43], a[12:15]
  ds_read2_b32 v[16:17], v61 offset0:192 offset1:193
  ds_read2_b32 v[18:19], v61 offset0:194 offset1:195
  ds_read_b32 v20, v61 offset:784
  s_waitcnt lgkmcnt(9)
  v_alignbyte_b32 v116, v39, v38, v6
  v_alignbyte_b32 v117, v40, v39, v6
  v_alignbyte_b32 v118, v41, v40, v6
  v_alignbyte_b32 v119, v42, v41, v6
  v_mfma_f32_16x16x32_bf16 a[8:11], v[148:151], a[40:43], a[8:11]
  ds_read2_b32 v[32:33], v61 offset0:64 offset1:65
  ds_read2_b32 v[34:35], v61 offset0:66 offset1:67
  ds_read_b32 v36, v61 offset:272
  s_waitcnt lgkmcnt(9)
  v_alignbyte_b32 v22, v45, v44, v6
  v_alignbyte_b32 v23, v46, v45, v6
  v_alignbyte_b32 v24, v47, v46, v6
  v_alignbyte_b32 v25, v48, v47, v6
  v_mfma_f32_16x16x32_bf16 a[4:7], v[116:119], a[40:43], a[4:7]
  ds_read2_b32 v[38:39], v60 offset0:192 offset1:193
  ds_read2_b32 v[40:41], v60 offset0:194 offset1:195
  ds_read_b32 v42, v60 offset:784
  s_waitcnt lgkmcnt(9)
  v_alignbyte_b32 v56, v11, v10, v6
  v_alignbyte_b32 v57, v12, v11, v6
  v_alignbyte_b32 v58, v13, v12, v6
  v_alignbyte_b32 v59, v14, v13, v6
  v_accvgpr_write_b32 a80, v56
  v_accvgpr_write_b32 a81, v57
  v_accvgpr_write_b32 a82, v58
  v_accvgpr_write_b32 a83, v59
  v_mfma_f32_16x16x32_bf16 a[28:31], v[22:25], a[44:47], a[28:31]
  ds_read2_b32 v[44:45], v60 offset0:64 offset1:65
  ds_read2_b32 v[46:47], v60 offset0:66 offset1:67
  ds_read_b32 v48, v60 offset:272
  ds_read_b128 a[40:43], v4 offset:3648
  s_waitcnt lgkmcnt(10)
  v_alignbyte_b32 v240, v17, v16, v6
  v_alignbyte_b32 v241, v18, v17, v6
  v_alignbyte_b32 v242, v19, v18, v6
  v_alignbyte_b32 v243, v20, v19, v6
  v_mfma_f32_16x16x32_bf16 a[24:27], a[80:83], a[44:47], a[24:27]
  ds_read2_b32 v[10:11], v5 offset0:192 offset1:193
  ds_read2_b32 v[12:13], v5 offset0:194 offset1:195
  ds_read_b32 v14, v5 offset:784
  s_waitcnt lgkmcnt(10)
  v_alignbyte_b32 v208, v33, v32, v6
  v_alignbyte_b32 v209, v34, v33, v6
  v_alignbyte_b32 v210, v35, v34, v6
  v_alignbyte_b32 v211, v36, v35, v6
  v_mfma_f32_16x16x32_bf16 a[20:23], v[240:243], a[44:47], a[20:23]
  ds_read2_b32 v[16:17], v62 offset0:176 offset1:177
  ds_read2_b32 v[18:19], v62 offset0:178 offset1:179
  ds_read_b32 v20, v62 offset:720
  s_waitcnt lgkmcnt(10)
  v_alignbyte_b32 v176, v39, v38, v6
  v_alignbyte_b32 v177, v40, v39, v6
  v_alignbyte_b32 v178, v41, v40, v6
  v_alignbyte_b32 v179, v42, v41, v6
  v_mfma_f32_16x16x32_bf16 a[16:19], v[208:211], a[44:47], a[16:19]
  ds_read2_b32 v[32:33], v62 offset0:48 offset1:49
  ds_read2_b32 v[34:35], v62 offset0:50 offset1:51
  ds_read_b32 v36, v62 offset:208
  s_waitcnt lgkmcnt(10)
  v_alignbyte_b32 v144, v45, v44, v6
  v_alignbyte_b32 v145, v46, v45, v6
  v_alignbyte_b32 v146, v47, v46, v6
  v_alignbyte_b32 v147, v48, v47, v6
  v_mfma_f32_16x16x32_bf16 a[12:15], v[176:179], a[44:47], a[12:15]
  ds_read2_b32 v[38:39], v61 offset0:176 offset1:177
  ds_read2_b32 v[40:41], v61 offset0:178 offset1:179
  ds_read_b32 v42, v61 offset:720
  s_waitcnt lgkmcnt(9)
  v_alignbyte_b32 v112, v11, v10, v6
  v_alignbyte_b32 v113, v12, v11, v6
  v_alignbyte_b32 v114, v13, v12, v6
  v_alignbyte_b32 v115, v14, v13, v6
  v_mfma_f32_16x16x32_bf16 a[8:11], v[144:147], a[44:47], a[8:11]
  ds_read2_b32 v[44:45], v61 offset0:48 offset1:49
  ds_read2_b32 v[46:47], v61 offset0:50 offset1:51
  ds_read_b32 v48, v61 offset:208
  s_waitcnt lgkmcnt(9)
  v_alignbyte_b32 v26, v17, v16, v6
  v_alignbyte_b32 v27, v18, v17, v6
  v_alignbyte_b32 v28, v19, v18, v6
  v_alignbyte_b32 v29, v20, v19, v6
  v_mfma_f32_16x16x32_bf16 a[4:7], v[112:115], a[44:47], a[4:7]
  ds_read2_b32 v[10:11], v60 offset0:176 offset1:177
  ds_read2_b32 v[12:13], v60 offset0:178 offset1:179
  ds_read_b32 v14, v60 offset:720
  s_waitcnt lgkmcnt(9)
  v_alignbyte_b32 v56, v33, v32, v6
  v_alignbyte_b32 v57, v34, v33, v6
  v_alignbyte_b32 v58, v35, v34, v6
  v_alignbyte_b32 v59, v36, v35, v6
  v_accvgpr_write_b32 a76, v56
  v_accvgpr_write_b32 a77, v57
  v_accvgpr_write_b32 a78, v58
  v_accvgpr_write_b32 a79, v59
  v_mfma_f32_16x16x32_bf16 a[28:31], v[26:29], a[32:35], a[28:31]
  ds_read2_b32 v[16:17], v60 offset0:48 offset1:49
  ds_read2_b32 v[18:19], v60 offset0:50 offset1:51
  ds_read_b32 v20, v60 offset:208
  ds_read_b128 a[44:47], v4 offset:3584
  s_waitcnt lgkmcnt(10)
  v_alignbyte_b32 v236, v39, v38, v6
  v_alignbyte_b32 v237, v40, v39, v6
  v_alignbyte_b32 v238, v41, v40, v6
  v_alignbyte_b32 v239, v42, v41, v6
  v_mfma_f32_16x16x32_bf16 a[24:27], a[76:79], a[32:35], a[24:27]
  ds_read2_b32 v[32:33], v5 offset0:176 offset1:177
  ds_read2_b32 v[34:35], v5 offset0:178 offset1:179
  ds_read_b32 v36, v5 offset:720
  s_waitcnt lgkmcnt(10)
  v_alignbyte_b32 v204, v45, v44, v6
  v_alignbyte_b32 v205, v46, v45, v6
  v_alignbyte_b32 v206, v47, v46, v6
  v_alignbyte_b32 v207, v48, v47, v6
  v_mfma_f32_16x16x32_bf16 a[20:23], v[236:239], a[32:35], a[20:23]
  ds_read2_b32 v[38:39], v62 offset0:160 offset1:161
  ds_read2_b32 v[40:41], v62 offset0:162 offset1:163
  ds_read_b32 v42, v62 offset:656
  s_waitcnt lgkmcnt(10)
  v_alignbyte_b32 v172, v11, v10, v6
  v_alignbyte_b32 v173, v12, v11, v6
  v_alignbyte_b32 v174, v13, v12, v6
  v_alignbyte_b32 v175, v14, v13, v6
  v_mfma_f32_16x16x32_bf16 a[16:19], v[204:207], a[32:35], a[16:19]
  ds_read2_b32 v[44:45], v62 offset0:32 offset1:33
  ds_read2_b32 v[46:47], v62 offset0:34 offset1:35
  ds_read_b32 v48, v62 offset:144
  s_waitcnt lgkmcnt(10)
  v_alignbyte_b32 v140, v17, v16, v6
  v_alignbyte_b32 v141, v18, v17, v6
  v_alignbyte_b32 v142, v19, v18, v6
  v_alignbyte_b32 v143, v20, v19, v6
  v_mfma_f32_16x16x32_bf16 a[12:15], v[172:175], a[32:35], a[12:15]
  ds_read2_b32 v[10:11], v61 offset0:160 offset1:161
  ds_read2_b32 v[12:13], v61 offset0:162 offset1:163
  ds_read_b32 v14, v61 offset:656
  s_waitcnt lgkmcnt(9)
  v_alignbyte_b32 v108, v33, v32, v6
  v_alignbyte_b32 v109, v34, v33, v6
  v_alignbyte_b32 v110, v35, v34, v6
  v_alignbyte_b32 v111, v36, v35, v6
  v_mfma_f32_16x16x32_bf16 a[8:11], v[140:143], a[32:35], a[8:11]
  ds_read2_b32 v[16:17], v61 offset0:32 offset1:33
  ds_read2_b32 v[18:19], v61 offset0:34 offset1:35
  ds_read_b32 v20, v61 offset:144
  s_waitcnt lgkmcnt(9)
  v_alignbyte_b32 v22, v39, v38, v6
  v_alignbyte_b32 v23, v40, v39, v6
  v_alignbyte_b32 v24, v41, v40, v6
  v_alignbyte_b32 v25, v42, v41, v6
  v_mfma_f32_16x16x32_bf16 a[4:7], v[108:111], a[32:35], a[4:7]
  ds_read2_b32 v[32:33], v60 offset0:160 offset1:161
  ds_read2_b32 v[34:35], v60 offset0:162 offset1:163
  ds_read_b32 v36, v60 offset:656
  s_waitcnt lgkmcnt(9)
  v_alignbyte_b32 v56, v45, v44, v6
  v_alignbyte_b32 v57, v46, v45, v6
  v_alignbyte_b32 v58, v47, v46, v6
  v_alignbyte_b32 v59, v48, v47, v6
  v_accvgpr_write_b32 a72, v56
  v_accvgpr_write_b32 a73, v57
  v_accvgpr_write_b32 a74, v58
  v_accvgpr_write_b32 a75, v59
  v_mfma_f32_16x16x32_bf16 a[28:31], v[22:25], a[36:39], a[28:31]
  ds_read2_b32 v[38:39], v60 offset0:32 offset1:33
  ds_read2_b32 v[40:41], v60 offset0:34 offset1:35
  ds_read_b32 v42, v60 offset:144
  ds_read_b128 a[32:35], v4 offset:3520
  s_waitcnt lgkmcnt(10)
  v_alignbyte_b32 v232, v11, v10, v6
  v_alignbyte_b32 v233, v12, v11, v6
  v_alignbyte_b32 v234, v13, v12, v6
  v_alignbyte_b32 v235, v14, v13, v6
  v_mfma_f32_16x16x32_bf16 a[24:27], a[72:75], a[36:39], a[24:27]
  ds_read2_b32 v[44:45], v5 offset0:160 offset1:161
  ds_read2_b32 v[46:47], v5 offset0:162 offset1:163
  ds_read_b32 v48, v5 offset:656
  s_waitcnt lgkmcnt(10)
  v_alignbyte_b32 v200, v17, v16, v6
  v_alignbyte_b32 v201, v18, v17, v6
  v_alignbyte_b32 v202, v19, v18, v6
  v_alignbyte_b32 v203, v20, v19, v6
  v_mfma_f32_16x16x32_bf16 a[20:23], v[232:235], a[36:39], a[20:23]
  ds_read2_b32 v[10:11], v62 offset0:144 offset1:145
  ds_read2_b32 v[12:13], v62 offset0:146 offset1:147
  ds_read_b32 v14, v62 offset:592
  s_waitcnt lgkmcnt(10)
  v_alignbyte_b32 v168, v33, v32, v6
  v_alignbyte_b32 v169, v34, v33, v6
  v_alignbyte_b32 v170, v35, v34, v6
  v_alignbyte_b32 v171, v36, v35, v6
  v_mfma_f32_16x16x32_bf16 a[16:19], v[200:203], a[36:39], a[16:19]
  ds_read2_b32 v[16:17], v62 offset0:16 offset1:17
  ds_read2_b32 v[18:19], v62 offset0:18 offset1:19
  ds_read_b32 v20, v62 offset:80
  s_waitcnt lgkmcnt(10)
  v_alignbyte_b32 v136, v39, v38, v6
  v_alignbyte_b32 v137, v40, v39, v6
  v_alignbyte_b32 v138, v41, v40, v6
  v_alignbyte_b32 v139, v42, v41, v6
  v_mfma_f32_16x16x32_bf16 a[12:15], v[168:171], a[36:39], a[12:15]
  ds_read2_b32 v[32:33], v61 offset0:144 offset1:145
  ds_read2_b32 v[34:35], v61 offset0:146 offset1:147
  ds_read_b32 v36, v61 offset:592
  s_waitcnt lgkmcnt(9)
  v_alignbyte_b32 v104, v45, v44, v6
  v_alignbyte_b32 v105, v46, v45, v6
  v_alignbyte_b32 v106, v47, v46, v6
  v_alignbyte_b32 v107, v48, v47, v6
  v_mfma_f32_16x16x32_bf16 a[8:11], v[136:139], a[36:39], a[8:11]
  ds_read2_b32 v[38:39], v61 offset0:16 offset1:17
  ds_read2_b32 v[40:41], v61 offset0:18 offset1:19
  ds_read_b32 v42, v61 offset:80
  s_waitcnt lgkmcnt(9)
  v_alignbyte_b32 v26, v11, v10, v6
  v_alignbyte_b32 v27, v12, v11, v6
  v_alignbyte_b32 v28, v13, v12, v6
  v_alignbyte_b32 v29, v14, v13, v6
  v_mfma_f32_16x16x32_bf16 a[4:7], v[104:107], a[36:39], a[4:7]
  ds_read2_b32 v[44:45], v60 offset0:144 offset1:145
  ds_read2_b32 v[46:47], v60 offset0:146 offset1:147
  ds_read_b32 v48, v60 offset:592
  s_waitcnt lgkmcnt(9)
  v_alignbyte_b32 v56, v17, v16, v6
  v_alignbyte_b32 v57, v18, v17, v6
  v_alignbyte_b32 v58, v19, v18, v6
  v_alignbyte_b32 v59, v20, v19, v6
  v_accvgpr_write_b32 a68, v56
  v_accvgpr_write_b32 a69, v57
  v_accvgpr_write_b32 a70, v58
  v_accvgpr_write_b32 a71, v59
  v_mfma_f32_16x16x32_bf16 a[28:31], v[26:29], a[40:43], a[28:31]
  ds_read2_b32 v[10:11], v60 offset0:16 offset1:17
  ds_read2_b32 v[12:13], v60 offset0:18 offset1:19
  ds_read_b32 v14, v60 offset:80
  ds_read_b128 a[36:39], v4 offset:3456
  s_waitcnt lgkmcnt(10)
  v_alignbyte_b32 v228, v33, v32, v6
  v_alignbyte_b32 v229, v34, v33, v6
  v_alignbyte_b32 v230, v35, v34, v6
  v_alignbyte_b32 v231, v36, v35, v6
  v_mfma_f32_16x16x32_bf16 a[24:27], a[68:71], a[40:43], a[24:27]
  ds_read2_b32 v[16:17], v5 offset0:144 offset1:145
  ds_read2_b32 v[18:19], v5 offset0:146 offset1:147
  ds_read_b32 v20, v5 offset:592
  s_waitcnt lgkmcnt(10)
  v_alignbyte_b32 v196, v39, v38, v6
  v_alignbyte_b32 v197, v40, v39, v6
  v_alignbyte_b32 v198, v41, v40, v6
  v_alignbyte_b32 v199, v42, v41, v6
  v_mfma_f32_16x16x32_bf16 a[20:23], v[228:231], a[40:43], a[20:23]
  ds_read2_b32 v[32:33], v62 offset0:128 offset1:129
  ds_read2_b32 v[34:35], v62 offset0:130 offset1:131
  ds_read_b32 v36, v62 offset:528
  s_waitcnt lgkmcnt(10)
  v_alignbyte_b32 v164, v45, v44, v6
  v_alignbyte_b32 v165, v46, v45, v6
  v_alignbyte_b32 v166, v47, v46, v6
  v_alignbyte_b32 v167, v48, v47, v6
  v_mfma_f32_16x16x32_bf16 a[16:19], v[196:199], a[40:43], a[16:19]
  ds_read2_b32 v[38:39], v62 offset0:0 offset1:1
  ds_read2_b32 v[40:41], v62 offset0:2 offset1:3
  ds_read_b32 v42, v62 offset:16
  s_waitcnt lgkmcnt(10)
  v_alignbyte_b32 v132, v11, v10, v6
  v_alignbyte_b32 v133, v12, v11, v6
  v_alignbyte_b32 v134, v13, v12, v6
  v_alignbyte_b32 v135, v14, v13, v6
  v_mfma_f32_16x16x32_bf16 a[12:15], v[164:167], a[40:43], a[12:15]
  ds_read2_b32 v[44:45], v61 offset0:128 offset1:129
  ds_read2_b32 v[46:47], v61 offset0:130 offset1:131
  ds_read_b32 v48, v61 offset:528
  s_waitcnt lgkmcnt(9)
  v_alignbyte_b32 v100, v17, v16, v6
  v_alignbyte_b32 v101, v18, v17, v6
  v_alignbyte_b32 v102, v19, v18, v6
  v_alignbyte_b32 v103, v20, v19, v6
  v_mfma_f32_16x16x32_bf16 a[8:11], v[132:135], a[40:43], a[8:11]
  ds_read2_b32 v[10:11], v61 offset0:0 offset1:1
  ds_read2_b32 v[12:13], v61 offset0:2 offset1:3
  ds_read_b32 v14, v61 offset:16
  s_waitcnt lgkmcnt(9)
  v_alignbyte_b32 v22, v33, v32, v6
  v_alignbyte_b32 v23, v34, v33, v6
  v_alignbyte_b32 v24, v35, v34, v6
  v_alignbyte_b32 v25, v36, v35, v6
  v_mfma_f32_16x16x32_bf16 a[4:7], v[100:103], a[40:43], a[4:7]
  ds_read2_b32 v[16:17], v60 offset0:128 offset1:129
  ds_read2_b32 v[18:19], v60 offset0:130 offset1:131
  ds_read_b32 v20, v60 offset:528
  s_waitcnt lgkmcnt(9)
  v_alignbyte_b32 v56, v39, v38, v6
  v_alignbyte_b32 v57, v40, v39, v6
  v_alignbyte_b32 v58, v41, v40, v6
  v_alignbyte_b32 v59, v42, v41, v6
  v_accvgpr_write_b32 a64, v56
  v_accvgpr_write_b32 a65, v57
  v_accvgpr_write_b32 a66, v58
  v_accvgpr_write_b32 a67, v59
  v_mfma_f32_16x16x32_bf16 a[28:31], v[22:25], a[44:47], a[28:31]
  ds_read2_b32 v[32:33], v60 offset0:0 offset1:1
  ds_read2_b32 v[34:35], v60 offset0:2 offset1:3
  ds_read_b32 v36, v60 offset:16
  ds_read_b128 a[40:43], v4 offset:3392
  s_waitcnt lgkmcnt(10)
  v_alignbyte_b32 v224, v45, v44, v6
  v_alignbyte_b32 v225, v46, v45, v6
  v_alignbyte_b32 v226, v47, v46, v6
  v_alignbyte_b32 v227, v48, v47, v6
  v_mfma_f32_16x16x32_bf16 a[24:27], a[64:67], a[44:47], a[24:27]
  ds_read2_b32 v[38:39], v5 offset0:128 offset1:129
  ds_read2_b32 v[40:41], v5 offset0:130 offset1:131
  ds_read_b32 v42, v5 offset:528
  s_waitcnt lgkmcnt(10)
  v_alignbyte_b32 v192, v11, v10, v6
  v_alignbyte_b32 v193, v12, v11, v6
  v_alignbyte_b32 v194, v13, v12, v6
  v_alignbyte_b32 v195, v14, v13, v6
  v_mfma_f32_16x16x32_bf16 a[20:23], v[224:227], a[44:47], a[20:23]
  s_waitcnt lgkmcnt(7)
  v_alignbyte_b32 v160, v17, v16, v6
  v_alignbyte_b32 v161, v18, v17, v6
  v_alignbyte_b32 v162, v19, v18, v6
  v_alignbyte_b32 v163, v20, v19, v6
  v_mfma_f32_16x16x32_bf16 a[16:19], v[192:195], a[44:47], a[16:19]
  s_waitcnt lgkmcnt(4)
  v_alignbyte_b32 v128, v33, v32, v6
  v_alignbyte_b32 v129, v34, v33, v6
  v_alignbyte_b32 v130, v35, v34, v6
  v_alignbyte_b32 v131, v36, v35, v6
  v_mfma_f32_16x16x32_bf16 a[12:15], v[160:163], a[44:47], a[12:15]
  s_waitcnt lgkmcnt(0)
  v_alignbyte_b32 v96, v39, v38, v6
  v_alignbyte_b32 v97, v40, v39, v6
  v_alignbyte_b32 v98, v41, v40, v6
  v_alignbyte_b32 v99, v42, v41, v6
  v_mfma_f32_16x16x32_bf16 a[8:11], v[128:131], a[44:47], a[8:11]
  s_nop 0
  v_mfma_f32_16x16x32_bf16 a[4:7], v[96:99], a[44:47], a[4:7]
  v_mfma_f32_16x16x32_bf16 a[28:31], a[92:95], a[32:35], a[28:31]
  ds_read_b128 a[44:47], v4 offset:3328
  v_mfma_f32_16x16x32_bf16 a[24:27], v[252:255], a[32:35], a[24:27]
  v_mfma_f32_16x16x32_bf16 a[20:23], v[220:223], a[32:35], a[20:23]
  v_mfma_f32_16x16x32_bf16 a[16:19], v[188:191], a[32:35], a[16:19]
  v_mfma_f32_16x16x32_bf16 a[12:15], v[156:159], a[32:35], a[12:15]
  v_mfma_f32_16x16x32_bf16 a[8:11], v[124:127], a[32:35], a[8:11]
  v_mfma_f32_16x16x32_bf16 a[4:7], v[92:95], a[32:35], a[4:7]
  v_mfma_f32_16x16x32_bf16 a[28:31], a[88:91], a[36:39], a[28:31]
  ds_read_b128 a[32:35], v4 offset:3264
  v_mfma_f32_16x16x32_bf16 a[24:27], v[248:251], a[36:39], a[24:27]
  v_mfma_f32_16x16x32_bf16 a[20:23], v[216:219], a[36:39], a[20:23]
  v_mfma_f32_16x16x32_bf16 a[16:19], v[184:187], a[36:39], a[16:19]
  v_mfma_f32_16x16x32_bf16 a[12:15], v[152:155], a[36:39], a[12:15]
  v_mfma_f32_16x16x32_bf16 a[8:11], v[120:123], a[36:39], a[8:11]
  v_mfma_f32_16x16x32_bf16 a[4:7], v[88:91], a[36:39], a[4:7]
  v_mfma_f32_16x16x32_bf16 a[28:31], a[84:87], a[40:43], a[28:31]
  ds_read_b128 a[36:39], v4 offset:3200
  v_mfma_f32_16x16x32_bf16 a[24:27], v[244:247], a[40:43], a[24:27]
  v_mfma_f32_16x16x32_bf16 a[20:23], v[212:215], a[40:43], a[20:23]
  v_mfma_f32_16x16x32_bf16 a[16:19], v[180:183], a[40:43], a[16:19]
  v_mfma_f32_16x16x32_bf16 a[12:15], v[148:151], a[40:43], a[12:15]
  v_mfma_f32_16x16x32_bf16 a[8:11], v[116:119], a[40:43], a[8:11]
  v_mfma_f32_16x16x32_bf16 a[4:7], v[84:87], a[40:43], a[4:7]
  s_waitcnt lgkmcnt(2)
  v_mfma_f32_16x16x32_bf16 a[28:31], a[80:83], a[44:47], a[28:31]
  ds_read_b128 a[40:43], v4 offset:3136
  v_mfma_f32_16x16x32_bf16 a[24:27], v[240:243], a[44:47], a[24:27]
  v_mfma_f32_16x16x32_bf16 a[20:23], v[208:211], a[44:47], a[20:23]
  v_mfma_f32_16x16x32_bf16 a[16:19], v[176:179], a[44:47], a[16:19]
  v_mfma_f32_16x16x32_bf16 a[12:15], v[144:147], a[44:47], a[12:15]
  v_mfma_f32_16x16x32_bf16 a[8:11], v[112:115], a[44:47], a[8:11]
  v_mfma_f32_16x16x32_bf16 a[4:7], v[80:83], a[44:47], a[4:7]
  s_waitcnt lgkmcnt(2)
  v_mfma_f32_16x16x32_bf16 a[28:31], a[76:79], a[32:35], a[28:31]
  ds_read_b128 a[44:47], v4 offset:3072
  v_mfma_f32_16x16x32_bf16 a[24:27], v[236:239], a[32:35], a[24:27]
  v_mfma_f32_16x16x32_bf16 a[20:23], v[204:207], a[32:35], a[20:23]
  v_mfma_f32_16x16x32_bf16 a[16:19], v[172:175], a[32:35], a[16:19]
  v_mfma_f32_16x16x32_bf16 a[12:15], v[140:143], a[32:35], a[12:15]
  v_mfma_f32_16x16x32_bf16 a[8:11], v[108:111], a[32:35], a[8:11]
  v_mfma_f32_16x16x32_bf16 a[4:7], v[76:79], a[32:35], a[4:7]
  s_waitcnt lgkmcnt(2)
  v_mfma_f32_16x16x32_bf16 a[28:31], a[72:75], a[36:39], a[28:31]
  ds_read_b128 a[32:35], v4 offset:3008
  v_mfma_f32_16x16x32_bf16 a[24:27], v[232:235], a[36:39], a[24:27]
  v_mfma_f32_16x16x32_bf16 a[20:23], v[200:203], a[36:39], a[20:23]
  v_mfma_f32_16x16x32_bf16 a[16:19], v[168:171], a[36:39], a[16:19]
  v_mfma_f32_16x16x32_bf16 a[12:15], v[136:139], a[36:39], a[12:15]
  v_mfma_f32_16x16x32_bf16 a[8:11], v[104:107], a[36:39], a[8:11]
  v_mfma_f32_16x16x32_bf16 a[4:7], v[72:75], a[36:39], a[4:7]
  s_waitcnt lgkmcnt(2)
  v_mfma_f32_16x16x32_bf16 a[28:31], a[68:71], a[40:43], a[28:31]
  ds_read_b128 a[36:39], v4 offset:2944
  v_mfma_f32_16x16x32_bf16 a[24:27], v[228:231], a[40:43], a[24:27]
  v_mfma_f32_16x16x32_bf16 a[20:23], v[196:199], a[40:43], a[20:23]
  v_mfma_f32_16x16x32_bf16 a[16:19], v[164:167], a[40:43], a[16:19]
  v_mfma_f32_16x16x32_bf16 a[12:15], v[132:135], a[40:43], a[12:15]
  v_mfma_f32_16x16x32_bf16 a[8:11], v[100:103], a[40:43], a[8:11]
  v_mfma_f32_16x16x32_bf16 a[4:7], v[68:71], a[40:43], a[4:7]
  s_waitcnt lgkmcnt(2)
  v_mfma_f32_16x16x32_bf16 a[28:31], a[64:67], a[44:47], a[28:31]
  ds_read_b128 a[40:43], v4 offset:2880
  v_mfma_f32_16x16x32_bf16 a[24:27], v[224:227], a[44:47], a[24:27]
  v_mfma_f32_16x16x32_bf16 a[20:23], v[192:195], a[44:47], a[20:23]
  v_mfma_f32_16x16x32_bf16 a[16:19], v[160:163], a[44:47], a[16:19]
  v_mfma_f32_16x16x32_bf16 a[12:15], v[128:131], a[44:47], a[12:15]
  v_mfma_f32_16x16x32_bf16 a[8:11], v[96:99], a[44:47], a[8:11]
  v_mfma_f32_16x16x32_bf16 a[4:7], v[64:67], a[44:47], a[4:7]
  s_waitcnt lgkmcnt(2)
  v_mfma_f32_16x16x32_bf16 a[28:31], v[252:255], a[32:35], a[28:31]
  ds_read_b128 a[44:47], v4 offset:2816
  ds_read_b64 v[36:37], v7 offset:512
  ds_read_b64 v[38:39], v8 offset:512
  s_nop 2
  v_accvgpr_read_b32 v44, a4
  v_accvgpr_read_b32 v45, a5
  v_mfma_f32_16x16x32_bf16 a[24:27], v[220:223], a[32:35], a[24:27]
  v_accvgpr_read_b32 v46, a6
  v_accvgpr_read_b32 v47, a7
  v_mfma_f32_16x16x32_bf16 a[20:23], v[188:191], a[32:35], a[20:23]
  s_waitcnt lgkmcnt(0)
  v_lshlrev_b32 v48, 16, v36
  v_and_b32 v49, 0xffff0000, v36
  v_mfma_f32_16x16x32_bf16 a[16:19], v[156:159], a[32:35], a[16:19]
  v_lshlrev_b32 v50, 16, v37
  v_and_b32 v51, 0xffff0000, v37
  v_mfma_f32_16x16x32_bf16 a[12:15], v[124:127], a[32:35], a[12:15]
  v_lshlrev_b32 v32, 16, v38
  v_and_b32 v33, 0xffff0000, v38
  v_mfma_f32_16x16x32_bf16 a[8:11], v[92:95], a[32:35], a[8:11]
  v_lshlrev_b32 v34, 16, v39
  v_and_b32 v35, 0xffff0000, v39
  v_mfma_f32_16x16x32_bf16 a[28:31], v[248:251], a[36:39], a[28:31]
  ds_read_b128 a[32:35], v4 offset:2752
  v_mul_f32 v52, v48, v31
  v_mul_f32 v53, v49, v31
  v_mfma_f32_16x16x32_bf16 a[24:27], v[216:219], a[36:39], a[24:27]
  v_mul_f32 v54, v50, v31
  v_mul_f32 v55, v51, v31
  v_mfma_f32_16x16x32_bf16 a[20:23], v[184:187], a[36:39], a[20:23]
  v_fmac_f32 v44, s61, v48
  v_fmac_f32 v45, s61, v49
  v_mfma_f32_16x16x32_bf16 a[16:19], v[152:155], a[36:39], a[16:19]
  v_fmac_f32 v46, s61, v50
  v_fmac_f32 v47, s61, v51
  v_mfma_f32_16x16x32_bf16 a[12:15], v[120:123], a[36:39], a[12:15]
  v_cvt_pk_bf16_f32 v36, v52, v53
  v_cvt_pk_bf16_f32 v37, v54, v55
  v_mfma_f32_16x16x32_bf16 a[8:11], v[88:91], a[36:39], a[8:11]
  v_lshlrev_b32 v52, 16, v36
  v_and_b32 v53, 0xffff0000, v36
  v_mfma_f32_16x16x32_bf16 a[28:31], v[244:247], a[40:43], a[28:31]
  ds_read_b128 a[36:39], v4 offset:2688
  v_lshlrev_b32 v54, 16, v37
  v_and_b32 v55, 0xffff0000, v37
  v_mfma_f32_16x16x32_bf16 a[24:27], v[212:215], a[40:43], a[24:27]
  v_cvt_pk_bf16_f32 v36, v44, v45
  v_cvt_pk_bf16_f32 v37, v46, v47
  v_mfma_f32_16x16x32_bf16 a[20:23], v[180:183], a[40:43], a[20:23]
  v_lshlrev_b32 v44, 16, v36
  v_and_b32 v45, 0xffff0000, v36
  v_mfma_f32_16x16x32_bf16 a[16:19], v[148:151], a[40:43], a[16:19]
  v_lshlrev_b32 v46, 16, v37
  v_and_b32 v47, 0xffff0000, v37
  v_mfma_f32_16x16x32_bf16 a[12:15], v[116:119], a[40:43], a[12:15]
  v_add_f32 v44, v44, v52
  v_add_f32 v45, v45, v53
  v_mfma_f32_16x16x32_bf16 a[8:11], v[84:87], a[40:43], a[8:11]
  v_add_f32 v46, v46, v54
  v_add_f32 v47, v47, v55
  v_mfma_f32_16x16x32_bf16 a[28:31], v[240:243], a[44:47], a[28:31]
  ds_read_b128 a[40:43], v4 offset:2624
  v_cvt_pk_bf16_f32 v36, v44, v45
  v_cvt_pk_bf16_f32 v37, v46, v47
  v_mfma_f32_16x16x32_bf16 a[24:27], v[208:211], a[44:47], a[24:27]
  v_lshlrev_b32 v44, 16, v36
  v_and_b32 v45, 0xffff0000, v36
  v_mfma_f32_16x16x32_bf16 a[20:23], v[176:179], a[44:47], a[20:23]
  v_lshlrev_b32 v46, 16, v37
  v_and_b32 v47, 0xffff0000, v37
  v_mfma_f32_16x16x32_bf16 a[16:19], v[144:147], a[44:47], a[16:19]
  v_add_f32 v44, v44, v32
  v_add_f32 v45, v45, v33
  v_mfma_f32_16x16x32_bf16 a[12:15], v[112:115], a[44:47], a[12:15]
  v_add_f32 v46, v46, v34
  v_add_f32 v47, v47, v35
  v_mfma_f32_16x16x32_bf16 a[8:11], v[80:83], a[44:47], a[8:11]
  v_cvt_pk_bf16_f32 v36, v44, v45
  v_cvt_pk_bf16_f32 v37, v46, v47
  s_waitcnt lgkmcnt(2)
  v_mfma_f32_16x16x32_bf16 a[28:31], v[236:239], a[32:35], a[28:31]
  ds_read_b128 a[44:47], v4 offset:2560
  s_add_u32 s6, s62, 262144
  buffer_store_dwordx2 v[36:37], v9, s[8:11], s6 offen sc1
  v_mfma_f32_16x16x32_bf16 a[24:27], v[204:207], a[32:35], a[24:27]
  v_mfma_f32_16x16x32_bf16 a[20:23], v[172:175], a[32:35], a[20:23]
  v_mfma_f32_16x16x32_bf16 a[16:19], v[140:143], a[32:35], a[16:19]
  v_mfma_f32_16x16x32_bf16 a[12:15], v[108:111], a[32:35], a[12:15]
  v_mfma_f32_16x16x32_bf16 a[8:11], v[76:79], a[32:35], a[8:11]
  s_waitcnt lgkmcnt(2)
  v_mfma_f32_16x16x32_bf16 a[28:31], v[232:235], a[36:39], a[28:31]
  ds_read_b128 a[32:35], v4 offset:2496
  v_mfma_f32_16x16x32_bf16 a[24:27], v[200:203], a[36:39], a[24:27]
  v_mfma_f32_16x16x32_bf16 a[20:23], v[168:171], a[36:39], a[20:23]
  v_mfma_f32_16x16x32_bf16 a[16:19], v[136:139], a[36:39], a[16:19]
  v_mfma_f32_16x16x32_bf16 a[12:15], v[104:107], a[36:39], a[12:15]
  v_mfma_f32_16x16x32_bf16 a[8:11], v[72:75], a[36:39], a[8:11]
  s_waitcnt lgkmcnt(2)
  v_mfma_f32_16x16x32_bf16 a[28:31], v[228:231], a[40:43], a[28:31]
  ds_read_b128 a[36:39], v4 offset:2432
  v_mfma_f32_16x16x32_bf16 a[24:27], v[196:199], a[40:43], a[24:27]
  v_mfma_f32_16x16x32_bf16 a[20:23], v[164:167], a[40:43], a[20:23]
  v_mfma_f32_16x16x32_bf16 a[16:19], v[132:135], a[40:43], a[16:19]
  v_mfma_f32_16x16x32_bf16 a[12:15], v[100:103], a[40:43], a[12:15]
  v_mfma_f32_16x16x32_bf16 a[8:11], v[68:71], a[40:43], a[8:11]
  s_waitcnt lgkmcnt(2)
  v_mfma_f32_16x16x32_bf16 a[28:31], v[224:227], a[44:47], a[28:31]
  ds_read_b128 a[40:43], v4 offset:2368
  v_mfma_f32_16x16x32_bf16 a[24:27], v[192:195], a[44:47], a[24:27]
  v_mfma_f32_16x16x32_bf16 a[20:23], v[160:163], a[44:47], a[20:23]
  v_mfma_f32_16x16x32_bf16 a[16:19], v[128:131], a[44:47], a[16:19]
  v_mfma_f32_16x16x32_bf16 a[12:15], v[96:99], a[44:47], a[12:15]
  v_mfma_f32_16x16x32_bf16 a[8:11], v[64:67], a[44:47], a[8:11]
  s_waitcnt lgkmcnt(2)
  v_mfma_f32_16x16x32_bf16 a[28:31], v[220:223], a[32:35], a[28:31]
  ds_read_b128 a[44:47], v4 offset:2304
  ds_read_b64 v[36:37], v7 offset:1024
  ds_read_b64 v[38:39], v8 offset:1024
  s_nop 2
  v_accvgpr_read_b32 v44, a8
  v_accvgpr_read_b32 v45, a9
  v_mfma_f32_16x16x32_bf16 a[24:27], v[188:191], a[32:35], a[24:27]
  v_accvgpr_read_b32 v46, a10
  v_accvgpr_read_b32 v47, a11
  v_mfma_f32_16x16x32_bf16 a[20:23], v[156:159], a[32:35], a[20:23]
  s_waitcnt lgkmcnt(0)
  v_lshlrev_b32 v48, 16, v36
  v_and_b32 v49, 0xffff0000, v36
  v_mfma_f32_16x16x32_bf16 a[16:19], v[124:127], a[32:35], a[16:19]
  v_lshlrev_b32 v50, 16, v37
  v_and_b32 v51, 0xffff0000, v37
  v_mfma_f32_16x16x32_bf16 a[12:15], v[92:95], a[32:35], a[12:15]
  v_lshlrev_b32 v32, 16, v38
  v_and_b32 v33, 0xffff0000, v38
  v_mfma_f32_16x16x32_bf16 a[28:31], v[216:219], a[36:39], a[28:31]
  ds_read_b128 a[32:35], v4 offset:2240
  v_lshlrev_b32 v34, 16, v39
  v_and_b32 v35, 0xffff0000, v39
  v_mfma_f32_16x16x32_bf16 a[24:27], v[184:187], a[36:39], a[24:27]
  v_mul_f32 v52, v48, v31
  v_mul_f32 v53, v49, v31
  v_mfma_f32_16x16x32_bf16 a[20:23], v[152:155], a[36:39], a[20:23]
  v_mul_f32 v54, v50, v31
  v_mul_f32 v55, v51, v31
  v_mfma_f32_16x16x32_bf16 a[16:19], v[120:123], a[36:39], a[16:19]
  v_fmac_f32 v44, s61, v48
  v_fmac_f32 v45, s61, v49
  v_mfma_f32_16x16x32_bf16 a[12:15], v[88:91], a[36:39], a[12:15]
  v_fmac_f32 v46, s61, v50
  v_fmac_f32 v47, s61, v51
  v_mfma_f32_16x16x32_bf16 a[28:31], v[212:215], a[40:43], a[28:31]
  ds_read_b128 a[36:39], v4 offset:2176
  v_cvt_pk_bf16_f32 v36, v52, v53
  v_cvt_pk_bf16_f32 v37, v54, v55
  v_mfma_f32_16x16x32_bf16 a[24:27], v[180:183], a[40:43], a[24:27]
  v_lshlrev_b32 v52, 16, v36
  v_and_b32 v53, 0xffff0000, v36
  v_mfma_f32_16x16x32_bf16 a[20:23], v[148:151], a[40:43], a[20:23]
  v_lshlrev_b32 v54, 16, v37
  v_and_b32 v55, 0xffff0000, v37
  v_mfma_f32_16x16x32_bf16 a[16:19], v[116:119], a[40:43], a[16:19]
  v_cvt_pk_bf16_f32 v36, v44, v45
  v_cvt_pk_bf16_f32 v37, v46, v47
  v_mfma_f32_16x16x32_bf16 a[12:15], v[84:87], a[40:43], a[12:15]
  v_lshlrev_b32 v44, 16, v36
  v_and_b32 v45, 0xffff0000, v36
  v_mfma_f32_16x16x32_bf16 a[28:31], v[208:211], a[44:47], a[28:31]
  ds_read_b128 a[40:43], v4 offset:2112
  v_lshlrev_b32 v46, 16, v37
  v_and_b32 v47, 0xffff0000, v37
  v_mfma_f32_16x16x32_bf16 a[24:27], v[176:179], a[44:47], a[24:27]
  v_add_f32 v44, v44, v52
  v_add_f32 v45, v45, v53
  v_mfma_f32_16x16x32_bf16 a[20:23], v[144:147], a[44:47], a[20:23]
  v_add_f32 v46, v46, v54
  v_add_f32 v47, v47, v55
  v_mfma_f32_16x16x32_bf16 a[16:19], v[112:115], a[44:47], a[16:19]
  v_cvt_pk_bf16_f32 v36, v44, v45
  v_cvt_pk_bf16_f32 v37, v46, v47
  v_mfma_f32_16x16x32_bf16 a[12:15], v[80:83], a[44:47], a[12:15]
  v_lshlrev_b32 v44, 16, v36
  v_and_b32 v45, 0xffff0000, v36
  s_waitcnt lgkmcnt(2)
  v_mfma_f32_16x16x32_bf16 a[28:31], v[204:207], a[32:35], a[28:31]
  ds_read_b128 a[44:47], v4 offset:2048
  v_lshlrev_b32 v46, 16, v37
  v_and_b32 v47, 0xffff0000, v37
  v_mfma_f32_16x16x32_bf16 a[24:27], v[172:175], a[32:35], a[24:27]
  v_add_f32 v44, v44, v32
  v_add_f32 v45, v45, v33
  v_mfma_f32_16x16x32_bf16 a[20:23], v[140:143], a[32:35], a[20:23]
  v_add_f32 v46, v46, v34
  v_add_f32 v47, v47, v35
  v_mfma_f32_16x16x32_bf16 a[16:19], v[108:111], a[32:35], a[16:19]
  v_cvt_pk_bf16_f32 v36, v44, v45
  v_cvt_pk_bf16_f32 v37, v46, v47
  v_mfma_f32_16x16x32_bf16 a[12:15], v[76:79], a[32:35], a[12:15]
  s_add_u32 s6, s62, 524288
  buffer_store_dwordx2 v[36:37], v9, s[8:11], s6 offen sc1
  s_waitcnt lgkmcnt(2)
  v_mfma_f32_16x16x32_bf16 a[28:31], v[200:203], a[36:39], a[28:31]
  ds_read_b128 a[32:35], v4 offset:1984
  v_mfma_f32_16x16x32_bf16 a[24:27], v[168:171], a[36:39], a[24:27]
  v_mfma_f32_16x16x32_bf16 a[20:23], v[136:139], a[36:39], a[20:23]
  v_mfma_f32_16x16x32_bf16 a[16:19], v[104:107], a[36:39], a[16:19]
  v_mfma_f32_16x16x32_bf16 a[12:15], v[72:75], a[36:39], a[12:15]
  s_waitcnt lgkmcnt(2)
  v_mfma_f32_16x16x32_bf16 a[28:31], v[196:199], a[40:43], a[28:31]
  ds_read_b128 a[36:39], v4 offset:1920
  v_mfma_f32_16x16x32_bf16 a[24:27], v[164:167], a[40:43], a[24:27]
  v_mfma_f32_16x16x32_bf16 a[20:23], v[132:135], a[40:43], a[20:23]
  v_mfma_f32_16x16x32_bf16 a[16:19], v[100:103], a[40:43], a[16:19]
  v_mfma_f32_16x16x32_bf16 a[12:15], v[68:71], a[40:43], a[12:15]
  s_waitcnt lgkmcnt(2)
  v_mfma_f32_16x16x32_bf16 a[28:31], v[192:195], a[44:47], a[28:31]
  ds_read_b128 a[40:43], v4 offset:1856
  v_mfma_f32_16x16x32_bf16 a[24:27], v[160:163], a[44:47], a[24:27]
  v_mfma_f32_16x16x32_bf16 a[20:23], v[128:131], a[44:47], a[20:23]
  v_mfma_f32_16x16x32_bf16 a[16:19], v[96:99], a[44:47], a[16:19]
  v_mfma_f32_16x16x32_bf16 a[12:15], v[64:67], a[44:47], a[12:15]
  s_waitcnt lgkmcnt(2)
  v_mfma_f32_16x16x32_bf16 a[28:31], v[188:191], a[32:35], a[28:31]
  ds_read_b128 a[44:47], v4 offset:1792
  ds_read_b64 v[36:37], v7 offset:1536
  ds_read_b64 v[38:39], v8 offset:1536
  s_nop 2
  v_accvgpr_read_b32 v44, a12
  v_accvgpr_read_b32 v45, a13
  v_mfma_f32_16x16x32_bf16 a[24:27], v[156:159], a[32:35], a[24:27]
  v_accvgpr_read_b32 v46, a14
  v_accvgpr_read_b32 v47, a15
  v_mfma_f32_16x16x32_bf16 a[20:23], v[124:127], a[32:35], a[20:23]
  s_waitcnt lgkmcnt(0)
  v_lshlrev_b32 v48, 16, v36
  v_and_b32 v49, 0xffff0000, v36
  v_mfma_f32_16x16x32_bf16 a[16:19], v[92:95], a[32:35], a[16:19]
  v_lshlrev_b32 v50, 16, v37
  v_and_b32 v51, 0xffff0000, v37
  v_mfma_f32_16x16x32_bf16 a[28:31], v[184:187], a[36:39], a[28:31]
  ds_read_b128 a[32:35], v4 offset:1728
  v_lshlrev_b32 v32, 16, v38
  v_and_b32 v33, 0xffff0000, v38
  v_mfma_f32_16x16x32_bf16 a[24:27], v[152:155], a[36:39], a[24:27]
  v_lshlrev_b32 v34, 16, v39
  v_and_b32 v35, 0xffff0000, v39
  v_mfma_f32_16x16x32_bf16 a[20:23], v[120:123], a[36:39], a[20:23]
  v_mul_f32 v52, v48, v31
  v_mul_f32 v53, v49, v31
  v_mfma_f32_16x16x32_bf16 a[16:19], v[88:91], a[36:39], a[16:19]
  v_mul_f32 v54, v50, v31
  v_mul_f32 v55, v51, v31
  v_mfma_f32_16x16x32_bf16 a[28:31], v[180:183], a[40:43], a[28:31]
  ds_read_b128 a[36:39], v4 offset:1664
  v_fmac_f32 v44, s61, v48
  v_fmac_f32 v45, s61, v49
  v_mfma_f32_16x16x32_bf16 a[24:27], v[148:151], a[40:43], a[24:27]
  v_fmac_f32 v46, s61, v50
  v_fmac_f32 v47, s61, v51
  v_mfma_f32_16x16x32_bf16 a[20:23], v[116:119], a[40:43], a[20:23]
  v_cvt_pk_bf16_f32 v36, v52, v53
  v_cvt_pk_bf16_f32 v37, v54, v55
  v_mfma_f32_16x16x32_bf16 a[16:19], v[84:87], a[40:43], a[16:19]
  v_lshlrev_b32 v52, 16, v36
  v_and_b32 v53, 0xffff0000, v36
  v_mfma_f32_16x16x32_bf16 a[28:31], v[176:179], a[44:47], a[28:31]
  ds_read_b128 a[40:43], v4 offset:1600
  v_lshlrev_b32 v54, 16, v37
  v_and_b32 v55, 0xffff0000, v37
  v_mfma_f32_16x16x32_bf16 a[24:27], v[144:147], a[44:47], a[24:27]
  v_cvt_pk_bf16_f32 v36, v44, v45
  v_cvt_pk_bf16_f32 v37, v46, v47
  v_mfma_f32_16x16x32_bf16 a[20:23], v[112:115], a[44:47], a[20:23]
  v_lshlrev_b32 v44, 16, v36
  v_and_b32 v45, 0xffff0000, v36
  v_mfma_f32_16x16x32_bf16 a[16:19], v[80:83], a[44:47], a[16:19]
  v_lshlrev_b32 v46, 16, v37
  v_and_b32 v47, 0xffff0000, v37
  s_waitcnt lgkmcnt(2)
  v_mfma_f32_16x16x32_bf16 a[28:31], v[172:175], a[32:35], a[28:31]
  ds_read_b128 a[44:47], v4 offset:1536
  v_add_f32 v44, v44, v52
  v_add_f32 v45, v45, v53
  v_mfma_f32_16x16x32_bf16 a[24:27], v[140:143], a[32:35], a[24:27]
  v_add_f32 v46, v46, v54
  v_add_f32 v47, v47, v55
  v_mfma_f32_16x16x32_bf16 a[20:23], v[108:111], a[32:35], a[20:23]
  v_cvt_pk_bf16_f32 v36, v44, v45
  v_cvt_pk_bf16_f32 v37, v46, v47
  v_mfma_f32_16x16x32_bf16 a[16:19], v[76:79], a[32:35], a[16:19]
  v_lshlrev_b32 v44, 16, v36
  v_and_b32 v45, 0xffff0000, v36
  s_waitcnt lgkmcnt(2)
  v_mfma_f32_16x16x32_bf16 a[28:31], v[168:171], a[36:39], a[28:31]
  ds_read_b128 a[32:35], v4 offset:1472
  v_lshlrev_b32 v46, 16, v37
  v_and_b32 v47, 0xffff0000, v37
  v_mfma_f32_16x16x32_bf16 a[24:27], v[136:139], a[36:39], a[24:27]
  v_add_f32 v44, v44, v32
  v_add_f32 v45, v45, v33
  v_mfma_f32_16x16x32_bf16 a[20:23], v[104:107], a[36:39], a[20:23]
  v_add_f32 v46, v46, v34
  v_add_f32 v47, v47, v35
  v_mfma_f32_16x16x32_bf16 a[16:19], v[72:75], a[36:39], a[16:19]
  v_cvt_pk_bf16_f32 v36, v44, v45
  v_cvt_pk_bf16_f32 v37, v46, v47
  s_waitcnt lgkmcnt(2)
  v_mfma_f32_16x16x32_bf16 a[28:31], v[164:167], a[40:43], a[28:31]
  ds_read_b128 a[36:39], v4 offset:1408
  s_add_u32 s6, s62, 786432
  buffer_store_dwordx2 v[36:37], v9, s[8:11], s6 offen sc1
  v_mfma_f32_16x16x32_bf16 a[24:27], v[132:135], a[40:43], a[24:27]
  v_mfma_f32_16x16x32_bf16 a[20:23], v[100:103], a[40:43], a[20:23]
  v_mfma_f32_16x16x32_bf16 a[16:19], v[68:71], a[40:43], a[16:19]
  s_waitcnt lgkmcnt(2)
  v_mfma_f32_16x16x32_bf16 a[28:31], v[160:163], a[44:47], a[28:31]
  ds_read_b128 a[40:43], v4 offset:1344
  v_mfma_f32_16x16x32_bf16 a[24:27], v[128:131], a[44:47], a[24:27]
  v_mfma_f32_16x16x32_bf16 a[20:23], v[96:99], a[44:47], a[20:23]
  v_mfma_f32_16x16x32_bf16 a[16:19], v[64:67], a[44:47], a[16:19]
  s_waitcnt lgkmcnt(2)
  v_mfma_f32_16x16x32_bf16 a[28:31], v[156:159], a[32:35], a[28:31]
  ds_read_b128 a[44:47], v4 offset:1280
  ds_read_b64 v[36:37], v7 offset:2048
  ds_read_b64 v[38:39], v8 offset:2048
  s_nop 2
  v_accvgpr_read_b32 v44, a16
  v_accvgpr_read_b32 v45, a17
  v_mfma_f32_16x16x32_bf16 a[24:27], v[124:127], a[32:35], a[24:27]
  v_accvgpr_read_b32 v46, a18
  v_accvgpr_read_b32 v47, a19
  v_mfma_f32_16x16x32_bf16 a[20:23], v[92:95], a[32:35], a[20:23]
  s_waitcnt lgkmcnt(0)
  v_lshlrev_b32 v48, 16, v36
  v_and_b32 v49, 0xffff0000, v36
  v_mfma_f32_16x16x32_bf16 a[28:31], v[152:155], a[36:39], a[28:31]
  ds_read_b128 a[32:35], v4 offset:1216
  v_lshlrev_b32 v50, 16, v37
  v_and_b32 v51, 0xffff0000, v37
  v_mfma_f32_16x16x32_bf16 a[24:27], v[120:123], a[36:39], a[24:27]
  v_lshlrev_b32 v32, 16, v38
  v_and_b32 v33, 0xffff0000, v38
  v_mfma_f32_16x16x32_bf16 a[20:23], v[88:91], a[36:39], a[20:23]
  v_lshlrev_b32 v34, 16, v39
  v_and_b32 v35, 0xffff0000, v39
  v_mfma_f32_16x16x32_bf16 a[28:31], v[148:151], a[40:43], a[28:31]
  ds_read_b128 a[36:39], v4 offset:1152
  v_mul_f32 v52, v48, v31
  v_mul_f32 v53, v49, v31
  v_mfma_f32_16x16x32_bf16 a[24:27], v[116:119], a[40:43], a[24:27]
  v_mul_f32 v54, v50, v31
  v_mul_f32 v55, v51, v31
  v_mfma_f32_16x16x32_bf16 a[20:23], v[84:87], a[40:43], a[20:23]
  v_fmac_f32 v44, s61, v48
  v_fmac_f32 v45, s61, v49
  v_mfma_f32_16x16x32_bf16 a[28:31], v[144:147], a[44:47], a[28:31]
  ds_read_b128 a[40:43], v4 offset:1088
  v_fmac_f32 v46, s61, v50
  v_fmac_f32 v47, s61, v51
  v_mfma_f32_16x16x32_bf16 a[24:27], v[112:115], a[44:47], a[24:27]
  v_cvt_pk_bf16_f32 v36, v52, v53
  v_cvt_pk_bf16_f32 v37, v54, v55
  v_mfma_f32_16x16x32_bf16 a[20:23], v[80:83], a[44:47], a[20:23]
  v_lshlrev_b32 v52, 16, v36
  v_and_b32 v53, 0xffff0000, v36
  s_waitcnt lgkmcnt(2)
  v_mfma_f32_16x16x32_bf16 a[28:31], v[140:143], a[32:35], a[28:31]
  ds_read_b128 a[44:47], v4 offset:1024
  v_lshlrev_b32 v54, 16, v37
  v_and_b32 v55, 0xffff0000, v37
  v_mfma_f32_16x16x32_bf16 a[24:27], v[108:111], a[32:35], a[24:27]
  v_cvt_pk_bf16_f32 v36, v44, v45
  v_cvt_pk_bf16_f32 v37, v46, v47
  v_mfma_f32_16x16x32_bf16 a[20:23], v[76:79], a[32:35], a[20:23]
  v_lshlrev_b32 v44, 16, v36
  v_and_b32 v45, 0xffff0000, v36
  s_waitcnt lgkmcnt(2)
  v_mfma_f32_16x16x32_bf16 a[28:31], v[136:139], a[36:39], a[28:31]
  ds_read_b128 a[32:35], v4 offset:960
  v_lshlrev_b32 v46, 16, v37
  v_and_b32 v47, 0xffff0000, v37
  v_mfma_f32_16x16x32_bf16 a[24:27], v[104:107], a[36:39], a[24:27]
  v_add_f32 v44, v44, v52
  v_add_f32 v45, v45, v53
  v_mfma_f32_16x16x32_bf16 a[20:23], v[72:75], a[36:39], a[20:23]
  v_add_f32 v46, v46, v54
  v_add_f32 v47, v47, v55
  s_waitcnt lgkmcnt(2)
  v_mfma_f32_16x16x32_bf16 a[28:31], v[132:135], a[40:43], a[28:31]
  ds_read_b128 a[36:39], v4 offset:896
  v_cvt_pk_bf16_f32 v36, v44, v45
  v_cvt_pk_bf16_f32 v37, v46, v47
  v_mfma_f32_16x16x32_bf16 a[24:27], v[100:103], a[40:43], a[24:27]
  v_lshlrev_b32 v44, 16, v36
  v_and_b32 v45, 0xffff0000, v36
  v_mfma_f32_16x16x32_bf16 a[20:23], v[68:71], a[40:43], a[20:23]
  v_lshlrev_b32 v46, 16, v37
  v_and_b32 v47, 0xffff0000, v37
  s_waitcnt lgkmcnt(2)
  v_mfma_f32_16x16x32_bf16 a[28:31], v[128:131], a[44:47], a[28:31]
  ds_read_b128 a[40:43], v4 offset:832
  v_add_f32 v44, v44, v32
  v_add_f32 v45, v45, v33
  v_mfma_f32_16x16x32_bf16 a[24:27], v[96:99], a[44:47], a[24:27]
  v_add_f32 v46, v46, v34
  v_add_f32 v47, v47, v35
  v_mfma_f32_16x16x32_bf16 a[20:23], v[64:67], a[44:47], a[20:23]
  v_cvt_pk_bf16_f32 v36, v44, v45
  v_cvt_pk_bf16_f32 v37, v46, v47
  s_waitcnt lgkmcnt(2)
  v_mfma_f32_16x16x32_bf16 a[28:31], v[124:127], a[32:35], a[28:31]
  ds_read_b128 a[44:47], v4 offset:768
  s_add_u32 s6, s62, 1048576
  buffer_store_dwordx2 v[36:37], v9, s[8:11], s6 offen sc1
  v_mfma_f32_16x16x32_bf16 a[24:27], v[92:95], a[32:35], a[24:27]
  ds_read_b64 v[36:37], v7 offset:2560
  ds_read_b64 v[38:39], v8 offset:2560
  v_accvgpr_read_b32 v44, a20
  v_accvgpr_read_b32 v45, a21
  s_waitcnt lgkmcnt(4)
  v_mfma_f32_16x16x32_bf16 a[28:31], v[120:123], a[36:39], a[28:31]
  ds_read_b128 a[32:35], v4 offset:704
  v_accvgpr_read_b32 v46, a22
  v_accvgpr_read_b32 v47, a23
  v_mfma_f32_16x16x32_bf16 a[24:27], v[88:91], a[36:39], a[24:27]
  s_waitcnt lgkmcnt(1)
  v_lshlrev_b32 v48, 16, v36
  v_and_b32 v49, 0xffff0000, v36
  v_mfma_f32_16x16x32_bf16 a[28:31], v[116:119], a[40:43], a[28:31]
  ds_read_b128 a[36:39], v4 offset:640
  v_lshlrev_b32 v50, 16, v37
  v_and_b32 v51, 0xffff0000, v37
  v_mfma_f32_16x16x32_bf16 a[24:27], v[84:87], a[40:43], a[24:27]
  v_lshlrev_b32 v32, 16, v38
  v_and_b32 v33, 0xffff0000, v38
  v_mfma_f32_16x16x32_bf16 a[28:31], v[112:115], a[44:47], a[28:31]
  ds_read_b128 a[40:43], v4 offset:576
  v_lshlrev_b32 v34, 16, v39
  v_and_b32 v35, 0xffff0000, v39
  v_mfma_f32_16x16x32_bf16 a[24:27], v[80:83], a[44:47], a[24:27]
  v_mul_f32 v52, v48, v31
  v_mul_f32 v53, v49, v31
  s_waitcnt lgkmcnt(2)
  v_mfma_f32_16x16x32_bf16 a[28:31], v[108:111], a[32:35], a[28:31]
  ds_read_b128 a[44:47], v4 offset:512
  v_mul_f32 v54, v50, v31
  v_mul_f32 v55, v51, v31
  v_mfma_f32_16x16x32_bf16 a[24:27], v[76:79], a[32:35], a[24:27]
  v_fmac_f32 v44, s61, v48
  v_fmac_f32 v45, s61, v49
  s_waitcnt lgkmcnt(2)
  v_mfma_f32_16x16x32_bf16 a[28:31], v[104:107], a[36:39], a[28:31]
  ds_read_b128 a[32:35], v4 offset:448
  v_fmac_f32 v46, s61, v50
  v_fmac_f32 v47, s61, v51
  v_mfma_f32_16x16x32_bf16 a[24:27], v[72:75], a[36:39], a[24:27]
  v_cvt_pk_bf16_f32 v36, v52, v53
  v_cvt_pk_bf16_f32 v37, v54, v55
  s_waitcnt lgkmcnt(2)
  v_mfma_f32_16x16x32_bf16 a[28:31], v[100:103], a[40:43], a[28:31]
  ds_read_b128 a[36:39], v4 offset:384
  v_lshlrev_b32 v52, 16, v36
  v_and_b32 v53, 0xffff0000, v36
  v_mfma_f32_16x16x32_bf16 a[24:27], v[68:71], a[40:43], a[24:27]
  v_lshlrev_b32 v54, 16, v37
  v_and_b32 v55, 0xffff0000, v37
  s_waitcnt lgkmcnt(2)
  v_mfma_f32_16x16x32_bf16 a[28:31], v[96:99], a[44:47], a[28:31]
  ds_read_b128 a[40:43], v4 offset:320
  v_cvt_pk_bf16_f32 v36, v44, v45
  v_cvt_pk_bf16_f32 v37, v46, v47
  v_mfma_f32_16x16x32_bf16 a[24:27], v[64:67], a[44:47], a[24:27]
  v_lshlrev_b32 v44, 16, v36
  v_and_b32 v45, 0xffff0000, v36
  s_waitcnt lgkmcnt(2)
  v_mfma_f32_16x16x32_bf16 a[28:31], v[92:95], a[32:35], a[28:31]
  ds_read_b128 a[44:47], v4 offset:256
  v_lshlrev_b32 v46, 16, v37
  v_and_b32 v47, 0xffff0000, v37
  s_waitcnt lgkmcnt(2)
  v_mfma_f32_16x16x32_bf16 a[28:31], v[88:91], a[36:39], a[28:31]
  ds_read_b128 a[32:35], v4 offset:192
  v_add_f32 v44, v44, v52
  v_add_f32 v45, v45, v53
  s_waitcnt lgkmcnt(2)
  v_mfma_f32_16x16x32_bf16 a[28:31], v[84:87], a[40:43], a[28:31]
  ds_read_b128 a[36:39], v4 offset:128
  v_add_f32 v46, v46, v54
  v_add_f32 v47, v47, v55
  s_waitcnt lgkmcnt(2)
  v_mfma_f32_16x16x32_bf16 a[28:31], v[80:83], a[44:47], a[28:31]
  ds_read_b128 a[40:43], v4 offset:64
  v_cvt_pk_bf16_f32 v36, v44, v45
  v_cvt_pk_bf16_f32 v37, v46, v47
  s_waitcnt lgkmcnt(2)
  v_mfma_f32_16x16x32_bf16 a[28:31], v[76:79], a[32:35], a[28:31]
  ds_read_b128 a[44:47], v4 offset:0
  v_lshlrev_b32 v44, 16, v36
  v_and_b32 v45, 0xffff0000, v36
  s_waitcnt lgkmcnt(2)
  v_mfma_f32_16x16x32_bf16 a[28:31], v[72:75], a[36:39], a[28:31]
  v_lshlrev_b32 v46, 16, v37
  v_and_b32 v47, 0xffff0000, v37
  s_waitcnt lgkmcnt(1)
  v_mfma_f32_16x16x32_bf16 a[28:31], v[68:71], a[40:43], a[28:31]
  v_add_f32 v44, v44, v32
  v_add_f32 v45, v45, v33
  s_waitcnt lgkmcnt(0)
  v_mfma_f32_16x16x32_bf16 a[28:31], v[64:67], a[44:47], a[28:31]
  v_add_f32 v46, v46, v34
  v_add_f32 v47, v47, v35
  v_cvt_pk_bf16_f32 v36, v44, v45
  v_cvt_pk_bf16_f32 v37, v46, v47
  s_add_u32 s6, s62, 1310720
  buffer_store_dwordx2 v[36:37], v9, s[8:11], s6 offen sc1
  ds_read_b64 v[36:37], v7 offset:3072
  ds_read_b64 v[38:39], v8 offset:3072
  v_accvgpr_read_b32 v44, a24
  v_accvgpr_read_b32 v45, a25
  v_accvgpr_read_b32 v46, a26
  v_accvgpr_read_b32 v47, a27
  s_waitcnt lgkmcnt(0)
  v_lshlrev_b32 v48, 16, v36
  v_and_b32 v49, 0xffff0000, v36
  v_lshlrev_b32 v50, 16, v37
  v_and_b32 v51, 0xffff0000, v37
  v_lshlrev_b32 v32, 16, v38
  v_and_b32 v33, 0xffff0000, v38
  v_lshlrev_b32 v34, 16, v39
  v_and_b32 v35, 0xffff0000, v39
  v_mul_f32 v52, v48, v31
  v_mul_f32 v53, v49, v31
  v_mul_f32 v54, v50, v31
  v_mul_f32 v55, v51, v31
  v_fmac_f32 v44, s61, v48
  v_fmac_f32 v45, s61, v49
  v_fmac_f32 v46, s61, v50
  v_fmac_f32 v47, s61, v51
  v_cvt_pk_bf16_f32 v36, v52, v53
  v_cvt_pk_bf16_f32 v37, v54, v55
  v_lshlrev_b32 v52, 16, v36
  v_and_b32 v53, 0xffff0000, v36
  v_lshlrev_b32 v54, 16, v37
  v_and_b32 v55, 0xffff0000, v37
  v_cvt_pk_bf16_f32 v36, v44, v45
  v_cvt_pk_bf16_f32 v37, v46, v47
  v_lshlrev_b32 v44, 16, v36
  v_and_b32 v45, 0xffff0000, v36
  v_lshlrev_b32 v46, 16, v37
  v_and_b32 v47, 0xffff0000, v37
  v_add_f32 v44, v44, v52
  v_add_f32 v45, v45, v53
  v_add_f32 v46, v46, v54
  v_add_f32 v47, v47, v55
  v_cvt_pk_bf16_f32 v36, v44, v45
  v_cvt_pk_bf16_f32 v37, v46, v47
  v_lshlrev_b32 v44, 16, v36
  v_and_b32 v45, 0xffff0000, v36
  v_lshlrev_b32 v46, 16, v37
  v_and_b32 v47, 0xffff0000, v37
  v_add_f32 v44, v44, v32
  v_add_f32 v45, v45, v33
  v_add_f32 v46, v46, v34
  v_add_f32 v47, v47, v35
  v_cvt_pk_bf16_f32 v36, v44, v45
  v_cvt_pk_bf16_f32 v37, v46, v47
  s_add_u32 s6, s62, 1572864
  buffer_store_dwordx2 v[36:37], v9, s[8:11], s6 offen sc1
  ds_read_b64 v[36:37], v7 offset:3584
  ds_read_b64 v[38:39], v8 offset:3584
  v_accvgpr_read_b32 v44, a28
  v_accvgpr_read_b32 v45, a29
  v_accvgpr_read_b32 v46, a30
  v_accvgpr_read_b32 v47, a31
  s_waitcnt lgkmcnt(0)
  v_lshlrev_b32 v48, 16, v36
  v_and_b32 v49, 0xffff0000, v36
  v_lshlrev_b32 v50, 16, v37
  v_and_b32 v51, 0xffff0000, v37
  v_lshlrev_b32 v32, 16, v38
  v_and_b32 v33, 0xffff0000, v38
  v_lshlrev_b32 v34, 16, v39
  v_and_b32 v35, 0xffff0000, v39
  v_mul_f32 v52, v48, v31
  v_mul_f32 v53, v49, v31
  v_mul_f32 v54, v50, v31
  v_mul_f32 v55, v51, v31
  v_fmac_f32 v44, s61, v48
  v_fmac_f32 v45, s61, v49
  v_fmac_f32 v46, s61, v50
  v_fmac_f32 v47, s61, v51
  v_cvt_pk_bf16_f32 v36, v52, v53
  v_cvt_pk_bf16_f32 v37, v54, v55
  v_lshlrev_b32 v52, 16, v36
  v_and_b32 v53, 0xffff0000, v36
  v_lshlrev_b32 v54, 16, v37
  v_and_b32 v55, 0xffff0000, v37
  v_cvt_pk_bf16_f32 v36, v44, v45
  v_cvt_pk_bf16_f32 v37, v46, v47
  v_lshlrev_b32 v44, 16, v36
  v_and_b32 v45, 0xffff0000, v36
  v_lshlrev_b32 v46, 16, v37
  v_and_b32 v47, 0xffff0000, v37
  v_add_f32 v44, v44, v52
  v_add_f32 v45, v45, v53
  v_add_f32 v46, v46, v54
  v_add_f32 v47, v47, v55
  v_cvt_pk_bf16_f32 v36, v44, v45
  v_cvt_pk_bf16_f32 v37, v46, v47
  v_lshlrev_b32 v44, 16, v36
  v_and_b32 v45, 0xffff0000, v36
  v_lshlrev_b32 v46, 16, v37
  v_and_b32 v47, 0xffff0000, v37
  v_add_f32 v44, v44, v32
  v_add_f32 v45, v45, v33
  v_add_f32 v46, v46, v34
  v_add_f32 v47, v47, v35
  v_cvt_pk_bf16_f32 v36, v44, v45
  v_cvt_pk_bf16_f32 v37, v46, v47
  s_add_u32 s6, s62, 1835008
  buffer_store_dwordx2 v[36:37], v9, s[8:11], s6 offen sc1
  s_lshl_b32 s6, s60, 2
  s_add_u32 s6, s6, 0x710000
  v_mov_b32 v16, 127
  s_waitcnt vmcnt(0)
  s_mov_b64 exec, 1
  buffer_store_dword v16, v1, s[8:11], s6 offen sc1
  s_mov_b64 exec, -1
  s_barrier
  s_cmp_eq_u32 s4, 1
  s_cbranch_scc1 L_rec2
  s_cmp_eq_u32 s4, 6
  s_cbranch_scc1 L_o2
  s_branch L_p2
L_c:
  v_lshlrev_b32 v4, 2, v0
  v_lshlrev_b32 v0, 4, v0
  v_mov_b32 v1, 0
  v_mov_b32 v2, 150016
  s_lshl_b32 s6, s5, 8
  s_lshl_b32 s7, s3, 13
  s_add_u32 s6, s6, s7
  s_add_u32 s6, s6, 0x738000
  buffer_store_dword v1, v4, s[8:11], s6 offen sc1
  s_lshl_b32 s6, s5, 3
  s_add_u32 s6, s6, 0x710800
  s_mov_b64 exec, 3
  buffer_store_dword v1, v4, s[8:11], s6 offen sc1
  buffer_store_dword v1, v4, s[8:11], s6 offen offset:256 sc1
  s_mov_b64 exec, -1
  s_lshl_b32 s6, s5, 10
  s_lshl_b32 s7, s3, 15
  s_add_u32 s6, s6, s7
  s_add_u32 s6, s6, 0x8800000
  v_mov_b32 v8, 0
  v_mov_b32 v9, 0
  v_mov_b32 v10, 0
  v_mov_b32 v11, 0
  buffer_store_dwordx4 v[8:11], v0, s[8:11], s6 offen sc1
  s_add_u32 s6, s6, 0x20000
  buffer_store_dwordx4 v[8:11], v0, s[8:11], s6 offen sc1
  s_add_u32 s6, s6, 0x20000
  buffer_store_dwordx4 v[8:11], v0, s[8:11], s6 offen sc1
  s_add_u32 s6, s6, 0x20000
  buffer_store_dwordx4 v[8:11], v0, s[8:11], s6 offen sc1
  s_add_u32 s6, s6, 0x7a0000
  buffer_store_dwordx4 v[8:11], v0, s[8:11], s6 offen sc1
  s_add_u32 s6, s6, 0x20000
  buffer_store_dwordx4 v[8:11], v0, s[8:11], s6 offen sc1
  s_add_u32 s6, s6, 0x20000
  buffer_store_dwordx4 v[8:11], v0, s[8:11], s6 offen sc1
  s_add_u32 s6, s6, 0x20000
  buffer_store_dwordx4 v[8:11], v0, s[8:11], s6 offen sc1
  s_waitcnt vmcnt(0)
  s_barrier
  s_cmp_lg_u32 s3, 0
  s_cbranch_scc1 L_sd_111
  s_mov_b64 exec, 1
  s_and_b32 s6, s4, 3
  s_lshl_b32 s6, s6, 6
  v_mov_b32 v6, 16
  v_mov_b32 v7, 1
  buffer_atomic_add v7, v6, s[12:15], s6 offen sc1
  s_mov_b64 exec, -1
L_sd_111:
  v_bfe_u32 v5, v0, 5, 4
  v_mul_u32_u24 v5, 4128, v5
  v_and_b32 v6, 16, v0
  v_add3_u32 v5, v5, v6, v1
  v_add_u32 v5, 73728, v5
  ds_write_b128 v5, v[8:11]
  ds_write_b128 v2, v[8:11]
  ds_write_b128 v2, v[8:11] offset:16
  v_accvgpr_write_b32 a0, 0
  v_accvgpr_write_b32 a1, 0
  v_accvgpr_write_b32 a2, 0
  v_accvgpr_write_b32 a3, 0
  v_accvgpr_write_b32 a4, 0
  v_accvgpr_write_b32 a5, 0
  v_accvgpr_write_b32 a6, 0
  v_accvgpr_write_b32 a7, 0
  v_accvgpr_write_b32 a8, 0
  v_accvgpr_write_b32 a9, 0
  v_accvgpr_write_b32 a10, 0
  v_accvgpr_write_b32 a11, 0
  v_accvgpr_write_b32 a12, 0
  v_accvgpr_write_b32 a13, 0
  v_accvgpr_write_b32 a14, 0
  v_accvgpr_write_b32 a15, 0
  v_accvgpr_write_b32 a16, 0
  v_accvgpr_write_b32 a17, 0
  v_accvgpr_write_b32 a18, 0
  v_accvgpr_write_b32 a19, 0
  v_accvgpr_write_b32 a20, 0
  v_accvgpr_write_b32 a21, 0
  v_accvgpr_write_b32 a22, 0
  v_accvgpr_write_b32 a23, 0
  v_accvgpr_write_b32 a24, 0
  v_accvgpr_write_b32 a25, 0
  v_accvgpr_write_b32 a26, 0
  v_accvgpr_write_b32 a27, 0
  v_accvgpr_write_b32 a28, 0
  v_accvgpr_write_b32 a29, 0
  v_accvgpr_write_b32 a30, 0
  v_accvgpr_write_b32 a31, 0
  v_accvgpr_write_b32 a32, 0
  v_accvgpr_write_b32 a33, 0
  v_accvgpr_write_b32 a34, 0
  v_accvgpr_write_b32 a35, 0
  v_accvgpr_write_b32 a36, 0
  v_accvgpr_write_b32 a37, 0
  v_accvgpr_write_b32 a38, 0
  v_accvgpr_write_b32 a39, 0
  v_accvgpr_write_b32 a40, 0
  v_accvgpr_write_b32 a41, 0
  v_accvgpr_write_b32 a42, 0
  v_accvgpr_write_b32 a43, 0
  v_accvgpr_write_b32 a44, 0
  v_accvgpr_write_b32 a45, 0
  v_accvgpr_write_b32 a46, 0
  v_accvgpr_write_b32 a47, 0
  v_accvgpr_write_b32 a48, 0
  v_accvgpr_write_b32 a49, 0
  v_accvgpr_write_b32 a50, 0
  v_accvgpr_write_b32 a51, 0
  v_accvgpr_write_b32 a52, 0
  v_accvgpr_write_b32 a53, 0
  v_accvgpr_write_b32 a54, 0
  v_accvgpr_write_b32 a55, 0
  v_accvgpr_write_b32 a56, 0
  v_accvgpr_write_b32 a57, 0
  v_accvgpr_write_b32 a58, 0
  v_accvgpr_write_b32 a59, 0
  v_accvgpr_write_b32 a60, 0
  v_accvgpr_write_b32 a61, 0
  v_accvgpr_write_b32 a62, 0
  v_accvgpr_write_b32 a63, 0
  v_accvgpr_write_b32 a64, 0
  v_accvgpr_write_b32 a65, 0
  v_accvgpr_write_b32 a66, 0
  v_accvgpr_write_b32 a67, 0
  v_accvgpr_write_b32 a68, 0
  v_accvgpr_write_b32 a69, 0
  v_accvgpr_write_b32 a70, 0
  v_accvgpr_write_b32 a71, 0
  v_accvgpr_write_b32 a72, 0
  v_accvgpr_write_b32 a73, 0
  v_accvgpr_write_b32 a74, 0
  v_accvgpr_write_b32 a75, 0
  v_accvgpr_write_b32 a76, 0
  v_accvgpr_write_b32 a77, 0
  v_accvgpr_write_b32 a78, 0
  v_accvgpr_write_b32 a79, 0
  v_accvgpr_write_b32 a80, 0
  v_accvgpr_write_b32 a81, 0
  v_accvgpr_write_b32 a82, 0
  v_accvgpr_write_b32 a83, 0
  v_accvgpr_write_b32 a84, 0
  v_accvgpr_write_b32 a85, 0
  v_accvgpr_write_b32 a86, 0
  v_accvgpr_write_b32 a87, 0
  v_accvgpr_write_b32 a88, 0
  v_accvgpr_write_b32 a89, 0
  v_accvgpr_write_b32 a90, 0
  v_accvgpr_write_b32 a91, 0
  v_accvgpr_write_b32 a92, 0
  v_accvgpr_write_b32 a93, 0
  v_accvgpr_write_b32 a94, 0
  v_accvgpr_write_b32 a95, 0
  v_accvgpr_write_b32 a96, 0
  v_accvgpr_write_b32 a97, 0
  v_accvgpr_write_b32 a98, 0
  v_accvgpr_write_b32 a99, 0
  v_accvgpr_write_b32 a100, 0
  v_accvgpr_write_b32 a101, 0
  v_accvgpr_write_b32 a102, 0
  v_accvgpr_write_b32 a103, 0
  v_accvgpr_write_b32 a104, 0
  v_accvgpr_write_b32 a105, 0
  v_accvgpr_write_b32 a106, 0
  v_accvgpr_write_b32 a107, 0
  v_accvgpr_write_b32 a108, 0
  v_accvgpr_write_b32 a109, 0
  v_accvgpr_write_b32 a110, 0
  v_accvgpr_write_b32 a111, 0
  v_accvgpr_write_b32 a112, 0
  v_accvgpr_write_b32 a113, 0
  v_accvgpr_write_b32 a114, 0
  v_accvgpr_write_b32 a115, 0
  v_accvgpr_write_b32 a116, 0
  v_accvgpr_write_b32 a117, 0
  v_accvgpr_write_b32 a118, 0
  v_accvgpr_write_b32 a119, 0
  v_accvgpr_write_b32 a120, 0
  v_accvgpr_write_b32 a121, 0
  v_accvgpr_write_b32 a122, 0
  v_accvgpr_write_b32 a123, 0
  v_accvgpr_write_b32 a124, 0
  v_accvgpr_write_b32 a125, 0
  v_accvgpr_write_b32 a126, 0
  v_accvgpr_write_b32 a127, 0
  v_accvgpr_write_b32 a128, 0
  v_accvgpr_write_b32 a129, 0
  v_accvgpr_write_b32 a130, 0
  v_accvgpr_write_b32 a131, 0
  v_accvgpr_write_b32 a132, 0
  v_accvgpr_write_b32 a133, 0
  v_accvgpr_write_b32 a134, 0
  v_accvgpr_write_b32 a135, 0
  v_accvgpr_write_b32 a136, 0
  v_accvgpr_write_b32 a137, 0
  v_accvgpr_write_b32 a138, 0
  v_accvgpr_write_b32 a139, 0
  v_accvgpr_write_b32 a140, 0
  v_accvgpr_write_b32 a141, 0
  v_accvgpr_write_b32 a142, 0
  v_accvgpr_write_b32 a143, 0
  v_accvgpr_write_b32 a144, 0
  v_accvgpr_write_b32 a145, 0
  v_accvgpr_write_b32 a146, 0
  v_accvgpr_write_b32 a147, 0
  v_accvgpr_write_b32 a148, 0
  v_accvgpr_write_b32 a149, 0
  v_accvgpr_write_b32 a150, 0
  v_accvgpr_write_b32 a151, 0
  v_accvgpr_write_b32 a152, 0
  v_accvgpr_write_b32 a153, 0
  v_accvgpr_write_b32 a154, 0
  v_accvgpr_write_b32 a155, 0
  v_accvgpr_write_b32 a156, 0
  v_accvgpr_write_b32 a157, 0
  v_accvgpr_write_b32 a158, 0
  v_accvgpr_write_b32 a159, 0
  v_accvgpr_write_b32 a160, 0
  v_accvgpr_write_b32 a161, 0
  v_accvgpr_write_b32 a162, 0
  v_accvgpr_write_b32 a163, 0
  v_accvgpr_write_b32 a164, 0
  v_accvgpr_write_b32 a165, 0
  v_accvgpr_write_b32 a166, 0
  v_accvgpr_write_b32 a167, 0
  v_accvgpr_write_b32 a168, 0
  v_accvgpr_write_b32 a169, 0
  v_accvgpr_write_b32 a170, 0
  v_accvgpr_write_b32 a171, 0
  v_accvgpr_write_b32 a172, 0
  v_accvgpr_write_b32 a173, 0
  v_accvgpr_write_b32 a174, 0
  v_accvgpr_write_b32 a175, 0
  v_accvgpr_write_b32 a176, 0
  v_accvgpr_write_b32 a177, 0
  v_accvgpr_write_b32 a178, 0
  v_accvgpr_write_b32 a179, 0
  v_accvgpr_write_b32 a180, 0
  v_accvgpr_write_b32 a181, 0
  v_accvgpr_write_b32 a182, 0
  v_accvgpr_write_b32 a183, 0
  v_accvgpr_write_b32 a184, 0
  v_accvgpr_write_b32 a185, 0
  v_accvgpr_write_b32 a186, 0
  v_accvgpr_write_b32 a187, 0
  v_accvgpr_write_b32 a188, 0
  v_accvgpr_write_b32 a189, 0
  v_accvgpr_write_b32 a190, 0
  v_accvgpr_write_b32 a191, 0
  v_accvgpr_write_b32 a192, 0
  v_accvgpr_write_b32 a193, 0
  v_accvgpr_write_b32 a194, 0
  v_accvgpr_write_b32 a195, 0
  v_accvgpr_write_b32 a196, 0
  v_accvgpr_write_b32 a197, 0
  v_accvgpr_write_b32 a198, 0
  v_accvgpr_write_b32 a199, 0
  v_accvgpr_write_b32 a200, 0
  v_accvgpr_write_b32 a201, 0
  v_accvgpr_write_b32 a202, 0
  v_accvgpr_write_b32 a203, 0
  v_accvgpr_write_b32 a204, 0
  v_accvgpr_write_b32 a205, 0
  v_accvgpr_write_b32 a206, 0
  v_accvgpr_write_b32 a207, 0
  v_accvgpr_write_b32 a208, 0
  v_accvgpr_write_b32 a209, 0
  v_accvgpr_write_b32 a210, 0
  v_accvgpr_write_b32 a211, 0
  v_accvgpr_write_b32 a212, 0
  v_accvgpr_write_b32 a213, 0
  v_accvgpr_write_b32 a214, 0
  v_accvgpr_write_b32 a215, 0
  v_accvgpr_write_b32 a216, 0
  v_accvgpr_write_b32 a217, 0
  v_accvgpr_write_b32 a218, 0
  v_accvgpr_write_b32 a219, 0
  v_accvgpr_write_b32 a220, 0
  v_accvgpr_write_b32 a221, 0
  v_accvgpr_write_b32 a222, 0
  v_accvgpr_write_b32 a223, 0
  v_accvgpr_write_b32 a224, 0
  v_accvgpr_write_b32 a225, 0
  v_accvgpr_write_b32 a226, 0
  v_accvgpr_write_b32 a227, 0
  v_accvgpr_write_b32 a228, 0
  v_accvgpr_write_b32 a229, 0
  v_accvgpr_write_b32 a230, 0
  v_accvgpr_write_b32 a231, 0
  v_accvgpr_write_b32 a232, 0
  v_accvgpr_write_b32 a233, 0
  v_accvgpr_write_b32 a234, 0
  v_accvgpr_write_b32 a235, 0
  v_accvgpr_write_b32 a236, 0
  v_accvgpr_write_b32 a237, 0
  v_accvgpr_write_b32 a238, 0
  v_accvgpr_write_b32 a239, 0
  v_accvgpr_write_b32 a240, 0
  v_accvgpr_write_b32 a241, 0
  v_accvgpr_write_b32 a242, 0
  v_accvgpr_write_b32 a243, 0
  v_accvgpr_write_b32 a244, 0
  v_accvgpr_write_b32 a245, 0
  v_accvgpr_write_b32 a246, 0
  v_accvgpr_write_b32 a247, 0
  v_accvgpr_write_b32 a248, 0
  v_accvgpr_write_b32 a249, 0
  v_accvgpr_write_b32 a250, 0
  v_accvgpr_write_b32 a251, 0
  v_accvgpr_write_b32 a252, 0
  v_accvgpr_write_b32 a253, 0
  v_accvgpr_write_b32 a254, 0
  v_accvgpr_write_b32 a255, 0
  s_cmp_lg_u32 s3, 0
  s_cbranch_scc1 L_wdo_113
  s_mov_b32 s7, 0
  v_mbcnt_lo_u32_b32 v8, -1, 0
  v_and_b32 v8, 3, v8
  v_lshlrev_b32 v8, 6, v8
L_wd_112:
  buffer_load_dword v9, v8, s[12:15], 0 offen offset:16 sc1
  s_waitcnt vmcnt(0)
  v_cmp_ne_u32 vcc, 64, v9
  s_cbranch_vccz L_wdo_113
  s_add_u32 s7, s7, 1
  s_cmp_lt_u32 s7, 131072
  s_cbranch_scc1 L_wd_112
  s_mov_b32 s6, 40
  s_branch L_err
L_wdo_113:
  s_barrier
  v_and_b32 v4, 60, v4
  s_lshl_b32 s6, s5, 6
  s_add_u32 s34, s6, 0x710000
  s_mov_b32 s33, 127
  s_mov_b32 s7, 0
L_pl_114:
  buffer_load_dword v8, v4, s[8:11], s34 offen offset:0 sc1
  s_waitcnt vmcnt(0)
  v_cmp_gt_u32 vcc, s33, v8
  s_cbranch_vccz L_plo_115
  s_add_u32 s7, s7, 1
  s_cmp_lt_u32 s7, 131072
  s_cbranch_scc1 L_pl_114
  s_mov_b32 s6, 41
  s_branch L_err
L_plo_115:
  s_mul_i32 s34, s5, 73728
  s_mul_i32 s35, s3, 18432
  s_add_u32 s34, s34, s35
  s_add_u32 s34, s34, 0x400000
  s_add_u32 m0, s35, 0
  s_add_u32 s6, s34, 0
  buffer_load_dwordx4 v0, s[8:11], s6 offen offset:0 lds
  buffer_load_dwordx4 v0, s[8:11], s6 offen offset:1024 lds
  buffer_load_dwordx4 v0, s[8:11], s6 offen offset:2048 lds
  buffer_load_dwordx4 v0, s[8:11], s6 offen offset:3072 lds
  s_add_u32 m0, s35, 4096
  s_add_u32 s6, s34, 4096
  buffer_load_dwordx4 v0, s[8:11], s6 offen offset:0 lds
  buffer_load_dwordx4 v0, s[8:11], s6 offen offset:1024 lds
  buffer_load_dwordx4 v0, s[8:11], s6 offen offset:2048 lds
  buffer_load_dwordx4 v0, s[8:11], s6 offen offset:3072 lds
  s_add_u32 m0, s35, 8192
  s_add_u32 s6, s34, 8192
  buffer_load_dwordx4 v0, s[8:11], s6 offen offset:0 lds
  buffer_load_dwordx4 v0, s[8:11], s6 offen offset:1024 lds
  buffer_load_dwordx4 v0, s[8:11], s6 offen offset:2048 lds
  buffer_load_dwordx4 v0, s[8:11], s6 offen offset:3072 lds
  s_add_u32 m0, s35, 12288
  s_add_u32 s6, s34, 12288
  buffer_load_dwordx4 v0, s[8:11], s6 offen offset:0 lds
  buffer_load_dwordx4 v0, s[8:11], s6 offen offset:1024 lds
  buffer_load_dwordx4 v0, s[8:11], s6 offen offset:2048 lds
  buffer_load_dwordx4 v0, s[8:11], s6 offen offset:3072 lds
  s_add_u32 m0, s35, 16384
  s_add_u32 s6, s34, 16384
  buffer_load_dwordx4 v0, s[8:11], s6 offen offset:0 lds
  buffer_load_dwordx4 v0, s[8:11], s6 offen offset:1024 lds
  s_mov_b32 s32, 0
  s_waitcnt vmcnt(0) lgkmcnt(0)
  s_barrier
  s_cmp_ge_u32 s3, 2
  s_cbranch_scc1 L_c_res
  s_mov_b32 s16, s76
  s_mov_b32 s17, s77
  s_mov_b32 s18, 0x400
  s_mov_b32 s19, 0x20000
  v_bfe_u32 v16, v0, 4, 4
  v_lshrrev_b32 v17, 8, v0
  v_lshrrev_b32 v18, 7, v0
  s_lshl_b32 s6, s5, 5
  s_lshl_b32 s7, s3, 4
  s_add_u32 s6, s6, s7
  v_lshlrev_b32 v19, 1, v18
  buffer_load_ushort v12, v19, s[16:19], s6 offen
  s_mul_i32 s6, s3, 36864
  v_mul_u32_u24 v19, 4608, v18
  v_add_u32 v19, s6, v19
  ds_read_b32 v11, v19 offset:4576
  s_add_u32 s6, s6, 480
  v_lshlrev_b32 v19, 5, v16
  v_sub_u32 v19, s6, v19
  v_lshl_add_u32 v4, v17, 4, v19
  s_mul_i32 s6, s3, 33024
  s_add_u32 s6, s6, 73728
  v_lshlrev_b32 v19, 1, v16
  v_lshl_add_u32 v19, v17, 4, v19
  v_add_u32 v5, s6, v19
  v_mul_u32_u24 v19, 4128, v18
  v_bfe_u32 v20, v0, 1, 6
  v_add3_u32 v19, v19, v20, s6
  v_add_u32 v8, 32, v19
  s_lshl_b32 s6, s3, 10
  s_add_u32 s6, s6, 147968
  v_add_u32 v7, s6, v0
  v_and_b32 v19, 1, v16
  v_lshlrev_b32 v19, 6, v19
  v_lshl_add_u32 v19, v17, 4, v19
  v_add_u32 v6, s6, v19
  v_lshrrev_b32 v10, 1, v0
  s_lshl_b32 s6, s3, 9
  s_add_u32 s35, s6, 139776
  s_lshl_b32 s7, s5, 10
  s_add_u32 s6, s6, s7
  s_add_u32 s40, s6, 0x200000
  s_lshl_b32 s6, s5, 3
  s_lshl_b32 s7, s3, 2
  s_add_u32 s6, s6, s7
  s_add_u32 s39, s6, 0x710800
  v_add_u32 v14, s7, v2
  s_waitcnt vmcnt(0) lgkmcnt(0)
  v_lshlrev_b32 v12, 16, v12
  v_and_b32 v15, 2, v5
  v_and_b32 v5, -4, v5
  v_add_u32 v104, 0, v5
  v_add_u32 v105, 4128, v5
  v_add_u32 v106, 8256, v5
  v_add_u32 v107, 12384, v5
  v_add_u32 v108, 16512, v5
  v_add_u32 v109, 20640, v5
  v_add_u32 v110, 24768, v5
  v_add_u32 v111, 28896, v5
L_c_conv0:
  s_add_u32 s33, s32, 1
  s_and_b32 s6, s32, 7
  s_lshl_b32 s7, s6, 10
  s_add_u32 s7, s7, s35
  v_add_u32 v9, s7, v10
  s_lshl_b32 s6, s6, 1
  s_lshl_b32 s42, 0x30003, s6
  v_mov_b32 v13, s33
  ds_read_b128 v[48:51], v4 offset:3584
  ds_read_b128 v[52:55], v4 offset:8192
  ds_read_b128 v[56:59], v4 offset:12800
  ds_read_b128 v[60:63], v4 offset:17408
  ds_read_b128 v[64:67], v4 offset:22016
  ds_read_b128 v[68:71], v4 offset:26624
  ds_read_b128 v[72:75], v4 offset:31232
  ds_read_b128 v[76:79], v4 offset:35840
  s_mov_b32 s7, 0
L_lw_116:
  ds_read_b32 v88, v2 offset:0
  s_waitcnt lgkmcnt(0)
  v_cmp_gt_i32 vcc, s33, v88
  s_cbranch_vccz L_lwo_117
  s_add_u32 s7, s7, 1
  s_cmp_lt_u32 s7, 131072
  s_cbranch_scc1 L_lw_116
  s_mov_b32 s6, 42
  s_branch L_err
L_lwo_117:
  ds_read2_b32 v[112:113], v104 offset0:0 offset1:1
  ds_read2_b32 v[114:115], v104 offset0:2 offset1:3
  ds_read_b32 v116, v104 offset:16
  ds_read2_b32 v[118:119], v105 offset0:0 offset1:1
  ds_read2_b32 v[120:121], v105 offset0:2 offset1:3
  ds_read_b32 v122, v105 offset:16
  ds_read2_b32 v[124:125], v106 offset0:0 offset1:1
  ds_read2_b32 v[126:127], v106 offset0:2 offset1:3
  ds_read_b32 v128, v106 offset:16
  ds_read2_b32 v[130:131], v107 offset0:0 offset1:1
  ds_read2_b32 v[132:133], v107 offset0:2 offset1:3
  ds_read_b32 v134, v107 offset:16
  s_waitcnt lgkmcnt(9)
  v_alignbyte_b32 v16, v113, v112, v15
  v_alignbyte_b32 v17, v114, v113, v15
  v_alignbyte_b32 v18, v115, v114, v15
  v_alignbyte_b32 v19, v116, v115, v15
  ds_read2_b32 v[112:113], v108 offset0:0 offset1:1
  ds_read2_b32 v[114:115], v108 offset0:2 offset1:3
  ds_read_b32 v116, v108 offset:16
  s_waitcnt lgkmcnt(9)
  v_alignbyte_b32 v20, v119, v118, v15
  v_alignbyte_b32 v21, v120, v119, v15
  v_alignbyte_b32 v22, v121, v120, v15
  v_alignbyte_b32 v23, v122, v121, v15
  ds_read2_b32 v[118:119], v109 offset0:0 offset1:1
  ds_read2_b32 v[120:121], v109 offset0:2 offset1:3
  ds_read_b32 v122, v109 offset:16
  v_mfma_f32_16x16x32_bf16 a[0:3], v[16:19], v[48:51], a[0:3]
  s_waitcnt lgkmcnt(9)
  v_alignbyte_b32 v24, v125, v124, v15
  v_alignbyte_b32 v25, v126, v125, v15
  v_alignbyte_b32 v26, v127, v126, v15
  v_alignbyte_b32 v27, v128, v127, v15
  ds_read2_b32 v[124:125], v110 offset0:0 offset1:1
  ds_read2_b32 v[126:127], v110 offset0:2 offset1:3
  ds_read_b32 v128, v110 offset:16
  v_mfma_f32_16x16x32_bf16 a[32:35], v[20:23], v[52:55], a[32:35]
  s_waitcnt lgkmcnt(9)
  v_alignbyte_b32 v28, v131, v130, v15
  v_alignbyte_b32 v29, v132, v131, v15
  v_alignbyte_b32 v30, v133, v132, v15
  v_alignbyte_b32 v31, v134, v133, v15
  ds_read2_b32 v[130:131], v111 offset0:0 offset1:1
  ds_read2_b32 v[132:133], v111 offset0:2 offset1:3
  ds_read_b32 v134, v111 offset:16
  v_mfma_f32_16x16x32_bf16 a[64:67], v[24:27], v[56:59], a[64:67]
  s_waitcnt lgkmcnt(9)
  v_alignbyte_b32 v32, v113, v112, v15
  v_alignbyte_b32 v33, v114, v113, v15
  v_alignbyte_b32 v34, v115, v114, v15
  v_alignbyte_b32 v35, v116, v115, v15
  ds_read_b64 v[84:85], v8
  ds_read_b64 v[86:87], v9
  v_mfma_f32_16x16x32_bf16 a[96:99], v[28:31], v[60:63], a[96:99]
  s_waitcnt lgkmcnt(8)
  v_alignbyte_b32 v36, v119, v118, v15
  v_alignbyte_b32 v37, v120, v119, v15
  v_alignbyte_b32 v38, v121, v120, v15
  v_alignbyte_b32 v39, v122, v121, v15
  v_mfma_f32_16x16x32_bf16 a[128:131], v[32:35], v[64:67], a[128:131]
  s_waitcnt lgkmcnt(5)
  v_alignbyte_b32 v40, v125, v124, v15
  v_alignbyte_b32 v41, v126, v125, v15
  v_alignbyte_b32 v42, v127, v126, v15
  v_alignbyte_b32 v43, v128, v127, v15
  v_mfma_f32_16x16x32_bf16 a[160:163], v[36:39], v[68:71], a[160:163]
  s_waitcnt lgkmcnt(2)
  v_alignbyte_b32 v44, v131, v130, v15
  v_alignbyte_b32 v45, v132, v131, v15
  v_alignbyte_b32 v46, v133, v132, v15
  v_alignbyte_b32 v47, v134, v133, v15
  v_mfma_f32_16x16x32_bf16 a[192:195], v[40:43], v[72:75], a[192:195]
  s_nop 0
  v_mfma_f32_16x16x32_bf16 a[224:227], v[44:47], v[76:79], a[224:227]
  s_waitcnt lgkmcnt(0)
  ds_read_b128 v[48:51], v4 offset:3072
  ds_read_b128 v[52:55], v4 offset:7680
  ds_read_b128 v[56:59], v4 offset:12288
  ds_read_b128 v[60:63], v4 offset:16896
  ds_read_b128 v[64:67], v4 offset:21504
  ds_read_b128 v[68:71], v4 offset:26112
  ds_read_b128 v[72:75], v4 offset:30720
  ds_read_b128 v[76:79], v4 offset:35328
  s_mov_b32 exec_lo, s42
  s_mov_b32 exec_hi, s42
  ds_write_b128 v6, a[0:3] offset:0
  ds_write_b128 v6, a[32:35] offset:128
  ds_write_b128 v6, a[64:67] offset:256
  ds_write_b128 v6, a[96:99] offset:384
  ds_write_b128 v6, a[128:131] offset:512
  ds_write_b128 v6, a[160:163] offset:640
  ds_write_b128 v6, a[192:195] offset:768
  ds_write_b128 v6, a[224:227] offset:896
  s_mov_b64 exec, -1
  ds_read_b128 v[80:83], v7
  ds_write_b32 v14, v13 offset:8
  v_lshlrev_b32 v88, 16, v84
  v_and_b32 v89, 0xffff0000, v84
  v_lshlrev_b32 v90, 16, v85
  v_and_b32 v91, 0xffff0000, v85
  v_lshlrev_b32 v96, 16, v86
  v_and_b32 v97, 0xffff0000, v86
  v_lshlrev_b32 v98, 16, v87
  v_and_b32 v99, 0xffff0000, v87
  v_mul_f32 v92, v88, v12
  v_mul_f32 v93, v89, v12
  v_mul_f32 v94, v90, v12
  v_mul_f32 v95, v91, v12
  v_cvt_pk_bf16_f32 v84, v92, v93
  v_cvt_pk_bf16_f32 v85, v94, v95
  v_lshlrev_b32 v92, 16, v84
  v_and_b32 v93, 0xffff0000, v84
  v_lshlrev_b32 v94, 16, v85
  v_and_b32 v95, 0xffff0000, v85
  s_waitcnt lgkmcnt(1)
  v_fmac_f32 v80, v88, v11
  v_fmac_f32 v81, v89, v11
  v_fmac_f32 v82, v90, v11
  v_fmac_f32 v83, v91, v11
  v_cvt_pk_bf16_f32 v84, v80, v81
  v_cvt_pk_bf16_f32 v85, v82, v83
  v_lshlrev_b32 v80, 16, v84
  v_and_b32 v81, 0xffff0000, v84
  v_lshlrev_b32 v82, 16, v85
  v_and_b32 v83, 0xffff0000, v85
  v_add_f32 v80, v80, v92
  v_add_f32 v81, v81, v93
  v_add_f32 v82, v82, v94
  v_add_f32 v83, v83, v95
  v_cvt_pk_bf16_f32 v84, v80, v81
  v_cvt_pk_bf16_f32 v85, v82, v83
  v_lshlrev_b32 v80, 16, v84
  v_and_b32 v81, 0xffff0000, v84
  v_lshlrev_b32 v82, 16, v85
  v_and_b32 v83, 0xffff0000, v85
  v_add_f32 v80, v80, v96
  v_add_f32 v81, v81, v97
  v_add_f32 v82, v82, v98
  v_add_f32 v83, v83, v99
  v_cvt_pk_bf16_f32 v84, v80, v81
  v_cvt_pk_bf16_f32 v85, v82, v83
  buffer_store_dwordx2 v[84:85], v10, s[8:11], s40 offen sc1
  v_mfma_f32_16x16x32_bf16 a[4:7], v[16:19], v[48:51], a[4:7]
  ds_read_b128 v[48:51], v4 offset:2560
  v_mfma_f32_16x16x32_bf16 a[36:39], v[20:23], v[52:55], a[36:39]
  ds_read_b128 v[52:55], v4 offset:7168
  v_mfma_f32_16x16x32_bf16 a[68:71], v[24:27], v[56:59], a[68:71]
  ds_read_b128 v[56:59], v4 offset:11776
  v_mfma_f32_16x16x32_bf16 a[100:103], v[28:31], v[60:63], a[100:103]
  ds_read_b128 v[60:63], v4 offset:16384
  v_mfma_f32_16x16x32_bf16 a[132:135], v[32:35], v[64:67], a[132:135]
  ds_read_b128 v[64:67], v4 offset:20992
  v_mfma_f32_16x16x32_bf16 a[164:167], v[36:39], v[68:71], a[164:167]
  ds_read_b128 v[68:71], v4 offset:25600
  v_mfma_f32_16x16x32_bf16 a[196:199], v[40:43], v[72:75], a[196:199]
  ds_read_b128 v[72:75], v4 offset:30208
  v_mfma_f32_16x16x32_bf16 a[228:231], v[44:47], v[76:79], a[228:231]
  ds_read_b128 v[76:79], v4 offset:34816
  s_waitcnt lgkmcnt(7)
  v_mfma_f32_16x16x32_bf16 a[8:11], v[16:19], v[48:51], a[8:11]
  ds_read_b128 v[48:51], v4 offset:2048
  s_waitcnt lgkmcnt(7)
  v_mfma_f32_16x16x32_bf16 a[40:43], v[20:23], v[52:55], a[40:43]
  ds_read_b128 v[52:55], v4 offset:6656
  s_waitcnt lgkmcnt(7)
  v_mfma_f32_16x16x32_bf16 a[72:75], v[24:27], v[56:59], a[72:75]
  ds_read_b128 v[56:59], v4 offset:11264
  s_waitcnt lgkmcnt(7)
  v_mfma_f32_16x16x32_bf16 a[104:107], v[28:31], v[60:63], a[104:107]
  ds_read_b128 v[60:63], v4 offset:15872
  s_waitcnt lgkmcnt(7)
  v_mfma_f32_16x16x32_bf16 a[136:139], v[32:35], v[64:67], a[136:139]
  ds_read_b128 v[64:67], v4 offset:20480
  s_waitcnt lgkmcnt(7)
  v_mfma_f32_16x16x32_bf16 a[168:171], v[36:39], v[68:71], a[168:171]
  ds_read_b128 v[68:71], v4 offset:25088
  s_waitcnt lgkmcnt(7)
  v_mfma_f32_16x16x32_bf16 a[200:203], v[40:43], v[72:75], a[200:203]
  ds_read_b128 v[72:75], v4 offset:29696
  s_waitcnt lgkmcnt(7)
  v_mfma_f32_16x16x32_bf16 a[232:235], v[44:47], v[76:79], a[232:235]
  ds_read_b128 v[76:79], v4 offset:34304
  s_waitcnt lgkmcnt(7)
  v_mfma_f32_16x16x32_bf16 a[12:15], v[16:19], v[48:51], a[12:15]
  ds_read_b128 v[48:51], v4 offset:1536
  s_waitcnt lgkmcnt(7)
  v_mfma_f32_16x16x32_bf16 a[44:47], v[20:23], v[52:55], a[44:47]
  ds_read_b128 v[52:55], v4 offset:6144
  s_waitcnt lgkmcnt(7)
  v_mfma_f32_16x16x32_bf16 a[76:79], v[24:27], v[56:59], a[76:79]
  ds_read_b128 v[56:59], v4 offset:10752
  s_waitcnt lgkmcnt(7)
  v_mfma_f32_16x16x32_bf16 a[108:111], v[28:31], v[60:63], a[108:111]
  ds_read_b128 v[60:63], v4 offset:15360
  s_waitcnt lgkmcnt(7)
  v_mfma_f32_16x16x32_bf16 a[140:143], v[32:35], v[64:67], a[140:143]
  ds_read_b128 v[64:67], v4 offset:19968
  s_waitcnt lgkmcnt(7)
  v_mfma_f32_16x16x32_bf16 a[172:175], v[36:39], v[68:71], a[172:175]
  ds_read_b128 v[68:71], v4 offset:24576
  s_waitcnt lgkmcnt(7)
  v_mfma_f32_16x16x32_bf16 a[204:207], v[40:43], v[72:75], a[204:207]
  ds_read_b128 v[72:75], v4 offset:29184
  s_waitcnt lgkmcnt(7)
  v_mfma_f32_16x16x32_bf16 a[236:239], v[44:47], v[76:79], a[236:239]
  ds_read_b128 v[76:79], v4 offset:33792
  s_waitcnt lgkmcnt(7)
  v_mfma_f32_16x16x32_bf16 a[16:19], v[16:19], v[48:51], a[16:19]
  ds_read_b128 v[48:51], v4 offset:1024
  s_waitcnt lgkmcnt(7)
  v_mfma_f32_16x16x32_bf16 a[48:51], v[20:23], v[52:55], a[48:51]
  ds_read_b128 v[52:55], v4 offset:5632
  s_waitcnt lgkmcnt(7)
  v_mfma_f32_16x16x32_bf16 a[80:83], v[24:27], v[56:59], a[80:83]
  ds_read_b128 v[56:59], v4 offset:10240
  s_waitcnt lgkmcnt(7)
  v_mfma_f32_16x16x32_bf16 a[112:115], v[28:31], v[60:63], a[112:115]
  ds_read_b128 v[60:63], v4 offset:14848
  s_waitcnt lgkmcnt(7)
  v_mfma_f32_16x16x32_bf16 a[144:147], v[32:35], v[64:67], a[144:147]
  ds_read_b128 v[64:67], v4 offset:19456
  s_waitcnt lgkmcnt(7)
  v_mfma_f32_16x16x32_bf16 a[176:179], v[36:39], v[68:71], a[176:179]
  ds_read_b128 v[68:71], v4 offset:24064
  s_waitcnt lgkmcnt(7)
  v_mfma_f32_16x16x32_bf16 a[208:211], v[40:43], v[72:75], a[208:211]
  ds_read_b128 v[72:75], v4 offset:28672
  s_waitcnt lgkmcnt(7)
  v_mfma_f32_16x16x32_bf16 a[240:243], v[44:47], v[76:79], a[240:243]
  ds_read_b128 v[76:79], v4 offset:33280
  s_waitcnt lgkmcnt(7)
  v_mfma_f32_16x16x32_bf16 a[20:23], v[16:19], v[48:51], a[20:23]
  ds_read_b128 v[48:51], v4 offset:512
  s_waitcnt lgkmcnt(7)
  v_mfma_f32_16x16x32_bf16 a[52:55], v[20:23], v[52:55], a[52:55]
  ds_read_b128 v[52:55], v4 offset:5120
  s_waitcnt lgkmcnt(7)
  v_mfma_f32_16x16x32_bf16 a[84:87], v[24:27], v[56:59], a[84:87]
  ds_read_b128 v[56:59], v4 offset:9728
  s_waitcnt lgkmcnt(7)
  v_mfma_f32_16x16x32_bf16 a[116:119], v[28:31], v[60:63], a[116:119]
  ds_read_b128 v[60:63], v4 offset:14336
  s_waitcnt lgkmcnt(7)
  v_mfma_f32_16x16x32_bf16 a[148:151], v[32:35], v[64:67], a[148:151]
  ds_read_b128 v[64:67], v4 offset:18944
  s_waitcnt lgkmcnt(7)
  v_mfma_f32_16x16x32_bf16 a[180:183], v[36:39], v[68:71], a[180:183]
  ds_read_b128 v[68:71], v4 offset:23552
  s_waitcnt lgkmcnt(7)
  v_mfma_f32_16x16x32_bf16 a[212:215], v[40:43], v[72:75], a[212:215]
  ds_read_b128 v[72:75], v4 offset:28160
  s_waitcnt lgkmcnt(7)
  v_mfma_f32_16x16x32_bf16 a[244:247], v[44:47], v[76:79], a[244:247]
  ds_read_b128 v[76:79], v4 offset:32768
  s_waitcnt lgkmcnt(7)
  v_mfma_f32_16x16x32_bf16 a[24:27], v[16:19], v[48:51], a[24:27]
  ds_read_b128 v[48:51], v4 offset:0
  s_waitcnt lgkmcnt(7)
  v_mfma_f32_16x16x32_bf16 a[56:59], v[20:23], v[52:55], a[56:59]
  ds_read_b128 v[52:55], v4 offset:4608
  s_waitcnt lgkmcnt(7)
  v_mfma_f32_16x16x32_bf16 a[88:91], v[24:27], v[56:59], a[88:91]
  ds_read_b128 v[56:59], v4 offset:9216
  s_waitcnt lgkmcnt(7)
  v_mfma_f32_16x16x32_bf16 a[120:123], v[28:31], v[60:63], a[120:123]
  ds_read_b128 v[60:63], v4 offset:13824
  s_waitcnt lgkmcnt(7)
  v_mfma_f32_16x16x32_bf16 a[152:155], v[32:35], v[64:67], a[152:155]
  ds_read_b128 v[64:67], v4 offset:18432
  s_waitcnt lgkmcnt(7)
  v_mfma_f32_16x16x32_bf16 a[184:187], v[36:39], v[68:71], a[184:187]
  ds_read_b128 v[68:71], v4 offset:23040
  s_waitcnt lgkmcnt(7)
  v_mfma_f32_16x16x32_bf16 a[216:219], v[40:43], v[72:75], a[216:219]
  ds_read_b128 v[72:75], v4 offset:27648
  s_waitcnt lgkmcnt(7)
  v_mfma_f32_16x16x32_bf16 a[248:251], v[44:47], v[76:79], a[248:251]
  ds_read_b128 v[76:79], v4 offset:32256
  s_waitcnt lgkmcnt(7)
  v_mfma_f32_16x16x32_bf16 a[28:31], v[16:19], v[48:51], a[28:31]
  s_waitcnt lgkmcnt(6)
  v_mfma_f32_16x16x32_bf16 a[60:63], v[20:23], v[52:55], a[60:63]
  s_waitcnt lgkmcnt(5)
  v_mfma_f32_16x16x32_bf16 a[92:95], v[24:27], v[56:59], a[92:95]
  s_waitcnt lgkmcnt(4)
  v_mfma_f32_16x16x32_bf16 a[124:127], v[28:31], v[60:63], a[124:127]
  s_waitcnt lgkmcnt(3)
  v_mfma_f32_16x16x32_bf16 a[156:159], v[32:35], v[64:67], a[156:159]
  s_waitcnt lgkmcnt(2)
  v_mfma_f32_16x16x32_bf16 a[188:191], v[36:39], v[68:71], a[188:191]
  s_waitcnt lgkmcnt(1)
  v_mfma_f32_16x16x32_bf16 a[220:223], v[40:43], v[72:75], a[220:223]
  s_waitcnt lgkmcnt(0)
  v_mfma_f32_16x16x32_bf16 a[252:255], v[44:47], v[76:79], a[252:255]
  v_add_u32 v104, 64, v104
  v_add_u32 v105, 64, v105
  v_add_u32 v106, 64, v106
  v_add_u32 v107, 64, v107
  v_add_u32 v108, 64, v108
  v_add_u32 v109, 64, v109
  v_add_u32 v110, 64, v110
  v_add_u32 v111, 64, v111
  v_add_u32 v4, 64, v4
  v_add_u32 v8, 64, v8
  s_add_u32 s40, s40, 0x8000
  s_waitcnt vmcnt(0)
  s_mov_b64 exec, 1
  buffer_store_dword v13, v1, s[8:11], s39 offen sc1
  s_mov_b64 exec, -1
  ds_write_b32 v14, v13 offset:16
  s_add_u32 s32, s32, 1
  s_and_b32 s6, s32, 7
  s_cbranch_scc1 L_c_conv0
L_c_conv1:
  s_add_u32 s33, s32, 1
  s_and_b32 s6, s32, 7
  s_lshl_b32 s7, s6, 10
  s_add_u32 s7, s7, s35
  v_add_u32 v9, s7, v10
  s_lshl_b32 s6, s6, 1
  s_lshl_b32 s42, 0x30003, s6
  v_mov_b32 v13, s33
  ds_read_b128 v[48:51], v4 offset:3072
  ds_read_b128 v[52:55], v4 offset:7680
  ds_read_b128 v[56:59], v4 offset:12288
  ds_read_b128 v[60:63], v4 offset:16896
  ds_read_b128 v[64:67], v4 offset:21504
  ds_read_b128 v[68:71], v4 offset:26112
  ds_read_b128 v[72:75], v4 offset:30720
  ds_read_b128 v[76:79], v4 offset:35328
  s_mov_b32 s7, 0
L_lw_118:
  ds_read_b32 v88, v2 offset:0
  s_waitcnt lgkmcnt(0)
  v_cmp_gt_i32 vcc, s33, v88
  s_cbranch_vccz L_lwo_119
  s_add_u32 s7, s7, 1
  s_cmp_lt_u32 s7, 131072
  s_cbranch_scc1 L_lw_118
  s_mov_b32 s6, 42
  s_branch L_err
L_lwo_119:
  ds_read2_b32 v[112:113], v104 offset0:0 offset1:1
  ds_read2_b32 v[114:115], v104 offset0:2 offset1:3
  ds_read_b32 v116, v104 offset:16
  ds_read2_b32 v[118:119], v105 offset0:0 offset1:1
  ds_read2_b32 v[120:121], v105 offset0:2 offset1:3
  ds_read_b32 v122, v105 offset:16
  ds_read2_b32 v[124:125], v106 offset0:0 offset1:1
  ds_read2_b32 v[126:127], v106 offset0:2 offset1:3
  ds_read_b32 v128, v106 offset:16
  ds_read2_b32 v[130:131], v107 offset0:0 offset1:1
  ds_read2_b32 v[132:133], v107 offset0:2 offset1:3
  ds_read_b32 v134, v107 offset:16
  s_waitcnt lgkmcnt(9)
  v_alignbyte_b32 v16, v113, v112, v15
  v_alignbyte_b32 v17, v114, v113, v15
  v_alignbyte_b32 v18, v115, v114, v15
  v_alignbyte_b32 v19, v116, v115, v15
  ds_read2_b32 v[112:113], v108 offset0:0 offset1:1
  ds_read2_b32 v[114:115], v108 offset0:2 offset1:3
  ds_read_b32 v116, v108 offset:16
  s_waitcnt lgkmcnt(9)
  v_alignbyte_b32 v20, v119, v118, v15
  v_alignbyte_b32 v21, v120, v119, v15
  v_alignbyte_b32 v22, v121, v120, v15
  v_alignbyte_b32 v23, v122, v121, v15
  ds_read2_b32 v[118:119], v109 offset0:0 offset1:1
  ds_read2_b32 v[120:121], v109 offset0:2 offset1:3
  ds_read_b32 v122, v109 offset:16
  v_mfma_f32_16x16x32_bf16 a[4:7], v[16:19], v[48:51], a[4:7]
  s_waitcnt lgkmcnt(9)
  v_alignbyte_b32 v24, v125, v124, v15
  v_alignbyte_b32 v25, v126, v125, v15
  v_alignbyte_b32 v26, v127, v126, v15
  v_alignbyte_b32 v27, v128, v127, v15
  ds_read2_b32 v[124:125], v110 offset0:0 offset1:1
  ds_read2_b32 v[126:127], v110 offset0:2 offset1:3
  ds_read_b32 v128, v110 offset:16
  v_mfma_f32_16x16x32_bf16 a[36:39], v[20:23], v[52:55], a[36:39]
  s_waitcnt lgkmcnt(9)
  v_alignbyte_b32 v28, v131, v130, v15
  v_alignbyte_b32 v29, v132, v131, v15
  v_alignbyte_b32 v30, v133, v132, v15
  v_alignbyte_b32 v31, v134, v133, v15
  ds_read2_b32 v[130:131], v111 offset0:0 offset1:1
  ds_read2_b32 v[132:133], v111 offset0:2 offset1:3
  ds_read_b32 v134, v111 offset:16
  v_mfma_f32_16x16x32_bf16 a[68:71], v[24:27], v[56:59], a[68:71]
  s_waitcnt lgkmcnt(9)
  v_alignbyte_b32 v32, v113, v112, v15
  v_alignbyte_b32 v33, v114, v113, v15
  v_alignbyte_b32 v34, v115, v114, v15
  v_alignbyte_b32 v35, v116, v115, v15
  ds_read_b64 v[84:85], v8
  ds_read_b64 v[86:87], v9
  v_mfma_f32_16x16x32_bf16 a[100:103], v[28:31], v[60:63], a[100:103]
  s_waitcnt lgkmcnt(8)
  v_alignbyte_b32 v36, v119, v118, v15
  v_alignbyte_b32 v37, v120, v119, v15
  v_alignbyte_b32 v38, v121, v120, v15
  v_alignbyte_b32 v39, v122, v121, v15
  v_mfma_f32_16x16x32_bf16 a[132:135], v[32:35], v[64:67], a[132:135]
  s_waitcnt lgkmcnt(5)
  v_alignbyte_b32 v40, v125, v124, v15
  v_alignbyte_b32 v41, v126, v125, v15
  v_alignbyte_b32 v42, v127, v126, v15
  v_alignbyte_b32 v43, v128, v127, v15
  v_mfma_f32_16x16x32_bf16 a[164:167], v[36:39], v[68:71], a[164:167]
  s_waitcnt lgkmcnt(2)
  v_alignbyte_b32 v44, v131, v130, v15
  v_alignbyte_b32 v45, v132, v131, v15
  v_alignbyte_b32 v46, v133, v132, v15
  v_alignbyte_b32 v47, v134, v133, v15
  v_mfma_f32_16x16x32_bf16 a[196:199], v[40:43], v[72:75], a[196:199]
  s_nop 0
  v_mfma_f32_16x16x32_bf16 a[228:231], v[44:47], v[76:79], a[228:231]
  s_waitcnt lgkmcnt(0)
  ds_read_b128 v[48:51], v4 offset:2560
  ds_read_b128 v[52:55], v4 offset:7168
  ds_read_b128 v[56:59], v4 offset:11776
  ds_read_b128 v[60:63], v4 offset:16384
  ds_read_b128 v[64:67], v4 offset:20992
  ds_read_b128 v[68:71], v4 offset:25600
  ds_read_b128 v[72:75], v4 offset:30208
  ds_read_b128 v[76:79], v4 offset:34816
  s_mov_b32 exec_lo, s42
  s_mov_b32 exec_hi, s42
  ds_write_b128 v6, a[4:7] offset:0
  ds_write_b128 v6, a[36:39] offset:128
  ds_write_b128 v6, a[68:71] offset:256
  ds_write_b128 v6, a[100:103] offset:384
  ds_write_b128 v6, a[132:135] offset:512
  ds_write_b128 v6, a[164:167] offset:640
  ds_write_b128 v6, a[196:199] offset:768
  ds_write_b128 v6, a[228:231] offset:896
  s_mov_b64 exec, -1
  ds_read_b128 v[80:83], v7
  ds_write_b32 v14, v13 offset:8
  v_lshlrev_b32 v88, 16, v84
  v_and_b32 v89, 0xffff0000, v84
  v_lshlrev_b32 v90, 16, v85
  v_and_b32 v91, 0xffff0000, v85
  v_lshlrev_b32 v96, 16, v86
  v_and_b32 v97, 0xffff0000, v86
  v_lshlrev_b32 v98, 16, v87
  v_and_b32 v99, 0xffff0000, v87
  v_mul_f32 v92, v88, v12
  v_mul_f32 v93, v89, v12
  v_mul_f32 v94, v90, v12
  v_mul_f32 v95, v91, v12
  v_cvt_pk_bf16_f32 v84, v92, v93
  v_cvt_pk_bf16_f32 v85, v94, v95
  v_lshlrev_b32 v92, 16, v84
  v_and_b32 v93, 0xffff0000, v84
  v_lshlrev_b32 v94, 16, v85
  v_and_b32 v95, 0xffff0000, v85
  s_waitcnt lgkmcnt(1)
  v_fmac_f32 v80, v88, v11
  v_fmac_f32 v81, v89, v11
  v_fmac_f32 v82, v90, v11
  v_fmac_f32 v83, v91, v11
  v_cvt_pk_bf16_f32 v84, v80, v81
  v_cvt_pk_bf16_f32 v85, v82, v83
  v_lshlrev_b32 v80, 16, v84
  v_and_b32 v81, 0xffff0000, v84
  v_lshlrev_b32 v82, 16, v85
  v_and_b32 v83, 0xffff0000, v85
  v_add_f32 v80, v80, v92
  v_add_f32 v81, v81, v93
  v_add_f32 v82, v82, v94
  v_add_f32 v83, v83, v95
  v_cvt_pk_bf16_f32 v84, v80, v81
  v_cvt_pk_bf16_f32 v85, v82, v83
  v_lshlrev_b32 v80, 16, v84
  v_and_b32 v81, 0xffff0000, v84
  v_lshlrev_b32 v82, 16, v85
  v_and_b32 v83, 0xffff0000, v85
  v_add_f32 v80, v80, v96
  v_add_f32 v81, v81, v97
  v_add_f32 v82, v82, v98
  v_add_f32 v83, v83, v99
  v_cvt_pk_bf16_f32 v84, v80, v81
  v_cvt_pk_bf16_f32 v85, v82, v83
  buffer_store_dwordx2 v[84:85], v10, s[8:11], s40 offen sc1
  v_mfma_f32_16x16x32_bf16 a[8:11], v[16:19], v[48:51], a[8:11]
  ds_read_b128 v[48:51], v4 offset:2048
  v_mfma_f32_16x16x32_bf16 a[40:43], v[20:23], v[52:55], a[40:43]
  ds_read_b128 v[52:55], v4 offset:6656
  v_mfma_f32_16x16x32_bf16 a[72:75], v[24:27], v[56:59], a[72:75]
  ds_read_b128 v[56:59], v4 offset:11264
  v_mfma_f32_16x16x32_bf16 a[104:107], v[28:31], v[60:63], a[104:107]
  ds_read_b128 v[60:63], v4 offset:15872
  v_mfma_f32_16x16x32_bf16 a[136:139], v[32:35], v[64:67], a[136:139]
  ds_read_b128 v[64:67], v4 offset:20480
  v_mfma_f32_16x16x32_bf16 a[168:171], v[36:39], v[68:71], a[168:171]
  ds_read_b128 v[68:71], v4 offset:25088
  v_mfma_f32_16x16x32_bf16 a[200:203], v[40:43], v[72:75], a[200:203]
  ds_read_b128 v[72:75], v4 offset:29696
  v_mfma_f32_16x16x32_bf16 a[232:235], v[44:47], v[76:79], a[232:235]
  ds_read_b128 v[76:79], v4 offset:34304
  s_waitcnt lgkmcnt(7)
  v_mfma_f32_16x16x32_bf16 a[12:15], v[16:19], v[48:51], a[12:15]
  ds_read_b128 v[48:51], v4 offset:1536
  s_waitcnt lgkmcnt(7)
  v_mfma_f32_16x16x32_bf16 a[44:47], v[20:23], v[52:55], a[44:47]
  ds_read_b128 v[52:55], v4 offset:6144
  s_waitcnt lgkmcnt(7)
  v_mfma_f32_16x16x32_bf16 a[76:79], v[24:27], v[56:59], a[76:79]
  ds_read_b128 v[56:59], v4 offset:10752
  s_waitcnt lgkmcnt(7)
  v_mfma_f32_16x16x32_bf16 a[108:111], v[28:31], v[60:63], a[108:111]
  ds_read_b128 v[60:63], v4 offset:15360
  s_waitcnt lgkmcnt(7)
  v_mfma_f32_16x16x32_bf16 a[140:143], v[32:35], v[64:67], a[140:143]
  ds_read_b128 v[64:67], v4 offset:19968
  s_waitcnt lgkmcnt(7)
  v_mfma_f32_16x16x32_bf16 a[172:175], v[36:39], v[68:71], a[172:175]
  ds_read_b128 v[68:71], v4 offset:24576
  s_waitcnt lgkmcnt(7)
  v_mfma_f32_16x16x32_bf16 a[204:207], v[40:43], v[72:75], a[204:207]
  ds_read_b128 v[72:75], v4 offset:29184
  s_waitcnt lgkmcnt(7)
  v_mfma_f32_16x16x32_bf16 a[236:239], v[44:47], v[76:79], a[236:239]
  ds_read_b128 v[76:79], v4 offset:33792
  s_waitcnt lgkmcnt(7)
  v_mfma_f32_16x16x32_bf16 a[16:19], v[16:19], v[48:51], a[16:19]
  ds_read_b128 v[48:51], v4 offset:1024
  s_waitcnt lgkmcnt(7)
  v_mfma_f32_16x16x32_bf16 a[48:51], v[20:23], v[52:55], a[48:51]
  ds_read_b128 v[52:55], v4 offset:5632
  s_waitcnt lgkmcnt(7)
  v_mfma_f32_16x16x32_bf16 a[80:83], v[24:27], v[56:59], a[80:83]
  ds_read_b128 v[56:59], v4 offset:10240
  s_waitcnt lgkmcnt(7)
  v_mfma_f32_16x16x32_bf16 a[112:115], v[28:31], v[60:63], a[112:115]
  ds_read_b128 v[60:63], v4 offset:14848
  s_waitcnt lgkmcnt(7)
  v_mfma_f32_16x16x32_bf16 a[144:147], v[32:35], v[64:67], a[144:147]
  ds_read_b128 v[64:67], v4 offset:19456
  s_waitcnt lgkmcnt(7)
  v_mfma_f32_16x16x32_bf16 a[176:179], v[36:39], v[68:71], a[176:179]
  ds_read_b128 v[68:71], v4 offset:24064
  s_waitcnt lgkmcnt(7)
  v_mfma_f32_16x16x32_bf16 a[208:211], v[40:43], v[72:75], a[208:211]
  ds_read_b128 v[72:75], v4 offset:28672
  s_waitcnt lgkmcnt(7)
  v_mfma_f32_16x16x32_bf16 a[240:243], v[44:47], v[76:79], a[240:243]
  ds_read_b128 v[76:79], v4 offset:33280
  s_waitcnt lgkmcnt(7)
  v_mfma_f32_16x16x32_bf16 a[20:23], v[16:19], v[48:51], a[20:23]
  ds_read_b128 v[48:51], v4 offset:512
  s_waitcnt lgkmcnt(7)
  v_mfma_f32_16x16x32_bf16 a[52:55], v[20:23], v[52:55], a[52:55]
  ds_read_b128 v[52:55], v4 offset:5120
  s_waitcnt lgkmcnt(7)
  v_mfma_f32_16x16x32_bf16 a[84:87], v[24:27], v[56:59], a[84:87]
  ds_read_b128 v[56:59], v4 offset:9728
  s_waitcnt lgkmcnt(7)
  v_mfma_f32_16x16x32_bf16 a[116:119], v[28:31], v[60:63], a[116:119]
  ds_read_b128 v[60:63], v4 offset:14336
  s_waitcnt lgkmcnt(7)
  v_mfma_f32_16x16x32_bf16 a[148:151], v[32:35], v[64:67], a[148:151]
  ds_read_b128 v[64:67], v4 offset:18944
  s_waitcnt lgkmcnt(7)
  v_mfma_f32_16x16x32_bf16 a[180:183], v[36:39], v[68:71], a[180:183]
  ds_read_b128 v[68:71], v4 offset:23552
  s_waitcnt lgkmcnt(7)
  v_mfma_f32_16x16x32_bf16 a[212:215], v[40:43], v[72:75], a[212:215]
  ds_read_b128 v[72:75], v4 offset:28160
  s_waitcnt lgkmcnt(7)
  v_mfma_f32_16x16x32_bf16 a[244:247], v[44:47], v[76:79], a[244:247]
  ds_read_b128 v[76:79], v4 offset:32768
  s_waitcnt lgkmcnt(7)
  v_mfma_f32_16x16x32_bf16 a[24:27], v[16:19], v[48:51], a[24:27]
  ds_read_b128 v[48:51], v4 offset:0
  s_waitcnt lgkmcnt(7)
  v_mfma_f32_16x16x32_bf16 a[56:59], v[20:23], v[52:55], a[56:59]
  ds_read_b128 v[52:55], v4 offset:4608
  s_waitcnt lgkmcnt(7)
  v_mfma_f32_16x16x32_bf16 a[88:91], v[24:27], v[56:59], a[88:91]
  ds_read_b128 v[56:59], v4 offset:9216
  s_waitcnt lgkmcnt(7)
  v_mfma_f32_16x16x32_bf16 a[120:123], v[28:31], v[60:63], a[120:123]
  ds_read_b128 v[60:63], v4 offset:13824
  s_waitcnt lgkmcnt(7)
  v_mfma_f32_16x16x32_bf16 a[152:155], v[32:35], v[64:67], a[152:155]
  ds_read_b128 v[64:67], v4 offset:18432
  s_waitcnt lgkmcnt(7)
  v_mfma_f32_16x16x32_bf16 a[184:187], v[36:39], v[68:71], a[184:187]
  ds_read_b128 v[68:71], v4 offset:23040
  s_waitcnt lgkmcnt(7)
  v_mfma_f32_16x16x32_bf16 a[216:219], v[40:43], v[72:75], a[216:219]
  ds_read_b128 v[72:75], v4 offset:27648
  s_waitcnt lgkmcnt(7)
  v_mfma_f32_16x16x32_bf16 a[248:251], v[44:47], v[76:79], a[248:251]
  ds_read_b128 v[76:79], v4 offset:32256
  s_waitcnt lgkmcnt(7)
  v_mfma_f32_16x16x32_bf16 a[28:31], v[16:19], v[48:51], a[28:31]
  s_waitcnt lgkmcnt(6)
  v_mfma_f32_16x16x32_bf16 a[60:63], v[20:23], v[52:55], a[60:63]
  s_waitcnt lgkmcnt(5)
  v_mfma_f32_16x16x32_bf16 a[92:95], v[24:27], v[56:59], a[92:95]
  s_waitcnt lgkmcnt(4)
  v_mfma_f32_16x16x32_bf16 a[124:127], v[28:31], v[60:63], a[124:127]
  s_waitcnt lgkmcnt(3)
  v_mfma_f32_16x16x32_bf16 a[156:159], v[32:35], v[64:67], a[156:159]
  s_waitcnt lgkmcnt(2)
  v_mfma_f32_16x16x32_bf16 a[188:191], v[36:39], v[68:71], a[188:191]
  s_waitcnt lgkmcnt(1)
  v_mfma_f32_16x16x32_bf16 a[220:223], v[40:43], v[72:75], a[220:223]
  s_waitcnt lgkmcnt(0)
  v_mfma_f32_16x16x32_bf16 a[252:255], v[44:47], v[76:79], a[252:255]
  v_add_u32 v104, 64, v104
  v_add_u32 v105, 64, v105
  v_add_u32 v106, 64, v106
  v_add_u32 v107, 64, v107
  v_add_u32 v108, 64, v108
  v_add_u32 v109, 64, v109
  v_add_u32 v110, 64, v110
  v_add_u32 v111, 64, v111
  v_add_u32 v4, 64, v4
  v_add_u32 v8, 64, v8
  s_add_u32 s40, s40, 0x8000
  s_waitcnt vmcnt(0)
  s_mov_b64 exec, 1
  buffer_store_dword v13, v1, s[8:11], s39 offen sc1
  s_mov_b64 exec, -1
  ds_write_b32 v14, v13 offset:16
  s_add_u32 s32, s32, 1
  s_and_b32 s6, s32, 7
  s_cbranch_scc1 L_c_conv1
L_c_conv2:
  s_add_u32 s33, s32, 1
  s_and_b32 s6, s32, 7
  s_lshl_b32 s7, s6, 10
  s_add_u32 s7, s7, s35
  v_add_u32 v9, s7, v10
  s_lshl_b32 s6, s6, 1
  s_lshl_b32 s42, 0x30003, s6
  v_mov_b32 v13, s33
  ds_read_b128 v[48:51], v4 offset:2560
  ds_read_b128 v[52:55], v4 offset:7168
  ds_read_b128 v[56:59], v4 offset:11776
  ds_read_b128 v[60:63], v4 offset:16384
  ds_read_b128 v[64:67], v4 offset:20992
  ds_read_b128 v[68:71], v4 offset:25600
  ds_read_b128 v[72:75], v4 offset:30208
  ds_read_b128 v[76:79], v4 offset:34816
  s_mov_b32 s7, 0
L_lw_120:
  ds_read_b32 v88, v2 offset:0
  s_waitcnt lgkmcnt(0)
  v_cmp_gt_i32 vcc, s33, v88
  s_cbranch_vccz L_lwo_121
  s_add_u32 s7, s7, 1
  s_cmp_lt_u32 s7, 131072
  s_cbranch_scc1 L_lw_120
  s_mov_b32 s6, 42
  s_branch L_err
L_lwo_121:
  ds_read2_b32 v[112:113], v104 offset0:0 offset1:1
  ds_read2_b32 v[114:115], v104 offset0:2 offset1:3
  ds_read_b32 v116, v104 offset:16
  ds_read2_b32 v[118:119], v105 offset0:0 offset1:1
  ds_read2_b32 v[120:121], v105 offset0:2 offset1:3
  ds_read_b32 v122, v105 offset:16
  ds_read2_b32 v[124:125], v106 offset0:0 offset1:1
  ds_read2_b32 v[126:127], v106 offset0:2 offset1:3
  ds_read_b32 v128, v106 offset:16
  ds_read2_b32 v[130:131], v107 offset0:0 offset1:1
  ds_read2_b32 v[132:133], v107 offset0:2 offset1:3
  ds_read_b32 v134, v107 offset:16
  s_waitcnt lgkmcnt(9)
  v_alignbyte_b32 v16, v113, v112, v15
  v_alignbyte_b32 v17, v114, v113, v15
  v_alignbyte_b32 v18, v115, v114, v15
  v_alignbyte_b32 v19, v116, v115, v15
  ds_read2_b32 v[112:113], v108 offset0:0 offset1:1
  ds_read2_b32 v[114:115], v108 offset0:2 offset1:3
  ds_read_b32 v116, v108 offset:16
  s_waitcnt lgkmcnt(9)
  v_alignbyte_b32 v20, v119, v118, v15
  v_alignbyte_b32 v21, v120, v119, v15
  v_alignbyte_b32 v22, v121, v120, v15
  v_alignbyte_b32 v23, v122, v121, v15
  ds_read2_b32 v[118:119], v109 offset0:0 offset1:1
  ds_read2_b32 v[120:121], v109 offset0:2 offset1:3
  ds_read_b32 v122, v109 offset:16
  v_mfma_f32_16x16x32_bf16 a[8:11], v[16:19], v[48:51], a[8:11]
  s_waitcnt lgkmcnt(9)
  v_alignbyte_b32 v24, v125, v124, v15
  v_alignbyte_b32 v25, v126, v125, v15
  v_alignbyte_b32 v26, v127, v126, v15
  v_alignbyte_b32 v27, v128, v127, v15
  ds_read2_b32 v[124:125], v110 offset0:0 offset1:1
  ds_read2_b32 v[126:127], v110 offset0:2 offset1:3
  ds_read_b32 v128, v110 offset:16
  v_mfma_f32_16x16x32_bf16 a[40:43], v[20:23], v[52:55], a[40:43]
  s_waitcnt lgkmcnt(9)
  v_alignbyte_b32 v28, v131, v130, v15
  v_alignbyte_b32 v29, v132, v131, v15
  v_alignbyte_b32 v30, v133, v132, v15
  v_alignbyte_b32 v31, v134, v133, v15
  ds_read2_b32 v[130:131], v111 offset0:0 offset1:1
  ds_read2_b32 v[132:133], v111 offset0:2 offset1:3
  ds_read_b32 v134, v111 offset:16
  v_mfma_f32_16x16x32_bf16 a[72:75], v[24:27], v[56:59], a[72:75]
  s_waitcnt lgkmcnt(9)
  v_alignbyte_b32 v32, v113, v112, v15
  v_alignbyte_b32 v33, v114, v113, v15
  v_alignbyte_b32 v34, v115, v114, v15
  v_alignbyte_b32 v35, v116, v115, v15
  ds_read_b64 v[84:85], v8
  ds_read_b64 v[86:87], v9
  v_mfma_f32_16x16x32_bf16 a[104:107], v[28:31], v[60:63], a[104:107]
  s_waitcnt lgkmcnt(8)
  v_alignbyte_b32 v36, v119, v118, v15
  v_alignbyte_b32 v37, v120, v119, v15
  v_alignbyte_b32 v38, v121, v120, v15
  v_alignbyte_b32 v39, v122, v121, v15
  v_mfma_f32_16x16x32_bf16 a[136:139], v[32:35], v[64:67], a[136:139]
  s_waitcnt lgkmcnt(5)
  v_alignbyte_b32 v40, v125, v124, v15
  v_alignbyte_b32 v41, v126, v125, v15
  v_alignbyte_b32 v42, v127, v126, v15
  v_alignbyte_b32 v43, v128, v127, v15
  v_mfma_f32_16x16x32_bf16 a[168:171], v[36:39], v[68:71], a[168:171]
  s_waitcnt lgkmcnt(2)
  v_alignbyte_b32 v44, v131, v130, v15
  v_alignbyte_b32 v45, v132, v131, v15
  v_alignbyte_b32 v46, v133, v132, v15
  v_alignbyte_b32 v47, v134, v133, v15
  v_mfma_f32_16x16x32_bf16 a[200:203], v[40:43], v[72:75], a[200:203]
  s_nop 0
  v_mfma_f32_16x16x32_bf16 a[232:235], v[44:47], v[76:79], a[232:235]
  s_waitcnt lgkmcnt(0)
  ds_read_b128 v[48:51], v4 offset:2048
  ds_read_b128 v[52:55], v4 offset:6656
  ds_read_b128 v[56:59], v4 offset:11264
  ds_read_b128 v[60:63], v4 offset:15872
  ds_read_b128 v[64:67], v4 offset:20480
  ds_read_b128 v[68:71], v4 offset:25088
  ds_read_b128 v[72:75], v4 offset:29696
  ds_read_b128 v[76:79], v4 offset:34304
  s_mov_b32 exec_lo, s42
  s_mov_b32 exec_hi, s42
  ds_write_b128 v6, a[8:11] offset:0
  ds_write_b128 v6, a[40:43] offset:128
  ds_write_b128 v6, a[72:75] offset:256
  ds_write_b128 v6, a[104:107] offset:384
  ds_write_b128 v6, a[136:139] offset:512
  ds_write_b128 v6, a[168:171] offset:640
  ds_write_b128 v6, a[200:203] offset:768
  ds_write_b128 v6, a[232:235] offset:896
  s_mov_b64 exec, -1
  ds_read_b128 v[80:83], v7
  ds_write_b32 v14, v13 offset:8
  v_lshlrev_b32 v88, 16, v84
  v_and_b32 v89, 0xffff0000, v84
  v_lshlrev_b32 v90, 16, v85
  v_and_b32 v91, 0xffff0000, v85
  v_lshlrev_b32 v96, 16, v86
  v_and_b32 v97, 0xffff0000, v86
  v_lshlrev_b32 v98, 16, v87
  v_and_b32 v99, 0xffff0000, v87
  v_mul_f32 v92, v88, v12
  v_mul_f32 v93, v89, v12
  v_mul_f32 v94, v90, v12
  v_mul_f32 v95, v91, v12
  v_cvt_pk_bf16_f32 v84, v92, v93
  v_cvt_pk_bf16_f32 v85, v94, v95
  v_lshlrev_b32 v92, 16, v84
  v_and_b32 v93, 0xffff0000, v84
  v_lshlrev_b32 v94, 16, v85
  v_and_b32 v95, 0xffff0000, v85
  s_waitcnt lgkmcnt(1)
  v_fmac_f32 v80, v88, v11
  v_fmac_f32 v81, v89, v11
  v_fmac_f32 v82, v90, v11
  v_fmac_f32 v83, v91, v11
  v_cvt_pk_bf16_f32 v84, v80, v81
  v_cvt_pk_bf16_f32 v85, v82, v83
  v_lshlrev_b32 v80, 16, v84
  v_and_b32 v81, 0xffff0000, v84
  v_lshlrev_b32 v82, 16, v85
  v_and_b32 v83, 0xffff0000, v85
  v_add_f32 v80, v80, v92
  v_add_f32 v81, v81, v93
  v_add_f32 v82, v82, v94
  v_add_f32 v83, v83, v95
  v_cvt_pk_bf16_f32 v84, v80, v81
  v_cvt_pk_bf16_f32 v85, v82, v83
  v_lshlrev_b32 v80, 16, v84
  v_and_b32 v81, 0xffff0000, v84
  v_lshlrev_b32 v82, 16, v85
  v_and_b32 v83, 0xffff0000, v85
  v_add_f32 v80, v80, v96
  v_add_f32 v81, v81, v97
  v_add_f32 v82, v82, v98
  v_add_f32 v83, v83, v99
  v_cvt_pk_bf16_f32 v84, v80, v81
  v_cvt_pk_bf16_f32 v85, v82, v83
  buffer_store_dwordx2 v[84:85], v10, s[8:11], s40 offen sc1
  v_mfma_f32_16x16x32_bf16 a[12:15], v[16:19], v[48:51], a[12:15]
  ds_read_b128 v[48:51], v4 offset:1536
  v_mfma_f32_16x16x32_bf16 a[44:47], v[20:23], v[52:55], a[44:47]
  ds_read_b128 v[52:55], v4 offset:6144
  v_mfma_f32_16x16x32_bf16 a[76:79], v[24:27], v[56:59], a[76:79]
  ds_read_b128 v[56:59], v4 offset:10752
  v_mfma_f32_16x16x32_bf16 a[108:111], v[28:31], v[60:63], a[108:111]
  ds_read_b128 v[60:63], v4 offset:15360
  v_mfma_f32_16x16x32_bf16 a[140:143], v[32:35], v[64:67], a[140:143]
  ds_read_b128 v[64:67], v4 offset:19968
  v_mfma_f32_16x16x32_bf16 a[172:175], v[36:39], v[68:71], a[172:175]
  ds_read_b128 v[68:71], v4 offset:24576
  v_mfma_f32_16x16x32_bf16 a[204:207], v[40:43], v[72:75], a[204:207]
  ds_read_b128 v[72:75], v4 offset:29184
  v_mfma_f32_16x16x32_bf16 a[236:239], v[44:47], v[76:79], a[236:239]
  ds_read_b128 v[76:79], v4 offset:33792
  s_waitcnt lgkmcnt(7)
  v_mfma_f32_16x16x32_bf16 a[16:19], v[16:19], v[48:51], a[16:19]
  ds_read_b128 v[48:51], v4 offset:1024
  s_waitcnt lgkmcnt(7)
  v_mfma_f32_16x16x32_bf16 a[48:51], v[20:23], v[52:55], a[48:51]
  ds_read_b128 v[52:55], v4 offset:5632
  s_waitcnt lgkmcnt(7)
  v_mfma_f32_16x16x32_bf16 a[80:83], v[24:27], v[56:59], a[80:83]
  ds_read_b128 v[56:59], v4 offset:10240
  s_waitcnt lgkmcnt(7)
  v_mfma_f32_16x16x32_bf16 a[112:115], v[28:31], v[60:63], a[112:115]
  ds_read_b128 v[60:63], v4 offset:14848
  s_waitcnt lgkmcnt(7)
  v_mfma_f32_16x16x32_bf16 a[144:147], v[32:35], v[64:67], a[144:147]
  ds_read_b128 v[64:67], v4 offset:19456
  s_waitcnt lgkmcnt(7)
  v_mfma_f32_16x16x32_bf16 a[176:179], v[36:39], v[68:71], a[176:179]
  ds_read_b128 v[68:71], v4 offset:24064
  s_waitcnt lgkmcnt(7)
  v_mfma_f32_16x16x32_bf16 a[208:211], v[40:43], v[72:75], a[208:211]
  ds_read_b128 v[72:75], v4 offset:28672
  s_waitcnt lgkmcnt(7)
  v_mfma_f32_16x16x32_bf16 a[240:243], v[44:47], v[76:79], a[240:243]
  ds_read_b128 v[76:79], v4 offset:33280
  s_waitcnt lgkmcnt(7)
  v_mfma_f32_16x16x32_bf16 a[20:23], v[16:19], v[48:51], a[20:23]
  ds_read_b128 v[48:51], v4 offset:512
  s_waitcnt lgkmcnt(7)
  v_mfma_f32_16x16x32_bf16 a[52:55], v[20:23], v[52:55], a[52:55]
  ds_read_b128 v[52:55], v4 offset:5120
  s_waitcnt lgkmcnt(7)
  v_mfma_f32_16x16x32_bf16 a[84:87], v[24:27], v[56:59], a[84:87]
  ds_read_b128 v[56:59], v4 offset:9728
  s_waitcnt lgkmcnt(7)
  v_mfma_f32_16x16x32_bf16 a[116:119], v[28:31], v[60:63], a[116:119]
  ds_read_b128 v[60:63], v4 offset:14336
  s_waitcnt lgkmcnt(7)
  v_mfma_f32_16x16x32_bf16 a[148:151], v[32:35], v[64:67], a[148:151]
  ds_read_b128 v[64:67], v4 offset:18944
  s_waitcnt lgkmcnt(7)
  v_mfma_f32_16x16x32_bf16 a[180:183], v[36:39], v[68:71], a[180:183]
  ds_read_b128 v[68:71], v4 offset:23552
  s_waitcnt lgkmcnt(7)
  v_mfma_f32_16x16x32_bf16 a[212:215], v[40:43], v[72:75], a[212:215]
  ds_read_b128 v[72:75], v4 offset:28160
  s_waitcnt lgkmcnt(7)
  v_mfma_f32_16x16x32_bf16 a[244:247], v[44:47], v[76:79], a[244:247]
  ds_read_b128 v[76:79], v4 offset:32768
  s_waitcnt lgkmcnt(7)
  v_mfma_f32_16x16x32_bf16 a[24:27], v[16:19], v[48:51], a[24:27]
  ds_read_b128 v[48:51], v4 offset:0
  s_waitcnt lgkmcnt(7)
  v_mfma_f32_16x16x32_bf16 a[56:59], v[20:23], v[52:55], a[56:59]
  ds_read_b128 v[52:55], v4 offset:4608
  s_waitcnt lgkmcnt(7)
  v_mfma_f32_16x16x32_bf16 a[88:91], v[24:27], v[56:59], a[88:91]
  ds_read_b128 v[56:59], v4 offset:9216
  s_waitcnt lgkmcnt(7)
  v_mfma_f32_16x16x32_bf16 a[120:123], v[28:31], v[60:63], a[120:123]
  ds_read_b128 v[60:63], v4 offset:13824
  s_waitcnt lgkmcnt(7)
  v_mfma_f32_16x16x32_bf16 a[152:155], v[32:35], v[64:67], a[152:155]
  ds_read_b128 v[64:67], v4 offset:18432
  s_waitcnt lgkmcnt(7)
  v_mfma_f32_16x16x32_bf16 a[184:187], v[36:39], v[68:71], a[184:187]
  ds_read_b128 v[68:71], v4 offset:23040
  s_waitcnt lgkmcnt(7)
  v_mfma_f32_16x16x32_bf16 a[216:219], v[40:43], v[72:75], a[216:219]
  ds_read_b128 v[72:75], v4 offset:27648
  s_waitcnt lgkmcnt(7)
  v_mfma_f32_16x16x32_bf16 a[248:251], v[44:47], v[76:79], a[248:251]
  ds_read_b128 v[76:79], v4 offset:32256
  s_waitcnt lgkmcnt(7)
  v_mfma_f32_16x16x32_bf16 a[28:31], v[16:19], v[48:51], a[28:31]
  s_waitcnt lgkmcnt(6)
  v_mfma_f32_16x16x32_bf16 a[60:63], v[20:23], v[52:55], a[60:63]
  s_waitcnt lgkmcnt(5)
  v_mfma_f32_16x16x32_bf16 a[92:95], v[24:27], v[56:59], a[92:95]
  s_waitcnt lgkmcnt(4)
  v_mfma_f32_16x16x32_bf16 a[124:127], v[28:31], v[60:63], a[124:127]
  s_waitcnt lgkmcnt(3)
  v_mfma_f32_16x16x32_bf16 a[156:159], v[32:35], v[64:67], a[156:159]
  s_waitcnt lgkmcnt(2)
  v_mfma_f32_16x16x32_bf16 a[188:191], v[36:39], v[68:71], a[188:191]
  s_waitcnt lgkmcnt(1)
  v_mfma_f32_16x16x32_bf16 a[220:223], v[40:43], v[72:75], a[220:223]
  s_waitcnt lgkmcnt(0)
  v_mfma_f32_16x16x32_bf16 a[252:255], v[44:47], v[76:79], a[252:255]
  v_add_u32 v104, 64, v104
  v_add_u32 v105, 64, v105
  v_add_u32 v106, 64, v106
  v_add_u32 v107, 64, v107
  v_add_u32 v108, 64, v108
  v_add_u32 v109, 64, v109
  v_add_u32 v110, 64, v110
  v_add_u32 v111, 64, v111
  v_add_u32 v4, 64, v4
  v_add_u32 v8, 64, v8
  s_add_u32 s40, s40, 0x8000
  s_waitcnt vmcnt(0)
  s_mov_b64 exec, 1
  buffer_store_dword v13, v1, s[8:11], s39 offen sc1
  s_mov_b64 exec, -1
  ds_write_b32 v14, v13 offset:16
  s_add_u32 s32, s32, 1
  s_and_b32 s6, s32, 7
  s_cbranch_scc1 L_c_conv2
L_c_conv3:
  s_add_u32 s33, s32, 1
  s_and_b32 s6, s32, 7
  s_lshl_b32 s7, s6, 10
  s_add_u32 s7, s7, s35
  v_add_u32 v9, s7, v10
  s_lshl_b32 s6, s6, 1
  s_lshl_b32 s42, 0x30003, s6
  v_mov_b32 v13, s33
  ds_read_b128 v[48:51], v4 offset:2048
  ds_read_b128 v[52:55], v4 offset:6656
  ds_read_b128 v[56:59], v4 offset:11264
  ds_read_b128 v[60:63], v4 offset:15872
  ds_read_b128 v[64:67], v4 offset:20480
  ds_read_b128 v[68:71], v4 offset:25088
  ds_read_b128 v[72:75], v4 offset:29696
  ds_read_b128 v[76:79], v4 offset:34304
  s_mov_b32 s7, 0
L_lw_122:
  ds_read_b32 v88, v2 offset:0
  s_waitcnt lgkmcnt(0)
  v_cmp_gt_i32 vcc, s33, v88
  s_cbranch_vccz L_lwo_123
  s_add_u32 s7, s7, 1
  s_cmp_lt_u32 s7, 131072
  s_cbranch_scc1 L_lw_122
  s_mov_b32 s6, 42
  s_branch L_err
L_lwo_123:
  ds_read2_b32 v[112:113], v104 offset0:0 offset1:1
  ds_read2_b32 v[114:115], v104 offset0:2 offset1:3
  ds_read_b32 v116, v104 offset:16
  ds_read2_b32 v[118:119], v105 offset0:0 offset1:1
  ds_read2_b32 v[120:121], v105 offset0:2 offset1:3
  ds_read_b32 v122, v105 offset:16
  ds_read2_b32 v[124:125], v106 offset0:0 offset1:1
  ds_read2_b32 v[126:127], v106 offset0:2 offset1:3
  ds_read_b32 v128, v106 offset:16
  ds_read2_b32 v[130:131], v107 offset0:0 offset1:1
  ds_read2_b32 v[132:133], v107 offset0:2 offset1:3
  ds_read_b32 v134, v107 offset:16
  s_waitcnt lgkmcnt(9)
  v_alignbyte_b32 v16, v113, v112, v15
  v_alignbyte_b32 v17, v114, v113, v15
  v_alignbyte_b32 v18, v115, v114, v15
  v_alignbyte_b32 v19, v116, v115, v15
  ds_read2_b32 v[112:113], v108 offset0:0 offset1:1
  ds_read2_b32 v[114:115], v108 offset0:2 offset1:3
  ds_read_b32 v116, v108 offset:16
  s_waitcnt lgkmcnt(9)
  v_alignbyte_b32 v20, v119, v118, v15
  v_alignbyte_b32 v21, v120, v119, v15
  v_alignbyte_b32 v22, v121, v120, v15
  v_alignbyte_b32 v23, v122, v121, v15
  ds_read2_b32 v[118:119], v109 offset0:0 offset1:1
  ds_read2_b32 v[120:121], v109 offset0:2 offset1:3
  ds_read_b32 v122, v109 offset:16
  v_mfma_f32_16x16x32_bf16 a[12:15], v[16:19], v[48:51], a[12:15]
  s_waitcnt lgkmcnt(9)
  v_alignbyte_b32 v24, v125, v124, v15
  v_alignbyte_b32 v25, v126, v125, v15
  v_alignbyte_b32 v26, v127, v126, v15
  v_alignbyte_b32 v27, v128, v127, v15
  ds_read2_b32 v[124:125], v110 offset0:0 offset1:1
  ds_read2_b32 v[126:127], v110 offset0:2 offset1:3
  ds_read_b32 v128, v110 offset:16
  v_mfma_f32_16x16x32_bf16 a[44:47], v[20:23], v[52:55], a[44:47]
  s_waitcnt lgkmcnt(9)
  v_alignbyte_b32 v28, v131, v130, v15
  v_alignbyte_b32 v29, v132, v131, v15
  v_alignbyte_b32 v30, v133, v132, v15
  v_alignbyte_b32 v31, v134, v133, v15
  ds_read2_b32 v[130:131], v111 offset0:0 offset1:1
  ds_read2_b32 v[132:133], v111 offset0:2 offset1:3
  ds_read_b32 v134, v111 offset:16
  v_mfma_f32_16x16x32_bf16 a[76:79], v[24:27], v[56:59], a[76:79]
  s_waitcnt lgkmcnt(9)
  v_alignbyte_b32 v32, v113, v112, v15
  v_alignbyte_b32 v33, v114, v113, v15
  v_alignbyte_b32 v34, v115, v114, v15
  v_alignbyte_b32 v35, v116, v115, v15
  ds_read_b64 v[84:85], v8
  ds_read_b64 v[86:87], v9
  v_mfma_f32_16x16x32_bf16 a[108:111], v[28:31], v[60:63], a[108:111]
  s_waitcnt lgkmcnt(8)
  v_alignbyte_b32 v36, v119, v118, v15
  v_alignbyte_b32 v37, v120, v119, v15
  v_alignbyte_b32 v38, v121, v120, v15
  v_alignbyte_b32 v39, v122, v121, v15
  v_mfma_f32_16x16x32_bf16 a[140:143], v[32:35], v[64:67], a[140:143]
  s_waitcnt lgkmcnt(5)
  v_alignbyte_b32 v40, v125, v124, v15
  v_alignbyte_b32 v41, v126, v125, v15
  v_alignbyte_b32 v42, v127, v126, v15
  v_alignbyte_b32 v43, v128, v127, v15
  v_mfma_f32_16x16x32_bf16 a[172:175], v[36:39], v[68:71], a[172:175]
  s_waitcnt lgkmcnt(2)
  v_alignbyte_b32 v44, v131, v130, v15
  v_alignbyte_b32 v45, v132, v131, v15
  v_alignbyte_b32 v46, v133, v132, v15
  v_alignbyte_b32 v47, v134, v133, v15
  v_mfma_f32_16x16x32_bf16 a[204:207], v[40:43], v[72:75], a[204:207]
  s_nop 0
  v_mfma_f32_16x16x32_bf16 a[236:239], v[44:47], v[76:79], a[236:239]
  s_waitcnt lgkmcnt(0)
  ds_read_b128 v[48:51], v4 offset:1536
  ds_read_b128 v[52:55], v4 offset:6144
  ds_read_b128 v[56:59], v4 offset:10752
  ds_read_b128 v[60:63], v4 offset:15360
  ds_read_b128 v[64:67], v4 offset:19968
  ds_read_b128 v[68:71], v4 offset:24576
  ds_read_b128 v[72:75], v4 offset:29184
  ds_read_b128 v[76:79], v4 offset:33792
  s_mov_b32 exec_lo, s42
  s_mov_b32 exec_hi, s42
  ds_write_b128 v6, a[12:15] offset:0
  ds_write_b128 v6, a[44:47] offset:128
  ds_write_b128 v6, a[76:79] offset:256
  ds_write_b128 v6, a[108:111] offset:384
  ds_write_b128 v6, a[140:143] offset:512
  ds_write_b128 v6, a[172:175] offset:640
  ds_write_b128 v6, a[204:207] offset:768
  ds_write_b128 v6, a[236:239] offset:896
  s_mov_b64 exec, -1
  ds_read_b128 v[80:83], v7
  ds_write_b32 v14, v13 offset:8
  v_lshlrev_b32 v88, 16, v84
  v_and_b32 v89, 0xffff0000, v84
  v_lshlrev_b32 v90, 16, v85
  v_and_b32 v91, 0xffff0000, v85
  v_lshlrev_b32 v96, 16, v86
  v_and_b32 v97, 0xffff0000, v86
  v_lshlrev_b32 v98, 16, v87
  v_and_b32 v99, 0xffff0000, v87
  v_mul_f32 v92, v88, v12
  v_mul_f32 v93, v89, v12
  v_mul_f32 v94, v90, v12
  v_mul_f32 v95, v91, v12
  v_cvt_pk_bf16_f32 v84, v92, v93
  v_cvt_pk_bf16_f32 v85, v94, v95
  v_lshlrev_b32 v92, 16, v84
  v_and_b32 v93, 0xffff0000, v84
  v_lshlrev_b32 v94, 16, v85
  v_and_b32 v95, 0xffff0000, v85
  s_waitcnt lgkmcnt(1)
  v_fmac_f32 v80, v88, v11
  v_fmac_f32 v81, v89, v11
  v_fmac_f32 v82, v90, v11
  v_fmac_f32 v83, v91, v11
  v_cvt_pk_bf16_f32 v84, v80, v81
  v_cvt_pk_bf16_f32 v85, v82, v83
  v_lshlrev_b32 v80, 16, v84
  v_and_b32 v81, 0xffff0000, v84
  v_lshlrev_b32 v82, 16, v85
  v_and_b32 v83, 0xffff0000, v85
  v_add_f32 v80, v80, v92
  v_add_f32 v81, v81, v93
  v_add_f32 v82, v82, v94
  v_add_f32 v83, v83, v95
  v_cvt_pk_bf16_f32 v84, v80, v81
  v_cvt_pk_bf16_f32 v85, v82, v83
  v_lshlrev_b32 v80, 16, v84
  v_and_b32 v81, 0xffff0000, v84
  v_lshlrev_b32 v82, 16, v85
  v_and_b32 v83, 0xffff0000, v85
  v_add_f32 v80, v80, v96
  v_add_f32 v81, v81, v97
  v_add_f32 v82, v82, v98
  v_add_f32 v83, v83, v99
  v_cvt_pk_bf16_f32 v84, v80, v81
  v_cvt_pk_bf16_f32 v85, v82, v83
  buffer_store_dwordx2 v[84:85], v10, s[8:11], s40 offen sc1
  v_mfma_f32_16x16x32_bf16 a[16:19], v[16:19], v[48:51], a[16:19]
  ds_read_b128 v[48:51], v4 offset:1024
  v_mfma_f32_16x16x32_bf16 a[48:51], v[20:23], v[52:55], a[48:51]
  ds_read_b128 v[52:55], v4 offset:5632
  v_mfma_f32_16x16x32_bf16 a[80:83], v[24:27], v[56:59], a[80:83]
  ds_read_b128 v[56:59], v4 offset:10240
  v_mfma_f32_16x16x32_bf16 a[112:115], v[28:31], v[60:63], a[112:115]
  ds_read_b128 v[60:63], v4 offset:14848
  v_mfma_f32_16x16x32_bf16 a[144:147], v[32:35], v[64:67], a[144:147]
  ds_read_b128 v[64:67], v4 offset:19456
  v_mfma_f32_16x16x32_bf16 a[176:179], v[36:39], v[68:71], a[176:179]
  ds_read_b128 v[68:71], v4 offset:24064
  v_mfma_f32_16x16x32_bf16 a[208:211], v[40:43], v[72:75], a[208:211]
  ds_read_b128 v[72:75], v4 offset:28672
  v_mfma_f32_16x16x32_bf16 a[240:243], v[44:47], v[76:79], a[240:243]
  ds_read_b128 v[76:79], v4 offset:33280
  s_waitcnt lgkmcnt(7)
  v_mfma_f32_16x16x32_bf16 a[20:23], v[16:19], v[48:51], a[20:23]
  ds_read_b128 v[48:51], v4 offset:512
  s_waitcnt lgkmcnt(7)
  v_mfma_f32_16x16x32_bf16 a[52:55], v[20:23], v[52:55], a[52:55]
  ds_read_b128 v[52:55], v4 offset:5120
  s_waitcnt lgkmcnt(7)
  v_mfma_f32_16x16x32_bf16 a[84:87], v[24:27], v[56:59], a[84:87]
  ds_read_b128 v[56:59], v4 offset:9728
  s_waitcnt lgkmcnt(7)
  v_mfma_f32_16x16x32_bf16 a[116:119], v[28:31], v[60:63], a[116:119]
  ds_read_b128 v[60:63], v4 offset:14336
  s_waitcnt lgkmcnt(7)
  v_mfma_f32_16x16x32_bf16 a[148:151], v[32:35], v[64:67], a[148:151]
  ds_read_b128 v[64:67], v4 offset:18944
  s_waitcnt lgkmcnt(7)
  v_mfma_f32_16x16x32_bf16 a[180:183], v[36:39], v[68:71], a[180:183]
  ds_read_b128 v[68:71], v4 offset:23552
  s_waitcnt lgkmcnt(7)
  v_mfma_f32_16x16x32_bf16 a[212:215], v[40:43], v[72:75], a[212:215]
  ds_read_b128 v[72:75], v4 offset:28160
  s_waitcnt lgkmcnt(7)
  v_mfma_f32_16x16x32_bf16 a[244:247], v[44:47], v[76:79], a[244:247]
  ds_read_b128 v[76:79], v4 offset:32768
  s_waitcnt lgkmcnt(7)
  v_mfma_f32_16x16x32_bf16 a[24:27], v[16:19], v[48:51], a[24:27]
  ds_read_b128 v[48:51], v4 offset:0
  s_waitcnt lgkmcnt(7)
  v_mfma_f32_16x16x32_bf16 a[56:59], v[20:23], v[52:55], a[56:59]
  ds_read_b128 v[52:55], v4 offset:4608
  s_waitcnt lgkmcnt(7)
  v_mfma_f32_16x16x32_bf16 a[88:91], v[24:27], v[56:59], a[88:91]
  ds_read_b128 v[56:59], v4 offset:9216
  s_waitcnt lgkmcnt(7)
  v_mfma_f32_16x16x32_bf16 a[120:123], v[28:31], v[60:63], a[120:123]
  ds_read_b128 v[60:63], v4 offset:13824
  s_waitcnt lgkmcnt(7)
  v_mfma_f32_16x16x32_bf16 a[152:155], v[32:35], v[64:67], a[152:155]
  ds_read_b128 v[64:67], v4 offset:18432
  s_waitcnt lgkmcnt(7)
  v_mfma_f32_16x16x32_bf16 a[184:187], v[36:39], v[68:71], a[184:187]
  ds_read_b128 v[68:71], v4 offset:23040
  s_waitcnt lgkmcnt(7)
  v_mfma_f32_16x16x32_bf16 a[216:219], v[40:43], v[72:75], a[216:219]
  ds_read_b128 v[72:75], v4 offset:27648
  s_waitcnt lgkmcnt(7)
  v_mfma_f32_16x16x32_bf16 a[248:251], v[44:47], v[76:79], a[248:251]
  ds_read_b128 v[76:79], v4 offset:32256
  s_waitcnt lgkmcnt(7)
  v_mfma_f32_16x16x32_bf16 a[28:31], v[16:19], v[48:51], a[28:31]
  s_waitcnt lgkmcnt(6)
  v_mfma_f32_16x16x32_bf16 a[60:63], v[20:23], v[52:55], a[60:63]
  s_waitcnt lgkmcnt(5)
  v_mfma_f32_16x16x32_bf16 a[92:95], v[24:27], v[56:59], a[92:95]
  s_waitcnt lgkmcnt(4)
  v_mfma_f32_16x16x32_bf16 a[124:127], v[28:31], v[60:63], a[124:127]
  s_waitcnt lgkmcnt(3)
  v_mfma_f32_16x16x32_bf16 a[156:159], v[32:35], v[64:67], a[156:159]
  s_waitcnt lgkmcnt(2)
  v_mfma_f32_16x16x32_bf16 a[188:191], v[36:39], v[68:71], a[188:191]
  s_waitcnt lgkmcnt(1)
  v_mfma_f32_16x16x32_bf16 a[220:223], v[40:43], v[72:75], a[220:223]
  s_waitcnt lgkmcnt(0)
  v_mfma_f32_16x16x32_bf16 a[252:255], v[44:47], v[76:79], a[252:255]
  v_add_u32 v104, 64, v104
  v_add_u32 v105, 64, v105
  v_add_u32 v106, 64, v106
  v_add_u32 v107, 64, v107
  v_add_u32 v108, 64, v108
  v_add_u32 v109, 64, v109
  v_add_u32 v110, 64, v110
  v_add_u32 v111, 64, v111
  v_add_u32 v4, 64, v4
  v_add_u32 v8, 64, v8
  s_add_u32 s40, s40, 0x8000
  s_waitcnt vmcnt(0)
  s_mov_b64 exec, 1
  buffer_store_dword v13, v1, s[8:11], s39 offen sc1
  s_mov_b64 exec, -1
  ds_write_b32 v14, v13 offset:16
  s_add_u32 s32, s32, 1
  s_and_b32 s6, s32, 7
  s_cbranch_scc1 L_c_conv3
L_c_conv4:
  s_add_u32 s33, s32, 1
  s_and_b32 s6, s32, 7
  s_lshl_b32 s7, s6, 10
  s_add_u32 s7, s7, s35
  v_add_u32 v9, s7, v10
  s_lshl_b32 s6, s6, 1
  s_lshl_b32 s42, 0x30003, s6
  v_mov_b32 v13, s33
  ds_read_b128 v[48:51], v4 offset:1536
  ds_read_b128 v[52:55], v4 offset:6144
  ds_read_b128 v[56:59], v4 offset:10752
  ds_read_b128 v[60:63], v4 offset:15360
  ds_read_b128 v[64:67], v4 offset:19968
  ds_read_b128 v[68:71], v4 offset:24576
  ds_read_b128 v[72:75], v4 offset:29184
  ds_read_b128 v[76:79], v4 offset:33792
  s_mov_b32 s7, 0
L_lw_124:
  ds_read_b32 v88, v2 offset:0
  s_waitcnt lgkmcnt(0)
  v_cmp_gt_i32 vcc, s33, v88
  s_cbranch_vccz L_lwo_125
  s_add_u32 s7, s7, 1
  s_cmp_lt_u32 s7, 131072
  s_cbranch_scc1 L_lw_124
  s_mov_b32 s6, 42
  s_branch L_err
L_lwo_125:
  ds_read2_b32 v[112:113], v104 offset0:0 offset1:1
  ds_read2_b32 v[114:115], v104 offset0:2 offset1:3
  ds_read_b32 v116, v104 offset:16
  ds_read2_b32 v[118:119], v105 offset0:0 offset1:1
  ds_read2_b32 v[120:121], v105 offset0:2 offset1:3
  ds_read_b32 v122, v105 offset:16
  ds_read2_b32 v[124:125], v106 offset0:0 offset1:1
  ds_read2_b32 v[126:127], v106 offset0:2 offset1:3
  ds_read_b32 v128, v106 offset:16
  ds_read2_b32 v[130:131], v107 offset0:0 offset1:1
  ds_read2_b32 v[132:133], v107 offset0:2 offset1:3
  ds_read_b32 v134, v107 offset:16
  s_waitcnt lgkmcnt(9)
  v_alignbyte_b32 v16, v113, v112, v15
  v_alignbyte_b32 v17, v114, v113, v15
  v_alignbyte_b32 v18, v115, v114, v15
  v_alignbyte_b32 v19, v116, v115, v15
  ds_read2_b32 v[112:113], v108 offset0:0 offset1:1
  ds_read2_b32 v[114:115], v108 offset0:2 offset1:3
  ds_read_b32 v116, v108 offset:16
  s_waitcnt lgkmcnt(9)
  v_alignbyte_b32 v20, v119, v118, v15
  v_alignbyte_b32 v21, v120, v119, v15
  v_alignbyte_b32 v22, v121, v120, v15
  v_alignbyte_b32 v23, v122, v121, v15
  ds_read2_b32 v[118:119], v109 offset0:0 offset1:1
  ds_read2_b32 v[120:121], v109 offset0:2 offset1:3
  ds_read_b32 v122, v109 offset:16
  v_mfma_f32_16x16x32_bf16 a[16:19], v[16:19], v[48:51], a[16:19]
  s_waitcnt lgkmcnt(9)
  v_alignbyte_b32 v24, v125, v124, v15
  v_alignbyte_b32 v25, v126, v125, v15
  v_alignbyte_b32 v26, v127, v126, v15
  v_alignbyte_b32 v27, v128, v127, v15
  ds_read2_b32 v[124:125], v110 offset0:0 offset1:1
  ds_read2_b32 v[126:127], v110 offset0:2 offset1:3
  ds_read_b32 v128, v110 offset:16
  v_mfma_f32_16x16x32_bf16 a[48:51], v[20:23], v[52:55], a[48:51]
  s_waitcnt lgkmcnt(9)
  v_alignbyte_b32 v28, v131, v130, v15
  v_alignbyte_b32 v29, v132, v131, v15
  v_alignbyte_b32 v30, v133, v132, v15
  v_alignbyte_b32 v31, v134, v133, v15
  ds_read2_b32 v[130:131], v111 offset0:0 offset1:1
  ds_read2_b32 v[132:133], v111 offset0:2 offset1:3
  ds_read_b32 v134, v111 offset:16
  v_mfma_f32_16x16x32_bf16 a[80:83], v[24:27], v[56:59], a[80:83]
  s_waitcnt lgkmcnt(9)
  v_alignbyte_b32 v32, v113, v112, v15
  v_alignbyte_b32 v33, v114, v113, v15
  v_alignbyte_b32 v34, v115, v114, v15
  v_alignbyte_b32 v35, v116, v115, v15
  ds_read_b64 v[84:85], v8
  ds_read_b64 v[86:87], v9
  v_mfma_f32_16x16x32_bf16 a[112:115], v[28:31], v[60:63], a[112:115]
  s_waitcnt lgkmcnt(8)
  v_alignbyte_b32 v36, v119, v118, v15
  v_alignbyte_b32 v37, v120, v119, v15
  v_alignbyte_b32 v38, v121, v120, v15
  v_alignbyte_b32 v39, v122, v121, v15
  v_mfma_f32_16x16x32_bf16 a[144:147], v[32:35], v[64:67], a[144:147]
  s_waitcnt lgkmcnt(5)
  v_alignbyte_b32 v40, v125, v124, v15
  v_alignbyte_b32 v41, v126, v125, v15
  v_alignbyte_b32 v42, v127, v126, v15
  v_alignbyte_b32 v43, v128, v127, v15
  v_mfma_f32_16x16x32_bf16 a[176:179], v[36:39], v[68:71], a[176:179]
  s_waitcnt lgkmcnt(2)
  v_alignbyte_b32 v44, v131, v130, v15
  v_alignbyte_b32 v45, v132, v131, v15
  v_alignbyte_b32 v46, v133, v132, v15
  v_alignbyte_b32 v47, v134, v133, v15
  v_mfma_f32_16x16x32_bf16 a[208:211], v[40:43], v[72:75], a[208:211]
  s_nop 0
  v_mfma_f32_16x16x32_bf16 a[240:243], v[44:47], v[76:79], a[240:243]
  s_waitcnt lgkmcnt(0)
  ds_read_b128 v[48:51], v4 offset:1024
  ds_read_b128 v[52:55], v4 offset:5632
  ds_read_b128 v[56:59], v4 offset:10240
  ds_read_b128 v[60:63], v4 offset:14848
  ds_read_b128 v[64:67], v4 offset:19456
  ds_read_b128 v[68:71], v4 offset:24064
  ds_read_b128 v[72:75], v4 offset:28672
  ds_read_b128 v[76:79], v4 offset:33280
  s_mov_b32 exec_lo, s42
  s_mov_b32 exec_hi, s42
  ds_write_b128 v6, a[16:19] offset:0
  ds_write_b128 v6, a[48:51] offset:128
  ds_write_b128 v6, a[80:83] offset:256
  ds_write_b128 v6, a[112:115] offset:384
  ds_write_b128 v6, a[144:147] offset:512
  ds_write_b128 v6, a[176:179] offset:640
  ds_write_b128 v6, a[208:211] offset:768
  ds_write_b128 v6, a[240:243] offset:896
  s_mov_b64 exec, -1
  ds_read_b128 v[80:83], v7
  ds_write_b32 v14, v13 offset:8
  v_lshlrev_b32 v88, 16, v84
  v_and_b32 v89, 0xffff0000, v84
  v_lshlrev_b32 v90, 16, v85
  v_and_b32 v91, 0xffff0000, v85
  v_lshlrev_b32 v96, 16, v86
  v_and_b32 v97, 0xffff0000, v86
  v_lshlrev_b32 v98, 16, v87
  v_and_b32 v99, 0xffff0000, v87
  v_mul_f32 v92, v88, v12
  v_mul_f32 v93, v89, v12
  v_mul_f32 v94, v90, v12
  v_mul_f32 v95, v91, v12
  v_cvt_pk_bf16_f32 v84, v92, v93
  v_cvt_pk_bf16_f32 v85, v94, v95
  v_lshlrev_b32 v92, 16, v84
  v_and_b32 v93, 0xffff0000, v84
  v_lshlrev_b32 v94, 16, v85
  v_and_b32 v95, 0xffff0000, v85
  s_waitcnt lgkmcnt(1)
  v_fmac_f32 v80, v88, v11
  v_fmac_f32 v81, v89, v11
  v_fmac_f32 v82, v90, v11
  v_fmac_f32 v83, v91, v11
  v_cvt_pk_bf16_f32 v84, v80, v81
  v_cvt_pk_bf16_f32 v85, v82, v83
  v_lshlrev_b32 v80, 16, v84
  v_and_b32 v81, 0xffff0000, v84
  v_lshlrev_b32 v82, 16, v85
  v_and_b32 v83, 0xffff0000, v85
  v_add_f32 v80, v80, v92
  v_add_f32 v81, v81, v93
  v_add_f32 v82, v82, v94
  v_add_f32 v83, v83, v95
  v_cvt_pk_bf16_f32 v84, v80, v81
  v_cvt_pk_bf16_f32 v85, v82, v83
  v_lshlrev_b32 v80, 16, v84
  v_and_b32 v81, 0xffff0000, v84
  v_lshlrev_b32 v82, 16, v85
  v_and_b32 v83, 0xffff0000, v85
  v_add_f32 v80, v80, v96
  v_add_f32 v81, v81, v97
  v_add_f32 v82, v82, v98
  v_add_f32 v83, v83, v99
  v_cvt_pk_bf16_f32 v84, v80, v81
  v_cvt_pk_bf16_f32 v85, v82, v83
  buffer_store_dwordx2 v[84:85], v10, s[8:11], s40 offen sc1
  v_mfma_f32_16x16x32_bf16 a[20:23], v[16:19], v[48:51], a[20:23]
  ds_read_b128 v[48:51], v4 offset:512
  v_mfma_f32_16x16x32_bf16 a[52:55], v[20:23], v[52:55], a[52:55]
  ds_read_b128 v[52:55], v4 offset:5120
  v_mfma_f32_16x16x32_bf16 a[84:87], v[24:27], v[56:59], a[84:87]
  ds_read_b128 v[56:59], v4 offset:9728
  v_mfma_f32_16x16x32_bf16 a[116:119], v[28:31], v[60:63], a[116:119]
  ds_read_b128 v[60:63], v4 offset:14336
  v_mfma_f32_16x16x32_bf16 a[148:151], v[32:35], v[64:67], a[148:151]
  ds_read_b128 v[64:67], v4 offset:18944
  v_mfma_f32_16x16x32_bf16 a[180:183], v[36:39], v[68:71], a[180:183]
  ds_read_b128 v[68:71], v4 offset:23552
  v_mfma_f32_16x16x32_bf16 a[212:215], v[40:43], v[72:75], a[212:215]
  ds_read_b128 v[72:75], v4 offset:28160
  v_mfma_f32_16x16x32_bf16 a[244:247], v[44:47], v[76:79], a[244:247]
  ds_read_b128 v[76:79], v4 offset:32768
  s_waitcnt lgkmcnt(7)
  v_mfma_f32_16x16x32_bf16 a[24:27], v[16:19], v[48:51], a[24:27]
  ds_read_b128 v[48:51], v4 offset:0
  s_waitcnt lgkmcnt(7)
  v_mfma_f32_16x16x32_bf16 a[56:59], v[20:23], v[52:55], a[56:59]
  ds_read_b128 v[52:55], v4 offset:4608
  s_waitcnt lgkmcnt(7)
  v_mfma_f32_16x16x32_bf16 a[88:91], v[24:27], v[56:59], a[88:91]
  ds_read_b128 v[56:59], v4 offset:9216
  s_waitcnt lgkmcnt(7)
  v_mfma_f32_16x16x32_bf16 a[120:123], v[28:31], v[60:63], a[120:123]
  ds_read_b128 v[60:63], v4 offset:13824
  s_waitcnt lgkmcnt(7)
  v_mfma_f32_16x16x32_bf16 a[152:155], v[32:35], v[64:67], a[152:155]
  ds_read_b128 v[64:67], v4 offset:18432
  s_waitcnt lgkmcnt(7)
  v_mfma_f32_16x16x32_bf16 a[184:187], v[36:39], v[68:71], a[184:187]
  ds_read_b128 v[68:71], v4 offset:23040
  s_waitcnt lgkmcnt(7)
  v_mfma_f32_16x16x32_bf16 a[216:219], v[40:43], v[72:75], a[216:219]
  ds_read_b128 v[72:75], v4 offset:27648
  s_waitcnt lgkmcnt(7)
  v_mfma_f32_16x16x32_bf16 a[248:251], v[44:47], v[76:79], a[248:251]
  ds_read_b128 v[76:79], v4 offset:32256
  s_waitcnt lgkmcnt(7)
  v_mfma_f32_16x16x32_bf16 a[28:31], v[16:19], v[48:51], a[28:31]
  s_waitcnt lgkmcnt(6)
  v_mfma_f32_16x16x32_bf16 a[60:63], v[20:23], v[52:55], a[60:63]
  s_waitcnt lgkmcnt(5)
  v_mfma_f32_16x16x32_bf16 a[92:95], v[24:27], v[56:59], a[92:95]
  s_waitcnt lgkmcnt(4)
  v_mfma_f32_16x16x32_bf16 a[124:127], v[28:31], v[60:63], a[124:127]
  s_waitcnt lgkmcnt(3)
  v_mfma_f32_16x16x32_bf16 a[156:159], v[32:35], v[64:67], a[156:159]
  s_waitcnt lgkmcnt(2)
  v_mfma_f32_16x16x32_bf16 a[188:191], v[36:39], v[68:71], a[188:191]
  s_waitcnt lgkmcnt(1)
  v_mfma_f32_16x16x32_bf16 a[220:223], v[40:43], v[72:75], a[220:223]
  s_waitcnt lgkmcnt(0)
  v_mfma_f32_16x16x32_bf16 a[252:255], v[44:47], v[76:79], a[252:255]
  v_add_u32 v104, 64, v104
  v_add_u32 v105, 64, v105
  v_add_u32 v106, 64, v106
  v_add_u32 v107, 64, v107
  v_add_u32 v108, 64, v108
  v_add_u32 v109, 64, v109
  v_add_u32 v110, 64, v110
  v_add_u32 v111, 64, v111
  v_add_u32 v4, 64, v4
  v_add_u32 v8, 64, v8
  s_add_u32 s40, s40, 0x8000
  s_waitcnt vmcnt(0)
  s_mov_b64 exec, 1
  buffer_store_dword v13, v1, s[8:11], s39 offen sc1
  s_mov_b64 exec, -1
  ds_write_b32 v14, v13 offset:16
  s_add_u32 s32, s32, 1
  s_and_b32 s6, s32, 7
  s_cbranch_scc1 L_c_conv4
L_c_conv5:
  s_add_u32 s33, s32, 1
  s_and_b32 s6, s32, 7
  s_lshl_b32 s7, s6, 10
  s_add_u32 s7, s7, s35
  v_add_u32 v9, s7, v10
  s_lshl_b32 s6, s6, 1
  s_lshl_b32 s42, 0x30003, s6
  v_mov_b32 v13, s33
  ds_read_b128 v[48:51], v4 offset:1024
  ds_read_b128 v[52:55], v4 offset:5632
  ds_read_b128 v[56:59], v4 offset:10240
  ds_read_b128 v[60:63], v4 offset:14848
  ds_read_b128 v[64:67], v4 offset:19456
  ds_read_b128 v[68:71], v4 offset:24064
  ds_read_b128 v[72:75], v4 offset:28672
  ds_read_b128 v[76:79], v4 offset:33280
  s_mov_b32 s7, 0
L_lw_126:
  ds_read_b32 v88, v2 offset:0
  s_waitcnt lgkmcnt(0)
  v_cmp_gt_i32 vcc, s33, v88
  s_cbranch_vccz L_lwo_127
  s_add_u32 s7, s7, 1
  s_cmp_lt_u32 s7, 131072
  s_cbranch_scc1 L_lw_126
  s_mov_b32 s6, 42
  s_branch L_err
L_lwo_127:
  ds_read2_b32 v[112:113], v104 offset0:0 offset1:1
  ds_read2_b32 v[114:115], v104 offset0:2 offset1:3
  ds_read_b32 v116, v104 offset:16
  ds_read2_b32 v[118:119], v105 offset0:0 offset1:1
  ds_read2_b32 v[120:121], v105 offset0:2 offset1:3
  ds_read_b32 v122, v105 offset:16
  ds_read2_b32 v[124:125], v106 offset0:0 offset1:1
  ds_read2_b32 v[126:127], v106 offset0:2 offset1:3
  ds_read_b32 v128, v106 offset:16
  ds_read2_b32 v[130:131], v107 offset0:0 offset1:1
  ds_read2_b32 v[132:133], v107 offset0:2 offset1:3
  ds_read_b32 v134, v107 offset:16
  s_waitcnt lgkmcnt(9)
  v_alignbyte_b32 v16, v113, v112, v15
  v_alignbyte_b32 v17, v114, v113, v15
  v_alignbyte_b32 v18, v115, v114, v15
  v_alignbyte_b32 v19, v116, v115, v15
  ds_read2_b32 v[112:113], v108 offset0:0 offset1:1
  ds_read2_b32 v[114:115], v108 offset0:2 offset1:3
  ds_read_b32 v116, v108 offset:16
  s_waitcnt lgkmcnt(9)
  v_alignbyte_b32 v20, v119, v118, v15
  v_alignbyte_b32 v21, v120, v119, v15
  v_alignbyte_b32 v22, v121, v120, v15
  v_alignbyte_b32 v23, v122, v121, v15
  ds_read2_b32 v[118:119], v109 offset0:0 offset1:1
  ds_read2_b32 v[120:121], v109 offset0:2 offset1:3
  ds_read_b32 v122, v109 offset:16
  v_mfma_f32_16x16x32_bf16 a[20:23], v[16:19], v[48:51], a[20:23]
  s_waitcnt lgkmcnt(9)
  v_alignbyte_b32 v24, v125, v124, v15
  v_alignbyte_b32 v25, v126, v125, v15
  v_alignbyte_b32 v26, v127, v126, v15
  v_alignbyte_b32 v27, v128, v127, v15
  ds_read2_b32 v[124:125], v110 offset0:0 offset1:1
  ds_read2_b32 v[126:127], v110 offset0:2 offset1:3
  ds_read_b32 v128, v110 offset:16
  v_mfma_f32_16x16x32_bf16 a[52:55], v[20:23], v[52:55], a[52:55]
  s_waitcnt lgkmcnt(9)
  v_alignbyte_b32 v28, v131, v130, v15
  v_alignbyte_b32 v29, v132, v131, v15
  v_alignbyte_b32 v30, v133, v132, v15
  v_alignbyte_b32 v31, v134, v133, v15
  ds_read2_b32 v[130:131], v111 offset0:0 offset1:1
  ds_read2_b32 v[132:133], v111 offset0:2 offset1:3
  ds_read_b32 v134, v111 offset:16
  v_mfma_f32_16x16x32_bf16 a[84:87], v[24:27], v[56:59], a[84:87]
  s_waitcnt lgkmcnt(9)
  v_alignbyte_b32 v32, v113, v112, v15
  v_alignbyte_b32 v33, v114, v113, v15
  v_alignbyte_b32 v34, v115, v114, v15
  v_alignbyte_b32 v35, v116, v115, v15
  ds_read_b64 v[84:85], v8
  ds_read_b64 v[86:87], v9
  v_mfma_f32_16x16x32_bf16 a[116:119], v[28:31], v[60:63], a[116:119]
  s_waitcnt lgkmcnt(8)
  v_alignbyte_b32 v36, v119, v118, v15
  v_alignbyte_b32 v37, v120, v119, v15
  v_alignbyte_b32 v38, v121, v120, v15
  v_alignbyte_b32 v39, v122, v121, v15
  v_mfma_f32_16x16x32_bf16 a[148:151], v[32:35], v[64:67], a[148:151]
  s_waitcnt lgkmcnt(5)
  v_alignbyte_b32 v40, v125, v124, v15
  v_alignbyte_b32 v41, v126, v125, v15
  v_alignbyte_b32 v42, v127, v126, v15
  v_alignbyte_b32 v43, v128, v127, v15
  v_mfma_f32_16x16x32_bf16 a[180:183], v[36:39], v[68:71], a[180:183]
  s_waitcnt lgkmcnt(2)
  v_alignbyte_b32 v44, v131, v130, v15
  v_alignbyte_b32 v45, v132, v131, v15
  v_alignbyte_b32 v46, v133, v132, v15
  v_alignbyte_b32 v47, v134, v133, v15
  v_mfma_f32_16x16x32_bf16 a[212:215], v[40:43], v[72:75], a[212:215]
  s_nop 0
  v_mfma_f32_16x16x32_bf16 a[244:247], v[44:47], v[76:79], a[244:247]
  s_waitcnt lgkmcnt(0)
  ds_read_b128 v[48:51], v4 offset:512
  ds_read_b128 v[52:55], v4 offset:5120
  ds_read_b128 v[56:59], v4 offset:9728
  ds_read_b128 v[60:63], v4 offset:14336
  ds_read_b128 v[64:67], v4 offset:18944
  ds_read_b128 v[68:71], v4 offset:23552
  ds_read_b128 v[72:75], v4 offset:28160
  ds_read_b128 v[76:79], v4 offset:32768
  s_mov_b32 exec_lo, s42
  s_mov_b32 exec_hi, s42
  ds_write_b128 v6, a[20:23] offset:0
  ds_write_b128 v6, a[52:55] offset:128
  ds_write_b128 v6, a[84:87] offset:256
  ds_write_b128 v6, a[116:119] offset:384
  ds_write_b128 v6, a[148:151] offset:512
  ds_write_b128 v6, a[180:183] offset:640
  ds_write_b128 v6, a[212:215] offset:768
  ds_write_b128 v6, a[244:247] offset:896
  s_mov_b64 exec, -1
  ds_read_b128 v[80:83], v7
  ds_write_b32 v14, v13 offset:8
  v_lshlrev_b32 v88, 16, v84
  v_and_b32 v89, 0xffff0000, v84
  v_lshlrev_b32 v90, 16, v85
  v_and_b32 v91, 0xffff0000, v85
  v_lshlrev_b32 v96, 16, v86
  v_and_b32 v97, 0xffff0000, v86
  v_lshlrev_b32 v98, 16, v87
  v_and_b32 v99, 0xffff0000, v87
  v_mul_f32 v92, v88, v12
  v_mul_f32 v93, v89, v12
  v_mul_f32 v94, v90, v12
  v_mul_f32 v95, v91, v12
  v_cvt_pk_bf16_f32 v84, v92, v93
  v_cvt_pk_bf16_f32 v85, v94, v95
  v_lshlrev_b32 v92, 16, v84
  v_and_b32 v93, 0xffff0000, v84
  v_lshlrev_b32 v94, 16, v85
  v_and_b32 v95, 0xffff0000, v85
  s_waitcnt lgkmcnt(1)
  v_fmac_f32 v80, v88, v11
  v_fmac_f32 v81, v89, v11
  v_fmac_f32 v82, v90, v11
  v_fmac_f32 v83, v91, v11
  v_cvt_pk_bf16_f32 v84, v80, v81
  v_cvt_pk_bf16_f32 v85, v82, v83
  v_lshlrev_b32 v80, 16, v84
  v_and_b32 v81, 0xffff0000, v84
  v_lshlrev_b32 v82, 16, v85
  v_and_b32 v83, 0xffff0000, v85
  v_add_f32 v80, v80, v92
  v_add_f32 v81, v81, v93
  v_add_f32 v82, v82, v94
  v_add_f32 v83, v83, v95
  v_cvt_pk_bf16_f32 v84, v80, v81
  v_cvt_pk_bf16_f32 v85, v82, v83
  v_lshlrev_b32 v80, 16, v84
  v_and_b32 v81, 0xffff0000, v84
  v_lshlrev_b32 v82, 16, v85
  v_and_b32 v83, 0xffff0000, v85
  v_add_f32 v80, v80, v96
  v_add_f32 v81, v81, v97
  v_add_f32 v82, v82, v98
  v_add_f32 v83, v83, v99
  v_cvt_pk_bf16_f32 v84, v80, v81
  v_cvt_pk_bf16_f32 v85, v82, v83
  buffer_store_dwordx2 v[84:85], v10, s[8:11], s40 offen sc1
  v_mfma_f32_16x16x32_bf16 a[24:27], v[16:19], v[48:51], a[24:27]
  ds_read_b128 v[48:51], v4 offset:0
  v_mfma_f32_16x16x32_bf16 a[56:59], v[20:23], v[52:55], a[56:59]
  ds_read_b128 v[52:55], v4 offset:4608
  v_mfma_f32_16x16x32_bf16 a[88:91], v[24:27], v[56:59], a[88:91]
  ds_read_b128 v[56:59], v4 offset:9216
  v_mfma_f32_16x16x32_bf16 a[120:123], v[28:31], v[60:63], a[120:123]
  ds_read_b128 v[60:63], v4 offset:13824
  v_mfma_f32_16x16x32_bf16 a[152:155], v[32:35], v[64:67], a[152:155]
  ds_read_b128 v[64:67], v4 offset:18432
  v_mfma_f32_16x16x32_bf16 a[184:187], v[36:39], v[68:71], a[184:187]
  ds_read_b128 v[68:71], v4 offset:23040
  v_mfma_f32_16x16x32_bf16 a[216:219], v[40:43], v[72:75], a[216:219]
  ds_read_b128 v[72:75], v4 offset:27648
  v_mfma_f32_16x16x32_bf16 a[248:251], v[44:47], v[76:79], a[248:251]
  ds_read_b128 v[76:79], v4 offset:32256
  s_waitcnt lgkmcnt(7)
  v_mfma_f32_16x16x32_bf16 a[28:31], v[16:19], v[48:51], a[28:31]
  s_waitcnt lgkmcnt(6)
  v_mfma_f32_16x16x32_bf16 a[60:63], v[20:23], v[52:55], a[60:63]
  s_waitcnt lgkmcnt(5)
  v_mfma_f32_16x16x32_bf16 a[92:95], v[24:27], v[56:59], a[92:95]
  s_waitcnt lgkmcnt(4)
  v_mfma_f32_16x16x32_bf16 a[124:127], v[28:31], v[60:63], a[124:127]
  s_waitcnt lgkmcnt(3)
  v_mfma_f32_16x16x32_bf16 a[156:159], v[32:35], v[64:67], a[156:159]
  s_waitcnt lgkmcnt(2)
  v_mfma_f32_16x16x32_bf16 a[188:191], v[36:39], v[68:71], a[188:191]
  s_waitcnt lgkmcnt(1)
  v_mfma_f32_16x16x32_bf16 a[220:223], v[40:43], v[72:75], a[220:223]
  s_waitcnt lgkmcnt(0)
  v_mfma_f32_16x16x32_bf16 a[252:255], v[44:47], v[76:79], a[252:255]
  v_add_u32 v104, 64, v104
  v_add_u32 v105, 64, v105
  v_add_u32 v106, 64, v106
  v_add_u32 v107, 64, v107
  v_add_u32 v108, 64, v108
  v_add_u32 v109, 64, v109
  v_add_u32 v110, 64, v110
  v_add_u32 v111, 64, v111
  v_add_u32 v4, 64, v4
  v_add_u32 v8, 64, v8
  s_add_u32 s40, s40, 0x8000
  s_waitcnt vmcnt(0)
  s_mov_b64 exec, 1
  buffer_store_dword v13, v1, s[8:11], s39 offen sc1
  s_mov_b64 exec, -1
  ds_write_b32 v14, v13 offset:16
  s_add_u32 s32, s32, 1
  s_and_b32 s6, s32, 7
  s_cbranch_scc1 L_c_conv5
L_c_conv6:
  s_add_u32 s33, s32, 1
  s_and_b32 s6, s32, 7
  s_lshl_b32 s7, s6, 10
  s_add_u32 s7, s7, s35
  v_add_u32 v9, s7, v10
  s_lshl_b32 s6, s6, 1
  s_lshl_b32 s42, 0x30003, s6
  v_mov_b32 v13, s33
  ds_read_b128 v[48:51], v4 offset:512
  ds_read_b128 v[52:55], v4 offset:5120
  ds_read_b128 v[56:59], v4 offset:9728
  ds_read_b128 v[60:63], v4 offset:14336
  ds_read_b128 v[64:67], v4 offset:18944
  ds_read_b128 v[68:71], v4 offset:23552
  ds_read_b128 v[72:75], v4 offset:28160
  ds_read_b128 v[76:79], v4 offset:32768
  s_mov_b32 s7, 0
L_lw_128:
  ds_read_b32 v88, v2 offset:0
  s_waitcnt lgkmcnt(0)
  v_cmp_gt_i32 vcc, s33, v88
  s_cbranch_vccz L_lwo_129
  s_add_u32 s7, s7, 1
  s_cmp_lt_u32 s7, 131072
  s_cbranch_scc1 L_lw_128
  s_mov_b32 s6, 42
  s_branch L_err
L_lwo_129:
  ds_read2_b32 v[112:113], v104 offset0:0 offset1:1
  ds_read2_b32 v[114:115], v104 offset0:2 offset1:3
  ds_read_b32 v116, v104 offset:16
  ds_read2_b32 v[118:119], v105 offset0:0 offset1:1
  ds_read2_b32 v[120:121], v105 offset0:2 offset1:3
  ds_read_b32 v122, v105 offset:16
  ds_read2_b32 v[124:125], v106 offset0:0 offset1:1
  ds_read2_b32 v[126:127], v106 offset0:2 offset1:3
  ds_read_b32 v128, v106 offset:16
  ds_read2_b32 v[130:131], v107 offset0:0 offset1:1
  ds_read2_b32 v[132:133], v107 offset0:2 offset1:3
  ds_read_b32 v134, v107 offset:16
  s_waitcnt lgkmcnt(9)
  v_alignbyte_b32 v16, v113, v112, v15
  v_alignbyte_b32 v17, v114, v113, v15
  v_alignbyte_b32 v18, v115, v114, v15
  v_alignbyte_b32 v19, v116, v115, v15
  ds_read2_b32 v[112:113], v108 offset0:0 offset1:1
  ds_read2_b32 v[114:115], v108 offset0:2 offset1:3
  ds_read_b32 v116, v108 offset:16
  s_waitcnt lgkmcnt(9)
  v_alignbyte_b32 v20, v119, v118, v15
  v_alignbyte_b32 v21, v120, v119, v15
  v_alignbyte_b32 v22, v121, v120, v15
  v_alignbyte_b32 v23, v122, v121, v15
  ds_read2_b32 v[118:119], v109 offset0:0 offset1:1
  ds_read2_b32 v[120:121], v109 offset0:2 offset1:3
  ds_read_b32 v122, v109 offset:16
  v_mfma_f32_16x16x32_bf16 a[24:27], v[16:19], v[48:51], a[24:27]
  s_waitcnt lgkmcnt(9)
  v_alignbyte_b32 v24, v125, v124, v15
  v_alignbyte_b32 v25, v126, v125, v15
  v_alignbyte_b32 v26, v127, v126, v15
  v_alignbyte_b32 v27, v128, v127, v15
  ds_read2_b32 v[124:125], v110 offset0:0 offset1:1
  ds_read2_b32 v[126:127], v110 offset0:2 offset1:3
  ds_read_b32 v128, v110 offset:16
  v_mfma_f32_16x16x32_bf16 a[56:59], v[20:23], v[52:55], a[56:59]
  s_waitcnt lgkmcnt(9)
  v_alignbyte_b32 v28, v131, v130, v15
  v_alignbyte_b32 v29, v132, v131, v15
  v_alignbyte_b32 v30, v133, v132, v15
  v_alignbyte_b32 v31, v134, v133, v15
  ds_read2_b32 v[130:131], v111 offset0:0 offset1:1
  ds_read2_b32 v[132:133], v111 offset0:2 offset1:3
  ds_read_b32 v134, v111 offset:16
  v_mfma_f32_16x16x32_bf16 a[88:91], v[24:27], v[56:59], a[88:91]
  s_waitcnt lgkmcnt(9)
  v_alignbyte_b32 v32, v113, v112, v15
  v_alignbyte_b32 v33, v114, v113, v15
  v_alignbyte_b32 v34, v115, v114, v15
  v_alignbyte_b32 v35, v116, v115, v15
  ds_read_b64 v[84:85], v8
  ds_read_b64 v[86:87], v9
  v_mfma_f32_16x16x32_bf16 a[120:123], v[28:31], v[60:63], a[120:123]
  s_waitcnt lgkmcnt(8)
  v_alignbyte_b32 v36, v119, v118, v15
  v_alignbyte_b32 v37, v120, v119, v15
  v_alignbyte_b32 v38, v121, v120, v15
  v_alignbyte_b32 v39, v122, v121, v15
  v_mfma_f32_16x16x32_bf16 a[152:155], v[32:35], v[64:67], a[152:155]
  s_waitcnt lgkmcnt(5)
  v_alignbyte_b32 v40, v125, v124, v15
  v_alignbyte_b32 v41, v126, v125, v15
  v_alignbyte_b32 v42, v127, v126, v15
  v_alignbyte_b32 v43, v128, v127, v15
  v_mfma_f32_16x16x32_bf16 a[184:187], v[36:39], v[68:71], a[184:187]
  s_waitcnt lgkmcnt(2)
  v_alignbyte_b32 v44, v131, v130, v15
  v_alignbyte_b32 v45, v132, v131, v15
  v_alignbyte_b32 v46, v133, v132, v15
  v_alignbyte_b32 v47, v134, v133, v15
  v_mfma_f32_16x16x32_bf16 a[216:219], v[40:43], v[72:75], a[216:219]
  s_nop 0
  v_mfma_f32_16x16x32_bf16 a[248:251], v[44:47], v[76:79], a[248:251]
  s_waitcnt lgkmcnt(0)
  ds_read_b128 v[48:51], v4 offset:0
  ds_read_b128 v[52:55], v4 offset:4608
  ds_read_b128 v[56:59], v4 offset:9216
  ds_read_b128 v[60:63], v4 offset:13824
  ds_read_b128 v[64:67], v4 offset:18432
  ds_read_b128 v[68:71], v4 offset:23040
  ds_read_b128 v[72:75], v4 offset:27648
  ds_read_b128 v[76:79], v4 offset:32256
  s_mov_b32 exec_lo, s42
  s_mov_b32 exec_hi, s42
  ds_write_b128 v6, a[24:27] offset:0
  ds_write_b128 v6, a[56:59] offset:128
  ds_write_b128 v6, a[88:91] offset:256
  ds_write_b128 v6, a[120:123] offset:384
  ds_write_b128 v6, a[152:155] offset:512
  ds_write_b128 v6, a[184:187] offset:640
  ds_write_b128 v6, a[216:219] offset:768
  ds_write_b128 v6, a[248:251] offset:896
  s_mov_b64 exec, -1
  ds_read_b128 v[80:83], v7
  ds_write_b32 v14, v13 offset:8
  v_lshlrev_b32 v88, 16, v84
  v_and_b32 v89, 0xffff0000, v84
  v_lshlrev_b32 v90, 16, v85
  v_and_b32 v91, 0xffff0000, v85
  v_lshlrev_b32 v96, 16, v86
  v_and_b32 v97, 0xffff0000, v86
  v_lshlrev_b32 v98, 16, v87
  v_and_b32 v99, 0xffff0000, v87
  v_mul_f32 v92, v88, v12
  v_mul_f32 v93, v89, v12
  v_mul_f32 v94, v90, v12
  v_mul_f32 v95, v91, v12
  v_cvt_pk_bf16_f32 v84, v92, v93
  v_cvt_pk_bf16_f32 v85, v94, v95
  v_lshlrev_b32 v92, 16, v84
  v_and_b32 v93, 0xffff0000, v84
  v_lshlrev_b32 v94, 16, v85
  v_and_b32 v95, 0xffff0000, v85
  s_waitcnt lgkmcnt(1)
  v_fmac_f32 v80, v88, v11
  v_fmac_f32 v81, v89, v11
  v_fmac_f32 v82, v90, v11
  v_fmac_f32 v83, v91, v11
  v_cvt_pk_bf16_f32 v84, v80, v81
  v_cvt_pk_bf16_f32 v85, v82, v83
  v_lshlrev_b32 v80, 16, v84
  v_and_b32 v81, 0xffff0000, v84
  v_lshlrev_b32 v82, 16, v85
  v_and_b32 v83, 0xffff0000, v85
  v_add_f32 v80, v80, v92
  v_add_f32 v81, v81, v93
  v_add_f32 v82, v82, v94
  v_add_f32 v83, v83, v95
  v_cvt_pk_bf16_f32 v84, v80, v81
  v_cvt_pk_bf16_f32 v85, v82, v83
  v_lshlrev_b32 v80, 16, v84
  v_and_b32 v81, 0xffff0000, v84
  v_lshlrev_b32 v82, 16, v85
  v_and_b32 v83, 0xffff0000, v85
  v_add_f32 v80, v80, v96
  v_add_f32 v81, v81, v97
  v_add_f32 v82, v82, v98
  v_add_f32 v83, v83, v99
  v_cvt_pk_bf16_f32 v84, v80, v81
  v_cvt_pk_bf16_f32 v85, v82, v83
  buffer_store_dwordx2 v[84:85], v10, s[8:11], s40 offen sc1
  v_mfma_f32_16x16x32_bf16 a[28:31], v[16:19], v[48:51], a[28:31]
  v_mfma_f32_16x16x32_bf16 a[60:63], v[20:23], v[52:55], a[60:63]
  v_mfma_f32_16x16x32_bf16 a[92:95], v[24:27], v[56:59], a[92:95]
  v_mfma_f32_16x16x32_bf16 a[124:127], v[28:31], v[60:63], a[124:127]
  v_mfma_f32_16x16x32_bf16 a[156:159], v[32:35], v[64:67], a[156:159]
  v_mfma_f32_16x16x32_bf16 a[188:191], v[36:39], v[68:71], a[188:191]
  v_mfma_f32_16x16x32_bf16 a[220:223], v[40:43], v[72:75], a[220:223]
  v_mfma_f32_16x16x32_bf16 a[252:255], v[44:47], v[76:79], a[252:255]
  v_add_u32 v104, 64, v104
  v_add_u32 v105, 64, v105
  v_add_u32 v106, 64, v106
  v_add_u32 v107, 64, v107
  v_add_u32 v108, 64, v108
  v_add_u32 v109, 64, v109
  v_add_u32 v110, 64, v110
  v_add_u32 v111, 64, v111
  v_add_u32 v4, 64, v4
  v_add_u32 v8, 64, v8
  s_add_u32 s40, s40, 0x8000
  s_waitcnt vmcnt(0)
  s_mov_b64 exec, 1
  buffer_store_dword v13, v1, s[8:11], s39 offen sc1
  s_mov_b64 exec, -1
  ds_write_b32 v14, v13 offset:16
  s_add_u32 s32, s32, 1
  s_and_b32 s6, s32, 7
  s_cbranch_scc1 L_c_conv6
L_c_conv7:
  s_add_u32 s33, s32, 1
  s_and_b32 s6, s32, 7
  s_lshl_b32 s7, s6, 10
  s_add_u32 s7, s7, s35
  v_add_u32 v9, s7, v10
  s_lshl_b32 s6, s6, 1
  s_lshl_b32 s42, 0x30003, s6
  v_mov_b32 v13, s33
  ds_read_b128 v[48:51], v4 offset:0
  ds_read_b128 v[52:55], v4 offset:4608
  ds_read_b128 v[56:59], v4 offset:9216
  ds_read_b128 v[60:63], v4 offset:13824
  ds_read_b128 v[64:67], v4 offset:18432
  ds_read_b128 v[68:71], v4 offset:23040
  ds_read_b128 v[72:75], v4 offset:27648
  ds_read_b128 v[76:79], v4 offset:32256
  s_mov_b32 s7, 0
L_lw_130:
  ds_read_b32 v88, v2 offset:0
  s_waitcnt lgkmcnt(0)
  v_cmp_gt_i32 vcc, s33, v88
  s_cbranch_vccz L_lwo_131
  s_add_u32 s7, s7, 1
  s_cmp_lt_u32 s7, 131072
  s_cbranch_scc1 L_lw_130
  s_mov_b32 s6, 42
  s_branch L_err
L_lwo_131:
  ds_read2_b32 v[112:113], v104 offset0:0 offset1:1
  ds_read2_b32 v[114:115], v104 offset0:2 offset1:3
  ds_read_b32 v116, v104 offset:16
  ds_read2_b32 v[118:119], v105 offset0:0 offset1:1
  ds_read2_b32 v[120:121], v105 offset0:2 offset1:3
  ds_read_b32 v122, v105 offset:16
  ds_read2_b32 v[124:125], v106 offset0:0 offset1:1
  ds_read2_b32 v[126:127], v106 offset0:2 offset1:3
  ds_read_b32 v128, v106 offset:16
  ds_read2_b32 v[130:131], v107 offset0:0 offset1:1
  ds_read2_b32 v[132:133], v107 offset0:2 offset1:3
  ds_read_b32 v134, v107 offset:16
  s_waitcnt lgkmcnt(9)
  v_alignbyte_b32 v16, v113, v112, v15
  v_alignbyte_b32 v17, v114, v113, v15
  v_alignbyte_b32 v18, v115, v114, v15
  v_alignbyte_b32 v19, v116, v115, v15
  ds_read2_b32 v[112:113], v108 offset0:0 offset1:1
  ds_read2_b32 v[114:115], v108 offset0:2 offset1:3
  ds_read_b32 v116, v108 offset:16
  s_waitcnt lgkmcnt(9)
  v_alignbyte_b32 v20, v119, v118, v15
  v_alignbyte_b32 v21, v120, v119, v15
  v_alignbyte_b32 v22, v121, v120, v15
  v_alignbyte_b32 v23, v122, v121, v15
  ds_read2_b32 v[118:119], v109 offset0:0 offset1:1
  ds_read2_b32 v[120:121], v109 offset0:2 offset1:3
  ds_read_b32 v122, v109 offset:16
  v_mfma_f32_16x16x32_bf16 a[28:31], v[16:19], v[48:51], a[28:31]
  s_waitcnt lgkmcnt(9)
  v_alignbyte_b32 v24, v125, v124, v15
  v_alignbyte_b32 v25, v126, v125, v15
  v_alignbyte_b32 v26, v127, v126, v15
  v_alignbyte_b32 v27, v128, v127, v15
  ds_read2_b32 v[124:125], v110 offset0:0 offset1:1
  ds_read2_b32 v[126:127], v110 offset0:2 offset1:3
  ds_read_b32 v128, v110 offset:16
  v_mfma_f32_16x16x32_bf16 a[60:63], v[20:23], v[52:55], a[60:63]
  s_waitcnt lgkmcnt(9)
  v_alignbyte_b32 v28, v131, v130, v15
  v_alignbyte_b32 v29, v132, v131, v15
  v_alignbyte_b32 v30, v133, v132, v15
  v_alignbyte_b32 v31, v134, v133, v15
  ds_read2_b32 v[130:131], v111 offset0:0 offset1:1
  ds_read2_b32 v[132:133], v111 offset0:2 offset1:3
  ds_read_b32 v134, v111 offset:16
  v_mfma_f32_16x16x32_bf16 a[92:95], v[24:27], v[56:59], a[92:95]
  s_waitcnt lgkmcnt(9)
  v_alignbyte_b32 v32, v113, v112, v15
  v_alignbyte_b32 v33, v114, v113, v15
  v_alignbyte_b32 v34, v115, v114, v15
  v_alignbyte_b32 v35, v116, v115, v15
  ds_read_b64 v[84:85], v8
  ds_read_b64 v[86:87], v9
  v_mfma_f32_16x16x32_bf16 a[124:127], v[28:31], v[60:63], a[124:127]
  s_waitcnt lgkmcnt(8)
  v_alignbyte_b32 v36, v119, v118, v15
  v_alignbyte_b32 v37, v120, v119, v15
  v_alignbyte_b32 v38, v121, v120, v15
  v_alignbyte_b32 v39, v122, v121, v15
  v_mfma_f32_16x16x32_bf16 a[156:159], v[32:35], v[64:67], a[156:159]
  s_waitcnt lgkmcnt(5)
  v_alignbyte_b32 v40, v125, v124, v15
  v_alignbyte_b32 v41, v126, v125, v15
  v_alignbyte_b32 v42, v127, v126, v15
  v_alignbyte_b32 v43, v128, v127, v15
  v_mfma_f32_16x16x32_bf16 a[188:191], v[36:39], v[68:71], a[188:191]
  s_waitcnt lgkmcnt(2)
  v_alignbyte_b32 v44, v131, v130, v15
  v_alignbyte_b32 v45, v132, v131, v15
  v_alignbyte_b32 v46, v133, v132, v15
  v_alignbyte_b32 v47, v134, v133, v15
  v_mfma_f32_16x16x32_bf16 a[220:223], v[40:43], v[72:75], a[220:223]
  s_nop 0
  v_mfma_f32_16x16x32_bf16 a[252:255], v[44:47], v[76:79], a[252:255]
  s_waitcnt lgkmcnt(0)
  s_mov_b32 exec_lo, s42
  s_mov_b32 exec_hi, s42
  ds_write_b128 v6, a[28:31] offset:0
  ds_write_b128 v6, a[60:63] offset:128
  ds_write_b128 v6, a[92:95] offset:256
  ds_write_b128 v6, a[124:127] offset:384
  ds_write_b128 v6, a[156:159] offset:512
  ds_write_b128 v6, a[188:191] offset:640
  ds_write_b128 v6, a[220:223] offset:768
  ds_write_b128 v6, a[252:255] offset:896
  s_mov_b64 exec, -1
  ds_read_b128 v[80:83], v7
  ds_write_b32 v14, v13 offset:8
  v_lshlrev_b32 v88, 16, v84
  v_and_b32 v89, 0xffff0000, v84
  v_lshlrev_b32 v90, 16, v85
  v_and_b32 v91, 0xffff0000, v85
  v_lshlrev_b32 v96, 16, v86
  v_and_b32 v97, 0xffff0000, v86
  v_lshlrev_b32 v98, 16, v87
  v_and_b32 v99, 0xffff0000, v87
  v_mul_f32 v92, v88, v12
  v_mul_f32 v93, v89, v12
  v_mul_f32 v94, v90, v12
  v_mul_f32 v95, v91, v12
  v_cvt_pk_bf16_f32 v84, v92, v93
  v_cvt_pk_bf16_f32 v85, v94, v95
  v_lshlrev_b32 v92, 16, v84
  v_and_b32 v93, 0xffff0000, v84
  v_lshlrev_b32 v94, 16, v85
  v_and_b32 v95, 0xffff0000, v85
  s_waitcnt lgkmcnt(1)
  v_fmac_f32 v80, v88, v11
  v_fmac_f32 v81, v89, v11
  v_fmac_f32 v82, v90, v11
  v_fmac_f32 v83, v91, v11
  v_cvt_pk_bf16_f32 v84, v80, v81
  v_cvt_pk_bf16_f32 v85, v82, v83
  v_lshlrev_b32 v80, 16, v84
  v_and_b32 v81, 0xffff0000, v84
  v_lshlrev_b32 v82, 16, v85
  v_and_b32 v83, 0xffff0000, v85
  v_add_f32 v80, v80, v92
  v_add_f32 v81, v81, v93
  v_add_f32 v82, v82, v94
  v_add_f32 v83, v83, v95
  v_cvt_pk_bf16_f32 v84, v80, v81
  v_cvt_pk_bf16_f32 v85, v82, v83
  v_lshlrev_b32 v80, 16, v84
  v_and_b32 v81, 0xffff0000, v84
  v_lshlrev_b32 v82, 16, v85
  v_and_b32 v83, 0xffff0000, v85
  v_add_f32 v80, v80, v96
  v_add_f32 v81, v81, v97
  v_add_f32 v82, v82, v98
  v_add_f32 v83, v83, v99
  v_cvt_pk_bf16_f32 v84, v80, v81
  v_cvt_pk_bf16_f32 v85, v82, v83
  buffer_store_dwordx2 v[84:85], v10, s[8:11], s40 offen sc1
  v_add_u32 v104, 64, v104
  v_add_u32 v105, 64, v105
  v_add_u32 v106, 64, v106
  v_add_u32 v107, 64, v107
  v_add_u32 v108, 64, v108
  v_add_u32 v109, 64, v109
  v_add_u32 v110, 64, v110
  v_add_u32 v111, 64, v111
  v_add_u32 v4, 64, v4
  v_add_u32 v8, 64, v8
  s_add_u32 s40, s40, 0x8000
  s_waitcnt vmcnt(0)
  s_mov_b64 exec, 1
  buffer_store_dword v13, v1, s[8:11], s39 offen sc1
  s_mov_b64 exec, -1
  ds_write_b32 v14, v13 offset:16
  s_add_u32 s32, s32, 1
  s_and_b32 s6, s32, 7
  s_cbranch_scc1 L_c_conv7
  s_waitcnt vmcnt(0)
  s_endpgm
L_c_res:
  s_mov_b32 s16, s92
  s_mov_b32 s17, s93
  s_mov_b32 s18, 0x200000
  s_mov_b32 s19, 0x20000
  s_and_b32 s6, s3, 1
  s_mul_i32 s37, s6, 0x200000
  s_mul_i32 s38, s6, 0x800000
  s_lshl_b32 s7, s5, 10
  s_add_u32 s37, s37, s7
  s_add_u32 s37, s37, 0x0
  s_add_u32 s38, s38, s7
  s_add_u32 s38, s38, 0x8800000
  s_lshl_b32 s6, s5, 3
  s_add_u32 s39, s6, 0x710900
  s_lshl_b32 s41, s5, 5
  v_bfe_u32 v16, v0, 4, 5
  v_lshrrev_b32 v17, 9, v0
  v_lshlrev_b32 v18, 1, v16
  v_lshl_or_b32 v4, v17, 8, v18
  v_add_u32 v8, 139776, v4
  v_mul_u32_u24 v19, 16512, v17
  v_add_u32 v19, v19, v18
  v_add_u32 v7, 73760, v19
  v_bfe_u32 v5, v0, 2, 3
  v_bfe_u32 v6, v0, 8, 1
  v_lshlrev_b32 v6, 3, v6
  v_and_b32 v19, 0xf0, v0
  v_or_b32 v6, v19, v6
  v_lshlrev_b32 v19, 10, v16
  v_lshl_or_b32 v9, v17, 3, v19
  s_mov_b32 s43, 0
  s_mov_b32 s46, 0
  s_mov_b32 s23, 0
  s_mov_b32 s20, 0x3f80
  s_mov_b32 s21, 0x3f800000
  s_mov_b32 s22, 0x3f803f80
  v_bfe_u32 v10, v0, 4, 2
  v_lshlrev_b32 v10, 15, v10
  v_mov_b32 v32, 0
  v_mov_b32 v33, 0
  v_mov_b32 v34, 0
  v_mov_b32 v35, 0
  v_mov_b32 v36, 0
  v_mov_b32 v37, 0
  v_mov_b32 v38, 0
  v_mov_b32 v39, 0
  s_cmp_eq_u32 s3, 2
  s_cbranch_scc0 L_c_r5
L_c_rf:
  s_cmp_eq_u32 s3, 2
  s_cbranch_scc1 L_ga_132
  s_mov_b32 s47, 0
L_gl_134:
  ds_read_b32 v52, v2 offset:24
  s_waitcnt lgkmcnt(0)
  v_readfirstlane_b32 s6, v52
  s_cmp_gt_i32 s6, s46
  s_cbranch_scc1 L_gb_133
  s_add_u32 s47, s47, 1
  s_cmp_lt_u32 s47, 131072
  s_cbranch_scc1 L_gl_134
  s_mov_b32 s6, 47
  s_branch L_err
L_ga_132:
  s_add_u32 s6, s46, 1
  v_mov_b32 v52, s6
  ds_write_b32 v2, v52 offset:24
L_gb_133:
  s_min_i32 s46, s6, 0x7ffffffe
  buffer_load_short_d16_hi v32, v4, s[8:11], s37 offen offset:0
  buffer_load_short_d16_hi v33, v4, s[8:11], s37 offen offset:64
  buffer_load_short_d16_hi v34, v4, s[8:11], s37 offen offset:128
  buffer_load_short_d16_hi v35, v4, s[8:11], s37 offen offset:192
  buffer_load_short_d16_hi v36, v4, s[8:11], s37 offen offset:512
  buffer_load_short_d16_hi v37, v4, s[8:11], s37 offen offset:576
  buffer_load_short_d16_hi v38, v4, s[8:11], s37 offen offset:640
  buffer_load_short_d16_hi v39, v4, s[8:11], s37 offen offset:704
  s_and_b32 s6, s43, 3
  s_lshl_b32 s6, s6, 17
  s_add_u32 s44, s38, s6
  s_lshr_b32 s6, s43, 2
  s_andn2_b32 s45, 1, s6
  s_add_u32 s6, s44, 0
  buffer_load_dwordx4 v[16:19], v0, s[8:11], s6 offen sc1
  s_add_u32 s6, s44, 32768
  buffer_load_dwordx4 v[20:23], v0, s[8:11], s6 offen sc1
  s_add_u32 s6, s44, 65536
  buffer_load_dwordx4 v[24:27], v0, s[8:11], s6 offen sc1
  s_add_u32 s6, s44, 98304
  buffer_load_dwordx4 v[28:31], v0, s[8:11], s6 offen sc1
  s_add_u32 s37, s37, 0x8000
  s_add_u32 s43, s43, 1
L_c_rloop:
  s_mov_b32 s7, 0
L_c_rp:
  s_waitcnt vmcnt(0)
  v_bitop3_b32 v52, v16, v20, s45 bitop3:0x7e
  v_bitop3_b32 v53, v24, v28, s45 bitop3:0x7e
  v_bitop3_b32 v52, v52, v53, 1 bitop3:0xa8
  v_cmp_ne_u32 vcc, 0, v52
  s_cbranch_vccz L_c_rok
  s_cmp_eq_u32 s3, 2
  s_cbranch_scc1 L_ga_135
  s_mov_b32 s47, 0
L_gl_137:
  ds_read_b32 v52, v2 offset:24
  s_waitcnt lgkmcnt(0)
  v_readfirstlane_b32 s6, v52
  s_cmp_gt_i32 s6, s46
  s_cbranch_scc1 L_gb_136
  s_add_u32 s47, s47, 1
  s_cmp_lt_u32 s47, 131072
  s_cbranch_scc1 L_gl_137
  s_mov_b32 s6, 47
  s_branch L_err
L_gb_136:
  s_min_i32 s46, s6, 0x7ffffffe
L_ga_135:
  s_add_u32 s6, s44, 0
  s_nop 0
  buffer_load_dwordx4 v[16:19], v0, s[8:11], s6 offen sc1
  s_add_u32 s6, s44, 32768
  buffer_load_dwordx4 v[20:23], v0, s[8:11], s6 offen sc1
  s_add_u32 s6, s44, 65536
  buffer_load_dwordx4 v[24:27], v0, s[8:11], s6 offen sc1
  s_add_u32 s6, s44, 98304
  buffer_load_dwordx4 v[28:31], v0, s[8:11], s6 offen sc1
  s_add_u32 s7, s7, 1
  s_cmp_lt_u32 s7, 131072
  s_cbranch_scc1 L_c_rp
  s_mov_b32 s6, 43
  s_branch L_err
L_c_rok:
  v_dot2_f32_bf16 v40, v16, s20, 0
  v_dot2_f32_bf16 v41, v16, s21, 0
  v_dot2_f32_bf16 v42, v17, s20, 0
  v_dot2_f32_bf16 v43, v17, s21, 0
  v_dot2_f32_bf16 v44, v18, s20, 0
  v_dot2_f32_bf16 v45, v18, s21, 0
  v_dot2_f32_bf16 v46, v19, s20, 0
  v_dot2_f32_bf16 v47, v19, s21, 0
  v_dot2_f32_bf16 v40, v20, s20, v40
  v_dot2_f32_bf16 v41, v20, s21, v41
  v_dot2_f32_bf16 v42, v21, s20, v42
  v_dot2_f32_bf16 v43, v21, s21, v43
  v_dot2_f32_bf16 v44, v22, s20, v44
  v_dot2_f32_bf16 v45, v22, s21, v45
  v_dot2_f32_bf16 v46, v23, s20, v46
  v_dot2_f32_bf16 v47, v23, s21, v47
  v_dot2_f32_bf16 v40, v24, s20, v40
  v_dot2_f32_bf16 v41, v24, s21, v41
  v_dot2_f32_bf16 v42, v25, s20, v42
  v_dot2_f32_bf16 v43, v25, s21, v43
  v_dot2_f32_bf16 v44, v26, s20, v44
  v_dot2_f32_bf16 v45, v26, s21, v45
  v_dot2_f32_bf16 v46, v27, s20, v46
  v_dot2_f32_bf16 v47, v27, s21, v47
  v_dot2_f32_bf16 v40, v28, s20, v40
  v_dot2_f32_bf16 v41, v28, s21, v41
  v_dot2_f32_bf16 v42, v29, s20, v42
  v_dot2_f32_bf16 v43, v29, s21, v43
  v_dot2_f32_bf16 v44, v30, s20, v44
  v_dot2_f32_bf16 v45, v30, s21, v45
  v_dot2_f32_bf16 v46, v31, s20, v46
  v_dot2_f32_bf16 v47, v31, s21, v47
  v_cvt_pk_bf16_f32 v48, v40, v41
  v_cvt_pk_bf16_f32 v49, v42, v43
  v_cvt_pk_bf16_f32 v50, v44, v45
  v_cvt_pk_bf16_f32 v51, v46, v47
  v_dot2_f32_bf16 v40, v48, s20, v32
  v_dot2_f32_bf16 v41, v48, s21, v33
  v_dot2_f32_bf16 v42, v49, s20, v34
  v_dot2_f32_bf16 v43, v49, s21, v35
  v_dot2_f32_bf16 v44, v50, s20, v36
  v_dot2_f32_bf16 v45, v50, s21, v37
  v_dot2_f32_bf16 v46, v51, s20, v38
  v_dot2_f32_bf16 v47, v51, s21, v39
  v_cvt_pk_bf16_f32 v48, v40, v41
  v_cvt_pk_bf16_f32 v49, v42, v43
  v_cvt_pk_bf16_f32 v50, v44, v45
  v_cvt_pk_bf16_f32 v51, v46, v47
  s_cmp_eq_u32 s3, 2
  s_cbranch_scc1 L_c_ln
  buffer_store_dwordx2 v[48:49], v9, s[16:19], s41 offen
  buffer_store_dwordx2 v[50:51], v9, s[16:19], s41 offen offset:16
  s_add_u32 s41, s41, 0x8000
  v_mov_b32 v52, s43
  s_mov_b64 exec, 3
  buffer_store_dword v52, v5, s[8:11], s39 offen sc1
  s_mov_b64 exec, -1
  s_add_u32 s32, s32, 1
  s_cmp_eq_u32 s32, 64
  s_cbranch_scc1 L_c_rend
L_c_r5:
  s_add_u32 s33, s32, 1
  s_mov_b32 s7, 0
L_lw_138:
  ds_read_b64 v[52:53], v2 offset:16
  s_waitcnt lgkmcnt(0)
  v_min_i32 v52, v52, v53
  v_cmp_gt_i32 vcc, s33, v52
  s_cbranch_vccz L_lwo_139
  s_add_u32 s7, s7, 1
  s_cmp_lt_u32 s7, 131072
  s_cbranch_scc1 L_lw_138
  s_mov_b32 s6, 46
  s_branch L_err
L_lwo_139:
  s_branch L_c_rf
L_c_ln:
  s_cmp_eq_u32 s32, 63
  s_cbranch_scc0 L_cf_140
  v_mov_b32 v52, 0x7fffffff
  ds_write_b32 v2, v52 offset:24
  s_branch L_cnf_141
L_cf_140:
L_ga_142:
  s_add_u32 s6, s46, 1
  v_mov_b32 v52, s6
  ds_write_b32 v2, v52 offset:24
L_gb_143:
  s_min_i32 s46, s6, 0x7ffffffe
  buffer_load_short_d16_hi v32, v4, s[8:11], s37 offen offset:0
  buffer_load_short_d16_hi v33, v4, s[8:11], s37 offen offset:64
  buffer_load_short_d16_hi v34, v4, s[8:11], s37 offen offset:128
  buffer_load_short_d16_hi v35, v4, s[8:11], s37 offen offset:192
  buffer_load_short_d16_hi v36, v4, s[8:11], s37 offen offset:512
  buffer_load_short_d16_hi v37, v4, s[8:11], s37 offen offset:576
  buffer_load_short_d16_hi v38, v4, s[8:11], s37 offen offset:640
  buffer_load_short_d16_hi v39, v4, s[8:11], s37 offen offset:704
  s_and_b32 s6, s43, 3
  s_lshl_b32 s6, s6, 17
  s_add_u32 s44, s38, s6
  s_lshr_b32 s6, s43, 2
  s_andn2_b32 s45, 1, s6
  s_add_u32 s6, s44, 0
  buffer_load_dwordx4 v[16:19], v0, s[8:11], s6 offen sc1
  s_add_u32 s6, s44, 32768
  buffer_load_dwordx4 v[20:23], v0, s[8:11], s6 offen sc1
  s_add_u32 s6, s44, 65536
  buffer_load_dwordx4 v[24:27], v0, s[8:11], s6 offen sc1
  s_add_u32 s6, s44, 98304
  buffer_load_dwordx4 v[28:31], v0, s[8:11], s6 offen sc1
  s_add_u32 s37, s37, 0x8000
  s_add_u32 s43, s43, 1
L_cnf_141:
  v_dot2_f32_bf16 v52, v48, s22, 0
  v_dot2_f32_bf16 v53, v48, v48, 0
  v_dot2_f32_bf16 v52, v49, s22, v52
  v_dot2_f32_bf16 v53, v49, v49, v53
  v_dot2_f32_bf16 v52, v50, s22, v52
  v_dot2_f32_bf16 v53, v50, v50, v53
  v_dot2_f32_bf16 v52, v51, s22, v52
  v_dot2_f32_bf16 v53, v51, v51, v53
  s_lshr_b32 s6, s32, 2
  s_andn2_b32 s36, 1, s6
  s_and_b32 s6, s32, 3
  s_lshl_b32 s6, s6, 13
  s_add_u32 s34, s6, 0x738000
  s_lshl_b32 s6, s5, 8
  s_add_u32 s6, s6, s34
  v_mov_b32 v54, v52
  v_mov_b32 v55, v53
  s_nop 0
  v_permlane32_swap_b32 v52, v54
  v_permlane32_swap_b32 v53, v55
  v_add_f32 v52, v52, v54
  v_add_f32 v53, v53, v55
  v_bfi_b32 v53, 1, s36, v53
  s_mov_b32 exec_hi, 0
  buffer_store_dwordx2 v[52:53], v6, s[8:11], s6 offen
  s_cmp_lt_u32 s32, 62
  s_cbranch_scc1 L_cnl_145
  buffer_store_dwordx2 v[52:53], v6, s[8:11], s6 offen sc1
L_cnl_145:
  s_mov_b32 exec_hi, -1
  s_add_u32 s35, s34, 4096
  s_sub_u32 s33, s32, 7
  s_mov_b32 s7, 0
L_lw_146:
  ds_read_b64 v[52:53], v2 offset:8
  s_waitcnt lgkmcnt(0)
  v_min_i32 v52, v52, v53
  v_cmp_gt_i32 vcc, s33, v52
  s_cbranch_vccz L_lwo_147
  s_add_u32 s7, s7, 1
  s_cmp_lt_u32 s7, 131072
  s_cbranch_scc1 L_lw_146
  s_mov_b32 s6, 44
  s_branch L_err
L_lwo_147:
  s_and_b32 s6, s32, 7
  s_lshl_b32 s6, s6, 10
  v_add_u32 v52, s6, v8
  ds_write_b16 v52, v48 offset:0
  ds_write_b16_d16_hi v52, v48 offset:64
  ds_write_b16 v52, v49 offset:128
  ds_write_b16_d16_hi v52, v49 offset:192
  ds_write_b16 v52, v50 offset:512
  ds_write_b16_d16_hi v52, v50 offset:576
  ds_write_b16 v52, v51 offset:640
  ds_write_b16_d16_hi v52, v51 offset:704
  buffer_load_dwordx4 v[64:67], v0, s[8:11], s34 offen offset:0 sc1
  buffer_load_dwordx4 v[68:71], v0, s[8:11], s34 offen offset:1024 sc1
  buffer_load_dwordx4 v[72:75], v0, s[8:11], s34 offen offset:2048 sc1
  buffer_load_dwordx4 v[76:79], v0, s[8:11], s34 offen offset:3072 sc1
  buffer_load_dwordx4 v[80:83], v0, s[8:11], s35 offen offset:0 sc1
  buffer_load_dwordx4 v[84:87], v0, s[8:11], s35 offen offset:1024 sc1
  buffer_load_dwordx4 v[88:91], v0, s[8:11], s35 offen offset:2048 sc1
  buffer_load_dwordx4 v[92:95], v0, s[8:11], s35 offen offset:3072 sc1
  s_mov_b32 s7, 0
L_c_g:
  s_waitcnt vmcnt(0)
L_c_g1:
  v_bitop3_b32 v56, v65, v67, s36 bitop3:0x7e
  v_bitop3_b32 v57, v69, v71, s36 bitop3:0x7e
  v_bitop3_b32 v58, v73, v75, s36 bitop3:0x7e
  v_bitop3_b32 v59, v77, v79, s36 bitop3:0x7e
  v_bitop3_b32 v60, v81, v83, s36 bitop3:0x7e
  v_bitop3_b32 v61, v85, v87, s36 bitop3:0x7e
  v_bitop3_b32 v62, v89, v91, s36 bitop3:0x7e
  v_bitop3_b32 v63, v93, v95, s36 bitop3:0x7e
  v_or3_b32 v52, v56, v57, v58
  v_or3_b32 v53, v59, v60, v61
  v_or3_b32 v52, v52, v62, v63
  v_bitop3_b32 v52, v52, v53, 1 bitop3:0xa8
  v_cmp_ne_u32 vcc, 0, v52
  s_cbranch_vccz L_c_gok0
  v_and_b32 v56, 1, v56
  v_and_b32 v57, 1, v57
  v_and_b32 v58, 1, v58
  v_and_b32 v59, 1, v59
  v_and_b32 v60, 1, v60
  v_and_b32 v61, 1, v61
  v_and_b32 v62, 1, v62
  v_and_b32 v63, 1, v63
  v_cmp_ne_u32 s[48:49], 0, v56
  v_cmp_ne_u32 s[50:51], 0, v57
  v_cmp_ne_u32 s[52:53], 0, v58
  v_cmp_ne_u32 s[54:55], 0, v59
  v_cmp_ne_u32 s[56:57], 0, v60
  v_cmp_ne_u32 s[58:59], 0, v61
  v_cmp_ne_u32 s[60:61], 0, v62
  v_cmp_ne_u32 s[62:63], 0, v63
  s_or_b64 exec, s[48:49], 1
  buffer_load_dwordx4 v[64:67], v0, s[8:11], s34 offen offset:0 sc1
  s_or_b64 exec, s[50:51], 1
  buffer_load_dwordx4 v[68:71], v0, s[8:11], s34 offen offset:1024 sc1
  s_or_b64 exec, s[52:53], 1
  buffer_load_dwordx4 v[72:75], v0, s[8:11], s34 offen offset:2048 sc1
  s_or_b64 exec, s[54:55], 1
  buffer_load_dwordx4 v[76:79], v0, s[8:11], s34 offen offset:3072 sc1
  s_or_b64 exec, s[56:57], 1
  buffer_load_dwordx4 v[80:83], v0, s[8:11], s35 offen offset:0 sc1
  s_or_b64 exec, s[58:59], 1
  buffer_load_dwordx4 v[84:87], v0, s[8:11], s35 offen offset:1024 sc1
  s_or_b64 exec, s[60:61], 1
  buffer_load_dwordx4 v[88:91], v0, s[8:11], s35 offen offset:2048 sc1
  s_or_b64 exec, s[62:63], 1
  buffer_load_dwordx4 v[92:95], v0, s[8:11], s35 offen offset:3072 sc1
  s_mov_b64 exec, -1
  s_cmp_lg_u32 s23, 0
  s_cbranch_scc1 L_c_na
  s_cmp_eq_u32 s32, 63
  s_cbranch_scc1 L_c_na
  s_waitcnt vmcnt(8)
  v_bitop3_b32 v52, v16, v20, s45 bitop3:0x7e
  v_bitop3_b32 v53, v24, v28, s45 bitop3:0x7e
  v_bitop3_b32 v52, v52, v53, 1 bitop3:0xa8
  v_cmp_ne_u32 vcc, 0, v52
  s_cbranch_vccz L_c_pa
  s_cmp_lg_u32 s7, 0
  s_cbranch_scc1 L_c_na
  s_add_u32 s6, s44, 0
  buffer_load_dwordx4 v[16:19], v0, s[8:11], s6 offen sc1
  s_add_u32 s6, s44, 32768
  buffer_load_dwordx4 v[20:23], v0, s[8:11], s6 offen sc1
  s_add_u32 s6, s44, 65536
  buffer_load_dwordx4 v[24:27], v0, s[8:11], s6 offen sc1
  s_add_u32 s6, s44, 98304
  buffer_load_dwordx4 v[28:31], v0, s[8:11], s6 offen sc1
  s_mov_b32 s7, 1
  s_waitcnt vmcnt(4)
  s_branch L_c_g1
L_c_pa:
  s_cbranch_vccnz L_c_na
  s_add_u32 s26, s32, 1
  s_mov_b32 s23, 1
  v_dot2_f32_bf16 v40, v16, s20, 0
  v_dot2_f32_bf16 v41, v16, s21, 0
  v_dot2_f32_bf16 v42, v17, s20, 0
  v_dot2_f32_bf16 v43, v17, s21, 0
  v_dot2_f32_bf16 v44, v18, s20, 0
  v_dot2_f32_bf16 v45, v18, s21, 0
  v_dot2_f32_bf16 v46, v19, s20, 0
  v_dot2_f32_bf16 v47, v19, s21, 0
  v_dot2_f32_bf16 v40, v20, s20, v40
  v_dot2_f32_bf16 v41, v20, s21, v41
  v_dot2_f32_bf16 v42, v21, s20, v42
  v_dot2_f32_bf16 v43, v21, s21, v43
  v_dot2_f32_bf16 v44, v22, s20, v44
  v_dot2_f32_bf16 v45, v22, s21, v45
  v_dot2_f32_bf16 v46, v23, s20, v46
  v_dot2_f32_bf16 v47, v23, s21, v47
  v_dot2_f32_bf16 v40, v24, s20, v40
  v_dot2_f32_bf16 v41, v24, s21, v41
  v_dot2_f32_bf16 v42, v25, s20, v42
  v_dot2_f32_bf16 v43, v25, s21, v43
  v_dot2_f32_bf16 v44, v26, s20, v44
  v_dot2_f32_bf16 v45, v26, s21, v45
  v_dot2_f32_bf16 v46, v27, s20, v46
  v_dot2_f32_bf16 v47, v27, s21, v47
  v_dot2_f32_bf16 v40, v28, s20, v40
  v_dot2_f32_bf16 v41, v28, s21, v41
  v_dot2_f32_bf16 v42, v29, s20, v42
  v_dot2_f32_bf16 v43, v29, s21, v43
  v_dot2_f32_bf16 v44, v30, s20, v44
  v_dot2_f32_bf16 v45, v30, s21, v45
  v_dot2_f32_bf16 v46, v31, s20, v46
  v_dot2_f32_bf16 v47, v31, s21, v47
  v_cvt_pk_bf16_f32 v96, v40, v41
  v_cvt_pk_bf16_f32 v97, v42, v43
  v_cvt_pk_bf16_f32 v98, v44, v45
  v_cvt_pk_bf16_f32 v99, v46, v47
  v_dot2_f32_bf16 v40, v96, s20, v32
  v_dot2_f32_bf16 v41, v96, s21, v33
  v_dot2_f32_bf16 v42, v97, s20, v34
  v_dot2_f32_bf16 v43, v97, s21, v35
  v_dot2_f32_bf16 v44, v98, s20, v36
  v_dot2_f32_bf16 v45, v98, s21, v37
  v_dot2_f32_bf16 v46, v99, s20, v38
  v_dot2_f32_bf16 v47, v99, s21, v39
  v_cvt_pk_bf16_f32 v96, v40, v41
  v_cvt_pk_bf16_f32 v97, v42, v43
  v_cvt_pk_bf16_f32 v98, v44, v45
  v_cvt_pk_bf16_f32 v99, v46, v47
  v_dot2_f32_bf16 v52, v96, s22, 0
  v_dot2_f32_bf16 v53, v96, v96, 0
  v_dot2_f32_bf16 v52, v97, s22, v52
  v_dot2_f32_bf16 v53, v97, v97, v53
  v_dot2_f32_bf16 v52, v98, s22, v52
  v_dot2_f32_bf16 v53, v98, v98, v53
  v_dot2_f32_bf16 v52, v99, s22, v52
  v_dot2_f32_bf16 v53, v99, v99, v53
  s_lshr_b32 s6, s26, 2
  s_andn2_b32 s24, 1, s6
  s_and_b32 s6, s26, 3
  s_lshl_b32 s6, s6, 13
  s_add_u32 s25, s6, 0x738000
  s_lshl_b32 s6, s5, 8
  s_add_u32 s6, s6, s25
  v_mov_b32 v54, v52
  v_mov_b32 v55, v53
  s_nop 0
  v_permlane32_swap_b32 v52, v54
  v_permlane32_swap_b32 v53, v55
  v_add_f32 v52, v52, v54
  v_add_f32 v53, v53, v55
  v_bfi_b32 v53, 1, s24, v53
  s_mov_b32 exec_hi, 0
  buffer_store_dwordx2 v[52:53], v6, s[8:11], s6 offen
  s_cmp_lt_u32 s26, 62
  s_cbranch_scc1 L_cnl_148
  buffer_store_dwordx2 v[52:53], v6, s[8:11], s6 offen sc1
  s_waitcnt vmcnt(1)
L_cnl_148:
  s_mov_b32 exec_hi, -1
  s_sub_u32 s33, s26, 7
  s_mov_b32 s7, 0
L_lw_149:
  ds_read_b64 v[52:53], v2 offset:8
  s_waitcnt lgkmcnt(0)
  v_min_i32 v52, v52, v53
  v_cmp_gt_i32 vcc, s33, v52
  s_cbranch_vccz L_lwo_150
  s_add_u32 s7, s7, 1
  s_cmp_lt_u32 s7, 131072
  s_cbranch_scc1 L_lw_149
  s_mov_b32 s6, 44
  s_branch L_err
L_lwo_150:
  s_and_b32 s6, s26, 7
  s_lshl_b32 s6, s6, 10
  v_add_u32 v52, s6, v8
  ds_write_b16 v52, v96 offset:0
  ds_write_b16_d16_hi v52, v96 offset:64
  ds_write_b16 v52, v97 offset:128
  ds_write_b16_d16_hi v52, v97 offset:192
  ds_write_b16 v52, v98 offset:512
  ds_write_b16_d16_hi v52, v98 offset:576
  ds_write_b16 v52, v99 offset:640
  ds_write_b16_d16_hi v52, v99 offset:704
  s_waitcnt vmcnt(1)
  s_branch L_c_g1
L_c_pre:
  s_mov_b32 s23, 0
  s_mov_b32 s36, s24
  s_mov_b32 s34, s25
  s_add_u32 s35, s25, 4096
  s_mov_b32 s7, 0
  buffer_load_dwordx4 v[64:67], v0, s[8:11], s34 offen offset:0 sc1
  buffer_load_dwordx4 v[68:71], v0, s[8:11], s34 offen offset:1024 sc1
  buffer_load_dwordx4 v[72:75], v0, s[8:11], s34 offen offset:2048 sc1
  buffer_load_dwordx4 v[76:79], v0, s[8:11], s34 offen offset:3072 sc1
  buffer_load_dwordx4 v[80:83], v0, s[8:11], s35 offen offset:0 sc1
  buffer_load_dwordx4 v[84:87], v0, s[8:11], s35 offen offset:1024 sc1
  buffer_load_dwordx4 v[88:91], v0, s[8:11], s35 offen offset:2048 sc1
  buffer_load_dwordx4 v[92:95], v0, s[8:11], s35 offen offset:3072 sc1
  v_mov_b32 v48, v96
  v_mov_b32 v49, v97
  v_mov_b32 v50, v98
  v_mov_b32 v51, v99
  s_cmp_eq_u32 s32, 63
  s_cbranch_scc0 L_cf_151
  v_mov_b32 v52, 0x7fffffff
  ds_write_b32 v2, v52 offset:24
  s_waitcnt vmcnt(0)
  s_branch L_cnf_152
L_cf_151:
L_ga_153:
  s_add_u32 s6, s46, 1
  v_mov_b32 v52, s6
  ds_write_b32 v2, v52 offset:24
L_gb_154:
  s_min_i32 s46, s6, 0x7ffffffe
  buffer_load_short_d16_hi v32, v4, s[8:11], s37 offen offset:0
  buffer_load_short_d16_hi v33, v4, s[8:11], s37 offen offset:64
  buffer_load_short_d16_hi v34, v4, s[8:11], s37 offen offset:128
  buffer_load_short_d16_hi v35, v4, s[8:11], s37 offen offset:192
  buffer_load_short_d16_hi v36, v4, s[8:11], s37 offen offset:512
  buffer_load_short_d16_hi v37, v4, s[8:11], s37 offen offset:576
  buffer_load_short_d16_hi v38, v4, s[8:11], s37 offen offset:640
  buffer_load_short_d16_hi v39, v4, s[8:11], s37 offen offset:704
  s_and_b32 s6, s43, 3
  s_lshl_b32 s6, s6, 17
  s_add_u32 s44, s38, s6
  s_lshr_b32 s6, s43, 2
  s_andn2_b32 s45, 1, s6
  s_add_u32 s6, s44, 0
  buffer_load_dwordx4 v[16:19], v0, s[8:11], s6 offen sc1
  s_add_u32 s6, s44, 32768
  buffer_load_dwordx4 v[20:23], v0, s[8:11], s6 offen sc1
  s_add_u32 s6, s44, 65536
  buffer_load_dwordx4 v[24:27], v0, s[8:11], s6 offen sc1
  s_add_u32 s6, s44, 98304
  buffer_load_dwordx4 v[28:31], v0, s[8:11], s6 offen sc1
  s_add_u32 s37, s37, 0x8000
  s_add_u32 s43, s43, 1
L_cnf_152:
  s_waitcnt vmcnt(12)
  s_branch L_c_g1
L_c_na:
  s_and_b32 s6, s7, 31
  s_cmp_lg_u32 s6, 31
  s_cbranch_scc1 L_tf_156
  buffer_wbl2 sc1
  s_waitcnt vmcnt(0)
  buffer_inv sc1
  s_waitcnt vmcnt(0)
L_tf_156:
  s_add_u32 s7, s7, 1
  s_cmp_lt_u32 s7, 131072
  s_cbranch_scc1 L_c_g
  s_mov_b32 s6, 45
  s_branch L_err
L_c_gok0:
  v_pk_add_f32 v[64:65], v[64:65], v[80:81]
  v_pk_add_f32 v[66:67], v[66:67], v[82:83]
  v_pk_add_f32 v[68:69], v[68:69], v[84:85]
  v_pk_add_f32 v[70:71], v[70:71], v[86:87]
  v_pk_add_f32 v[72:73], v[72:73], v[88:89]
  v_pk_add_f32 v[74:75], v[74:75], v[90:91]
  v_pk_add_f32 v[76:77], v[76:77], v[92:93]
  v_pk_add_f32 v[78:79], v[78:79], v[94:95]
L_c_gok:
  v_pk_add_f32 v[64:65], v[64:65], v[72:73]
  v_pk_add_f32 v[66:67], v[66:67], v[74:75]
  v_pk_add_f32 v[68:69], v[68:69], v[76:77]
  v_pk_add_f32 v[70:71], v[70:71], v[78:79]
  v_pk_add_f32 v[64:65], v[64:65], v[68:69]
  v_pk_add_f32 v[66:67], v[66:67], v[70:71]
  s_nop 1
  v_permlane16_swap_b32 v64, v66
  v_permlane16_swap_b32 v65, v67
  v_pk_add_f32 v[52:53], v[64:65], v[66:67]
  v_mov_b32 v54, v52
  v_mov_b32 v55, v53
  s_nop 0
  v_permlane32_swap_b32 v52, v54
  v_permlane32_swap_b32 v53, v55
  v_add_f32 v52, v52, v54
  v_add_f32 v53, v53, v55
  v_mul_f32 v52, 0x3b000000, v52
  v_mul_f32 v54, v52, v52
  v_mul_f32 v53, 0x3b000000, v53
  v_sub_f32 v53, v53, v54
  v_max_f32 v53, 0, v53
  v_cvt_pk_bf16_f32 v53, v53, v53
  v_and_b32 v53, 0xffff0000, v53
  v_add_f32 v53, 0x3727c5ac, v53
  v_cvt_pk_bf16_f32 v53, v53, v53
  v_and_b32 v53, 0xffff0000, v53
  v_sqrt_f32 v53, v53
  v_cvt_pk_bf16_f32 v52, v52, v52
  v_and_b32 v52, 0xffff0000, v52
  v_cvt_pk_bf16_f32 v53, v53, v53
  v_and_b32 v53, 0xffff0000, v53
  v_rcp_f32 v53, v53
  v_dot2_f32_bf16 v40, v48, s20, v52 neg_lo:[0,0,1]
  v_dot2_f32_bf16 v41, v48, s21, v52 neg_lo:[0,0,1]
  v_dot2_f32_bf16 v42, v49, s20, v52 neg_lo:[0,0,1]
  v_dot2_f32_bf16 v43, v49, s21, v52 neg_lo:[0,0,1]
  v_dot2_f32_bf16 v44, v50, s20, v52 neg_lo:[0,0,1]
  v_dot2_f32_bf16 v45, v50, s21, v52 neg_lo:[0,0,1]
  v_dot2_f32_bf16 v46, v51, s20, v52 neg_lo:[0,0,1]
  v_dot2_f32_bf16 v47, v51, s21, v52 neg_lo:[0,0,1]
  v_cvt_pk_bf16_f32 v48, v40, v41
  v_cvt_pk_bf16_f32 v49, v42, v43
  v_cvt_pk_bf16_f32 v50, v44, v45
  v_cvt_pk_bf16_f32 v51, v46, v47
  v_lshlrev_b32 v40, 16, v48
  v_and_b32 v41, 0xffff0000, v48
  v_lshlrev_b32 v42, 16, v49
  v_and_b32 v43, 0xffff0000, v49
  v_lshlrev_b32 v44, 16, v50
  v_and_b32 v45, 0xffff0000, v50
  v_lshlrev_b32 v46, 16, v51
  v_and_b32 v47, 0xffff0000, v51
  v_mul_f32 v40, v40, v53
  v_mul_f32 v41, v41, v53
  v_mul_f32 v42, v42, v53
  v_mul_f32 v43, v43, v53
  v_mul_f32 v44, v44, v53
  v_mul_f32 v45, v45, v53
  v_mul_f32 v46, v46, v53
  v_mul_f32 v47, v47, v53
  v_cvt_pk_bf16_f32 v48, v40, v41
  v_cvt_pk_bf16_f32 v49, v42, v43
  v_cvt_pk_bf16_f32 v50, v44, v45
  v_cvt_pk_bf16_f32 v51, v46, v47
  s_add_u32 s6, s32, 1
  v_mov_b32 v52, s6
  ds_write_b16 v7, v48 offset:0
  ds_write_b16_d16_hi v7, v48 offset:4128
  ds_write_b16 v7, v49 offset:8256
  ds_write_b16_d16_hi v7, v49 offset:12384
  ds_write_b16 v7, v50 offset:33024
  ds_write_b16_d16_hi v7, v50 offset:37152
  ds_write_b16 v7, v51 offset:41280
  ds_write_b16_d16_hi v7, v51 offset:45408
  ds_write_b32 v2, v52
  v_add_u32 v7, 64, v7
  s_add_u32 s32, s32, 1
  s_cmp_lg_u32 s23, 0
  s_cbranch_scc1 L_c_pre
  s_cmp_lt_u32 s32, 64
  s_cbranch_scc1 L_c_rloop
L_c_rend:
  s_waitcnt vmcnt(0)
  s_endpgm
.section .rodata,"a"
.p2align 6
.amdhsa_kernel interleave_layers__ssm_conv_s4d__memory_aug_recurrent_mem_tr__prompt_kernel
  .amdhsa_next_free_vgpr 512
  .amdhsa_next_free_sgpr 102
  .amdhsa_accum_offset 256
  .amdhsa_group_segment_fixed_size 0
  .amdhsa_kernarg_size 136
  .amdhsa_user_sgpr_count 2
  .amdhsa_user_sgpr_kernarg_segment_ptr 1
  .amdhsa_system_sgpr_workgroup_id_x 1
.end_amdhsa_kernel
```

```asm
; @launch grid=(256,1,1) block=(256,1,1) lds=163840
.amdgcn_target "amdgcn-amd-amdhsa--gfx950"
.text
.globl interleave_layers__ssm_conv_s4d__memory_aug_recurrent_mem_tr__prompt_kernel
.p2align 8
.type interleave_layers__ssm_conv_s4d__memory_aug_recurrent_mem_tr__prompt_kernel,@function
interleave_layers__ssm_conv_s4d__memory_aug_recurrent_mem_tr__prompt_kernel:
  s_cmp_ge_u32 s2, 256
  s_cbranch_scc1 L_end
  s_load_dwordx16 s[64:79], s[0:1], 0
  s_load_dwordx16 s[80:95], s[0:1], 64
  s_load_dwordx2 s[96:97], s[0:1], 128
  s_getreg_b32 s4, hwreg(HW_REG_XCC_ID,0,4)
  v_lshrrev_b32 v1, 6, v0
  v_and_b32 v0, 63, v0
  s_and_b32 s4, s4, 7
  v_readfirstlane_b32 s3, v1
  s_lshl_b32 s4, s4, 2
  s_lshr_b32 s4, 0x10675432, s4
  s_and_b32 s4, s4, 7
  s_waitcnt lgkmcnt(0)
  s_mov_b32 s12, s94
  s_mov_b32 s13, s95
  s_mov_b32 s14, 0x100
  s_mov_b32 s15, 0x20000
  s_mov_b32 s8, s96
  s_mov_b32 s9, s97
  s_mov_b32 s10, 0x10000000
  s_mov_b32 s11, 0x20000
  s_mov_b32 s16, s64
  s_mov_b32 s17, s65
  s_mov_b32 s18, 0x200000
  s_mov_b32 s19, 0x20000
  s_lshl_b32 s6, s2, 3
  s_lshl_b32 s7, s3, 1
  s_add_u32 s32, s6, s7
  s_lshl_b32 s6, s32, 10
  v_lshlrev_b32 v4, 5, v0
  buffer_load_dwordx4 v[40:43], v4, s[16:19], s6 offen
  buffer_load_dwordx4 v[44:47], v4, s[16:19], s6 offen offset:16
  s_cmp_lg_u32 s3, 0
  s_cbranch_scc1 L_tk_1
  s_and_b32 s6, s4, 3
  s_lshl_b32 s6, s6, 6
  s_and_b32 s7, s4, 4
  s_add_u32 s6, s6, s7
  s_mov_b64 exec, 1
  v_mov_b32 v2, s6
  v_mov_b32 v3, 1
  buffer_atomic_add v3, v2, s[12:15], 0 offen sc0 sc1
  s_mov_b64 exec, -1
L_tk_1:
  s_cmp_lg_u32 s3, 0
  s_waitcnt vmcnt(1)
  s_cbranch_scc0 L_xw_2
  s_waitcnt vmcnt(0)
L_xw_2:
  v_mov_b32 v5, 0
  v_mov_b32 v6, 0
  v_mov_b32 v7, 0x3f803f80
  v_dot2c_f32_bf16 v5, v40, v7
  v_dot2c_f32_bf16 v6, v40, v40
  v_dot2c_f32_bf16 v5, v41, v7
  v_dot2c_f32_bf16 v6, v41, v41
  v_dot2c_f32_bf16 v5, v42, v7
  v_dot2c_f32_bf16 v6, v42, v42
  v_dot2c_f32_bf16 v5, v43, v7
  v_dot2c_f32_bf16 v6, v43, v43
  v_dot2c_f32_bf16 v5, v44, v7
  v_dot2c_f32_bf16 v6, v44, v44
  v_dot2c_f32_bf16 v5, v45, v7
  v_dot2c_f32_bf16 v6, v45, v45
  v_dot2c_f32_bf16 v5, v46, v7
  v_dot2c_f32_bf16 v6, v46, v46
  v_dot2c_f32_bf16 v5, v47, v7
  v_dot2c_f32_bf16 v6, v47, v47
  s_nop 1
  v_add_f32_dpp v5, v5, v5 quad_perm:[1,0,3,2] row_mask:0xf bank_mask:0xf
  v_add_f32_dpp v6, v6, v6 quad_perm:[1,0,3,2] row_mask:0xf bank_mask:0xf
  s_nop 0
  v_add_f32_dpp v5, v5, v5 quad_perm:[2,3,0,1] row_mask:0xf bank_mask:0xf
  v_add_f32_dpp v6, v6, v6 quad_perm:[2,3,0,1] row_mask:0xf bank_mask:0xf
  s_nop 0
  v_add_f32_dpp v5, v5, v5 row_half_mirror row_mask:0xf bank_mask:0xf
  v_add_f32_dpp v6, v6, v6 row_half_mirror row_mask:0xf bank_mask:0xf
  s_nop 0
  v_add_f32_dpp v5, v5, v5 row_mirror row_mask:0xf bank_mask:0xf
  v_add_f32_dpp v6, v6, v6 row_mirror row_mask:0xf bank_mask:0xf
  v_mov_b32 v8, v5
  v_mov_b32 v9, v6
  s_nop 0
  v_permlane16_swap_b32 v5, v8
  v_permlane16_swap_b32 v6, v9
  v_add_f32 v8, v5, v8
  v_add_f32 v9, v6, v9
  v_mul_f32 v8, 0x3b000000, v8
  v_mul_f32 v10, v8, v8
  v_mul_f32 v9, 0x3b000000, v9
  v_sub_f32 v9, v9, v10
  v_max_f32 v9, 0, v9
  v_cvt_pk_bf16_f32 v9, v9, v9
  v_and_b32 v9, 0xffff0000, v9
  v_add_f32 v9, 0x3727c5ac, v9
  v_cvt_pk_bf16_f32 v9, v9, v9
  v_and_b32 v9, 0xffff0000, v9
  v_sqrt_f32 v9, v9
  v_cvt_pk_bf16_f32 v8, v8, v8
  v_and_b32 v8, 0xffff0000, v8
  v_cvt_pk_bf16_f32 v9, v9, v9
  v_and_b32 v9, 0xffff0000, v9
  v_rcp_f32 v9, v9
  v_lshlrev_b32 v16, 16, v40
  v_and_b32 v17, 0xffff0000, v40
  v_lshlrev_b32 v18, 16, v41
  v_and_b32 v19, 0xffff0000, v41
  v_lshlrev_b32 v20, 16, v42
  v_and_b32 v21, 0xffff0000, v42
  v_lshlrev_b32 v22, 16, v43
  v_and_b32 v23, 0xffff0000, v43
  v_lshlrev_b32 v24, 16, v44
  v_and_b32 v25, 0xffff0000, v44
  v_lshlrev_b32 v26, 16, v45
  v_and_b32 v27, 0xffff0000, v45
  v_lshlrev_b32 v28, 16, v46
  v_and_b32 v29, 0xffff0000, v46
  v_lshlrev_b32 v30, 16, v47
  v_and_b32 v31, 0xffff0000, v47
  v_sub_f32 v16, v16, v8
  v_sub_f32 v17, v17, v8
  v_sub_f32 v18, v18, v8
  v_sub_f32 v19, v19, v8
  v_sub_f32 v20, v20, v8
  v_sub_f32 v21, v21, v8
  v_sub_f32 v22, v22, v8
  v_sub_f32 v23, v23, v8
  v_sub_f32 v24, v24, v8
  v_sub_f32 v25, v25, v8
  v_sub_f32 v26, v26, v8
  v_sub_f32 v27, v27, v8
  v_sub_f32 v28, v28, v8
  v_sub_f32 v29, v29, v8
  v_sub_f32 v30, v30, v8
  v_sub_f32 v31, v31, v8
  v_cvt_pk_bf16_f32 v32, v16, v17
  v_cvt_pk_bf16_f32 v33, v18, v19
  v_cvt_pk_bf16_f32 v34, v20, v21
  v_cvt_pk_bf16_f32 v35, v22, v23
  v_cvt_pk_bf16_f32 v36, v24, v25
  v_cvt_pk_bf16_f32 v37, v26, v27
  v_cvt_pk_bf16_f32 v38, v28, v29
  v_cvt_pk_bf16_f32 v39, v30, v31
  v_lshlrev_b32 v16, 16, v32
  v_and_b32 v17, 0xffff0000, v32
  v_lshlrev_b32 v18, 16, v33
  v_and_b32 v19, 0xffff0000, v33
  v_lshlrev_b32 v20, 16, v34
  v_and_b32 v21, 0xffff0000, v34
  v_lshlrev_b32 v22, 16, v35
  v_and_b32 v23, 0xffff0000, v35
  v_lshlrev_b32 v24, 16, v36
  v_and_b32 v25, 0xffff0000, v36
  v_lshlrev_b32 v26, 16, v37
  v_and_b32 v27, 0xffff0000, v37
  v_lshlrev_b32 v28, 16, v38
  v_and_b32 v29, 0xffff0000, v38
  v_lshlrev_b32 v30, 16, v39
  v_and_b32 v31, 0xffff0000, v39
  v_mul_f32 v16, v16, v9
  v_mul_f32 v17, v17, v9
  v_mul_f32 v18, v18, v9
  v_mul_f32 v19, v19, v9
  v_mul_f32 v20, v20, v9
  v_mul_f32 v21, v21, v9
  v_mul_f32 v22, v22, v9
  v_mul_f32 v23, v23, v9
  v_mul_f32 v24, v24, v9
  v_mul_f32 v25, v25, v9
  v_mul_f32 v26, v26, v9
  v_mul_f32 v27, v27, v9
  v_mul_f32 v28, v28, v9
  v_mul_f32 v29, v29, v9
  v_mul_f32 v30, v30, v9
  v_mul_f32 v31, v31, v9
  v_cvt_pk_bf16_f32 v32, v16, v17
  v_cvt_pk_bf16_f32 v33, v18, v19
  v_cvt_pk_bf16_f32 v34, v20, v21
  v_cvt_pk_bf16_f32 v35, v22, v23
  v_cvt_pk_bf16_f32 v36, v24, v25
  v_cvt_pk_bf16_f32 v37, v26, v27
  v_cvt_pk_bf16_f32 v38, v28, v29
  v_cvt_pk_bf16_f32 v39, v30, v31
  s_mov_b32 s6, 0x05040100
  s_mov_b32 s7, 0x07060302
  v_and_b32 v4, 31, v0
  v_mul_u32_u24 v4, 528, v4
  v_lshrrev_b32 v5, 5, v0
  v_lshl_add_u32 v4, v5, 8, v4
  s_lshl_b32 s34, s3, 2
  s_add_u32 s34, s34, 64
  v_add_u32 v4, s34, v4
  v_permlane32_swap_b32 v32, v36
  v_permlane32_swap_b32 v33, v37
  v_permlane32_swap_b32 v34, v38
  v_permlane32_swap_b32 v35, v39
  v_perm_b32 v16, v36, v32, s6
  ds_write_b32 v4, v16 offset:0
  v_perm_b32 v17, v36, v32, s7
  ds_write_b32 v4, v17 offset:16
  v_perm_b32 v18, v37, v33, s6
  ds_write_b32 v4, v18 offset:32
  v_perm_b32 v19, v37, v33, s7
  ds_write_b32 v4, v19 offset:48
  v_perm_b32 v20, v38, v34, s6
  ds_write_b32 v4, v20 offset:128
  v_perm_b32 v21, v38, v34, s7
  ds_write_b32 v4, v21 offset:144
  v_perm_b32 v22, v39, v35, s6
  ds_write_b32 v4, v22 offset:160
  v_perm_b32 v23, v39, v35, s7
  ds_write_b32 v4, v23 offset:176
  v_permlane32_swap_b32 v40, v44
  v_permlane32_swap_b32 v41, v45
  v_permlane32_swap_b32 v42, v46
  v_permlane32_swap_b32 v43, v47
  v_perm_b32 v24, v44, v40, s6
  ds_write_b32 v4, v24 offset:64
  v_perm_b32 v25, v44, v40, s7
  ds_write_b32 v4, v25 offset:80
  v_perm_b32 v26, v45, v41, s6
  ds_write_b32 v4, v26 offset:96
  v_perm_b32 v27, v45, v41, s7
  ds_write_b32 v4, v27 offset:112
  v_perm_b32 v28, v46, v42, s6
  ds_write_b32 v4, v28 offset:192
  v_perm_b32 v29, v46, v42, s7
  ds_write_b32 v4, v29 offset:208
  v_perm_b32 v30, v47, v43, s6
  ds_write_b32 v4, v30 offset:224
  v_perm_b32 v31, v47, v43, s7
  ds_write_b32 v4, v31 offset:240
  s_cmp_lg_u32 s3, 0
  s_cbranch_scc1 L_rl_3
  s_waitcnt vmcnt(0)
  v_readfirstlane_b32 s5, v3
  s_cmp_lt_u32 s5, 32
  s_cbranch_scc1 L_rok_4
  s_mov_b64 exec, 1
  v_mov_b32 v2, 32
  v_mov_b32 v3, 1
  buffer_atomic_add v3, v2, s[12:15], 0 offen sc0 sc1
  s_waitcnt vmcnt(0)
  v_readfirstlane_b32 s33, v3
  s_mov_b64 exec, -1
  s_mov_b32 s7, 0
  v_lshlrev_b32 v2, 2, v0
L_row_5:
  buffer_load_dword v3, v2, s[12:15], 0 offen sc1
  s_waitcnt vmcnt(0)
  s_mov_b32 s34, 0
  v_readlane_b32 s40, v3, 0
  v_readlane_b32 s41, v3, 16
  v_readlane_b32 s42, v3, 32
  v_readlane_b32 s43, v3, 48
  v_readlane_b32 s44, v3, 1
  v_readlane_b32 s45, v3, 17
  v_readlane_b32 s46, v3, 33
  v_readlane_b32 s47, v3, 49
  s_add_u32 s34, s34, s40
  s_add_u32 s34, s34, s41
  s_add_u32 s34, s34, s42
  s_add_u32 s34, s34, s43
  s_add_u32 s34, s34, s44
  s_add_u32 s34, s34, s45
  s_add_u32 s34, s34, s46
  s_add_u32 s34, s34, s47
  s_cmp_eq_u32 s34, 256
  s_cbranch_scc1 L_row2_6
  s_add_u32 s7, s7, 1
  s_cmp_lt_u32 s7, 131072
  s_cbranch_scc1 L_row_5
  s_mov_b32 s6, 1
  s_branch L_err
L_row2_6:
  s_min_u32 s5, s40, 32
  s_sub_u32 s35, 32, s5
  s_cmp_ge_u32 s33, s35
  s_cbranch_scc1 L_ovn_7
  s_add_u32 s5, s5, s33
  s_mov_b32 s4, 0
  s_branch L_rok_4
L_ovn_7:
  s_sub_u32 s33, s33, s35
  s_min_u32 s5, s41, 32
  s_sub_u32 s35, 32, s5
  s_cmp_ge_u32 s33, s35
  s_cbranch_scc1 L_ovn_8
  s_add_u32 s5, s5, s33
  s_mov_b32 s4, 1
  s_branch L_rok_4
L_ovn_8:
  s_sub_u32 s33, s33, s35
  s_min_u32 s5, s42, 32
  s_sub_u32 s35, 32, s5
  s_cmp_ge_u32 s33, s35
  s_cbranch_scc1 L_ovn_9
  s_add_u32 s5, s5, s33
  s_mov_b32 s4, 2
  s_branch L_rok_4
L_ovn_9:
  s_sub_u32 s33, s33, s35
  s_min_u32 s5, s43, 32
  s_sub_u32 s35, 32, s5
  s_cmp_ge_u32 s33, s35
  s_cbranch_scc1 L_ovn_10
  s_add_u32 s5, s5, s33
  s_mov_b32 s4, 3
  s_branch L_rok_4
L_ovn_10:
  s_sub_u32 s33, s33, s35
  s_min_u32 s5, s44, 32
  s_sub_u32 s35, 32, s5
  s_cmp_ge_u32 s33, s35
  s_cbranch_scc1 L_ovn_11
  s_add_u32 s5, s5, s33
  s_mov_b32 s4, 4
  s_branch L_rok_4
L_ovn_11:
  s_sub_u32 s33, s33, s35
  s_min_u32 s5, s45, 32
  s_sub_u32 s35, 32, s5
  s_cmp_ge_u32 s33, s35
  s_cbranch_scc1 L_ovn_12
  s_add_u32 s5, s5, s33
  s_mov_b32 s4, 5
  s_branch L_rok_4
L_ovn_12:
  s_sub_u32 s33, s33, s35
  s_min_u32 s5, s46, 32
  s_sub_u32 s35, 32, s5
  s_cmp_ge_u32 s33, s35
  s_cbranch_scc1 L_ovn_13
  s_add_u32 s5, s5, s33
  s_mov_b32 s4, 6
  s_branch L_rok_4
L_ovn_13:
  s_sub_u32 s33, s33, s35
  s_min_u32 s5, s47, 32
  s_sub_u32 s35, 32, s5
  s_cmp_ge_u32 s33, s35
  s_cbranch_scc1 L_ovn_14
  s_add_u32 s5, s5, s33
  s_mov_b32 s4, 7
  s_branch L_rok_4
L_ovn_14:
  s_sub_u32 s33, s33, s35
  s_mov_b32 s6, 2
  s_branch L_err
L_rok_4:
  s_lshl_b32 s6, s4, 5
  s_add_u32 s6, s6, s5
  v_mov_b32 v2, 0
  v_mov_b32 v3, s6
  ds_write_b32 v2, v3
L_rl_3:
  v_lshrrev_b32 v4, 5, v0
  s_lshl_b32 s6, s3, 1
  v_add_u32 v4, s6, v4
  v_mul_u32_u24 v4, 528, v4
  v_and_b32 v5, 31, v0
  v_lshl_add_u32 v4, v5, 4, v4
  v_lshrrev_b32 v5, 3, v0
  v_lshlrev_b32 v5, 15, v5
  v_and_b32 v6, 7, v0
  v_lshl_or_b32 v5, v6, 4, v5
  s_lshl_b32 s6, s3, 18
  s_lshl_b32 s7, s2, 7
  s_add_u32 s6, s6, s7
  s_add_u32 s6, s6, 0xb000000
  s_waitcnt lgkmcnt(0)
  s_barrier
  ds_read_b128 v[16:19], v4 offset:64
  ds_read_b128 v[20:23], v4 offset:4288
  ds_read_b128 v[24:27], v4 offset:8512
  ds_read_b128 v[28:31], v4 offset:12736
  s_waitcnt lgkmcnt(3)
  buffer_store_dwordx4 v[16:19], v5, s[8:11], s6 offen sc1
  s_add_u32 s6, s6, 1048576
  s_waitcnt lgkmcnt(2)
  buffer_store_dwordx4 v[20:23], v5, s[8:11], s6 offen sc1
  s_add_u32 s6, s6, 1048576
  s_waitcnt lgkmcnt(1)
  buffer_store_dwordx4 v[24:27], v5, s[8:11], s6 offen sc1
  s_add_u32 s6, s6, 1048576
  s_waitcnt lgkmcnt(0)
  buffer_store_dwordx4 v[28:31], v5, s[8:11], s6 offen sc1
  s_add_u32 s6, s6, 1048576
  v_mov_b32 v2, 0
  ds_read_b32 v3, v2
  s_waitcnt lgkmcnt(0)
  v_readfirstlane_b32 s6, v3
  s_barrier
  s_lshr_b32 s4, s6, 5
  s_and_b32 s4, s4, 7
  s_and_b32 s5, s6, 31
  s_cmp_eq_u32 s4, 0
  s_cbranch_scc1 L_rec
  s_cmp_eq_u32 s4, 1
  s_cbranch_scc1 L_rec
  s_cmp_eq_u32 s4, 2
  s_cbranch_scc1 L_p
  s_cmp_eq_u32 s4, 3
  s_cbranch_scc1 L_p
  s_cmp_eq_u32 s4, 4
  s_cbranch_scc1 L_p
  s_cmp_eq_u32 s4, 5
  s_cbranch_scc1 L_p
  s_cmp_eq_u32 s4, 6
  s_cbranch_scc1 L_o
  s_cmp_eq_u32 s4, 7
  s_cbranch_scc1 L_c
  s_waitcnt vmcnt(0)
  s_barrier
  s_cmp_lg_u32 s3, 0
  s_cbranch_scc1 L_sd_15
  s_mov_b64 exec, 1
  s_and_b32 s6, s4, 3
  s_lshl_b32 s6, s6, 6
  v_mov_b32 v2, 16
  v_mov_b32 v3, 1
  buffer_atomic_add v3, v2, s[12:15], s6 offen sc1
  s_mov_b64 exec, -1
L_sd_15:
  s_waitcnt vmcnt(0)
  s_endpgm
L_err:
  s_mov_b64 exec, 1
  s_lshl_b32 s7, s4, 2
  s_add_u32 s7, s7, 160
  v_mov_b32 v2, s7
  v_mov_b32 v3, s6
  buffer_store_dword v3, v2, s[12:15], 0 offen sc1
  s_waitcnt vmcnt(0)
L_end:
  s_endpgm
L_rec:
  s_and_b32 s58, s4, 1
  s_mul_i32 s35, s58, 0x2000000
  s_add_u32 s35, s35, 0x800000
  s_mul_i32 s36, s58, 0x1000000
  s_add_u32 s36, s36, 0x4800000
  s_mul_i32 s39, s58, 0x40000
  s_add_u32 s39, s39, 0x740000
  s_mul_i32 s44, s58, 0x2000
  s_add_u32 s44, s44, 0x708000
  s_lshl_b32 s6, s5, 14
  s_lshl_b32 s7, s3, 11
  s_add_u32 s35, s35, s6
  s_add_u32 s35, s35, s7
  s_mov_b32 s48, s7
  s_lshl_b32 s6, s5, 8
  s_add_u32 s43, s44, s6
  s_add_u32 s44, s44, s7
  s_lshl_b32 s7, s5, 13
  s_add_u32 s41, s39, s7
  s_add_u32 s42, s41, 4096
  s_add_u32 s39, s39, s6
  s_add_u32 s40, s39, 32768
  s_lshl_b32 s7, s5, 12
  s_add_u32 s36, s36, s7
  s_lshl_b32 s7, s3, 10
  s_add_u32 s36, s36, s7
  s_add_u32 s53, s48, 8192
  s_add_u32 s37, s48, 16384
  s_lshl_b32 s6, s58, 13
  s_lshl_b32 s7, s5, 7
  s_add_u32 s38, s6, s7
  s_add_u32 s38, s38, 0x714000
  s_mov_b32 s54, 0x00ff00ff
  s_mov_b32 s55, 0x00ff00ff
  s_mov_b32 s56, 0x33333333
  s_mov_b32 s57, 0x33333333
  s_mov_b32 s34, 0x3e0293ee
  s_add_u32 s6, s3, 1
  s_and_b32 s6, s6, 3
  s_lshl_b32 s45, s6, 11
  s_add_u32 s6, s3, 2
  s_and_b32 s6, s6, 3
  s_lshl_b32 s46, s6, 11
  s_add_u32 s6, s3, 3
  s_and_b32 s6, s6, 3
  s_lshl_b32 s47, s6, 11
  v_and_b32 v16, 15, v0
  v_lshrrev_b32 v17, 4, v0
  v_lshlrev_b32 v1, 4, v0
  s_lshl_b32 s6, s3, 8
  s_add_u32 s6, s6, 24576
  v_mul_u32_u24 v18, 1088, v17
  v_lshl_add_u32 v18, v16, 3, v18
  v_add_u32 v2, s6, v18
  v_and_b32 v18, 3, v0
  v_mul_u32_u24 v18, 1088, v18
  v_bfe_u32 v19, v0, 2, 3
  v_lshl_add_u32 v18, v19, 3, v18
  v_lshrrev_b32 v19, 5, v0
  v_lshl_add_u32 v18, v19, 7, v18
  v_add_u32 v3, 24576, v18
  v_and_b32 v18, 7, v0
  v_bfe_u32 v19, v0, 3, 1
  v_lshl_or_b32 v18, v19, 4, v18
  v_lshlrev_b32 v18, 4, v18
  v_lshl_add_u32 v18, v17, 9, v18
  v_add_u32 v4, 8192, v18
  v_lshrrev_b32 v18, 2, v16
  v_and_b32 v19, 1, v0
  v_lshl_or_b32 v18, v18, 1, v19
  v_mul_u32_u24 v18, 288, v18
  v_lshl_add_u32 v18, v17, 2, v18
  s_lshl_b32 s6, s3, 6
  s_add_u32 s6, s6, 28928
  v_add_u32 v5, s6, v18
  v_lshrrev_b32 v18, 1, v16
  v_mul_u32_u24 v18, 288, v18
  v_lshl_add_u32 v18, v17, 5, v18
  v_lshl_add_u32 v18, v19, 4, v18
  v_add_u32 v6, 28928, v18
  s_lshl_b32 s6, s3, 15
  s_add_u32 s6, s6, 32768
  v_add_u32 v7, s6, v1
  v_lshrrev_b32 v18, 2, v16
  v_lshlrev_b32 v18, 13, v18
  v_and_b32 v19, 3, v0
  v_lshl_or_b32 v19, v17, 2, v19
  v_lshl_or_b32 v18, v19, 4, v18
  s_lshl_b32 s6, s3, 16
  v_add_u32 v8, s6, v18
  v_lshlrev_b32 v18, 4, v16
  v_lshl_or_b32 v18, v17, 9, v18
  v_add_u32 v9, s37, v18
  v_mov_b32 v10, 0x3f803f80
  v_mov_b32 v11, 0x3f803f80
  v_mov_b32 v12, 0
  v_mov_b32 v13, 0
  v_mov_b32 v14, 0
  v_mov_b32 v15, 0
  buffer_store_dwordx4 v[12:15], v8, s[8:11], s39 offen sc1
  buffer_store_dwordx4 v[12:15], v8, s[8:11], s40 offen sc1
  s_add_u32 s6, s36, 0
  buffer_store_dwordx4 v[12:15], v1, s[8:11], s6 offen sc1
  s_add_u32 s6, s36, 131072
  buffer_store_dwordx4 v[12:15], v1, s[8:11], s6 offen sc1
  s_add_u32 s6, s36, 262144
  buffer_store_dwordx4 v[12:15], v1, s[8:11], s6 offen sc1
  s_add_u32 s6, s36, 393216
  buffer_store_dwordx4 v[12:15], v1, s[8:11], s6 offen sc1
  s_mov_b64 exec, 0xffff
  buffer_store_dwordx4 v[12:15], v1, s[8:11], s43 offen sc1
  s_mov_b64 exec, -1
  s_cmp_eq_u32 s4, 1
  s_cbranch_scc1 L_pro
  s_branch L_rec3
L_rec2:
  v_and_b32 v16, 15, v0
  v_lshrrev_b32 v17, 4, v0
  v_lshlrev_b32 v1, 4, v0
  s_lshl_b32 s6, s3, 8
  s_add_u32 s6, s6, 24576
  v_mul_u32_u24 v18, 1088, v17
  v_lshl_add_u32 v18, v16, 3, v18
  v_add_u32 v2, s6, v18
  v_and_b32 v18, 3, v0
  v_mul_u32_u24 v18, 1088, v18
  v_bfe_u32 v19, v0, 2, 3
  v_lshl_add_u32 v18, v19, 3, v18
  v_lshrrev_b32 v19, 5, v0
  v_lshl_add_u32 v18, v19, 7, v18
  v_add_u32 v3, 24576, v18
  v_and_b32 v18, 7, v0
  v_bfe_u32 v19, v0, 3, 1
  v_lshl_or_b32 v18, v19, 4, v18
  v_lshlrev_b32 v18, 4, v18
  v_lshl_add_u32 v18, v17, 9, v18
  v_add_u32 v4, 8192, v18
  v_lshrrev_b32 v18, 2, v16
  v_and_b32 v19, 1, v0
  v_lshl_or_b32 v18, v18, 1, v19
  v_mul_u32_u24 v18, 288, v18
  v_lshl_add_u32 v18, v17, 2, v18
  s_lshl_b32 s6, s3, 6
  s_add_u32 s6, s6, 28928
  v_add_u32 v5, s6, v18
  v_lshrrev_b32 v18, 1, v16
  v_mul_u32_u24 v18, 288, v18
  v_lshl_add_u32 v18, v17, 5, v18
  v_lshl_add_u32 v18, v19, 4, v18
  v_add_u32 v6, 28928, v18
  s_lshl_b32 s6, s3, 15
  s_add_u32 s6, s6, 32768
  v_add_u32 v7, s6, v1
  v_lshrrev_b32 v18, 2, v16
  v_lshlrev_b32 v18, 13, v18
  v_and_b32 v19, 3, v0
  v_lshl_or_b32 v19, v17, 2, v19
  v_lshl_or_b32 v18, v19, 4, v18
  s_lshl_b32 s6, s3, 16
  v_add_u32 v8, s6, v18
  v_lshlrev_b32 v18, 4, v16
  v_lshl_or_b32 v18, v17, 9, v18
  v_add_u32 v9, s37, v18
  v_mov_b32 v10, 0x3f803f80
  v_mov_b32 v11, 0x3f803f80
  v_mov_b32 v12, 0
  v_mov_b32 v13, 0
  v_mov_b32 v14, 0
  v_mov_b32 v15, 0
L_rec3:
  s_mov_b32 s16, s82
  s_mov_b32 s17, s83
  s_mov_b32 s18, 0x400000
  s_mov_b32 s19, 0x20000
  s_mov_b32 s20, s84
  s_mov_b32 s21, s85
  s_mov_b32 s22, 0x400000
  s_mov_b32 s23, 0x20000
  s_mov_b32 s24, s86
  s_mov_b32 s25, s87
  s_mov_b32 s26, 0x400000
  s_mov_b32 s27, 0x20000
  s_mov_b32 s28, s88
  s_mov_b32 s29, s89
  s_mov_b32 s30, 0x400000
  s_mov_b32 s31, 0x20000
  s_lshr_b32 s6, 0x72, s4
  s_bitcmp1_b32 s6, 0
  s_cbranch_scc1 L_rdn_16
  s_waitcnt vmcnt(0)
  s_barrier
  s_cmp_lg_u32 s3, 0
  s_cbranch_scc1 L_sd_17
  s_mov_b64 exec, 1
  s_and_b32 s6, s4, 3
  s_lshl_b32 s6, s6, 6
  v_mov_b32 v18, 16
  v_mov_b32 v19, 1
  buffer_atomic_add v19, v18, s[12:15], s6 offen sc1
  s_mov_b64 exec, -1
L_sd_17:
L_rdn_16:
  v_bfe_u32 v16, v0, 4, 1
  v_lshrrev_b32 v17, 5, v0
  v_lshl_or_b32 v18, v17, 5, v16
  s_and_b32 s6, s3, 1
  s_lshr_b32 s7, s3, 1
  s_lshl_b32 s60, s6, 4
  s_lshl_b32 s7, s7, 6
  s_add_u32 s7, s7, s60
  v_add_u32 v18, s7, v18
  v_lshlrev_b32 v18, 13, v18
  v_lshrrev_b32 v19, 4, v0
  s_lshl_b32 s6, s6, 2
  v_or_b32 v19, s6, v19
  v_lshlrev_b32 v19, 1, v19
  v_and_b32 v116, 15, v0
  v_xor_b32 v19, v19, v116
  v_lshl_or_b32 v116, v19, 4, v18
  v_bfe_u32 v18, v0, 2, 2
  v_lshl_or_b32 v19, v16, 2, v18
  v_lshl_or_b32 v18, v17, 3, v18
  v_lshl_or_b32 v18, v16, 5, v18
  v_lshlrev_b32 v18, 8, v18
  s_lshl_b32 s6, s3, 1
  v_xor_b32 v19, s6, v19
  v_lshl_or_b32 v18, v19, 5, v18
  v_and_b32 v19, 3, v0
  v_lshl_or_b32 v18, v19, 3, v18
  v_add_u32 v120, 32768, v18
  v_xor_b32 v121, 32, v120
  v_add_u32 v122, 0x10000, v120
  v_add_u32 v123, 0x10000, v121
  v_lshrrev_b32 v16, 4, v0
  v_and_b32 v17, 15, v0
  v_lshlrev_b32 v18, 1, v16
  v_xor_b32 v17, v17, v18
  v_lshlrev_b32 v17, 4, v17
  v_lshl_or_b32 v118, v16, 10, v17
  v_xor_b32 v119, 0x80, v118
  s_lshl_b32 s60, s3, 13
  s_add_u32 s60, s60, 32768
  v_bfe_u32 v17, v0, 2, 2
  v_bfe_u32 v18, v0, 4, 1
  v_lshl_or_b32 v18, v18, 2, v17
  v_lshl_or_b32 v17, v16, 3, v17
  v_lshlrev_b32 v17, 8, v17
  v_lshl_or_b32 v17, v18, 5, v17
  v_lshl_or_b32 v17, v19, 3, v17
  v_add_u32 v124, s60, v17
  v_add_u32 v127, s60, v1
  s_lshl_b32 s63, s5, 8
  s_add_u32 s61, s63, 0
  s_add_u32 m0, s60, 0
  s_add_u32 s62, s61, 0
  buffer_load_dwordx4 v116, s[16:19], s62 offen lds
  s_add_u32 m0, s60, 1024
  s_add_u32 s62, s61, 16384
  buffer_load_dwordx4 v116, s[16:19], s62 offen lds
  s_add_u32 m0, s60, 2048
  s_add_u32 s62, s61, 32768
  buffer_load_dwordx4 v116, s[16:19], s62 offen lds
  s_add_u32 m0, s60, 3072
  s_add_u32 s62, s61, 49152
  buffer_load_dwordx4 v116, s[16:19], s62 offen lds
  s_add_u32 m0, s60, 4096
  s_add_u32 s62, s61, 65536
  buffer_load_dwordx4 v116, s[16:19], s62 offen lds
  s_add_u32 m0, s60, 5120
  s_add_u32 s62, s61, 81920
  buffer_load_dwordx4 v116, s[16:19], s62 offen lds
  s_add_u32 m0, s60, 6144
  s_add_u32 s62, s61, 98304
  buffer_load_dwordx4 v116, s[16:19], s62 offen lds
  s_add_u32 m0, s60, 7168
  s_add_u32 s62, s61, 114688
  buffer_load_dwordx4 v116, s[16:19], s62 offen lds
  s_add_u32 s61, s63, 1048576
  s_add_u32 m0, s60, 32768
  s_add_u32 s62, s61, 0
  buffer_load_dwordx4 v116, s[16:19], s62 offen lds
  s_add_u32 m0, s60, 33792
  s_add_u32 s62, s61, 16384
  buffer_load_dwordx4 v116, s[16:19], s62 offen lds
  s_add_u32 m0, s60, 34816
  s_add_u32 s62, s61, 32768
  buffer_load_dwordx4 v116, s[16:19], s62 offen lds
  s_add_u32 m0, s60, 35840
  s_add_u32 s62, s61, 49152
  buffer_load_dwordx4 v116, s[16:19], s62 offen lds
  s_add_u32 m0, s60, 36864
  s_add_u32 s62, s61, 65536
  buffer_load_dwordx4 v116, s[16:19], s62 offen lds
  s_add_u32 m0, s60, 37888
  s_add_u32 s62, s61, 81920
  buffer_load_dwordx4 v116, s[16:19], s62 offen lds
  s_add_u32 m0, s60, 38912
  s_add_u32 s62, s61, 98304
  buffer_load_dwordx4 v116, s[16:19], s62 offen lds
  s_add_u32 m0, s60, 39936
  s_add_u32 s62, s61, 114688
  buffer_load_dwordx4 v116, s[16:19], s62 offen lds
  s_add_u32 s61, s63, 2097152
  s_add_u32 m0, s60, 65536
  s_add_u32 s62, s61, 0
  buffer_load_dwordx4 v116, s[16:19], s62 offen lds
  s_add_u32 m0, s60, 66560
  s_add_u32 s62, s61, 16384
  buffer_load_dwordx4 v116, s[16:19], s62 offen lds
  s_add_u32 m0, s60, 67584
  s_add_u32 s62, s61, 32768
  buffer_load_dwordx4 v116, s[16:19], s62 offen lds
  s_add_u32 m0, s60, 68608
  s_add_u32 s62, s61, 49152
  buffer_load_dwordx4 v116, s[16:19], s62 offen lds
  s_add_u32 m0, s60, 69632
  s_add_u32 s62, s61, 65536
  buffer_load_dwordx4 v116, s[16:19], s62 offen lds
  s_add_u32 m0, s60, 70656
  s_add_u32 s62, s61, 81920
  buffer_load_dwordx4 v116, s[16:19], s62 offen lds
  s_add_u32 m0, s60, 71680
  s_add_u32 s62, s61, 98304
  buffer_load_dwordx4 v116, s[16:19], s62 offen lds
  s_add_u32 m0, s60, 72704
  s_add_u32 s62, s61, 114688
  buffer_load_dwordx4 v116, s[16:19], s62 offen lds
  s_waitcnt vmcnt(16)
  s_barrier
  s_add_u32 s61, s63, 3145728
  s_add_u32 m0, s60, 98304
  s_add_u32 s62, s61, 0
  buffer_load_dwordx4 v116, s[16:19], s62 offen lds
  s_add_u32 m0, s60, 99328
  s_add_u32 s62, s61, 16384
  buffer_load_dwordx4 v116, s[16:19], s62 offen lds
  s_add_u32 m0, s60, 100352
  s_add_u32 s62, s61, 32768
  buffer_load_dwordx4 v116, s[16:19], s62 offen lds
  s_add_u32 m0, s60, 101376
  s_add_u32 s62, s61, 49152
  buffer_load_dwordx4 v116, s[16:19], s62 offen lds
  s_add_u32 m0, s60, 102400
  s_add_u32 s62, s61, 65536
  buffer_load_dwordx4 v116, s[16:19], s62 offen lds
  s_add_u32 m0, s60, 103424
  s_add_u32 s62, s61, 81920
  buffer_load_dwordx4 v116, s[16:19], s62 offen lds
  s_add_u32 m0, s60, 104448
  s_add_u32 s62, s61, 98304
  buffer_load_dwordx4 v116, s[16:19], s62 offen lds
  s_add_u32 m0, s60, 105472
  s_add_u32 s62, s61, 114688
  buffer_load_dwordx4 v116, s[16:19], s62 offen lds
  s_cmp_eq_u32 s3, 1
  s_cbranch_scc1 L_lv_20
  s_cmp_eq_u32 s3, 2
  s_cbranch_scc1 L_lv_21
  s_cmp_eq_u32 s3, 3
  s_cbranch_scc1 L_lv_22
L_lv_19:
  ds_read_b64_tr_b16 a[0:1], v120 offset:0
  ds_read_b64_tr_b16 a[2:3], v120 offset:1024
  ds_read_b64_tr_b16 a[4:5], v120 offset:4096
  ds_read_b64_tr_b16 a[6:7], v120 offset:5120
  ds_read_b64_tr_b16 a[8:9], v121 offset:0
  ds_read_b64_tr_b16 a[10:11], v121 offset:1024
  ds_read_b64_tr_b16 a[12:13], v121 offset:4096
  ds_read_b64_tr_b16 a[14:15], v121 offset:5120
  ds_read_b64_tr_b16 a[16:17], v120 offset:16384
  ds_read_b64_tr_b16 a[18:19], v120 offset:17408
  ds_read_b64_tr_b16 a[20:21], v120 offset:20480
  ds_read_b64_tr_b16 a[22:23], v120 offset:21504
  ds_read_b64_tr_b16 a[24:25], v121 offset:16384
  ds_read_b64_tr_b16 a[26:27], v121 offset:17408
  ds_read_b64_tr_b16 a[28:29], v121 offset:20480
  ds_read_b64_tr_b16 a[30:31], v121 offset:21504
  s_branch L_lw_18
L_lv_20:
  ds_read_b64_tr_b16 a[96:97], v120 offset:0
  ds_read_b64_tr_b16 a[98:99], v120 offset:1024
  ds_read_b64_tr_b16 a[100:101], v120 offset:4096
  ds_read_b64_tr_b16 a[102:103], v120 offset:5120
  ds_read_b64_tr_b16 a[104:105], v121 offset:0
  ds_read_b64_tr_b16 a[106:107], v121 offset:1024
  ds_read_b64_tr_b16 a[108:109], v121 offset:4096
  ds_read_b64_tr_b16 a[110:111], v121 offset:5120
  ds_read_b64_tr_b16 a[112:113], v120 offset:16384
  ds_read_b64_tr_b16 a[114:115], v120 offset:17408
  ds_read_b64_tr_b16 a[116:117], v120 offset:20480
  ds_read_b64_tr_b16 a[118:119], v120 offset:21504
  ds_read_b64_tr_b16 a[120:121], v121 offset:16384
  ds_read_b64_tr_b16 a[122:123], v121 offset:17408
  ds_read_b64_tr_b16 a[124:125], v121 offset:20480
  ds_read_b64_tr_b16 a[126:127], v121 offset:21504
  s_branch L_lw_18
L_lv_21:
  ds_read_b64_tr_b16 a[64:65], v120 offset:0
  ds_read_b64_tr_b16 a[66:67], v120 offset:1024
  ds_read_b64_tr_b16 a[68:69], v120 offset:4096
  ds_read_b64_tr_b16 a[70:71], v120 offset:5120
  ds_read_b64_tr_b16 a[72:73], v121 offset:0
  ds_read_b64_tr_b16 a[74:75], v121 offset:1024
  ds_read_b64_tr_b16 a[76:77], v121 offset:4096
  ds_read_b64_tr_b16 a[78:79], v121 offset:5120
  ds_read_b64_tr_b16 a[80:81], v120 offset:16384
  ds_read_b64_tr_b16 a[82:83], v120 offset:17408
  ds_read_b64_tr_b16 a[84:85], v120 offset:20480
  ds_read_b64_tr_b16 a[86:87], v120 offset:21504
  ds_read_b64_tr_b16 a[88:89], v121 offset:16384
  ds_read_b64_tr_b16 a[90:91], v121 offset:17408
  ds_read_b64_tr_b16 a[92:93], v121 offset:20480
  ds_read_b64_tr_b16 a[94:95], v121 offset:21504
  s_branch L_lw_18
L_lv_22:
  ds_read_b64_tr_b16 a[32:33], v120 offset:0
  ds_read_b64_tr_b16 a[34:35], v120 offset:1024
  ds_read_b64_tr_b16 a[36:37], v120 offset:4096
  ds_read_b64_tr_b16 a[38:39], v120 offset:5120
  ds_read_b64_tr_b16 a[40:41], v121 offset:0
  ds_read_b64_tr_b16 a[42:43], v121 offset:1024
  ds_read_b64_tr_b16 a[44:45], v121 offset:4096
  ds_read_b64_tr_b16 a[46:47], v121 offset:5120
  ds_read_b64_tr_b16 a[48:49], v120 offset:16384
  ds_read_b64_tr_b16 a[50:51], v120 offset:17408
  ds_read_b64_tr_b16 a[52:53], v120 offset:20480
  ds_read_b64_tr_b16 a[54:55], v120 offset:21504
  ds_read_b64_tr_b16 a[56:57], v121 offset:16384
  ds_read_b64_tr_b16 a[58:59], v121 offset:17408
  ds_read_b64_tr_b16 a[60:61], v121 offset:20480
  ds_read_b64_tr_b16 a[62:63], v121 offset:21504
L_lw_18:
  s_waitcnt lgkmcnt(0)
  s_waitcnt vmcnt(16)
  s_barrier
  s_add_u32 s61, s63, 0
  s_add_u32 m0, s60, 0
  s_add_u32 s62, s61, 0
  buffer_load_dwordx4 v116, s[20:23], s62 offen lds
  s_add_u32 m0, s60, 1024
  s_add_u32 s62, s61, 16384
  buffer_load_dwordx4 v116, s[20:23], s62 offen lds
  s_add_u32 m0, s60, 2048
  s_add_u32 s62, s61, 32768
  buffer_load_dwordx4 v116, s[20:23], s62 offen lds
  s_add_u32 m0, s60, 3072
  s_add_u32 s62, s61, 49152
  buffer_load_dwordx4 v116, s[20:23], s62 offen lds
  s_add_u32 m0, s60, 4096
  s_add_u32 s62, s61, 65536
  buffer_load_dwordx4 v116, s[20:23], s62 offen lds
  s_add_u32 m0, s60, 5120
  s_add_u32 s62, s61, 81920
  buffer_load_dwordx4 v116, s[20:23], s62 offen lds
  s_add_u32 m0, s60, 6144
  s_add_u32 s62, s61, 98304
  buffer_load_dwordx4 v116, s[20:23], s62 offen lds
  s_add_u32 m0, s60, 7168
  s_add_u32 s62, s61, 114688
  buffer_load_dwordx4 v116, s[20:23], s62 offen lds
  s_cmp_eq_u32 s3, 1
  s_cbranch_scc1 L_lv_25
  s_cmp_eq_u32 s3, 2
  s_cbranch_scc1 L_lv_26
  s_cmp_eq_u32 s3, 3
  s_cbranch_scc1 L_lv_27
L_lv_24:
  ds_read_b64_tr_b16 a[32:33], v120 offset:32768
  ds_read_b64_tr_b16 a[34:35], v120 offset:33792
  ds_read_b64_tr_b16 a[36:37], v120 offset:36864
  ds_read_b64_tr_b16 a[38:39], v120 offset:37888
  ds_read_b64_tr_b16 a[40:41], v121 offset:32768
  ds_read_b64_tr_b16 a[42:43], v121 offset:33792
  ds_read_b64_tr_b16 a[44:45], v121 offset:36864
  ds_read_b64_tr_b16 a[46:47], v121 offset:37888
  ds_read_b64_tr_b16 a[48:49], v120 offset:49152
  ds_read_b64_tr_b16 a[50:51], v120 offset:50176
  ds_read_b64_tr_b16 a[52:53], v120 offset:53248
  ds_read_b64_tr_b16 a[54:55], v120 offset:54272
  ds_read_b64_tr_b16 a[56:57], v121 offset:49152
  ds_read_b64_tr_b16 a[58:59], v121 offset:50176
  ds_read_b64_tr_b16 a[60:61], v121 offset:53248
  ds_read_b64_tr_b16 a[62:63], v121 offset:54272
  s_branch L_lw_23
L_lv_25:
  ds_read_b64_tr_b16 a[0:1], v120 offset:32768
  ds_read_b64_tr_b16 a[2:3], v120 offset:33792
  ds_read_b64_tr_b16 a[4:5], v120 offset:36864
  ds_read_b64_tr_b16 a[6:7], v120 offset:37888
  ds_read_b64_tr_b16 a[8:9], v121 offset:32768
  ds_read_b64_tr_b16 a[10:11], v121 offset:33792
  ds_read_b64_tr_b16 a[12:13], v121 offset:36864
  ds_read_b64_tr_b16 a[14:15], v121 offset:37888
  ds_read_b64_tr_b16 a[16:17], v120 offset:49152
  ds_read_b64_tr_b16 a[18:19], v120 offset:50176
  ds_read_b64_tr_b16 a[20:21], v120 offset:53248
  ds_read_b64_tr_b16 a[22:23], v120 offset:54272
  ds_read_b64_tr_b16 a[24:25], v121 offset:49152
  ds_read_b64_tr_b16 a[26:27], v121 offset:50176
  ds_read_b64_tr_b16 a[28:29], v121 offset:53248
  ds_read_b64_tr_b16 a[30:31], v121 offset:54272
  s_branch L_lw_23
L_lv_26:
  ds_read_b64_tr_b16 a[96:97], v120 offset:32768
  ds_read_b64_tr_b16 a[98:99], v120 offset:33792
  ds_read_b64_tr_b16 a[100:101], v120 offset:36864
  ds_read_b64_tr_b16 a[102:103], v120 offset:37888
  ds_read_b64_tr_b16 a[104:105], v121 offset:32768
  ds_read_b64_tr_b16 a[106:107], v121 offset:33792
  ds_read_b64_tr_b16 a[108:109], v121 offset:36864
  ds_read_b64_tr_b16 a[110:111], v121 offset:37888
  ds_read_b64_tr_b16 a[112:113], v120 offset:49152
  ds_read_b64_tr_b16 a[114:115], v120 offset:50176
  ds_read_b64_tr_b16 a[116:117], v120 offset:53248
  ds_read_b64_tr_b16 a[118:119], v120 offset:54272
  ds_read_b64_tr_b16 a[120:121], v121 offset:49152
  ds_read_b64_tr_b16 a[122:123], v121 offset:50176
  ds_read_b64_tr_b16 a[124:125], v121 offset:53248
  ds_read_b64_tr_b16 a[126:127], v121 offset:54272
  s_branch L_lw_23
L_lv_27:
  ds_read_b64_tr_b16 a[64:65], v120 offset:32768
  ds_read_b64_tr_b16 a[66:67], v120 offset:33792
  ds_read_b64_tr_b16 a[68:69], v120 offset:36864
  ds_read_b64_tr_b16 a[70:71], v120 offset:37888
  ds_read_b64_tr_b16 a[72:73], v121 offset:32768
  ds_read_b64_tr_b16 a[74:75], v121 offset:33792
  ds_read_b64_tr_b16 a[76:77], v121 offset:36864
  ds_read_b64_tr_b16 a[78:79], v121 offset:37888
  ds_read_b64_tr_b16 a[80:81], v120 offset:49152
  ds_read_b64_tr_b16 a[82:83], v120 offset:50176
  ds_read_b64_tr_b16 a[84:85], v120 offset:53248
  ds_read_b64_tr_b16 a[86:87], v120 offset:54272
  ds_read_b64_tr_b16 a[88:89], v121 offset:49152
  ds_read_b64_tr_b16 a[90:91], v121 offset:50176
  ds_read_b64_tr_b16 a[92:93], v121 offset:53248
  ds_read_b64_tr_b16 a[94:95], v121 offset:54272
L_lw_23:
  s_waitcnt lgkmcnt(0)
  s_waitcnt vmcnt(16)
  s_barrier
  s_add_u32 s61, s63, 1048576
  s_add_u32 m0, s60, 32768
  s_add_u32 s62, s61, 0
  buffer_load_dwordx4 v116, s[20:23], s62 offen lds
  s_add_u32 m0, s60, 33792
  s_add_u32 s62, s61, 16384
  buffer_load_dwordx4 v116, s[20:23], s62 offen lds
  s_add_u32 m0, s60, 34816
  s_add_u32 s62, s61, 32768
  buffer_load_dwordx4 v116, s[20:23], s62 offen lds
  s_add_u32 m0, s60, 35840
  s_add_u32 s62, s61, 49152
  buffer_load_dwordx4 v116, s[20:23], s62 offen lds
  s_add_u32 m0, s60, 36864
  s_add_u32 s62, s61, 65536
  buffer_load_dwordx4 v116, s[20:23], s62 offen lds
  s_add_u32 m0, s60, 37888
  s_add_u32 s62, s61, 81920
  buffer_load_dwordx4 v116, s[20:23], s62 offen lds
  s_add_u32 m0, s60, 38912
  s_add_u32 s62, s61, 98304
  buffer_load_dwordx4 v116, s[20:23], s62 offen lds
  s_add_u32 m0, s60, 39936
  s_add_u32 s62, s61, 114688
  buffer_load_dwordx4 v116, s[20:23], s62 offen lds
  s_cmp_eq_u32 s3, 1
  s_cbranch_scc1 L_lv_30
  s_cmp_eq_u32 s3, 2
  s_cbranch_scc1 L_lv_31
  s_cmp_eq_u32 s3, 3
  s_cbranch_scc1 L_lv_32
L_lv_29:
  ds_read_b64_tr_b16 a[64:65], v122 offset:0
  ds_read_b64_tr_b16 a[66:67], v122 offset:1024
  ds_read_b64_tr_b16 a[68:69], v122 offset:4096
  ds_read_b64_tr_b16 a[70:71], v122 offset:5120
  ds_read_b64_tr_b16 a[72:73], v123 offset:0
  ds_read_b64_tr_b16 a[74:75], v123 offset:1024
  ds_read_b64_tr_b16 a[76:77], v123 offset:4096
  ds_read_b64_tr_b16 a[78:79], v123 offset:5120
  ds_read_b64_tr_b16 a[80:81], v122 offset:16384
  ds_read_b64_tr_b16 a[82:83], v122 offset:17408
  ds_read_b64_tr_b16 a[84:85], v122 offset:20480
  ds_read_b64_tr_b16 a[86:87], v122 offset:21504
  ds_read_b64_tr_b16 a[88:89], v123 offset:16384
  ds_read_b64_tr_b16 a[90:91], v123 offset:17408
  ds_read_b64_tr_b16 a[92:93], v123 offset:20480
  ds_read_b64_tr_b16 a[94:95], v123 offset:21504
  s_branch L_lw_28
L_lv_30:
  ds_read_b64_tr_b16 a[32:33], v122 offset:0
  ds_read_b64_tr_b16 a[34:35], v122 offset:1024
  ds_read_b64_tr_b16 a[36:37], v122 offset:4096
  ds_read_b64_tr_b16 a[38:39], v122 offset:5120
  ds_read_b64_tr_b16 a[40:41], v123 offset:0
  ds_read_b64_tr_b16 a[42:43], v123 offset:1024
  ds_read_b64_tr_b16 a[44:45], v123 offset:4096
  ds_read_b64_tr_b16 a[46:47], v123 offset:5120
  ds_read_b64_tr_b16 a[48:49], v122 offset:16384
  ds_read_b64_tr_b16 a[50:51], v122 offset:17408
  ds_read_b64_tr_b16 a[52:53], v122 offset:20480
  ds_read_b64_tr_b16 a[54:55], v122 offset:21504
  ds_read_b64_tr_b16 a[56:57], v123 offset:16384
  ds_read_b64_tr_b16 a[58:59], v123 offset:17408
  ds_read_b64_tr_b16 a[60:61], v123 offset:20480
  ds_read_b64_tr_b16 a[62:63], v123 offset:21504
  s_branch L_lw_28
L_lv_31:
  ds_read_b64_tr_b16 a[0:1], v122 offset:0
  ds_read_b64_tr_b16 a[2:3], v122 offset:1024
  ds_read_b64_tr_b16 a[4:5], v122 offset:4096
  ds_read_b64_tr_b16 a[6:7], v122 offset:5120
  ds_read_b64_tr_b16 a[8:9], v123 offset:0
  ds_read_b64_tr_b16 a[10:11], v123 offset:1024
  ds_read_b64_tr_b16 a[12:13], v123 offset:4096
  ds_read_b64_tr_b16 a[14:15], v123 offset:5120
  ds_read_b64_tr_b16 a[16:17], v122 offset:16384
  ds_read_b64_tr_b16 a[18:19], v122 offset:17408
  ds_read_b64_tr_b16 a[20:21], v122 offset:20480
  ds_read_b64_tr_b16 a[22:23], v122 offset:21504
  ds_read_b64_tr_b16 a[24:25], v123 offset:16384
  ds_read_b64_tr_b16 a[26:27], v123 offset:17408
  ds_read_b64_tr_b16 a[28:29], v123 offset:20480
  ds_read_b64_tr_b16 a[30:31], v123 offset:21504
  s_branch L_lw_28
L_lv_32:
  ds_read_b64_tr_b16 a[96:97], v122 offset:0
  ds_read_b64_tr_b16 a[98:99], v122 offset:1024
  ds_read_b64_tr_b16 a[100:101], v122 offset:4096
  ds_read_b64_tr_b16 a[102:103], v122 offset:5120
  ds_read_b64_tr_b16 a[104:105], v123 offset:0
  ds_read_b64_tr_b16 a[106:107], v123 offset:1024
  ds_read_b64_tr_b16 a[108:109], v123 offset:4096
  ds_read_b64_tr_b16 a[110:111], v123 offset:5120
  ds_read_b64_tr_b16 a[112:113], v122 offset:16384
  ds_read_b64_tr_b16 a[114:115], v122 offset:17408
  ds_read_b64_tr_b16 a[116:117], v122 offset:20480
  ds_read_b64_tr_b16 a[118:119], v122 offset:21504
  ds_read_b64_tr_b16 a[120:121], v123 offset:16384
  ds_read_b64_tr_b16 a[122:123], v123 offset:17408
  ds_read_b64_tr_b16 a[124:125], v123 offset:20480
  ds_read_b64_tr_b16 a[126:127], v123 offset:21504
L_lw_28:
  s_waitcnt lgkmcnt(0)
  s_waitcnt vmcnt(16)
  s_barrier
  s_add_u32 s61, s63, 2097152
  s_add_u32 m0, s60, 65536
  s_add_u32 s62, s61, 0
  buffer_load_dwordx4 v116, s[20:23], s62 offen lds
  s_add_u32 m0, s60, 66560
  s_add_u32 s62, s61, 16384
  buffer_load_dwordx4 v116, s[20:23], s62 offen lds
  s_add_u32 m0, s60, 67584
  s_add_u32 s62, s61, 32768
  buffer_load_dwordx4 v116, s[20:23], s62 offen lds
  s_add_u32 m0, s60, 68608
  s_add_u32 s62, s61, 49152
  buffer_load_dwordx4 v116, s[20:23], s62 offen lds
  s_add_u32 m0, s60, 69632
  s_add_u32 s62, s61, 65536
  buffer_load_dwordx4 v116, s[20:23], s62 offen lds
  s_add_u32 m0, s60, 70656
  s_add_u32 s62, s61, 81920
  buffer_load_dwordx4 v116, s[20:23], s62 offen lds
  s_add_u32 m0, s60, 71680
  s_add_u32 s62, s61, 98304
  buffer_load_dwordx4 v116, s[20:23], s62 offen lds
  s_add_u32 m0, s60, 72704
  s_add_u32 s62, s61, 114688
  buffer_load_dwordx4 v116, s[20:23], s62 offen lds
  s_cmp_eq_u32 s3, 1
  s_cbranch_scc1 L_lv_35
  s_cmp_eq_u32 s3, 2
  s_cbranch_scc1 L_lv_36
  s_cmp_eq_u32 s3, 3
  s_cbranch_scc1 L_lv_37
L_lv_34:
  ds_read_b64_tr_b16 a[96:97], v122 offset:32768
  ds_read_b64_tr_b16 a[98:99], v122 offset:33792
  ds_read_b64_tr_b16 a[100:101], v122 offset:36864
  ds_read_b64_tr_b16 a[102:103], v122 offset:37888
  ds_read_b64_tr_b16 a[104:105], v123 offset:32768
  ds_read_b64_tr_b16 a[106:107], v123 offset:33792
  ds_read_b64_tr_b16 a[108:109], v123 offset:36864
  ds_read_b64_tr_b16 a[110:111], v123 offset:37888
  ds_read_b64_tr_b16 a[112:113], v122 offset:49152
  ds_read_b64_tr_b16 a[114:115], v122 offset:50176
  ds_read_b64_tr_b16 a[116:117], v122 offset:53248
  ds_read_b64_tr_b16 a[118:119], v122 offset:54272
  ds_read_b64_tr_b16 a[120:121], v123 offset:49152
  ds_read_b64_tr_b16 a[122:123], v123 offset:50176
  ds_read_b64_tr_b16 a[124:125], v123 offset:53248
  ds_read_b64_tr_b16 a[126:127], v123 offset:54272
  s_branch L_lw_33
L_lv_35:
  ds_read_b64_tr_b16 a[64:65], v122 offset:32768
  ds_read_b64_tr_b16 a[66:67], v122 offset:33792
  ds_read_b64_tr_b16 a[68:69], v122 offset:36864
  ds_read_b64_tr_b16 a[70:71], v122 offset:37888
  ds_read_b64_tr_b16 a[72:73], v123 offset:32768
  ds_read_b64_tr_b16 a[74:75], v123 offset:33792
  ds_read_b64_tr_b16 a[76:77], v123 offset:36864
  ds_read_b64_tr_b16 a[78:79], v123 offset:37888
  ds_read_b64_tr_b16 a[80:81], v122 offset:49152
  ds_read_b64_tr_b16 a[82:83], v122 offset:50176
  ds_read_b64_tr_b16 a[84:85], v122 offset:53248
  ds_read_b64_tr_b16 a[86:87], v122 offset:54272
  ds_read_b64_tr_b16 a[88:89], v123 offset:49152
  ds_read_b64_tr_b16 a[90:91], v123 offset:50176
  ds_read_b64_tr_b16 a[92:93], v123 offset:53248
  ds_read_b64_tr_b16 a[94:95], v123 offset:54272
  s_branch L_lw_33
L_lv_36:
  ds_read_b64_tr_b16 a[32:33], v122 offset:32768
  ds_read_b64_tr_b16 a[34:35], v122 offset:33792
  ds_read_b64_tr_b16 a[36:37], v122 offset:36864
  ds_read_b64_tr_b16 a[38:39], v122 offset:37888
  ds_read_b64_tr_b16 a[40:41], v123 offset:32768
  ds_read_b64_tr_b16 a[42:43], v123 offset:33792
  ds_read_b64_tr_b16 a[44:45], v123 offset:36864
  ds_read_b64_tr_b16 a[46:47], v123 offset:37888
  ds_read_b64_tr_b16 a[48:49], v122 offset:49152
  ds_read_b64_tr_b16 a[50:51], v122 offset:50176
  ds_read_b64_tr_b16 a[52:53], v122 offset:53248
  ds_read_b64_tr_b16 a[54:55], v122 offset:54272
  ds_read_b64_tr_b16 a[56:57], v123 offset:49152
  ds_read_b64_tr_b16 a[58:59], v123 offset:50176
  ds_read_b64_tr_b16 a[60:61], v123 offset:53248
  ds_read_b64_tr_b16 a[62:63], v123 offset:54272
  s_branch L_lw_33
L_lv_37:
  ds_read_b64_tr_b16 a[0:1], v122 offset:32768
  ds_read_b64_tr_b16 a[2:3], v122 offset:33792
  ds_read_b64_tr_b16 a[4:5], v122 offset:36864
  ds_read_b64_tr_b16 a[6:7], v122 offset:37888
  ds_read_b64_tr_b16 a[8:9], v123 offset:32768
  ds_read_b64_tr_b16 a[10:11], v123 offset:33792
  ds_read_b64_tr_b16 a[12:13], v123 offset:36864
  ds_read_b64_tr_b16 a[14:15], v123 offset:37888
  ds_read_b64_tr_b16 a[16:17], v122 offset:49152
  ds_read_b64_tr_b16 a[18:19], v122 offset:50176
  ds_read_b64_tr_b16 a[20:21], v122 offset:53248
  ds_read_b64_tr_b16 a[22:23], v122 offset:54272
  ds_read_b64_tr_b16 a[24:25], v123 offset:49152
  ds_read_b64_tr_b16 a[26:27], v123 offset:50176
  ds_read_b64_tr_b16 a[28:29], v123 offset:53248
  ds_read_b64_tr_b16 a[30:31], v123 offset:54272
L_lw_33:
  s_waitcnt lgkmcnt(0)
  s_waitcnt vmcnt(16)
  s_barrier
  s_add_u32 s61, s63, 3145728
  s_add_u32 m0, s60, 98304
  s_add_u32 s62, s61, 0
  buffer_load_dwordx4 v116, s[20:23], s62 offen lds
  s_add_u32 m0, s60, 99328
  s_add_u32 s62, s61, 16384
  buffer_load_dwordx4 v116, s[20:23], s62 offen lds
  s_add_u32 m0, s60, 100352
  s_add_u32 s62, s61, 32768
  buffer_load_dwordx4 v116, s[20:23], s62 offen lds
  s_add_u32 m0, s60, 101376
  s_add_u32 s62, s61, 49152
  buffer_load_dwordx4 v116, s[20:23], s62 offen lds
  s_add_u32 m0, s60, 102400
  s_add_u32 s62, s61, 65536
  buffer_load_dwordx4 v116, s[20:23], s62 offen lds
  s_add_u32 m0, s60, 103424
  s_add_u32 s62, s61, 81920
  buffer_load_dwordx4 v116, s[20:23], s62 offen lds
  s_add_u32 m0, s60, 104448
  s_add_u32 s62, s61, 98304
  buffer_load_dwordx4 v116, s[20:23], s62 offen lds
  s_add_u32 m0, s60, 105472
  s_add_u32 s62, s61, 114688
  buffer_load_dwordx4 v116, s[20:23], s62 offen lds
  s_cmp_eq_u32 s3, 1
  s_cbranch_scc1 L_lv_40
  s_cmp_eq_u32 s3, 2
  s_cbranch_scc1 L_lv_41
  s_cmp_eq_u32 s3, 3
  s_cbranch_scc1 L_lv_42
L_lv_39:
  ds_read_b64_tr_b16 a[128:129], v120 offset:0
  ds_read_b64_tr_b16 a[130:131], v120 offset:1024
  ds_read_b64_tr_b16 a[132:133], v120 offset:4096
  ds_read_b64_tr_b16 a[134:135], v120 offset:5120
  ds_read_b64_tr_b16 a[136:137], v121 offset:0
  ds_read_b64_tr_b16 a[138:139], v121 offset:1024
  ds_read_b64_tr_b16 a[140:141], v121 offset:4096
  ds_read_b64_tr_b16 a[142:143], v121 offset:5120
  ds_read_b64_tr_b16 a[144:145], v120 offset:16384
  ds_read_b64_tr_b16 a[146:147], v120 offset:17408
  ds_read_b64_tr_b16 a[148:149], v120 offset:20480
  ds_read_b64_tr_b16 a[150:151], v120 offset:21504
  ds_read_b64_tr_b16 a[152:153], v121 offset:16384
  ds_read_b64_tr_b16 a[154:155], v121 offset:17408
  ds_read_b64_tr_b16 a[156:157], v121 offset:20480
  ds_read_b64_tr_b16 a[158:159], v121 offset:21504
  s_branch L_lw_38
L_lv_40:
  ds_read_b64_tr_b16 a[224:225], v120 offset:0
  ds_read_b64_tr_b16 a[226:227], v120 offset:1024
  ds_read_b64_tr_b16 a[228:229], v120 offset:4096
  ds_read_b64_tr_b16 a[230:231], v120 offset:5120
  ds_read_b64_tr_b16 a[232:233], v121 offset:0
  ds_read_b64_tr_b16 a[234:235], v121 offset:1024
  ds_read_b64_tr_b16 a[236:237], v121 offset:4096
  ds_read_b64_tr_b16 a[238:239], v121 offset:5120
  ds_read_b64_tr_b16 a[240:241], v120 offset:16384
  ds_read_b64_tr_b16 a[242:243], v120 offset:17408
  ds_read_b64_tr_b16 a[244:245], v120 offset:20480
  ds_read_b64_tr_b16 a[246:247], v120 offset:21504
  ds_read_b64_tr_b16 a[248:249], v121 offset:16384
  ds_read_b64_tr_b16 a[250:251], v121 offset:17408
  ds_read_b64_tr_b16 a[252:253], v121 offset:20480
  ds_read_b64_tr_b16 a[254:255], v121 offset:21504
  s_branch L_lw_38
L_lv_41:
  ds_read_b64_tr_b16 a[192:193], v120 offset:0
  ds_read_b64_tr_b16 a[194:195], v120 offset:1024
  ds_read_b64_tr_b16 a[196:197], v120 offset:4096
  ds_read_b64_tr_b16 a[198:199], v120 offset:5120
  ds_read_b64_tr_b16 a[200:201], v121 offset:0
  ds_read_b64_tr_b16 a[202:203], v121 offset:1024
  ds_read_b64_tr_b16 a[204:205], v121 offset:4096
  ds_read_b64_tr_b16 a[206:207], v121 offset:5120
  ds_read_b64_tr_b16 a[208:209], v120 offset:16384
  ds_read_b64_tr_b16 a[210:211], v120 offset:17408
  ds_read_b64_tr_b16 a[212:213], v120 offset:20480
  ds_read_b64_tr_b16 a[214:215], v120 offset:21504
  ds_read_b64_tr_b16 a[216:217], v121 offset:16384
  ds_read_b64_tr_b16 a[218:219], v121 offset:17408
  ds_read_b64_tr_b16 a[220:221], v121 offset:20480
  ds_read_b64_tr_b16 a[222:223], v121 offset:21504
  s_branch L_lw_38
L_lv_42:
  ds_read_b64_tr_b16 a[160:161], v120 offset:0
  ds_read_b64_tr_b16 a[162:163], v120 offset:1024
  ds_read_b64_tr_b16 a[164:165], v120 offset:4096
  ds_read_b64_tr_b16 a[166:167], v120 offset:5120
  ds_read_b64_tr_b16 a[168:169], v121 offset:0
  ds_read_b64_tr_b16 a[170:171], v121 offset:1024
  ds_read_b64_tr_b16 a[172:173], v121 offset:4096
  ds_read_b64_tr_b16 a[174:175], v121 offset:5120
  ds_read_b64_tr_b16 a[176:177], v120 offset:16384
  ds_read_b64_tr_b16 a[178:179], v120 offset:17408
  ds_read_b64_tr_b16 a[180:181], v120 offset:20480
  ds_read_b64_tr_b16 a[182:183], v120 offset:21504
  ds_read_b64_tr_b16 a[184:185], v121 offset:16384
  ds_read_b64_tr_b16 a[186:187], v121 offset:17408
  ds_read_b64_tr_b16 a[188:189], v121 offset:20480
  ds_read_b64_tr_b16 a[190:191], v121 offset:21504
L_lw_38:
  s_waitcnt lgkmcnt(0)
  s_waitcnt vmcnt(16)
  s_barrier
  s_add_u32 s61, s63, 0
  s_add_u32 m0, s60, 0
  s_add_u32 s62, s61, 0
  buffer_load_dwordx4 v116, s[24:27], s62 offen lds
  s_add_u32 m0, s60, 1024
  s_add_u32 s62, s61, 16384
  buffer_load_dwordx4 v116, s[24:27], s62 offen lds
  s_add_u32 m0, s60, 2048
  s_add_u32 s62, s61, 32768
  buffer_load_dwordx4 v116, s[24:27], s62 offen lds
  s_add_u32 m0, s60, 3072
  s_add_u32 s62, s61, 49152
  buffer_load_dwordx4 v116, s[24:27], s62 offen lds
  s_add_u32 m0, s60, 4096
  s_add_u32 s62, s61, 65536
  buffer_load_dwordx4 v116, s[24:27], s62 offen lds
  s_add_u32 m0, s60, 5120
  s_add_u32 s62, s61, 81920
  buffer_load_dwordx4 v116, s[24:27], s62 offen lds
  s_add_u32 m0, s60, 6144
  s_add_u32 s62, s61, 98304
  buffer_load_dwordx4 v116, s[24:27], s62 offen lds
  s_add_u32 m0, s60, 7168
  s_add_u32 s62, s61, 114688
  buffer_load_dwordx4 v116, s[24:27], s62 offen lds
  s_cmp_eq_u32 s3, 1
  s_cbranch_scc1 L_lv_45
  s_cmp_eq_u32 s3, 2
  s_cbranch_scc1 L_lv_46
  s_cmp_eq_u32 s3, 3
  s_cbranch_scc1 L_lv_47
L_lv_44:
  ds_read_b64_tr_b16 a[160:161], v120 offset:32768
  ds_read_b64_tr_b16 a[162:163], v120 offset:33792
  ds_read_b64_tr_b16 a[164:165], v120 offset:36864
  ds_read_b64_tr_b16 a[166:167], v120 offset:37888
  ds_read_b64_tr_b16 a[168:169], v121 offset:32768
  ds_read_b64_tr_b16 a[170:171], v121 offset:33792
  ds_read_b64_tr_b16 a[172:173], v121 offset:36864
  ds_read_b64_tr_b16 a[174:175], v121 offset:37888
  ds_read_b64_tr_b16 a[176:177], v120 offset:49152
  ds_read_b64_tr_b16 a[178:179], v120 offset:50176
  ds_read_b64_tr_b16 a[180:181], v120 offset:53248
  ds_read_b64_tr_b16 a[182:183], v120 offset:54272
  ds_read_b64_tr_b16 a[184:185], v121 offset:49152
  ds_read_b64_tr_b16 a[186:187], v121 offset:50176
  ds_read_b64_tr_b16 a[188:189], v121 offset:53248
  ds_read_b64_tr_b16 a[190:191], v121 offset:54272
  s_branch L_lw_43
L_lv_45:
  ds_read_b64_tr_b16 a[128:129], v120 offset:32768
  ds_read_b64_tr_b16 a[130:131], v120 offset:33792
  ds_read_b64_tr_b16 a[132:133], v120 offset:36864
  ds_read_b64_tr_b16 a[134:135], v120 offset:37888
  ds_read_b64_tr_b16 a[136:137], v121 offset:32768
  ds_read_b64_tr_b16 a[138:139], v121 offset:33792
  ds_read_b64_tr_b16 a[140:141], v121 offset:36864
  ds_read_b64_tr_b16 a[142:143], v121 offset:37888
  ds_read_b64_tr_b16 a[144:145], v120 offset:49152
  ds_read_b64_tr_b16 a[146:147], v120 offset:50176
  ds_read_b64_tr_b16 a[148:149], v120 offset:53248
  ds_read_b64_tr_b16 a[150:151], v120 offset:54272
  ds_read_b64_tr_b16 a[152:153], v121 offset:49152
  ds_read_b64_tr_b16 a[154:155], v121 offset:50176
  ds_read_b64_tr_b16 a[156:157], v121 offset:53248
  ds_read_b64_tr_b16 a[158:159], v121 offset:54272
  s_branch L_lw_43
L_lv_46:
  ds_read_b64_tr_b16 a[224:225], v120 offset:32768
  ds_read_b64_tr_b16 a[226:227], v120 offset:33792
  ds_read_b64_tr_b16 a[228:229], v120 offset:36864
  ds_read_b64_tr_b16 a[230:231], v120 offset:37888
  ds_read_b64_tr_b16 a[232:233], v121 offset:32768
  ds_read_b64_tr_b16 a[234:235], v121 offset:33792
  ds_read_b64_tr_b16 a[236:237], v121 offset:36864
  ds_read_b64_tr_b16 a[238:239], v121 offset:37888
  ds_read_b64_tr_b16 a[240:241], v120 offset:49152
  ds_read_b64_tr_b16 a[242:243], v120 offset:50176
  ds_read_b64_tr_b16 a[244:245], v120 offset:53248
  ds_read_b64_tr_b16 a[246:247], v120 offset:54272
  ds_read_b64_tr_b16 a[248:249], v121 offset:49152
  ds_read_b64_tr_b16 a[250:251], v121 offset:50176
  ds_read_b64_tr_b16 a[252:253], v121 offset:53248
  ds_read_b64_tr_b16 a[254:255], v121 offset:54272
  s_branch L_lw_43
L_lv_47:
  ds_read_b64_tr_b16 a[192:193], v120 offset:32768
  ds_read_b64_tr_b16 a[194:195], v120 offset:33792
  ds_read_b64_tr_b16 a[196:197], v120 offset:36864
  ds_read_b64_tr_b16 a[198:199], v120 offset:37888
  ds_read_b64_tr_b16 a[200:201], v121 offset:32768
  ds_read_b64_tr_b16 a[202:203], v121 offset:33792
  ds_read_b64_tr_b16 a[204:205], v121 offset:36864
  ds_read_b64_tr_b16 a[206:207], v121 offset:37888
  ds_read_b64_tr_b16 a[208:209], v120 offset:49152
  ds_read_b64_tr_b16 a[210:211], v120 offset:50176
  ds_read_b64_tr_b16 a[212:213], v120 offset:53248
  ds_read_b64_tr_b16 a[214:215], v120 offset:54272
  ds_read_b64_tr_b16 a[216:217], v121 offset:49152
  ds_read_b64_tr_b16 a[218:219], v121 offset:50176
  ds_read_b64_tr_b16 a[220:221], v121 offset:53248
  ds_read_b64_tr_b16 a[222:223], v121 offset:54272
L_lw_43:
  s_waitcnt lgkmcnt(0)
  s_waitcnt vmcnt(16)
  s_barrier
  s_add_u32 s61, s63, 1048576
  s_add_u32 m0, s60, 32768
  s_add_u32 s62, s61, 0
  buffer_load_dwordx4 v116, s[24:27], s62 offen lds
  s_add_u32 m0, s60, 33792
  s_add_u32 s62, s61, 16384
  buffer_load_dwordx4 v116, s[24:27], s62 offen lds
  s_add_u32 m0, s60, 34816
  s_add_u32 s62, s61, 32768
  buffer_load_dwordx4 v116, s[24:27], s62 offen lds
  s_add_u32 m0, s60, 35840
  s_add_u32 s62, s61, 49152
  buffer_load_dwordx4 v116, s[24:27], s62 offen lds
  s_add_u32 m0, s60, 36864
  s_add_u32 s62, s61, 65536
  buffer_load_dwordx4 v116, s[24:27], s62 offen lds
  s_add_u32 m0, s60, 37888
  s_add_u32 s62, s61, 81920
  buffer_load_dwordx4 v116, s[24:27], s62 offen lds
  s_add_u32 m0, s60, 38912
  s_add_u32 s62, s61, 98304
  buffer_load_dwordx4 v116, s[24:27], s62 offen lds
  s_add_u32 m0, s60, 39936
  s_add_u32 s62, s61, 114688
  buffer_load_dwordx4 v116, s[24:27], s62 offen lds
  s_cmp_eq_u32 s3, 1
  s_cbranch_scc1 L_lv_50
  s_cmp_eq_u32 s3, 2
  s_cbranch_scc1 L_lv_51
  s_cmp_eq_u32 s3, 3
  s_cbranch_scc1 L_lv_52
L_lv_49:
  ds_read_b64_tr_b16 a[192:193], v122 offset:0
  ds_read_b64_tr_b16 a[194:195], v122 offset:1024
  ds_read_b64_tr_b16 a[196:197], v122 offset:4096
  ds_read_b64_tr_b16 a[198:199], v122 offset:5120
  ds_read_b64_tr_b16 a[200:201], v123 offset:0
  ds_read_b64_tr_b16 a[202:203], v123 offset:1024
  ds_read_b64_tr_b16 a[204:205], v123 offset:4096
  ds_read_b64_tr_b16 a[206:207], v123 offset:5120
  ds_read_b64_tr_b16 a[208:209], v122 offset:16384
  ds_read_b64_tr_b16 a[210:211], v122 offset:17408
  ds_read_b64_tr_b16 a[212:213], v122 offset:20480
  ds_read_b64_tr_b16 a[214:215], v122 offset:21504
  ds_read_b64_tr_b16 a[216:217], v123 offset:16384
  ds_read_b64_tr_b16 a[218:219], v123 offset:17408
  ds_read_b64_tr_b16 a[220:221], v123 offset:20480
  ds_read_b64_tr_b16 a[222:223], v123 offset:21504
  s_branch L_lw_48
L_lv_50:
  ds_read_b64_tr_b16 a[160:161], v122 offset:0
  ds_read_b64_tr_b16 a[162:163], v122 offset:1024
  ds_read_b64_tr_b16 a[164:165], v122 offset:4096
  ds_read_b64_tr_b16 a[166:167], v122 offset:5120
  ds_read_b64_tr_b16 a[168:169], v123 offset:0
  ds_read_b64_tr_b16 a[170:171], v123 offset:1024
  ds_read_b64_tr_b16 a[172:173], v123 offset:4096
  ds_read_b64_tr_b16 a[174:175], v123 offset:5120
  ds_read_b64_tr_b16 a[176:177], v122 offset:16384
  ds_read_b64_tr_b16 a[178:179], v122 offset:17408
  ds_read_b64_tr_b16 a[180:181], v122 offset:20480
  ds_read_b64_tr_b16 a[182:183], v122 offset:21504
  ds_read_b64_tr_b16 a[184:185], v123 offset:16384
  ds_read_b64_tr_b16 a[186:187], v123 offset:17408
  ds_read_b64_tr_b16 a[188:189], v123 offset:20480
  ds_read_b64_tr_b16 a[190:191], v123 offset:21504
  s_branch L_lw_48
L_lv_51:
  ds_read_b64_tr_b16 a[128:129], v122 offset:0
  ds_read_b64_tr_b16 a[130:131], v122 offset:1024
  ds_read_b64_tr_b16 a[132:133], v122 offset:4096
  ds_read_b64_tr_b16 a[134:135], v122 offset:5120
  ds_read_b64_tr_b16 a[136:137], v123 offset:0
  ds_read_b64_tr_b16 a[138:139], v123 offset:1024
  ds_read_b64_tr_b16 a[140:141], v123 offset:4096
  ds_read_b64_tr_b16 a[142:143], v123 offset:5120
  ds_read_b64_tr_b16 a[144:145], v122 offset:16384
  ds_read_b64_tr_b16 a[146:147], v122 offset:17408
  ds_read_b64_tr_b16 a[148:149], v122 offset:20480
  ds_read_b64_tr_b16 a[150:151], v122 offset:21504
  ds_read_b64_tr_b16 a[152:153], v123 offset:16384
  ds_read_b64_tr_b16 a[154:155], v123 offset:17408
  ds_read_b64_tr_b16 a[156:157], v123 offset:20480
  ds_read_b64_tr_b16 a[158:159], v123 offset:21504
  s_branch L_lw_48
L_lv_52:
  ds_read_b64_tr_b16 a[224:225], v122 offset:0
  ds_read_b64_tr_b16 a[226:227], v122 offset:1024
  ds_read_b64_tr_b16 a[228:229], v122 offset:4096
  ds_read_b64_tr_b16 a[230:231], v122 offset:5120
  ds_read_b64_tr_b16 a[232:233], v123 offset:0
  ds_read_b64_tr_b16 a[234:235], v123 offset:1024
  ds_read_b64_tr_b16 a[236:237], v123 offset:4096
  ds_read_b64_tr_b16 a[238:239], v123 offset:5120
  ds_read_b64_tr_b16 a[240:241], v122 offset:16384
  ds_read_b64_tr_b16 a[242:243], v122 offset:17408
  ds_read_b64_tr_b16 a[244:245], v122 offset:20480
  ds_read_b64_tr_b16 a[246:247], v122 offset:21504
  ds_read_b64_tr_b16 a[248:249], v123 offset:16384
  ds_read_b64_tr_b16 a[250:251], v123 offset:17408
  ds_read_b64_tr_b16 a[252:253], v123 offset:20480
  ds_read_b64_tr_b16 a[254:255], v123 offset:21504
L_lw_48:
  s_waitcnt lgkmcnt(0)
  s_waitcnt vmcnt(16)
  s_barrier
  s_add_u32 s61, s63, 2097152
  s_add_u32 m0, s60, 65536
  s_add_u32 s62, s61, 0
  buffer_load_dwordx4 v116, s[24:27], s62 offen lds
  s_add_u32 m0, s60, 66560
  s_add_u32 s62, s61, 16384
  buffer_load_dwordx4 v116, s[24:27], s62 offen lds
  s_add_u32 m0, s60, 67584
  s_add_u32 s62, s61, 32768
  buffer_load_dwordx4 v116, s[24:27], s62 offen lds
  s_add_u32 m0, s60, 68608
  s_add_u32 s62, s61, 49152
  buffer_load_dwordx4 v116, s[24:27], s62 offen lds
  s_add_u32 m0, s60, 69632
  s_add_u32 s62, s61, 65536
  buffer_load_dwordx4 v116, s[24:27], s62 offen lds
  s_add_u32 m0, s60, 70656
  s_add_u32 s62, s61, 81920
  buffer_load_dwordx4 v116, s[24:27], s62 offen lds
  s_add_u32 m0, s60, 71680
  s_add_u32 s62, s61, 98304
  buffer_load_dwordx4 v116, s[24:27], s62 offen lds
  s_add_u32 m0, s60, 72704
  s_add_u32 s62, s61, 114688
  buffer_load_dwordx4 v116, s[24:27], s62 offen lds
  s_cmp_eq_u32 s3, 1
  s_cbranch_scc1 L_lv_55
  s_cmp_eq_u32 s3, 2
  s_cbranch_scc1 L_lv_56
  s_cmp_eq_u32 s3, 3
  s_cbranch_scc1 L_lv_57
L_lv_54:
  ds_read_b64_tr_b16 a[224:225], v122 offset:32768
  ds_read_b64_tr_b16 a[226:227], v122 offset:33792
  ds_read_b64_tr_b16 a[228:229], v122 offset:36864
  ds_read_b64_tr_b16 a[230:231], v122 offset:37888
  ds_read_b64_tr_b16 a[232:233], v123 offset:32768
  ds_read_b64_tr_b16 a[234:235], v123 offset:33792
  ds_read_b64_tr_b16 a[236:237], v123 offset:36864
  ds_read_b64_tr_b16 a[238:239], v123 offset:37888
  ds_read_b64_tr_b16 a[240:241], v122 offset:49152
  ds_read_b64_tr_b16 a[242:243], v122 offset:50176
  ds_read_b64_tr_b16 a[244:245], v122 offset:53248
  ds_read_b64_tr_b16 a[246:247], v122 offset:54272
  ds_read_b64_tr_b16 a[248:249], v123 offset:49152
  ds_read_b64_tr_b16 a[250:251], v123 offset:50176
  ds_read_b64_tr_b16 a[252:253], v123 offset:53248
  ds_read_b64_tr_b16 a[254:255], v123 offset:54272
  s_branch L_lw_53
L_lv_55:
  ds_read_b64_tr_b16 a[192:193], v122 offset:32768
  ds_read_b64_tr_b16 a[194:195], v122 offset:33792
  ds_read_b64_tr_b16 a[196:197], v122 offset:36864
  ds_read_b64_tr_b16 a[198:199], v122 offset:37888
  ds_read_b64_tr_b16 a[200:201], v123 offset:32768
  ds_read_b64_tr_b16 a[202:203], v123 offset:33792
  ds_read_b64_tr_b16 a[204:205], v123 offset:36864
  ds_read_b64_tr_b16 a[206:207], v123 offset:37888
  ds_read_b64_tr_b16 a[208:209], v122 offset:49152
  ds_read_b64_tr_b16 a[210:211], v122 offset:50176
  ds_read_b64_tr_b16 a[212:213], v122 offset:53248
  ds_read_b64_tr_b16 a[214:215], v122 offset:54272
  ds_read_b64_tr_b16 a[216:217], v123 offset:49152
  ds_read_b64_tr_b16 a[218:219], v123 offset:50176
  ds_read_b64_tr_b16 a[220:221], v123 offset:53248
  ds_read_b64_tr_b16 a[222:223], v123 offset:54272
  s_branch L_lw_53
L_lv_56:
  ds_read_b64_tr_b16 a[160:161], v122 offset:32768
  ds_read_b64_tr_b16 a[162:163], v122 offset:33792
  ds_read_b64_tr_b16 a[164:165], v122 offset:36864
  ds_read_b64_tr_b16 a[166:167], v122 offset:37888
  ds_read_b64_tr_b16 a[168:169], v123 offset:32768
  ds_read_b64_tr_b16 a[170:171], v123 offset:33792
  ds_read_b64_tr_b16 a[172:173], v123 offset:36864
  ds_read_b64_tr_b16 a[174:175], v123 offset:37888
  ds_read_b64_tr_b16 a[176:177], v122 offset:49152
  ds_read_b64_tr_b16 a[178:179], v122 offset:50176
  ds_read_b64_tr_b16 a[180:181], v122 offset:53248
  ds_read_b64_tr_b16 a[182:183], v122 offset:54272
  ds_read_b64_tr_b16 a[184:185], v123 offset:49152
  ds_read_b64_tr_b16 a[186:187], v123 offset:50176
  ds_read_b64_tr_b16 a[188:189], v123 offset:53248
  ds_read_b64_tr_b16 a[190:191], v123 offset:54272
  s_branch L_lw_53
L_lv_57:
  ds_read_b64_tr_b16 a[128:129], v122 offset:32768
  ds_read_b64_tr_b16 a[130:131], v122 offset:33792
  ds_read_b64_tr_b16 a[132:133], v122 offset:36864
  ds_read_b64_tr_b16 a[134:135], v122 offset:37888
  ds_read_b64_tr_b16 a[136:137], v123 offset:32768
  ds_read_b64_tr_b16 a[138:139], v123 offset:33792
  ds_read_b64_tr_b16 a[140:141], v123 offset:36864
  ds_read_b64_tr_b16 a[142:143], v123 offset:37888
  ds_read_b64_tr_b16 a[144:145], v122 offset:49152
  ds_read_b64_tr_b16 a[146:147], v122 offset:50176
  ds_read_b64_tr_b16 a[148:149], v122 offset:53248
  ds_read_b64_tr_b16 a[150:151], v122 offset:54272
  ds_read_b64_tr_b16 a[152:153], v123 offset:49152
  ds_read_b64_tr_b16 a[154:155], v123 offset:50176
  ds_read_b64_tr_b16 a[156:157], v123 offset:53248
  ds_read_b64_tr_b16 a[158:159], v123 offset:54272
L_lw_53:
  s_waitcnt lgkmcnt(0)
  s_waitcnt vmcnt(16)
  s_barrier
  s_add_u32 s61, s63, 3145728
  s_add_u32 m0, s60, 98304
  s_add_u32 s62, s61, 0
  buffer_load_dwordx4 v116, s[24:27], s62 offen lds
  s_add_u32 m0, s60, 99328
  s_add_u32 s62, s61, 16384
  buffer_load_dwordx4 v116, s[24:27], s62 offen lds
  s_add_u32 m0, s60, 100352
  s_add_u32 s62, s61, 32768
  buffer_load_dwordx4 v116, s[24:27], s62 offen lds
  s_add_u32 m0, s60, 101376
  s_add_u32 s62, s61, 49152
  buffer_load_dwordx4 v116, s[24:27], s62 offen lds
  s_add_u32 m0, s60, 102400
  s_add_u32 s62, s61, 65536
  buffer_load_dwordx4 v116, s[24:27], s62 offen lds
  s_add_u32 m0, s60, 103424
  s_add_u32 s62, s61, 81920
  buffer_load_dwordx4 v116, s[24:27], s62 offen lds
  s_add_u32 m0, s60, 104448
  s_add_u32 s62, s61, 98304
  buffer_load_dwordx4 v116, s[24:27], s62 offen lds
  s_add_u32 m0, s60, 105472
  s_add_u32 s62, s61, 114688
  buffer_load_dwordx4 v116, s[24:27], s62 offen lds
  s_mov_b32 s16, s80
  s_mov_b32 s17, s81
  s_mov_b32 s18, 0x2000
  s_mov_b32 s19, 0x20000
  v_and_b32 v16, 15, v0
  v_lshrrev_b32 v17, 1, v16
  v_lshlrev_b32 v17, 10, v17
  v_and_b32 v18, 1, v0
  v_lshl_or_b32 v17, v18, 6, v17
  v_lshrrev_b32 v19, 4, v0
  v_lshl_or_b32 v17, v19, 3, v17
  s_lshl_b32 s6, s3, 8
  buffer_load_dwordx2 v[84:85], v17, s[16:19], s6 offen offset:0
  buffer_load_dwordx2 v[86:87], v17, s[16:19], s6 offen offset:32
  buffer_load_dwordx2 v[88:89], v17, s[16:19], s6 offen offset:128
  buffer_load_dwordx2 v[90:91], v17, s[16:19], s6 offen offset:160
  v_mov_b32 v19, 0x4444
  v_mov_b32 v16, 0xeeee
  v_cmp_eq_u32 vcc, 0, v18
  s_nop 1
  v_cndmask_b32 v0, v16, v19, vcc
  v_mbcnt_lo_u32_b32 v16, -1, 0
  v_and_b32 v16, 3, v16
  v_lshlrev_b32 v16, 6, v16
  buffer_load_dword v17, v16, s[12:15], 0 offen offset:16 sc1
  s_cmp_eq_u32 s3, 1
  s_cbranch_scc1 L_lv_60
  s_cmp_eq_u32 s3, 2
  s_cbranch_scc1 L_lv_61
  s_cmp_eq_u32 s3, 3
  s_cbranch_scc1 L_lv_62
L_lv_59:
  ds_read_b64_tr_b16 v[128:129], v120 offset:0
  ds_read_b64_tr_b16 v[130:131], v120 offset:1024
  ds_read_b64_tr_b16 v[132:133], v120 offset:4096
  ds_read_b64_tr_b16 v[134:135], v120 offset:5120
  ds_read_b64_tr_b16 v[136:137], v121 offset:0
  ds_read_b64_tr_b16 v[138:139], v121 offset:1024
  ds_read_b64_tr_b16 v[140:141], v121 offset:4096
  ds_read_b64_tr_b16 v[142:143], v121 offset:5120
  ds_read_b64_tr_b16 v[144:145], v120 offset:16384
  ds_read_b64_tr_b16 v[146:147], v120 offset:17408
  ds_read_b64_tr_b16 v[148:149], v120 offset:20480
  ds_read_b64_tr_b16 v[150:151], v120 offset:21504
  ds_read_b64_tr_b16 v[152:153], v121 offset:16384
  ds_read_b64_tr_b16 v[154:155], v121 offset:17408
  ds_read_b64_tr_b16 v[156:157], v121 offset:20480
  ds_read_b64_tr_b16 v[158:159], v121 offset:21504
  s_branch L_lw_58
L_lv_60:
  ds_read_b64_tr_b16 v[224:225], v120 offset:0
  ds_read_b64_tr_b16 v[226:227], v120 offset:1024
  ds_read_b64_tr_b16 v[228:229], v120 offset:4096
  ds_read_b64_tr_b16 v[230:231], v120 offset:5120
  ds_read_b64_tr_b16 v[232:233], v121 offset:0
  ds_read_b64_tr_b16 v[234:235], v121 offset:1024
  ds_read_b64_tr_b16 v[236:237], v121 offset:4096
  ds_read_b64_tr_b16 v[238:239], v121 offset:5120
  ds_read_b64_tr_b16 v[240:241], v120 offset:16384
  ds_read_b64_tr_b16 v[242:243], v120 offset:17408
  ds_read_b64_tr_b16 v[244:245], v120 offset:20480
  ds_read_b64_tr_b16 v[246:247], v120 offset:21504
  ds_read_b64_tr_b16 v[248:249], v121 offset:16384
  ds_read_b64_tr_b16 v[250:251], v121 offset:17408
  ds_read_b64_tr_b16 v[252:253], v121 offset:20480
  ds_read_b64_tr_b16 v[254:255], v121 offset:21504
  s_branch L_lw_58
L_lv_61:
  ds_read_b64_tr_b16 v[192:193], v120 offset:0
  ds_read_b64_tr_b16 v[194:195], v120 offset:1024
  ds_read_b64_tr_b16 v[196:197], v120 offset:4096
  ds_read_b64_tr_b16 v[198:199], v120 offset:5120
  ds_read_b64_tr_b16 v[200:201], v121 offset:0
  ds_read_b64_tr_b16 v[202:203], v121 offset:1024
  ds_read_b64_tr_b16 v[204:205], v121 offset:4096
  ds_read_b64_tr_b16 v[206:207], v121 offset:5120
  ds_read_b64_tr_b16 v[208:209], v120 offset:16384
  ds_read_b64_tr_b16 v[210:211], v120 offset:17408
  ds_read_b64_tr_b16 v[212:213], v120 offset:20480
  ds_read_b64_tr_b16 v[214:215], v120 offset:21504
  ds_read_b64_tr_b16 v[216:217], v121 offset:16384
  ds_read_b64_tr_b16 v[218:219], v121 offset:17408
  ds_read_b64_tr_b16 v[220:221], v121 offset:20480
  ds_read_b64_tr_b16 v[222:223], v121 offset:21504
  s_branch L_lw_58
L_lv_62:
  ds_read_b64_tr_b16 v[160:161], v120 offset:0
  ds_read_b64_tr_b16 v[162:163], v120 offset:1024
  ds_read_b64_tr_b16 v[164:165], v120 offset:4096
  ds_read_b64_tr_b16 v[166:167], v120 offset:5120
  ds_read_b64_tr_b16 v[168:169], v121 offset:0
  ds_read_b64_tr_b16 v[170:171], v121 offset:1024
  ds_read_b64_tr_b16 v[172:173], v121 offset:4096
  ds_read_b64_tr_b16 v[174:175], v121 offset:5120
  ds_read_b64_tr_b16 v[176:177], v120 offset:16384
  ds_read_b64_tr_b16 v[178:179], v120 offset:17408
  ds_read_b64_tr_b16 v[180:181], v120 offset:20480
  ds_read_b64_tr_b16 v[182:183], v120 offset:21504
  ds_read_b64_tr_b16 v[184:185], v121 offset:16384
  ds_read_b64_tr_b16 v[186:187], v121 offset:17408
  ds_read_b64_tr_b16 v[188:189], v121 offset:20480
  ds_read_b64_tr_b16 v[190:191], v121 offset:21504
L_lw_58:
  s_waitcnt lgkmcnt(0)
  s_waitcnt vmcnt(16)
  s_barrier
  s_lshl_b32 s61, s5, 17
  s_lshl_b32 s62, s3, 15
  s_add_u32 s61, s61, s62
  s_add_u32 s61, s61, 0
  s_add_u32 m0, s60, 0
  s_add_u32 s62, s61, 0
  buffer_load_dwordx4 v118, s[28:31], s62 offen lds
  s_add_u32 m0, s60, 1024
  s_add_u32 s62, s61, 4096
  buffer_load_dwordx4 v118, s[28:31], s62 offen lds
  s_add_u32 m0, s60, 2048
  s_add_u32 s62, s61, 8192
  buffer_load_dwordx4 v119, s[28:31], s62 offen lds
  s_add_u32 m0, s60, 3072
  s_add_u32 s62, s61, 12288
  buffer_load_dwordx4 v119, s[28:31], s62 offen lds
  s_add_u32 m0, s60, 4096
  s_add_u32 s62, s61, 16384
  buffer_load_dwordx4 v118, s[28:31], s62 offen lds
  s_add_u32 m0, s60, 5120
  s_add_u32 s62, s61, 20480
  buffer_load_dwordx4 v118, s[28:31], s62 offen lds
  s_add_u32 m0, s60, 6144
  s_add_u32 s62, s61, 24576
  buffer_load_dwordx4 v119, s[28:31], s62 offen lds
  s_add_u32 m0, s60, 7168
  s_add_u32 s62, s61, 28672
  buffer_load_dwordx4 v119, s[28:31], s62 offen lds
  s_cmp_eq_u32 s3, 1
  s_cbranch_scc1 L_lv_65
  s_cmp_eq_u32 s3, 2
  s_cbranch_scc1 L_lv_66
  s_cmp_eq_u32 s3, 3
  s_cbranch_scc1 L_lv_67
L_lv_64:
  ds_read_b64_tr_b16 v[160:161], v120 offset:32768
  ds_read_b64_tr_b16 v[162:163], v120 offset:33792
  ds_read_b64_tr_b16 v[164:165], v120 offset:36864
  ds_read_b64_tr_b16 v[166:167], v120 offset:37888
  ds_read_b64_tr_b16 v[168:169], v121 offset:32768
  ds_read_b64_tr_b16 v[170:171], v121 offset:33792
  ds_read_b64_tr_b16 v[172:173], v121 offset:36864
  ds_read_b64_tr_b16 v[174:175], v121 offset:37888
  ds_read_b64_tr_b16 v[176:177], v120 offset:49152
  ds_read_b64_tr_b16 v[178:179], v120 offset:50176
  ds_read_b64_tr_b16 v[180:181], v120 offset:53248
  ds_read_b64_tr_b16 v[182:183], v120 offset:54272
  ds_read_b64_tr_b16 v[184:185], v121 offset:49152
  ds_read_b64_tr_b16 v[186:187], v121 offset:50176
  ds_read_b64_tr_b16 v[188:189], v121 offset:53248
  ds_read_b64_tr_b16 v[190:191], v121 offset:54272
  s_branch L_lw_63
L_lv_65:
  ds_read_b64_tr_b16 v[128:129], v120 offset:32768
  ds_read_b64_tr_b16 v[130:131], v120 offset:33792
  ds_read_b64_tr_b16 v[132:133], v120 offset:36864
  ds_read_b64_tr_b16 v[134:135], v120 offset:37888
  ds_read_b64_tr_b16 v[136:137], v121 offset:32768
  ds_read_b64_tr_b16 v[138:139], v121 offset:33792
  ds_read_b64_tr_b16 v[140:141], v121 offset:36864
  ds_read_b64_tr_b16 v[142:143], v121 offset:37888
  ds_read_b64_tr_b16 v[144:145], v120 offset:49152
  ds_read_b64_tr_b16 v[146:147], v120 offset:50176
  ds_read_b64_tr_b16 v[148:149], v120 offset:53248
  ds_read_b64_tr_b16 v[150:151], v120 offset:54272
  ds_read_b64_tr_b16 v[152:153], v121 offset:49152
  ds_read_b64_tr_b16 v[154:155], v121 offset:50176
  ds_read_b64_tr_b16 v[156:157], v121 offset:53248
  ds_read_b64_tr_b16 v[158:159], v121 offset:54272
  s_branch L_lw_63
L_lv_66:
  ds_read_b64_tr_b16 v[224:225], v120 offset:32768
  ds_read_b64_tr_b16 v[226:227], v120 offset:33792
  ds_read_b64_tr_b16 v[228:229], v120 offset:36864
  ds_read_b64_tr_b16 v[230:231], v120 offset:37888
  ds_read_b64_tr_b16 v[232:233], v121 offset:32768
  ds_read_b64_tr_b16 v[234:235], v121 offset:33792
  ds_read_b64_tr_b16 v[236:237], v121 offset:36864
  ds_read_b64_tr_b16 v[238:239], v121 offset:37888
  ds_read_b64_tr_b16 v[240:241], v120 offset:49152
  ds_read_b64_tr_b16 v[242:243], v120 offset:50176
  ds_read_b64_tr_b16 v[244:245], v120 offset:53248
  ds_read_b64_tr_b16 v[246:247], v120 offset:54272
  ds_read_b64_tr_b16 v[248:249], v121 offset:49152
  ds_read_b64_tr_b16 v[250:251], v121 offset:50176
  ds_read_b64_tr_b16 v[252:253], v121 offset:53248
  ds_read_b64_tr_b16 v[254:255], v121 offset:54272
  s_branch L_lw_63
L_lv_67:
  ds_read_b64_tr_b16 v[192:193], v120 offset:32768
  ds_read_b64_tr_b16 v[194:195], v120 offset:33792
  ds_read_b64_tr_b16 v[196:197], v120 offset:36864
  ds_read_b64_tr_b16 v[198:199], v120 offset:37888
  ds_read_b64_tr_b16 v[200:201], v121 offset:32768
  ds_read_b64_tr_b16 v[202:203], v121 offset:33792
  ds_read_b64_tr_b16 v[204:205], v121 offset:36864
  ds_read_b64_tr_b16 v[206:207], v121 offset:37888
  ds_read_b64_tr_b16 v[208:209], v120 offset:49152
  ds_read_b64_tr_b16 v[210:211], v120 offset:50176
  ds_read_b64_tr_b16 v[212:213], v120 offset:53248
  ds_read_b64_tr_b16 v[214:215], v120 offset:54272
  ds_read_b64_tr_b16 v[216:217], v121 offset:49152
  ds_read_b64_tr_b16 v[218:219], v121 offset:50176
  ds_read_b64_tr_b16 v[220:221], v121 offset:53248
  ds_read_b64_tr_b16 v[222:223], v121 offset:54272
L_lw_63:
  s_waitcnt lgkmcnt(0)
  s_waitcnt vmcnt(16)
  s_barrier
  s_lshl_b32 s61, s5, 17
  s_lshl_b32 s62, s3, 15
  s_add_u32 s61, s61, s62
  s_add_u32 s61, s61, 256
  s_add_u32 m0, s60, 32768
  s_add_u32 s62, s61, 0
  buffer_load_dwordx4 v118, s[28:31], s62 offen lds
  s_add_u32 m0, s60, 33792
  s_add_u32 s62, s61, 4096
  buffer_load_dwordx4 v118, s[28:31], s62 offen lds
  s_add_u32 m0, s60, 34816
  s_add_u32 s62, s61, 8192
  buffer_load_dwordx4 v119, s[28:31], s62 offen lds
  s_add_u32 m0, s60, 35840
  s_add_u32 s62, s61, 12288
  buffer_load_dwordx4 v119, s[28:31], s62 offen lds
  s_add_u32 m0, s60, 36864
  s_add_u32 s62, s61, 16384
  buffer_load_dwordx4 v118, s[28:31], s62 offen lds
  s_add_u32 m0, s60, 37888
  s_add_u32 s62, s61, 20480
  buffer_load_dwordx4 v118, s[28:31], s62 offen lds
  s_add_u32 m0, s60, 38912
  s_add_u32 s62, s61, 24576
  buffer_load_dwordx4 v119, s[28:31], s62 offen lds
  s_add_u32 m0, s60, 39936
  s_add_u32 s62, s61, 28672
  buffer_load_dwordx4 v119, s[28:31], s62 offen lds
  s_cmp_eq_u32 s3, 1
  s_cbranch_scc1 L_lv_70
  s_cmp_eq_u32 s3, 2
  s_cbranch_scc1 L_lv_71
  s_cmp_eq_u32 s3, 3
  s_cbranch_scc1 L_lv_72
L_lv_69:
  ds_read_b64_tr_b16 v[192:193], v122 offset:0
  ds_read_b64_tr_b16 v[194:195], v122 offset:1024
  ds_read_b64_tr_b16 v[196:197], v122 offset:4096
  ds_read_b64_tr_b16 v[198:199], v122 offset:5120
  ds_read_b64_tr_b16 v[200:201], v123 offset:0
  ds_read_b64_tr_b16 v[202:203], v123 offset:1024
  ds_read_b64_tr_b16 v[204:205], v123 offset:4096
  ds_read_b64_tr_b16 v[206:207], v123 offset:5120
  ds_read_b64_tr_b16 v[208:209], v122 offset:16384
  ds_read_b64_tr_b16 v[210:211], v122 offset:17408
  ds_read_b64_tr_b16 v[212:213], v122 offset:20480
  ds_read_b64_tr_b16 v[214:215], v122 offset:21504
  ds_read_b64_tr_b16 v[216:217], v123 offset:16384
  ds_read_b64_tr_b16 v[218:219], v123 offset:17408
  ds_read_b64_tr_b16 v[220:221], v123 offset:20480
  ds_read_b64_tr_b16 v[222:223], v123 offset:21504
  s_branch L_lw_68
L_lv_70:
  ds_read_b64_tr_b16 v[160:161], v122 offset:0
  ds_read_b64_tr_b16 v[162:163], v122 offset:1024
  ds_read_b64_tr_b16 v[164:165], v122 offset:4096
  ds_read_b64_tr_b16 v[166:167], v122 offset:5120
  ds_read_b64_tr_b16 v[168:169], v123 offset:0
  ds_read_b64_tr_b16 v[170:171], v123 offset:1024
  ds_read_b64_tr_b16 v[172:173], v123 offset:4096
  ds_read_b64_tr_b16 v[174:175], v123 offset:5120
  ds_read_b64_tr_b16 v[176:177], v122 offset:16384
  ds_read_b64_tr_b16 v[178:179], v122 offset:17408
  ds_read_b64_tr_b16 v[180:181], v122 offset:20480
  ds_read_b64_tr_b16 v[182:183], v122 offset:21504
  ds_read_b64_tr_b16 v[184:185], v123 offset:16384
  ds_read_b64_tr_b16 v[186:187], v123 offset:17408
  ds_read_b64_tr_b16 v[188:189], v123 offset:20480
  ds_read_b64_tr_b16 v[190:191], v123 offset:21504
  s_branch L_lw_68
L_lv_71:
  ds_read_b64_tr_b16 v[128:129], v122 offset:0
  ds_read_b64_tr_b16 v[130:131], v122 offset:1024
  ds_read_b64_tr_b16 v[132:133], v122 offset:4096
  ds_read_b64_tr_b16 v[134:135], v122 offset:5120
  ds_read_b64_tr_b16 v[136:137], v123 offset:0
  ds_read_b64_tr_b16 v[138:139], v123 offset:1024
  ds_read_b64_tr_b16 v[140:141], v123 offset:4096
  ds_read_b64_tr_b16 v[142:143], v123 offset:5120
  ds_read_b64_tr_b16 v[144:145], v122 offset:16384
  ds_read_b64_tr_b16 v[146:147], v122 offset:17408
  ds_read_b64_tr_b16 v[148:149], v122 offset:20480
  ds_read_b64_tr_b16 v[150:151], v122 offset:21504
  ds_read_b64_tr_b16 v[152:153], v123 offset:16384
  ds_read_b64_tr_b16 v[154:155], v123 offset:17408
  ds_read_b64_tr_b16 v[156:157], v123 offset:20480
  ds_read_b64_tr_b16 v[158:159], v123 offset:21504
  s_branch L_lw_68
L_lv_72:
  ds_read_b64_tr_b16 v[224:225], v122 offset:0
  ds_read_b64_tr_b16 v[226:227], v122 offset:1024
  ds_read_b64_tr_b16 v[228:229], v122 offset:4096
  ds_read_b64_tr_b16 v[230:231], v122 offset:5120
  ds_read_b64_tr_b16 v[232:233], v123 offset:0
  ds_read_b64_tr_b16 v[234:235], v123 offset:1024
  ds_read_b64_tr_b16 v[236:237], v123 offset:4096
  ds_read_b64_tr_b16 v[238:239], v123 offset:5120
  ds_read_b64_tr_b16 v[240:241], v122 offset:16384
  ds_read_b64_tr_b16 v[242:243], v122 offset:17408
  ds_read_b64_tr_b16 v[244:245], v122 offset:20480
  ds_read_b64_tr_b16 v[246:247], v122 offset:21504
  ds_read_b64_tr_b16 v[248:249], v123 offset:16384
  ds_read_b64_tr_b16 v[250:251], v123 offset:17408
  ds_read_b64_tr_b16 v[252:253], v123 offset:20480
  ds_read_b64_tr_b16 v[254:255], v123 offset:21504
L_lw_68:
  s_waitcnt lgkmcnt(0)
  s_waitcnt vmcnt(16)
  s_barrier
  s_lshl_b32 s61, s5, 17
  s_lshl_b32 s62, s3, 15
  s_add_u32 s61, s61, s62
  s_add_u32 s61, s61, 512
  s_add_u32 m0, s60, 65536
  s_add_u32 s62, s61, 0
  buffer_load_dwordx4 v118, s[28:31], s62 offen lds
  s_add_u32 m0, s60, 66560
  s_add_u32 s62, s61, 4096
  buffer_load_dwordx4 v118, s[28:31], s62 offen lds
  s_add_u32 m0, s60, 67584
  s_add_u32 s62, s61, 8192
  buffer_load_dwordx4 v119, s[28:31], s62 offen lds
  s_add_u32 m0, s60, 68608
  s_add_u32 s62, s61, 12288
  buffer_load_dwordx4 v119, s[28:31], s62 offen lds
  s_add_u32 m0, s60, 69632
  s_add_u32 s62, s61, 16384
  buffer_load_dwordx4 v118, s[28:31], s62 offen lds
  s_add_u32 m0, s60, 70656
  s_add_u32 s62, s61, 20480
  buffer_load_dwordx4 v118, s[28:31], s62 offen lds
  s_add_u32 m0, s60, 71680
  s_add_u32 s62, s61, 24576
  buffer_load_dwordx4 v119, s[28:31], s62 offen lds
  s_add_u32 m0, s60, 72704
  s_add_u32 s62, s61, 28672
  buffer_load_dwordx4 v119, s[28:31], s62 offen lds
  s_cmp_eq_u32 s3, 1
  s_cbranch_scc1 L_lv_75
  s_cmp_eq_u32 s3, 2
  s_cbranch_scc1 L_lv_76
  s_cmp_eq_u32 s3, 3
  s_cbranch_scc1 L_lv_77
L_lv_74:
  ds_read_b64_tr_b16 v[224:225], v122 offset:32768
  ds_read_b64_tr_b16 v[226:227], v122 offset:33792
  ds_read_b64_tr_b16 v[228:229], v122 offset:36864
  ds_read_b64_tr_b16 v[230:231], v122 offset:37888
  ds_read_b64_tr_b16 v[232:233], v123 offset:32768
  ds_read_b64_tr_b16 v[234:235], v123 offset:33792
  ds_read_b64_tr_b16 v[236:237], v123 offset:36864
  ds_read_b64_tr_b16 v[238:239], v123 offset:37888
  ds_read_b64_tr_b16 v[240:241], v122 offset:49152
  ds_read_b64_tr_b16 v[242:243], v122 offset:50176
  ds_read_b64_tr_b16 v[244:245], v122 offset:53248
  ds_read_b64_tr_b16 v[246:247], v122 offset:54272
  ds_read_b64_tr_b16 v[248:249], v123 offset:49152
  ds_read_b64_tr_b16 v[250:251], v123 offset:50176
  ds_read_b64_tr_b16 v[252:253], v123 offset:53248
  ds_read_b64_tr_b16 v[254:255], v123 offset:54272
  s_branch L_lw_73
L_lv_75:
  ds_read_b64_tr_b16 v[192:193], v122 offset:32768
  ds_read_b64_tr_b16 v[194:195], v122 offset:33792
  ds_read_b64_tr_b16 v[196:197], v122 offset:36864
  ds_read_b64_tr_b16 v[198:199], v122 offset:37888
  ds_read_b64_tr_b16 v[200:201], v123 offset:32768
  ds_read_b64_tr_b16 v[202:203], v123 offset:33792
  ds_read_b64_tr_b16 v[204:205], v123 offset:36864
  ds_read_b64_tr_b16 v[206:207], v123 offset:37888
  ds_read_b64_tr_b16 v[208:209], v122 offset:49152
  ds_read_b64_tr_b16 v[210:211], v122 offset:50176
  ds_read_b64_tr_b16 v[212:213], v122 offset:53248
  ds_read_b64_tr_b16 v[214:215], v122 offset:54272
  ds_read_b64_tr_b16 v[216:217], v123 offset:49152
  ds_read_b64_tr_b16 v[218:219], v123 offset:50176
  ds_read_b64_tr_b16 v[220:221], v123 offset:53248
  ds_read_b64_tr_b16 v[222:223], v123 offset:54272
  s_branch L_lw_73
L_lv_76:
  ds_read_b64_tr_b16 v[160:161], v122 offset:32768
  ds_read_b64_tr_b16 v[162:163], v122 offset:33792
  ds_read_b64_tr_b16 v[164:165], v122 offset:36864
  ds_read_b64_tr_b16 v[166:167], v122 offset:37888
  ds_read_b64_tr_b16 v[168:169], v123 offset:32768
  ds_read_b64_tr_b16 v[170:171], v123 offset:33792
  ds_read_b64_tr_b16 v[172:173], v123 offset:36864
  ds_read_b64_tr_b16 v[174:175], v123 offset:37888
  ds_read_b64_tr_b16 v[176:177], v122 offset:49152
  ds_read_b64_tr_b16 v[178:179], v122 offset:50176
  ds_read_b64_tr_b16 v[180:181], v122 offset:53248
  ds_read_b64_tr_b16 v[182:183], v122 offset:54272
  ds_read_b64_tr_b16 v[184:185], v123 offset:49152
  ds_read_b64_tr_b16 v[186:187], v123 offset:50176
  ds_read_b64_tr_b16 v[188:189], v123 offset:53248
  ds_read_b64_tr_b16 v[190:191], v123 offset:54272
  s_branch L_lw_73
L_lv_77:
  ds_read_b64_tr_b16 v[128:129], v122 offset:32768
  ds_read_b64_tr_b16 v[130:131], v122 offset:33792
  ds_read_b64_tr_b16 v[132:133], v122 offset:36864
  ds_read_b64_tr_b16 v[134:135], v122 offset:37888
  ds_read_b64_tr_b16 v[136:137], v123 offset:32768
  ds_read_b64_tr_b16 v[138:139], v123 offset:33792
  ds_read_b64_tr_b16 v[140:141], v123 offset:36864
  ds_read_b64_tr_b16 v[142:143], v123 offset:37888
  ds_read_b64_tr_b16 v[144:145], v122 offset:49152
  ds_read_b64_tr_b16 v[146:147], v122 offset:50176
  ds_read_b64_tr_b16 v[148:149], v122 offset:53248
  ds_read_b64_tr_b16 v[150:151], v122 offset:54272
  ds_read_b64_tr_b16 v[152:153], v123 offset:49152
  ds_read_b64_tr_b16 v[154:155], v123 offset:50176
  ds_read_b64_tr_b16 v[156:157], v123 offset:53248
  ds_read_b64_tr_b16 v[158:159], v123 offset:54272
L_lw_73:
  s_waitcnt lgkmcnt(0)
  s_waitcnt vmcnt(16)
  s_barrier
  s_lshl_b32 s61, s5, 17
  s_lshl_b32 s62, s3, 15
  s_add_u32 s61, s61, s62
  s_add_u32 s61, s61, 768
  s_add_u32 m0, s60, 98304
  s_add_u32 s62, s61, 0
  buffer_load_dwordx4 v118, s[28:31], s62 offen lds
  s_add_u32 m0, s60, 99328
  s_add_u32 s62, s61, 4096
  buffer_load_dwordx4 v118, s[28:31], s62 offen lds
  s_add_u32 m0, s60, 100352
  s_add_u32 s62, s61, 8192
  buffer_load_dwordx4 v119, s[28:31], s62 offen lds
  s_add_u32 m0, s60, 101376
  s_add_u32 s62, s61, 12288
  buffer_load_dwordx4 v119, s[28:31], s62 offen lds
  s_add_u32 m0, s60, 102400
  s_add_u32 s62, s61, 16384
  buffer_load_dwordx4 v118, s[28:31], s62 offen lds
  s_add_u32 m0, s60, 103424
  s_add_u32 s62, s61, 20480
  buffer_load_dwordx4 v118, s[28:31], s62 offen lds
  s_add_u32 m0, s60, 104448
  s_add_u32 s62, s61, 24576
  buffer_load_dwordx4 v119, s[28:31], s62 offen lds
  s_add_u32 m0, s60, 105472
  s_add_u32 s62, s61, 28672
  buffer_load_dwordx4 v119, s[28:31], s62 offen lds
  v_xor_b32 v126, 0, v124
  ds_read_b64_tr_b16 v[20:21], v126 offset:0
  ds_read_b64_tr_b16 v[22:23], v126 offset:1024
  v_xor_b32 v126, 32, v124
  ds_read_b64_tr_b16 v[24:25], v126 offset:0
  ds_read_b64_tr_b16 v[26:27], v126 offset:1024
  v_xor_b32 v126, 64, v124
  ds_read_b64_tr_b16 v[28:29], v126 offset:0
  ds_read_b64_tr_b16 v[30:31], v126 offset:1024
  v_xor_b32 v126, 96, v124
  ds_read_b64_tr_b16 v[32:33], v126 offset:0
  ds_read_b64_tr_b16 v[34:35], v126 offset:1024
  v_xor_b32 v126, 128, v124
  ds_read_b64_tr_b16 v[36:37], v126 offset:0
  ds_read_b64_tr_b16 v[38:39], v126 offset:1024
  v_xor_b32 v126, 160, v124
  ds_read_b64_tr_b16 v[40:41], v126 offset:0
  ds_read_b64_tr_b16 v[42:43], v126 offset:1024
  v_xor_b32 v126, 192, v124
  ds_read_b64_tr_b16 v[44:45], v126 offset:0
  ds_read_b64_tr_b16 v[46:47], v126 offset:1024
  v_xor_b32 v126, 224, v124
  ds_read_b64_tr_b16 v[48:49], v126 offset:0
  ds_read_b64_tr_b16 v[50:51], v126 offset:1024
  s_waitcnt lgkmcnt(0)
  ds_write_b128 v127, v[20:23] offset:0
  ds_write_b128 v127, v[24:27] offset:1024
  ds_write_b128 v127, v[28:31] offset:2048
  ds_write_b128 v127, v[32:35] offset:3072
  ds_write_b128 v127, v[36:39] offset:4096
  ds_write_b128 v127, v[40:43] offset:5120
  ds_write_b128 v127, v[44:47] offset:6144
  ds_write_b128 v127, v[48:51] offset:7168
  s_waitcnt lgkmcnt(0)
  v_add_u32 v124, 0x8000, v124
  v_add_u32 v127, 0x8000, v127
  s_waitcnt vmcnt(16)
  v_xor_b32 v126, 0, v124
  ds_read_b64_tr_b16 v[20:21], v126 offset:0
  ds_read_b64_tr_b16 v[22:23], v126 offset:1024
  v_xor_b32 v126, 32, v124
  ds_read_b64_tr_b16 v[24:25], v126 offset:0
  ds_read_b64_tr_b16 v[26:27], v126 offset:1024
  v_xor_b32 v126, 64, v124
  ds_read_b64_tr_b16 v[28:29], v126 offset:0
  ds_read_b64_tr_b16 v[30:31], v126 offset:1024
  v_xor_b32 v126, 96, v124
  ds_read_b64_tr_b16 v[32:33], v126 offset:0
  ds_read_b64_tr_b16 v[34:35], v126 offset:1024
  v_xor_b32 v126, 128, v124
  ds_read_b64_tr_b16 v[36:37], v126 offset:0
  ds_read_b64_tr_b16 v[38:39], v126 offset:1024
  v_xor_b32 v126, 160, v124
  ds_read_b64_tr_b16 v[40:41], v126 offset:0
  ds_read_b64_tr_b16 v[42:43], v126 offset:1024
  v_xor_b32 v126, 192, v124
  ds_read_b64_tr_b16 v[44:45], v126 offset:0
  ds_read_b64_tr_b16 v[46:47], v126 offset:1024
  v_xor_b32 v126, 224, v124
  ds_read_b64_tr_b16 v[48:49], v126 offset:0
  ds_read_b64_tr_b16 v[50:51], v126 offset:1024
  s_waitcnt lgkmcnt(0)
  ds_write_b128 v127, v[20:23] offset:0
  ds_write_b128 v127, v[24:27] offset:1024
  ds_write_b128 v127, v[28:31] offset:2048
  ds_write_b128 v127, v[32:35] offset:3072
  ds_write_b128 v127, v[36:39] offset:4096
  ds_write_b128 v127, v[40:43] offset:5120
  ds_write_b128 v127, v[44:47] offset:6144
  ds_write_b128 v127, v[48:51] offset:7168
  s_waitcnt lgkmcnt(0)
  v_add_u32 v124, 0x8000, v124
  v_add_u32 v127, 0x8000, v127
  s_waitcnt vmcnt(8)
  v_xor_b32 v126, 0, v124
  ds_read_b64_tr_b16 v[20:21], v126 offset:0
  ds_read_b64_tr_b16 v[22:23], v126 offset:1024
  v_xor_b32 v126, 32, v124
  ds_read_b64_tr_b16 v[24:25], v126 offset:0
  ds_read_b64_tr_b16 v[26:27], v126 offset:1024
  v_xor_b32 v126, 64, v124
  ds_read_b64_tr_b16 v[28:29], v126 offset:0
  ds_read_b64_tr_b16 v[30:31], v126 offset:1024
  v_xor_b32 v126, 96, v124
  ds_read_b64_tr_b16 v[32:33], v126 offset:0
  ds_read_b64_tr_b16 v[34:35], v126 offset:1024
  v_xor_b32 v126, 128, v124
  ds_read_b64_tr_b16 v[36:37], v126 offset:0
  ds_read_b64_tr_b16 v[38:39], v126 offset:1024
  v_xor_b32 v126, 160, v124
  ds_read_b64_tr_b16 v[40:41], v126 offset:0
  ds_read_b64_tr_b16 v[42:43], v126 offset:1024
  v_xor_b32 v126, 192, v124
  ds_read_b64_tr_b16 v[44:45], v126 offset:0
  ds_read_b64_tr_b16 v[46:47], v126 offset:1024
  v_xor_b32 v126, 224, v124
  ds_read_b64_tr_b16 v[48:49], v126 offset:0
  ds_read_b64_tr_b16 v[50:51], v126 offset:1024
  s_waitcnt lgkmcnt(0)
  ds_write_b128 v127, v[20:23] offset:0
  ds_write_b128 v127, v[24:27] offset:1024
  ds_write_b128 v127, v[28:31] offset:2048
  ds_write_b128 v127, v[32:35] offset:3072
  ds_write_b128 v127, v[36:39] offset:4096
  ds_write_b128 v127, v[40:43] offset:5120
  ds_write_b128 v127, v[44:47] offset:6144
  ds_write_b128 v127, v[48:51] offset:7168
  s_waitcnt lgkmcnt(0)
  v_add_u32 v124, 0x8000, v124
  v_add_u32 v127, 0x8000, v127
  s_waitcnt vmcnt(0)
  v_cmp_ne_u32 vcc, 64, v17
  s_cbranch_vccz L_rec_dn
  s_mov_b32 s7, 0
  v_mbcnt_lo_u32_b32 v16, -1, 0
  v_and_b32 v16, 3, v16
  v_lshlrev_b32 v16, 6, v16
L_wd_78:
  buffer_load_dword v17, v16, s[12:15], 0 offen offset:16 sc1
  s_waitcnt vmcnt(0)
  v_cmp_ne_u32 vcc, 64, v17
  s_cbranch_vccz L_wdo_79
  s_add_u32 s7, s7, 1
  s_cmp_lt_u32 s7, 131072
  s_cbranch_scc1 L_wd_78
  s_mov_b32 s6, 10
  s_branch L_err
L_wdo_79:
L_rec_dn:
  s_sub_u32 s60, s35, s53
  s_add_u32 s61, s60, 4096
  buffer_load_dwordx4 v[52:55], v4, s[8:11], s60 offen offset:0 sc1
  buffer_load_dwordx4 v[68:71], v4, s[8:11], s60 offen offset:128 sc1
  buffer_load_dwordx4 v[56:59], v4, s[8:11], s60 offen offset:2048 sc1
  buffer_load_dwordx4 v[72:75], v4, s[8:11], s60 offen offset:2176 sc1
  buffer_load_dwordx4 v[60:63], v4, s[8:11], s61 offen offset:0 sc1
  buffer_load_dwordx4 v[76:79], v4, s[8:11], s61 offen offset:128 sc1
  buffer_load_dwordx4 v[64:67], v4, s[8:11], s61 offen offset:2048 sc1
  buffer_load_dwordx4 v[80:83], v4, s[8:11], s61 offen offset:2176 sc1
  buffer_load_dwordx4 v[108:111], v9, s[8:11], s60 offen offset:0 sc1
  buffer_load_dwordx4 v[112:115], v9, s[8:11], s60 offen offset:256 sc1
  v_xor_b32 v126, 0, v124
  ds_read_b64_tr_b16 v[20:21], v126 offset:0
  ds_read_b64_tr_b16 v[22:23], v126 offset:1024
  v_xor_b32 v126, 32, v124
  ds_read_b64_tr_b16 v[24:25], v126 offset:0
  ds_read_b64_tr_b16 v[26:27], v126 offset:1024
  v_xor_b32 v126, 64, v124
  ds_read_b64_tr_b16 v[28:29], v126 offset:0
  ds_read_b64_tr_b16 v[30:31], v126 offset:1024
  v_xor_b32 v126, 96, v124
  ds_read_b64_tr_b16 v[32:33], v126 offset:0
  ds_read_b64_tr_b16 v[34:35], v126 offset:1024
  v_xor_b32 v126, 128, v124
  ds_read_b64_tr_b16 v[36:37], v126 offset:0
  ds_read_b64_tr_b16 v[38:39], v126 offset:1024
  v_xor_b32 v126, 160, v124
  ds_read_b64_tr_b16 v[40:41], v126 offset:0
  ds_read_b64_tr_b16 v[42:43], v126 offset:1024
  v_xor_b32 v126, 192, v124
  ds_read_b64_tr_b16 v[44:45], v126 offset:0
  ds_read_b64_tr_b16 v[46:47], v126 offset:1024
  v_xor_b32 v126, 224, v124
  ds_read_b64_tr_b16 v[48:49], v126 offset:0
  ds_read_b64_tr_b16 v[50:51], v126 offset:1024
  s_waitcnt lgkmcnt(0)
  ds_write_b128 v127, v[20:23] offset:0
  ds_write_b128 v127, v[24:27] offset:1024
  ds_write_b128 v127, v[28:31] offset:2048
  ds_write_b128 v127, v[32:35] offset:3072
  ds_write_b128 v127, v[36:39] offset:4096
  ds_write_b128 v127, v[40:43] offset:5120
  ds_write_b128 v127, v[44:47] offset:6144
  ds_write_b128 v127, v[48:51] offset:7168
  s_waitcnt lgkmcnt(0)
  v_add_u32 v124, 0x8000, v124
  v_add_u32 v127, 0x8000, v127
  v_mov_b64 v[20:21], v[84:85]
  v_mov_b64 v[22:23], v[86:87]
  v_mov_b64 v[24:25], v[88:89]
  v_mov_b64 v[26:27], v[90:91]
  s_mov_b32 s32, 0
  s_mov_b32 s49, 1
  s_mov_b32 s33, 1
  s_mov_b32 s59, 1
  s_and_b32 s6, s32, 3
  s_lshl_b32 s6, s6, 19
  s_add_u32 s6, s6, s35
  s_sub_u32 s60, s6, s53
  s_add_u32 s61, s60, 4096
  s_mov_b32 s7, 0
  s_branch L_kvt_81
L_kvs_80:
  buffer_load_dwordx4 v[52:55], v4, s[8:11], s60 offen offset:0 sc1
  buffer_load_dwordx4 v[68:71], v4, s[8:11], s60 offen offset:128 sc1
  buffer_load_dwordx4 v[56:59], v4, s[8:11], s60 offen offset:2048 sc1
  buffer_load_dwordx4 v[72:75], v4, s[8:11], s60 offen offset:2176 sc1
  buffer_load_dwordx4 v[60:63], v4, s[8:11], s61 offen offset:0 sc1
  buffer_load_dwordx4 v[76:79], v4, s[8:11], s61 offen offset:128 sc1
  buffer_load_dwordx4 v[64:67], v4, s[8:11], s61 offen offset:2048 sc1
  buffer_load_dwordx4 v[80:83], v4, s[8:11], s61 offen offset:2176 sc1
  buffer_load_dwordx4 v[108:111], v9, s[8:11], s60 offen offset:0 sc1
  buffer_load_dwordx4 v[112:115], v9, s[8:11], s60 offen offset:256 sc1
L_kvt_81:
  s_waitcnt vmcnt(0)
  v_bitop3_b32 v16, v52, v56, s59 bitop3:0x7e
  v_bitop3_b32 v17, v60, v64, s59 bitop3:0x7e
  v_bitop3_b32 v18, v68, v72, s59 bitop3:0x7e
  v_bitop3_b32 v19, v76, v80, s59 bitop3:0x7e
  v_or3_b32 v16, v16, v17, v18
  v_bitop3_b32 v17, v108, v112, s59 bitop3:0x7e
  v_or3_b32 v16, v16, v17, v19
  v_and_b32 v16, 1, v16
  v_cmp_ne_u32 vcc, 0, v16
  s_cbranch_vccz L_rec_go
  s_add_u32 s7, s7, 1
  s_cmp_lt_u32 s7, 131072
  s_cbranch_scc1 L_kvs_80
  s_mov_b32 s6, 13
  s_branch L_err
L_rec_go:
  s_add_u32 s6, s32, 1
  s_and_b32 s6, s6, 3
  s_lshl_b32 s6, s6, 19
  s_add_u32 s50, s35, s6
  s_add_u32 s51, s50, 0x2000
  v_add_u32 v116, s48, v1
  v_add_u32 v117, s45, v1
  v_add_u32 v118, s46, v1
  v_add_u32 v119, s47, v1
  v_mov_b64 v[84:85], 0
  v_mov_b64 v[86:87], 0
  v_mov_b64 v[88:89], 0
  v_mov_b64 v[90:91], 0
  v_mov_b64 v[92:93], 0
  v_mov_b64 v[94:95], 0
  v_mov_b64 v[96:97], 0
  v_mov_b64 v[98:99], 0
  v_mov_b64 v[100:101], 0
  v_mov_b64 v[102:103], 0
  v_mov_b64 v[104:105], 0
  v_mov_b64 v[106:107], 0
  s_mov_b64 s[60:61], 0
  s_branch L_rec_step
L_rec_loop:
  buffer_load_dwordx4 v[20:23], v1, s[8:11], s44 offen sc1
  buffer_load_dwordx4 v[24:27], v1, s[8:11], s44 offen offset:1024 sc1
  s_mov_b32 s7, 0
  v_add_u32 v116, s48, v1
  v_add_u32 v117, s45, v1
  v_add_u32 v118, s46, v1
  v_add_u32 v119, s47, v1
  v_mov_b64 v[84:85], 0
  v_mov_b64 v[86:87], 0
  v_mov_b64 v[88:89], 0
  v_mov_b64 v[90:91], 0
  v_mov_b64 v[92:93], 0
  v_mov_b64 v[94:95], 0
  v_mov_b64 v[96:97], 0
  v_mov_b64 v[98:99], 0
  v_mov_b64 v[100:101], 0
  v_mov_b64 v[102:103], 0
  v_mov_b64 v[104:105], 0
  v_mov_b64 v[106:107], 0
  buffer_load_dwordx4 v[120:123], v1, s[8:11], s44 offen sc1
  buffer_load_dwordx4 v[124:127], v1, s[8:11], s44 offen offset:1024 sc1
  s_branch L_rec_gather1
L_rec_gather:
  buffer_load_dwordx4 v[120:123], v1, s[8:11], s44 offen sc1
  buffer_load_dwordx4 v[124:127], v1, s[8:11], s44 offen offset:1024 sc1
L_rec_gather1:
  s_waitcnt vmcnt(2)
  v_bitop3_b32 v16, v20, v22, s33 bitop3:0x7e
  v_bitop3_b32 v17, v24, v26, s33 bitop3:0x7e
  v_bitop3_b32 v16, v16, v17, 1 bitop3:0xa8
  v_cmp_ne_u32 vcc, 0, v16
  s_cbranch_vccz L_rec_got
  buffer_load_dwordx4 v[20:23], v1, s[8:11], s44 offen sc1
  buffer_load_dwordx4 v[24:27], v1, s[8:11], s44 offen offset:1024 sc1
  s_waitcnt vmcnt(2)
  v_bitop3_b32 v16, v120, v122, s33 bitop3:0x7e
  v_bitop3_b32 v17, v124, v126, s33 bitop3:0x7e
  v_bitop3_b32 v16, v16, v17, 1 bitop3:0xa8
  v_cmp_ne_u32 vcc, 0, v16
  s_cbranch_vccz L_rec_got1
  s_and_b32 s6, s7, 31
  s_cmp_lg_u32 s6, 31
  s_cbranch_scc1 L_tf_82
  buffer_wbl2 sc1
  s_waitcnt vmcnt(0)
  buffer_inv sc1
  s_waitcnt vmcnt(0)
L_tf_82:
  s_add_u32 s7, s7, 1
  s_cmp_lt_u32 s7, 131072
  s_cbranch_scc1 L_rec_gather
  s_mov_b32 s6, 12
  s_branch L_err
L_rec_got1:
  v_mov_b64 v[20:21], v[120:121]
  v_mov_b64 v[22:23], v[122:123]
  v_mov_b64 v[24:25], v[124:125]
  v_mov_b64 v[26:27], v[126:127]
L_rec_got:
  s_mov_b32 s63, s7
  s_xor_b32 s33, s33, 1
L_rec_step:
  ds_write_b128 v116, v[20:23]
  ds_write_b128 v116, v[24:27] offset:1024
  v_smfmac_f32_16x16x64_bf16 v[84:87], v[20:23], a[0:7], v0
  s_and_b32 s6, s32, 3
  v_smfmac_f32_16x16x64_bf16 v[88:91], v[20:23], a[8:15], v0
  s_lshl_b32 s6, s6, 17
  v_smfmac_f32_16x16x64_bf16 v[84:87], v[24:27], a[16:23], v0
  s_add_u32 s52, s36, s6
  v_smfmac_f32_16x16x64_bf16 v[88:91], v[24:27], a[24:31], v0
  s_cmp_lg_u64 s[60:61], 0
  s_waitcnt lgkmcnt(0)
  s_barrier
  ds_read_b128 v[28:31], v117 offset:0
  ds_read_b128 v[32:35], v117 offset:1024
  v_smfmac_f32_16x16x64_bf16 v[92:95], v[20:23], a[128:135], v0
  ds_read_b128 v[36:39], v118 offset:0
  ds_read_b128 v[40:43], v118 offset:1024
  v_smfmac_f32_16x16x64_bf16 v[96:99], v[20:23], a[136:143], v0
  ds_read_b128 v[44:47], v119 offset:0
  ds_read_b128 v[48:51], v119 offset:1024
  v_smfmac_f32_16x16x64_bf16 v[92:95], v[24:27], a[144:151], v0
  v_smfmac_f32_16x16x64_bf16 v[96:99], v[24:27], a[152:159], v0
  v_smfmac_f32_16x16x64_bf16 v[100:103], v[20:23], v[128:135], v0
  v_smfmac_f32_16x16x64_bf16 v[104:107], v[20:23], v[136:143], v0
  v_smfmac_f32_16x16x64_bf16 v[100:103], v[24:27], v[144:151], v0
  v_smfmac_f32_16x16x64_bf16 v[104:107], v[24:27], v[152:159], v0
  s_cbranch_scc1 L_rec_kvwait
L_rec_kvok:
  s_waitcnt lgkmcnt(5)
  v_smfmac_f32_16x16x64_bf16 v[84:87], v[28:31], a[32:39], v0
  v_smfmac_f32_16x16x64_bf16 v[88:91], v[28:31], a[40:47], v0
  s_mov_b32 m0, s53
  s_waitcnt lgkmcnt(4)
  v_smfmac_f32_16x16x64_bf16 v[84:87], v[32:35], a[48:55], v0
  v_smfmac_f32_16x16x64_bf16 v[88:91], v[32:35], a[56:63], v0
  buffer_load_dwordx4 v1, s[8:11], s50 offen sc1 lds
  s_waitcnt lgkmcnt(3)
  v_smfmac_f32_16x16x64_bf16 v[84:87], v[36:39], a[64:71], v0
  v_smfmac_f32_16x16x64_bf16 v[88:91], v[36:39], a[72:79], v0
  buffer_load_dwordx4 v1, s[8:11], s50 offen offset:1024 sc1 lds
  s_waitcnt lgkmcnt(2)
  v_smfmac_f32_16x16x64_bf16 v[84:87], v[40:43], a[80:87], v0
  v_smfmac_f32_16x16x64_bf16 v[88:91], v[40:43], a[88:95], v0
  s_mov_b32 m0, s37
  s_waitcnt lgkmcnt(1)
  v_smfmac_f32_16x16x64_bf16 v[84:87], v[44:47], a[96:103], v0
  v_smfmac_f32_16x16x64_bf16 v[88:91], v[44:47], a[104:111], v0
  buffer_load_dwordx4 v1, s[8:11], s51 offen sc1 lds
  s_waitcnt lgkmcnt(0)
  v_smfmac_f32_16x16x64_bf16 v[84:87], v[48:51], a[112:119], v0
  v_smfmac_f32_16x16x64_bf16 v[88:91], v[48:51], a[120:127], v0
  buffer_load_dwordx4 v1, s[8:11], s51 offen offset:1024 sc1 lds
  v_smfmac_f32_16x16x64_bf16 v[92:95], v[28:31], a[160:167], v0
  v_smfmac_f32_16x16x64_bf16 v[92:95], v[32:35], a[176:183], v0
  v_smfmac_f32_16x16x64_bf16 v[92:95], v[36:39], a[192:199], v0
  v_smfmac_f32_16x16x64_bf16 v[92:95], v[40:43], a[208:215], v0
  v_smfmac_f32_16x16x64_bf16 v[92:95], v[44:47], a[224:231], v0
  s_nop 0
  v_add_f32 v84, v84, v85
  v_add_f32 v86, v86, v87
  v_smfmac_f32_16x16x64_bf16 v[92:95], v[48:51], a[240:247], v0
  v_cvt_pk_bf16_f32 v16, v84, v86
  v_add_f32 v88, v88, v89
  v_smfmac_f32_16x16x64_bf16 v[96:99], v[28:31], a[168:175], v0
  v_add_f32 v90, v90, v91
  v_cvt_pk_bf16_f32 v18, v88, v90
  v_smfmac_f32_16x16x64_bf16 v[96:99], v[32:35], a[184:191], v0
  v_smfmac_f32_16x16x64_bf16 v[96:99], v[36:39], a[200:207], v0
  s_nop 0
  v_add_f32 v92, v92, v93
  v_smfmac_f32_16x16x64_bf16 v[96:99], v[40:43], a[216:223], v0
  v_add_f32 v94, v94, v95
  v_smfmac_f32_16x16x64_bf16 v[96:99], v[44:47], a[232:239], v0
  v_cvt_pk_bf16_f32 v17, v92, v94
  v_smfmac_f32_16x16x64_bf16 v[96:99], v[48:51], a[248:255], v0
  ds_write_b64 v2, v[16:17]
  v_smfmac_f32_16x16x64_bf16 v[100:103], v[28:31], v[160:167], v0
  v_smfmac_f32_16x16x64_bf16 v[104:107], v[28:31], v[168:175], v0
  s_nop 4
  v_add_f32 v96, v96, v97
  v_add_f32 v98, v98, v99
  v_cvt_pk_bf16_f32 v19, v96, v98
  ds_write_b64 v2, v[18:19] offset:128
  v_smfmac_f32_16x16x64_bf16 v[100:103], v[32:35], v[176:183], v0
  v_smfmac_f32_16x16x64_bf16 v[104:107], v[32:35], v[184:191], v0
  s_waitcnt lgkmcnt(0)
  s_barrier
  ds_read_b64_tr_b16 v[84:85], v3 offset:0
  ds_read_b64_tr_b16 v[86:87], v3 offset:64
  v_smfmac_f32_16x16x64_bf16 v[100:103], v[36:39], v[192:199], v0
  ds_read_b64_tr_b16 v[88:89], v3 offset:256
  ds_read_b64_tr_b16 v[90:91], v3 offset:320
  v_smfmac_f32_16x16x64_bf16 v[104:107], v[36:39], v[200:207], v0
  ds_read_b64_tr_b16 v[92:93], v3 offset:512
  ds_read_b64_tr_b16 v[94:95], v3 offset:576
  v_smfmac_f32_16x16x64_bf16 v[100:103], v[40:43], v[208:215], v0
  ds_read_b64_tr_b16 v[96:97], v3 offset:768
  ds_read_b64_tr_b16 v[98:99], v3 offset:832
  v_smfmac_f32_16x16x64_bf16 v[104:107], v[40:43], v[216:223], v0
  s_waitcnt vmcnt(4)
  s_waitcnt lgkmcnt(6)
  v_mfma_f32_16x16x32_bf16 v[116:119], v[52:55], v[84:87], 0
  v_mfma_f32_16x16x32_bf16 v[120:123], v[68:71], v[84:87], 0
  v_mfma_f32_16x16x32_bf16 v[124:127], v[84:87], v[84:87], 0
  s_waitcnt lgkmcnt(4)
  v_mfma_f32_16x16x32_bf16 v[116:119], v[56:59], v[88:91], v[116:119]
  v_mfma_f32_16x16x32_bf16 v[120:123], v[72:75], v[88:91], v[120:123]
  v_mfma_f32_16x16x32_bf16 v[124:127], v[88:91], v[88:91], v[124:127]
  s_waitcnt lgkmcnt(2)
  v_mfma_f32_16x16x32_bf16 v[116:119], v[60:63], v[92:95], v[116:119]
  v_mfma_f32_16x16x32_bf16 v[120:123], v[76:79], v[92:95], v[120:123]
  v_mfma_f32_16x16x32_bf16 v[124:127], v[92:95], v[92:95], v[124:127]
  s_waitcnt lgkmcnt(0)
  v_mfma_f32_16x16x32_bf16 v[116:119], v[64:67], v[96:99], v[116:119]
  v_mfma_f32_16x16x32_bf16 v[120:123], v[80:83], v[96:99], v[120:123]
  v_mfma_f32_16x16x32_bf16 v[124:127], v[96:99], v[96:99], v[124:127]
  v_smfmac_f32_16x16x64_bf16 v[100:103], v[44:47], v[224:231], v0
  ds_read_b128 v[52:55], v7 offset:0
  ds_read_b128 v[56:59], v7 offset:8192
  s_nop 2
  v_max3_f32 v88, v116, v117, v118
  v_max3_f32 v89, v120, v121, v122
  v_max3_f32 v88, v88, v119, v123
  v_max3_f32 v89, v89, v126, v127
  v_max_f32 v88, v88, v89
  v_max_f32 v89, v88, v89
  v_smfmac_f32_16x16x64_bf16 v[104:107], v[44:47], v[232:239], v0
  ds_read_b128 v[60:63], v7 offset:1024
  v_permlane32_swap_b32 v88, v89
  v_max_f32 v88, v88, v89
  v_max_f32 v89, v88, v89
  v_smfmac_f32_16x16x64_bf16 v[100:103], v[48:51], v[240:247], v0
  ds_read_b128 v[64:67], v7 offset:9216
  v_permlane16_swap_b32 v88, v89
  v_max_f32 v88, v88, v89
  v_mul_f32 v88, s34, v88
  v_smfmac_f32_16x16x64_bf16 v[104:107], v[48:51], v[248:255], v0
  v_fma_f32 v126, v126, s34, -v88
  v_fma_f32 v127, v127, s34, -v88
  v_exp_f32 v126, v126
  ds_read_b128 v[68:71], v7 offset:16384
  v_exp_f32 v127, v127
  ds_read_b128 v[72:75], v7 offset:24576
  v_fma_f32 v116, v116, s34, -v88
  v_fma_f32 v117, v117, s34, -v88
  v_fma_f32 v118, v118, s34, -v88
  v_fma_f32 v119, v119, s34, -v88
  v_cvt_pk_bf16_f32 v12, v126, v127
  v_exp_f32 v116, v116
  ds_read_b128 v[76:79], v7 offset:17408
  v_exp_f32 v117, v117
  ds_read_b128 v[80:83], v7 offset:25600
  v_mfma_f32_16x16x16_bf16 v[124:127], v[10:11], v[12:13], 0
  v_exp_f32 v118, v118
  ds_read_b128 v[20:23], v7 offset:2048
  v_exp_f32 v119, v119
  ds_read_b128 v[24:27], v7 offset:10240
  v_add_f32 v100, v100, v101
  v_add_f32 v102, v102, v103
  v_cvt_pk_bf16_f32 v16, v100, v102
  v_cvt_pk_bf16_f32 v92, v116, v117
  v_cvt_pk_bf16_f32 v93, v118, v119
  v_add_f32 v104, v104, v105
  v_add_f32 v106, v106, v107
  v_cvt_pk_bf16_f32 v18, v104, v106
  v_mfma_f32_16x16x16_bf16 v[124:127], v[10:11], v[92:93], v[124:127]
  v_bfi_b32 v16, 1, s59, v16
  v_fma_f32 v120, v120, s34, -v88
  v_fma_f32 v121, v121, s34, -v88
  buffer_store_dwordx4 v[16:19], v1, s[8:11], s52 offen sc1
  v_mfma_f32_16x16x16_bf16 v[100:103], v[16:17], v[12:13], 0
  v_fma_f32 v122, v122, s34, -v88
  v_fma_f32 v123, v123, s34, -v88
  v_mfma_f32_16x16x16_bf16 v[104:107], v[18:19], v[12:13], 0
  v_exp_f32 v120, v120
  ds_read_b128 v[28:31], v7 offset:3072
  v_exp_f32 v121, v121
  ds_read_b128 v[32:35], v7 offset:11264
  v_exp_f32 v122, v122
  ds_read_b128 v[36:39], v7 offset:18432
  v_exp_f32 v123, v123
  ds_read_b128 v[40:43], v7 offset:26624
  s_cmp_eq_u32 s32, 63
  v_cvt_pk_bf16_f32 v94, v120, v121
  v_cvt_pk_bf16_f32 v95, v122, v123
  s_cbranch_scc1 L_rec_last
  s_nop 0
  v_mfma_f32_16x16x16_bf16 v[124:127], v[10:11], v[94:95], v[124:127]
  v_mfma_f32_16x16x32_bf16 v[100:103], v[108:111], v[92:95], v[100:103]
  v_mfma_f32_16x16x32_bf16 v[104:107], v[112:115], v[92:95], v[104:107]
  ds_read_b128 v[44:47], v7 offset:19456
  ds_read_b128 v[48:51], v7 offset:27648
  s_nop 3
  v_rcp_f32 v124, v124
  s_nop 0
  v_pk_mul_f32 v[100:101], v[100:101], v[124:125] op_sel_hi:[1,0]
  v_pk_mul_f32 v[102:103], v[102:103], v[124:125] op_sel_hi:[1,0]
  v_cvt_pk_bf16_f32 v116, v100, v101
  v_cvt_pk_bf16_f32 v117, v102, v103
  v_pk_mul_f32 v[104:105], v[104:105], v[124:125] op_sel_hi:[1,0]
  v_pk_mul_f32 v[106:107], v[106:107], v[124:125] op_sel_hi:[1,0]
  v_cvt_pk_bf16_f32 v118, v104, v105
  v_cvt_pk_bf16_f32 v119, v106, v107
  s_mov_b64 exec, s[56:57]
  ds_write2_b32 v5, v116, v117 offset0:0 offset1:4
  ds_write2_b32 v5, v118, v119 offset0:8 offset1:12
  s_mov_b64 exec, -1
  v_mfma_f32_32x32x8_bf16 v[84:99], v[12:13], v[14:15], 0
  v_mfma_f32_32x32x8_bf16 v[100:115], v[12:13], v[14:15], 0
  s_waitcnt vmcnt(1) lgkmcnt(0)
  s_barrier
  ds_read_b128 v[116:119], v6
  ds_read_b128 v[120:123], v6 offset:128
  s_waitcnt lgkmcnt(1)
  s_nop 3
  v_smfmac_f32_16x16x64_bf16 v[84:87], v[116:119], v[52:59], v0
  ds_read_b128 v[52:55], v7 offset:4096
  ds_read_b128 v[56:59], v7 offset:12288
  v_smfmac_f32_16x16x64_bf16 v[88:91], v[116:119], v[60:67], v0
  ds_read_b128 v[60:63], v7 offset:5120
  ds_read_b128 v[64:67], v7 offset:13312
  s_waitcnt lgkmcnt(4)
  v_smfmac_f32_16x16x64_bf16 v[84:87], v[120:123], v[68:75], v0
  ds_read_b128 v[68:71], v7 offset:20480
  ds_read_b128 v[72:75], v7 offset:28672
  v_smfmac_f32_16x16x64_bf16 v[88:91], v[120:123], v[76:83], v0
  ds_read_b128 v[76:79], v7 offset:21504
  ds_read_b128 v[80:83], v7 offset:29696
  v_smfmac_f32_16x16x64_bf16 v[92:95], v[116:119], v[20:27], v0
  ds_read_b128 v[20:23], v7 offset:6144
  ds_read_b128 v[24:27], v7 offset:14336
  v_smfmac_f32_16x16x64_bf16 v[96:99], v[116:119], v[28:35], v0
  ds_read_b128 v[28:31], v7 offset:7168
  ds_read_b128 v[32:35], v7 offset:15360
  v_add_f32 v84, v84, v85
  v_smfmac_f32_16x16x64_bf16 v[92:95], v[120:123], v[36:43], v0
  ds_read_b128 v[36:39], v7 offset:22528
  ds_read_b128 v[40:43], v7 offset:30720
  v_add_f32 v86, v86, v87
  v_smfmac_f32_16x16x64_bf16 v[96:99], v[120:123], v[44:51], v0
  ds_read_b128 v[44:47], v7 offset:23552
  ds_read_b128 v[48:51], v7 offset:31744
  v_cvt_pk_bf16_f32 v124, v84, v86
  s_waitcnt lgkmcnt(14)
  v_smfmac_f32_16x16x64_bf16 v[100:103], v[116:119], v[52:59], v0
  v_add_f32 v88, v88, v89
  v_add_f32 v90, v90, v91
  s_waitcnt lgkmcnt(12)
  v_smfmac_f32_16x16x64_bf16 v[104:107], v[116:119], v[60:67], v0
  v_cvt_pk_bf16_f32 v125, v88, v90
  v_add_f32 v92, v92, v93
  s_waitcnt lgkmcnt(10)
  v_smfmac_f32_16x16x64_bf16 v[100:103], v[120:123], v[68:75], v0
  v_add_f32 v94, v94, v95
  v_cvt_pk_bf16_f32 v126, v92, v94
  s_waitcnt lgkmcnt(8)
  v_smfmac_f32_16x16x64_bf16 v[104:107], v[120:123], v[76:83], v0
  v_add_f32 v96, v96, v97
  v_add_f32 v98, v98, v99
  s_waitcnt lgkmcnt(6)
  v_smfmac_f32_16x16x64_bf16 v[108:111], v[116:119], v[20:27], v0
  v_cvt_pk_bf16_f32 v127, v96, v98
  v_bfi_b32 v124, 1, s33, v124
  s_waitcnt lgkmcnt(4)
  v_smfmac_f32_16x16x64_bf16 v[112:115], v[116:119], v[28:35], v0
  buffer_store_dwordx4 v[124:127], v8, s[8:11], s39 offen
  v_add_f32 v100, v100, v101
  s_waitcnt lgkmcnt(2)
  v_smfmac_f32_16x16x64_bf16 v[108:111], v[120:123], v[36:43], v0
  v_add_f32 v102, v102, v103
  v_cvt_pk_bf16_f32 v16, v100, v102
  s_waitcnt lgkmcnt(0)
  v_smfmac_f32_16x16x64_bf16 v[112:115], v[120:123], v[44:51], v0
  v_add_f32 v104, v104, v105
  v_add_f32 v106, v106, v107
  v_cvt_pk_bf16_f32 v17, v104, v106
  s_nop 0
  v_add_f32 v108, v108, v109
  v_add_f32 v110, v110, v111
  v_cvt_pk_bf16_f32 v18, v108, v110
  s_nop 0
  v_add_f32 v112, v112, v113
  v_add_f32 v114, v114, v115
  v_cvt_pk_bf16_f32 v19, v112, v114
  v_bfi_b32 v16, 1, s33, v16
  buffer_store_dwordx4 v[16:19], v8, s[8:11], s40 offen
  s_add_u32 s32, s32, 1
  ds_read_b128 v[52:55], v4 offset:0
  ds_read_b128 v[68:71], v4 offset:128
  ds_read_b128 v[56:59], v4 offset:2048
  ds_read_b128 v[72:75], v4 offset:2176
  ds_read_b128 v[60:63], v4 offset:4096
  ds_read_b128 v[76:79], v4 offset:4224
  ds_read_b128 v[64:67], v4 offset:6144
  ds_read_b128 v[80:83], v4 offset:6272
  ds_read_b128 v[108:111], v9
  ds_read_b128 v[112:115], v9 offset:256
  s_lshr_b32 s6, s32, 2
  s_andn2_b32 s59, 1, s6
  s_add_u32 s6, s32, 1
  s_and_b32 s6, s6, 3
  s_lshl_b32 s6, s6, 19
  s_add_u32 s50, s35, s6
  s_add_u32 s51, s50, 0x2000
  v_bfe_u32 v19, v1, 4, 4
  v_and_b32 v16, 1, v19
  v_lshlrev_b32 v17, 4, v16
  v_mov_b32 v18, 0x3f80
  v_lshlrev_b32 v17, v17, v18
  v_lshrrev_b32 v18, 1, v19
  v_cmp_eq_u32 vcc, 0, v18
  s_nop 1
  v_cndmask_b32 v120, 0, v17, vcc
  v_cmp_eq_u32 vcc, 1, v18
  s_nop 1
  v_cndmask_b32 v121, 0, v17, vcc
  v_cmp_eq_u32 vcc, 2, v18
  s_nop 1
  v_cndmask_b32 v122, 0, v17, vcc
  v_cmp_eq_u32 vcc, 3, v18
  s_nop 1
  v_cndmask_b32 v123, 0, v17, vcc
  v_lshlrev_b32 v16, 5, v16
  v_bfe_u32 v17, v19, 2, 1
  v_lshl_or_b32 v16, v17, 4, v16
  v_bfe_u32 v17, v19, 1, 1
  v_lshl_or_b32 v16, v17, 3, v16
  v_lshrrev_b32 v17, 8, v1
  v_lshl_or_b32 v124, v17, 6, v16
  s_waitcnt lgkmcnt(0)
  v_bitop3_b32 v16, v52, v56, s59 bitop3:0x7e
  v_bitop3_b32 v17, v60, v64, s59 bitop3:0x7e
  v_bitop3_b32 v18, v68, v72, s59 bitop3:0x7e
  v_bitop3_b32 v19, v76, v80, s59 bitop3:0x7e
  v_or3_b32 v16, v16, v17, v18
  v_bitop3_b32 v17, v108, v112, s59 bitop3:0x7e
  v_or3_b32 v16, v16, v17, v19
  v_and_b32 v16, 1, v16
  v_cmp_ne_u32 s[60:61], 0, v16
  v_mov_b32 v19, v124
  s_cmp_lg_u32 s3, 0
  s_cbranch_scc1 L_rec_nored
  s_mov_b32 s7, 0
L_rec_rr:
  buffer_load_dwordx4 v[20:23], v1, s[8:11], s41 offen offset:0 sc1
  buffer_load_dwordx4 v[24:27], v1, s[8:11], s41 offen offset:1024 sc1
  buffer_load_dwordx4 v[28:31], v1, s[8:11], s41 offen offset:2048 sc1
  buffer_load_dwordx4 v[32:35], v1, s[8:11], s41 offen offset:3072 sc1
  buffer_load_dwordx4 v[36:39], v1, s[8:11], s42 offen offset:0 sc1
  buffer_load_dwordx4 v[40:43], v1, s[8:11], s42 offen offset:1024 sc1
  buffer_load_dwordx4 v[44:47], v1, s[8:11], s42 offen offset:2048 sc1
  buffer_load_dwordx4 v[48:51], v1, s[8:11], s42 offen offset:3072 sc1
  s_waitcnt vmcnt(7)
  v_mfma_f32_16x16x32_bf16 v[124:127], v[20:23], v[120:123], 0
  s_waitcnt vmcnt(6)
  v_mfma_f32_16x16x32_bf16 v[124:127], v[24:27], v[120:123], v[124:127]
  v_bitop3_b32 v16, v20, v24, s33 bitop3:0x7e
  s_waitcnt vmcnt(5)
  v_mfma_f32_16x16x32_bf16 v[124:127], v[28:31], v[120:123], v[124:127]
  s_waitcnt vmcnt(4)
  v_mfma_f32_16x16x32_bf16 v[124:127], v[32:35], v[120:123], v[124:127]
  v_bitop3_b32 v17, v28, v32, s33 bitop3:0x7e
  s_waitcnt vmcnt(3)
  v_mfma_f32_16x16x32_bf16 v[124:127], v[36:39], v[120:123], v[124:127]
  s_waitcnt vmcnt(2)
  v_mfma_f32_16x16x32_bf16 v[124:127], v[40:43], v[120:123], v[124:127]
  v_bitop3_b32 v18, v36, v40, s33 bitop3:0x7e
  s_waitcnt vmcnt(1)
  v_mfma_f32_16x16x32_bf16 v[124:127], v[44:47], v[120:123], v[124:127]
  v_or3_b32 v16, v16, v17, v18
  s_waitcnt vmcnt(0)
  v_mfma_f32_16x16x32_bf16 v[124:127], v[48:51], v[120:123], v[124:127]
  v_bitop3_b32 v17, v44, v48, s33 bitop3:0x7e
  v_bitop3_b32 v16, v16, v17, 1 bitop3:0xa8
  v_cmp_ne_u32 vcc, 0, v16
  s_cbranch_vccz L_rec_red
  s_and_b32 s6, s7, 31
  s_cmp_lg_u32 s6, 31
  s_cbranch_scc1 L_tf_83
  buffer_wbl2 sc1
  s_waitcnt vmcnt(0)
  buffer_inv sc1
  s_waitcnt vmcnt(0)
L_tf_83:
  s_add_u32 s7, s7, 1
  s_cmp_lt_u32 s7, 131072
  s_cbranch_scc1 L_rec_rr
  s_mov_b32 s6, 14
  s_branch L_err
L_rec_red:
  s_nop 3
  v_cvt_pk_bf16_f32 v124, v124, v125
  v_cvt_pk_bf16_f32 v125, v126, v127
  v_bfi_b32 v124, 1, s33, v124
  s_mov_b64 exec, s[54:55]
  buffer_store_dwordx2 v[124:125], v19, s[8:11], s43 offen
  s_cmp_lg_u32 s32, 63
  s_cbranch_scc1 L_rec_nl
  buffer_store_dwordx2 v[124:125], v19, s[8:11], s43 offen sc1
L_rec_nl:
  s_mov_b64 exec, -1
  s_barrier
  s_branch L_rec_loop
L_rec_nored:
  s_barrier
  s_branch L_rec_loop
L_rec_kvwait:
  s_and_b32 s6, s32, 3
  s_lshl_b32 s6, s6, 19
  s_add_u32 s6, s6, s35
  s_sub_u32 s60, s6, s53
  s_add_u32 s61, s60, 4096
  s_mov_b32 s7, 0
L_kvs_84:
  buffer_load_dwordx4 v[52:55], v4, s[8:11], s60 offen offset:0 sc1
  buffer_load_dwordx4 v[68:71], v4, s[8:11], s60 offen offset:128 sc1
  buffer_load_dwordx4 v[56:59], v4, s[8:11], s60 offen offset:2048 sc1
  buffer_load_dwordx4 v[72:75], v4, s[8:11], s60 offen offset:2176 sc1
  buffer_load_dwordx4 v[60:63], v4, s[8:11], s61 offen offset:0 sc1
  buffer_load_dwordx4 v[76:79], v4, s[8:11], s61 offen offset:128 sc1
  buffer_load_dwordx4 v[64:67], v4, s[8:11], s61 offen offset:2048 sc1
  buffer_load_dwordx4 v[80:83], v4, s[8:11], s61 offen offset:2176 sc1
  buffer_load_dwordx4 v[108:111], v9, s[8:11], s60 offen offset:0 sc1
  buffer_load_dwordx4 v[112:115], v9, s[8:11], s60 offen offset:256 sc1
L_kvt_85:
  s_waitcnt vmcnt(0)
  v_bitop3_b32 v16, v52, v56, s59 bitop3:0x7e
  v_bitop3_b32 v17, v60, v64, s59 bitop3:0x7e
  v_bitop3_b32 v18, v68, v72, s59 bitop3:0x7e
  v_bitop3_b32 v19, v76, v80, s59 bitop3:0x7e
  v_or3_b32 v16, v16, v17, v18
  v_bitop3_b32 v17, v108, v112, s59 bitop3:0x7e
  v_or3_b32 v16, v16, v17, v19
  v_and_b32 v16, 1, v16
  v_cmp_ne_u32 vcc, 0, v16
  s_cbranch_vccz L_rec_kvok
  s_add_u32 s7, s7, 1
  s_cmp_lt_u32 s7, 131072
  s_cbranch_scc1 L_kvs_84
  s_mov_b32 s6, 13
  s_branch L_err
L_rec_last:
  s_waitcnt vmcnt(0)
  s_endpgm
L_p:
  s_sub_u32 s35, s4, 2
  s_lshr_b32 s35, s35, 1
  s_and_b32 s6, s4, 1
  s_lshl_b32 s6, s6, 4
  s_and_b32 s36, s5, 15
  s_add_u32 s36, s36, s6
  s_lshr_b32 s37, s5, 4
  s_mul_i32 s38, s35, 0x200000
  s_add_u32 s38, s38, 0x0
  s_mul_i32 s39, s35, 0x2000000
  s_add_u32 s39, s39, 0x800000
  s_mul_i32 s40, s35, 0x1000000
  s_add_u32 s40, s40, 0x4800000
  s_mul_i32 s41, s35, 0x1000000
  s_add_u32 s41, s41, 0x6800000
  s_mul_i32 s44, s35, 0x800
  s_add_u32 s44, s44, 0x710000
  s_lshl_b32 s6, s3, 13
  s_add_u32 s38, s38, s6
  s_add_u32 s53, s6, 0
  s_lshl_b32 s6, s36, 14
  s_lshl_b32 s7, s3, 11
  s_add_u32 s39, s39, s6
  s_add_u32 s39, s39, s7
  s_lshl_b32 s6, s36, 12
  s_lshl_b32 s7, s3, 10
  s_add_u32 s40, s40, s6
  s_add_u32 s40, s40, s7
  s_lshl_b32 s6, s36, 13
  s_lshr_b32 s7, s3, 1
  s_lshl_b32 s7, s7, 12
  s_add_u32 s41, s41, s6
  s_add_u32 s41, s41, s7
  s_lshl_b32 s6, s35, 13
  s_lshl_b32 s7, s37, 12
  s_add_u32 s6, s6, s7
  s_lshl_b32 s7, s36, 7
  s_add_u32 s6, s6, s7
  s_lshl_b32 s7, s3, 2
  s_add_u32 s6, s6, s7
  s_add_u32 s43, s6, 0x718000
  s_mov_b32 s34, 0x3e0293ee
  v_mov_b32 v12, 0
  v_mov_b32 v13, 0
  v_mov_b32 v14, 0
  v_mov_b32 v15, 0
  v_lshlrev_b32 v16, 4, v0
  s_lshl_b32 s6, s37, 19
  s_add_u32 s6, s6, s39
  s_mov_b64 exec, 1
  buffer_store_dword v12, v12, s[8:11], s43 offen sc1
  s_mov_b64 exec, -1
  buffer_store_dwordx4 v[12:15], v16, s[8:11], s6 offen offset:0 sc1
  buffer_store_dwordx4 v[12:15], v16, s[8:11], s6 offen offset:1024 sc1
  s_add_u32 s6, s6, 8192
  buffer_store_dwordx4 v[12:15], v16, s[8:11], s6 offen offset:0 sc1
  buffer_store_dwordx4 v[12:15], v16, s[8:11], s6 offen offset:1024 sc1
  s_add_u32 s6, s6, 1040384
  buffer_store_dwordx4 v[12:15], v16, s[8:11], s6 offen offset:0 sc1
  buffer_store_dwordx4 v[12:15], v16, s[8:11], s6 offen offset:1024 sc1
  s_add_u32 s6, s6, 8192
  buffer_store_dwordx4 v[12:15], v16, s[8:11], s6 offen offset:0 sc1
  buffer_store_dwordx4 v[12:15], v16, s[8:11], s6 offen offset:1024 sc1
  s_cmp_ge_u32 s4, 4
  s_cbranch_scc1 L_pro
L_p2:
  v_mov_b32 v12, 0
  v_mov_b32 v13, 0
  v_lshlrev_b32 v0, 4, v0
  s_mov_b32 s16, s82
  s_mov_b32 s17, s83
  s_mov_b32 s18, 0x400000
  s_mov_b32 s19, 0x20000
  s_mov_b32 s20, s84
  s_mov_b32 s21, s85
  s_mov_b32 s22, 0x400000
  s_mov_b32 s23, 0x20000
  s_mov_b32 s24, s86
  s_mov_b32 s25, s87
  s_mov_b32 s26, 0x400000
  s_mov_b32 s27, 0x20000
  v_mov_b32 v80, 0x3f803f80
  v_mov_b32 v81, 0x3f803f80
  v_mov_b32 v82, 0x3f803f80
  v_mov_b32 v83, 0x3f803f80
  v_lshrrev_b32 v104, 4, v0
  v_lshrrev_b32 v100, 8, v0
  v_lshlrev_b32 v105, 2, v100
  v_and_b32 v104, 15, v104
  v_xor_b32 v104, v104, v105
  v_mul_u32_u24 v100, 8192, v100
  v_lshl_add_u32 v100, v104, 4, v100
  v_bfe_u32 v104, v0, 6, 2
  v_lshlrev_b32 v105, 2, v104
  v_bfe_u32 v106, v0, 8, 1
  v_lshlrev_b32 v106, 1, v106
  v_bfe_u32 v107, v0, 5, 1
  v_or_b32 v106, v106, v107
  s_lshl_b32 s6, s3, 2
  v_or_b32 v106, s6, v106
  v_xor_b32 v106, v106, v105
  v_lshlrev_b32 v106, 4, v106
  v_bfe_u32 v107, v0, 4, 1
  v_lshl_or_b32 v106, v107, 3, v106
  v_bfe_u32 v107, v0, 9, 1
  v_lshl_or_b32 v104, v107, 3, v104
  v_lshl_or_b32 v104, v104, 8, v106
  v_add_u32 v105, 0x10000, v104
  s_lshl_b32 s60, s3, 13
  s_mul_i32 s63, s3, 262144
  s_lshr_b32 s6, 0x72, s4
  s_bitcmp1_b32 s6, 0
  s_cbranch_scc1 L_rdn_86
  s_waitcnt vmcnt(0)
  s_barrier
  s_cmp_lg_u32 s3, 0
  s_cbranch_scc1 L_sd_87
  s_mov_b64 exec, 1
  s_and_b32 s6, s4, 3
  s_lshl_b32 s6, s6, 6
  v_mov_b32 v18, 16
  v_mov_b32 v19, 1
  buffer_atomic_add v19, v18, s[12:15], s6 offen sc1
  s_mov_b64 exec, -1
L_sd_87:
L_rdn_86:
  s_lshl_b32 s61, s36, 8
  s_add_u32 s61, s61, 0
  s_add_u32 s61, s61, s63
  s_add_u32 m0, s60, 0
  s_add_u32 s62, s61, 0
  buffer_load_dwordx4 v100, s[16:19], s62 offen lds
  s_add_u32 m0, s60, 1024
  s_add_u32 s62, s61, 32768
  buffer_load_dwordx4 v100, s[16:19], s62 offen lds
  s_add_u32 m0, s60, 2048
  s_add_u32 s62, s61, 65536
  buffer_load_dwordx4 v100, s[16:19], s62 offen lds
  s_add_u32 m0, s60, 3072
  s_add_u32 s62, s61, 98304
  buffer_load_dwordx4 v100, s[16:19], s62 offen lds
  s_add_u32 m0, s60, 4096
  s_add_u32 s62, s61, 131072
  buffer_load_dwordx4 v100, s[16:19], s62 offen lds
  s_add_u32 m0, s60, 5120
  s_add_u32 s62, s61, 163840
  buffer_load_dwordx4 v100, s[16:19], s62 offen lds
  s_add_u32 m0, s60, 6144
  s_add_u32 s62, s61, 196608
  buffer_load_dwordx4 v100, s[16:19], s62 offen lds
  s_add_u32 m0, s60, 7168
  s_add_u32 s62, s61, 229376
  buffer_load_dwordx4 v100, s[16:19], s62 offen lds
  s_lshl_b32 s61, s36, 8
  s_add_u32 s61, s61, 1048576
  s_add_u32 s61, s61, s63
  s_add_u32 m0, s60, 32768
  s_add_u32 s62, s61, 0
  buffer_load_dwordx4 v100, s[16:19], s62 offen lds
  s_add_u32 m0, s60, 33792
  s_add_u32 s62, s61, 32768
  buffer_load_dwordx4 v100, s[16:19], s62 offen lds
  s_add_u32 m0, s60, 34816
  s_add_u32 s62, s61, 65536
  buffer_load_dwordx4 v100, s[16:19], s62 offen lds
  s_add_u32 m0, s60, 35840
  s_add_u32 s62, s61, 98304
  buffer_load_dwordx4 v100, s[16:19], s62 offen lds
  s_add_u32 m0, s60, 36864
  s_add_u32 s62, s61, 131072
  buffer_load_dwordx4 v100, s[16:19], s62 offen lds
  s_add_u32 m0, s60, 37888
  s_add_u32 s62, s61, 163840
  buffer_load_dwordx4 v100, s[16:19], s62 offen lds
  s_add_u32 m0, s60, 38912
  s_add_u32 s62, s61, 196608
  buffer_load_dwordx4 v100, s[16:19], s62 offen lds
  s_add_u32 m0, s60, 39936
  s_add_u32 s62, s61, 229376
  buffer_load_dwordx4 v100, s[16:19], s62 offen lds
  s_lshl_b32 s61, s36, 8
  s_add_u32 s61, s61, 2097152
  s_add_u32 s61, s61, s63
  s_add_u32 m0, s60, 65536
  s_add_u32 s62, s61, 0
  buffer_load_dwordx4 v100, s[16:19], s62 offen lds
  s_add_u32 m0, s60, 66560
  s_add_u32 s62, s61, 32768
  buffer_load_dwordx4 v100, s[16:19], s62 offen lds
  s_add_u32 m0, s60, 67584
  s_add_u32 s62, s61, 65536
  buffer_load_dwordx4 v100, s[16:19], s62 offen lds
  s_add_u32 m0, s60, 68608
  s_add_u32 s62, s61, 98304
  buffer_load_dwordx4 v100, s[16:19], s62 offen lds
  s_add_u32 m0, s60, 69632
  s_add_u32 s62, s61, 131072
  buffer_load_dwordx4 v100, s[16:19], s62 offen lds
  s_add_u32 m0, s60, 70656
  s_add_u32 s62, s61, 163840
  buffer_load_dwordx4 v100, s[16:19], s62 offen lds
  s_add_u32 m0, s60, 71680
  s_add_u32 s62, s61, 196608
  buffer_load_dwordx4 v100, s[16:19], s62 offen lds
  s_add_u32 m0, s60, 72704
  s_add_u32 s62, s61, 229376
  buffer_load_dwordx4 v100, s[16:19], s62 offen lds
  s_waitcnt vmcnt(16)
  s_barrier
  s_lshl_b32 s61, s36, 8
  s_add_u32 s61, s61, 3145728
  s_add_u32 s61, s61, s63
  s_add_u32 m0, s60, 98304
  s_add_u32 s62, s61, 0
  buffer_load_dwordx4 v100, s[16:19], s62 offen lds
  s_add_u32 m0, s60, 99328
  s_add_u32 s62, s61, 32768
  buffer_load_dwordx4 v100, s[16:19], s62 offen lds
  s_add_u32 m0, s60, 100352
  s_add_u32 s62, s61, 65536
  buffer_load_dwordx4 v100, s[16:19], s62 offen lds
  s_add_u32 m0, s60, 101376
  s_add_u32 s62, s61, 98304
  buffer_load_dwordx4 v100, s[16:19], s62 offen lds
  s_add_u32 m0, s60, 102400
  s_add_u32 s62, s61, 131072
  buffer_load_dwordx4 v100, s[16:19], s62 offen lds
  s_add_u32 m0, s60, 103424
  s_add_u32 s62, s61, 163840
  buffer_load_dwordx4 v100, s[16:19], s62 offen lds
  s_add_u32 m0, s60, 104448
  s_add_u32 s62, s61, 196608
  buffer_load_dwordx4 v100, s[16:19], s62 offen lds
  s_add_u32 m0, s60, 105472
  s_add_u32 s62, s61, 229376
  buffer_load_dwordx4 v100, s[16:19], s62 offen lds
  ds_read_b64_tr_b16 a[0:1], v104 offset:0
  ds_read_b64_tr_b16 a[2:3], v104 offset:1024
  ds_read_b64_tr_b16 a[4:5], v104 offset:4096
  ds_read_b64_tr_b16 a[6:7], v104 offset:5120
  ds_read_b64_tr_b16 a[8:9], v104 offset:8192
  ds_read_b64_tr_b16 a[10:11], v104 offset:9216
  ds_read_b64_tr_b16 a[12:13], v104 offset:12288
  ds_read_b64_tr_b16 a[14:15], v104 offset:13312
  ds_read_b64_tr_b16 a[16:17], v104 offset:16384
  ds_read_b64_tr_b16 a[18:19], v104 offset:17408
  ds_read_b64_tr_b16 a[20:21], v104 offset:20480
  ds_read_b64_tr_b16 a[22:23], v104 offset:21504
  ds_read_b64_tr_b16 a[24:25], v104 offset:24576
  ds_read_b64_tr_b16 a[26:27], v104 offset:25600
  ds_read_b64_tr_b16 a[28:29], v104 offset:28672
  ds_read_b64_tr_b16 a[30:31], v104 offset:29696
  s_waitcnt lgkmcnt(0)
  v_mfma_f32_32x32x16_bf16 v[32:47], v[80:83], a[0:3], 0
  v_mfma_f32_32x32x16_bf16 v[32:47], v[80:83], a[4:7], v[32:47]
  v_mfma_f32_32x32x16_bf16 v[32:47], v[80:83], a[8:11], v[32:47]
  v_mfma_f32_32x32x16_bf16 v[32:47], v[80:83], a[12:15], v[32:47]
  v_mfma_f32_32x32x16_bf16 v[32:47], v[80:83], a[16:19], v[32:47]
  v_mfma_f32_32x32x16_bf16 v[32:47], v[80:83], a[20:23], v[32:47]
  v_mfma_f32_32x32x16_bf16 v[32:47], v[80:83], a[24:27], v[32:47]
  v_mfma_f32_32x32x16_bf16 v[32:47], v[80:83], a[28:31], v[32:47]
  s_waitcnt vmcnt(16)
  s_barrier
  s_lshl_b32 s61, s36, 8
  s_add_u32 s61, s61, 0
  s_add_u32 s61, s61, s63
  s_add_u32 m0, s60, 0
  s_add_u32 s62, s61, 0
  buffer_load_dwordx4 v100, s[20:23], s62 offen lds
  s_add_u32 m0, s60, 1024
  s_add_u32 s62, s61, 32768
  buffer_load_dwordx4 v100, s[20:23], s62 offen lds
  s_add_u32 m0, s60, 2048
  s_add_u32 s62, s61, 65536
  buffer_load_dwordx4 v100, s[20:23], s62 offen lds
  s_add_u32 m0, s60, 3072
  s_add_u32 s62, s61, 98304
  buffer_load_dwordx4 v100, s[20:23], s62 offen lds
  s_add_u32 m0, s60, 4096
  s_add_u32 s62, s61, 131072
  buffer_load_dwordx4 v100, s[20:23], s62 offen lds
  s_add_u32 m0, s60, 5120
  s_add_u32 s62, s61, 163840
  buffer_load_dwordx4 v100, s[20:23], s62 offen lds
  s_add_u32 m0, s60, 6144
  s_add_u32 s62, s61, 196608
  buffer_load_dwordx4 v100, s[20:23], s62 offen lds
  s_add_u32 m0, s60, 7168
  s_add_u32 s62, s61, 229376
  buffer_load_dwordx4 v100, s[20:23], s62 offen lds
  ds_read_b64_tr_b16 a[32:33], v104 offset:32768
  ds_read_b64_tr_b16 a[34:35], v104 offset:33792
  ds_read_b64_tr_b16 a[36:37], v104 offset:36864
  ds_read_b64_tr_b16 a[38:39], v104 offset:37888
  ds_read_b64_tr_b16 a[40:41], v104 offset:40960
  ds_read_b64_tr_b16 a[42:43], v104 offset:41984
  ds_read_b64_tr_b16 a[44:45], v104 offset:45056
  ds_read_b64_tr_b16 a[46:47], v104 offset:46080
  ds_read_b64_tr_b16 a[48:49], v104 offset:49152
  ds_read_b64_tr_b16 a[50:51], v104 offset:50176
  ds_read_b64_tr_b16 a[52:53], v104 offset:53248
  ds_read_b64_tr_b16 a[54:55], v104 offset:54272
  ds_read_b64_tr_b16 a[56:57], v104 offset:57344
  ds_read_b64_tr_b16 a[58:59], v104 offset:58368
  ds_read_b64_tr_b16 a[60:61], v104 offset:61440
  ds_read_b64_tr_b16 a[62:63], v104 offset:62464
  s_waitcnt lgkmcnt(0)
  v_mfma_f32_32x32x16_bf16 v[32:47], v[80:83], a[32:35], v[32:47]
  v_mfma_f32_32x32x16_bf16 v[32:47], v[80:83], a[36:39], v[32:47]
  v_mfma_f32_32x32x16_bf16 v[32:47], v[80:83], a[40:43], v[32:47]
  v_mfma_f32_32x32x16_bf16 v[32:47], v[80:83], a[44:47], v[32:47]
  v_mfma_f32_32x32x16_bf16 v[32:47], v[80:83], a[48:51], v[32:47]
  v_mfma_f32_32x32x16_bf16 v[32:47], v[80:83], a[52:55], v[32:47]
  v_mfma_f32_32x32x16_bf16 v[32:47], v[80:83], a[56:59], v[32:47]
  v_mfma_f32_32x32x16_bf16 v[32:47], v[80:83], a[60:63], v[32:47]
  s_waitcnt vmcnt(16)
  s_barrier
  s_lshl_b32 s61, s36, 8
  s_add_u32 s61, s61, 1048576
  s_add_u32 s61, s61, s63
  s_add_u32 m0, s60, 32768
  s_add_u32 s62, s61, 0
  buffer_load_dwordx4 v100, s[20:23], s62 offen lds
  s_add_u32 m0, s60, 33792
  s_add_u32 s62, s61, 32768
  buffer_load_dwordx4 v100, s[20:23], s62 offen lds
  s_add_u32 m0, s60, 34816
  s_add_u32 s62, s61, 65536
  buffer_load_dwordx4 v100, s[20:23], s62 offen lds
  s_add_u32 m0, s60, 35840
  s_add_u32 s62, s61, 98304
  buffer_load_dwordx4 v100, s[20:23], s62 offen lds
  s_add_u32 m0, s60, 36864
  s_add_u32 s62, s61, 131072
  buffer_load_dwordx4 v100, s[20:23], s62 offen lds
  s_add_u32 m0, s60, 37888
  s_add_u32 s62, s61, 163840
  buffer_load_dwordx4 v100, s[20:23], s62 offen lds
  s_add_u32 m0, s60, 38912
  s_add_u32 s62, s61, 196608
  buffer_load_dwordx4 v100, s[20:23], s62 offen lds
  s_add_u32 m0, s60, 39936
  s_add_u32 s62, s61, 229376
  buffer_load_dwordx4 v100, s[20:23], s62 offen lds
  ds_read_b64_tr_b16 a[64:65], v105 offset:0
  ds_read_b64_tr_b16 a[66:67], v105 offset:1024
  ds_read_b64_tr_b16 a[68:69], v105 offset:4096
  ds_read_b64_tr_b16 a[70:71], v105 offset:5120
  ds_read_b64_tr_b16 a[72:73], v105 offset:8192
  ds_read_b64_tr_b16 a[74:75], v105 offset:9216
  ds_read_b64_tr_b16 a[76:77], v105 offset:12288
  ds_read_b64_tr_b16 a[78:79], v105 offset:13312
  ds_read_b64_tr_b16 a[80:81], v105 offset:16384
  ds_read_b64_tr_b16 a[82:83], v105 offset:17408
  ds_read_b64_tr_b16 a[84:85], v105 offset:20480
  ds_read_b64_tr_b16 a[86:87], v105 offset:21504
  ds_read_b64_tr_b16 a[88:89], v105 offset:24576
  ds_read_b64_tr_b16 a[90:91], v105 offset:25600
  ds_read_b64_tr_b16 a[92:93], v105 offset:28672
  ds_read_b64_tr_b16 a[94:95], v105 offset:29696
  s_waitcnt lgkmcnt(0)
  v_mfma_f32_32x32x16_bf16 v[32:47], v[80:83], a[64:67], v[32:47]
  v_mfma_f32_32x32x16_bf16 v[32:47], v[80:83], a[68:71], v[32:47]
  v_mfma_f32_32x32x16_bf16 v[32:47], v[80:83], a[72:75], v[32:47]
  v_mfma_f32_32x32x16_bf16 v[32:47], v[80:83], a[76:79], v[32:47]
  v_mfma_f32_32x32x16_bf16 v[32:47], v[80:83], a[80:83], v[32:47]
  v_mfma_f32_32x32x16_bf16 v[32:47], v[80:83], a[84:87], v[32:47]
  v_mfma_f32_32x32x16_bf16 v[32:47], v[80:83], a[88:91], v[32:47]
  v_mfma_f32_32x32x16_bf16 v[32:47], v[80:83], a[92:95], v[32:47]
  s_waitcnt vmcnt(16)
  s_barrier
  s_lshl_b32 s61, s36, 8
  s_add_u32 s61, s61, 2097152
  s_add_u32 s61, s61, s63
  s_add_u32 m0, s60, 65536
  s_add_u32 s62, s61, 0
  buffer_load_dwordx4 v100, s[20:23], s62 offen lds
  s_add_u32 m0, s60, 66560
  s_add_u32 s62, s61, 32768
  buffer_load_dwordx4 v100, s[20:23], s62 offen lds
  s_add_u32 m0, s60, 67584
  s_add_u32 s62, s61, 65536
  buffer_load_dwordx4 v100, s[20:23], s62 offen lds
  s_add_u32 m0, s60, 68608
  s_add_u32 s62, s61, 98304
  buffer_load_dwordx4 v100, s[20:23], s62 offen lds
  s_add_u32 m0, s60, 69632
  s_add_u32 s62, s61, 131072
  buffer_load_dwordx4 v100, s[20:23], s62 offen lds
  s_add_u32 m0, s60, 70656
  s_add_u32 s62, s61, 163840
  buffer_load_dwordx4 v100, s[20:23], s62 offen lds
  s_add_u32 m0, s60, 71680
  s_add_u32 s62, s61, 196608
  buffer_load_dwordx4 v100, s[20:23], s62 offen lds
  s_add_u32 m0, s60, 72704
  s_add_u32 s62, s61, 229376
  buffer_load_dwordx4 v100, s[20:23], s62 offen lds
  ds_read_b64_tr_b16 a[96:97], v105 offset:32768
  ds_read_b64_tr_b16 a[98:99], v105 offset:33792
  ds_read_b64_tr_b16 a[100:101], v105 offset:36864
  ds_read_b64_tr_b16 a[102:103], v105 offset:37888
  ds_read_b64_tr_b16 a[104:105], v105 offset:40960
  ds_read_b64_tr_b16 a[106:107], v105 offset:41984
  ds_read_b64_tr_b16 a[108:109], v105 offset:45056
  ds_read_b64_tr_b16 a[110:111], v105 offset:46080
  ds_read_b64_tr_b16 a[112:113], v105 offset:49152
  ds_read_b64_tr_b16 a[114:115], v105 offset:50176
  ds_read_b64_tr_b16 a[116:117], v105 offset:53248
  ds_read_b64_tr_b16 a[118:119], v105 offset:54272
  ds_read_b64_tr_b16 a[120:121], v105 offset:57344
  ds_read_b64_tr_b16 a[122:123], v105 offset:58368
  ds_read_b64_tr_b16 a[124:125], v105 offset:61440
  ds_read_b64_tr_b16 a[126:127], v105 offset:62464
  s_waitcnt lgkmcnt(0)
  v_mfma_f32_32x32x16_bf16 v[32:47], v[80:83], a[96:99], v[32:47]
  v_mfma_f32_32x32x16_bf16 v[32:47], v[80:83], a[100:103], v[32:47]
  v_mfma_f32_32x32x16_bf16 v[32:47], v[80:83], a[104:107], v[32:47]
  v_mfma_f32_32x32x16_bf16 v[32:47], v[80:83], a[108:111], v[32:47]
  v_mfma_f32_32x32x16_bf16 v[32:47], v[80:83], a[112:115], v[32:47]
  v_mfma_f32_32x32x16_bf16 v[32:47], v[80:83], a[116:119], v[32:47]
  v_mfma_f32_32x32x16_bf16 v[32:47], v[80:83], a[120:123], v[32:47]
  v_mfma_f32_32x32x16_bf16 v[32:47], v[80:83], a[124:127], v[32:47]
  s_waitcnt vmcnt(16)
  s_barrier
  s_lshl_b32 s61, s36, 8
  s_add_u32 s61, s61, 3145728
  s_add_u32 s61, s61, s63
  s_add_u32 m0, s60, 98304
  s_add_u32 s62, s61, 0
  buffer_load_dwordx4 v100, s[20:23], s62 offen lds
  s_add_u32 m0, s60, 99328
  s_add_u32 s62, s61, 32768
  buffer_load_dwordx4 v100, s[20:23], s62 offen lds
  s_add_u32 m0, s60, 100352
  s_add_u32 s62, s61, 65536
  buffer_load_dwordx4 v100, s[20:23], s62 offen lds
  s_add_u32 m0, s60, 101376
  s_add_u32 s62, s61, 98304
  buffer_load_dwordx4 v100, s[20:23], s62 offen lds
  s_add_u32 m0, s60, 102400
  s_add_u32 s62, s61, 131072
  buffer_load_dwordx4 v100, s[20:23], s62 offen lds
  s_add_u32 m0, s60, 103424
  s_add_u32 s62, s61, 163840
  buffer_load_dwordx4 v100, s[20:23], s62 offen lds
  s_add_u32 m0, s60, 104448
  s_add_u32 s62, s61, 196608
  buffer_load_dwordx4 v100, s[20:23], s62 offen lds
  s_add_u32 m0, s60, 105472
  s_add_u32 s62, s61, 229376
  buffer_load_dwordx4 v100, s[20:23], s62 offen lds
  ds_read_b64_tr_b16 a[128:129], v104 offset:0
  ds_read_b64_tr_b16 a[130:131], v104 offset:1024
  ds_read_b64_tr_b16 a[132:133], v104 offset:4096
  ds_read_b64_tr_b16 a[134:135], v104 offset:5120
  ds_read_b64_tr_b16 a[136:137], v104 offset:8192
  ds_read_b64_tr_b16 a[138:139], v104 offset:9216
  ds_read_b64_tr_b16 a[140:141], v104 offset:12288
  ds_read_b64_tr_b16 a[142:143], v104 offset:13312
  ds_read_b64_tr_b16 a[144:145], v104 offset:16384
  ds_read_b64_tr_b16 a[146:147], v104 offset:17408
  ds_read_b64_tr_b16 a[148:149], v104 offset:20480
  ds_read_b64_tr_b16 a[150:151], v104 offset:21504
  ds_read_b64_tr_b16 a[152:153], v104 offset:24576
  ds_read_b64_tr_b16 a[154:155], v104 offset:25600
  ds_read_b64_tr_b16 a[156:157], v104 offset:28672
  ds_read_b64_tr_b16 a[158:159], v104 offset:29696
  s_waitcnt lgkmcnt(0)
  v_mfma_f32_32x32x16_bf16 v[48:63], v[80:83], a[128:131], 0
  v_mfma_f32_32x32x16_bf16 v[48:63], v[80:83], a[132:135], v[48:63]
  v_mfma_f32_32x32x16_bf16 v[48:63], v[80:83], a[136:139], v[48:63]
  v_mfma_f32_32x32x16_bf16 v[48:63], v[80:83], a[140:143], v[48:63]
  v_mfma_f32_32x32x16_bf16 v[48:63], v[80:83], a[144:147], v[48:63]
  v_mfma_f32_32x32x16_bf16 v[48:63], v[80:83], a[148:151], v[48:63]
  v_mfma_f32_32x32x16_bf16 v[48:63], v[80:83], a[152:155], v[48:63]
  v_mfma_f32_32x32x16_bf16 v[48:63], v[80:83], a[156:159], v[48:63]
  s_waitcnt vmcnt(16)
  s_barrier
  s_lshl_b32 s61, s36, 8
  s_add_u32 s61, s61, 0
  s_add_u32 s61, s61, s63
  s_add_u32 m0, s60, 0
  s_add_u32 s62, s61, 0
  buffer_load_dwordx4 v100, s[24:27], s62 offen lds
  s_add_u32 m0, s60, 1024
  s_add_u32 s62, s61, 32768
  buffer_load_dwordx4 v100, s[24:27], s62 offen lds
  s_add_u32 m0, s60, 2048
  s_add_u32 s62, s61, 65536
  buffer_load_dwordx4 v100, s[24:27], s62 offen lds
  s_add_u32 m0, s60, 3072
  s_add_u32 s62, s61, 98304
  buffer_load_dwordx4 v100, s[24:27], s62 offen lds
  s_add_u32 m0, s60, 4096
  s_add_u32 s62, s61, 131072
  buffer_load_dwordx4 v100, s[24:27], s62 offen lds
  s_add_u32 m0, s60, 5120
  s_add_u32 s62, s61, 163840
  buffer_load_dwordx4 v100, s[24:27], s62 offen lds
  s_add_u32 m0, s60, 6144
  s_add_u32 s62, s61, 196608
  buffer_load_dwordx4 v100, s[24:27], s62 offen lds
  s_add_u32 m0, s60, 7168
  s_add_u32 s62, s61, 229376
  buffer_load_dwordx4 v100, s[24:27], s62 offen lds
  ds_read_b64_tr_b16 a[160:161], v104 offset:32768
  ds_read_b64_tr_b16 a[162:163], v104 offset:33792
  ds_read_b64_tr_b16 a[164:165], v104 offset:36864
  ds_read_b64_tr_b16 a[166:167], v104 offset:37888
  ds_read_b64_tr_b16 a[168:169], v104 offset:40960
  ds_read_b64_tr_b16 a[170:171], v104 offset:41984
  ds_read_b64_tr_b16 a[172:173], v104 offset:45056
  ds_read_b64_tr_b16 a[174:175], v104 offset:46080
  ds_read_b64_tr_b16 a[176:177], v104 offset:49152
  ds_read_b64_tr_b16 a[178:179], v104 offset:50176
  ds_read_b64_tr_b16 a[180:181], v104 offset:53248
  ds_read_b64_tr_b16 a[182:183], v104 offset:54272
  ds_read_b64_tr_b16 a[184:185], v104 offset:57344
  ds_read_b64_tr_b16 a[186:187], v104 offset:58368
  ds_read_b64_tr_b16 a[188:189], v104 offset:61440
  ds_read_b64_tr_b16 a[190:191], v104 offset:62464
  s_waitcnt lgkmcnt(0)
  v_mfma_f32_32x32x16_bf16 v[48:63], v[80:83], a[160:163], v[48:63]
  v_mfma_f32_32x32x16_bf16 v[48:63], v[80:83], a[164:167], v[48:63]
  v_mfma_f32_32x32x16_bf16 v[48:63], v[80:83], a[168:171], v[48:63]
  v_mfma_f32_32x32x16_bf16 v[48:63], v[80:83], a[172:175], v[48:63]
  v_mfma_f32_32x32x16_bf16 v[48:63], v[80:83], a[176:179], v[48:63]
  v_mfma_f32_32x32x16_bf16 v[48:63], v[80:83], a[180:183], v[48:63]
  v_mfma_f32_32x32x16_bf16 v[48:63], v[80:83], a[184:187], v[48:63]
  v_mfma_f32_32x32x16_bf16 v[48:63], v[80:83], a[188:191], v[48:63]
  s_waitcnt vmcnt(16)
  s_barrier
  s_lshl_b32 s61, s36, 8
  s_add_u32 s61, s61, 1048576
  s_add_u32 s61, s61, s63
  s_add_u32 m0, s60, 32768
  s_add_u32 s62, s61, 0
  buffer_load_dwordx4 v100, s[24:27], s62 offen lds
  s_add_u32 m0, s60, 33792
  s_add_u32 s62, s61, 32768
  buffer_load_dwordx4 v100, s[24:27], s62 offen lds
  s_add_u32 m0, s60, 34816
  s_add_u32 s62, s61, 65536
  buffer_load_dwordx4 v100, s[24:27], s62 offen lds
  s_add_u32 m0, s60, 35840
  s_add_u32 s62, s61, 98304
  buffer_load_dwordx4 v100, s[24:27], s62 offen lds
  s_add_u32 m0, s60, 36864
  s_add_u32 s62, s61, 131072
  buffer_load_dwordx4 v100, s[24:27], s62 offen lds
  s_add_u32 m0, s60, 37888
  s_add_u32 s62, s61, 163840
  buffer_load_dwordx4 v100, s[24:27], s62 offen lds
  s_add_u32 m0, s60, 38912
  s_add_u32 s62, s61, 196608
  buffer_load_dwordx4 v100, s[24:27], s62 offen lds
  s_add_u32 m0, s60, 39936
  s_add_u32 s62, s61, 229376
  buffer_load_dwordx4 v100, s[24:27], s62 offen lds
  ds_read_b64_tr_b16 a[192:193], v105 offset:0
  ds_read_b64_tr_b16 a[194:195], v105 offset:1024
  ds_read_b64_tr_b16 a[196:197], v105 offset:4096
  ds_read_b64_tr_b16 a[198:199], v105 offset:5120
  ds_read_b64_tr_b16 a[200:201], v105 offset:8192
  ds_read_b64_tr_b16 a[202:203], v105 offset:9216
  ds_read_b64_tr_b16 a[204:205], v105 offset:12288
  ds_read_b64_tr_b16 a[206:207], v105 offset:13312
  ds_read_b64_tr_b16 a[208:209], v105 offset:16384
  ds_read_b64_tr_b16 a[210:211], v105 offset:17408
  ds_read_b64_tr_b16 a[212:213], v105 offset:20480
  ds_read_b64_tr_b16 a[214:215], v105 offset:21504
  ds_read_b64_tr_b16 a[216:217], v105 offset:24576
  ds_read_b64_tr_b16 a[218:219], v105 offset:25600
  ds_read_b64_tr_b16 a[220:221], v105 offset:28672
  ds_read_b64_tr_b16 a[222:223], v105 offset:29696
  s_waitcnt lgkmcnt(0)
  v_mfma_f32_32x32x16_bf16 v[48:63], v[80:83], a[192:195], v[48:63]
  v_mfma_f32_32x32x16_bf16 v[48:63], v[80:83], a[196:199], v[48:63]
  v_mfma_f32_32x32x16_bf16 v[48:63], v[80:83], a[200:203], v[48:63]
  v_mfma_f32_32x32x16_bf16 v[48:63], v[80:83], a[204:207], v[48:63]
  v_mfma_f32_32x32x16_bf16 v[48:63], v[80:83], a[208:211], v[48:63]
  v_mfma_f32_32x32x16_bf16 v[48:63], v[80:83], a[212:215], v[48:63]
  v_mfma_f32_32x32x16_bf16 v[48:63], v[80:83], a[216:219], v[48:63]
  v_mfma_f32_32x32x16_bf16 v[48:63], v[80:83], a[220:223], v[48:63]
  s_waitcnt vmcnt(16)
  s_barrier
  s_lshl_b32 s61, s36, 8
  s_add_u32 s61, s61, 2097152
  s_add_u32 s61, s61, s63
  s_add_u32 m0, s60, 65536
  s_add_u32 s62, s61, 0
  buffer_load_dwordx4 v100, s[24:27], s62 offen lds
  s_add_u32 m0, s60, 66560
  s_add_u32 s62, s61, 32768
  buffer_load_dwordx4 v100, s[24:27], s62 offen lds
  s_add_u32 m0, s60, 67584
  s_add_u32 s62, s61, 65536
  buffer_load_dwordx4 v100, s[24:27], s62 offen lds
  s_add_u32 m0, s60, 68608
  s_add_u32 s62, s61, 98304
  buffer_load_dwordx4 v100, s[24:27], s62 offen lds
  s_add_u32 m0, s60, 69632
  s_add_u32 s62, s61, 131072
  buffer_load_dwordx4 v100, s[24:27], s62 offen lds
  s_add_u32 m0, s60, 70656
  s_add_u32 s62, s61, 163840
  buffer_load_dwordx4 v100, s[24:27], s62 offen lds
  s_add_u32 m0, s60, 71680
  s_add_u32 s62, s61, 196608
  buffer_load_dwordx4 v100, s[24:27], s62 offen lds
  s_add_u32 m0, s60, 72704
  s_add_u32 s62, s61, 229376
  buffer_load_dwordx4 v100, s[24:27], s62 offen lds
  ds_read_b64_tr_b16 a[224:225], v105 offset:32768
  ds_read_b64_tr_b16 a[226:227], v105 offset:33792
  ds_read_b64_tr_b16 a[228:229], v105 offset:36864
  ds_read_b64_tr_b16 a[230:231], v105 offset:37888
  ds_read_b64_tr_b16 a[232:233], v105 offset:40960
  ds_read_b64_tr_b16 a[234:235], v105 offset:41984
  ds_read_b64_tr_b16 a[236:237], v105 offset:45056
  ds_read_b64_tr_b16 a[238:239], v105 offset:46080
  ds_read_b64_tr_b16 a[240:241], v105 offset:49152
  ds_read_b64_tr_b16 a[242:243], v105 offset:50176
  ds_read_b64_tr_b16 a[244:245], v105 offset:53248
  ds_read_b64_tr_b16 a[246:247], v105 offset:54272
  ds_read_b64_tr_b16 a[248:249], v105 offset:57344
  ds_read_b64_tr_b16 a[250:251], v105 offset:58368
  ds_read_b64_tr_b16 a[252:253], v105 offset:61440
  ds_read_b64_tr_b16 a[254:255], v105 offset:62464
  s_waitcnt lgkmcnt(0)
  v_mfma_f32_32x32x16_bf16 v[48:63], v[80:83], a[224:227], v[48:63]
  v_mfma_f32_32x32x16_bf16 v[48:63], v[80:83], a[228:231], v[48:63]
  v_mfma_f32_32x32x16_bf16 v[48:63], v[80:83], a[232:235], v[48:63]
  v_mfma_f32_32x32x16_bf16 v[48:63], v[80:83], a[236:239], v[48:63]
  v_mfma_f32_32x32x16_bf16 v[48:63], v[80:83], a[240:243], v[48:63]
  v_mfma_f32_32x32x16_bf16 v[48:63], v[80:83], a[244:247], v[48:63]
  v_mfma_f32_32x32x16_bf16 v[48:63], v[80:83], a[248:251], v[48:63]
  v_mfma_f32_32x32x16_bf16 v[48:63], v[80:83], a[252:255], v[48:63]
  s_waitcnt vmcnt(16)
  s_barrier
  s_lshl_b32 s61, s36, 8
  s_add_u32 s61, s61, 3145728
  s_add_u32 s61, s61, s63
  s_add_u32 m0, s60, 98304
  s_add_u32 s62, s61, 0
  buffer_load_dwordx4 v100, s[24:27], s62 offen lds
  s_add_u32 m0, s60, 99328
  s_add_u32 s62, s61, 32768
  buffer_load_dwordx4 v100, s[24:27], s62 offen lds
  s_add_u32 m0, s60, 100352
  s_add_u32 s62, s61, 65536
  buffer_load_dwordx4 v100, s[24:27], s62 offen lds
  s_add_u32 m0, s60, 101376
  s_add_u32 s62, s61, 98304
  buffer_load_dwordx4 v100, s[24:27], s62 offen lds
  s_add_u32 m0, s60, 102400
  s_add_u32 s62, s61, 131072
  buffer_load_dwordx4 v100, s[24:27], s62 offen lds
  s_add_u32 m0, s60, 103424
  s_add_u32 s62, s61, 163840
  buffer_load_dwordx4 v100, s[24:27], s62 offen lds
  s_add_u32 m0, s60, 104448
  s_add_u32 s62, s61, 196608
  buffer_load_dwordx4 v100, s[24:27], s62 offen lds
  s_add_u32 m0, s60, 105472
  s_add_u32 s62, s61, 229376
  buffer_load_dwordx4 v100, s[24:27], s62 offen lds
  ds_read_b64_tr_b16 v[128:129], v104 offset:0
  ds_read_b64_tr_b16 v[130:131], v104 offset:1024
  ds_read_b64_tr_b16 v[132:133], v104 offset:4096
  ds_read_b64_tr_b16 v[134:135], v104 offset:5120
  ds_read_b64_tr_b16 v[136:137], v104 offset:8192
  ds_read_b64_tr_b16 v[138:139], v104 offset:9216
  ds_read_b64_tr_b16 v[140:141], v104 offset:12288
  ds_read_b64_tr_b16 v[142:143], v104 offset:13312
  ds_read_b64_tr_b16 v[144:145], v104 offset:16384
  ds_read_b64_tr_b16 v[146:147], v104 offset:17408
  ds_read_b64_tr_b16 v[148:149], v104 offset:20480
  ds_read_b64_tr_b16 v[150:151], v104 offset:21504
  ds_read_b64_tr_b16 v[152:153], v104 offset:24576
  ds_read_b64_tr_b16 v[154:155], v104 offset:25600
  ds_read_b64_tr_b16 v[156:157], v104 offset:28672
  ds_read_b64_tr_b16 v[158:159], v104 offset:29696
  s_waitcnt lgkmcnt(0)
  v_mfma_f32_32x32x16_bf16 v[64:79], v[80:83], v[128:131], 0
  v_mfma_f32_32x32x16_bf16 v[64:79], v[80:83], v[132:135], v[64:79]
  v_mfma_f32_32x32x16_bf16 v[64:79], v[80:83], v[136:139], v[64:79]
  v_mfma_f32_32x32x16_bf16 v[64:79], v[80:83], v[140:143], v[64:79]
  v_mfma_f32_32x32x16_bf16 v[64:79], v[80:83], v[144:147], v[64:79]
  v_mfma_f32_32x32x16_bf16 v[64:79], v[80:83], v[148:151], v[64:79]
  v_mfma_f32_32x32x16_bf16 v[64:79], v[80:83], v[152:155], v[64:79]
  v_mfma_f32_32x32x16_bf16 v[64:79], v[80:83], v[156:159], v[64:79]
  s_waitcnt vmcnt(16)
  s_barrier
  ds_read_b64_tr_b16 v[160:161], v104 offset:32768
  ds_read_b64_tr_b16 v[162:163], v104 offset:33792
  ds_read_b64_tr_b16 v[164:165], v104 offset:36864
  ds_read_b64_tr_b16 v[166:167], v104 offset:37888
  ds_read_b64_tr_b16 v[168:169], v104 offset:40960
  ds_read_b64_tr_b16 v[170:171], v104 offset:41984
  ds_read_b64_tr_b16 v[172:173], v104 offset:45056
  ds_read_b64_tr_b16 v[174:175], v104 offset:46080
  ds_read_b64_tr_b16 v[176:177], v104 offset:49152
  ds_read_b64_tr_b16 v[178:179], v104 offset:50176
  ds_read_b64_tr_b16 v[180:181], v104 offset:53248
  ds_read_b64_tr_b16 v[182:183], v104 offset:54272
  ds_read_b64_tr_b16 v[184:185], v104 offset:57344
  ds_read_b64_tr_b16 v[186:187], v104 offset:58368
  ds_read_b64_tr_b16 v[188:189], v104 offset:61440
  ds_read_b64_tr_b16 v[190:191], v104 offset:62464
  s_waitcnt lgkmcnt(0)
  v_mfma_f32_32x32x16_bf16 v[64:79], v[80:83], v[160:163], v[64:79]
  v_mfma_f32_32x32x16_bf16 v[64:79], v[80:83], v[164:167], v[64:79]
  v_mfma_f32_32x32x16_bf16 v[64:79], v[80:83], v[168:171], v[64:79]
  v_mfma_f32_32x32x16_bf16 v[64:79], v[80:83], v[172:175], v[64:79]
  v_mfma_f32_32x32x16_bf16 v[64:79], v[80:83], v[176:179], v[64:79]
  v_mfma_f32_32x32x16_bf16 v[64:79], v[80:83], v[180:183], v[64:79]
  v_mfma_f32_32x32x16_bf16 v[64:79], v[80:83], v[184:187], v[64:79]
  v_mfma_f32_32x32x16_bf16 v[64:79], v[80:83], v[188:191], v[64:79]
  s_waitcnt vmcnt(8)
  s_barrier
  ds_read_b64_tr_b16 v[192:193], v105 offset:0
  ds_read_b64_tr_b16 v[194:195], v105 offset:1024
  ds_read_b64_tr_b16 v[196:197], v105 offset:4096
  ds_read_b64_tr_b16 v[198:199], v105 offset:5120
  ds_read_b64_tr_b16 v[200:201], v105 offset:8192
  ds_read_b64_tr_b16 v[202:203], v105 offset:9216
  ds_read_b64_tr_b16 v[204:205], v105 offset:12288
  ds_read_b64_tr_b16 v[206:207], v105 offset:13312
  ds_read_b64_tr_b16 v[208:209], v105 offset:16384
  ds_read_b64_tr_b16 v[210:211], v105 offset:17408
  ds_read_b64_tr_b16 v[212:213], v105 offset:20480
  ds_read_b64_tr_b16 v[214:215], v105 offset:21504
  ds_read_b64_tr_b16 v[216:217], v105 offset:24576
  ds_read_b64_tr_b16 v[218:219], v105 offset:25600
  ds_read_b64_tr_b16 v[220:221], v105 offset:28672
  ds_read_b64_tr_b16 v[222:223], v105 offset:29696
  s_waitcnt lgkmcnt(0)
  v_mfma_f32_32x32x16_bf16 v[64:79], v[80:83], v[192:195], v[64:79]
  v_mfma_f32_32x32x16_bf16 v[64:79], v[80:83], v[196:199], v[64:79]
  v_mfma_f32_32x32x16_bf16 v[64:79], v[80:83], v[200:203], v[64:79]
  v_mfma_f32_32x32x16_bf16 v[64:79], v[80:83], v[204:207], v[64:79]
  v_mfma_f32_32x32x16_bf16 v[64:79], v[80:83], v[208:211], v[64:79]
  v_mfma_f32_32x32x16_bf16 v[64:79], v[80:83], v[212:215], v[64:79]
  v_mfma_f32_32x32x16_bf16 v[64:79], v[80:83], v[216:219], v[64:79]
  v_mfma_f32_32x32x16_bf16 v[64:79], v[80:83], v[220:223], v[64:79]
  s_waitcnt vmcnt(0)
  s_barrier
  ds_read_b64_tr_b16 v[224:225], v105 offset:32768
  ds_read_b64_tr_b16 v[226:227], v105 offset:33792
  ds_read_b64_tr_b16 v[228:229], v105 offset:36864
  ds_read_b64_tr_b16 v[230:231], v105 offset:37888
  ds_read_b64_tr_b16 v[232:233], v105 offset:40960
  ds_read_b64_tr_b16 v[234:235], v105 offset:41984
  ds_read_b64_tr_b16 v[236:237], v105 offset:45056
  ds_read_b64_tr_b16 v[238:239], v105 offset:46080
  ds_read_b64_tr_b16 v[240:241], v105 offset:49152
  ds_read_b64_tr_b16 v[242:243], v105 offset:50176
  ds_read_b64_tr_b16 v[244:245], v105 offset:53248
  ds_read_b64_tr_b16 v[246:247], v105 offset:54272
  ds_read_b64_tr_b16 v[248:249], v105 offset:57344
  ds_read_b64_tr_b16 v[250:251], v105 offset:58368
  ds_read_b64_tr_b16 v[252:253], v105 offset:61440
  ds_read_b64_tr_b16 v[254:255], v105 offset:62464
  s_waitcnt lgkmcnt(0)
  v_mfma_f32_32x32x16_bf16 v[64:79], v[80:83], v[224:227], v[64:79]
  v_mfma_f32_32x32x16_bf16 v[64:79], v[80:83], v[228:231], v[64:79]
  v_mfma_f32_32x32x16_bf16 v[64:79], v[80:83], v[232:235], v[64:79]
  v_mfma_f32_32x32x16_bf16 v[64:79], v[80:83], v[236:239], v[64:79]
  v_mfma_f32_32x32x16_bf16 v[64:79], v[80:83], v[240:243], v[64:79]
  v_mfma_f32_32x32x16_bf16 v[64:79], v[80:83], v[244:247], v[64:79]
  v_mfma_f32_32x32x16_bf16 v[64:79], v[80:83], v[248:251], v[64:79]
  v_mfma_f32_32x32x16_bf16 v[64:79], v[80:83], v[252:255], v[64:79]
  s_barrier
  v_bfe_u32 v16, v0, 4, 4
  v_lshrrev_b32 v17, 8, v0
  v_lshrrev_b32 v114, 2, v0
  v_bfe_u32 v18, v0, 6, 2
  v_lshrrev_b32 v19, 9, v0
  v_lshl_or_b32 v18, v19, 3, v18
  v_lshlrev_b32 v18, 6, v18
  v_and_b32 v20, 1, v17
  v_lshl_or_b32 v18, v20, 5, v18
  v_and_b32 v20, 3, v16
  v_lshl_or_b32 v1, v20, 3, v18
  v_and_b32 v18, 7, v16
  v_lshrrev_b32 v20, 3, v16
  v_lshl_or_b32 v18, v20, 4, v18
  v_lshlrev_b32 v18, 4, v18
  v_lshl_add_u32 v18, v17, 9, v18
  v_add_u32 v2, 73728, v18
  s_and_b32 s6, s3, 1
  s_lshl_b32 s6, s6, 8
  v_lshlrev_b32 v18, 4, v16
  v_lshl_or_b32 v18, v17, 9, v18
  v_add_u32 v113, s6, v18
  v_add_u32 v3, 65536, v113
  s_lshr_b32 s7, s3, 1
  s_lshl_b32 s6, s7, 12
  s_add_u32 s6, s6, 81920
  v_add_u32 v4, s6, v18
  s_lshl_b32 s6, s3, 11
  s_add_u32 s6, s6, 32768
  v_add_u32 v112, s6, v0
  v_mul_u32_u24 v18, 1088, v17
  v_lshl_add_u32 v18, v16, 3, v18
  s_lshl_b32 s6, s3, 8
  s_add_u32 s6, s6, 57344
  v_add_u32 v5, s6, v18
  s_lshl_b32 s6, s7, 9
  s_add_u32 s6, s6, 57344
  v_add_u32 v7, s6, v18
  v_and_b32 v18, 3, v16
  v_mul_u32_u24 v18, 1088, v18
  v_bfe_u32 v20, v0, 6, 3
  v_lshl_add_u32 v18, v20, 3, v18
  v_lshl_add_u32 v18, v19, 7, v18
  v_add_u32 v6, 57344, v18
  s_lshl_b32 s6, s3, 7
  s_add_u32 s6, s6, 61952
  v_lshlrev_b32 v18, 4, v19
  v_add_u32 v8, s6, v18
  v_and_b32 v18, 0x7c, v114
  v_add_u32 v9, s6, v18
  v_lshlrev_b32 v18, 1, v18
  v_add_u32 v15, 62464, v18
  s_lshl_b32 s6, s3, 13
  v_add_u32 v14, s6, v1
  v_mov_b32 v10, 0x3f803f80
  v_mov_b32 v11, 0x3f803f80
  s_and_b32 s6, s3, 1
  s_lshl_b32 s6, s6, 4
  v_add_u32 v16, s6, v16
  v_lshlrev_b32 v18, 4, v19
  v_and_b32 v20, 1, v17
  v_lshl_or_b32 v18, v20, 2, v18
  v_sub_u32 v16, v16, v18
  v_mov_b32 v17, 0xf149f2ca
  v_cmp_gt_i32 vcc, 0, v16
  s_nop 1
  v_cndmask_b32 v24, 0, v17, vcc
  v_cmp_gt_i32 vcc, 1, v16
  s_nop 1
  v_cndmask_b32 v25, 0, v17, vcc
  v_cmp_gt_i32 vcc, 2, v16
  s_nop 1
  v_cndmask_b32 v26, 0, v17, vcc
  v_cmp_gt_i32 vcc, 3, v16
  s_nop 1
  v_cndmask_b32 v27, 0, v17, vcc
  v_cmp_gt_i32 vcc, 8, v16
  s_nop 1
  v_cndmask_b32 v28, 0, v17, vcc
  v_cmp_gt_i32 vcc, 9, v16
  s_nop 1
  v_cndmask_b32 v29, 0, v17, vcc
  v_cmp_gt_i32 vcc, 10, v16
  s_nop 1
  v_cndmask_b32 v30, 0, v17, vcc
  v_cmp_gt_i32 vcc, 11, v16
  s_nop 1
  v_cndmask_b32 v31, 0, v17, vcc
  v_cmp_gt_u32 vcc, 512, v0
  v_cvt_pk_bf16_f32 v33, v32, v32
  v_and_b32 v33, 0xffff0000, v33
  v_sub_f32 v32, v32, v33
  v_cvt_pk_bf16_f32 v32, v32, v33
  v_cndmask_b32 v16, 0, v32, vcc
  v_cvt_pk_bf16_f32 v49, v48, v48
  v_and_b32 v49, 0xffff0000, v49
  v_sub_f32 v48, v48, v49
  v_cvt_pk_bf16_f32 v48, v48, v49
  v_cndmask_b32 v17, 0, v48, vcc
  v_cvt_pk_bf16_f32 v65, v64, v64
  v_and_b32 v65, 0xffff0000, v65
  v_sub_f32 v64, v64, v65
  v_cvt_pk_bf16_f32 v64, v64, v65
  v_cndmask_b32 v18, 0, v64, vcc
  v_mov_b32 v19, 0
  v_mov_b32 v21, 0
  v_mov_b32 v22, 0
  s_mov_b32 s7, 0
  v_mbcnt_lo_u32_b32 v92, -1, 0
  v_and_b32 v92, 3, v92
  v_lshlrev_b32 v92, 6, v92
L_wd_88:
  buffer_load_dword v93, v92, s[12:15], 0 offen offset:16 sc1
  s_waitcnt vmcnt(0)
  v_cmp_ne_u32 vcc, 64, v93
  s_cbranch_vccz L_wdo_89
  s_add_u32 s7, s7, 1
  s_cmp_lt_u32 s7, 131072
  s_cbranch_scc1 L_wd_88
  s_mov_b32 s6, 20
  s_branch L_err
L_wdo_89:
  s_mov_b32 s32, 0
  s_mov_b32 s52, 0
  s_mov_b32 s33, s37
  s_add_u32 s49, s33, 1
  s_cmp_lg_u32 s35, 0
  s_cbranch_scc1 L_p1_90
  s_mov_b32 s7, 0
L_pl_91:
  buffer_load_dwordx4 v[32:35], v0, s[8:11], s44 offen offset:0 sc1
  buffer_load_dwordx4 v[36:39], v0, s[8:11], s44 offen offset:1024 sc1
  s_waitcnt vmcnt(0)
  v_min3_u32 v32, v32, v33, v34
  v_min3_u32 v35, v35, v36, v37
  v_min3_u32 v32, v32, v38, v39
  v_min_u32 v32, v32, v35
  v_cmp_gt_u32 vcc, s49, v32
  s_cbranch_vccz L_plo_92
  s_add_u32 s7, s7, 1
  s_cmp_lt_u32 s7, 131072
  s_cbranch_scc1 L_pl_91
  s_mov_b32 s6, 21
  s_branch L_err
L_plo_92:
L_p1_90:
L_p_xwait:
  s_mov_b32 s7, 0
L_pl_93:
  buffer_load_dword v92, v114, s[8:11], s44 offen offset:0 sc1
  s_waitcnt vmcnt(0)
  v_cmp_gt_u32 vcc, s49, v92
  s_cbranch_vccz L_plo_94
  s_add_u32 s7, s7, 1
  s_cmp_lt_u32 s7, 131072
  s_cbranch_scc1 L_pl_93
  s_mov_b32 s6, 22
  s_branch L_err
L_plo_94:
  s_sub_u32 s6, s49, 1
  s_lshl_b32 s6, s6, 15
  s_add_u32 s45, s38, s6
  s_mov_b32 m0, s53
  s_add_u32 s6, s45, 4096
  buffer_load_dwordx4 v0, s[8:11], s45 offen offset:0 lds
  buffer_load_dwordx4 v0, s[8:11], s45 offen offset:1024 lds
  buffer_load_dwordx4 v0, s[8:11], s45 offen offset:2048 lds
  buffer_load_dwordx4 v0, s[8:11], s45 offen offset:3072 lds
  s_add_u32 m0, s53, 4096
  s_nop 0
  buffer_load_dwordx4 v0, s[8:11], s6 offen offset:0 lds
  buffer_load_dwordx4 v0, s[8:11], s6 offen offset:1024 lds
  buffer_load_dwordx4 v0, s[8:11], s6 offen offset:2048 lds
  buffer_load_dwordx4 v0, s[8:11], s6 offen offset:3072 lds
  s_waitcnt vmcnt(0)
L_p_loop:
  s_barrier
  s_and_b32 s6, s33, 3
  s_lshl_b32 s6, s6, 19
  s_add_u32 s46, s39, s6
  s_lshr_b32 s6, s33, 2
  s_andn2_b32 s42, 1, s6
  s_add_u32 s49, s33, 3
  s_lshl_b32 s7, s3, 8
  ds_read_b64_tr_b16 v[80:81], v1 offset:0
  ds_read_b64_tr_b16 v[82:83], v1 offset:256
  ds_read_b64_tr_b16 v[84:85], v1 offset:1024
  ds_read_b64_tr_b16 v[86:87], v1 offset:1280
  ds_read_b64_tr_b16 v[96:97], v14 offset:0
  ds_read_b64_tr_b16 v[98:99], v14 offset:256
  v_mov_b32 v92, 0
  v_mov_b32 v93, 0
  v_add_u32 v108, s7, v15
  s_waitcnt lgkmcnt(4)
  v_mfma_f32_32x32x16_bf16 v[48:63], a[128:131], v[80:83], 0
  ds_read_b64_tr_b16 v[88:89], v1 offset:2048
  ds_read_b64_tr_b16 v[90:91], v1 offset:2304
  s_waitcnt lgkmcnt(2)
  ds_read_b64_tr_b16 v[100:101], v14 offset:1024
  ds_read_b64_tr_b16 v[102:103], v14 offset:1280
  v_lshlrev_b32 v104, 16, v96
  v_and_b32 v105, 0xffff0000, v96
  v_add_f32 v92, v92, v104
  v_mfma_f32_32x32x16_bf16 v[64:79], v[80:83], v[128:131], 0
  v_fmac_f32 v93, v104, v104
  v_add_f32 v92, v92, v105
  v_fmac_f32 v93, v105, v105
  v_lshlrev_b32 v106, 16, v97
  v_and_b32 v107, 0xffff0000, v97
  v_mfma_f32_32x32x16_bf16 v[48:63], a[132:135], v[84:87], v[48:63]
  ds_read_b64_tr_b16 v[80:81], v1 offset:3072
  ds_read_b64_tr_b16 v[82:83], v1 offset:3328
  v_add_f32 v92, v92, v106
  v_fmac_f32 v93, v106, v106
  v_add_f32 v92, v92, v107
  v_fmac_f32 v93, v107, v107
  v_mfma_f32_32x32x16_bf16 v[64:79], v[84:87], v[132:135], v[64:79]
  v_lshlrev_b32 v104, 16, v98
  v_and_b32 v105, 0xffff0000, v98
  v_add_f32 v92, v92, v104
  v_fmac_f32 v93, v104, v104
  s_waitcnt lgkmcnt(4)
  v_mfma_f32_32x32x16_bf16 v[48:63], a[136:139], v[88:91], v[48:63]
  ds_read_b64_tr_b16 v[84:85], v1 offset:4096
  ds_read_b64_tr_b16 v[86:87], v1 offset:4352
  v_add_f32 v92, v92, v105
  v_fmac_f32 v93, v105, v105
  v_lshlrev_b32 v106, 16, v99
  v_and_b32 v107, 0xffff0000, v99
  v_mfma_f32_32x32x16_bf16 v[64:79], v[88:91], v[136:139], v[64:79]
  v_add_f32 v92, v92, v106
  v_fmac_f32 v93, v106, v106
  v_add_f32 v92, v92, v107
  v_fmac_f32 v93, v107, v107
  s_waitcnt lgkmcnt(2)
  v_mfma_f32_32x32x16_bf16 v[48:63], a[140:143], v[80:83], v[48:63]
  ds_read_b64_tr_b16 v[88:89], v1 offset:5120
  ds_read_b64_tr_b16 v[90:91], v1 offset:5376
  ds_read_b64_tr_b16 v[96:97], v14 offset:2048
  ds_read_b64_tr_b16 v[98:99], v14 offset:2304
  v_lshlrev_b32 v104, 16, v100
  v_and_b32 v105, 0xffff0000, v100
  v_add_f32 v92, v92, v104
  v_mfma_f32_32x32x16_bf16 v[64:79], v[80:83], v[140:143], v[64:79]
  v_fmac_f32 v93, v104, v104
  v_add_f32 v92, v92, v105
  v_fmac_f32 v93, v105, v105
  v_lshlrev_b32 v106, 16, v101
  v_and_b32 v107, 0xffff0000, v101
  s_waitcnt lgkmcnt(4)
  v_mfma_f32_32x32x16_bf16 v[48:63], a[144:147], v[84:87], v[48:63]
  ds_read_b64_tr_b16 v[80:81], v1 offset:6144
  ds_read_b64_tr_b16 v[82:83], v1 offset:6400
  v_add_f32 v92, v92, v106
  v_fmac_f32 v93, v106, v106
  v_add_f32 v92, v92, v107
  v_fmac_f32 v93, v107, v107
  v_mfma_f32_32x32x16_bf16 v[64:79], v[84:87], v[144:147], v[64:79]
  v_lshlrev_b32 v104, 16, v102
  v_and_b32 v105, 0xffff0000, v102
  v_add_f32 v92, v92, v104
  v_fmac_f32 v93, v104, v104
  s_cmp_eq_u32 s52, 2
  s_cbranch_scc0 L_p_nof
  s_waitcnt vmcnt(0)
  s_mov_b64 exec, 1
  buffer_store_dword v126, v13, s[8:11], s43 offen sc1
  s_mov_b64 exec, -1
L_p_nof:
  s_waitcnt lgkmcnt(4)
  v_mfma_f32_32x32x16_bf16 v[48:63], a[148:151], v[88:91], v[48:63]
  ds_read_b64_tr_b16 v[84:85], v1 offset:7168
  ds_read_b64_tr_b16 v[86:87], v1 offset:7424
  v_add_f32 v92, v92, v105
  v_fmac_f32 v93, v105, v105
  v_lshlrev_b32 v106, 16, v103
  v_and_b32 v107, 0xffff0000, v103
  v_mfma_f32_32x32x16_bf16 v[64:79], v[88:91], v[148:151], v[64:79]
  v_add_f32 v92, v92, v106
  v_fmac_f32 v93, v106, v106
  v_add_f32 v92, v92, v107
  v_fmac_f32 v93, v107, v107
  s_waitcnt lgkmcnt(2)
  v_mfma_f32_32x32x16_bf16 v[48:63], a[152:155], v[80:83], v[48:63]
  ds_read_b64_tr_b16 v[88:89], v1 offset:8192
  ds_read_b64_tr_b16 v[90:91], v1 offset:8448
  ds_read_b64_tr_b16 v[100:101], v14 offset:3072
  ds_read_b64_tr_b16 v[102:103], v14 offset:3328
  v_lshlrev_b32 v104, 16, v96
  v_and_b32 v105, 0xffff0000, v96
  v_add_f32 v92, v92, v104
  v_mfma_f32_32x32x16_bf16 v[64:79], v[80:83], v[152:155], v[64:79]
  v_fmac_f32 v93, v104, v104
  v_add_f32 v92, v92, v105
  v_fmac_f32 v93, v105, v105
  v_lshlrev_b32 v106, 16, v97
  v_and_b32 v107, 0xffff0000, v97
  s_waitcnt lgkmcnt(4)
  v_mfma_f32_32x32x16_bf16 v[48:63], a[156:159], v[84:87], v[48:63]
  ds_read_b64_tr_b16 v[80:81], v1 offset:9216
  ds_read_b64_tr_b16 v[82:83], v1 offset:9472
  v_add_f32 v92, v92, v106
  v_fmac_f32 v93, v106, v106
  v_add_f32 v92, v92, v107
  v_fmac_f32 v93, v107, v107
  v_mfma_f32_32x32x16_bf16 v[64:79], v[84:87], v[156:159], v[64:79]
  v_lshlrev_b32 v104, 16, v98
  v_and_b32 v105, 0xffff0000, v98
  v_add_f32 v92, v92, v104
  v_fmac_f32 v93, v104, v104
  s_waitcnt lgkmcnt(4)
  v_mfma_f32_32x32x16_bf16 v[48:63], a[160:163], v[88:91], v[48:63]
  ds_read_b64_tr_b16 v[84:85], v1 offset:10240
  ds_read_b64_tr_b16 v[86:87], v1 offset:10496
  v_add_f32 v92, v92, v105
  v_fmac_f32 v93, v105, v105
  v_lshlrev_b32 v106, 16, v99
  v_and_b32 v107, 0xffff0000, v99
  v_mfma_f32_32x32x16_bf16 v[64:79], v[88:91], v[160:163], v[64:79]
  v_add_f32 v92, v92, v106
  v_fmac_f32 v93, v106, v106
  v_add_f32 v92, v92, v107
  v_fmac_f32 v93, v107, v107
  s_waitcnt lgkmcnt(2)
  v_mfma_f32_32x32x16_bf16 v[48:63], a[164:167], v[80:83], v[48:63]
  ds_read_b64_tr_b16 v[88:89], v1 offset:11264
  ds_read_b64_tr_b16 v[90:91], v1 offset:11520
  ds_read_b64_tr_b16 v[96:97], v14 offset:4096
  ds_read_b64_tr_b16 v[98:99], v14 offset:4352
  v_lshlrev_b32 v104, 16, v100
  v_and_b32 v105, 0xffff0000, v100
  v_add_f32 v92, v92, v104
  v_mfma_f32_32x32x16_bf16 v[64:79], v[80:83], v[164:167], v[64:79]
  v_fmac_f32 v93, v104, v104
  v_add_f32 v92, v92, v105
  v_fmac_f32 v93, v105, v105
  v_lshlrev_b32 v106, 16, v101
  v_and_b32 v107, 0xffff0000, v101
  s_waitcnt lgkmcnt(4)
  v_mfma_f32_32x32x16_bf16 v[48:63], a[168:171], v[84:87], v[48:63]
  ds_read_b64_tr_b16 v[80:81], v1 offset:12288
  ds_read_b64_tr_b16 v[82:83], v1 offset:12544
  v_add_f32 v92, v92, v106
  v_fmac_f32 v93, v106, v106
  v_add_f32 v92, v92, v107
  v_fmac_f32 v93, v107, v107
  v_mfma_f32_32x32x16_bf16 v[64:79], v[84:87], v[168:171], v[64:79]
  v_lshlrev_b32 v104, 16, v102
  v_and_b32 v105, 0xffff0000, v102
  v_add_f32 v92, v92, v104
  v_fmac_f32 v93, v104, v104
  s_waitcnt lgkmcnt(4)
  v_mfma_f32_32x32x16_bf16 v[48:63], a[172:175], v[88:91], v[48:63]
  ds_read_b64_tr_b16 v[84:85], v1 offset:13312
  ds_read_b64_tr_b16 v[86:87], v1 offset:13568
  v_add_f32 v92, v92, v105
  v_fmac_f32 v93, v105, v105
  v_lshlrev_b32 v106, 16, v103
  v_and_b32 v107, 0xffff0000, v103
  v_mfma_f32_32x32x16_bf16 v[64:79], v[88:91], v[172:175], v[64:79]
  v_add_f32 v92, v92, v106
  v_fmac_f32 v93, v106, v106
  v_add_f32 v92, v92, v107
  v_fmac_f32 v93, v107, v107
  s_waitcnt lgkmcnt(2)
  v_mfma_f32_32x32x16_bf16 v[48:63], a[176:179], v[80:83], v[48:63]
  ds_read_b64_tr_b16 v[88:89], v1 offset:14336
  ds_read_b64_tr_b16 v[90:91], v1 offset:14592
  ds_read_b64_tr_b16 v[100:101], v14 offset:5120
  ds_read_b64_tr_b16 v[102:103], v14 offset:5376
  v_lshlrev_b32 v104, 16, v96
  v_and_b32 v105, 0xffff0000, v96
  v_add_f32 v92, v92, v104
  v_mfma_f32_32x32x16_bf16 v[64:79], v[80:83], v[176:179], v[64:79]
  v_fmac_f32 v93, v104, v104
  v_add_f32 v92, v92, v105
  v_fmac_f32 v93, v105, v105
  v_lshlrev_b32 v106, 16, v97
  v_and_b32 v107, 0xffff0000, v97
  s_waitcnt lgkmcnt(4)
  v_mfma_f32_32x32x16_bf16 v[48:63], a[180:183], v[84:87], v[48:63]
  ds_read_b64_tr_b16 v[80:81], v1 offset:15360
  ds_read_b64_tr_b16 v[82:83], v1 offset:15616
  v_add_f32 v92, v92, v106
  v_fmac_f32 v93, v106, v106
  v_add_f32 v92, v92, v107
  v_fmac_f32 v93, v107, v107
  v_mfma_f32_32x32x16_bf16 v[64:79], v[84:87], v[180:183], v[64:79]
  v_lshlrev_b32 v104, 16, v98
  v_and_b32 v105, 0xffff0000, v98
  v_add_f32 v92, v92, v104
  v_fmac_f32 v93, v104, v104
  s_waitcnt lgkmcnt(4)
  v_mfma_f32_32x32x16_bf16 v[48:63], a[184:187], v[88:91], v[48:63]
  ds_read_b64_tr_b16 v[84:85], v1 offset:16384
  ds_read_b64_tr_b16 v[86:87], v1 offset:16640
  v_add_f32 v92, v92, v105
  v_fmac_f32 v93, v105, v105
  v_lshlrev_b32 v106, 16, v99
  v_and_b32 v107, 0xffff0000, v99
  v_mfma_f32_32x32x16_bf16 v[64:79], v[88:91], v[184:187], v[64:79]
  v_add_f32 v92, v92, v106
  v_fmac_f32 v93, v106, v106
  v_add_f32 v92, v92, v107
  v_fmac_f32 v93, v107, v107
  s_waitcnt lgkmcnt(2)
  v_mfma_f32_32x32x16_bf16 v[48:63], a[188:191], v[80:83], v[48:63]
  ds_read_b64_tr_b16 v[88:89], v1 offset:17408
  ds_read_b64_tr_b16 v[90:91], v1 offset:17664
  ds_read_b64_tr_b16 v[96:97], v14 offset:6144
  ds_read_b64_tr_b16 v[98:99], v14 offset:6400
  v_lshlrev_b32 v104, 16, v100
  v_and_b32 v105, 0xffff0000, v100
  v_add_f32 v92, v92, v104
  v_mfma_f32_32x32x16_bf16 v[64:79], v[80:83], v[188:191], v[64:79]
  v_fmac_f32 v93, v104, v104
  v_add_f32 v92, v92, v105
  v_fmac_f32 v93, v105, v105
  v_lshlrev_b32 v106, 16, v101
  v_and_b32 v107, 0xffff0000, v101
  s_waitcnt lgkmcnt(4)
  v_mfma_f32_32x32x16_bf16 v[48:63], a[192:195], v[84:87], v[48:63]
  ds_read_b64_tr_b16 v[80:81], v1 offset:18432
  ds_read_b64_tr_b16 v[82:83], v1 offset:18688
  v_add_f32 v92, v92, v106
  v_fmac_f32 v93, v106, v106
  v_add_f32 v92, v92, v107
  v_fmac_f32 v93, v107, v107
  v_mfma_f32_32x32x16_bf16 v[64:79], v[84:87], v[192:195], v[64:79]
  v_lshlrev_b32 v104, 16, v102
  v_and_b32 v105, 0xffff0000, v102
  v_add_f32 v92, v92, v104
  v_fmac_f32 v93, v104, v104
  s_waitcnt lgkmcnt(4)
  v_mfma_f32_32x32x16_bf16 v[48:63], a[196:199], v[88:91], v[48:63]
  ds_read_b64_tr_b16 v[84:85], v1 offset:19456
  ds_read_b64_tr_b16 v[86:87], v1 offset:19712
  v_add_f32 v92, v92, v105
  v_fmac_f32 v93, v105, v105
  v_lshlrev_b32 v106, 16, v103
  v_and_b32 v107, 0xffff0000, v103
  v_mfma_f32_32x32x16_bf16 v[64:79], v[88:91], v[196:199], v[64:79]
  v_add_f32 v92, v92, v106
  v_fmac_f32 v93, v106, v106
  v_add_f32 v92, v92, v107
  v_fmac_f32 v93, v107, v107
  s_waitcnt lgkmcnt(2)
  v_mfma_f32_32x32x16_bf16 v[48:63], a[200:203], v[80:83], v[48:63]
  ds_read_b64_tr_b16 v[88:89], v1 offset:20480
  ds_read_b64_tr_b16 v[90:91], v1 offset:20736
  ds_read_b64_tr_b16 v[100:101], v14 offset:7168
  ds_read_b64_tr_b16 v[102:103], v14 offset:7424
  v_lshlrev_b32 v104, 16, v96
  v_and_b32 v105, 0xffff0000, v96
  v_add_f32 v92, v92, v104
  v_mfma_f32_32x32x16_bf16 v[64:79], v[80:83], v[200:203], v[64:79]
  v_fmac_f32 v93, v104, v104
  v_add_f32 v92, v92, v105
  v_fmac_f32 v93, v105, v105
  v_lshlrev_b32 v106, 16, v97
  v_and_b32 v107, 0xffff0000, v97
  s_waitcnt lgkmcnt(4)
  v_mfma_f32_32x32x16_bf16 v[48:63], a[204:207], v[84:87], v[48:63]
  ds_read_b64_tr_b16 v[80:81], v1 offset:21504
  ds_read_b64_tr_b16 v[82:83], v1 offset:21760
  v_add_f32 v92, v92, v106
  v_fmac_f32 v93, v106, v106
  v_add_f32 v92, v92, v107
  v_fmac_f32 v93, v107, v107
  v_mfma_f32_32x32x16_bf16 v[64:79], v[84:87], v[204:207], v[64:79]
  v_lshlrev_b32 v104, 16, v98
  v_and_b32 v105, 0xffff0000, v98
  v_add_f32 v92, v92, v104
  v_fmac_f32 v93, v104, v104
  s_waitcnt lgkmcnt(4)
  v_mfma_f32_32x32x16_bf16 v[48:63], a[208:211], v[88:91], v[48:63]
  ds_read_b64_tr_b16 v[84:85], v1 offset:22528
  ds_read_b64_tr_b16 v[86:87], v1 offset:22784
  v_add_f32 v92, v92, v105
  v_fmac_f32 v93, v105, v105
  v_lshlrev_b32 v106, 16, v99
  v_and_b32 v107, 0xffff0000, v99
  v_mfma_f32_32x32x16_bf16 v[64:79], v[88:91], v[208:211], v[64:79]
  v_add_f32 v92, v92, v106
  v_fmac_f32 v93, v106, v106
  v_add_f32 v92, v92, v107
  v_fmac_f32 v93, v107, v107
  s_waitcnt lgkmcnt(2)
  v_mfma_f32_32x32x16_bf16 v[48:63], a[212:215], v[80:83], v[48:63]
  ds_read_b64_tr_b16 v[88:89], v1 offset:23552
  ds_read_b64_tr_b16 v[90:91], v1 offset:23808
  v_lshlrev_b32 v104, 16, v100
  v_and_b32 v105, 0xffff0000, v100
  v_add_f32 v92, v92, v104
  v_fmac_f32 v93, v104, v104
  v_mfma_f32_32x32x16_bf16 v[64:79], v[80:83], v[212:215], v[64:79]
  v_add_f32 v92, v92, v105
  v_fmac_f32 v93, v105, v105
  v_lshlrev_b32 v106, 16, v101
  v_and_b32 v107, 0xffff0000, v101
  s_waitcnt lgkmcnt(2)
  v_mfma_f32_32x32x16_bf16 v[48:63], a[216:219], v[84:87], v[48:63]
  ds_read_b64_tr_b16 v[80:81], v1 offset:24576
  ds_read_b64_tr_b16 v[82:83], v1 offset:24832
  v_add_f32 v92, v92, v106
  v_fmac_f32 v93, v106, v106
  v_add_f32 v92, v92, v107
  v_fmac_f32 v93, v107, v107
  v_mfma_f32_32x32x16_bf16 v[64:79], v[84:87], v[216:219], v[64:79]
  v_lshlrev_b32 v104, 16, v102
  v_and_b32 v105, 0xffff0000, v102
  v_add_f32 v92, v92, v104
  v_fmac_f32 v93, v104, v104
  s_waitcnt lgkmcnt(2)
  v_mfma_f32_32x32x16_bf16 v[48:63], a[220:223], v[88:91], v[48:63]
  ds_read_b64_tr_b16 v[84:85], v1 offset:25600
  ds_read_b64_tr_b16 v[86:87], v1 offset:25856
  v_add_f32 v92, v92, v105
  v_fmac_f32 v93, v105, v105
  v_lshlrev_b32 v106, 16, v103
  v_and_b32 v107, 0xffff0000, v103
  v_mfma_f32_32x32x16_bf16 v[64:79], v[88:91], v[220:223], v[64:79]
  v_add_f32 v92, v92, v106
  v_fmac_f32 v93, v106, v106
  v_add_f32 v92, v92, v107
  v_fmac_f32 v93, v107, v107
  s_waitcnt lgkmcnt(2)
  v_mfma_f32_32x32x16_bf16 v[48:63], a[224:227], v[80:83], v[48:63]
  ds_read_b64_tr_b16 v[88:89], v1 offset:26624
  ds_read_b64_tr_b16 v[90:91], v1 offset:26880
  v_mov_b32 v94, v92
  v_mov_b32 v95, v93
  s_nop 0
  v_permlane32_swap_b32 v92, v94
  v_permlane32_swap_b32 v93, v95
  v_mfma_f32_32x32x16_bf16 v[64:79], v[80:83], v[224:227], v[64:79]
  v_add_f32 v92, v92, v94
  v_add_f32 v93, v93, v95
  ds_write_b64 v108, v[92:93]
  s_waitcnt lgkmcnt(3)
  v_mfma_f32_32x32x16_bf16 v[48:63], a[228:231], v[84:87], v[48:63]
  ds_read_b64_tr_b16 v[80:81], v1 offset:27648
  ds_read_b64_tr_b16 v[82:83], v1 offset:27904
  s_waitcnt lgkmcnt(2)
  s_barrier
  ds_read_b64 v[96:97], v15 offset:0
  v_mfma_f32_32x32x16_bf16 v[64:79], v[84:87], v[228:231], v[64:79]
  ds_read_b64 v[98:99], v15 offset:256
  ds_read_b64 v[100:101], v15 offset:512
  ds_read_b64 v[102:103], v15 offset:768
  v_mfma_f32_32x32x16_bf16 v[48:63], a[232:235], v[88:91], v[48:63]
  ds_read_b64_tr_b16 v[84:85], v1 offset:28672
  ds_read_b64_tr_b16 v[86:87], v1 offset:28928
  v_mfma_f32_32x32x16_bf16 v[64:79], v[88:91], v[232:235], v[64:79]
  s_waitcnt lgkmcnt(6)
  v_mfma_f32_32x32x16_bf16 v[48:63], a[236:239], v[80:83], v[48:63]
  ds_read_b64_tr_b16 v[88:89], v1 offset:29696
  ds_read_b64_tr_b16 v[90:91], v1 offset:29952
  s_waitcnt lgkmcnt(4)
  v_add_f32 v92, v96, v98
  v_add_f32 v93, v97, v99
  v_add_f32 v94, v100, v102
  v_mfma_f32_32x32x16_bf16 v[64:79], v[80:83], v[236:239], v[64:79]
  v_add_f32 v95, v101, v103
  v_add_f32 v92, v92, v94
  v_add_f32 v93, v93, v95
  v_mul_f32 v92, 0x3b000000, v92
  s_waitcnt lgkmcnt(2)
  v_mfma_f32_32x32x16_bf16 v[48:63], a[240:243], v[84:87], v[48:63]
  ds_read_b64_tr_b16 v[80:81], v1 offset:30720
  ds_read_b64_tr_b16 v[82:83], v1 offset:30976
  v_mul_f32 v94, v92, v92
  v_mul_f32 v93, 0x3b000000, v93
  v_sub_f32 v93, v93, v94
  v_max_f32 v93, 0, v93
  v_mfma_f32_32x32x16_bf16 v[64:79], v[84:87], v[240:243], v[64:79]
  v_cvt_pk_bf16_f32 v93, v93, v93
  v_and_b32 v93, 0xffff0000, v93
  v_add_f32 v93, 0x3727c5ac, v93
  v_cvt_pk_bf16_f32 v93, v93, v93
  s_waitcnt lgkmcnt(2)
  v_mfma_f32_32x32x16_bf16 v[48:63], a[244:247], v[88:91], v[48:63]
  ds_read_b64_tr_b16 v[84:85], v1 offset:31744
  ds_read_b64_tr_b16 v[86:87], v1 offset:32000
  v_and_b32 v93, 0xffff0000, v93
  v_sqrt_f32 v93, v93
  v_cvt_pk_bf16_f32 v92, v92, v92
  v_and_b32 v92, 0xffff0000, v92
  v_mfma_f32_32x32x16_bf16 v[64:79], v[88:91], v[244:247], v[64:79]
  v_cvt_pk_bf16_f32 v93, v93, v93
  v_and_b32 v93, 0xffff0000, v93
  v_rcp_f32 v93, v93
  v_xor_b32 v92, 0x80000000, v92
  s_waitcnt lgkmcnt(2)
  v_mfma_f32_32x32x16_bf16 v[48:63], a[248:251], v[80:83], v[48:63]
  ds_read_b64_tr_b16 v[88:89], v1 offset:0
  ds_read_b64_tr_b16 v[90:91], v1 offset:256
  v_lshrrev_b32 v94, 16, v92
  v_or_b32 v20, v92, v94
  v_or_b32 v23, v92, v94
  v_mfma_f32_32x32x16_bf16 v[64:79], v[80:83], v[248:251], v[64:79]
  v_mov_b32 v92, v93
  ds_write_b32 v9, v93
  s_waitcnt lgkmcnt(3)
  v_mfma_f32_32x32x16_bf16 v[48:63], a[252:255], v[84:87], v[48:63]
  ds_read_b64_tr_b16 v[80:81], v1 offset:1024
  ds_read_b64_tr_b16 v[82:83], v1 offset:1280
  ds_read_b128 v[96:99], v8 offset:0
  ds_read_b128 v[100:103], v8 offset:32
  v_mfma_f32_32x32x16_bf16 v[64:79], v[84:87], v[252:255], v[64:79]
  ds_read_b128 v[104:107], v8 offset:64
  ds_read_b128 v[108:111], v8 offset:96
  s_add_u32 s7, s46, 0x2000
  v_mfma_f32_32x32x8_bf16 v[48:63], v[16:17], v[22:23], v[48:63]
  v_mfma_f32_32x32x8_bf16 v[64:79], v[20:21], v[18:19], v[64:79]
  s_waitcnt lgkmcnt(7)
  v_mfma_f32_32x32x16_bf16 v[32:47], a[0:3], v[88:91], 0
  ds_read_b64_tr_b16 v[84:85], v1 offset:2048
  ds_read_b64_tr_b16 v[86:87], v1 offset:2304
  s_waitcnt lgkmcnt(6)
  v_mfma_f32_32x32x16_bf16 v[32:47], a[4:7], v[80:83], v[32:47]
  ds_read_b64_tr_b16 v[88:89], v1 offset:3072
  ds_read_b64_tr_b16 v[90:91], v1 offset:3328
  s_nop 2
  v_pk_mul_f32 v[48:49], v[48:49], v[92:93]
  v_pk_mul_f32 v[50:51], v[50:51], v[92:93]
  v_pk_mul_f32 v[52:53], v[52:53], v[92:93]
  v_pk_mul_f32 v[54:55], v[54:55], v[92:93]
  s_waitcnt lgkmcnt(2)
  v_mfma_f32_32x32x16_bf16 v[32:47], a[8:11], v[84:87], v[32:47]
  ds_read_b64_tr_b16 v[80:81], v1 offset:4096
  ds_read_b64_tr_b16 v[82:83], v1 offset:4352
  v_pk_mul_f32 v[56:57], v[56:57], v[92:93]
  v_pk_mul_f32 v[58:59], v[58:59], v[92:93]
  v_pk_mul_f32 v[60:61], v[60:61], v[92:93]
  v_pk_mul_f32 v[62:63], v[62:63], v[92:93]
  s_waitcnt lgkmcnt(2)
  v_mfma_f32_32x32x16_bf16 v[32:47], a[12:15], v[88:91], v[32:47]
  ds_read_b64_tr_b16 v[84:85], v1 offset:5120
  ds_read_b64_tr_b16 v[86:87], v1 offset:5376
  v_cvt_pk_bf16_f32 v48, v48, v49
  v_cvt_pk_bf16_f32 v49, v50, v51
  v_cvt_pk_bf16_f32 v50, v52, v53
  v_cvt_pk_bf16_f32 v51, v54, v55
  s_waitcnt lgkmcnt(2)
  v_mfma_f32_32x32x16_bf16 v[32:47], a[16:19], v[80:83], v[32:47]
  ds_read_b64_tr_b16 v[88:89], v1 offset:6144
  ds_read_b64_tr_b16 v[90:91], v1 offset:6400
  v_cvt_pk_bf16_f32 v52, v56, v57
  v_cvt_pk_bf16_f32 v53, v58, v59
  v_cvt_pk_bf16_f32 v54, v60, v61
  v_cvt_pk_bf16_f32 v55, v62, v63
  s_waitcnt lgkmcnt(2)
  v_mfma_f32_32x32x16_bf16 v[32:47], a[20:23], v[84:87], v[32:47]
  ds_read_b64_tr_b16 v[80:81], v1 offset:7168
  ds_read_b64_tr_b16 v[82:83], v1 offset:7424
  v_bfi_b32 v48, 1, s42, v48
  v_bfi_b32 v52, 1, s42, v52
  buffer_store_dwordx4 v[48:51], v0, s[8:11], s46 offen offset:0 sc1
  ds_write_b128 v112, v[48:51] offset:8192
  s_waitcnt lgkmcnt(3)
  v_mfma_f32_32x32x16_bf16 v[32:47], a[24:27], v[88:91], v[32:47]
  ds_read_b64_tr_b16 v[84:85], v1 offset:8192
  ds_read_b64_tr_b16 v[86:87], v1 offset:8448
  buffer_store_dwordx4 v[52:55], v0, s[8:11], s46 offen offset:1024 sc1
  ds_write_b128 v112, v[52:55] offset:9216
  v_pk_mul_f32 v[64:65], v[64:65], v[96:97]
  s_waitcnt lgkmcnt(4)
  v_mfma_f32_32x32x16_bf16 v[32:47], a[28:31], v[80:83], v[32:47]
  ds_read_b64_tr_b16 v[88:89], v1 offset:9216
  ds_read_b64_tr_b16 v[90:91], v1 offset:9472
  v_pk_mul_f32 v[66:67], v[66:67], v[98:99]
  v_pk_mul_f32 v[68:69], v[68:69], v[100:101]
  v_pk_mul_f32 v[70:71], v[70:71], v[102:103]
  v_pk_mul_f32 v[72:73], v[72:73], v[104:105]
  s_waitcnt lgkmcnt(3)
  v_mfma_f32_32x32x16_bf16 v[32:47], a[32:35], v[84:87], v[32:47]
  ds_read_b64_tr_b16 v[80:81], v1 offset:10240
  ds_read_b64_tr_b16 v[82:83], v1 offset:10496
  v_pk_mul_f32 v[74:75], v[74:75], v[106:107]
  v_pk_mul_f32 v[76:77], v[76:77], v[108:109]
  v_pk_mul_f32 v[78:79], v[78:79], v[110:111]
  v_cvt_pk_bf16_f32 v64, v64, v65
  s_waitcnt lgkmcnt(2)
  v_mfma_f32_32x32x16_bf16 v[32:47], a[36:39], v[88:91], v[32:47]
  ds_read_b64_tr_b16 v[84:85], v1 offset:11264
  ds_read_b64_tr_b16 v[86:87], v1 offset:11520
  v_cvt_pk_bf16_f32 v65, v66, v67
  v_cvt_pk_bf16_f32 v66, v68, v69
  v_cvt_pk_bf16_f32 v67, v70, v71
  v_cvt_pk_bf16_f32 v68, v72, v73
  s_waitcnt lgkmcnt(2)
  v_mfma_f32_32x32x16_bf16 v[32:47], a[40:43], v[80:83], v[32:47]
  ds_read_b64_tr_b16 v[88:89], v1 offset:12288
  ds_read_b64_tr_b16 v[90:91], v1 offset:12544
  v_cvt_pk_bf16_f32 v69, v74, v75
  v_cvt_pk_bf16_f32 v70, v76, v77
  v_cvt_pk_bf16_f32 v71, v78, v79
  v_bfi_b32 v64, 1, s42, v64
  s_waitcnt lgkmcnt(2)
  v_mfma_f32_32x32x16_bf16 v[32:47], a[44:47], v[84:87], v[32:47]
  ds_read_b64_tr_b16 v[80:81], v1 offset:13312
  ds_read_b64_tr_b16 v[82:83], v1 offset:13568
  v_bfi_b32 v68, 1, s42, v68
  buffer_store_dwordx4 v[64:67], v0, s[8:11], s7 offen offset:0 sc1
  ds_write_b128 v112, v[64:67] offset:16384
  buffer_store_dwordx4 v[68:71], v0, s[8:11], s7 offen offset:1024 sc1
  s_waitcnt lgkmcnt(3)
  v_mfma_f32_32x32x16_bf16 v[32:47], a[48:51], v[88:91], v[32:47]
  ds_read_b64_tr_b16 v[84:85], v1 offset:14336
  ds_read_b64_tr_b16 v[86:87], v1 offset:14592
  ds_write_b128 v112, v[68:71] offset:17408
  s_waitcnt lgkmcnt(4)
  v_mfma_f32_32x32x16_bf16 v[32:47], a[52:55], v[80:83], v[32:47]
  ds_read_b64_tr_b16 v[88:89], v1 offset:15360
  ds_read_b64_tr_b16 v[90:91], v1 offset:15616
  s_waitcnt lgkmcnt(3)
  v_mfma_f32_32x32x16_bf16 v[32:47], a[56:59], v[84:87], v[32:47]
  ds_read_b64_tr_b16 v[80:81], v1 offset:16384
  ds_read_b64_tr_b16 v[82:83], v1 offset:16640
  s_waitcnt lgkmcnt(2)
  v_mfma_f32_32x32x16_bf16 v[32:47], a[60:63], v[88:91], v[32:47]
  ds_read_b64_tr_b16 v[84:85], v1 offset:17408
  ds_read_b64_tr_b16 v[86:87], v1 offset:17664
  s_waitcnt lgkmcnt(2)
  v_mfma_f32_32x32x16_bf16 v[32:47], a[64:67], v[80:83], v[32:47]
  ds_read_b64_tr_b16 v[88:89], v1 offset:18432
  ds_read_b64_tr_b16 v[90:91], v1 offset:18688
  s_waitcnt lgkmcnt(2)
  v_mfma_f32_32x32x16_bf16 v[32:47], a[68:71], v[84:87], v[32:47]
  ds_read_b64_tr_b16 v[80:81], v1 offset:19456
  ds_read_b64_tr_b16 v[82:83], v1 offset:19712
  s_waitcnt lgkmcnt(2)
  v_mfma_f32_32x32x16_bf16 v[32:47], a[72:75], v[88:91], v[32:47]
  ds_read_b64_tr_b16 v[84:85], v1 offset:20480
  ds_read_b64_tr_b16 v[86:87], v1 offset:20736
  s_waitcnt lgkmcnt(2)
  v_mfma_f32_32x32x16_bf16 v[32:47], a[76:79], v[80:83], v[32:47]
  ds_read_b64_tr_b16 v[88:89], v1 offset:21504
  ds_read_b64_tr_b16 v[90:91], v1 offset:21760
  s_waitcnt lgkmcnt(2)
  v_mfma_f32_32x32x16_bf16 v[32:47], a[80:83], v[84:87], v[32:47]
  ds_read_b64_tr_b16 v[80:81], v1 offset:22528
  ds_read_b64_tr_b16 v[82:83], v1 offset:22784
  s_waitcnt lgkmcnt(2)
  v_mfma_f32_32x32x16_bf16 v[32:47], a[84:87], v[88:91], v[32:47]
  ds_read_b64_tr_b16 v[84:85], v1 offset:23552
  ds_read_b64_tr_b16 v[86:87], v1 offset:23808
  s_waitcnt lgkmcnt(2)
  v_mfma_f32_32x32x16_bf16 v[32:47], a[88:91], v[80:83], v[32:47]
  ds_read_b64_tr_b16 v[88:89], v1 offset:24576
  ds_read_b64_tr_b16 v[90:91], v1 offset:24832
  s_waitcnt lgkmcnt(2)
  v_mfma_f32_32x32x16_bf16 v[32:47], a[92:95], v[84:87], v[32:47]
  ds_read_b64_tr_b16 v[80:81], v1 offset:25600
  ds_read_b64_tr_b16 v[82:83], v1 offset:25856
  s_waitcnt lgkmcnt(2)
  v_mfma_f32_32x32x16_bf16 v[32:47], a[96:99], v[88:91], v[32:47]
  ds_read_b64_tr_b16 v[84:85], v1 offset:26624
  ds_read_b64_tr_b16 v[86:87], v1 offset:26880
  s_waitcnt lgkmcnt(2)
  v_mfma_f32_32x32x16_bf16 v[32:47], a[100:103], v[80:83], v[32:47]
  ds_read_b64_tr_b16 v[88:89], v1 offset:27648
  ds_read_b64_tr_b16 v[90:91], v1 offset:27904
  s_waitcnt lgkmcnt(2)
  v_mfma_f32_32x32x16_bf16 v[32:47], a[104:107], v[84:87], v[32:47]
  ds_read_b64_tr_b16 v[80:81], v1 offset:28672
  ds_read_b64_tr_b16 v[82:83], v1 offset:28928
  s_waitcnt lgkmcnt(2)
  v_mfma_f32_32x32x16_bf16 v[32:47], a[108:111], v[88:91], v[32:47]
  ds_read_b64_tr_b16 v[84:85], v1 offset:29696
  ds_read_b64_tr_b16 v[86:87], v1 offset:29952
  s_waitcnt lgkmcnt(2)
  v_mfma_f32_32x32x16_bf16 v[32:47], a[112:115], v[80:83], v[32:47]
  ds_read_b64_tr_b16 v[88:89], v1 offset:30720
  ds_read_b64_tr_b16 v[90:91], v1 offset:30976
  s_waitcnt lgkmcnt(2)
  v_mfma_f32_32x32x16_bf16 v[32:47], a[116:119], v[84:87], v[32:47]
  ds_read_b64_tr_b16 v[80:81], v1 offset:31744
  ds_read_b64_tr_b16 v[82:83], v1 offset:32000
  s_waitcnt lgkmcnt(2)
  v_mfma_f32_32x32x16_bf16 v[32:47], a[120:123], v[88:91], v[32:47]
  s_waitcnt lgkmcnt(0)
  v_mfma_f32_32x32x16_bf16 v[32:47], a[124:127], v[80:83], v[32:47]
  s_sub_u32 s51, s33, 2
  s_and_b32 s6, s51, 3
  s_lshl_b32 s6, s6, 17
  s_add_u32 s47, s40, s6
  s_lshr_b32 s6, s51, 2
  s_andn2_b32 s50, 1, s6
  s_lshl_b32 s6, s51, 18
  s_add_u32 s48, s41, s6
  s_add_u32 s51, s51, 1
  buffer_load_dwordx4 v[116:119], v0, s[8:11], s47 offen sc1
  buffer_load_dword v115, v114, s[8:11], s44 offen sc1
  v_mfma_f32_32x32x8_bf16 v[32:47], v[16:17], v[20:21], v[32:47]
  s_nop 11
  v_pk_mul_f32 v[32:33], v[32:33], v[92:93]
  v_pk_mul_f32 v[34:35], v[34:35], v[92:93]
  v_pk_mul_f32 v[36:37], v[36:37], v[92:93]
  v_pk_mul_f32 v[38:39], v[38:39], v[92:93]
  v_pk_mul_f32 v[40:41], v[40:41], v[92:93]
  v_pk_mul_f32 v[42:43], v[42:43], v[92:93]
  v_pk_mul_f32 v[44:45], v[44:45], v[92:93]
  v_pk_mul_f32 v[46:47], v[46:47], v[92:93]
  v_cvt_pk_bf16_f32 v32, v32, v33
  v_cvt_pk_bf16_f32 v33, v34, v35
  v_cvt_pk_bf16_f32 v34, v36, v37
  v_cvt_pk_bf16_f32 v35, v38, v39
  v_cvt_pk_bf16_f32 v36, v40, v41
  v_cvt_pk_bf16_f32 v37, v42, v43
  v_cvt_pk_bf16_f32 v38, v44, v45
  v_cvt_pk_bf16_f32 v39, v46, v47
  ds_write_b128 v112, v[32:35] offset:0
  ds_write_b128 v112, v[36:39] offset:1024
  s_cmp_eq_u32 s32, 0
  s_cbranch_scc1 L_p_first
L_p_att:
  ds_read_b128 v[64:67], v3 offset:0
  ds_read_b128 v[32:35], v2 offset:0
  ds_read_b128 v[48:51], v2 offset:128
  ds_read_b128 v[68:71], v3 offset:2048
  ds_read_b128 v[36:39], v2 offset:2048
  ds_read_b128 v[52:55], v2 offset:2176
  ds_read_b128 v[72:75], v3 offset:4096
  ds_read_b128 v[40:43], v2 offset:4096
  ds_read_b128 v[56:59], v2 offset:4224
  ds_read_b128 v[76:79], v3 offset:6144
  ds_read_b128 v[44:47], v2 offset:6144
  ds_read_b128 v[60:63], v2 offset:6272
  s_waitcnt lgkmcnt(9)
  v_mfma_f32_16x16x32_bf16 v[96:99], v[32:35], v[64:67], v[24:27]
  v_mfma_f32_16x16x32_bf16 v[100:103], v[48:51], v[64:67], v[28:31]
  s_waitcnt lgkmcnt(6)
  v_mfma_f32_16x16x32_bf16 v[96:99], v[36:39], v[68:71], v[96:99]
  v_mfma_f32_16x16x32_bf16 v[100:103], v[52:55], v[68:71], v[100:103]
  s_waitcnt lgkmcnt(3)
  v_mfma_f32_16x16x32_bf16 v[96:99], v[40:43], v[72:75], v[96:99]
  v_mfma_f32_16x16x32_bf16 v[100:103], v[56:59], v[72:75], v[100:103]
  s_waitcnt lgkmcnt(0)
  v_mfma_f32_16x16x32_bf16 v[96:99], v[44:47], v[76:79], v[96:99]
  v_mfma_f32_16x16x32_bf16 v[100:103], v[60:63], v[76:79], v[100:103]
  ds_read_b128 v[80:83], v4 offset:0
  ds_read_b128 v[84:87], v4 offset:256
  ds_read_b128 v[88:91], v4 offset:2048
  ds_read_b128 v[92:95], v4 offset:2304
  s_mov_b32 s52, 0
  s_barrier
  s_mov_b32 s7, 0
  s_waitcnt vmcnt(0)
L_p_km:
  v_bitop3_b32 v126, v116, s50, 1 bitop3:0x28
  v_cmp_ne_u32 vcc, 0, v126
  s_cbranch_vccz L_p_kmok
  buffer_load_dwordx4 v[116:119], v0, s[8:11], s47 offen sc1
  s_cmp_lg_u32 s52, 0
  s_cbranch_scc1 L_p_k0
  s_cmp_ge_u32 s32, 31
  s_cbranch_scc1 L_p_k0
  v_cmp_gt_u32 vcc, s49, v115
  s_cbranch_vccnz L_p_k1
  s_mov_b32 s52, 1
  s_sub_u32 s6, s49, 1
  s_lshl_b32 s6, s6, 15
  s_add_u32 s45, s38, s6
  s_mov_b32 m0, s53
  s_add_u32 s6, s45, 4096
  buffer_load_dwordx4 v0, s[8:11], s45 offen offset:0 lds
  buffer_load_dwordx4 v0, s[8:11], s45 offen offset:1024 lds
  buffer_load_dwordx4 v0, s[8:11], s45 offen offset:2048 lds
  buffer_load_dwordx4 v0, s[8:11], s45 offen offset:3072 lds
  s_add_u32 m0, s53, 4096
  s_nop 0
  buffer_load_dwordx4 v0, s[8:11], s6 offen offset:0 lds
  buffer_load_dwordx4 v0, s[8:11], s6 offen offset:1024 lds
  buffer_load_dwordx4 v0, s[8:11], s6 offen offset:2048 lds
  buffer_load_dwordx4 v0, s[8:11], s6 offen offset:3072 lds
  s_waitcnt vmcnt(8)
  s_branch L_p_k2
L_p_k1:
  buffer_load_dword v115, v114, s[8:11], s44 offen sc1
L_p_k0:
  s_waitcnt vmcnt(0)
L_p_k2:
  s_add_u32 s7, s7, 1
  s_cmp_lt_u32 s7, 131072
  s_cbranch_scc1 L_p_km
  s_mov_b32 s6, 23
  s_branch L_err
L_p_kmok:
  s_cmp_lg_u32 s52, 0
  s_cbranch_scc1 L_nx_95
  s_cmp_ge_u32 s32, 31
  s_cbranch_scc1 L_nx_95
  v_cmp_gt_u32 vcc, s49, v115
  s_cbranch_vccnz L_nx_96
  s_mov_b32 s52, 1
  s_sub_u32 s6, s49, 1
  s_lshl_b32 s6, s6, 15
  s_add_u32 s45, s38, s6
  s_mov_b32 m0, s53
  s_add_u32 s6, s45, 4096
  buffer_load_dwordx4 v0, s[8:11], s45 offen offset:0 lds
  buffer_load_dwordx4 v0, s[8:11], s45 offen offset:1024 lds
  buffer_load_dwordx4 v0, s[8:11], s45 offen offset:2048 lds
  buffer_load_dwordx4 v0, s[8:11], s45 offen offset:3072 lds
  s_add_u32 m0, s53, 4096
  s_nop 0
  buffer_load_dwordx4 v0, s[8:11], s6 offen offset:0 lds
  buffer_load_dwordx4 v0, s[8:11], s6 offen offset:1024 lds
  buffer_load_dwordx4 v0, s[8:11], s6 offen offset:2048 lds
  buffer_load_dwordx4 v0, s[8:11], s6 offen offset:3072 lds
  s_branch L_nx_95
L_nx_96:
  buffer_load_dword v115, v114, s[8:11], s44 offen sc1
L_nx_95:
  ds_write_b64 v5, v[116:117]
  ds_write_b64 v5, v[118:119] offset:128
  v_max3_f32 v124, v96, v97, v98
  v_max3_f32 v125, v100, v101, v102
  v_max3_f32 v124, v124, v99, v103
  s_waitcnt lgkmcnt(0)
  s_barrier
  ds_read_b64_tr_b16 v[32:33], v6 offset:0
  ds_read_b64_tr_b16 v[34:35], v6 offset:64
  ds_read_b64_tr_b16 v[36:37], v6 offset:256
  ds_read_b64_tr_b16 v[38:39], v6 offset:320
  ds_read_b64_tr_b16 v[40:41], v6 offset:512
  ds_read_b64_tr_b16 v[42:43], v6 offset:576
  ds_read_b64_tr_b16 v[44:45], v6 offset:768
  ds_read_b64_tr_b16 v[46:47], v6 offset:832
  ds_read_b64 v[48:49], v7 offset:0
  ds_read_b64 v[50:51], v7 offset:128
  ds_read_b64 v[52:53], v7 offset:256
  ds_read_b64 v[54:55], v7 offset:384
  s_waitcnt lgkmcnt(10)
  v_mfma_f32_16x16x32_bf16 v[104:107], v[32:35], v[64:67], 0
  s_waitcnt lgkmcnt(8)
  v_mfma_f32_16x16x32_bf16 v[104:107], v[36:39], v[68:71], v[104:107]
  s_waitcnt lgkmcnt(6)
  v_mfma_f32_16x16x32_bf16 v[104:107], v[40:43], v[72:75], v[104:107]
  s_waitcnt lgkmcnt(4)
  v_mfma_f32_16x16x32_bf16 v[104:107], v[44:47], v[76:79], v[104:107]
  v_max_f32 v124, v124, v125
  s_nop 6
  v_max3_f32 v124, v124, v106, v107
  v_mov_b32 v125, v124
  s_nop 1
  v_permlane32_swap_b32 v124, v125
  v_max_f32 v124, v124, v125
  v_max_f32 v125, v124, v125
  s_nop 1
  v_permlane16_swap_b32 v124, v125
  v_max_f32 v124, v124, v125
  v_mul_f32 v124, s34, v124
  v_fma_f32 v106, v106, s34, -v124
  v_fma_f32 v107, v107, s34, -v124
  v_fma_f32 v96, v96, s34, -v124
  v_fma_f32 v97, v97, s34, -v124
  v_fma_f32 v98, v98, s34, -v124
  v_fma_f32 v99, v99, s34, -v124
  v_fma_f32 v100, v100, s34, -v124
  v_fma_f32 v101, v101, s34, -v124
  v_fma_f32 v102, v102, s34, -v124
  v_fma_f32 v103, v103, s34, -v124
  v_exp_f32 v106, v106
  v_exp_f32 v107, v107
  v_exp_f32 v96, v96
  v_cvt_pk_bf16_f32 v12, v106, v107
  v_exp_f32 v97, v97
  s_waitcnt lgkmcnt(0)
  v_mfma_f32_16x16x16_bf16 v[108:111], v[10:11], v[12:13], 0
  v_mfma_f32_16x16x16_bf16 v[56:59], v[48:49], v[12:13], 0
  v_exp_f32 v98, v98
  v_exp_f32 v99, v99
  v_mfma_f32_16x16x16_bf16 v[60:63], v[50:51], v[12:13], 0
  v_exp_f32 v100, v100
  v_exp_f32 v101, v101
  v_mfma_f32_16x16x16_bf16 v[64:67], v[52:53], v[12:13], 0
  v_exp_f32 v102, v102
  v_exp_f32 v103, v103
  v_mfma_f32_16x16x16_bf16 v[68:71], v[54:55], v[12:13], 0
  v_cvt_pk_bf16_f32 v120, v96, v97
  v_cvt_pk_bf16_f32 v121, v98, v99
  v_cvt_pk_bf16_f32 v122, v100, v101
  v_cvt_pk_bf16_f32 v123, v102, v103
  v_mfma_f32_16x16x16_bf16 v[108:111], v[10:11], v[120:121], v[108:111]
  s_nop 0
  v_mfma_f32_16x16x16_bf16 v[108:111], v[10:11], v[122:123], v[108:111]
  v_mfma_f32_16x16x32_bf16 v[56:59], v[80:83], v[120:123], v[56:59]
  v_mfma_f32_16x16x32_bf16 v[60:63], v[84:87], v[120:123], v[60:63]
  v_mfma_f32_16x16x32_bf16 v[64:67], v[88:91], v[120:123], v[64:67]
  v_mfma_f32_16x16x32_bf16 v[68:71], v[92:95], v[120:123], v[68:71]
  s_nop 3
  v_rcp_f32 v108, v108
  v_mov_b32 v126, s51
  v_pk_mul_f32 v[56:57], v[56:57], v[108:109] op_sel_hi:[1,0]
  v_pk_mul_f32 v[58:59], v[58:59], v[108:109] op_sel_hi:[1,0]
  v_pk_mul_f32 v[60:61], v[60:61], v[108:109] op_sel_hi:[1,0]
  v_pk_mul_f32 v[62:63], v[62:63], v[108:109] op_sel_hi:[1,0]
  v_cvt_pk_bf16_f32 v56, v56, v57
  v_cvt_pk_bf16_f32 v57, v58, v59
  v_cvt_pk_bf16_f32 v58, v60, v61
  v_cvt_pk_bf16_f32 v59, v62, v63
  buffer_store_dwordx4 v[56:59], v113, s[8:11], s48 offen offset:0 sc1
  v_pk_mul_f32 v[64:65], v[64:65], v[108:109] op_sel_hi:[1,0]
  v_pk_mul_f32 v[66:67], v[66:67], v[108:109] op_sel_hi:[1,0]
  v_pk_mul_f32 v[68:69], v[68:69], v[108:109] op_sel_hi:[1,0]
  v_pk_mul_f32 v[70:71], v[70:71], v[108:109] op_sel_hi:[1,0]
  v_cvt_pk_bf16_f32 v64, v64, v65
  v_cvt_pk_bf16_f32 v65, v66, v67
  v_cvt_pk_bf16_f32 v66, v68, v69
  v_cvt_pk_bf16_f32 v67, v70, v71
  buffer_store_dwordx4 v[64:67], v113, s[8:11], s48 offen offset:2048 sc1
  s_cmp_ge_u32 s32, 31
  s_cbranch_scc1 L_p_of
  s_cmp_lg_u32 s52, 0
  s_cbranch_scc1 L_p_of3
  s_waitcnt vmcnt(2)
  v_cmp_gt_u32 vcc, s49, v115
  s_cbranch_vccnz L_p_of
  s_mov_b32 s52, 1
  s_sub_u32 s6, s49, 1
  s_lshl_b32 s6, s6, 15
  s_add_u32 s45, s38, s6
  s_mov_b32 m0, s53
  s_add_u32 s6, s45, 4096
  buffer_load_dwordx4 v0, s[8:11], s45 offen offset:0 lds
  buffer_load_dwordx4 v0, s[8:11], s45 offen offset:1024 lds
  buffer_load_dwordx4 v0, s[8:11], s45 offen offset:2048 lds
  buffer_load_dwordx4 v0, s[8:11], s45 offen offset:3072 lds
  s_add_u32 m0, s53, 4096
  s_nop 0
  buffer_load_dwordx4 v0, s[8:11], s6 offen offset:0 lds
  buffer_load_dwordx4 v0, s[8:11], s6 offen offset:1024 lds
  buffer_load_dwordx4 v0, s[8:11], s6 offen offset:2048 lds
  buffer_load_dwordx4 v0, s[8:11], s6 offen offset:3072 lds
  s_waitcnt vmcnt(8)
  s_mov_b64 exec, 1
  buffer_store_dword v126, v13, s[8:11], s43 offen sc1
  s_mov_b64 exec, -1
  s_waitcnt vmcnt(1)
  s_branch L_p_of2
L_p_of3:
  s_mov_b32 s52, 2
  s_waitcnt vmcnt(2)
  s_branch L_p_of2
L_p_of:
  s_waitcnt vmcnt(0)
  s_mov_b64 exec, 1
  buffer_store_dword v126, v13, s[8:11], s43 offen sc1
  s_mov_b64 exec, -1
L_p_of2:
L_p_next:
  v_xor_b32 v2, 0x18000, v2
  v_xor_b32 v3, 0x18000, v3
  v_xor_b32 v4, 0x18000, v4
  v_xor_b32 v112, 0x18000, v112
  s_add_u32 s32, s32, 1
  s_add_u32 s33, s33, 2
  s_cmp_gt_u32 s32, 32
  s_cbranch_scc1 L_p_end
  s_cmp_eq_u32 s32, 32
  s_cbranch_scc1 L_p_tail
  s_cmp_eq_u32 s52, 0
  s_cbranch_scc1 L_p_xwait
  s_branch L_p_loop
L_p_tail:
  s_sub_u32 s51, s33, 2
  s_and_b32 s6, s51, 3
  s_lshl_b32 s6, s6, 17
  s_add_u32 s47, s40, s6
  s_lshr_b32 s6, s51, 2
  s_andn2_b32 s50, 1, s6
  s_lshl_b32 s6, s51, 18
  s_add_u32 s48, s41, s6
  s_add_u32 s51, s51, 1
  buffer_load_dwordx4 v[116:119], v0, s[8:11], s47 offen sc1
  s_waitcnt vmcnt(0) lgkmcnt(0)
  s_barrier
  s_branch L_p_att
L_p_first:
  s_waitcnt vmcnt(0) lgkmcnt(0)
  s_barrier
  s_mov_b32 s52, 0
  s_cmp_ge_u32 s32, 31
  s_cbranch_scc1 L_nx_97
  v_cmp_gt_u32 vcc, s49, v115
  s_cbranch_vccnz L_nx_97
  s_mov_b32 s52, 1
  s_sub_u32 s6, s49, 1
  s_lshl_b32 s6, s6, 15
  s_add_u32 s45, s38, s6
  s_mov_b32 m0, s53
  s_add_u32 s6, s45, 4096
  buffer_load_dwordx4 v0, s[8:11], s45 offen offset:0 lds
  buffer_load_dwordx4 v0, s[8:11], s45 offen offset:1024 lds
  buffer_load_dwordx4 v0, s[8:11], s45 offen offset:2048 lds
  buffer_load_dwordx4 v0, s[8:11], s45 offen offset:3072 lds
  s_add_u32 m0, s53, 4096
  s_nop 0
  buffer_load_dwordx4 v0, s[8:11], s6 offen offset:0 lds
  buffer_load_dwordx4 v0, s[8:11], s6 offen offset:1024 lds
  buffer_load_dwordx4 v0, s[8:11], s6 offen offset:2048 lds
  buffer_load_dwordx4 v0, s[8:11], s6 offen offset:3072 lds
L_nx_97:
  s_cmp_lg_u32 s35, 0
  s_cbranch_scc1 L_p_f2
  s_mov_b32 s51, 127
  s_mov_b32 s7, 0
L_pl_99:
  buffer_load_dwordx4 v[32:35], v0, s[8:11], s44 offen offset:0 sc1
  buffer_load_dwordx4 v[36:39], v0, s[8:11], s44 offen offset:1024 sc1
  s_waitcnt vmcnt(0)
  v_min3_u32 v32, v32, v33, v34
  v_min3_u32 v35, v35, v36, v37
  v_min3_u32 v32, v32, v38, v39
  v_min_u32 v32, v32, v35
  v_cmp_gt_u32 vcc, s51, v32
  s_cbranch_vccz L_plo_100
  s_add_u32 s7, s7, 1
  s_cmp_lt_u32 s7, 131072
  s_cbranch_scc1 L_pl_99
  s_mov_b32 s6, 24
  s_branch L_err
L_plo_100:
L_p_f2:
  s_waitcnt vmcnt(0)
  s_branch L_p_next
L_p_end:
  s_waitcnt vmcnt(0)
  s_endpgm
L_o:
  s_lshr_b32 s33, s5, 4
  s_bfe_u32 s34, s5, 0x20002
  s_and_b32 s35, s5, 3
  s_mul_i32 s36, s33, 0x1000000
  s_add_u32 s36, s36, 0x6800000
  s_lshl_b32 s6, s34, 3
  s_lshl_b32 s7, s3, 1
  s_add_u32 s6, s6, s7
  s_lshl_b32 s7, s6, 13
  s_add_u32 s36, s36, s7
  s_lshl_b32 s6, s6, 7
  s_lshl_b32 s7, s33, 13
  s_add_u32 s6, s6, s7
  s_add_u32 s38, s6, 0x718000
  s_mul_i32 s37, s33, 0x800000
  s_add_u32 s37, s37, 0x8800000
  s_lshl_b32 s6, s34, 15
  s_add_u32 s37, s37, s6
  s_lshl_b32 s6, s35, 13
  s_add_u32 s37, s37, s6
  s_lshl_b32 s6, s3, 11
  s_add_u32 s37, s37, s6
  s_lshl_b32 s6, s35, 6
  s_lshl_b32 s7, s3, 4
  s_add_u32 s6, s6, s7
  s_lshl_b32 s7, s33, 8
  s_add_u32 s6, s6, s7
  s_add_u32 s39, s6, 0x710800
  s_lshl_b32 s42, s3, 14
  s_branch L_pro
L_o2:
  v_lshlrev_b32 v0, 4, v0
  s_mov_b32 s16, s88
  s_mov_b32 s17, s89
  s_mov_b32 s18, 0x400000
  s_mov_b32 s19, 0x20000
  v_lshrrev_b32 v104, 4, v0
  v_lshrrev_b32 v100, 8, v0
  v_lshlrev_b32 v105, 2, v100
  v_and_b32 v104, 15, v104
  v_xor_b32 v104, v104, v105
  v_mul_u32_u24 v100, 1024, v100
  v_lshl_add_u32 v100, v104, 4, v100
  v_bfe_u32 v104, v0, 6, 2
  v_lshlrev_b32 v105, 2, v104
  v_bfe_u32 v106, v0, 8, 1
  v_lshlrev_b32 v106, 1, v106
  v_bfe_u32 v107, v0, 5, 1
  v_or_b32 v106, v106, v107
  s_lshl_b32 s6, s3, 2
  v_or_b32 v106, s6, v106
  v_xor_b32 v106, v106, v105
  v_lshlrev_b32 v106, 4, v106
  v_bfe_u32 v107, v0, 4, 1
  v_lshl_or_b32 v106, v107, 3, v106
  v_bfe_u32 v107, v0, 9, 1
  v_lshl_or_b32 v104, v107, 2, v104
  v_lshl_or_b32 v104, v104, 8, v106
  v_add_u32 v105, 0x10000, v104
  s_lshl_b32 s60, s3, 13
  s_mul_i32 s63, s3, 32768
  s_lshl_b32 s61, s34, 20
  s_lshl_b32 s62, s35, 8
  s_add_u32 s61, s61, s62
  s_add_u32 s61, s61, 0
  s_add_u32 s61, s61, s63
  s_add_u32 m0, s60, 0
  s_add_u32 s62, s61, 0
  buffer_load_dwordx4 v100, s[16:19], s62 offen lds
  s_add_u32 m0, s60, 1024
  s_add_u32 s62, s61, 4096
  buffer_load_dwordx4 v100, s[16:19], s62 offen lds
  s_add_u32 m0, s60, 2048
  s_add_u32 s62, s61, 8192
  buffer_load_dwordx4 v100, s[16:19], s62 offen lds
  s_add_u32 m0, s60, 3072
  s_add_u32 s62, s61, 12288
  buffer_load_dwordx4 v100, s[16:19], s62 offen lds
  s_add_u32 m0, s60, 4096
  s_add_u32 s62, s61, 16384
  buffer_load_dwordx4 v100, s[16:19], s62 offen lds
  s_add_u32 m0, s60, 5120
  s_add_u32 s62, s61, 20480
  buffer_load_dwordx4 v100, s[16:19], s62 offen lds
  s_add_u32 m0, s60, 6144
  s_add_u32 s62, s61, 24576
  buffer_load_dwordx4 v100, s[16:19], s62 offen lds
  s_add_u32 m0, s60, 7168
  s_add_u32 s62, s61, 28672
  buffer_load_dwordx4 v100, s[16:19], s62 offen lds
  s_lshl_b32 s61, s34, 20
  s_lshl_b32 s62, s35, 8
  s_add_u32 s61, s61, s62
  s_add_u32 s61, s61, 131072
  s_add_u32 s61, s61, s63
  s_add_u32 m0, s60, 32768
  s_add_u32 s62, s61, 0
  buffer_load_dwordx4 v100, s[16:19], s62 offen lds
  s_add_u32 m0, s60, 33792
  s_add_u32 s62, s61, 4096
  buffer_load_dwordx4 v100, s[16:19], s62 offen lds
  s_add_u32 m0, s60, 34816
  s_add_u32 s62, s61, 8192
  buffer_load_dwordx4 v100, s[16:19], s62 offen lds
  s_add_u32 m0, s60, 35840
  s_add_u32 s62, s61, 12288
  buffer_load_dwordx4 v100, s[16:19], s62 offen lds
  s_add_u32 m0, s60, 36864
  s_add_u32 s62, s61, 16384
  buffer_load_dwordx4 v100, s[16:19], s62 offen lds
  s_add_u32 m0, s60, 37888
  s_add_u32 s62, s61, 20480
  buffer_load_dwordx4 v100, s[16:19], s62 offen lds
  s_add_u32 m0, s60, 38912
  s_add_u32 s62, s61, 24576
  buffer_load_dwordx4 v100, s[16:19], s62 offen lds
  s_add_u32 m0, s60, 39936
  s_add_u32 s62, s61, 28672
  buffer_load_dwordx4 v100, s[16:19], s62 offen lds
  s_lshl_b32 s61, s34, 20
  s_lshl_b32 s62, s35, 8
  s_add_u32 s61, s61, s62
  s_add_u32 s61, s61, 262144
  s_add_u32 s61, s61, s63
  s_add_u32 m0, s60, 65536
  s_add_u32 s62, s61, 0
  buffer_load_dwordx4 v100, s[16:19], s62 offen lds
  s_add_u32 m0, s60, 66560
  s_add_u32 s62, s61, 4096
  buffer_load_dwordx4 v100, s[16:19], s62 offen lds
  s_add_u32 m0, s60, 67584
  s_add_u32 s62, s61, 8192
  buffer_load_dwordx4 v100, s[16:19], s62 offen lds
  s_add_u32 m0, s60, 68608
  s_add_u32 s62, s61, 12288
  buffer_load_dwordx4 v100, s[16:19], s62 offen lds
  s_add_u32 m0, s60, 69632
  s_add_u32 s62, s61, 16384
  buffer_load_dwordx4 v100, s[16:19], s62 offen lds
  s_add_u32 m0, s60, 70656
  s_add_u32 s62, s61, 20480
  buffer_load_dwordx4 v100, s[16:19], s62 offen lds
  s_add_u32 m0, s60, 71680
  s_add_u32 s62, s61, 24576
  buffer_load_dwordx4 v100, s[16:19], s62 offen lds
  s_add_u32 m0, s60, 72704
  s_add_u32 s62, s61, 28672
  buffer_load_dwordx4 v100, s[16:19], s62 offen lds
  s_waitcnt vmcnt(16)
  s_barrier
  s_lshl_b32 s61, s34, 20
  s_lshl_b32 s62, s35, 8
  s_add_u32 s61, s61, s62
  s_add_u32 s61, s61, 393216
  s_add_u32 s61, s61, s63
  s_add_u32 m0, s60, 98304
  s_add_u32 s62, s61, 0
  buffer_load_dwordx4 v100, s[16:19], s62 offen lds
  s_add_u32 m0, s60, 99328
  s_add_u32 s62, s61, 4096
  buffer_load_dwordx4 v100, s[16:19], s62 offen lds
  s_add_u32 m0, s60, 100352
  s_add_u32 s62, s61, 8192
  buffer_load_dwordx4 v100, s[16:19], s62 offen lds
  s_add_u32 m0, s60, 101376
  s_add_u32 s62, s61, 12288
  buffer_load_dwordx4 v100, s[16:19], s62 offen lds
  s_add_u32 m0, s60, 102400
  s_add_u32 s62, s61, 16384
  buffer_load_dwordx4 v100, s[16:19], s62 offen lds
  s_add_u32 m0, s60, 103424
  s_add_u32 s62, s61, 20480
  buffer_load_dwordx4 v100, s[16:19], s62 offen lds
  s_add_u32 m0, s60, 104448
  s_add_u32 s62, s61, 24576
  buffer_load_dwordx4 v100, s[16:19], s62 offen lds
  s_add_u32 m0, s60, 105472
  s_add_u32 s62, s61, 28672
  buffer_load_dwordx4 v100, s[16:19], s62 offen lds
  ds_read_b64_tr_b16 a[0:1], v104 offset:0
  ds_read_b64_tr_b16 a[2:3], v104 offset:4096
  ds_read_b64_tr_b16 a[4:5], v104 offset:2048
  ds_read_b64_tr_b16 a[6:7], v104 offset:6144
  ds_read_b64_tr_b16 a[8:9], v104 offset:8192
  ds_read_b64_tr_b16 a[10:11], v104 offset:12288
  ds_read_b64_tr_b16 a[12:13], v104 offset:10240
  ds_read_b64_tr_b16 a[14:15], v104 offset:14336
  ds_read_b64_tr_b16 a[16:17], v104 offset:16384
  ds_read_b64_tr_b16 a[18:19], v104 offset:20480
  ds_read_b64_tr_b16 a[20:21], v104 offset:18432
  ds_read_b64_tr_b16 a[22:23], v104 offset:22528
  ds_read_b64_tr_b16 a[24:25], v104 offset:24576
  ds_read_b64_tr_b16 a[26:27], v104 offset:28672
  ds_read_b64_tr_b16 a[28:29], v104 offset:26624
  ds_read_b64_tr_b16 a[30:31], v104 offset:30720
  s_waitcnt lgkmcnt(0)
  s_waitcnt vmcnt(16)
  s_barrier
  s_lshl_b32 s61, s34, 20
  s_lshl_b32 s62, s35, 8
  s_add_u32 s61, s61, s62
  s_add_u32 s61, s61, 524288
  s_add_u32 s61, s61, s63
  s_add_u32 m0, s60, 0
  s_add_u32 s62, s61, 0
  buffer_load_dwordx4 v100, s[16:19], s62 offen lds
  s_add_u32 m0, s60, 1024
  s_add_u32 s62, s61, 4096
  buffer_load_dwordx4 v100, s[16:19], s62 offen lds
  s_add_u32 m0, s60, 2048
  s_add_u32 s62, s61, 8192
  buffer_load_dwordx4 v100, s[16:19], s62 offen lds
  s_add_u32 m0, s60, 3072
  s_add_u32 s62, s61, 12288
  buffer_load_dwordx4 v100, s[16:19], s62 offen lds
  s_add_u32 m0, s60, 4096
  s_add_u32 s62, s61, 16384
  buffer_load_dwordx4 v100, s[16:19], s62 offen lds
  s_add_u32 m0, s60, 5120
  s_add_u32 s62, s61, 20480
  buffer_load_dwordx4 v100, s[16:19], s62 offen lds
  s_add_u32 m0, s60, 6144
  s_add_u32 s62, s61, 24576
  buffer_load_dwordx4 v100, s[16:19], s62 offen lds
  s_add_u32 m0, s60, 7168
  s_add_u32 s62, s61, 28672
  buffer_load_dwordx4 v100, s[16:19], s62 offen lds
  ds_read_b64_tr_b16 a[32:33], v104 offset:32768
  ds_read_b64_tr_b16 a[34:35], v104 offset:36864
  ds_read_b64_tr_b16 a[36:37], v104 offset:34816
  ds_read_b64_tr_b16 a[38:39], v104 offset:38912
  ds_read_b64_tr_b16 a[40:41], v104 offset:40960
  ds_read_b64_tr_b16 a[42:43], v104 offset:45056
  ds_read_b64_tr_b16 a[44:45], v104 offset:43008
  ds_read_b64_tr_b16 a[46:47], v104 offset:47104
  ds_read_b64_tr_b16 a[48:49], v104 offset:49152
  ds_read_b64_tr_b16 a[50:51], v104 offset:53248
  ds_read_b64_tr_b16 a[52:53], v104 offset:51200
  ds_read_b64_tr_b16 a[54:55], v104 offset:55296
  ds_read_b64_tr_b16 a[56:57], v104 offset:57344
  ds_read_b64_tr_b16 a[58:59], v104 offset:61440
  ds_read_b64_tr_b16 a[60:61], v104 offset:59392
  ds_read_b64_tr_b16 a[62:63], v104 offset:63488
  s_waitcnt lgkmcnt(0)
  s_waitcnt vmcnt(16)
  s_barrier
  s_lshl_b32 s61, s34, 20
  s_lshl_b32 s62, s35, 8
  s_add_u32 s61, s61, s62
  s_add_u32 s61, s61, 655360
  s_add_u32 s61, s61, s63
  s_add_u32 m0, s60, 32768
  s_add_u32 s62, s61, 0
  buffer_load_dwordx4 v100, s[16:19], s62 offen lds
  s_add_u32 m0, s60, 33792
  s_add_u32 s62, s61, 4096
  buffer_load_dwordx4 v100, s[16:19], s62 offen lds
  s_add_u32 m0, s60, 34816
  s_add_u32 s62, s61, 8192
  buffer_load_dwordx4 v100, s[16:19], s62 offen lds
  s_add_u32 m0, s60, 35840
  s_add_u32 s62, s61, 12288
  buffer_load_dwordx4 v100, s[16:19], s62 offen lds
  s_add_u32 m0, s60, 36864
  s_add_u32 s62, s61, 16384
  buffer_load_dwordx4 v100, s[16:19], s62 offen lds
  s_add_u32 m0, s60, 37888
  s_add_u32 s62, s61, 20480
  buffer_load_dwordx4 v100, s[16:19], s62 offen lds
  s_add_u32 m0, s60, 38912
  s_add_u32 s62, s61, 24576
  buffer_load_dwordx4 v100, s[16:19], s62 offen lds
  s_add_u32 m0, s60, 39936
  s_add_u32 s62, s61, 28672
  buffer_load_dwordx4 v100, s[16:19], s62 offen lds
  ds_read_b64_tr_b16 a[64:65], v105 offset:0
  ds_read_b64_tr_b16 a[66:67], v105 offset:4096
  ds_read_b64_tr_b16 a[68:69], v105 offset:2048
  ds_read_b64_tr_b16 a[70:71], v105 offset:6144
  ds_read_b64_tr_b16 a[72:73], v105 offset:8192
  ds_read_b64_tr_b16 a[74:75], v105 offset:12288
  ds_read_b64_tr_b16 a[76:77], v105 offset:10240
  ds_read_b64_tr_b16 a[78:79], v105 offset:14336
  ds_read_b64_tr_b16 a[80:81], v105 offset:16384
  ds_read_b64_tr_b16 a[82:83], v105 offset:20480
  ds_read_b64_tr_b16 a[84:85], v105 offset:18432
  ds_read_b64_tr_b16 a[86:87], v105 offset:22528
  ds_read_b64_tr_b16 a[88:89], v105 offset:24576
  ds_read_b64_tr_b16 a[90:91], v105 offset:28672
  ds_read_b64_tr_b16 a[92:93], v105 offset:26624
  ds_read_b64_tr_b16 a[94:95], v105 offset:30720
  s_waitcnt lgkmcnt(0)
  s_waitcnt vmcnt(16)
  s_barrier
  s_lshl_b32 s61, s34, 20
  s_lshl_b32 s62, s35, 8
  s_add_u32 s61, s61, s62
  s_add_u32 s61, s61, 786432
  s_add_u32 s61, s61, s63
  s_add_u32 m0, s60, 65536
  s_add_u32 s62, s61, 0
  buffer_load_dwordx4 v100, s[16:19], s62 offen lds
  s_add_u32 m0, s60, 66560
  s_add_u32 s62, s61, 4096
  buffer_load_dwordx4 v100, s[16:19], s62 offen lds
  s_add_u32 m0, s60, 67584
  s_add_u32 s62, s61, 8192
  buffer_load_dwordx4 v100, s[16:19], s62 offen lds
  s_add_u32 m0, s60, 68608
  s_add_u32 s62, s61, 12288
  buffer_load_dwordx4 v100, s[16:19], s62 offen lds
  s_add_u32 m0, s60, 69632
  s_add_u32 s62, s61, 16384
  buffer_load_dwordx4 v100, s[16:19], s62 offen lds
  s_add_u32 m0, s60, 70656
  s_add_u32 s62, s61, 20480
  buffer_load_dwordx4 v100, s[16:19], s62 offen lds
  s_add_u32 m0, s60, 71680
  s_add_u32 s62, s61, 24576
  buffer_load_dwordx4 v100, s[16:19], s62 offen lds
  s_add_u32 m0, s60, 72704
  s_add_u32 s62, s61, 28672
  buffer_load_dwordx4 v100, s[16:19], s62 offen lds
  ds_read_b64_tr_b16 a[96:97], v105 offset:32768
  ds_read_b64_tr_b16 a[98:99], v105 offset:36864
  ds_read_b64_tr_b16 a[100:101], v105 offset:34816
  ds_read_b64_tr_b16 a[102:103], v105 offset:38912
  ds_read_b64_tr_b16 a[104:105], v105 offset:40960
  ds_read_b64_tr_b16 a[106:107], v105 offset:45056
  ds_read_b64_tr_b16 a[108:109], v105 offset:43008
  ds_read_b64_tr_b16 a[110:111], v105 offset:47104
  ds_read_b64_tr_b16 a[112:113], v105 offset:49152
  ds_read_b64_tr_b16 a[114:115], v105 offset:53248
  ds_read_b64_tr_b16 a[116:117], v105 offset:51200
  ds_read_b64_tr_b16 a[118:119], v105 offset:55296
  ds_read_b64_tr_b16 a[120:121], v105 offset:57344
  ds_read_b64_tr_b16 a[122:123], v105 offset:61440
  ds_read_b64_tr_b16 a[124:125], v105 offset:59392
  ds_read_b64_tr_b16 a[126:127], v105 offset:63488
  s_waitcnt lgkmcnt(0)
  s_waitcnt vmcnt(16)
  s_barrier
  s_lshl_b32 s61, s34, 20
  s_lshl_b32 s62, s35, 8
  s_add_u32 s61, s61, s62
  s_add_u32 s61, s61, 917504
  s_add_u32 s61, s61, s63
  s_add_u32 m0, s60, 98304
  s_add_u32 s62, s61, 0
  buffer_load_dwordx4 v100, s[16:19], s62 offen lds
  s_add_u32 m0, s60, 99328
  s_add_u32 s62, s61, 4096
  buffer_load_dwordx4 v100, s[16:19], s62 offen lds
  s_add_u32 m0, s60, 100352
  s_add_u32 s62, s61, 8192
  buffer_load_dwordx4 v100, s[16:19], s62 offen lds
  s_add_u32 m0, s60, 101376
  s_add_u32 s62, s61, 12288
  buffer_load_dwordx4 v100, s[16:19], s62 offen lds
  s_add_u32 m0, s60, 102400
  s_add_u32 s62, s61, 16384
  buffer_load_dwordx4 v100, s[16:19], s62 offen lds
  s_add_u32 m0, s60, 103424
  s_add_u32 s62, s61, 20480
  buffer_load_dwordx4 v100, s[16:19], s62 offen lds
  s_add_u32 m0, s60, 104448
  s_add_u32 s62, s61, 24576
  buffer_load_dwordx4 v100, s[16:19], s62 offen lds
  s_add_u32 m0, s60, 105472
  s_add_u32 s62, s61, 28672
  buffer_load_dwordx4 v100, s[16:19], s62 offen lds
  ds_read_b64_tr_b16 a[128:129], v104 offset:0
  ds_read_b64_tr_b16 a[130:131], v104 offset:4096
  ds_read_b64_tr_b16 a[132:133], v104 offset:2048
  ds_read_b64_tr_b16 a[134:135], v104 offset:6144
  ds_read_b64_tr_b16 a[136:137], v104 offset:8192
  ds_read_b64_tr_b16 a[138:139], v104 offset:12288
  ds_read_b64_tr_b16 a[140:141], v104 offset:10240
  ds_read_b64_tr_b16 a[142:143], v104 offset:14336
  ds_read_b64_tr_b16 a[144:145], v104 offset:16384
  ds_read_b64_tr_b16 a[146:147], v104 offset:20480
  ds_read_b64_tr_b16 a[148:149], v104 offset:18432
  ds_read_b64_tr_b16 a[150:151], v104 offset:22528
  ds_read_b64_tr_b16 a[152:153], v104 offset:24576
  ds_read_b64_tr_b16 a[154:155], v104 offset:28672
  ds_read_b64_tr_b16 a[156:157], v104 offset:26624
  ds_read_b64_tr_b16 a[158:159], v104 offset:30720
  s_waitcnt lgkmcnt(0)
  s_waitcnt vmcnt(16)
  s_barrier
  ds_read_b64_tr_b16 a[160:161], v104 offset:32768
  ds_read_b64_tr_b16 a[162:163], v104 offset:36864
  ds_read_b64_tr_b16 a[164:165], v104 offset:34816
  ds_read_b64_tr_b16 a[166:167], v104 offset:38912
  ds_read_b64_tr_b16 a[168:169], v104 offset:40960
  ds_read_b64_tr_b16 a[170:171], v104 offset:45056
  ds_read_b64_tr_b16 a[172:173], v104 offset:43008
  ds_read_b64_tr_b16 a[174:175], v104 offset:47104
  ds_read_b64_tr_b16 a[176:177], v104 offset:49152
  ds_read_b64_tr_b16 a[178:179], v104 offset:53248
  ds_read_b64_tr_b16 a[180:181], v104 offset:51200
  ds_read_b64_tr_b16 a[182:183], v104 offset:55296
  ds_read_b64_tr_b16 a[184:185], v104 offset:57344
  ds_read_b64_tr_b16 a[186:187], v104 offset:61440
  ds_read_b64_tr_b16 a[188:189], v104 offset:59392
  ds_read_b64_tr_b16 a[190:191], v104 offset:63488
  s_waitcnt lgkmcnt(0)
  s_waitcnt vmcnt(8)
  s_barrier
  ds_read_b64_tr_b16 a[192:193], v105 offset:0
  ds_read_b64_tr_b16 a[194:195], v105 offset:4096
  ds_read_b64_tr_b16 a[196:197], v105 offset:2048
  ds_read_b64_tr_b16 a[198:199], v105 offset:6144
  ds_read_b64_tr_b16 a[200:201], v105 offset:8192
  ds_read_b64_tr_b16 a[202:203], v105 offset:12288
  ds_read_b64_tr_b16 a[204:205], v105 offset:10240
  ds_read_b64_tr_b16 a[206:207], v105 offset:14336
  ds_read_b64_tr_b16 a[208:209], v105 offset:16384
  ds_read_b64_tr_b16 a[210:211], v105 offset:20480
  ds_read_b64_tr_b16 a[212:213], v105 offset:18432
  ds_read_b64_tr_b16 a[214:215], v105 offset:22528
  ds_read_b64_tr_b16 a[216:217], v105 offset:24576
  ds_read_b64_tr_b16 a[218:219], v105 offset:28672
  ds_read_b64_tr_b16 a[220:221], v105 offset:26624
  ds_read_b64_tr_b16 a[222:223], v105 offset:30720
  s_waitcnt lgkmcnt(0)
  s_waitcnt vmcnt(0)
  s_barrier
  ds_read_b64_tr_b16 a[224:225], v105 offset:32768
  ds_read_b64_tr_b16 a[226:227], v105 offset:36864
  ds_read_b64_tr_b16 a[228:229], v105 offset:34816
  ds_read_b64_tr_b16 a[230:231], v105 offset:38912
  ds_read_b64_tr_b16 a[232:233], v105 offset:40960
  ds_read_b64_tr_b16 a[234:235], v105 offset:45056
  ds_read_b64_tr_b16 a[236:237], v105 offset:43008
  ds_read_b64_tr_b16 a[238:239], v105 offset:47104
  ds_read_b64_tr_b16 a[240:241], v105 offset:49152
  ds_read_b64_tr_b16 a[242:243], v105 offset:53248
  ds_read_b64_tr_b16 a[244:245], v105 offset:51200
  ds_read_b64_tr_b16 a[246:247], v105 offset:55296
  ds_read_b64_tr_b16 a[248:249], v105 offset:57344
  ds_read_b64_tr_b16 a[250:251], v105 offset:61440
  ds_read_b64_tr_b16 a[252:253], v105 offset:59392
  ds_read_b64_tr_b16 a[254:255], v105 offset:63488
  s_waitcnt lgkmcnt(0)
  s_barrier
  v_mov_b32 v3, 0
  v_mov_b32 v1, v0
  v_bfe_u32 v2, v0, 6, 1
  v_lshlrev_b32 v2, 7, v2
  v_bfe_u32 v4, v0, 2, 4
  v_or_b32 v2, v2, v4
  v_bfe_u32 v6, v0, 2, 4
  v_and_b32 v6, 12, v6
  s_mov_b32 s7, 0
  v_mbcnt_lo_u32_b32 v16, -1, 0
  v_and_b32 v16, 3, v16
  v_lshlrev_b32 v16, 6, v16
L_wd_101:
  buffer_load_dword v17, v16, s[12:15], 0 offen offset:16 sc1
  s_waitcnt vmcnt(0)
  v_cmp_ne_u32 vcc, 64, v17
  s_cbranch_vccz L_wdo_102
  s_add_u32 s7, s7, 1
  s_cmp_lt_u32 s7, 131072
  s_cbranch_scc1 L_wd_101
  s_mov_b32 s6, 30
  s_branch L_err
L_wdo_102:
  s_mov_b32 s32, 0
  s_mov_b32 s41, 1
  s_mov_b32 s40, s38
L_o_wait:
  s_mov_b32 s7, 0
L_pl_103:
  buffer_load_dword v4, v2, s[8:11], s40 offen offset:0 sc1
  s_waitcnt vmcnt(0)
  v_cmp_gt_u32 vcc, s41, v4
  s_cbranch_vccz L_plo_104
  s_add_u32 s7, s7, 1
  s_cmp_lt_u32 s7, 131072
  s_cbranch_scc1 L_pl_103
  s_mov_b32 s6, 31
  s_branch L_err
L_plo_104:
L_o_go:
  s_sub_u32 s6, s41, 1
  s_lshl_b32 s6, s6, 18
  s_add_u32 s44, s36, s6
  s_add_u32 m0, s42, 0
  s_add_u32 s45, s44, 0
  buffer_load_dwordx4 v0, s[8:11], s45 offen offset:0 lds
  buffer_load_dwordx4 v0, s[8:11], s45 offen offset:1024 lds
  buffer_load_dwordx4 v0, s[8:11], s45 offen offset:2048 lds
  buffer_load_dwordx4 v0, s[8:11], s45 offen offset:3072 lds
  s_add_u32 m0, s42, 4096
  s_add_u32 s45, s44, 4096
  buffer_load_dwordx4 v0, s[8:11], s45 offen offset:0 lds
  buffer_load_dwordx4 v0, s[8:11], s45 offen offset:1024 lds
  buffer_load_dwordx4 v0, s[8:11], s45 offen offset:2048 lds
  buffer_load_dwordx4 v0, s[8:11], s45 offen offset:3072 lds
  s_add_u32 m0, s42, 8192
  s_add_u32 s45, s44, 8192
  buffer_load_dwordx4 v0, s[8:11], s45 offen offset:0 lds
  buffer_load_dwordx4 v0, s[8:11], s45 offen offset:1024 lds
  buffer_load_dwordx4 v0, s[8:11], s45 offen offset:2048 lds
  buffer_load_dwordx4 v0, s[8:11], s45 offen offset:3072 lds
  s_add_u32 m0, s42, 12288
  s_add_u32 s45, s44, 12288
  buffer_load_dwordx4 v0, s[8:11], s45 offen offset:0 lds
  buffer_load_dwordx4 v0, s[8:11], s45 offen offset:1024 lds
  buffer_load_dwordx4 v0, s[8:11], s45 offen offset:2048 lds
  buffer_load_dwordx4 v0, s[8:11], s45 offen offset:3072 lds
  s_xor_b32 s42, s42, 0x10000
  s_mov_b32 s43, 0
  s_waitcnt vmcnt(8)
L_o_loop:
  s_barrier
  ds_read_b128 v[32:35], v1 offset:0
  ds_read_b128 v[36:39], v1 offset:1024
  ds_read_b128 v[40:43], v1 offset:2048
  s_add_u32 s41, s32, 2
  s_xor_b32 s40, s40, 0x1000
  buffer_load_dword v4, v2, s[8:11], s40 offen sc1
  buffer_load_dword v5, v6, s[8:11], s39 offen sc1
  s_waitcnt lgkmcnt(2)
  v_mfma_f32_32x32x16_bf16 v[16:31], a[0:3], v[32:35], 0
  ds_read_b128 v[44:47], v1 offset:3072
  s_waitcnt lgkmcnt(2)
  v_mfma_f32_32x32x16_bf16 v[16:31], a[4:7], v[36:39], v[16:31]
  ds_read_b128 v[32:35], v1 offset:4096
  s_waitcnt lgkmcnt(2)
  v_mfma_f32_32x32x16_bf16 v[16:31], a[8:11], v[40:43], v[16:31]
  ds_read_b128 v[36:39], v1 offset:5120
  s_waitcnt lgkmcnt(2)
  v_mfma_f32_32x32x16_bf16 v[16:31], a[12:15], v[44:47], v[16:31]
  ds_read_b128 v[40:43], v1 offset:6144
  s_waitcnt lgkmcnt(2)
  v_mfma_f32_32x32x16_bf16 v[16:31], a[16:19], v[32:35], v[16:31]
  ds_read_b128 v[44:47], v1 offset:7168
  s_waitcnt lgkmcnt(2)
  v_mfma_f32_32x32x16_bf16 v[16:31], a[20:23], v[36:39], v[16:31]
  ds_read_b128 v[32:35], v1 offset:16384
  s_waitcnt lgkmcnt(2)
  v_mfma_f32_32x32x16_bf16 v[16:31], a[24:27], v[40:43], v[16:31]
  ds_read_b128 v[36:39], v1 offset:17408
  s_waitcnt lgkmcnt(2)
  v_mfma_f32_32x32x16_bf16 v[16:31], a[28:31], v[44:47], v[16:31]
  ds_read_b128 v[40:43], v1 offset:18432
  s_waitcnt lgkmcnt(2)
  v_mfma_f32_32x32x16_bf16 v[16:31], a[64:67], v[32:35], v[16:31]
  ds_read_b128 v[44:47], v1 offset:19456
  s_waitcnt lgkmcnt(2)
  v_mfma_f32_32x32x16_bf16 v[16:31], a[68:71], v[36:39], v[16:31]
  ds_read_b128 v[32:35], v1 offset:20480
  s_waitcnt lgkmcnt(2)
  v_mfma_f32_32x32x16_bf16 v[16:31], a[72:75], v[40:43], v[16:31]
  ds_read_b128 v[36:39], v1 offset:21504
  s_waitcnt lgkmcnt(2)
  v_mfma_f32_32x32x16_bf16 v[16:31], a[76:79], v[44:47], v[16:31]
  ds_read_b128 v[40:43], v1 offset:22528
  s_waitcnt lgkmcnt(2)
  v_mfma_f32_32x32x16_bf16 v[16:31], a[80:83], v[32:35], v[16:31]
  ds_read_b128 v[44:47], v1 offset:23552
  s_waitcnt lgkmcnt(2)
  v_mfma_f32_32x32x16_bf16 v[16:31], a[84:87], v[36:39], v[16:31]
  ds_read_b128 v[32:35], v1 offset:32768
  s_waitcnt lgkmcnt(2)
  v_mfma_f32_32x32x16_bf16 v[16:31], a[88:91], v[40:43], v[16:31]
  ds_read_b128 v[36:39], v1 offset:33792
  s_waitcnt lgkmcnt(2)
  v_mfma_f32_32x32x16_bf16 v[16:31], a[92:95], v[44:47], v[16:31]
  ds_read_b128 v[40:43], v1 offset:34816
  s_waitcnt lgkmcnt(2)
  v_mfma_f32_32x32x16_bf16 v[16:31], a[128:131], v[32:35], v[16:31]
  ds_read_b128 v[44:47], v1 offset:35840
  s_waitcnt lgkmcnt(2)
  v_mfma_f32_32x32x16_bf16 v[16:31], a[132:135], v[36:39], v[16:31]
  ds_read_b128 v[32:35], v1 offset:36864
  s_waitcnt lgkmcnt(2)
  v_mfma_f32_32x32x16_bf16 v[16:31], a[136:139], v[40:43], v[16:31]
  ds_read_b128 v[36:39], v1 offset:37888
  s_waitcnt lgkmcnt(2)
  v_mfma_f32_32x32x16_bf16 v[16:31], a[140:143], v[44:47], v[16:31]
  ds_read_b128 v[40:43], v1 offset:38912
  s_waitcnt lgkmcnt(2)
  v_mfma_f32_32x32x16_bf16 v[16:31], a[144:147], v[32:35], v[16:31]
  ds_read_b128 v[44:47], v1 offset:39936
  s_waitcnt lgkmcnt(2)
  v_mfma_f32_32x32x16_bf16 v[16:31], a[148:151], v[36:39], v[16:31]
  ds_read_b128 v[32:35], v1 offset:49152
  s_waitcnt lgkmcnt(2)
  v_mfma_f32_32x32x16_bf16 v[16:31], a[152:155], v[40:43], v[16:31]
  ds_read_b128 v[36:39], v1 offset:50176
  s_waitcnt lgkmcnt(2)
  v_mfma_f32_32x32x16_bf16 v[16:31], a[156:159], v[44:47], v[16:31]
  ds_read_b128 v[40:43], v1 offset:51200
  s_waitcnt lgkmcnt(2)
  v_mfma_f32_32x32x16_bf16 v[16:31], a[192:195], v[32:35], v[16:31]
  ds_read_b128 v[44:47], v1 offset:52224
  s_waitcnt lgkmcnt(2)
  v_mfma_f32_32x32x16_bf16 v[16:31], a[196:199], v[36:39], v[16:31]
  ds_read_b128 v[32:35], v1 offset:53248
  s_waitcnt lgkmcnt(2)
  v_mfma_f32_32x32x16_bf16 v[16:31], a[200:203], v[40:43], v[16:31]
  ds_read_b128 v[36:39], v1 offset:54272
  s_waitcnt lgkmcnt(2)
  v_mfma_f32_32x32x16_bf16 v[16:31], a[204:207], v[44:47], v[16:31]
  ds_read_b128 v[40:43], v1 offset:55296
  s_waitcnt lgkmcnt(2)
  v_mfma_f32_32x32x16_bf16 v[16:31], a[208:211], v[32:35], v[16:31]
  ds_read_b128 v[44:47], v1 offset:56320
  s_waitcnt lgkmcnt(2)
  v_mfma_f32_32x32x16_bf16 v[16:31], a[212:215], v[36:39], v[16:31]
  s_waitcnt lgkmcnt(1)
  v_mfma_f32_32x32x16_bf16 v[16:31], a[216:219], v[40:43], v[16:31]
  s_waitcnt lgkmcnt(0)
  v_mfma_f32_32x32x16_bf16 v[16:31], a[220:223], v[44:47], v[16:31]
  s_waitcnt vmcnt(0)
  s_barrier
  ds_read_b128 v[32:35], v1 offset:8192
  ds_read_b128 v[36:39], v1 offset:9216
  ds_read_b128 v[40:43], v1 offset:10240
  s_mov_b32 s43, 0
  s_cmp_eq_u32 s32, 63
  s_cbranch_scc1 L_on_105
  v_cmp_gt_u32 vcc, s41, v4
  s_cbranch_vccnz L_on_105
  s_mov_b32 s43, 1
  s_waitcnt lgkmcnt(2)
  v_mfma_f32_32x32x16_bf16 v[16:31], a[32:35], v[32:35], v[16:31]
  ds_read_b128 v[44:47], v1 offset:11264
  s_sub_u32 s6, s41, 1
  s_lshl_b32 s6, s6, 18
  s_add_u32 s44, s36, s6
  s_waitcnt lgkmcnt(2)
  v_mfma_f32_32x32x16_bf16 v[16:31], a[36:39], v[36:39], v[16:31]
  ds_read_b128 v[32:35], v1 offset:12288
  s_add_u32 m0, s42, 0
  s_add_u32 s45, s44, 0
  buffer_load_dwordx4 v0, s[8:11], s45 offen offset:0 lds
  s_waitcnt lgkmcnt(2)
  v_mfma_f32_32x32x16_bf16 v[16:31], a[40:43], v[40:43], v[16:31]
  ds_read_b128 v[36:39], v1 offset:13312
  buffer_load_dwordx4 v0, s[8:11], s45 offen offset:1024 lds
  s_waitcnt lgkmcnt(2)
  v_mfma_f32_32x32x16_bf16 v[16:31], a[44:47], v[44:47], v[16:31]
  ds_read_b128 v[40:43], v1 offset:14336
  buffer_load_dwordx4 v0, s[8:11], s45 offen offset:2048 lds
  s_waitcnt lgkmcnt(2)
  v_mfma_f32_32x32x16_bf16 v[16:31], a[48:51], v[32:35], v[16:31]
  ds_read_b128 v[44:47], v1 offset:15360
  buffer_load_dwordx4 v0, s[8:11], s45 offen offset:3072 lds
  s_waitcnt lgkmcnt(2)
  v_mfma_f32_32x32x16_bf16 v[16:31], a[52:55], v[36:39], v[16:31]
  ds_read_b128 v[32:35], v1 offset:24576
  s_waitcnt lgkmcnt(2)
  v_mfma_f32_32x32x16_bf16 v[16:31], a[56:59], v[40:43], v[16:31]
  ds_read_b128 v[36:39], v1 offset:25600
  s_add_u32 m0, s42, 4096
  s_add_u32 s45, s44, 4096
  buffer_load_dwordx4 v0, s[8:11], s45 offen offset:0 lds
  s_waitcnt lgkmcnt(2)
  v_mfma_f32_32x32x16_bf16 v[16:31], a[60:63], v[44:47], v[16:31]
  ds_read_b128 v[40:43], v1 offset:26624
  s_waitcnt lgkmcnt(2)
  v_mfma_f32_32x32x16_bf16 v[16:31], a[96:99], v[32:35], v[16:31]
  ds_read_b128 v[44:47], v1 offset:27648
  buffer_load_dwordx4 v0, s[8:11], s45 offen offset:1024 lds
  s_waitcnt lgkmcnt(2)
  v_mfma_f32_32x32x16_bf16 v[16:31], a[100:103], v[36:39], v[16:31]
  ds_read_b128 v[32:35], v1 offset:28672
  s_waitcnt lgkmcnt(2)
  v_mfma_f32_32x32x16_bf16 v[16:31], a[104:107], v[40:43], v[16:31]
  ds_read_b128 v[36:39], v1 offset:29696
  buffer_load_dwordx4 v0, s[8:11], s45 offen offset:2048 lds
  s_waitcnt lgkmcnt(2)
  v_mfma_f32_32x32x16_bf16 v[16:31], a[108:111], v[44:47], v[16:31]
  ds_read_b128 v[40:43], v1 offset:30720
  s_waitcnt lgkmcnt(2)
  v_mfma_f32_32x32x16_bf16 v[16:31], a[112:115], v[32:35], v[16:31]
  ds_read_b128 v[44:47], v1 offset:31744
  buffer_load_dwordx4 v0, s[8:11], s45 offen offset:3072 lds
  s_waitcnt lgkmcnt(2)
  v_mfma_f32_32x32x16_bf16 v[16:31], a[116:119], v[36:39], v[16:31]
  ds_read_b128 v[32:35], v1 offset:40960
  s_waitcnt lgkmcnt(2)
  v_mfma_f32_32x32x16_bf16 v[16:31], a[120:123], v[40:43], v[16:31]
  ds_read_b128 v[36:39], v1 offset:41984
  s_add_u32 m0, s42, 8192
  s_add_u32 s45, s44, 8192
  buffer_load_dwordx4 v0, s[8:11], s45 offen offset:0 lds
  s_waitcnt lgkmcnt(2)
  v_mfma_f32_32x32x16_bf16 v[16:31], a[124:127], v[44:47], v[16:31]
  ds_read_b128 v[40:43], v1 offset:43008
  s_waitcnt lgkmcnt(2)
  v_mfma_f32_32x32x16_bf16 v[16:31], a[160:163], v[32:35], v[16:31]
  ds_read_b128 v[44:47], v1 offset:44032
  buffer_load_dwordx4 v0, s[8:11], s45 offen offset:1024 lds
  s_waitcnt lgkmcnt(2)
  v_mfma_f32_32x32x16_bf16 v[16:31], a[164:167], v[36:39], v[16:31]
  ds_read_b128 v[32:35], v1 offset:45056
  s_waitcnt lgkmcnt(2)
  v_mfma_f32_32x32x16_bf16 v[16:31], a[168:171], v[40:43], v[16:31]
  ds_read_b128 v[36:39], v1 offset:46080
  buffer_load_dwordx4 v0, s[8:11], s45 offen offset:2048 lds
  s_waitcnt lgkmcnt(2)
  v_mfma_f32_32x32x16_bf16 v[16:31], a[172:175], v[44:47], v[16:31]
  ds_read_b128 v[40:43], v1 offset:47104
  s_waitcnt lgkmcnt(2)
  v_mfma_f32_32x32x16_bf16 v[16:31], a[176:179], v[32:35], v[16:31]
  ds_read_b128 v[44:47], v1 offset:48128
  buffer_load_dwordx4 v0, s[8:11], s45 offen offset:3072 lds
  s_waitcnt lgkmcnt(2)
  v_mfma_f32_32x32x16_bf16 v[16:31], a[180:183], v[36:39], v[16:31]
  ds_read_b128 v[32:35], v1 offset:57344
  s_waitcnt lgkmcnt(2)
  v_mfma_f32_32x32x16_bf16 v[16:31], a[184:187], v[40:43], v[16:31]
  ds_read_b128 v[36:39], v1 offset:58368
  s_add_u32 m0, s42, 12288
  s_add_u32 s45, s44, 12288
  buffer_load_dwordx4 v0, s[8:11], s45 offen offset:0 lds
  s_waitcnt lgkmcnt(2)
  v_mfma_f32_32x32x16_bf16 v[16:31], a[188:191], v[44:47], v[16:31]
  ds_read_b128 v[40:43], v1 offset:59392
  s_waitcnt lgkmcnt(2)
  v_mfma_f32_32x32x16_bf16 v[16:31], a[224:227], v[32:35], v[16:31]
  ds_read_b128 v[44:47], v1 offset:60416
  buffer_load_dwordx4 v0, s[8:11], s45 offen offset:1024 lds
  s_waitcnt lgkmcnt(2)
  v_mfma_f32_32x32x16_bf16 v[16:31], a[228:231], v[36:39], v[16:31]
  ds_read_b128 v[32:35], v1 offset:61440
  s_waitcnt lgkmcnt(2)
  v_mfma_f32_32x32x16_bf16 v[16:31], a[232:235], v[40:43], v[16:31]
  ds_read_b128 v[36:39], v1 offset:62464
  buffer_load_dwordx4 v0, s[8:11], s45 offen offset:2048 lds
  s_waitcnt lgkmcnt(2)
  v_mfma_f32_32x32x16_bf16 v[16:31], a[236:239], v[44:47], v[16:31]
  ds_read_b128 v[40:43], v1 offset:63488
  s_waitcnt lgkmcnt(2)
  v_mfma_f32_32x32x16_bf16 v[16:31], a[240:243], v[32:35], v[16:31]
  ds_read_b128 v[44:47], v1 offset:64512
  buffer_load_dwordx4 v0, s[8:11], s45 offen offset:3072 lds
  s_waitcnt lgkmcnt(2)
  v_mfma_f32_32x32x16_bf16 v[16:31], a[244:247], v[36:39], v[16:31]
  s_waitcnt lgkmcnt(1)
  v_mfma_f32_32x32x16_bf16 v[16:31], a[248:251], v[40:43], v[16:31]
  s_xor_b32 s42, s42, 0x10000
  s_waitcnt lgkmcnt(0)
  v_mfma_f32_32x32x16_bf16 v[16:31], a[252:255], v[44:47], v[16:31]
  s_branch L_o_h2
L_on_105:
  s_waitcnt lgkmcnt(2)
  v_mfma_f32_32x32x16_bf16 v[16:31], a[32:35], v[32:35], v[16:31]
  ds_read_b128 v[44:47], v1 offset:11264
  s_waitcnt lgkmcnt(2)
  v_mfma_f32_32x32x16_bf16 v[16:31], a[36:39], v[36:39], v[16:31]
  ds_read_b128 v[32:35], v1 offset:12288
  s_waitcnt lgkmcnt(2)
  v_mfma_f32_32x32x16_bf16 v[16:31], a[40:43], v[40:43], v[16:31]
  ds_read_b128 v[36:39], v1 offset:13312
  s_waitcnt lgkmcnt(2)
  v_mfma_f32_32x32x16_bf16 v[16:31], a[44:47], v[44:47], v[16:31]
  ds_read_b128 v[40:43], v1 offset:14336
  s_waitcnt lgkmcnt(2)
  v_mfma_f32_32x32x16_bf16 v[16:31], a[48:51], v[32:35], v[16:31]
  ds_read_b128 v[44:47], v1 offset:15360
  buffer_load_dword v4, v2, s[8:11], s40 offen sc1
  s_waitcnt lgkmcnt(2)
  v_mfma_f32_32x32x16_bf16 v[16:31], a[52:55], v[36:39], v[16:31]
  ds_read_b128 v[32:35], v1 offset:24576
  s_waitcnt lgkmcnt(2)
  v_mfma_f32_32x32x16_bf16 v[16:31], a[56:59], v[40:43], v[16:31]
  ds_read_b128 v[36:39], v1 offset:25600
  s_waitcnt lgkmcnt(2)
  v_mfma_f32_32x32x16_bf16 v[16:31], a[60:63], v[44:47], v[16:31]
  ds_read_b128 v[40:43], v1 offset:26624
  s_waitcnt lgkmcnt(2)
  v_mfma_f32_32x32x16_bf16 v[16:31], a[96:99], v[32:35], v[16:31]
  ds_read_b128 v[44:47], v1 offset:27648
  s_waitcnt lgkmcnt(2)
  v_mfma_f32_32x32x16_bf16 v[16:31], a[100:103], v[36:39], v[16:31]
  ds_read_b128 v[32:35], v1 offset:28672
  s_waitcnt lgkmcnt(2)
  v_mfma_f32_32x32x16_bf16 v[16:31], a[104:107], v[40:43], v[16:31]
  ds_read_b128 v[36:39], v1 offset:29696
  s_waitcnt lgkmcnt(2)
  v_mfma_f32_32x32x16_bf16 v[16:31], a[108:111], v[44:47], v[16:31]
  ds_read_b128 v[40:43], v1 offset:30720
  s_waitcnt lgkmcnt(2)
  v_mfma_f32_32x32x16_bf16 v[16:31], a[112:115], v[32:35], v[16:31]
  ds_read_b128 v[44:47], v1 offset:31744
  s_waitcnt lgkmcnt(2)
  v_mfma_f32_32x32x16_bf16 v[16:31], a[116:119], v[36:39], v[16:31]
  ds_read_b128 v[32:35], v1 offset:40960
  s_waitcnt lgkmcnt(2)
  v_mfma_f32_32x32x16_bf16 v[16:31], a[120:123], v[40:43], v[16:31]
  ds_read_b128 v[36:39], v1 offset:41984
  s_waitcnt lgkmcnt(2)
  v_mfma_f32_32x32x16_bf16 v[16:31], a[124:127], v[44:47], v[16:31]
  ds_read_b128 v[40:43], v1 offset:43008
  s_waitcnt lgkmcnt(2)
  v_mfma_f32_32x32x16_bf16 v[16:31], a[160:163], v[32:35], v[16:31]
  ds_read_b128 v[44:47], v1 offset:44032
  s_waitcnt lgkmcnt(2)
  v_mfma_f32_32x32x16_bf16 v[16:31], a[164:167], v[36:39], v[16:31]
  ds_read_b128 v[32:35], v1 offset:45056
  s_waitcnt lgkmcnt(2)
  v_mfma_f32_32x32x16_bf16 v[16:31], a[168:171], v[40:43], v[16:31]
  ds_read_b128 v[36:39], v1 offset:46080
  s_waitcnt lgkmcnt(2)
  v_mfma_f32_32x32x16_bf16 v[16:31], a[172:175], v[44:47], v[16:31]
  ds_read_b128 v[40:43], v1 offset:47104
  s_waitcnt lgkmcnt(2)
  v_mfma_f32_32x32x16_bf16 v[16:31], a[176:179], v[32:35], v[16:31]
  ds_read_b128 v[44:47], v1 offset:48128
  s_waitcnt lgkmcnt(2)
  v_mfma_f32_32x32x16_bf16 v[16:31], a[180:183], v[36:39], v[16:31]
  ds_read_b128 v[32:35], v1 offset:57344
  s_waitcnt lgkmcnt(2)
  v_mfma_f32_32x32x16_bf16 v[16:31], a[184:187], v[40:43], v[16:31]
  ds_read_b128 v[36:39], v1 offset:58368
  s_waitcnt lgkmcnt(2)
  v_mfma_f32_32x32x16_bf16 v[16:31], a[188:191], v[44:47], v[16:31]
  ds_read_b128 v[40:43], v1 offset:59392
  s_waitcnt lgkmcnt(2)
  v_mfma_f32_32x32x16_bf16 v[16:31], a[224:227], v[32:35], v[16:31]
  ds_read_b128 v[44:47], v1 offset:60416
  s_waitcnt lgkmcnt(2)
  v_mfma_f32_32x32x16_bf16 v[16:31], a[228:231], v[36:39], v[16:31]
  ds_read_b128 v[32:35], v1 offset:61440
  s_waitcnt lgkmcnt(2)
  v_mfma_f32_32x32x16_bf16 v[16:31], a[232:235], v[40:43], v[16:31]
  ds_read_b128 v[36:39], v1 offset:62464
  s_waitcnt lgkmcnt(2)
  v_mfma_f32_32x32x16_bf16 v[16:31], a[236:239], v[44:47], v[16:31]
  ds_read_b128 v[40:43], v1 offset:63488
  s_waitcnt lgkmcnt(2)
  v_mfma_f32_32x32x16_bf16 v[16:31], a[240:243], v[32:35], v[16:31]
  ds_read_b128 v[44:47], v1 offset:64512
  s_waitcnt lgkmcnt(2)
  v_mfma_f32_32x32x16_bf16 v[16:31], a[244:247], v[36:39], v[16:31]
  s_waitcnt lgkmcnt(1)
  v_mfma_f32_32x32x16_bf16 v[16:31], a[248:251], v[40:43], v[16:31]
  s_waitcnt lgkmcnt(0)
  v_mfma_f32_32x32x16_bf16 v[16:31], a[252:255], v[44:47], v[16:31]
L_o_h2:
  s_sub_u32 s45, s32, 3
  v_cmp_gt_i32 vcc, s45, v5
  s_cbranch_vccz L_o_free
  s_mov_b32 s7, 0
L_o_bp:
  buffer_load_dword v5, v6, s[8:11], s39 offen sc1
  s_waitcnt vmcnt(0)
  v_cmp_gt_i32 vcc, s45, v5
  s_cbranch_vccz L_o_free
  s_add_u32 s7, s7, 1
  s_cmp_lt_u32 s7, 131072
  s_cbranch_scc1 L_o_bp
  s_mov_b32 s6, 32
  s_branch L_err
L_o_free:
  s_and_b32 s6, s32, 3
  s_lshl_b32 s6, s6, 17
  s_add_u32 s44, s37, s6
  s_lshr_b32 s6, s32, 2
  s_andn2_b32 s45, 1, s6
  s_add_u32 s32, s32, 1
  v_xor_b32 v1, 0x10000, v1
  s_nop 1
  v_cvt_pk_bf16_f32 v48, v16, v17
  v_cvt_pk_bf16_f32 v49, v18, v19
  v_cvt_pk_bf16_f32 v50, v20, v21
  v_cvt_pk_bf16_f32 v51, v22, v23
  v_bfi_b32 v48, 1, s45, v48
  buffer_store_dwordx4 v[48:51], v0, s[8:11], s44 offen offset:0 sc1
  v_cvt_pk_bf16_f32 v52, v24, v25
  v_cvt_pk_bf16_f32 v53, v26, v27
  v_cvt_pk_bf16_f32 v54, v28, v29
  v_cvt_pk_bf16_f32 v55, v30, v31
  v_bfi_b32 v52, 1, s45, v52
  buffer_store_dwordx4 v[52:55], v0, s[8:11], s44 offen offset:1024 sc1
  s_cmp_eq_u32 s43, 0
  s_waitcnt vmcnt(10)
  s_cbranch_scc0 L_o_loop
  s_cmp_eq_u32 s32, 64
  s_cbranch_scc1 L_o_end
  s_waitcnt vmcnt(2)
  v_cmp_gt_u32 vcc, s41, v4
  s_cbranch_vccz L_o_go
  s_branch L_o_wait
L_o_end:
  s_waitcnt vmcnt(0)
  s_endpgm
L_pro:
  s_max_u32 s6, s4, 3
  s_sub_u32 s6, s6, 3
  s_lshl_b32 s6, s6, 5
  s_add_u32 s6, s6, s5
  s_lshl_b32 s62, s6, 15
  s_lshl_b32 s6, s6, 2
  s_add_u32 s60, s6, s3
  s_lshl_b32 s6, s60, 2
  s_add_u32 s6, s6, 0x710000
  v_mov_b32 v1, 0
  v_lshlrev_b32 v2, 4, v0
  s_mov_b64 exec, 1
  buffer_store_dword v1, v1, s[8:11], s6 offen sc1
  s_mov_b64 exec, -1
  v_lshlrev_b32 v16, 2, v0
  s_lshl_b32 s6, s60, 8
  s_lshl_b32 s7, s60, 1
  s_mov_b32 s16, s66
  s_mov_b32 s17, s67
  s_mov_b32 s18, 0x20000
  s_mov_b32 s19, 0x20000
  buffer_load_dword v20, v16, s[16:19], s6 offen
  s_mov_b32 s20, s68
  s_mov_b32 s21, s69
  s_mov_b32 s22, 0x20000
  s_mov_b32 s23, 0x20000
  buffer_load_dword v21, v16, s[20:23], s6 offen
  s_mov_b32 s24, s70
  s_mov_b32 s25, s71
  s_mov_b32 s26, 0x20000
  s_mov_b32 s27, 0x20000
  buffer_load_dword v22, v16, s[24:27], s6 offen
  s_mov_b32 s28, s72
  s_mov_b32 s29, s73
  s_mov_b32 s30, 0x20000
  s_mov_b32 s31, 0x20000
  buffer_load_dword v23, v16, s[28:31], s6 offen
  s_mov_b32 s16, s74
  s_mov_b32 s17, s75
  s_mov_b32 s18, 0x400
  s_mov_b32 s19, 0x20000
  buffer_load_ushort v24, v1, s[16:19], s7 offen
  s_mov_b32 s20, s76
  s_mov_b32 s21, s77
  s_mov_b32 s22, 0x400
  s_mov_b32 s23, 0x20000
  buffer_load_ushort v232, v1, s[20:23], s7 offen
  s_waitcnt vmcnt(6)
  s_barrier
  s_cmp_lg_u32 s3, 0
  s_cbranch_scc1 L_sd_106
  s_mov_b64 exec, 1
  s_and_b32 s6, s4, 3
  s_lshl_b32 s6, s6, 6
  v_mov_b32 v18, 16
  v_mov_b32 v19, 1
  buffer_atomic_add v19, v18, s[12:15], s6 offen sc1
  s_mov_b64 exec, -1
L_sd_106:
  v_and_b32 v16, 15, v0
  v_and_b32 v17, 7, v16
  v_lshrrev_b32 v18, 3, v16
  v_lshl_add_u32 v19, v18, 7, v17
  v_add_u32 v19, 1, v19
  v_cvt_f32_u32 v4, v19
  v_and_b32 v19, 3, v16
  v_lshrrev_b32 v25, 2, v16
  v_lshlrev_b32 v25, 6, v25
  v_add_u32 v19, v19, v25
  v_lshlrev_b32 v19, 1, v19
  v_add_u32 v19, 258, v19
  v_cmp_gt_u32 vcc, 8, v16
  s_nop 1
  v_cndmask_b32 v19, 0, v19, vcc
  v_cvt_f32_u32 v5, v19
  v_and_b32 v19, 1, v16
  v_lshrrev_b32 v25, 1, v17
  v_lshlrev_b32 v25, 7, v25
  v_lshl_add_u32 v19, v19, 2, v25
  v_add_u32 v19, 516, v19
  v_lshlrev_b32 v25, 7, v17
  v_add_u32 v25, 1032, v25
  v_cndmask_b32 v19, v25, v19, vcc
  v_cvt_f32_u32 v6, v19
  v_lshlrev_b32 v19, 3, v16
  v_cvt_f32_u32 v7, v19
  v_lshrrev_b32 v19, 4, v0
  s_lshl_b32 s6, s3, 11
  v_lshl_add_u32 v3, v19, 6, s6
  v_lshlrev_b32 v16, 4, v0
  v_cvt_f32_u32 v16, v16
  s_mul_i32 s63, s3, 4352
  s_add_u32 s63, s63, 8192
  v_sub_f32 v17, 0x45800000, v16
  v_sub_f32 v18, 0x457fe000, v16
  v_cvt_pk_bf16_f32 v17, v17, v18
  v_lshlrev_b32 v160, 16, v17
  v_and_b32 v161, 0xffff0000, v17
  v_cvt_u32_f32 v160, v160
  v_cvt_u32_f32 v161, v161
  v_add_u32 v160, s63, v160
  v_add_u32 v161, s63, v161
  v_sub_f32 v17, 0x457fc000, v16
  v_sub_f32 v18, 0x457fa000, v16
  v_cvt_pk_bf16_f32 v17, v17, v18
  v_lshlrev_b32 v162, 16, v17
  v_and_b32 v163, 0xffff0000, v17
  v_cvt_u32_f32 v162, v162
  v_cvt_u32_f32 v163, v163
  v_add_u32 v162, s63, v162
  v_add_u32 v163, s63, v163
  v_sub_f32 v17, 0x457f8000, v16
  v_sub_f32 v18, 0x457f6000, v16
  v_cvt_pk_bf16_f32 v17, v17, v18
  v_lshlrev_b32 v164, 16, v17
  v_and_b32 v165, 0xffff0000, v17
  v_cvt_u32_f32 v164, v164
  v_cvt_u32_f32 v165, v165
  v_add_u32 v164, s63, v164
  v_add_u32 v165, s63, v165
  v_sub_f32 v17, 0x457f4000, v16
  v_sub_f32 v18, 0x457f2000, v16
  v_cvt_pk_bf16_f32 v17, v17, v18
  v_lshlrev_b32 v166, 16, v17
  v_and_b32 v167, 0xffff0000, v17
  v_cvt_u32_f32 v166, v166
  v_cvt_u32_f32 v167, v167
  v_add_u32 v166, s63, v166
  v_add_u32 v167, s63, v167
  v_sub_f32 v17, 0x45400000, v16
  v_sub_f32 v18, 0x453fe000, v16
  v_cvt_pk_bf16_f32 v17, v17, v18
  v_lshlrev_b32 v168, 16, v17
  v_and_b32 v169, 0xffff0000, v17
  v_cvt_u32_f32 v168, v168
  v_cvt_u32_f32 v169, v169
  v_add_u32 v168, s63, v168
  v_add_u32 v169, s63, v169
  v_sub_f32 v17, 0x453fc000, v16
  v_sub_f32 v18, 0x453fa000, v16
  v_cvt_pk_bf16_f32 v17, v17, v18
  v_lshlrev_b32 v170, 16, v17
  v_and_b32 v171, 0xffff0000, v17
  v_cvt_u32_f32 v170, v170
  v_cvt_u32_f32 v171, v171
  v_add_u32 v170, s63, v170
  v_add_u32 v171, s63, v171
  v_sub_f32 v17, 0x453f8000, v16
  v_sub_f32 v18, 0x453f6000, v16
  v_cvt_pk_bf16_f32 v17, v17, v18
  v_lshlrev_b32 v172, 16, v17
  v_and_b32 v173, 0xffff0000, v17
  v_cvt_u32_f32 v172, v172
  v_cvt_u32_f32 v173, v173
  v_add_u32 v172, s63, v172
  v_add_u32 v173, s63, v173
  v_sub_f32 v17, 0x453f4000, v16
  v_sub_f32 v18, 0x453f2000, v16
  v_cvt_pk_bf16_f32 v17, v17, v18
  v_lshlrev_b32 v174, 16, v17
  v_and_b32 v175, 0xffff0000, v17
  v_cvt_u32_f32 v174, v174
  v_cvt_u32_f32 v175, v175
  v_add_u32 v174, s63, v174
  v_add_u32 v175, s63, v175
  v_sub_f32 v17, 0x45000000, v16
  v_sub_f32 v18, 0x44ffc000, v16
  v_cvt_pk_bf16_f32 v17, v17, v18
  v_lshlrev_b32 v176, 16, v17
  v_and_b32 v177, 0xffff0000, v17
  v_cvt_u32_f32 v176, v176
  v_cvt_u32_f32 v177, v177
  v_add_u32 v176, s63, v176
  v_add_u32 v177, s63, v177
  v_sub_f32 v17, 0x44ff8000, v16
  v_sub_f32 v18, 0x44ff4000, v16
  v_cvt_pk_bf16_f32 v17, v17, v18
  v_lshlrev_b32 v178, 16, v17
  v_and_b32 v179, 0xffff0000, v17
  v_cvt_u32_f32 v178, v178
  v_cvt_u32_f32 v179, v179
  v_add_u32 v178, s63, v178
  v_add_u32 v179, s63, v179
  v_sub_f32 v17, 0x44ff0000, v16
  v_sub_f32 v18, 0x44fec000, v16
  v_cvt_pk_bf16_f32 v17, v17, v18
  v_lshlrev_b32 v180, 16, v17
  v_and_b32 v181, 0xffff0000, v17
  v_cvt_u32_f32 v180, v180
  v_cvt_u32_f32 v181, v181
  v_add_u32 v180, s63, v180
  v_add_u32 v181, s63, v181
  v_sub_f32 v17, 0x44fe8000, v16
  v_sub_f32 v18, 0x44fe4000, v16
  v_cvt_pk_bf16_f32 v17, v17, v18
  v_lshlrev_b32 v182, 16, v17
  v_and_b32 v183, 0xffff0000, v17
  v_cvt_u32_f32 v182, v182
  v_cvt_u32_f32 v183, v183
  v_add_u32 v182, s63, v182
  v_add_u32 v183, s63, v183
  v_sub_f32 v17, 0x44800000, v16
  v_sub_f32 v18, 0x447f8000, v16
  v_cvt_pk_bf16_f32 v17, v17, v18
  v_lshlrev_b32 v184, 16, v17
  v_and_b32 v185, 0xffff0000, v17
  v_cvt_u32_f32 v184, v184
  v_cvt_u32_f32 v185, v185
  v_add_u32 v184, s63, v184
  v_add_u32 v185, s63, v185
  v_sub_f32 v17, 0x447f0000, v16
  v_sub_f32 v18, 0x447e8000, v16
  v_cvt_pk_bf16_f32 v17, v17, v18
  v_lshlrev_b32 v186, 16, v17
  v_and_b32 v187, 0xffff0000, v17
  v_cvt_u32_f32 v186, v186
  v_cvt_u32_f32 v187, v187
  v_add_u32 v186, s63, v186
  v_add_u32 v187, s63, v187
  v_sub_f32 v17, 0x447e0000, v16
  v_sub_f32 v18, 0x447d8000, v16
  v_cvt_pk_bf16_f32 v17, v17, v18
  v_lshlrev_b32 v188, 16, v17
  v_and_b32 v189, 0xffff0000, v17
  v_cvt_u32_f32 v188, v188
  v_cvt_u32_f32 v189, v189
  v_add_u32 v188, s63, v188
  v_add_u32 v189, s63, v189
  v_sub_f32 v17, 0x447d0000, v16
  v_sub_f32 v18, 0x447c8000, v16
  v_cvt_pk_bf16_f32 v17, v17, v18
  v_lshlrev_b32 v190, 16, v17
  v_and_b32 v191, 0xffff0000, v17
  v_cvt_u32_f32 v190, v190
  v_cvt_u32_f32 v191, v191
  v_add_u32 v190, s63, v190
  v_add_u32 v191, s63, v191
  s_waitcnt vmcnt(1)
  v_lshlrev_b32 v24, 16, v24
  v_mul_f32 v26, 0x3fb8aa3b, v24
  v_mov_b32 v27, 0x3fb8aa3b
  v_fma_f32 v27, v24, v27, -v26
  v_fmac_f32 v27, 0x32a57060, v24
  v_exp_f32 v26, v26
  v_mul_f32 v27, 0x3f317218, v27
  v_fma_f32 v24, v26, v27, v26
  v_cvt_pk_bf16_f32 v24, v24, v24
  v_and_b32 v24, 0xffff0000, v24
  v_lshlrev_b32 v32, 16, v20
  v_and_b32 v36, 0xffff0000, v20
  v_lshlrev_b32 v33, 16, v21
  v_and_b32 v37, 0xffff0000, v21
  v_lshlrev_b32 v34, 16, v22
  v_and_b32 v38, 0xffff0000, v22
  v_lshlrev_b32 v35, 16, v23
  v_and_b32 v39, 0xffff0000, v23
  v_max3_f32 v28, |v34|, |v35|, |v38|
  v_max_f32 v28, |v39|, v28
  s_nop 1
  v_max_f32_dpp v28, v28, v28 quad_perm:[1,0,3,2] row_mask:0xf bank_mask:0xf
  s_nop 1
  v_max_f32_dpp v28, v28, v28 quad_perm:[2,3,0,1] row_mask:0xf bank_mask:0xf
  s_nop 1
  v_max_f32_dpp v28, v28, v28 row_half_mirror row_mask:0xf bank_mask:0xf
  s_nop 1
  v_max_f32_dpp v28, v28, v28 row_mirror row_mask:0xf bank_mask:0xf
  v_mov_b32 v29, v28
  s_nop 1
  v_permlane16_swap_b32 v28, v29
  v_max_f32 v28, v28, v29
  v_mov_b32 v29, v28
  s_nop 1
  v_permlane32_swap_b32 v28, v29
  v_max_f32 v28, v28, v29
  v_frexp_exp_i32_f32 v28, v28
  v_sub_u32 v29, 0, v28
  v_mul_f32 v26, 0x3fb8aa3b, v32
  v_mov_b32 v27, 0x3fb8aa3b
  v_fma_f32 v27, v32, v27, -v26
  v_fmac_f32 v27, 0x32a57060, v32
  v_exp_f32 v26, v26
  v_mul_f32 v27, 0x3f317218, v27
  v_fma_f32 v32, v26, v27, v26
  v_cvt_pk_bf16_f32 v32, v32, v32
  v_and_b32 v32, 0xffff0000, v32
  v_mul_f32 v32, v32, v24
  v_mul_f32 v33, v33, v24
  v_ldexp_f32 v34, v34, v29
  v_ldexp_f32 v35, v35, v29
  v_mul_f32 v32, 0xbfb8aa3b, v32
  v_mul_f32 v33, 0x3e22f983, v33
  v_mul_f32 v26, 0x3fb8aa3b, v36
  v_mov_b32 v27, 0x3fb8aa3b
  v_fma_f32 v27, v36, v27, -v26
  v_fmac_f32 v27, 0x32a57060, v36
  v_exp_f32 v26, v26
  v_mul_f32 v27, 0x3f317218, v27
  v_fma_f32 v36, v26, v27, v26
  v_cvt_pk_bf16_f32 v36, v36, v36
  v_and_b32 v36, 0xffff0000, v36
  v_mul_f32 v36, v36, v24
  v_mul_f32 v37, v37, v24
  v_ldexp_f32 v38, v38, v29
  v_ldexp_f32 v39, v39, v29
  v_mul_f32 v36, 0xbfb8aa3b, v36
  v_mul_f32 v37, 0x3e22f983, v37
  v_add_f32 v24, v24, v24
  v_ldexp_f32 v233, v24, v28
  s_lshl_b32 s6, s3, 11
  v_lshl_add_u32 v16, v0, 5, s6
  ds_write_b128 v16, v[32:35] offset:0
  ds_write_b128 v16, v[36:39] offset:16
  ds_read_b128 v[8:11], v3 offset:0
  v_mov_b32 v48, 0
  v_mov_b32 v49, 0
  v_mov_b32 v50, 0
  v_mov_b32 v51, 0
  v_mov_b32 v52, 0
  v_mov_b32 v53, 0
  v_mov_b32 v54, 0
  v_mov_b32 v55, 0
  v_mov_b32 v56, 0
  v_mov_b32 v57, 0
  v_mov_b32 v58, 0
  v_mov_b32 v59, 0
  v_mov_b32 v16, 0
  v_mov_b32 v17, 0
  v_mov_b32 v18, 0
  v_mov_b32 v19, 0
  v_mov_b32 v20, 0
  v_mov_b32 v21, 0
  v_mov_b32 v22, 0
  v_mov_b32 v23, 0
  v_mov_b32 v24, 0
  v_mov_b32 v25, 0
  v_mov_b32 v26, 0
  v_mov_b32 v27, 0
  v_mov_b32 v28, 0
  v_mov_b32 v29, 0
  v_mov_b32 v30, 0
  v_mov_b32 v31, 0
  s_mov_b32 s6, 2
L_kg_107:
  s_waitcnt lgkmcnt(0)
  ds_read_b128 v[12:15], v3 offset:16
  v_mfma_f32_16x16x32_f16 v[48:51], v[16:19], v[28:31], v[48:51]
  v_pk_mul_f32 v[38:39], v[8:9], v[6:7] op_sel:[0,1] op_sel_hi:[1,1]
  v_mfma_f32_16x16x32_f16 v[52:55], v[20:23], v[28:31], v[52:55]
  v_pk_mul_f32 v[32:33], v[8:9], v[4:5] op_sel:[0,0] op_sel_hi:[1,0]
  v_mfma_f32_16x16x32_f16 v[56:59], v[24:27], v[28:31], v[56:59]
  v_pk_mul_f32 v[34:35], v[8:9], v[4:5] op_sel:[0,1] op_sel_hi:[1,1]
  v_pk_mul_f32 v[36:37], v[8:9], v[6:7] op_sel:[0,0] op_sel_hi:[1,0]
  v_fract_f32 v39, v39
  v_fract_f32 v33, v33
  v_fract_f32 v35, v35
  v_fract_f32 v37, v37
  v_exp_f32 v38, v38
  v_cos_f32 v46, v39
  v_sin_f32 v47, v39
  v_exp_f32 v32, v32
  v_cos_f32 v40, v33
  v_sin_f32 v41, v33
  v_exp_f32 v34, v34
  v_cos_f32 v42, v35
  v_sin_f32 v43, v35
  v_exp_f32 v36, v36
  v_cos_f32 v44, v37
  v_sin_f32 v45, v37
  v_pk_mul_f32 v[46:47], v[46:47], v[38:39] op_sel_hi:[1,0]
  v_pk_mul_f32 v[40:41], v[40:41], v[32:33] op_sel_hi:[1,0]
  v_pk_mul_f32 v[42:43], v[42:43], v[34:35] op_sel_hi:[1,0]
  v_pk_mul_f32 v[44:45], v[44:45], v[36:37] op_sel_hi:[1,0]
  v_pk_mul_f32 v[32:33], v[46:47], v[10:11] op_sel_hi:[1,0] neg_hi:[1,0]
  v_cvt_pk_f16_f32 v16, v40, v41
  v_pk_fma_f32 v[32:33], v[46:47], v[10:11], v[32:33] op_sel:[1,1,0] op_sel_hi:[0,1,1] neg_lo:[1,0,0] neg_hi:[1,0,0]
  v_cvt_pk_f16_f32 v20, v42, v43
  v_cvt_pk_f16_f32 v24, v44, v45
  v_cvt_pk_f16_f32 v28, v32, v33
  s_waitcnt lgkmcnt(0)
  ds_read_b128 v[8:11], v3 offset:32
  v_pk_mul_f32 v[38:39], v[12:13], v[6:7] op_sel:[0,1] op_sel_hi:[1,1]
  v_pk_mul_f32 v[32:33], v[12:13], v[4:5] op_sel:[0,0] op_sel_hi:[1,0]
  v_pk_mul_f32 v[34:35], v[12:13], v[4:5] op_sel:[0,1] op_sel_hi:[1,1]
  v_pk_mul_f32 v[36:37], v[12:13], v[6:7] op_sel:[0,0] op_sel_hi:[1,0]
  v_fract_f32 v39, v39
  v_fract_f32 v33, v33
  v_fract_f32 v35, v35
  v_fract_f32 v37, v37
  v_exp_f32 v38, v38
  v_cos_f32 v46, v39
  v_sin_f32 v47, v39
  v_exp_f32 v32, v32
  v_cos_f32 v40, v33
  v_sin_f32 v41, v33
  v_exp_f32 v34, v34
  v_cos_f32 v42, v35
  v_sin_f32 v43, v35
  v_exp_f32 v36, v36
  v_cos_f32 v44, v37
  v_sin_f32 v45, v37
  v_pk_mul_f32 v[46:47], v[46:47], v[38:39] op_sel_hi:[1,0]
  v_pk_mul_f32 v[40:41], v[40:41], v[32:33] op_sel_hi:[1,0]
  v_pk_mul_f32 v[42:43], v[42:43], v[34:35] op_sel_hi:[1,0]
  v_pk_mul_f32 v[44:45], v[44:45], v[36:37] op_sel_hi:[1,0]
  v_pk_mul_f32 v[32:33], v[46:47], v[14:15] op_sel_hi:[1,0] neg_hi:[1,0]
  v_cvt_pk_f16_f32 v17, v40, v41
  v_pk_fma_f32 v[32:33], v[46:47], v[14:15], v[32:33] op_sel:[1,1,0] op_sel_hi:[0,1,1] neg_lo:[1,0,0] neg_hi:[1,0,0]
  v_cvt_pk_f16_f32 v21, v42, v43
  v_cvt_pk_f16_f32 v25, v44, v45
  v_cvt_pk_f16_f32 v29, v32, v33
  s_waitcnt lgkmcnt(0)
  ds_read_b128 v[12:15], v3 offset:48
  v_pk_mul_f32 v[38:39], v[8:9], v[6:7] op_sel:[0,1] op_sel_hi:[1,1]
  v_pk_mul_f32 v[32:33], v[8:9], v[4:5] op_sel:[0,0] op_sel_hi:[1,0]
  v_pk_mul_f32 v[34:35], v[8:9], v[4:5] op_sel:[0,1] op_sel_hi:[1,1]
  v_pk_mul_f32 v[36:37], v[8:9], v[6:7] op_sel:[0,0] op_sel_hi:[1,0]
  v_fract_f32 v39, v39
  v_fract_f32 v33, v33
  v_fract_f32 v35, v35
  v_fract_f32 v37, v37
  v_exp_f32 v38, v38
  v_cos_f32 v46, v39
  v_sin_f32 v47, v39
  v_exp_f32 v32, v32
  v_cos_f32 v40, v33
  v_sin_f32 v41, v33
  v_exp_f32 v34, v34
  v_cos_f32 v42, v35
  v_sin_f32 v43, v35
  v_exp_f32 v36, v36
  v_cos_f32 v44, v37
  v_sin_f32 v45, v37
  v_pk_mul_f32 v[46:47], v[46:47], v[38:39] op_sel_hi:[1,0]
  v_pk_mul_f32 v[40:41], v[40:41], v[32:33] op_sel_hi:[1,0]
  v_pk_mul_f32 v[42:43], v[42:43], v[34:35] op_sel_hi:[1,0]
  v_pk_mul_f32 v[44:45], v[44:45], v[36:37] op_sel_hi:[1,0]
  v_pk_mul_f32 v[32:33], v[46:47], v[10:11] op_sel_hi:[1,0] neg_hi:[1,0]
  v_cvt_pk_f16_f32 v18, v40, v41
  v_pk_fma_f32 v[32:33], v[46:47], v[10:11], v[32:33] op_sel:[1,1,0] op_sel_hi:[0,1,1] neg_lo:[1,0,0] neg_hi:[1,0,0]
  v_cvt_pk_f16_f32 v22, v42, v43
  v_cvt_pk_f16_f32 v26, v44, v45
  v_cvt_pk_f16_f32 v30, v32, v33
  s_waitcnt lgkmcnt(0)
  ds_read_b128 v[8:11], v3 offset:256
  v_pk_mul_f32 v[38:39], v[12:13], v[6:7] op_sel:[0,1] op_sel_hi:[1,1]
  v_pk_mul_f32 v[32:33], v[12:13], v[4:5] op_sel:[0,0] op_sel_hi:[1,0]
  v_pk_mul_f32 v[34:35], v[12:13], v[4:5] op_sel:[0,1] op_sel_hi:[1,1]
  v_pk_mul_f32 v[36:37], v[12:13], v[6:7] op_sel:[0,0] op_sel_hi:[1,0]
  v_fract_f32 v39, v39
  v_fract_f32 v33, v33
  v_fract_f32 v35, v35
  v_fract_f32 v37, v37
  v_exp_f32 v38, v38
  v_cos_f32 v46, v39
  v_sin_f32 v47, v39
  v_exp_f32 v32, v32
  v_cos_f32 v40, v33
  v_sin_f32 v41, v33
  v_exp_f32 v34, v34
  v_cos_f32 v42, v35
  v_sin_f32 v43, v35
  v_exp_f32 v36, v36
  v_cos_f32 v44, v37
  v_sin_f32 v45, v37
  v_pk_mul_f32 v[46:47], v[46:47], v[38:39] op_sel_hi:[1,0]
  v_pk_mul_f32 v[40:41], v[40:41], v[32:33] op_sel_hi:[1,0]
  v_pk_mul_f32 v[42:43], v[42:43], v[34:35] op_sel_hi:[1,0]
  v_pk_mul_f32 v[44:45], v[44:45], v[36:37] op_sel_hi:[1,0]
  v_pk_mul_f32 v[32:33], v[46:47], v[14:15] op_sel_hi:[1,0] neg_hi:[1,0]
  v_cvt_pk_f16_f32 v19, v40, v41
  v_pk_fma_f32 v[32:33], v[46:47], v[14:15], v[32:33] op_sel:[1,1,0] op_sel_hi:[0,1,1] neg_lo:[1,0,0] neg_hi:[1,0,0]
  v_cvt_pk_f16_f32 v23, v42, v43
  v_cvt_pk_f16_f32 v27, v44, v45
  v_cvt_pk_f16_f32 v31, v32, v33
  v_add_u32 v3, 256, v3
  s_sub_u32 s6, s6, 1
  s_cmp_lg_u32 s6, 0
  s_cbranch_scc1 L_kg_107
  s_mov_b32 s6, 2
L_kg_108:
  s_waitcnt lgkmcnt(0)
  ds_read_b128 v[12:15], v3 offset:16
  v_mfma_f32_16x16x32_f16 v[48:51], v[16:19], v[28:31], v[48:51]
  v_pk_mul_f32 v[38:39], v[8:9], v[6:7] op_sel:[0,1] op_sel_hi:[1,1]
  v_mfma_f32_16x16x32_f16 v[52:55], v[20:23], v[28:31], v[52:55]
  v_pk_mul_f32 v[32:33], v[8:9], v[4:5] op_sel:[0,0] op_sel_hi:[1,0]
  v_mfma_f32_16x16x32_f16 v[56:59], v[24:27], v[28:31], v[56:59]
  v_pk_mul_f32 v[34:35], v[8:9], v[4:5] op_sel:[0,1] op_sel_hi:[1,1]
  v_pk_mul_f32 v[36:37], v[8:9], v[6:7] op_sel:[0,0] op_sel_hi:[1,0]
  v_fract_f32 v39, v39
  v_fract_f32 v33, v33
  v_fract_f32 v35, v35
  v_fract_f32 v37, v37
  v_exp_f32 v38, v38
  v_cos_f32 v46, v39
  v_sin_f32 v47, v39
  v_exp_f32 v32, v32
  v_cos_f32 v40, v33
  v_sin_f32 v41, v33
  v_exp_f32 v34, v34
  v_cos_f32 v42, v35
  v_sin_f32 v43, v35
  v_exp_f32 v36, v36
  v_cos_f32 v44, v37
  v_sin_f32 v45, v37
  v_pk_mul_f32 v[46:47], v[46:47], v[38:39] op_sel_hi:[1,0]
  v_pk_mul_f32 v[40:41], v[40:41], v[32:33] op_sel_hi:[1,0]
  v_pk_mul_f32 v[42:43], v[42:43], v[34:35] op_sel_hi:[1,0]
  v_pk_mul_f32 v[44:45], v[44:45], v[36:37] op_sel_hi:[1,0]
  v_pk_mul_f32 v[32:33], v[46:47], v[10:11] op_sel_hi:[1,0] neg_hi:[1,0]
  v_cvt_pk_f16_f32 v16, v40, v41
  v_pk_fma_f32 v[32:33], v[46:47], v[10:11], v[32:33] op_sel:[1,1,0] op_sel_hi:[0,1,1] neg_lo:[1,0,0] neg_hi:[1,0,0]
  v_cvt_pk_f16_f32 v20, v42, v43
  v_cvt_pk_f16_f32 v24, v44, v45
  v_cvt_pk_f16_f32 v28, v32, v33
  s_waitcnt lgkmcnt(0)
  ds_read_b128 v[8:11], v3 offset:32
  v_pk_mul_f32 v[38:39], v[12:13], v[6:7] op_sel:[0,1] op_sel_hi:[1,1]
  v_pk_mul_f32 v[32:33], v[12:13], v[4:5] op_sel:[0,0] op_sel_hi:[1,0]
  v_pk_mul_f32 v[34:35], v[12:13], v[4:5] op_sel:[0,1] op_sel_hi:[1,1]
  v_pk_mul_f32 v[36:37], v[12:13], v[6:7] op_sel:[0,0] op_sel_hi:[1,0]
  v_fract_f32 v39, v39
  v_fract_f32 v33, v33
  v_fract_f32 v35, v35
  v_fract_f32 v37, v37
  v_exp_f32 v38, v38
  v_cos_f32 v46, v39
  v_sin_f32 v47, v39
  v_exp_f32 v32, v32
  v_cos_f32 v40, v33
  v_sin_f32 v41, v33
  v_exp_f32 v34, v34
  v_cos_f32 v42, v35
  v_sin_f32 v43, v35
  v_exp_f32 v36, v36
  v_cos_f32 v44, v37
  v_sin_f32 v45, v37
  v_pk_mul_f32 v[46:47], v[46:47], v[38:39] op_sel_hi:[1,0]
  v_pk_mul_f32 v[40:41], v[40:41], v[32:33] op_sel_hi:[1,0]
  v_pk_mul_f32 v[42:43], v[42:43], v[34:35] op_sel_hi:[1,0]
  v_pk_mul_f32 v[44:45], v[44:45], v[36:37] op_sel_hi:[1,0]
  v_pk_mul_f32 v[32:33], v[46:47], v[14:15] op_sel_hi:[1,0] neg_hi:[1,0]
  v_cvt_pk_f16_f32 v17, v40, v41
  v_pk_fma_f32 v[32:33], v[46:47], v[14:15], v[32:33] op_sel:[1,1,0] op_sel_hi:[0,1,1] neg_lo:[1,0,0] neg_hi:[1,0,0]
  v_cvt_pk_f16_f32 v21, v42, v43
  v_cvt_pk_f16_f32 v25, v44, v45
  v_cvt_pk_f16_f32 v29, v32, v33
  s_waitcnt lgkmcnt(0)
  ds_read_b128 v[12:15], v3 offset:48
  v_pk_mul_f32 v[38:39], v[8:9], v[6:7] op_sel:[0,1] op_sel_hi:[1,1]
  v_pk_mul_f32 v[32:33], v[8:9], v[4:5] op_sel:[0,0] op_sel_hi:[1,0]
  v_pk_mul_f32 v[34:35], v[8:9], v[4:5] op_sel:[0,1] op_sel_hi:[1,1]
  v_pk_mul_f32 v[36:37], v[8:9], v[6:7] op_sel:[0,0] op_sel_hi:[1,0]
  v_fract_f32 v39, v39
  v_fract_f32 v33, v33
  v_fract_f32 v35, v35
  v_fract_f32 v37, v37
  v_exp_f32 v38, v38
  v_cos_f32 v46, v39
  v_sin_f32 v47, v39
  v_exp_f32 v32, v32
  v_cos_f32 v40, v33
  v_sin_f32 v41, v33
  v_exp_f32 v34, v34
  v_cos_f32 v42, v35
  v_sin_f32 v43, v35
  v_exp_f32 v36, v36
  v_cos_f32 v44, v37
  v_sin_f32 v45, v37
  v_pk_mul_f32 v[46:47], v[46:47], v[38:39] op_sel_hi:[1,0]
  v_pk_mul_f32 v[40:41], v[40:41], v[32:33] op_sel_hi:[1,0]
  v_pk_mul_f32 v[42:43], v[42:43], v[34:35] op_sel_hi:[1,0]
  v_pk_mul_f32 v[44:45], v[44:45], v[36:37] op_sel_hi:[1,0]
  v_pk_mul_f32 v[32:33], v[46:47], v[10:11] op_sel_hi:[1,0] neg_hi:[1,0]
  v_cvt_pk_f16_f32 v18, v40, v41
  v_pk_fma_f32 v[32:33], v[46:47], v[10:11], v[32:33] op_sel:[1,1,0] op_sel_hi:[0,1,1] neg_lo:[1,0,0] neg_hi:[1,0,0]
  v_cvt_pk_f16_f32 v22, v42, v43
  v_cvt_pk_f16_f32 v26, v44, v45
  v_cvt_pk_f16_f32 v30, v32, v33
  s_waitcnt lgkmcnt(0)
  ds_read_b128 v[8:11], v3 offset:256
  v_pk_mul_f32 v[38:39], v[12:13], v[6:7] op_sel:[0,1] op_sel_hi:[1,1]
  v_pk_mul_f32 v[32:33], v[12:13], v[4:5] op_sel:[0,0] op_sel_hi:[1,0]
  v_pk_mul_f32 v[34:35], v[12:13], v[4:5] op_sel:[0,1] op_sel_hi:[1,1]
  v_pk_mul_f32 v[36:37], v[12:13], v[6:7] op_sel:[0,0] op_sel_hi:[1,0]
  v_fract_f32 v39, v39
  v_fract_f32 v33, v33
  v_fract_f32 v35, v35
  v_fract_f32 v37, v37
  v_exp_f32 v38, v38
  v_cos_f32 v46, v39
  v_sin_f32 v47, v39
  v_exp_f32 v32, v32
  v_cos_f32 v40, v33
  v_sin_f32 v41, v33
  v_exp_f32 v34, v34
  v_cos_f32 v42, v35
  v_sin_f32 v43, v35
  v_exp_f32 v36, v36
  v_cos_f32 v44, v37
  v_sin_f32 v45, v37
  v_pk_mul_f32 v[46:47], v[46:47], v[38:39] op_sel_hi:[1,0]
  v_pk_mul_f32 v[40:41], v[40:41], v[32:33] op_sel_hi:[1,0]
  v_pk_mul_f32 v[42:43], v[42:43], v[34:35] op_sel_hi:[1,0]
  v_pk_mul_f32 v[44:45], v[44:45], v[36:37] op_sel_hi:[1,0]
  v_pk_mul_f32 v[32:33], v[46:47], v[14:15] op_sel_hi:[1,0] neg_hi:[1,0]
  v_cvt_pk_f16_f32 v19, v40, v41
  v_pk_fma_f32 v[32:33], v[46:47], v[14:15], v[32:33] op_sel:[1,1,0] op_sel_hi:[0,1,1] neg_lo:[1,0,0] neg_hi:[1,0,0]
  v_cvt_pk_f16_f32 v23, v42, v43
  v_cvt_pk_f16_f32 v27, v44, v45
  v_cvt_pk_f16_f32 v31, v32, v33
  v_add_u32 v3, 256, v3
  s_sub_u32 s6, s6, 1
  s_cmp_lg_u32 s6, 0
  s_cbranch_scc1 L_kg_108
  s_mov_b32 s6, 2
L_kg_109:
  s_waitcnt lgkmcnt(0)
  ds_read_b128 v[12:15], v3 offset:16
  v_mfma_f32_16x16x32_f16 v[48:51], v[16:19], v[28:31], v[48:51]
  v_pk_mul_f32 v[38:39], v[8:9], v[6:7] op_sel:[0,1] op_sel_hi:[1,1]
  v_mfma_f32_16x16x32_f16 v[52:55], v[20:23], v[28:31], v[52:55]
  v_pk_mul_f32 v[32:33], v[8:9], v[4:5] op_sel:[0,0] op_sel_hi:[1,0]
  v_mfma_f32_16x16x32_f16 v[56:59], v[24:27], v[28:31], v[56:59]
  v_pk_mul_f32 v[34:35], v[8:9], v[4:5] op_sel:[0,1] op_sel_hi:[1,1]
  v_pk_mul_f32 v[36:37], v[8:9], v[6:7] op_sel:[0,0] op_sel_hi:[1,0]
  v_fract_f32 v39, v39
  v_fract_f32 v33, v33
  v_fract_f32 v35, v35
  v_fract_f32 v37, v37
  v_exp_f32 v38, v38
  v_cos_f32 v46, v39
  v_sin_f32 v47, v39
  v_exp_f32 v32, v32
  v_cos_f32 v40, v33
  v_sin_f32 v41, v33
  v_exp_f32 v34, v34
  v_cos_f32 v42, v35
  v_sin_f32 v43, v35
  v_exp_f32 v36, v36
  v_cos_f32 v44, v37
  v_sin_f32 v45, v37
  v_pk_mul_f32 v[46:47], v[46:47], v[38:39] op_sel_hi:[1,0]
  v_pk_mul_f32 v[40:41], v[40:41], v[32:33] op_sel_hi:[1,0]
  v_pk_mul_f32 v[42:43], v[42:43], v[34:35] op_sel_hi:[1,0]
  v_pk_mul_f32 v[44:45], v[44:45], v[36:37] op_sel_hi:[1,0]
  v_pk_mul_f32 v[32:33], v[46:47], v[10:11] op_sel_hi:[1,0] neg_hi:[1,0]
  v_cvt_pk_f16_f32 v16, v40, v41
  v_pk_fma_f32 v[32:33], v[46:47], v[10:11], v[32:33] op_sel:[1,1,0] op_sel_hi:[0,1,1] neg_lo:[1,0,0] neg_hi:[1,0,0]
  v_cvt_pk_f16_f32 v20, v42, v43
  v_cvt_pk_f16_f32 v24, v44, v45
  v_cvt_pk_f16_f32 v28, v32, v33
  s_waitcnt lgkmcnt(0)
  ds_read_b128 v[8:11], v3 offset:32
  v_pk_mul_f32 v[38:39], v[12:13], v[6:7] op_sel:[0,1] op_sel_hi:[1,1]
  v_pk_mul_f32 v[32:33], v[12:13], v[4:5] op_sel:[0,0] op_sel_hi:[1,0]
  v_pk_mul_f32 v[34:35], v[12:13], v[4:5] op_sel:[0,1] op_sel_hi:[1,1]
  v_pk_mul_f32 v[36:37], v[12:13], v[6:7] op_sel:[0,0] op_sel_hi:[1,0]
  v_fract_f32 v39, v39
  v_fract_f32 v33, v33
  v_fract_f32 v35, v35
  v_fract_f32 v37, v37
  v_exp_f32 v38, v38
  v_cos_f32 v46, v39
  v_sin_f32 v47, v39
  v_exp_f32 v32, v32
  v_cos_f32 v40, v33
  v_sin_f32 v41, v33
  v_exp_f32 v34, v34
  v_cos_f32 v42, v35
  v_sin_f32 v43, v35
  v_exp_f32 v36, v36
  v_cos_f32 v44, v37
  v_sin_f32 v45, v37
  v_pk_mul_f32 v[46:47], v[46:47], v[38:39] op_sel_hi:[1,0]
  v_pk_mul_f32 v[40:41], v[40:41], v[32:33] op_sel_hi:[1,0]
  v_pk_mul_f32 v[42:43], v[42:43], v[34:35] op_sel_hi:[1,0]
  v_pk_mul_f32 v[44:45], v[44:45], v[36:37] op_sel_hi:[1,0]
  v_pk_mul_f32 v[32:33], v[46:47], v[14:15] op_sel_hi:[1,0] neg_hi:[1,0]
  v_cvt_pk_f16_f32 v17, v40, v41
  v_pk_fma_f32 v[32:33], v[46:47], v[14:15], v[32:33] op_sel:[1,1,0] op_sel_hi:[0,1,1] neg_lo:[1,0,0] neg_hi:[1,0,0]
  v_cvt_pk_f16_f32 v21, v42, v43
  v_cvt_pk_f16_f32 v25, v44, v45
  v_cvt_pk_f16_f32 v29, v32, v33
  s_waitcnt lgkmcnt(0)
  ds_read_b128 v[12:15], v3 offset:48
  v_pk_mul_f32 v[38:39], v[8:9], v[6:7] op_sel:[0,1] op_sel_hi:[1,1]
  v_pk_mul_f32 v[32:33], v[8:9], v[4:5] op_sel:[0,0] op_sel_hi:[1,0]
  v_pk_mul_f32 v[34:35], v[8:9], v[4:5] op_sel:[0,1] op_sel_hi:[1,1]
  v_pk_mul_f32 v[36:37], v[8:9], v[6:7] op_sel:[0,0] op_sel_hi:[1,0]
  v_fract_f32 v39, v39
  v_fract_f32 v33, v33
  v_fract_f32 v35, v35
  v_fract_f32 v37, v37
  v_exp_f32 v38, v38
  v_cos_f32 v46, v39
  v_sin_f32 v47, v39
  v_exp_f32 v32, v32
  v_cos_f32 v40, v33
  v_sin_f32 v41, v33
  v_exp_f32 v34, v34
  v_cos_f32 v42, v35
  v_sin_f32 v43, v35
  v_exp_f32 v36, v36
  v_cos_f32 v44, v37
  v_sin_f32 v45, v37
  v_pk_mul_f32 v[46:47], v[46:47], v[38:39] op_sel_hi:[1,0]
  v_pk_mul_f32 v[40:41], v[40:41], v[32:33] op_sel_hi:[1,0]
  v_pk_mul_f32 v[42:43], v[42:43], v[34:35] op_sel_hi:[1,0]
  v_pk_mul_f32 v[44:45], v[44:45], v[36:37] op_sel_hi:[1,0]
  v_pk_mul_f32 v[32:33], v[46:47], v[10:11] op_sel_hi:[1,0] neg_hi:[1,0]
  v_cvt_pk_f16_f32 v18, v40, v41
  v_pk_fma_f32 v[32:33], v[46:47], v[10:11], v[32:33] op_sel:[1,1,0] op_sel_hi:[0,1,1] neg_lo:[1,0,0] neg_hi:[1,0,0]
  v_cvt_pk_f16_f32 v22, v42, v43
  v_cvt_pk_f16_f32 v26, v44, v45
  v_cvt_pk_f16_f32 v30, v32, v33
  s_waitcnt lgkmcnt(0)
  ds_read_b128 v[8:11], v3 offset:256
  v_pk_mul_f32 v[38:39], v[12:13], v[6:7] op_sel:[0,1] op_sel_hi:[1,1]
  v_pk_mul_f32 v[32:33], v[12:13], v[4:5] op_sel:[0,0] op_sel_hi:[1,0]
  v_pk_mul_f32 v[34:35], v[12:13], v[4:5] op_sel:[0,1] op_sel_hi:[1,1]
  v_pk_mul_f32 v[36:37], v[12:13], v[6:7] op_sel:[0,0] op_sel_hi:[1,0]
  v_fract_f32 v39, v39
  v_fract_f32 v33, v33
  v_fract_f32 v35, v35
  v_fract_f32 v37, v37
  v_exp_f32 v38, v38
  v_cos_f32 v46, v39
  v_sin_f32 v47, v39
  v_exp_f32 v32, v32
  v_cos_f32 v40, v33
  v_sin_f32 v41, v33
  v_exp_f32 v34, v34
  v_cos_f32 v42, v35
  v_sin_f32 v43, v35
  v_exp_f32 v36, v36
  v_cos_f32 v44, v37
  v_sin_f32 v45, v37
  v_pk_mul_f32 v[46:47], v[46:47], v[38:39] op_sel_hi:[1,0]
  v_pk_mul_f32 v[40:41], v[40:41], v[32:33] op_sel_hi:[1,0]
  v_pk_mul_f32 v[42:43], v[42:43], v[34:35] op_sel_hi:[1,0]
  v_pk_mul_f32 v[44:45], v[44:45], v[36:37] op_sel_hi:[1,0]
  v_pk_mul_f32 v[32:33], v[46:47], v[14:15] op_sel_hi:[1,0] neg_hi:[1,0]
  v_cvt_pk_f16_f32 v19, v40, v41
  v_pk_fma_f32 v[32:33], v[46:47], v[14:15], v[32:33] op_sel:[1,1,0] op_sel_hi:[0,1,1] neg_lo:[1,0,0] neg_hi:[1,0,0]
  v_cvt_pk_f16_f32 v23, v42, v43
  v_cvt_pk_f16_f32 v27, v44, v45
  v_cvt_pk_f16_f32 v31, v32, v33
  v_add_u32 v3, 256, v3
  s_sub_u32 s6, s6, 1
  s_cmp_lg_u32 s6, 0
  s_cbranch_scc1 L_kg_109
  s_cmp_lg_u32 s3, 0
  s_cbranch_scc1 L_wdo_111
  s_mov_b32 s7, 0
  v_mbcnt_lo_u32_b32 v216, -1, 0
  v_and_b32 v216, 3, v216
  v_lshlrev_b32 v216, 6, v216
L_wd_110:
  buffer_load_dword v217, v216, s[12:15], 0 offen offset:16 sc1
  s_waitcnt vmcnt(0)
  v_cmp_ne_u32 vcc, 64, v217
  s_cbranch_vccz L_wdo_111
  s_add_u32 s7, s7, 1
  s_cmp_lt_u32 s7, 131072
  s_cbranch_scc1 L_wd_110
  s_mov_b32 s6, 50
  s_branch L_err
L_wdo_111:
  s_barrier
  s_lshl_b32 s6, s3, 13
  s_add_u32 s6, s6, s62
  s_add_u32 s6, s6, 0xb000000
  s_lshl_b32 s7, s3, 10
  v_lshlrev_b32 v216, 7, v0
  s_add_u32 m0, s7, 44064
  s_nop 0
  buffer_load_dwordx4 v216, s[8:11], s6 offen lds
  s_add_u32 s6, s6, 16
  s_add_u32 m0, s7, 48192
  s_nop 0
  buffer_load_dwordx4 v216, s[8:11], s6 offen lds
  s_add_u32 s6, s6, 16
  s_add_u32 m0, s7, 52320
  s_nop 0
  buffer_load_dwordx4 v216, s[8:11], s6 offen lds
  s_add_u32 s6, s6, 16
  s_add_u32 m0, s7, 56448
  s_nop 0
  buffer_load_dwordx4 v216, s[8:11], s6 offen lds
  s_add_u32 s6, s6, 16
  s_add_u32 m0, s7, 60544
  s_nop 0
  buffer_load_dwordx4 v216, s[8:11], s6 offen lds
  s_add_u32 s6, s6, 16
  s_add_u32 m0, s7, 64640
  s_nop 0
  buffer_load_dwordx4 v216, s[8:11], s6 offen lds
  s_add_u32 s6, s6, 16
  s_add_u32 m0, s7, 68736
  s_nop 0
  buffer_load_dwordx4 v216, s[8:11], s6 offen lds
  s_add_u32 s6, s6, 16
  s_add_u32 m0, s7, 72832
  s_nop 0
  buffer_load_dwordx4 v216, s[8:11], s6 offen lds
  s_add_u32 s6, s6, 16
  s_mov_b32 s6, 2
L_kg_112:
  s_waitcnt lgkmcnt(0)
  ds_read_b128 v[12:15], v3 offset:16
  v_mfma_f32_16x16x32_f16 v[48:51], v[16:19], v[28:31], v[48:51]
  v_pk_mul_f32 v[38:39], v[8:9], v[6:7] op_sel:[0,1] op_sel_hi:[1,1]
  v_mfma_f32_16x16x32_f16 v[52:55], v[20:23], v[28:31], v[52:55]
  v_pk_mul_f32 v[32:33], v[8:9], v[4:5] op_sel:[0,0] op_sel_hi:[1,0]
  v_mfma_f32_16x16x32_f16 v[56:59], v[24:27], v[28:31], v[56:59]
  v_pk_mul_f32 v[34:35], v[8:9], v[4:5] op_sel:[0,1] op_sel_hi:[1,1]
  v_pk_mul_f32 v[36:37], v[8:9], v[6:7] op_sel:[0,0] op_sel_hi:[1,0]
  v_fract_f32 v39, v39
  v_fract_f32 v33, v33
  v_fract_f32 v35, v35
  v_fract_f32 v37, v37
  v_exp_f32 v38, v38
  v_cos_f32 v46, v39
  v_sin_f32 v47, v39
  v_exp_f32 v32, v32
  v_cos_f32 v40, v33
  v_sin_f32 v41, v33
  v_exp_f32 v34, v34
  v_cos_f32 v42, v35
  v_sin_f32 v43, v35
  v_exp_f32 v36, v36
  v_cos_f32 v44, v37
  v_sin_f32 v45, v37
  v_pk_mul_f32 v[46:47], v[46:47], v[38:39] op_sel_hi:[1,0]
  v_pk_mul_f32 v[40:41], v[40:41], v[32:33] op_sel_hi:[1,0]
  v_pk_mul_f32 v[42:43], v[42:43], v[34:35] op_sel_hi:[1,0]
  v_pk_mul_f32 v[44:45], v[44:45], v[36:37] op_sel_hi:[1,0]
  v_pk_mul_f32 v[32:33], v[46:47], v[10:11] op_sel_hi:[1,0] neg_hi:[1,0]
  v_cvt_pk_f16_f32 v16, v40, v41
  v_pk_fma_f32 v[32:33], v[46:47], v[10:11], v[32:33] op_sel:[1,1,0] op_sel_hi:[0,1,1] neg_lo:[1,0,0] neg_hi:[1,0,0]
  v_cvt_pk_f16_f32 v20, v42, v43
  v_cvt_pk_f16_f32 v24, v44, v45
  v_cvt_pk_f16_f32 v28, v32, v33
  s_waitcnt lgkmcnt(0)
  ds_read_b128 v[8:11], v3 offset:32
  v_pk_mul_f32 v[38:39], v[12:13], v[6:7] op_sel:[0,1] op_sel_hi:[1,1]
  v_pk_mul_f32 v[32:33], v[12:13], v[4:5] op_sel:[0,0] op_sel_hi:[1,0]
  v_pk_mul_f32 v[34:35], v[12:13], v[4:5] op_sel:[0,1] op_sel_hi:[1,1]
  v_pk_mul_f32 v[36:37], v[12:13], v[6:7] op_sel:[0,0] op_sel_hi:[1,0]
  v_fract_f32 v39, v39
  v_fract_f32 v33, v33
  v_fract_f32 v35, v35
  v_fract_f32 v37, v37
  v_exp_f32 v38, v38
  v_cos_f32 v46, v39
  v_sin_f32 v47, v39
  v_exp_f32 v32, v32
  v_cos_f32 v40, v33
  v_sin_f32 v41, v33
  v_exp_f32 v34, v34
  v_cos_f32 v42, v35
  v_sin_f32 v43, v35
  v_exp_f32 v36, v36
  v_cos_f32 v44, v37
  v_sin_f32 v45, v37
  v_pk_mul_f32 v[46:47], v[46:47], v[38:39] op_sel_hi:[1,0]
  v_pk_mul_f32 v[40:41], v[40:41], v[32:33] op_sel_hi:[1,0]
  v_pk_mul_f32 v[42:43], v[42:43], v[34:35] op_sel_hi:[1,0]
  v_pk_mul_f32 v[44:45], v[44:45], v[36:37] op_sel_hi:[1,0]
  v_pk_mul_f32 v[32:33], v[46:47], v[14:15] op_sel_hi:[1,0] neg_hi:[1,0]
  v_cvt_pk_f16_f32 v17, v40, v41
  v_pk_fma_f32 v[32:33], v[46:47], v[14:15], v[32:33] op_sel:[1,1,0] op_sel_hi:[0,1,1] neg_lo:[1,0,0] neg_hi:[1,0,0]
  v_cvt_pk_f16_f32 v21, v42, v43
  v_cvt_pk_f16_f32 v25, v44, v45
  v_cvt_pk_f16_f32 v29, v32, v33
  s_waitcnt lgkmcnt(0)
  ds_read_b128 v[12:15], v3 offset:48
  v_pk_mul_f32 v[38:39], v[8:9], v[6:7] op_sel:[0,1] op_sel_hi:[1,1]
  v_pk_mul_f32 v[32:33], v[8:9], v[4:5] op_sel:[0,0] op_sel_hi:[1,0]
  v_pk_mul_f32 v[34:35], v[8:9], v[4:5] op_sel:[0,1] op_sel_hi:[1,1]
  v_pk_mul_f32 v[36:37], v[8:9], v[6:7] op_sel:[0,0] op_sel_hi:[1,0]
  v_fract_f32 v39, v39
  v_fract_f32 v33, v33
  v_fract_f32 v35, v35
  v_fract_f32 v37, v37
  v_exp_f32 v38, v38
  v_cos_f32 v46, v39
  v_sin_f32 v47, v39
  v_exp_f32 v32, v32
  v_cos_f32 v40, v33
  v_sin_f32 v41, v33
  v_exp_f32 v34, v34
  v_cos_f32 v42, v35
  v_sin_f32 v43, v35
  v_exp_f32 v36, v36
  v_cos_f32 v44, v37
  v_sin_f32 v45, v37
  v_pk_mul_f32 v[46:47], v[46:47], v[38:39] op_sel_hi:[1,0]
  v_pk_mul_f32 v[40:41], v[40:41], v[32:33] op_sel_hi:[1,0]
  v_pk_mul_f32 v[42:43], v[42:43], v[34:35] op_sel_hi:[1,0]
  v_pk_mul_f32 v[44:45], v[44:45], v[36:37] op_sel_hi:[1,0]
  v_pk_mul_f32 v[32:33], v[46:47], v[10:11] op_sel_hi:[1,0] neg_hi:[1,0]
  v_cvt_pk_f16_f32 v18, v40, v41
  v_pk_fma_f32 v[32:33], v[46:47], v[10:11], v[32:33] op_sel:[1,1,0] op_sel_hi:[0,1,1] neg_lo:[1,0,0] neg_hi:[1,0,0]
  v_cvt_pk_f16_f32 v22, v42, v43
  v_cvt_pk_f16_f32 v26, v44, v45
  v_cvt_pk_f16_f32 v30, v32, v33
  s_waitcnt lgkmcnt(0)
  ds_read_b128 v[8:11], v3 offset:256
  v_pk_mul_f32 v[38:39], v[12:13], v[6:7] op_sel:[0,1] op_sel_hi:[1,1]
  v_pk_mul_f32 v[32:33], v[12:13], v[4:5] op_sel:[0,0] op_sel_hi:[1,0]
  v_pk_mul_f32 v[34:35], v[12:13], v[4:5] op_sel:[0,1] op_sel_hi:[1,1]
  v_pk_mul_f32 v[36:37], v[12:13], v[6:7] op_sel:[0,0] op_sel_hi:[1,0]
  v_fract_f32 v39, v39
  v_fract_f32 v33, v33
  v_fract_f32 v35, v35
  v_fract_f32 v37, v37
  v_exp_f32 v38, v38
  v_cos_f32 v46, v39
  v_sin_f32 v47, v39
  v_exp_f32 v32, v32
  v_cos_f32 v40, v33
  v_sin_f32 v41, v33
  v_exp_f32 v34, v34
  v_cos_f32 v42, v35
  v_sin_f32 v43, v35
  v_exp_f32 v36, v36
  v_cos_f32 v44, v37
  v_sin_f32 v45, v37
  v_pk_mul_f32 v[46:47], v[46:47], v[38:39] op_sel_hi:[1,0]
  v_pk_mul_f32 v[40:41], v[40:41], v[32:33] op_sel_hi:[1,0]
  v_pk_mul_f32 v[42:43], v[42:43], v[34:35] op_sel_hi:[1,0]
  v_pk_mul_f32 v[44:45], v[44:45], v[36:37] op_sel_hi:[1,0]
  v_pk_mul_f32 v[32:33], v[46:47], v[14:15] op_sel_hi:[1,0] neg_hi:[1,0]
  v_cvt_pk_f16_f32 v19, v40, v41
  v_pk_fma_f32 v[32:33], v[46:47], v[14:15], v[32:33] op_sel:[1,1,0] op_sel_hi:[0,1,1] neg_lo:[1,0,0] neg_hi:[1,0,0]
  v_cvt_pk_f16_f32 v23, v42, v43
  v_cvt_pk_f16_f32 v27, v44, v45
  v_cvt_pk_f16_f32 v31, v32, v33
  v_add_u32 v3, 256, v3
  s_sub_u32 s6, s6, 1
  s_cmp_lg_u32 s6, 0
  s_cbranch_scc1 L_kg_112
  v_mfma_f32_16x16x32_f16 v[48:51], v[16:19], v[28:31], v[48:51]
  v_mfma_f32_16x16x32_f16 v[52:55], v[20:23], v[28:31], v[52:55]
  v_mfma_f32_16x16x32_f16 v[56:59], v[24:27], v[28:31], v[56:59]
  s_waitcnt lgkmcnt(0)
  s_nop 4
  v_mul_f32 v48, v48, v233
  v_mul_f32 v49, v49, v233
  v_mul_f32 v50, v50, v233
  v_mul_f32 v51, v51, v233
  v_mul_f32 v52, v52, v233
  v_mul_f32 v53, v53, v233
  v_mul_f32 v54, v54, v233
  v_mul_f32 v55, v55, v233
  v_mul_f32 v56, v56, v233
  v_mul_f32 v57, v57, v233
  v_mul_f32 v58, v58, v233
  v_mul_f32 v59, v59, v233
  v_readlane_b32 s61, v52, 32
  v_lshrrev_b32 v16, 4, v0
  v_and_b32 v17, 15, v0
  v_lshlrev_b32 v17, 4, v17
  v_add_u32 v17, s63, v17
  v_lshrrev_b32 v18, 1, v16
  v_and_b32 v19, 1, v16
  v_lshlrev_b32 v20, 8, v18
  v_lshl_add_u32 v20, v19, 3, v20
  v_add3_u32 v20, v20, v17, 2
  v_lshlrev_b32 v21, 8, v19
  v_add_u32 v21, 516, v21
  v_cmp_eq_u32 vcc, 0, v18
  s_nop 1
  v_cndmask_b32 v21, 0, v21, vcc
  v_cndmask_b32 v22, 0, 4, vcc
  v_add_u32 v21, v21, v17
  v_lshlrev_b32 v23, 9, v19
  v_add_u32 v23, 1032, v23
  v_lshlrev_b32 v24, 10, v19
  v_add_u32 v24, 2064, v24
  v_cndmask_b32 v23, v24, v23, vcc
  v_add_u32 v23, v23, v17
  v_mov_b32 v24, 0x100
  v_cndmask_b32 v24, v24, 8, vcc
  v_mov_b32 v25, 0x200
  v_cndmask_b32 v25, v25, v24, vcc
  v_mov_b32 v26, 0x100
  v_cndmask_b32 v25, v25, v26, vcc
  v_cvt_pk_bf16_f32 v32, v48, v49
  v_cvt_pk_bf16_f32 v33, v50, v51
  v_cvt_pk_bf16_f32 v34, v52, v53
  v_cvt_pk_bf16_f32 v35, v54, v55
  v_cvt_pk_bf16_f32 v36, v56, v57
  v_cvt_pk_bf16_f32 v37, v58, v59
  ds_write_b16 v21, v34
  v_add_u32 v21, v21, v22
  ds_write_b16_d16_hi v21, v34
  v_add_u32 v21, v21, v22
  ds_write_b16 v21, v35
  v_add_u32 v21, v21, v22
  ds_write_b16_d16_hi v21, v35
  ds_write_b16 v20, v32 offset:0
  ds_write_b16_d16_hi v20, v32 offset:2
  ds_write_b16 v20, v33 offset:4
  ds_write_b16_d16_hi v20, v33 offset:6
  ds_write_b16 v23, v36
  v_add_u32 v26, v23, v24
  v_add_u32 v23, v23, v25
  ds_write_b16_d16_hi v26, v36
  ds_write_b16 v23, v37
  v_add_u32 v23, v23, v24
  ds_write_b16_d16_hi v23, v37
  ds_read_u16 v160, v160
  ds_read_u16 v161, v161
  ds_read_u16 v162, v162
  ds_read_u16 v163, v163
  ds_read_u16 v164, v164
  ds_read_u16 v165, v165
  ds_read_u16 v166, v166
  ds_read_u16 v167, v167
  ds_read_u16 v168, v168
  ds_read_u16 v169, v169
  ds_read_u16 v170, v170
  ds_read_u16 v171, v171
  ds_read_u16 v172, v172
  ds_read_u16 v173, v173
  ds_read_u16 v174, v174
  ds_read_u16 v175, v175
  ds_read_u16 v176, v176
  ds_read_u16 v177, v177
  ds_read_u16 v178, v178
  ds_read_u16 v179, v179
  ds_read_u16 v180, v180
  ds_read_u16 v181, v181
  ds_read_u16 v182, v182
  ds_read_u16 v183, v183
  ds_read_u16 v184, v184
  ds_read_u16 v185, v185
  ds_read_u16 v186, v186
  ds_read_u16 v187, v187
  ds_read_u16 v188, v188
  ds_read_u16 v189, v189
  ds_read_u16 v190, v190
  ds_read_u16 v191, v191
  s_mul_i32 s6, s3, 4608
  s_add_u32 s6, s6, 25600
  v_add_u32 v16, s6, v2
  s_mul_i32 s7, s60, 4608
  s_add_u32 s7, s7, 0x400000
  v_mov_b32 v21, 0
  v_mov_b32 v22, 0
  v_mov_b32 v23, 0
  v_mov_b32 v20, s61
  v_cmp_eq_u32 vcc, 30, v0
  s_nop 1
  v_cndmask_b32 v20, 0, v20, vcc
  s_mul_i32 s62, s3, 4128
  s_add_u32 s62, s62, 44032
  v_and_b32 v24, 16, v2
  v_add_u32 v24, s62, v24
  v_mov_b32 v28, 0
  v_mov_b32 v29, 0
  v_mov_b32 v30, 0
  v_mov_b32 v31, 0
  s_waitcnt lgkmcnt(15)
  v_lshl_or_b32 v160, v161, 16, v160
  v_lshl_or_b32 v161, v163, 16, v162
  v_lshl_or_b32 v162, v165, 16, v164
  v_lshl_or_b32 v163, v167, 16, v166
  ds_write_b128 v16, v[160:163] offset:0
  buffer_store_dwordx4 v[160:163], v2, s[8:11], s7 offen offset:0 sc1
  s_waitcnt lgkmcnt(15)
  s_waitcnt lgkmcnt(15)
  v_lshl_or_b32 v168, v169, 16, v168
  v_lshl_or_b32 v169, v171, 16, v170
  v_lshl_or_b32 v170, v173, 16, v172
  v_lshl_or_b32 v171, v175, 16, v174
  ds_write_b128 v16, v[168:171] offset:1024
  buffer_store_dwordx4 v[168:171], v2, s[8:11], s7 offen offset:1024 sc1
  s_waitcnt lgkmcnt(10)
  v_lshl_or_b32 v176, v177, 16, v176
  v_lshl_or_b32 v177, v179, 16, v178
  v_lshl_or_b32 v178, v181, 16, v180
  v_lshl_or_b32 v179, v183, 16, v182
  ds_write_b128 v16, v[176:179] offset:2048
  buffer_store_dwordx4 v[176:179], v2, s[8:11], s7 offen offset:2048 sc1
  s_waitcnt lgkmcnt(3)
  v_lshl_or_b32 v184, v185, 16, v184
  v_lshl_or_b32 v185, v187, 16, v186
  v_lshl_or_b32 v186, v189, 16, v188
  v_lshl_or_b32 v187, v191, 16, v190
  ds_write_b128 v16, v[184:187] offset:3072
  buffer_store_dwordx4 v[184:187], v2, s[8:11], s7 offen offset:3072 sc1
  s_add_u32 s7, s7, 4096
  ds_write_b128 v24, v[28:31]
  s_mov_b32 exec_hi, 0
  ds_write_b128 v16, v[20:23] offset:4096
  buffer_store_dwordx4 v[20:23], v2, s[8:11], s7 offen sc1
  s_mov_b32 exec_hi, -1
  v_and_b32 v16, 15, v0
  v_lshrrev_b32 v17, 4, v0
  v_lshlrev_b32 v18, 5, v16
  s_add_u32 s6, s6, 480
  v_sub_u32 v18, s6, v18
  v_lshl_add_u32 v4, v17, 4, v18
  v_lshlrev_b32 v18, 1, v16
  v_lshl_add_u32 v18, v17, 4, v18
  v_and_b32 v6, 2, v18
  v_and_b32 v18, -4, v18
  v_add_u32 v5, s62, v18
  v_lshlrev_b32 v18, 5, v16
  v_lshl_add_u32 v18, v17, 3, v18
  v_add3_u32 v7, v18, s62, 32
  s_lshl_b32 s7, s3, 12
  s_add_u32 s7, s7, 60544
  v_add_u32 v8, s7, v18
  v_lshrrev_b32 v18, 1, v16
  v_lshlrev_b32 v18, 15, v18
  v_and_b32 v19, 1, v16
  v_lshl_or_b32 v18, v19, 5, v18
  v_lshl_or_b32 v9, v17, 3, v18
  v_lshlrev_b32 v31, 16, v232
  v_add_u32 v60, 1024, v5
  v_add_u32 v61, 2048, v5
  v_add_u32 v62, 3072, v5
  s_lshl_b32 s62, s60, 6
  s_add_u32 s62, s62, 0x0
  s_waitcnt vmcnt(5) lgkmcnt(0)
  s_barrier
  ds_read_b128 a[32:35], v4 offset:4032
  ds_read_b128 a[36:39], v4 offset:3968
  ds_read_b128 a[40:43], v4 offset:3904
  ds_read2_b32 v[10:11], v5 offset0:112 offset1:113
  ds_read2_b32 v[12:13], v5 offset0:114 offset1:115
  ds_read_b32 v14, v5 offset:464
  ds_read2_b32 v[16:17], v5 offset0:96 offset1:97
  ds_read2_b32 v[18:19], v5 offset0:98 offset1:99
  ds_read_b32 v20, v5 offset:400
  ds_read2_b32 v[32:33], v5 offset0:80 offset1:81
  ds_read2_b32 v[34:35], v5 offset0:82 offset1:83
  ds_read_b32 v36, v5 offset:336
  ds_read2_b32 v[38:39], v5 offset0:64 offset1:65
  ds_read2_b32 v[40:41], v5 offset0:66 offset1:67
  ds_read_b32 v42, v5 offset:272
  ds_read2_b32 v[44:45], v5 offset0:48 offset1:49
  ds_read2_b32 v[46:47], v5 offset0:50 offset1:51
  ds_read_b32 v48, v5 offset:208
  s_waitcnt lgkmcnt(12)
  v_alignbyte_b32 v92, v11, v10, v6
  v_alignbyte_b32 v93, v12, v11, v6
  v_alignbyte_b32 v94, v13, v12, v6
  v_alignbyte_b32 v95, v14, v13, v6
  s_waitcnt lgkmcnt(9)
  v_alignbyte_b32 v88, v17, v16, v6
  v_alignbyte_b32 v89, v18, v17, v6
  v_alignbyte_b32 v90, v19, v18, v6
  v_alignbyte_b32 v91, v20, v19, v6
  v_mfma_f32_16x16x32_bf16 a[0:3], v[92:95], a[32:35], 0
  ds_read2_b32 v[10:11], v5 offset0:32 offset1:33
  ds_read2_b32 v[12:13], v5 offset0:34 offset1:35
  ds_read_b32 v14, v5 offset:144
  ds_read_b128 a[44:47], v4 offset:3840
  s_waitcnt lgkmcnt(10)
  v_alignbyte_b32 v84, v33, v32, v6
  v_alignbyte_b32 v85, v34, v33, v6
  v_alignbyte_b32 v86, v35, v34, v6
  v_alignbyte_b32 v87, v36, v35, v6
  v_mfma_f32_16x16x32_bf16 a[0:3], v[88:91], a[36:39], a[0:3]
  ds_read2_b32 v[16:17], v5 offset0:16 offset1:17
  ds_read2_b32 v[18:19], v5 offset0:18 offset1:19
  ds_read_b32 v20, v5 offset:80
  ds_read_b128 a[32:35], v4 offset:3776
  s_waitcnt lgkmcnt(11)
  v_alignbyte_b32 v80, v39, v38, v6
  v_alignbyte_b32 v81, v40, v39, v6
  v_alignbyte_b32 v82, v41, v40, v6
  v_alignbyte_b32 v83, v42, v41, v6
  v_mfma_f32_16x16x32_bf16 a[0:3], v[84:87], a[40:43], a[0:3]
  ds_read2_b32 v[32:33], v5 offset0:0 offset1:1
  ds_read2_b32 v[34:35], v5 offset0:2 offset1:3
  ds_read_b32 v36, v5 offset:16
  ds_read_b128 a[36:39], v4 offset:3712
  s_waitcnt lgkmcnt(12)
  v_alignbyte_b32 v76, v45, v44, v6
  v_alignbyte_b32 v77, v46, v45, v6
  v_alignbyte_b32 v78, v47, v46, v6
  v_alignbyte_b32 v79, v48, v47, v6
  s_waitcnt lgkmcnt(8)
  v_mfma_f32_16x16x32_bf16 a[0:3], v[80:83], a[44:47], a[0:3]
  ds_read2_b32 v[38:39], v62 offset0:240 offset1:241
  ds_read2_b32 v[40:41], v62 offset0:242 offset1:243
  ds_read_b32 v42, v62 offset:976
  ds_read_b128 a[40:43], v4 offset:3648
  v_alignbyte_b32 v72, v11, v10, v6
  v_alignbyte_b32 v73, v12, v11, v6
  v_alignbyte_b32 v74, v13, v12, v6
  v_alignbyte_b32 v75, v14, v13, v6
  s_waitcnt lgkmcnt(8)
  v_mfma_f32_16x16x32_bf16 a[0:3], v[76:79], a[32:35], a[0:3]
  ds_read2_b32 v[44:45], v62 offset0:112 offset1:113
  ds_read2_b32 v[46:47], v62 offset0:114 offset1:115
  ds_read_b32 v48, v62 offset:464
  ds_read_b128 a[44:47], v4 offset:3584
  v_alignbyte_b32 v68, v17, v16, v6
  v_alignbyte_b32 v69, v18, v17, v6
  v_alignbyte_b32 v70, v19, v18, v6
  v_alignbyte_b32 v71, v20, v19, v6
  s_waitcnt lgkmcnt(8)
  v_mfma_f32_16x16x32_bf16 a[0:3], v[72:75], a[36:39], a[0:3]
  ds_read2_b32 v[10:11], v61 offset0:240 offset1:241
  ds_read2_b32 v[12:13], v61 offset0:242 offset1:243
  ds_read_b32 v14, v61 offset:976
  ds_read_b128 a[32:35], v4 offset:4032
  v_alignbyte_b32 v64, v33, v32, v6
  v_alignbyte_b32 v65, v34, v33, v6
  v_alignbyte_b32 v66, v35, v34, v6
  v_alignbyte_b32 v67, v36, v35, v6
  s_waitcnt lgkmcnt(8)
  v_mfma_f32_16x16x32_bf16 a[0:3], v[68:71], a[40:43], a[0:3]
  ds_read2_b32 v[16:17], v61 offset0:112 offset1:113
  ds_read2_b32 v[18:19], v61 offset0:114 offset1:115
  ds_read_b32 v20, v61 offset:464
  ds_read_b128 a[36:39], v4 offset:3968
  v_alignbyte_b32 v26, v39, v38, v6
  v_alignbyte_b32 v27, v40, v39, v6
  v_alignbyte_b32 v28, v41, v40, v6
  v_alignbyte_b32 v29, v42, v41, v6
  s_waitcnt lgkmcnt(8)
  v_mfma_f32_16x16x32_bf16 a[0:3], v[64:67], a[44:47], a[0:3]
  ds_read2_b32 v[32:33], v60 offset0:240 offset1:241
  ds_read2_b32 v[34:35], v60 offset0:242 offset1:243
  ds_read_b32 v36, v60 offset:976
  ds_read_b128 a[40:43], v4 offset:3904
  v_alignbyte_b32 v56, v45, v44, v6
  v_alignbyte_b32 v57, v46, v45, v6
  v_alignbyte_b32 v58, v47, v46, v6
  v_alignbyte_b32 v59, v48, v47, v6
  v_accvgpr_write_b32 a92, v56
  v_accvgpr_write_b32 a93, v57
  v_accvgpr_write_b32 a94, v58
  v_accvgpr_write_b32 a95, v59
  s_waitcnt lgkmcnt(8)
  v_mfma_f32_16x16x32_bf16 a[28:31], v[26:29], a[32:35], 0
  ds_read2_b32 v[38:39], v60 offset0:112 offset1:113
  ds_read2_b32 v[40:41], v60 offset0:114 offset1:115
  ds_read_b32 v42, v60 offset:464
  ds_read_b128 a[44:47], v4 offset:3840
  ds_read_b64 v[224:225], v7 offset:0
  ds_read_b64 v[226:227], v8 offset:0
  v_accvgpr_read_b32 v96, a0
  v_accvgpr_read_b32 v97, a1
  v_accvgpr_read_b32 v98, a2
  v_accvgpr_read_b32 v99, a3
  s_waitcnt lgkmcnt(0)
  v_lshlrev_b32 v128, 16, v224
  v_and_b32 v129, 0xffff0000, v224
  v_lshlrev_b32 v130, 16, v225
  v_and_b32 v131, 0xffff0000, v225
  v_lshlrev_b32 v192, 16, v226
  v_and_b32 v193, 0xffff0000, v226
  v_lshlrev_b32 v194, 16, v227
  v_and_b32 v195, 0xffff0000, v227
  v_mul_f32 v160, v128, v31
  v_mul_f32 v161, v129, v31
  v_mul_f32 v162, v130, v31
  v_mul_f32 v163, v131, v31
  v_fmac_f32 v96, s61, v128
  v_fmac_f32 v97, s61, v129
  v_fmac_f32 v98, s61, v130
  v_fmac_f32 v99, s61, v131
  v_cvt_pk_bf16_f32 v224, v160, v161
  v_cvt_pk_bf16_f32 v225, v162, v163
  v_lshlrev_b32 v160, 16, v224
  v_and_b32 v161, 0xffff0000, v224
  v_lshlrev_b32 v162, 16, v225
  v_and_b32 v163, 0xffff0000, v225
  v_cvt_pk_bf16_f32 v224, v96, v97
  v_cvt_pk_bf16_f32 v225, v98, v99
  v_lshlrev_b32 v96, 16, v224
  v_and_b32 v97, 0xffff0000, v224
  v_lshlrev_b32 v98, 16, v225
  v_and_b32 v99, 0xffff0000, v225
  v_add_f32 v96, v96, v160
  v_add_f32 v97, v97, v161
  v_add_f32 v98, v98, v162
  v_add_f32 v99, v99, v163
  v_cvt_pk_bf16_f32 v224, v96, v97
  v_cvt_pk_bf16_f32 v225, v98, v99
  v_lshlrev_b32 v96, 16, v224
  v_and_b32 v97, 0xffff0000, v224
  v_lshlrev_b32 v98, 16, v225
  v_and_b32 v99, 0xffff0000, v225
  v_add_f32 v96, v96, v192
  v_add_f32 v97, v97, v193
  v_add_f32 v98, v98, v194
  v_add_f32 v99, v99, v195
  v_cvt_pk_bf16_f32 v224, v96, v97
  v_cvt_pk_bf16_f32 v225, v98, v99
  s_add_u32 s6, s62, 0
  buffer_store_dwordx2 v[224:225], v9, s[8:11], s6 offen sc1
  v_alignbyte_b32 v252, v11, v10, v6
  v_alignbyte_b32 v253, v12, v11, v6
  v_alignbyte_b32 v254, v13, v12, v6
  v_alignbyte_b32 v255, v14, v13, v6
  v_mfma_f32_16x16x32_bf16 a[24:27], a[92:95], a[32:35], 0
  ds_read2_b32 v[44:45], v5 offset0:240 offset1:241
  ds_read2_b32 v[46:47], v5 offset0:242 offset1:243
  ds_read_b32 v48, v5 offset:976
  v_alignbyte_b32 v220, v17, v16, v6
  v_alignbyte_b32 v221, v18, v17, v6
  v_alignbyte_b32 v222, v19, v18, v6
  v_alignbyte_b32 v223, v20, v19, v6
  v_mfma_f32_16x16x32_bf16 a[20:23], v[252:255], a[32:35], 0
  ds_read2_b32 v[10:11], v62 offset0:224 offset1:225
  ds_read2_b32 v[12:13], v62 offset0:226 offset1:227
  ds_read_b32 v14, v62 offset:912
  v_alignbyte_b32 v188, v33, v32, v6
  v_alignbyte_b32 v189, v34, v33, v6
  v_alignbyte_b32 v190, v35, v34, v6
  v_alignbyte_b32 v191, v36, v35, v6
  v_mfma_f32_16x16x32_bf16 a[16:19], v[220:223], a[32:35], 0
  ds_read2_b32 v[16:17], v62 offset0:96 offset1:97
  ds_read2_b32 v[18:19], v62 offset0:98 offset1:99
  ds_read_b32 v20, v62 offset:400
  v_alignbyte_b32 v156, v39, v38, v6
  v_alignbyte_b32 v157, v40, v39, v6
  v_alignbyte_b32 v158, v41, v40, v6
  v_alignbyte_b32 v159, v42, v41, v6
  v_mfma_f32_16x16x32_bf16 a[12:15], v[188:191], a[32:35], 0
  ds_read2_b32 v[32:33], v61 offset0:224 offset1:225
  ds_read2_b32 v[34:35], v61 offset0:226 offset1:227
  ds_read_b32 v36, v61 offset:912
  s_waitcnt lgkmcnt(9)
  v_alignbyte_b32 v124, v45, v44, v6
  v_alignbyte_b32 v125, v46, v45, v6
  v_alignbyte_b32 v126, v47, v46, v6
  v_alignbyte_b32 v127, v48, v47, v6
  v_mfma_f32_16x16x32_bf16 a[8:11], v[156:159], a[32:35], 0
  ds_read2_b32 v[38:39], v61 offset0:96 offset1:97
  ds_read2_b32 v[40:41], v61 offset0:98 offset1:99
  ds_read_b32 v42, v61 offset:400
  s_waitcnt lgkmcnt(9)
  v_alignbyte_b32 v22, v11, v10, v6
  v_alignbyte_b32 v23, v12, v11, v6
  v_alignbyte_b32 v24, v13, v12, v6
  v_alignbyte_b32 v25, v14, v13, v6
  v_mfma_f32_16x16x32_bf16 a[4:7], v[124:127], a[32:35], 0
  ds_read2_b32 v[44:45], v60 offset0:224 offset1:225
  ds_read2_b32 v[46:47], v60 offset0:226 offset1:227
  ds_read_b32 v48, v60 offset:912
  s_waitcnt lgkmcnt(9)
  v_alignbyte_b32 v56, v17, v16, v6
  v_alignbyte_b32 v57, v18, v17, v6
  v_alignbyte_b32 v58, v19, v18, v6
  v_alignbyte_b32 v59, v20, v19, v6
  v_accvgpr_write_b32 a88, v56
  v_accvgpr_write_b32 a89, v57
  v_accvgpr_write_b32 a90, v58
  v_accvgpr_write_b32 a91, v59
  v_mfma_f32_16x16x32_bf16 a[28:31], v[22:25], a[36:39], a[28:31]
  ds_read2_b32 v[10:11], v60 offset0:96 offset1:97
  ds_read2_b32 v[12:13], v60 offset0:98 offset1:99
  ds_read_b32 v14, v60 offset:400
  ds_read_b128 a[32:35], v4 offset:3776
  s_waitcnt lgkmcnt(10)
  v_alignbyte_b32 v248, v33, v32, v6
  v_alignbyte_b32 v249, v34, v33, v6
  v_alignbyte_b32 v250, v35, v34, v6
  v_alignbyte_b32 v251, v36, v35, v6
  v_mfma_f32_16x16x32_bf16 a[24:27], a[88:91], a[36:39], a[24:27]
  ds_read2_b32 v[16:17], v5 offset0:224 offset1:225
  ds_read2_b32 v[18:19], v5 offset0:226 offset1:227
  ds_read_b32 v20, v5 offset:912
  s_waitcnt lgkmcnt(10)
  v_alignbyte_b32 v216, v39, v38, v6
  v_alignbyte_b32 v217, v40, v39, v6
  v_alignbyte_b32 v218, v41, v40, v6
  v_alignbyte_b32 v219, v42, v41, v6
  v_mfma_f32_16x16x32_bf16 a[20:23], v[248:251], a[36:39], a[20:23]
  ds_read2_b32 v[32:33], v62 offset0:208 offset1:209
  ds_read2_b32 v[34:35], v62 offset0:210 offset1:211
  ds_read_b32 v36, v62 offset:848
  s_waitcnt lgkmcnt(10)
  v_alignbyte_b32 v184, v45, v44, v6
  v_alignbyte_b32 v185, v46, v45, v6
  v_alignbyte_b32 v186, v47, v46, v6
  v_alignbyte_b32 v187, v48, v47, v6
  v_mfma_f32_16x16x32_bf16 a[16:19], v[216:219], a[36:39], a[16:19]
  ds_read2_b32 v[38:39], v62 offset0:80 offset1:81
  ds_read2_b32 v[40:41], v62 offset0:82 offset1:83
  ds_read_b32 v42, v62 offset:336
  s_waitcnt lgkmcnt(10)
  v_alignbyte_b32 v152, v11, v10, v6
  v_alignbyte_b32 v153, v12, v11, v6
  v_alignbyte_b32 v154, v13, v12, v6
  v_alignbyte_b32 v155, v14, v13, v6
  v_mfma_f32_16x16x32_bf16 a[12:15], v[184:187], a[36:39], a[12:15]
  ds_read2_b32 v[44:45], v61 offset0:208 offset1:209
  ds_read2_b32 v[46:47], v61 offset0:210 offset1:211
  ds_read_b32 v48, v61 offset:848
  s_waitcnt lgkmcnt(9)
  v_alignbyte_b32 v120, v17, v16, v6
  v_alignbyte_b32 v121, v18, v17, v6
  v_alignbyte_b32 v122, v19, v18, v6
  v_alignbyte_b32 v123, v20, v19, v6
  v_mfma_f32_16x16x32_bf16 a[8:11], v[152:155], a[36:39], a[8:11]
  ds_read2_b32 v[10:11], v61 offset0:80 offset1:81
  ds_read2_b32 v[12:13], v61 offset0:82 offset1:83
  ds_read_b32 v14, v61 offset:336
  s_waitcnt lgkmcnt(9)
  v_alignbyte_b32 v26, v33, v32, v6
  v_alignbyte_b32 v27, v34, v33, v6
  v_alignbyte_b32 v28, v35, v34, v6
  v_alignbyte_b32 v29, v36, v35, v6
  v_mfma_f32_16x16x32_bf16 a[4:7], v[120:123], a[36:39], a[4:7]
  ds_read2_b32 v[16:17], v60 offset0:208 offset1:209
  ds_read2_b32 v[18:19], v60 offset0:210 offset1:211
  ds_read_b32 v20, v60 offset:848
  s_waitcnt lgkmcnt(9)
  v_alignbyte_b32 v56, v39, v38, v6
  v_alignbyte_b32 v57, v40, v39, v6
  v_alignbyte_b32 v58, v41, v40, v6
  v_alignbyte_b32 v59, v42, v41, v6
  v_accvgpr_write_b32 a84, v56
  v_accvgpr_write_b32 a85, v57
  v_accvgpr_write_b32 a86, v58
  v_accvgpr_write_b32 a87, v59
  v_mfma_f32_16x16x32_bf16 a[28:31], v[26:29], a[40:43], a[28:31]
  ds_read2_b32 v[32:33], v60 offset0:80 offset1:81
  ds_read2_b32 v[34:35], v60 offset0:82 offset1:83
  ds_read_b32 v36, v60 offset:336
  ds_read_b128 a[36:39], v4 offset:3712
  s_lshl_b32 s6, s60, 2
  s_add_u32 s6, s6, 0x710000
  v_mov_b32 v226, 8
  s_waitcnt vmcnt(0)
  s_mov_b64 exec, 1
  buffer_store_dword v226, v1, s[8:11], s6 offen sc1
  s_mov_b64 exec, -1
  s_waitcnt lgkmcnt(10)
  v_alignbyte_b32 v244, v45, v44, v6
  v_alignbyte_b32 v245, v46, v45, v6
  v_alignbyte_b32 v246, v47, v46, v6
  v_alignbyte_b32 v247, v48, v47, v6
  v_mfma_f32_16x16x32_bf16 a[24:27], a[84:87], a[40:43], a[24:27]
  ds_read2_b32 v[38:39], v5 offset0:208 offset1:209
  ds_read2_b32 v[40:41], v5 offset0:210 offset1:211
  ds_read_b32 v42, v5 offset:848
  s_waitcnt lgkmcnt(10)
  v_alignbyte_b32 v212, v11, v10, v6
  v_alignbyte_b32 v213, v12, v11, v6
  v_alignbyte_b32 v214, v13, v12, v6
  v_alignbyte_b32 v215, v14, v13, v6
  v_mfma_f32_16x16x32_bf16 a[20:23], v[244:247], a[40:43], a[20:23]
  ds_read2_b32 v[44:45], v62 offset0:192 offset1:193
  ds_read2_b32 v[46:47], v62 offset0:194 offset1:195
  ds_read_b32 v48, v62 offset:784
  s_waitcnt lgkmcnt(10)
  v_alignbyte_b32 v180, v17, v16, v6
  v_alignbyte_b32 v181, v18, v17, v6
  v_alignbyte_b32 v182, v19, v18, v6
  v_alignbyte_b32 v183, v20, v19, v6
  v_mfma_f32_16x16x32_bf16 a[16:19], v[212:215], a[40:43], a[16:19]
  ds_read2_b32 v[10:11], v62 offset0:64 offset1:65
  ds_read2_b32 v[12:13], v62 offset0:66 offset1:67
  ds_read_b32 v14, v62 offset:272
  s_waitcnt lgkmcnt(10)
  v_alignbyte_b32 v148, v33, v32, v6
  v_alignbyte_b32 v149, v34, v33, v6
  v_alignbyte_b32 v150, v35, v34, v6
  v_alignbyte_b32 v151, v36, v35, v6
  v_mfma_f32_16x16x32_bf16 a[12:15], v[180:183], a[40:43], a[12:15]
  ds_read2_b32 v[16:17], v61 offset0:192 offset1:193
  ds_read2_b32 v[18:19], v61 offset0:194 offset1:195
  ds_read_b32 v20, v61 offset:784
  s_waitcnt lgkmcnt(9)
  v_alignbyte_b32 v116, v39, v38, v6
  v_alignbyte_b32 v117, v40, v39, v6
  v_alignbyte_b32 v118, v41, v40, v6
  v_alignbyte_b32 v119, v42, v41, v6
  v_mfma_f32_16x16x32_bf16 a[8:11], v[148:151], a[40:43], a[8:11]
  ds_read2_b32 v[32:33], v61 offset0:64 offset1:65
  ds_read2_b32 v[34:35], v61 offset0:66 offset1:67
  ds_read_b32 v36, v61 offset:272
  s_waitcnt lgkmcnt(9)
  v_alignbyte_b32 v22, v45, v44, v6
  v_alignbyte_b32 v23, v46, v45, v6
  v_alignbyte_b32 v24, v47, v46, v6
  v_alignbyte_b32 v25, v48, v47, v6
  v_mfma_f32_16x16x32_bf16 a[4:7], v[116:119], a[40:43], a[4:7]
  ds_read2_b32 v[38:39], v60 offset0:192 offset1:193
  ds_read2_b32 v[40:41], v60 offset0:194 offset1:195
  ds_read_b32 v42, v60 offset:784
  s_waitcnt lgkmcnt(9)
  v_alignbyte_b32 v56, v11, v10, v6
  v_alignbyte_b32 v57, v12, v11, v6
  v_alignbyte_b32 v58, v13, v12, v6
  v_alignbyte_b32 v59, v14, v13, v6
  v_accvgpr_write_b32 a80, v56
  v_accvgpr_write_b32 a81, v57
  v_accvgpr_write_b32 a82, v58
  v_accvgpr_write_b32 a83, v59
  v_mfma_f32_16x16x32_bf16 a[28:31], v[22:25], a[44:47], a[28:31]
  ds_read2_b32 v[44:45], v60 offset0:64 offset1:65
  ds_read2_b32 v[46:47], v60 offset0:66 offset1:67
  ds_read_b32 v48, v60 offset:272
  ds_read_b128 a[40:43], v4 offset:3648
  s_waitcnt lgkmcnt(10)
  v_alignbyte_b32 v240, v17, v16, v6
  v_alignbyte_b32 v241, v18, v17, v6
  v_alignbyte_b32 v242, v19, v18, v6
  v_alignbyte_b32 v243, v20, v19, v6
  v_mfma_f32_16x16x32_bf16 a[24:27], a[80:83], a[44:47], a[24:27]
  ds_read2_b32 v[10:11], v5 offset0:192 offset1:193
  ds_read2_b32 v[12:13], v5 offset0:194 offset1:195
  ds_read_b32 v14, v5 offset:784
  s_waitcnt lgkmcnt(10)
  v_alignbyte_b32 v208, v33, v32, v6
  v_alignbyte_b32 v209, v34, v33, v6
  v_alignbyte_b32 v210, v35, v34, v6
  v_alignbyte_b32 v211, v36, v35, v6
  v_mfma_f32_16x16x32_bf16 a[20:23], v[240:243], a[44:47], a[20:23]
  ds_read2_b32 v[16:17], v62 offset0:176 offset1:177
  ds_read2_b32 v[18:19], v62 offset0:178 offset1:179
  ds_read_b32 v20, v62 offset:720
  s_waitcnt lgkmcnt(10)
  v_alignbyte_b32 v176, v39, v38, v6
  v_alignbyte_b32 v177, v40, v39, v6
  v_alignbyte_b32 v178, v41, v40, v6
  v_alignbyte_b32 v179, v42, v41, v6
  v_mfma_f32_16x16x32_bf16 a[16:19], v[208:211], a[44:47], a[16:19]
  ds_read2_b32 v[32:33], v62 offset0:48 offset1:49
  ds_read2_b32 v[34:35], v62 offset0:50 offset1:51
  ds_read_b32 v36, v62 offset:208
  s_waitcnt lgkmcnt(10)
  v_alignbyte_b32 v144, v45, v44, v6
  v_alignbyte_b32 v145, v46, v45, v6
  v_alignbyte_b32 v146, v47, v46, v6
  v_alignbyte_b32 v147, v48, v47, v6
  v_mfma_f32_16x16x32_bf16 a[12:15], v[176:179], a[44:47], a[12:15]
  ds_read2_b32 v[38:39], v61 offset0:176 offset1:177
  ds_read2_b32 v[40:41], v61 offset0:178 offset1:179
  ds_read_b32 v42, v61 offset:720
  s_waitcnt lgkmcnt(9)
  v_alignbyte_b32 v112, v11, v10, v6
  v_alignbyte_b32 v113, v12, v11, v6
  v_alignbyte_b32 v114, v13, v12, v6
  v_alignbyte_b32 v115, v14, v13, v6
  v_mfma_f32_16x16x32_bf16 a[8:11], v[144:147], a[44:47], a[8:11]
  ds_read2_b32 v[44:45], v61 offset0:48 offset1:49
  ds_read2_b32 v[46:47], v61 offset0:50 offset1:51
  ds_read_b32 v48, v61 offset:208
  s_waitcnt lgkmcnt(9)
  v_alignbyte_b32 v26, v17, v16, v6
  v_alignbyte_b32 v27, v18, v17, v6
  v_alignbyte_b32 v28, v19, v18, v6
  v_alignbyte_b32 v29, v20, v19, v6
  v_mfma_f32_16x16x32_bf16 a[4:7], v[112:115], a[44:47], a[4:7]
  ds_read2_b32 v[10:11], v60 offset0:176 offset1:177
  ds_read2_b32 v[12:13], v60 offset0:178 offset1:179
  ds_read_b32 v14, v60 offset:720
  s_waitcnt lgkmcnt(9)
  v_alignbyte_b32 v56, v33, v32, v6
  v_alignbyte_b32 v57, v34, v33, v6
  v_alignbyte_b32 v58, v35, v34, v6
  v_alignbyte_b32 v59, v36, v35, v6
  v_accvgpr_write_b32 a76, v56
  v_accvgpr_write_b32 a77, v57
  v_accvgpr_write_b32 a78, v58
  v_accvgpr_write_b32 a79, v59
  v_mfma_f32_16x16x32_bf16 a[28:31], v[26:29], a[32:35], a[28:31]
  ds_read2_b32 v[16:17], v60 offset0:48 offset1:49
  ds_read2_b32 v[18:19], v60 offset0:50 offset1:51
  ds_read_b32 v20, v60 offset:208
  ds_read_b128 a[44:47], v4 offset:3584
  s_waitcnt lgkmcnt(10)
  v_alignbyte_b32 v236, v39, v38, v6
  v_alignbyte_b32 v237, v40, v39, v6
  v_alignbyte_b32 v238, v41, v40, v6
  v_alignbyte_b32 v239, v42, v41, v6
  v_mfma_f32_16x16x32_bf16 a[24:27], a[76:79], a[32:35], a[24:27]
  ds_read2_b32 v[32:33], v5 offset0:176 offset1:177
  ds_read2_b32 v[34:35], v5 offset0:178 offset1:179
  ds_read_b32 v36, v5 offset:720
  s_waitcnt lgkmcnt(10)
  v_alignbyte_b32 v204, v45, v44, v6
  v_alignbyte_b32 v205, v46, v45, v6
  v_alignbyte_b32 v206, v47, v46, v6
  v_alignbyte_b32 v207, v48, v47, v6
  v_mfma_f32_16x16x32_bf16 a[20:23], v[236:239], a[32:35], a[20:23]
  ds_read2_b32 v[38:39], v62 offset0:160 offset1:161
  ds_read2_b32 v[40:41], v62 offset0:162 offset1:163
  ds_read_b32 v42, v62 offset:656
  s_waitcnt lgkmcnt(10)
  v_alignbyte_b32 v172, v11, v10, v6
  v_alignbyte_b32 v173, v12, v11, v6
  v_alignbyte_b32 v174, v13, v12, v6
  v_alignbyte_b32 v175, v14, v13, v6
  v_mfma_f32_16x16x32_bf16 a[16:19], v[204:207], a[32:35], a[16:19]
  ds_read2_b32 v[44:45], v62 offset0:32 offset1:33
  ds_read2_b32 v[46:47], v62 offset0:34 offset1:35
  ds_read_b32 v48, v62 offset:144
  s_waitcnt lgkmcnt(10)
  v_alignbyte_b32 v140, v17, v16, v6
  v_alignbyte_b32 v141, v18, v17, v6
  v_alignbyte_b32 v142, v19, v18, v6
  v_alignbyte_b32 v143, v20, v19, v6
  v_mfma_f32_16x16x32_bf16 a[12:15], v[172:175], a[32:35], a[12:15]
  ds_read2_b32 v[10:11], v61 offset0:160 offset1:161
  ds_read2_b32 v[12:13], v61 offset0:162 offset1:163
  ds_read_b32 v14, v61 offset:656
  s_waitcnt lgkmcnt(9)
  v_alignbyte_b32 v108, v33, v32, v6
  v_alignbyte_b32 v109, v34, v33, v6
  v_alignbyte_b32 v110, v35, v34, v6
  v_alignbyte_b32 v111, v36, v35, v6
  v_mfma_f32_16x16x32_bf16 a[8:11], v[140:143], a[32:35], a[8:11]
  ds_read2_b32 v[16:17], v61 offset0:32 offset1:33
  ds_read2_b32 v[18:19], v61 offset0:34 offset1:35
  ds_read_b32 v20, v61 offset:144
  s_waitcnt lgkmcnt(9)
  v_alignbyte_b32 v22, v39, v38, v6
  v_alignbyte_b32 v23, v40, v39, v6
  v_alignbyte_b32 v24, v41, v40, v6
  v_alignbyte_b32 v25, v42, v41, v6
  v_mfma_f32_16x16x32_bf16 a[4:7], v[108:111], a[32:35], a[4:7]
  ds_read2_b32 v[32:33], v60 offset0:160 offset1:161
  ds_read2_b32 v[34:35], v60 offset0:162 offset1:163
  ds_read_b32 v36, v60 offset:656
  s_waitcnt lgkmcnt(9)
  v_alignbyte_b32 v56, v45, v44, v6
  v_alignbyte_b32 v57, v46, v45, v6
  v_alignbyte_b32 v58, v47, v46, v6
  v_alignbyte_b32 v59, v48, v47, v6
  v_accvgpr_write_b32 a72, v56
  v_accvgpr_write_b32 a73, v57
  v_accvgpr_write_b32 a74, v58
  v_accvgpr_write_b32 a75, v59
  v_mfma_f32_16x16x32_bf16 a[28:31], v[22:25], a[36:39], a[28:31]
  ds_read2_b32 v[38:39], v60 offset0:32 offset1:33
  ds_read2_b32 v[40:41], v60 offset0:34 offset1:35
  ds_read_b32 v42, v60 offset:144
  ds_read_b128 a[32:35], v4 offset:3520
  s_waitcnt lgkmcnt(10)
  v_alignbyte_b32 v232, v11, v10, v6
  v_alignbyte_b32 v233, v12, v11, v6
  v_alignbyte_b32 v234, v13, v12, v6
  v_alignbyte_b32 v235, v14, v13, v6
  v_mfma_f32_16x16x32_bf16 a[24:27], a[72:75], a[36:39], a[24:27]
  ds_read2_b32 v[44:45], v5 offset0:160 offset1:161
  ds_read2_b32 v[46:47], v5 offset0:162 offset1:163
  ds_read_b32 v48, v5 offset:656
  s_waitcnt lgkmcnt(10)
  v_alignbyte_b32 v200, v17, v16, v6
  v_alignbyte_b32 v201, v18, v17, v6
  v_alignbyte_b32 v202, v19, v18, v6
  v_alignbyte_b32 v203, v20, v19, v6
  v_mfma_f32_16x16x32_bf16 a[20:23], v[232:235], a[36:39], a[20:23]
  ds_read2_b32 v[10:11], v62 offset0:144 offset1:145
  ds_read2_b32 v[12:13], v62 offset0:146 offset1:147
  ds_read_b32 v14, v62 offset:592
  s_waitcnt lgkmcnt(10)
  v_alignbyte_b32 v168, v33, v32, v6
  v_alignbyte_b32 v169, v34, v33, v6
  v_alignbyte_b32 v170, v35, v34, v6
  v_alignbyte_b32 v171, v36, v35, v6
  v_mfma_f32_16x16x32_bf16 a[16:19], v[200:203], a[36:39], a[16:19]
  ds_read2_b32 v[16:17], v62 offset0:16 offset1:17
  ds_read2_b32 v[18:19], v62 offset0:18 offset1:19
  ds_read_b32 v20, v62 offset:80
  s_waitcnt lgkmcnt(10)
  v_alignbyte_b32 v136, v39, v38, v6
  v_alignbyte_b32 v137, v40, v39, v6
  v_alignbyte_b32 v138, v41, v40, v6
  v_alignbyte_b32 v139, v42, v41, v6
  v_mfma_f32_16x16x32_bf16 a[12:15], v[168:171], a[36:39], a[12:15]
  ds_read2_b32 v[32:33], v61 offset0:144 offset1:145
  ds_read2_b32 v[34:35], v61 offset0:146 offset1:147
  ds_read_b32 v36, v61 offset:592
  s_waitcnt lgkmcnt(9)
  v_alignbyte_b32 v104, v45, v44, v6
  v_alignbyte_b32 v105, v46, v45, v6
  v_alignbyte_b32 v106, v47, v46, v6
  v_alignbyte_b32 v107, v48, v47, v6
  v_mfma_f32_16x16x32_bf16 a[8:11], v[136:139], a[36:39], a[8:11]
  ds_read2_b32 v[38:39], v61 offset0:16 offset1:17
  ds_read2_b32 v[40:41], v61 offset0:18 offset1:19
  ds_read_b32 v42, v61 offset:80
  s_waitcnt lgkmcnt(9)
  v_alignbyte_b32 v26, v11, v10, v6
  v_alignbyte_b32 v27, v12, v11, v6
  v_alignbyte_b32 v28, v13, v12, v6
  v_alignbyte_b32 v29, v14, v13, v6
  v_mfma_f32_16x16x32_bf16 a[4:7], v[104:107], a[36:39], a[4:7]
  ds_read2_b32 v[44:45], v60 offset0:144 offset1:145
  ds_read2_b32 v[46:47], v60 offset0:146 offset1:147
  ds_read_b32 v48, v60 offset:592
  s_waitcnt lgkmcnt(9)
  v_alignbyte_b32 v56, v17, v16, v6
  v_alignbyte_b32 v57, v18, v17, v6
  v_alignbyte_b32 v58, v19, v18, v6
  v_alignbyte_b32 v59, v20, v19, v6
  v_accvgpr_write_b32 a68, v56
  v_accvgpr_write_b32 a69, v57
  v_accvgpr_write_b32 a70, v58
  v_accvgpr_write_b32 a71, v59
  v_mfma_f32_16x16x32_bf16 a[28:31], v[26:29], a[40:43], a[28:31]
  ds_read2_b32 v[10:11], v60 offset0:16 offset1:17
  ds_read2_b32 v[12:13], v60 offset0:18 offset1:19
  ds_read_b32 v14, v60 offset:80
  ds_read_b128 a[36:39], v4 offset:3456
  s_waitcnt lgkmcnt(10)
  v_alignbyte_b32 v228, v33, v32, v6
  v_alignbyte_b32 v229, v34, v33, v6
  v_alignbyte_b32 v230, v35, v34, v6
  v_alignbyte_b32 v231, v36, v35, v6
  v_mfma_f32_16x16x32_bf16 a[24:27], a[68:71], a[40:43], a[24:27]
  ds_read2_b32 v[16:17], v5 offset0:144 offset1:145
  ds_read2_b32 v[18:19], v5 offset0:146 offset1:147
  ds_read_b32 v20, v5 offset:592
  s_waitcnt lgkmcnt(10)
  v_alignbyte_b32 v196, v39, v38, v6
  v_alignbyte_b32 v197, v40, v39, v6
  v_alignbyte_b32 v198, v41, v40, v6
  v_alignbyte_b32 v199, v42, v41, v6
  v_mfma_f32_16x16x32_bf16 a[20:23], v[228:231], a[40:43], a[20:23]
  ds_read2_b32 v[32:33], v62 offset0:128 offset1:129
  ds_read2_b32 v[34:35], v62 offset0:130 offset1:131
  ds_read_b32 v36, v62 offset:528
  s_waitcnt lgkmcnt(10)
  v_alignbyte_b32 v164, v45, v44, v6
  v_alignbyte_b32 v165, v46, v45, v6
  v_alignbyte_b32 v166, v47, v46, v6
  v_alignbyte_b32 v167, v48, v47, v6
  v_mfma_f32_16x16x32_bf16 a[16:19], v[196:199], a[40:43], a[16:19]
  ds_read2_b32 v[38:39], v62 offset0:0 offset1:1
  ds_read2_b32 v[40:41], v62 offset0:2 offset1:3
  ds_read_b32 v42, v62 offset:16
  s_waitcnt lgkmcnt(10)
  v_alignbyte_b32 v132, v11, v10, v6
  v_alignbyte_b32 v133, v12, v11, v6
  v_alignbyte_b32 v134, v13, v12, v6
  v_alignbyte_b32 v135, v14, v13, v6
  v_mfma_f32_16x16x32_bf16 a[12:15], v[164:167], a[40:43], a[12:15]
  ds_read2_b32 v[44:45], v61 offset0:128 offset1:129
  ds_read2_b32 v[46:47], v61 offset0:130 offset1:131
  ds_read_b32 v48, v61 offset:528
  s_waitcnt lgkmcnt(9)
  v_alignbyte_b32 v100, v17, v16, v6
  v_alignbyte_b32 v101, v18, v17, v6
  v_alignbyte_b32 v102, v19, v18, v6
  v_alignbyte_b32 v103, v20, v19, v6
  v_mfma_f32_16x16x32_bf16 a[8:11], v[132:135], a[40:43], a[8:11]
  ds_read2_b32 v[10:11], v61 offset0:0 offset1:1
  ds_read2_b32 v[12:13], v61 offset0:2 offset1:3
  ds_read_b32 v14, v61 offset:16
  s_waitcnt lgkmcnt(9)
  v_alignbyte_b32 v22, v33, v32, v6
  v_alignbyte_b32 v23, v34, v33, v6
  v_alignbyte_b32 v24, v35, v34, v6
  v_alignbyte_b32 v25, v36, v35, v6
  v_mfma_f32_16x16x32_bf16 a[4:7], v[100:103], a[40:43], a[4:7]
  ds_read2_b32 v[16:17], v60 offset0:128 offset1:129
  ds_read2_b32 v[18:19], v60 offset0:130 offset1:131
  ds_read_b32 v20, v60 offset:528
  s_waitcnt lgkmcnt(9)
  v_alignbyte_b32 v56, v39, v38, v6
  v_alignbyte_b32 v57, v40, v39, v6
  v_alignbyte_b32 v58, v41, v40, v6
  v_alignbyte_b32 v59, v42, v41, v6
  v_accvgpr_write_b32 a64, v56
  v_accvgpr_write_b32 a65, v57
  v_accvgpr_write_b32 a66, v58
  v_accvgpr_write_b32 a67, v59
  v_mfma_f32_16x16x32_bf16 a[28:31], v[22:25], a[44:47], a[28:31]
  ds_read2_b32 v[32:33], v60 offset0:0 offset1:1
  ds_read2_b32 v[34:35], v60 offset0:2 offset1:3
  ds_read_b32 v36, v60 offset:16
  ds_read_b128 a[40:43], v4 offset:3392
  s_waitcnt lgkmcnt(10)
  v_alignbyte_b32 v224, v45, v44, v6
  v_alignbyte_b32 v225, v46, v45, v6
  v_alignbyte_b32 v226, v47, v46, v6
  v_alignbyte_b32 v227, v48, v47, v6
  v_mfma_f32_16x16x32_bf16 a[24:27], a[64:67], a[44:47], a[24:27]
  ds_read2_b32 v[38:39], v5 offset0:128 offset1:129
  ds_read2_b32 v[40:41], v5 offset0:130 offset1:131
  ds_read_b32 v42, v5 offset:528
  s_waitcnt lgkmcnt(10)
  v_alignbyte_b32 v192, v11, v10, v6
  v_alignbyte_b32 v193, v12, v11, v6
  v_alignbyte_b32 v194, v13, v12, v6
  v_alignbyte_b32 v195, v14, v13, v6
  v_mfma_f32_16x16x32_bf16 a[20:23], v[224:227], a[44:47], a[20:23]
  s_waitcnt lgkmcnt(7)
  v_alignbyte_b32 v160, v17, v16, v6
  v_alignbyte_b32 v161, v18, v17, v6
  v_alignbyte_b32 v162, v19, v18, v6
  v_alignbyte_b32 v163, v20, v19, v6
  v_mfma_f32_16x16x32_bf16 a[16:19], v[192:195], a[44:47], a[16:19]
  s_waitcnt lgkmcnt(4)
  v_alignbyte_b32 v128, v33, v32, v6
  v_alignbyte_b32 v129, v34, v33, v6
  v_alignbyte_b32 v130, v35, v34, v6
  v_alignbyte_b32 v131, v36, v35, v6
  v_mfma_f32_16x16x32_bf16 a[12:15], v[160:163], a[44:47], a[12:15]
  s_waitcnt lgkmcnt(0)
  v_alignbyte_b32 v96, v39, v38, v6
  v_alignbyte_b32 v97, v40, v39, v6
  v_alignbyte_b32 v98, v41, v40, v6
  v_alignbyte_b32 v99, v42, v41, v6
  v_mfma_f32_16x16x32_bf16 a[8:11], v[128:131], a[44:47], a[8:11]
  s_nop 0
  v_mfma_f32_16x16x32_bf16 a[4:7], v[96:99], a[44:47], a[4:7]
  v_mfma_f32_16x16x32_bf16 a[28:31], a[92:95], a[32:35], a[28:31]
  ds_read_b128 a[44:47], v4 offset:3328
  v_mfma_f32_16x16x32_bf16 a[24:27], v[252:255], a[32:35], a[24:27]
  v_mfma_f32_16x16x32_bf16 a[20:23], v[220:223], a[32:35], a[20:23]
  v_mfma_f32_16x16x32_bf16 a[16:19], v[188:191], a[32:35], a[16:19]
  v_mfma_f32_16x16x32_bf16 a[12:15], v[156:159], a[32:35], a[12:15]
  v_mfma_f32_16x16x32_bf16 a[8:11], v[124:127], a[32:35], a[8:11]
  v_mfma_f32_16x16x32_bf16 a[4:7], v[92:95], a[32:35], a[4:7]
  v_mfma_f32_16x16x32_bf16 a[28:31], a[88:91], a[36:39], a[28:31]
  ds_read_b128 a[32:35], v4 offset:3264
  v_mfma_f32_16x16x32_bf16 a[24:27], v[248:251], a[36:39], a[24:27]
  v_mfma_f32_16x16x32_bf16 a[20:23], v[216:219], a[36:39], a[20:23]
  v_mfma_f32_16x16x32_bf16 a[16:19], v[184:187], a[36:39], a[16:19]
  v_mfma_f32_16x16x32_bf16 a[12:15], v[152:155], a[36:39], a[12:15]
  v_mfma_f32_16x16x32_bf16 a[8:11], v[120:123], a[36:39], a[8:11]
  v_mfma_f32_16x16x32_bf16 a[4:7], v[88:91], a[36:39], a[4:7]
  v_mfma_f32_16x16x32_bf16 a[28:31], a[84:87], a[40:43], a[28:31]
  ds_read_b128 a[36:39], v4 offset:3200
  v_mfma_f32_16x16x32_bf16 a[24:27], v[244:247], a[40:43], a[24:27]
  v_mfma_f32_16x16x32_bf16 a[20:23], v[212:215], a[40:43], a[20:23]
  v_mfma_f32_16x16x32_bf16 a[16:19], v[180:183], a[40:43], a[16:19]
  v_mfma_f32_16x16x32_bf16 a[12:15], v[148:151], a[40:43], a[12:15]
  v_mfma_f32_16x16x32_bf16 a[8:11], v[116:119], a[40:43], a[8:11]
  v_mfma_f32_16x16x32_bf16 a[4:7], v[84:87], a[40:43], a[4:7]
  s_waitcnt lgkmcnt(2)
  v_mfma_f32_16x16x32_bf16 a[28:31], a[80:83], a[44:47], a[28:31]
  ds_read_b128 a[40:43], v4 offset:3136
  v_mfma_f32_16x16x32_bf16 a[24:27], v[240:243], a[44:47], a[24:27]
  v_mfma_f32_16x16x32_bf16 a[20:23], v[208:211], a[44:47], a[20:23]
  v_mfma_f32_16x16x32_bf16 a[16:19], v[176:179], a[44:47], a[16:19]
  v_mfma_f32_16x16x32_bf16 a[12:15], v[144:147], a[44:47], a[12:15]
  v_mfma_f32_16x16x32_bf16 a[8:11], v[112:115], a[44:47], a[8:11]
  v_mfma_f32_16x16x32_bf16 a[4:7], v[80:83], a[44:47], a[4:7]
  s_waitcnt lgkmcnt(2)
  v_mfma_f32_16x16x32_bf16 a[28:31], a[76:79], a[32:35], a[28:31]
  ds_read_b128 a[44:47], v4 offset:3072
  v_mfma_f32_16x16x32_bf16 a[24:27], v[236:239], a[32:35], a[24:27]
  v_mfma_f32_16x16x32_bf16 a[20:23], v[204:207], a[32:35], a[20:23]
  v_mfma_f32_16x16x32_bf16 a[16:19], v[172:175], a[32:35], a[16:19]
  v_mfma_f32_16x16x32_bf16 a[12:15], v[140:143], a[32:35], a[12:15]
  v_mfma_f32_16x16x32_bf16 a[8:11], v[108:111], a[32:35], a[8:11]
  v_mfma_f32_16x16x32_bf16 a[4:7], v[76:79], a[32:35], a[4:7]
  s_waitcnt lgkmcnt(2)
  v_mfma_f32_16x16x32_bf16 a[28:31], a[72:75], a[36:39], a[28:31]
  ds_read_b128 a[32:35], v4 offset:3008
  v_mfma_f32_16x16x32_bf16 a[24:27], v[232:235], a[36:39], a[24:27]
  v_mfma_f32_16x16x32_bf16 a[20:23], v[200:203], a[36:39], a[20:23]
  v_mfma_f32_16x16x32_bf16 a[16:19], v[168:171], a[36:39], a[16:19]
  v_mfma_f32_16x16x32_bf16 a[12:15], v[136:139], a[36:39], a[12:15]
  v_mfma_f32_16x16x32_bf16 a[8:11], v[104:107], a[36:39], a[8:11]
  v_mfma_f32_16x16x32_bf16 a[4:7], v[72:75], a[36:39], a[4:7]
  s_waitcnt lgkmcnt(2)
  v_mfma_f32_16x16x32_bf16 a[28:31], a[68:71], a[40:43], a[28:31]
  ds_read_b128 a[36:39], v4 offset:2944
  v_mfma_f32_16x16x32_bf16 a[24:27], v[228:231], a[40:43], a[24:27]
  v_mfma_f32_16x16x32_bf16 a[20:23], v[196:199], a[40:43], a[20:23]
  v_mfma_f32_16x16x32_bf16 a[16:19], v[164:167], a[40:43], a[16:19]
  v_mfma_f32_16x16x32_bf16 a[12:15], v[132:135], a[40:43], a[12:15]
  v_mfma_f32_16x16x32_bf16 a[8:11], v[100:103], a[40:43], a[8:11]
  v_mfma_f32_16x16x32_bf16 a[4:7], v[68:71], a[40:43], a[4:7]
  s_waitcnt lgkmcnt(2)
  v_mfma_f32_16x16x32_bf16 a[28:31], a[64:67], a[44:47], a[28:31]
  ds_read_b128 a[40:43], v4 offset:2880
  v_mfma_f32_16x16x32_bf16 a[24:27], v[224:227], a[44:47], a[24:27]
  v_mfma_f32_16x16x32_bf16 a[20:23], v[192:195], a[44:47], a[20:23]
  v_mfma_f32_16x16x32_bf16 a[16:19], v[160:163], a[44:47], a[16:19]
  v_mfma_f32_16x16x32_bf16 a[12:15], v[128:131], a[44:47], a[12:15]
  v_mfma_f32_16x16x32_bf16 a[8:11], v[96:99], a[44:47], a[8:11]
  v_mfma_f32_16x16x32_bf16 a[4:7], v[64:67], a[44:47], a[4:7]
  s_waitcnt lgkmcnt(2)
  v_mfma_f32_16x16x32_bf16 a[28:31], v[252:255], a[32:35], a[28:31]
  ds_read_b128 a[44:47], v4 offset:2816
  ds_read_b64 v[36:37], v7 offset:512
  ds_read_b64 v[38:39], v8 offset:512
  s_nop 2
  v_accvgpr_read_b32 v44, a4
  v_accvgpr_read_b32 v45, a5
  v_mfma_f32_16x16x32_bf16 a[24:27], v[220:223], a[32:35], a[24:27]
  v_accvgpr_read_b32 v46, a6
  v_accvgpr_read_b32 v47, a7
  v_mfma_f32_16x16x32_bf16 a[20:23], v[188:191], a[32:35], a[20:23]
  s_waitcnt lgkmcnt(0)
  v_lshlrev_b32 v48, 16, v36
  v_and_b32 v49, 0xffff0000, v36
  v_mfma_f32_16x16x32_bf16 a[16:19], v[156:159], a[32:35], a[16:19]
  v_lshlrev_b32 v50, 16, v37
  v_and_b32 v51, 0xffff0000, v37
  v_mfma_f32_16x16x32_bf16 a[12:15], v[124:127], a[32:35], a[12:15]
  v_lshlrev_b32 v32, 16, v38
  v_and_b32 v33, 0xffff0000, v38
  v_mfma_f32_16x16x32_bf16 a[8:11], v[92:95], a[32:35], a[8:11]
  v_lshlrev_b32 v34, 16, v39
  v_and_b32 v35, 0xffff0000, v39
  v_mfma_f32_16x16x32_bf16 a[28:31], v[248:251], a[36:39], a[28:31]
  ds_read_b128 a[32:35], v4 offset:2752
  v_mul_f32 v52, v48, v31
  v_mul_f32 v53, v49, v31
  v_mfma_f32_16x16x32_bf16 a[24:27], v[216:219], a[36:39], a[24:27]
  v_mul_f32 v54, v50, v31
  v_mul_f32 v55, v51, v31
  v_mfma_f32_16x16x32_bf16 a[20:23], v[184:187], a[36:39], a[20:23]
  v_fmac_f32 v44, s61, v48
  v_fmac_f32 v45, s61, v49
  v_mfma_f32_16x16x32_bf16 a[16:19], v[152:155], a[36:39], a[16:19]
  v_fmac_f32 v46, s61, v50
  v_fmac_f32 v47, s61, v51
  v_mfma_f32_16x16x32_bf16 a[12:15], v[120:123], a[36:39], a[12:15]
  v_cvt_pk_bf16_f32 v36, v52, v53
  v_cvt_pk_bf16_f32 v37, v54, v55
  v_mfma_f32_16x16x32_bf16 a[8:11], v[88:91], a[36:39], a[8:11]
  v_lshlrev_b32 v52, 16, v36
  v_and_b32 v53, 0xffff0000, v36
  v_mfma_f32_16x16x32_bf16 a[28:31], v[244:247], a[40:43], a[28:31]
  ds_read_b128 a[36:39], v4 offset:2688
  v_lshlrev_b32 v54, 16, v37
  v_and_b32 v55, 0xffff0000, v37
  v_mfma_f32_16x16x32_bf16 a[24:27], v[212:215], a[40:43], a[24:27]
  v_cvt_pk_bf16_f32 v36, v44, v45
  v_cvt_pk_bf16_f32 v37, v46, v47
  v_mfma_f32_16x16x32_bf16 a[20:23], v[180:183], a[40:43], a[20:23]
  v_lshlrev_b32 v44, 16, v36
  v_and_b32 v45, 0xffff0000, v36
  v_mfma_f32_16x16x32_bf16 a[16:19], v[148:151], a[40:43], a[16:19]
  v_lshlrev_b32 v46, 16, v37
  v_and_b32 v47, 0xffff0000, v37
  v_mfma_f32_16x16x32_bf16 a[12:15], v[116:119], a[40:43], a[12:15]
  v_add_f32 v44, v44, v52
  v_add_f32 v45, v45, v53
  v_mfma_f32_16x16x32_bf16 a[8:11], v[84:87], a[40:43], a[8:11]
  v_add_f32 v46, v46, v54
  v_add_f32 v47, v47, v55
  v_mfma_f32_16x16x32_bf16 a[28:31], v[240:243], a[44:47], a[28:31]
  ds_read_b128 a[40:43], v4 offset:2624
  v_cvt_pk_bf16_f32 v36, v44, v45
  v_cvt_pk_bf16_f32 v37, v46, v47
  v_mfma_f32_16x16x32_bf16 a[24:27], v[208:211], a[44:47], a[24:27]
  v_lshlrev_b32 v44, 16, v36
  v_and_b32 v45, 0xffff0000, v36
  v_mfma_f32_16x16x32_bf16 a[20:23], v[176:179], a[44:47], a[20:23]
  v_lshlrev_b32 v46, 16, v37
  v_and_b32 v47, 0xffff0000, v37
  v_mfma_f32_16x16x32_bf16 a[16:19], v[144:147], a[44:47], a[16:19]
  v_add_f32 v44, v44, v32
  v_add_f32 v45, v45, v33
  v_mfma_f32_16x16x32_bf16 a[12:15], v[112:115], a[44:47], a[12:15]
  v_add_f32 v46, v46, v34
  v_add_f32 v47, v47, v35
  v_mfma_f32_16x16x32_bf16 a[8:11], v[80:83], a[44:47], a[8:11]
  v_cvt_pk_bf16_f32 v36, v44, v45
  v_cvt_pk_bf16_f32 v37, v46, v47
  s_waitcnt lgkmcnt(2)
  v_mfma_f32_16x16x32_bf16 a[28:31], v[236:239], a[32:35], a[28:31]
  ds_read_b128 a[44:47], v4 offset:2560
  s_add_u32 s6, s62, 262144
  buffer_store_dwordx2 v[36:37], v9, s[8:11], s6 offen sc1
  v_mfma_f32_16x16x32_bf16 a[24:27], v[204:207], a[32:35], a[24:27]
  v_mfma_f32_16x16x32_bf16 a[20:23], v[172:175], a[32:35], a[20:23]
  v_mfma_f32_16x16x32_bf16 a[16:19], v[140:143], a[32:35], a[16:19]
  v_mfma_f32_16x16x32_bf16 a[12:15], v[108:111], a[32:35], a[12:15]
  v_mfma_f32_16x16x32_bf16 a[8:11], v[76:79], a[32:35], a[8:11]
  s_waitcnt lgkmcnt(2)
  v_mfma_f32_16x16x32_bf16 a[28:31], v[232:235], a[36:39], a[28:31]
  ds_read_b128 a[32:35], v4 offset:2496
  v_mfma_f32_16x16x32_bf16 a[24:27], v[200:203], a[36:39], a[24:27]
  v_mfma_f32_16x16x32_bf16 a[20:23], v[168:171], a[36:39], a[20:23]
  v_mfma_f32_16x16x32_bf16 a[16:19], v[136:139], a[36:39], a[16:19]
  v_mfma_f32_16x16x32_bf16 a[12:15], v[104:107], a[36:39], a[12:15]
  v_mfma_f32_16x16x32_bf16 a[8:11], v[72:75], a[36:39], a[8:11]
  s_waitcnt lgkmcnt(2)
  v_mfma_f32_16x16x32_bf16 a[28:31], v[228:231], a[40:43], a[28:31]
  ds_read_b128 a[36:39], v4 offset:2432
  v_mfma_f32_16x16x32_bf16 a[24:27], v[196:199], a[40:43], a[24:27]
  v_mfma_f32_16x16x32_bf16 a[20:23], v[164:167], a[40:43], a[20:23]
  v_mfma_f32_16x16x32_bf16 a[16:19], v[132:135], a[40:43], a[16:19]
  v_mfma_f32_16x16x32_bf16 a[12:15], v[100:103], a[40:43], a[12:15]
  v_mfma_f32_16x16x32_bf16 a[8:11], v[68:71], a[40:43], a[8:11]
  s_waitcnt lgkmcnt(2)
  v_mfma_f32_16x16x32_bf16 a[28:31], v[224:227], a[44:47], a[28:31]
  ds_read_b128 a[40:43], v4 offset:2368
  v_mfma_f32_16x16x32_bf16 a[24:27], v[192:195], a[44:47], a[24:27]
  v_mfma_f32_16x16x32_bf16 a[20:23], v[160:163], a[44:47], a[20:23]
  v_mfma_f32_16x16x32_bf16 a[16:19], v[128:131], a[44:47], a[16:19]
  v_mfma_f32_16x16x32_bf16 a[12:15], v[96:99], a[44:47], a[12:15]
  v_mfma_f32_16x16x32_bf16 a[8:11], v[64:67], a[44:47], a[8:11]
  s_waitcnt lgkmcnt(2)
  v_mfma_f32_16x16x32_bf16 a[28:31], v[220:223], a[32:35], a[28:31]
  ds_read_b128 a[44:47], v4 offset:2304
  ds_read_b64 v[36:37], v7 offset:1024
  ds_read_b64 v[38:39], v8 offset:1024
  s_nop 2
  v_accvgpr_read_b32 v44, a8
  v_accvgpr_read_b32 v45, a9
  v_mfma_f32_16x16x32_bf16 a[24:27], v[188:191], a[32:35], a[24:27]
  v_accvgpr_read_b32 v46, a10
  v_accvgpr_read_b32 v47, a11
  v_mfma_f32_16x16x32_bf16 a[20:23], v[156:159], a[32:35], a[20:23]
  s_waitcnt lgkmcnt(0)
  v_lshlrev_b32 v48, 16, v36
  v_and_b32 v49, 0xffff0000, v36
  v_mfma_f32_16x16x32_bf16 a[16:19], v[124:127], a[32:35], a[16:19]
  v_lshlrev_b32 v50, 16, v37
  v_and_b32 v51, 0xffff0000, v37
  v_mfma_f32_16x16x32_bf16 a[12:15], v[92:95], a[32:35], a[12:15]
  v_lshlrev_b32 v32, 16, v38
  v_and_b32 v33, 0xffff0000, v38
  v_mfma_f32_16x16x32_bf16 a[28:31], v[216:219], a[36:39], a[28:31]
  ds_read_b128 a[32:35], v4 offset:2240
  v_lshlrev_b32 v34, 16, v39
  v_and_b32 v35, 0xffff0000, v39
  v_mfma_f32_16x16x32_bf16 a[24:27], v[184:187], a[36:39], a[24:27]
  v_mul_f32 v52, v48, v31
  v_mul_f32 v53, v49, v31
  v_mfma_f32_16x16x32_bf16 a[20:23], v[152:155], a[36:39], a[20:23]
  v_mul_f32 v54, v50, v31
  v_mul_f32 v55, v51, v31
  v_mfma_f32_16x16x32_bf16 a[16:19], v[120:123], a[36:39], a[16:19]
  v_fmac_f32 v44, s61, v48
  v_fmac_f32 v45, s61, v49
  v_mfma_f32_16x16x32_bf16 a[12:15], v[88:91], a[36:39], a[12:15]
  v_fmac_f32 v46, s61, v50
  v_fmac_f32 v47, s61, v51
  v_mfma_f32_16x16x32_bf16 a[28:31], v[212:215], a[40:43], a[28:31]
  ds_read_b128 a[36:39], v4 offset:2176
  v_cvt_pk_bf16_f32 v36, v52, v53
  v_cvt_pk_bf16_f32 v37, v54, v55
  v_mfma_f32_16x16x32_bf16 a[24:27], v[180:183], a[40:43], a[24:27]
  v_lshlrev_b32 v52, 16, v36
  v_and_b32 v53, 0xffff0000, v36
  v_mfma_f32_16x16x32_bf16 a[20:23], v[148:151], a[40:43], a[20:23]
  v_lshlrev_b32 v54, 16, v37
  v_and_b32 v55, 0xffff0000, v37
  v_mfma_f32_16x16x32_bf16 a[16:19], v[116:119], a[40:43], a[16:19]
  v_cvt_pk_bf16_f32 v36, v44, v45
  v_cvt_pk_bf16_f32 v37, v46, v47
  v_mfma_f32_16x16x32_bf16 a[12:15], v[84:87], a[40:43], a[12:15]
  v_lshlrev_b32 v44, 16, v36
  v_and_b32 v45, 0xffff0000, v36
  v_mfma_f32_16x16x32_bf16 a[28:31], v[208:211], a[44:47], a[28:31]
  ds_read_b128 a[40:43], v4 offset:2112
  v_lshlrev_b32 v46, 16, v37
  v_and_b32 v47, 0xffff0000, v37
  v_mfma_f32_16x16x32_bf16 a[24:27], v[176:179], a[44:47], a[24:27]
  v_add_f32 v44, v44, v52
  v_add_f32 v45, v45, v53
  v_mfma_f32_16x16x32_bf16 a[20:23], v[144:147], a[44:47], a[20:23]
  v_add_f32 v46, v46, v54
  v_add_f32 v47, v47, v55
  v_mfma_f32_16x16x32_bf16 a[16:19], v[112:115], a[44:47], a[16:19]
  v_cvt_pk_bf16_f32 v36, v44, v45
  v_cvt_pk_bf16_f32 v37, v46, v47
  v_mfma_f32_16x16x32_bf16 a[12:15], v[80:83], a[44:47], a[12:15]
  v_lshlrev_b32 v44, 16, v36
  v_and_b32 v45, 0xffff0000, v36
  s_waitcnt lgkmcnt(2)
  v_mfma_f32_16x16x32_bf16 a[28:31], v[204:207], a[32:35], a[28:31]
  ds_read_b128 a[44:47], v4 offset:2048
  v_lshlrev_b32 v46, 16, v37
  v_and_b32 v47, 0xffff0000, v37
  v_mfma_f32_16x16x32_bf16 a[24:27], v[172:175], a[32:35], a[24:27]
  v_add_f32 v44, v44, v32
  v_add_f32 v45, v45, v33
  v_mfma_f32_16x16x32_bf16 a[20:23], v[140:143], a[32:35], a[20:23]
  v_add_f32 v46, v46, v34
  v_add_f32 v47, v47, v35
  v_mfma_f32_16x16x32_bf16 a[16:19], v[108:111], a[32:35], a[16:19]
  v_cvt_pk_bf16_f32 v36, v44, v45
  v_cvt_pk_bf16_f32 v37, v46, v47
  v_mfma_f32_16x16x32_bf16 a[12:15], v[76:79], a[32:35], a[12:15]
  s_add_u32 s6, s62, 524288
  buffer_store_dwordx2 v[36:37], v9, s[8:11], s6 offen sc1
  s_waitcnt lgkmcnt(2)
  v_mfma_f32_16x16x32_bf16 a[28:31], v[200:203], a[36:39], a[28:31]
  ds_read_b128 a[32:35], v4 offset:1984
  v_mfma_f32_16x16x32_bf16 a[24:27], v[168:171], a[36:39], a[24:27]
  v_mfma_f32_16x16x32_bf16 a[20:23], v[136:139], a[36:39], a[20:23]
  v_mfma_f32_16x16x32_bf16 a[16:19], v[104:107], a[36:39], a[16:19]
  v_mfma_f32_16x16x32_bf16 a[12:15], v[72:75], a[36:39], a[12:15]
  s_waitcnt lgkmcnt(2)
  v_mfma_f32_16x16x32_bf16 a[28:31], v[196:199], a[40:43], a[28:31]
  ds_read_b128 a[36:39], v4 offset:1920
  v_mfma_f32_16x16x32_bf16 a[24:27], v[164:167], a[40:43], a[24:27]
  v_mfma_f32_16x16x32_bf16 a[20:23], v[132:135], a[40:43], a[20:23]
  v_mfma_f32_16x16x32_bf16 a[16:19], v[100:103], a[40:43], a[16:19]
  v_mfma_f32_16x16x32_bf16 a[12:15], v[68:71], a[40:43], a[12:15]
  s_waitcnt lgkmcnt(2)
  v_mfma_f32_16x16x32_bf16 a[28:31], v[192:195], a[44:47], a[28:31]
  ds_read_b128 a[40:43], v4 offset:1856
  v_mfma_f32_16x16x32_bf16 a[24:27], v[160:163], a[44:47], a[24:27]
  v_mfma_f32_16x16x32_bf16 a[20:23], v[128:131], a[44:47], a[20:23]
  v_mfma_f32_16x16x32_bf16 a[16:19], v[96:99], a[44:47], a[16:19]
  v_mfma_f32_16x16x32_bf16 a[12:15], v[64:67], a[44:47], a[12:15]
  s_waitcnt lgkmcnt(2)
  v_mfma_f32_16x16x32_bf16 a[28:31], v[188:191], a[32:35], a[28:31]
  ds_read_b128 a[44:47], v4 offset:1792
  ds_read_b64 v[36:37], v7 offset:1536
  ds_read_b64 v[38:39], v8 offset:1536
  s_nop 2
  v_accvgpr_read_b32 v44, a12
  v_accvgpr_read_b32 v45, a13
  v_mfma_f32_16x16x32_bf16 a[24:27], v[156:159], a[32:35], a[24:27]
  v_accvgpr_read_b32 v46, a14
  v_accvgpr_read_b32 v47, a15
  v_mfma_f32_16x16x32_bf16 a[20:23], v[124:127], a[32:35], a[20:23]
  s_waitcnt lgkmcnt(0)
  v_lshlrev_b32 v48, 16, v36
  v_and_b32 v49, 0xffff0000, v36
  v_mfma_f32_16x16x32_bf16 a[16:19], v[92:95], a[32:35], a[16:19]
  v_lshlrev_b32 v50, 16, v37
  v_and_b32 v51, 0xffff0000, v37
  v_mfma_f32_16x16x32_bf16 a[28:31], v[184:187], a[36:39], a[28:31]
  ds_read_b128 a[32:35], v4 offset:1728
  v_lshlrev_b32 v32, 16, v38
  v_and_b32 v33, 0xffff0000, v38
  v_mfma_f32_16x16x32_bf16 a[24:27], v[152:155], a[36:39], a[24:27]
  v_lshlrev_b32 v34, 16, v39
  v_and_b32 v35, 0xffff0000, v39
  v_mfma_f32_16x16x32_bf16 a[20:23], v[120:123], a[36:39], a[20:23]
  v_mul_f32 v52, v48, v31
  v_mul_f32 v53, v49, v31
  v_mfma_f32_16x16x32_bf16 a[16:19], v[88:91], a[36:39], a[16:19]
  v_mul_f32 v54, v50, v31
  v_mul_f32 v55, v51, v31
  v_mfma_f32_16x16x32_bf16 a[28:31], v[180:183], a[40:43], a[28:31]
  ds_read_b128 a[36:39], v4 offset:1664
  v_fmac_f32 v44, s61, v48
  v_fmac_f32 v45, s61, v49
  v_mfma_f32_16x16x32_bf16 a[24:27], v[148:151], a[40:43], a[24:27]
  v_fmac_f32 v46, s61, v50
  v_fmac_f32 v47, s61, v51
  v_mfma_f32_16x16x32_bf16 a[20:23], v[116:119], a[40:43], a[20:23]
  v_cvt_pk_bf16_f32 v36, v52, v53
  v_cvt_pk_bf16_f32 v37, v54, v55
  v_mfma_f32_16x16x32_bf16 a[16:19], v[84:87], a[40:43], a[16:19]
  v_lshlrev_b32 v52, 16, v36
  v_and_b32 v53, 0xffff0000, v36
  v_mfma_f32_16x16x32_bf16 a[28:31], v[176:179], a[44:47], a[28:31]
  ds_read_b128 a[40:43], v4 offset:1600
  v_lshlrev_b32 v54, 16, v37
  v_and_b32 v55, 0xffff0000, v37
  v_mfma_f32_16x16x32_bf16 a[24:27], v[144:147], a[44:47], a[24:27]
  v_cvt_pk_bf16_f32 v36, v44, v45
  v_cvt_pk_bf16_f32 v37, v46, v47
  v_mfma_f32_16x16x32_bf16 a[20:23], v[112:115], a[44:47], a[20:23]
  v_lshlrev_b32 v44, 16, v36
  v_and_b32 v45, 0xffff0000, v36
  v_mfma_f32_16x16x32_bf16 a[16:19], v[80:83], a[44:47], a[16:19]
  v_lshlrev_b32 v46, 16, v37
  v_and_b32 v47, 0xffff0000, v37
  s_waitcnt lgkmcnt(2)
  v_mfma_f32_16x16x32_bf16 a[28:31], v[172:175], a[32:35], a[28:31]
  ds_read_b128 a[44:47], v4 offset:1536
  v_add_f32 v44, v44, v52
  v_add_f32 v45, v45, v53
  v_mfma_f32_16x16x32_bf16 a[24:27], v[140:143], a[32:35], a[24:27]
  v_add_f32 v46, v46, v54
  v_add_f32 v47, v47, v55
  v_mfma_f32_16x16x32_bf16 a[20:23], v[108:111], a[32:35], a[20:23]
  v_cvt_pk_bf16_f32 v36, v44, v45
  v_cvt_pk_bf16_f32 v37, v46, v47
  v_mfma_f32_16x16x32_bf16 a[16:19], v[76:79], a[32:35], a[16:19]
  v_lshlrev_b32 v44, 16, v36
  v_and_b32 v45, 0xffff0000, v36
  s_waitcnt lgkmcnt(2)
  v_mfma_f32_16x16x32_bf16 a[28:31], v[168:171], a[36:39], a[28:31]
  ds_read_b128 a[32:35], v4 offset:1472
  v_lshlrev_b32 v46, 16, v37
  v_and_b32 v47, 0xffff0000, v37
  v_mfma_f32_16x16x32_bf16 a[24:27], v[136:139], a[36:39], a[24:27]
  v_add_f32 v44, v44, v32
  v_add_f32 v45, v45, v33
  v_mfma_f32_16x16x32_bf16 a[20:23], v[104:107], a[36:39], a[20:23]
  v_add_f32 v46, v46, v34
  v_add_f32 v47, v47, v35
  v_mfma_f32_16x16x32_bf16 a[16:19], v[72:75], a[36:39], a[16:19]
  v_cvt_pk_bf16_f32 v36, v44, v45
  v_cvt_pk_bf16_f32 v37, v46, v47
  s_waitcnt lgkmcnt(2)
  v_mfma_f32_16x16x32_bf16 a[28:31], v[164:167], a[40:43], a[28:31]
  ds_read_b128 a[36:39], v4 offset:1408
  s_add_u32 s6, s62, 786432
  buffer_store_dwordx2 v[36:37], v9, s[8:11], s6 offen sc1
  v_mfma_f32_16x16x32_bf16 a[24:27], v[132:135], a[40:43], a[24:27]
  v_mfma_f32_16x16x32_bf16 a[20:23], v[100:103], a[40:43], a[20:23]
  v_mfma_f32_16x16x32_bf16 a[16:19], v[68:71], a[40:43], a[16:19]
  s_waitcnt lgkmcnt(2)
  v_mfma_f32_16x16x32_bf16 a[28:31], v[160:163], a[44:47], a[28:31]
  ds_read_b128 a[40:43], v4 offset:1344
  v_mfma_f32_16x16x32_bf16 a[24:27], v[128:131], a[44:47], a[24:27]
  v_mfma_f32_16x16x32_bf16 a[20:23], v[96:99], a[44:47], a[20:23]
  v_mfma_f32_16x16x32_bf16 a[16:19], v[64:67], a[44:47], a[16:19]
  s_waitcnt lgkmcnt(2)
  v_mfma_f32_16x16x32_bf16 a[28:31], v[156:159], a[32:35], a[28:31]
  ds_read_b128 a[44:47], v4 offset:1280
  ds_read_b64 v[36:37], v7 offset:2048
  ds_read_b64 v[38:39], v8 offset:2048
  s_nop 2
  v_accvgpr_read_b32 v44, a16
  v_accvgpr_read_b32 v45, a17
  v_mfma_f32_16x16x32_bf16 a[24:27], v[124:127], a[32:35], a[24:27]
  v_accvgpr_read_b32 v46, a18
  v_accvgpr_read_b32 v47, a19
  v_mfma_f32_16x16x32_bf16 a[20:23], v[92:95], a[32:35], a[20:23]
  s_waitcnt lgkmcnt(0)
  v_lshlrev_b32 v48, 16, v36
  v_and_b32 v49, 0xffff0000, v36
  v_mfma_f32_16x16x32_bf16 a[28:31], v[152:155], a[36:39], a[28:31]
  ds_read_b128 a[32:35], v4 offset:1216
  v_lshlrev_b32 v50, 16, v37
  v_and_b32 v51, 0xffff0000, v37
  v_mfma_f32_16x16x32_bf16 a[24:27], v[120:123], a[36:39], a[24:27]
  v_lshlrev_b32 v32, 16, v38
  v_and_b32 v33, 0xffff0000, v38
  v_mfma_f32_16x16x32_bf16 a[20:23], v[88:91], a[36:39], a[20:23]
  v_lshlrev_b32 v34, 16, v39
  v_and_b32 v35, 0xffff0000, v39
  v_mfma_f32_16x16x32_bf16 a[28:31], v[148:151], a[40:43], a[28:31]
  ds_read_b128 a[36:39], v4 offset:1152
  v_mul_f32 v52, v48, v31
  v_mul_f32 v53, v49, v31
  v_mfma_f32_16x16x32_bf16 a[24:27], v[116:119], a[40:43], a[24:27]
  v_mul_f32 v54, v50, v31
  v_mul_f32 v55, v51, v31
  v_mfma_f32_16x16x32_bf16 a[20:23], v[84:87], a[40:43], a[20:23]
  v_fmac_f32 v44, s61, v48
  v_fmac_f32 v45, s61, v49
  v_mfma_f32_16x16x32_bf16 a[28:31], v[144:147], a[44:47], a[28:31]
  ds_read_b128 a[40:43], v4 offset:1088
  v_fmac_f32 v46, s61, v50
  v_fmac_f32 v47, s61, v51
  v_mfma_f32_16x16x32_bf16 a[24:27], v[112:115], a[44:47], a[24:27]
  v_cvt_pk_bf16_f32 v36, v52, v53
  v_cvt_pk_bf16_f32 v37, v54, v55
  v_mfma_f32_16x16x32_bf16 a[20:23], v[80:83], a[44:47], a[20:23]
  v_lshlrev_b32 v52, 16, v36
  v_and_b32 v53, 0xffff0000, v36
  s_waitcnt lgkmcnt(2)
  v_mfma_f32_16x16x32_bf16 a[28:31], v[140:143], a[32:35], a[28:31]
  ds_read_b128 a[44:47], v4 offset:1024
  v_lshlrev_b32 v54, 16, v37
  v_and_b32 v55, 0xffff0000, v37
  v_mfma_f32_16x16x32_bf16 a[24:27], v[108:111], a[32:35], a[24:27]
  v_cvt_pk_bf16_f32 v36, v44, v45
  v_cvt_pk_bf16_f32 v37, v46, v47
  v_mfma_f32_16x16x32_bf16 a[20:23], v[76:79], a[32:35], a[20:23]
  v_lshlrev_b32 v44, 16, v36
  v_and_b32 v45, 0xffff0000, v36
  s_waitcnt lgkmcnt(2)
  v_mfma_f32_16x16x32_bf16 a[28:31], v[136:139], a[36:39], a[28:31]
  ds_read_b128 a[32:35], v4 offset:960
  v_lshlrev_b32 v46, 16, v37
  v_and_b32 v47, 0xffff0000, v37
  v_mfma_f32_16x16x32_bf16 a[24:27], v[104:107], a[36:39], a[24:27]
  v_add_f32 v44, v44, v52
  v_add_f32 v45, v45, v53
  v_mfma_f32_16x16x32_bf16 a[20:23], v[72:75], a[36:39], a[20:23]
  v_add_f32 v46, v46, v54
  v_add_f32 v47, v47, v55
  s_waitcnt lgkmcnt(2)
  v_mfma_f32_16x16x32_bf16 a[28:31], v[132:135], a[40:43], a[28:31]
  ds_read_b128 a[36:39], v4 offset:896
  v_cvt_pk_bf16_f32 v36, v44, v45
  v_cvt_pk_bf16_f32 v37, v46, v47
  v_mfma_f32_16x16x32_bf16 a[24:27], v[100:103], a[40:43], a[24:27]
  v_lshlrev_b32 v44, 16, v36
  v_and_b32 v45, 0xffff0000, v36
  v_mfma_f32_16x16x32_bf16 a[20:23], v[68:71], a[40:43], a[20:23]
  v_lshlrev_b32 v46, 16, v37
  v_and_b32 v47, 0xffff0000, v37
  s_waitcnt lgkmcnt(2)
  v_mfma_f32_16x16x32_bf16 a[28:31], v[128:131], a[44:47], a[28:31]
  ds_read_b128 a[40:43], v4 offset:832
  v_add_f32 v44, v44, v32
  v_add_f32 v45, v45, v33
  v_mfma_f32_16x16x32_bf16 a[24:27], v[96:99], a[44:47], a[24:27]
  v_add_f32 v46, v46, v34
  v_add_f32 v47, v47, v35
  v_mfma_f32_16x16x32_bf16 a[20:23], v[64:67], a[44:47], a[20:23]
  v_cvt_pk_bf16_f32 v36, v44, v45
  v_cvt_pk_bf16_f32 v37, v46, v47
  s_waitcnt lgkmcnt(2)
  v_mfma_f32_16x16x32_bf16 a[28:31], v[124:127], a[32:35], a[28:31]
  ds_read_b128 a[44:47], v4 offset:768
  s_add_u32 s6, s62, 1048576
  buffer_store_dwordx2 v[36:37], v9, s[8:11], s6 offen sc1
  v_mfma_f32_16x16x32_bf16 a[24:27], v[92:95], a[32:35], a[24:27]
  ds_read_b64 v[36:37], v7 offset:2560
  ds_read_b64 v[38:39], v8 offset:2560
  v_accvgpr_read_b32 v44, a20
  v_accvgpr_read_b32 v45, a21
  s_waitcnt lgkmcnt(4)
  v_mfma_f32_16x16x32_bf16 a[28:31], v[120:123], a[36:39], a[28:31]
  ds_read_b128 a[32:35], v4 offset:704
  v_accvgpr_read_b32 v46, a22
  v_accvgpr_read_b32 v47, a23
  v_mfma_f32_16x16x32_bf16 a[24:27], v[88:91], a[36:39], a[24:27]
  s_waitcnt lgkmcnt(1)
  v_lshlrev_b32 v48, 16, v36
  v_and_b32 v49, 0xffff0000, v36
  v_mfma_f32_16x16x32_bf16 a[28:31], v[116:119], a[40:43], a[28:31]
  ds_read_b128 a[36:39], v4 offset:640
  v_lshlrev_b32 v50, 16, v37
  v_and_b32 v51, 0xffff0000, v37
  v_mfma_f32_16x16x32_bf16 a[24:27], v[84:87], a[40:43], a[24:27]
  v_lshlrev_b32 v32, 16, v38
  v_and_b32 v33, 0xffff0000, v38
  v_mfma_f32_16x16x32_bf16 a[28:31], v[112:115], a[44:47], a[28:31]
  ds_read_b128 a[40:43], v4 offset:576
  v_lshlrev_b32 v34, 16, v39
  v_and_b32 v35, 0xffff0000, v39
  v_mfma_f32_16x16x32_bf16 a[24:27], v[80:83], a[44:47], a[24:27]
  v_mul_f32 v52, v48, v31
  v_mul_f32 v53, v49, v31
  s_waitcnt lgkmcnt(2)
  v_mfma_f32_16x16x32_bf16 a[28:31], v[108:111], a[32:35], a[28:31]
  ds_read_b128 a[44:47], v4 offset:512
  v_mul_f32 v54, v50, v31
  v_mul_f32 v55, v51, v31
  v_mfma_f32_16x16x32_bf16 a[24:27], v[76:79], a[32:35], a[24:27]
  v_fmac_f32 v44, s61, v48
  v_fmac_f32 v45, s61, v49
  s_waitcnt lgkmcnt(2)
  v_mfma_f32_16x16x32_bf16 a[28:31], v[104:107], a[36:39], a[28:31]
  ds_read_b128 a[32:35], v4 offset:448
  v_fmac_f32 v46, s61, v50
  v_fmac_f32 v47, s61, v51
  v_mfma_f32_16x16x32_bf16 a[24:27], v[72:75], a[36:39], a[24:27]
  v_cvt_pk_bf16_f32 v36, v52, v53
  v_cvt_pk_bf16_f32 v37, v54, v55
  s_waitcnt lgkmcnt(2)
  v_mfma_f32_16x16x32_bf16 a[28:31], v[100:103], a[40:43], a[28:31]
  ds_read_b128 a[36:39], v4 offset:384
  v_lshlrev_b32 v52, 16, v36
  v_and_b32 v53, 0xffff0000, v36
  v_mfma_f32_16x16x32_bf16 a[24:27], v[68:71], a[40:43], a[24:27]
  v_lshlrev_b32 v54, 16, v37
  v_and_b32 v55, 0xffff0000, v37
  s_waitcnt lgkmcnt(2)
  v_mfma_f32_16x16x32_bf16 a[28:31], v[96:99], a[44:47], a[28:31]
  ds_read_b128 a[40:43], v4 offset:320
  v_cvt_pk_bf16_f32 v36, v44, v45
  v_cvt_pk_bf16_f32 v37, v46, v47
  v_mfma_f32_16x16x32_bf16 a[24:27], v[64:67], a[44:47], a[24:27]
  v_lshlrev_b32 v44, 16, v36
  v_and_b32 v45, 0xffff0000, v36
  s_waitcnt lgkmcnt(2)
  v_mfma_f32_16x16x32_bf16 a[28:31], v[92:95], a[32:35], a[28:31]
  ds_read_b128 a[44:47], v4 offset:256
  v_lshlrev_b32 v46, 16, v37
  v_and_b32 v47, 0xffff0000, v37
  s_waitcnt lgkmcnt(2)
  v_mfma_f32_16x16x32_bf16 a[28:31], v[88:91], a[36:39], a[28:31]
  ds_read_b128 a[32:35], v4 offset:192
  v_add_f32 v44, v44, v52
  v_add_f32 v45, v45, v53
  s_waitcnt lgkmcnt(2)
  v_mfma_f32_16x16x32_bf16 a[28:31], v[84:87], a[40:43], a[28:31]
  ds_read_b128 a[36:39], v4 offset:128
  v_add_f32 v46, v46, v54
  v_add_f32 v47, v47, v55
  s_waitcnt lgkmcnt(2)
  v_mfma_f32_16x16x32_bf16 a[28:31], v[80:83], a[44:47], a[28:31]
  ds_read_b128 a[40:43], v4 offset:64
  v_cvt_pk_bf16_f32 v36, v44, v45
  v_cvt_pk_bf16_f32 v37, v46, v47
  s_waitcnt lgkmcnt(2)
  v_mfma_f32_16x16x32_bf16 a[28:31], v[76:79], a[32:35], a[28:31]
  ds_read_b128 a[44:47], v4 offset:0
  v_lshlrev_b32 v44, 16, v36
  v_and_b32 v45, 0xffff0000, v36
  s_waitcnt lgkmcnt(2)
  v_mfma_f32_16x16x32_bf16 a[28:31], v[72:75], a[36:39], a[28:31]
  v_lshlrev_b32 v46, 16, v37
  v_and_b32 v47, 0xffff0000, v37
  s_waitcnt lgkmcnt(1)
  v_mfma_f32_16x16x32_bf16 a[28:31], v[68:71], a[40:43], a[28:31]
  v_add_f32 v44, v44, v32
  v_add_f32 v45, v45, v33
  s_waitcnt lgkmcnt(0)
  v_mfma_f32_16x16x32_bf16 a[28:31], v[64:67], a[44:47], a[28:31]
  v_add_f32 v46, v46, v34
  v_add_f32 v47, v47, v35
  v_cvt_pk_bf16_f32 v36, v44, v45
  v_cvt_pk_bf16_f32 v37, v46, v47
  s_add_u32 s6, s62, 1310720
  buffer_store_dwordx2 v[36:37], v9, s[8:11], s6 offen sc1
  ds_read_b64 v[36:37], v7 offset:3072
  ds_read_b64 v[38:39], v8 offset:3072
  v_accvgpr_read_b32 v44, a24
  v_accvgpr_read_b32 v45, a25
  v_accvgpr_read_b32 v46, a26
  v_accvgpr_read_b32 v47, a27
  s_waitcnt lgkmcnt(0)
  v_lshlrev_b32 v48, 16, v36
  v_and_b32 v49, 0xffff0000, v36
  v_lshlrev_b32 v50, 16, v37
  v_and_b32 v51, 0xffff0000, v37
  v_lshlrev_b32 v32, 16, v38
  v_and_b32 v33, 0xffff0000, v38
  v_lshlrev_b32 v34, 16, v39
  v_and_b32 v35, 0xffff0000, v39
  v_mul_f32 v52, v48, v31
  v_mul_f32 v53, v49, v31
  v_mul_f32 v54, v50, v31
  v_mul_f32 v55, v51, v31
  v_fmac_f32 v44, s61, v48
  v_fmac_f32 v45, s61, v49
  v_fmac_f32 v46, s61, v50
  v_fmac_f32 v47, s61, v51
  v_cvt_pk_bf16_f32 v36, v52, v53
  v_cvt_pk_bf16_f32 v37, v54, v55
  v_lshlrev_b32 v52, 16, v36
  v_and_b32 v53, 0xffff0000, v36
  v_lshlrev_b32 v54, 16, v37
  v_and_b32 v55, 0xffff0000, v37
  v_cvt_pk_bf16_f32 v36, v44, v45
  v_cvt_pk_bf16_f32 v37, v46, v47
  v_lshlrev_b32 v44, 16, v36
  v_and_b32 v45, 0xffff0000, v36
  v_lshlrev_b32 v46, 16, v37
  v_and_b32 v47, 0xffff0000, v37
  v_add_f32 v44, v44, v52
  v_add_f32 v45, v45, v53
  v_add_f32 v46, v46, v54
  v_add_f32 v47, v47, v55
  v_cvt_pk_bf16_f32 v36, v44, v45
  v_cvt_pk_bf16_f32 v37, v46, v47
  v_lshlrev_b32 v44, 16, v36
  v_and_b32 v45, 0xffff0000, v36
  v_lshlrev_b32 v46, 16, v37
  v_and_b32 v47, 0xffff0000, v37
  v_add_f32 v44, v44, v32
  v_add_f32 v45, v45, v33
  v_add_f32 v46, v46, v34
  v_add_f32 v47, v47, v35
  v_cvt_pk_bf16_f32 v36, v44, v45
  v_cvt_pk_bf16_f32 v37, v46, v47
  s_add_u32 s6, s62, 1572864
  buffer_store_dwordx2 v[36:37], v9, s[8:11], s6 offen sc1
  ds_read_b64 v[36:37], v7 offset:3584
  ds_read_b64 v[38:39], v8 offset:3584
  v_accvgpr_read_b32 v44, a28
  v_accvgpr_read_b32 v45, a29
  v_accvgpr_read_b32 v46, a30
  v_accvgpr_read_b32 v47, a31
  s_waitcnt lgkmcnt(0)
  v_lshlrev_b32 v48, 16, v36
  v_and_b32 v49, 0xffff0000, v36
  v_lshlrev_b32 v50, 16, v37
  v_and_b32 v51, 0xffff0000, v37
  v_lshlrev_b32 v32, 16, v38
  v_and_b32 v33, 0xffff0000, v38
  v_lshlrev_b32 v34, 16, v39
  v_and_b32 v35, 0xffff0000, v39
  v_mul_f32 v52, v48, v31
  v_mul_f32 v53, v49, v31
  v_mul_f32 v54, v50, v31
  v_mul_f32 v55, v51, v31
  v_fmac_f32 v44, s61, v48
  v_fmac_f32 v45, s61, v49
  v_fmac_f32 v46, s61, v50
  v_fmac_f32 v47, s61, v51
  v_cvt_pk_bf16_f32 v36, v52, v53
  v_cvt_pk_bf16_f32 v37, v54, v55
  v_lshlrev_b32 v52, 16, v36
  v_and_b32 v53, 0xffff0000, v36
  v_lshlrev_b32 v54, 16, v37
  v_and_b32 v55, 0xffff0000, v37
  v_cvt_pk_bf16_f32 v36, v44, v45
  v_cvt_pk_bf16_f32 v37, v46, v47
  v_lshlrev_b32 v44, 16, v36
  v_and_b32 v45, 0xffff0000, v36
  v_lshlrev_b32 v46, 16, v37
  v_and_b32 v47, 0xffff0000, v37
  v_add_f32 v44, v44, v52
  v_add_f32 v45, v45, v53
  v_add_f32 v46, v46, v54
  v_add_f32 v47, v47, v55
  v_cvt_pk_bf16_f32 v36, v44, v45
  v_cvt_pk_bf16_f32 v37, v46, v47
  v_lshlrev_b32 v44, 16, v36
  v_and_b32 v45, 0xffff0000, v36
  v_lshlrev_b32 v46, 16, v37
  v_and_b32 v47, 0xffff0000, v37
  v_add_f32 v44, v44, v32
  v_add_f32 v45, v45, v33
  v_add_f32 v46, v46, v34
  v_add_f32 v47, v47, v35
  v_cvt_pk_bf16_f32 v36, v44, v45
  v_cvt_pk_bf16_f32 v37, v46, v47
  s_add_u32 s6, s62, 1835008
  buffer_store_dwordx2 v[36:37], v9, s[8:11], s6 offen sc1
  s_lshl_b32 s6, s60, 2
  s_add_u32 s6, s6, 0x710000
  v_mov_b32 v16, 127
  s_waitcnt vmcnt(0)
  s_mov_b64 exec, 1
  buffer_store_dword v16, v1, s[8:11], s6 offen sc1
  s_mov_b64 exec, -1
  s_barrier
  s_cmp_eq_u32 s4, 1
  s_cbranch_scc1 L_rec2
  s_cmp_eq_u32 s4, 6
  s_cbranch_scc1 L_o2
  s_branch L_p2
L_c:
  v_lshlrev_b32 v4, 2, v0
  v_lshlrev_b32 v0, 4, v0
  v_mov_b32 v1, 0
  v_mov_b32 v2, 150016
  s_lshl_b32 s6, s5, 8
  s_lshl_b32 s7, s3, 13
  s_add_u32 s6, s6, s7
  s_add_u32 s6, s6, 0x738000
  buffer_store_dword v1, v4, s[8:11], s6 offen sc1
  s_lshl_b32 s6, s5, 3
  s_add_u32 s6, s6, 0x710800
  s_mov_b64 exec, 3
  buffer_store_dword v1, v4, s[8:11], s6 offen sc1
  buffer_store_dword v1, v4, s[8:11], s6 offen offset:256 sc1
  s_mov_b64 exec, -1
  s_lshl_b32 s6, s5, 10
  s_lshl_b32 s7, s3, 15
  s_add_u32 s6, s6, s7
  s_add_u32 s6, s6, 0x8800000
  v_mov_b32 v8, 0
  v_mov_b32 v9, 0
  v_mov_b32 v10, 0
  v_mov_b32 v11, 0
  buffer_store_dwordx4 v[8:11], v0, s[8:11], s6 offen sc1
  s_add_u32 s6, s6, 0x20000
  buffer_store_dwordx4 v[8:11], v0, s[8:11], s6 offen sc1
  s_add_u32 s6, s6, 0x20000
  buffer_store_dwordx4 v[8:11], v0, s[8:11], s6 offen sc1
  s_add_u32 s6, s6, 0x20000
  buffer_store_dwordx4 v[8:11], v0, s[8:11], s6 offen sc1
  s_add_u32 s6, s6, 0x7a0000
  buffer_store_dwordx4 v[8:11], v0, s[8:11], s6 offen sc1
  s_add_u32 s6, s6, 0x20000
  buffer_store_dwordx4 v[8:11], v0, s[8:11], s6 offen sc1
  s_add_u32 s6, s6, 0x20000
  buffer_store_dwordx4 v[8:11], v0, s[8:11], s6 offen sc1
  s_add_u32 s6, s6, 0x20000
  buffer_store_dwordx4 v[8:11], v0, s[8:11], s6 offen sc1
  s_waitcnt vmcnt(0)
  s_barrier
  s_cmp_lg_u32 s3, 0
  s_cbranch_scc1 L_sd_113
  s_mov_b64 exec, 1
  s_and_b32 s6, s4, 3
  s_lshl_b32 s6, s6, 6
  v_mov_b32 v6, 16
  v_mov_b32 v7, 1
  buffer_atomic_add v7, v6, s[12:15], s6 offen sc1
  s_mov_b64 exec, -1
L_sd_113:
  v_bfe_u32 v5, v0, 5, 4
  v_mul_u32_u24 v5, 4128, v5
  v_and_b32 v6, 16, v0
  v_add3_u32 v5, v5, v6, v1
  v_add_u32 v5, 73728, v5
  ds_write_b128 v5, v[8:11]
  ds_write_b128 v2, v[8:11]
  ds_write_b128 v2, v[8:11] offset:16
  v_accvgpr_write_b32 a0, 0
  v_accvgpr_write_b32 a1, 0
  v_accvgpr_write_b32 a2, 0
  v_accvgpr_write_b32 a3, 0
  v_accvgpr_write_b32 a4, 0
  v_accvgpr_write_b32 a5, 0
  v_accvgpr_write_b32 a6, 0
  v_accvgpr_write_b32 a7, 0
  v_accvgpr_write_b32 a8, 0
  v_accvgpr_write_b32 a9, 0
  v_accvgpr_write_b32 a10, 0
  v_accvgpr_write_b32 a11, 0
  v_accvgpr_write_b32 a12, 0
  v_accvgpr_write_b32 a13, 0
  v_accvgpr_write_b32 a14, 0
  v_accvgpr_write_b32 a15, 0
  v_accvgpr_write_b32 a16, 0
  v_accvgpr_write_b32 a17, 0
  v_accvgpr_write_b32 a18, 0
  v_accvgpr_write_b32 a19, 0
  v_accvgpr_write_b32 a20, 0
  v_accvgpr_write_b32 a21, 0
  v_accvgpr_write_b32 a22, 0
  v_accvgpr_write_b32 a23, 0
  v_accvgpr_write_b32 a24, 0
  v_accvgpr_write_b32 a25, 0
  v_accvgpr_write_b32 a26, 0
  v_accvgpr_write_b32 a27, 0
  v_accvgpr_write_b32 a28, 0
  v_accvgpr_write_b32 a29, 0
  v_accvgpr_write_b32 a30, 0
  v_accvgpr_write_b32 a31, 0
  v_accvgpr_write_b32 a32, 0
  v_accvgpr_write_b32 a33, 0
  v_accvgpr_write_b32 a34, 0
  v_accvgpr_write_b32 a35, 0
  v_accvgpr_write_b32 a36, 0
  v_accvgpr_write_b32 a37, 0
  v_accvgpr_write_b32 a38, 0
  v_accvgpr_write_b32 a39, 0
  v_accvgpr_write_b32 a40, 0
  v_accvgpr_write_b32 a41, 0
  v_accvgpr_write_b32 a42, 0
  v_accvgpr_write_b32 a43, 0
  v_accvgpr_write_b32 a44, 0
  v_accvgpr_write_b32 a45, 0
  v_accvgpr_write_b32 a46, 0
  v_accvgpr_write_b32 a47, 0
  v_accvgpr_write_b32 a48, 0
  v_accvgpr_write_b32 a49, 0
  v_accvgpr_write_b32 a50, 0
  v_accvgpr_write_b32 a51, 0
  v_accvgpr_write_b32 a52, 0
  v_accvgpr_write_b32 a53, 0
  v_accvgpr_write_b32 a54, 0
  v_accvgpr_write_b32 a55, 0
  v_accvgpr_write_b32 a56, 0
  v_accvgpr_write_b32 a57, 0
  v_accvgpr_write_b32 a58, 0
  v_accvgpr_write_b32 a59, 0
  v_accvgpr_write_b32 a60, 0
  v_accvgpr_write_b32 a61, 0
  v_accvgpr_write_b32 a62, 0
  v_accvgpr_write_b32 a63, 0
  v_accvgpr_write_b32 a64, 0
  v_accvgpr_write_b32 a65, 0
  v_accvgpr_write_b32 a66, 0
  v_accvgpr_write_b32 a67, 0
  v_accvgpr_write_b32 a68, 0
  v_accvgpr_write_b32 a69, 0
  v_accvgpr_write_b32 a70, 0
  v_accvgpr_write_b32 a71, 0
  v_accvgpr_write_b32 a72, 0
  v_accvgpr_write_b32 a73, 0
  v_accvgpr_write_b32 a74, 0
  v_accvgpr_write_b32 a75, 0
  v_accvgpr_write_b32 a76, 0
  v_accvgpr_write_b32 a77, 0
  v_accvgpr_write_b32 a78, 0
  v_accvgpr_write_b32 a79, 0
  v_accvgpr_write_b32 a80, 0
  v_accvgpr_write_b32 a81, 0
  v_accvgpr_write_b32 a82, 0
  v_accvgpr_write_b32 a83, 0
  v_accvgpr_write_b32 a84, 0
  v_accvgpr_write_b32 a85, 0
  v_accvgpr_write_b32 a86, 0
  v_accvgpr_write_b32 a87, 0
  v_accvgpr_write_b32 a88, 0
  v_accvgpr_write_b32 a89, 0
  v_accvgpr_write_b32 a90, 0
  v_accvgpr_write_b32 a91, 0
  v_accvgpr_write_b32 a92, 0
  v_accvgpr_write_b32 a93, 0
  v_accvgpr_write_b32 a94, 0
  v_accvgpr_write_b32 a95, 0
  v_accvgpr_write_b32 a96, 0
  v_accvgpr_write_b32 a97, 0
  v_accvgpr_write_b32 a98, 0
  v_accvgpr_write_b32 a99, 0
  v_accvgpr_write_b32 a100, 0
  v_accvgpr_write_b32 a101, 0
  v_accvgpr_write_b32 a102, 0
  v_accvgpr_write_b32 a103, 0
  v_accvgpr_write_b32 a104, 0
  v_accvgpr_write_b32 a105, 0
  v_accvgpr_write_b32 a106, 0
  v_accvgpr_write_b32 a107, 0
  v_accvgpr_write_b32 a108, 0
  v_accvgpr_write_b32 a109, 0
  v_accvgpr_write_b32 a110, 0
  v_accvgpr_write_b32 a111, 0
  v_accvgpr_write_b32 a112, 0
  v_accvgpr_write_b32 a113, 0
  v_accvgpr_write_b32 a114, 0
  v_accvgpr_write_b32 a115, 0
  v_accvgpr_write_b32 a116, 0
  v_accvgpr_write_b32 a117, 0
  v_accvgpr_write_b32 a118, 0
  v_accvgpr_write_b32 a119, 0
  v_accvgpr_write_b32 a120, 0
  v_accvgpr_write_b32 a121, 0
  v_accvgpr_write_b32 a122, 0
  v_accvgpr_write_b32 a123, 0
  v_accvgpr_write_b32 a124, 0
  v_accvgpr_write_b32 a125, 0
  v_accvgpr_write_b32 a126, 0
  v_accvgpr_write_b32 a127, 0
  v_accvgpr_write_b32 a128, 0
  v_accvgpr_write_b32 a129, 0
  v_accvgpr_write_b32 a130, 0
  v_accvgpr_write_b32 a131, 0
  v_accvgpr_write_b32 a132, 0
  v_accvgpr_write_b32 a133, 0
  v_accvgpr_write_b32 a134, 0
  v_accvgpr_write_b32 a135, 0
  v_accvgpr_write_b32 a136, 0
  v_accvgpr_write_b32 a137, 0
  v_accvgpr_write_b32 a138, 0
  v_accvgpr_write_b32 a139, 0
  v_accvgpr_write_b32 a140, 0
  v_accvgpr_write_b32 a141, 0
  v_accvgpr_write_b32 a142, 0
  v_accvgpr_write_b32 a143, 0
  v_accvgpr_write_b32 a144, 0
  v_accvgpr_write_b32 a145, 0
  v_accvgpr_write_b32 a146, 0
  v_accvgpr_write_b32 a147, 0
  v_accvgpr_write_b32 a148, 0
  v_accvgpr_write_b32 a149, 0
  v_accvgpr_write_b32 a150, 0
  v_accvgpr_write_b32 a151, 0
  v_accvgpr_write_b32 a152, 0
  v_accvgpr_write_b32 a153, 0
  v_accvgpr_write_b32 a154, 0
  v_accvgpr_write_b32 a155, 0
  v_accvgpr_write_b32 a156, 0
  v_accvgpr_write_b32 a157, 0
  v_accvgpr_write_b32 a158, 0
  v_accvgpr_write_b32 a159, 0
  v_accvgpr_write_b32 a160, 0
  v_accvgpr_write_b32 a161, 0
  v_accvgpr_write_b32 a162, 0
  v_accvgpr_write_b32 a163, 0
  v_accvgpr_write_b32 a164, 0
  v_accvgpr_write_b32 a165, 0
  v_accvgpr_write_b32 a166, 0
  v_accvgpr_write_b32 a167, 0
  v_accvgpr_write_b32 a168, 0
  v_accvgpr_write_b32 a169, 0
  v_accvgpr_write_b32 a170, 0
  v_accvgpr_write_b32 a171, 0
  v_accvgpr_write_b32 a172, 0
  v_accvgpr_write_b32 a173, 0
  v_accvgpr_write_b32 a174, 0
  v_accvgpr_write_b32 a175, 0
  v_accvgpr_write_b32 a176, 0
  v_accvgpr_write_b32 a177, 0
  v_accvgpr_write_b32 a178, 0
  v_accvgpr_write_b32 a179, 0
  v_accvgpr_write_b32 a180, 0
  v_accvgpr_write_b32 a181, 0
  v_accvgpr_write_b32 a182, 0
  v_accvgpr_write_b32 a183, 0
  v_accvgpr_write_b32 a184, 0
  v_accvgpr_write_b32 a185, 0
  v_accvgpr_write_b32 a186, 0
  v_accvgpr_write_b32 a187, 0
  v_accvgpr_write_b32 a188, 0
  v_accvgpr_write_b32 a189, 0
  v_accvgpr_write_b32 a190, 0
  v_accvgpr_write_b32 a191, 0
  v_accvgpr_write_b32 a192, 0
  v_accvgpr_write_b32 a193, 0
  v_accvgpr_write_b32 a194, 0
  v_accvgpr_write_b32 a195, 0
  v_accvgpr_write_b32 a196, 0
  v_accvgpr_write_b32 a197, 0
  v_accvgpr_write_b32 a198, 0
  v_accvgpr_write_b32 a199, 0
  v_accvgpr_write_b32 a200, 0
  v_accvgpr_write_b32 a201, 0
  v_accvgpr_write_b32 a202, 0
  v_accvgpr_write_b32 a203, 0
  v_accvgpr_write_b32 a204, 0
  v_accvgpr_write_b32 a205, 0
  v_accvgpr_write_b32 a206, 0
  v_accvgpr_write_b32 a207, 0
  v_accvgpr_write_b32 a208, 0
  v_accvgpr_write_b32 a209, 0
  v_accvgpr_write_b32 a210, 0
  v_accvgpr_write_b32 a211, 0
  v_accvgpr_write_b32 a212, 0
  v_accvgpr_write_b32 a213, 0
  v_accvgpr_write_b32 a214, 0
  v_accvgpr_write_b32 a215, 0
  v_accvgpr_write_b32 a216, 0
  v_accvgpr_write_b32 a217, 0
  v_accvgpr_write_b32 a218, 0
  v_accvgpr_write_b32 a219, 0
  v_accvgpr_write_b32 a220, 0
  v_accvgpr_write_b32 a221, 0
  v_accvgpr_write_b32 a222, 0
  v_accvgpr_write_b32 a223, 0
  v_accvgpr_write_b32 a224, 0
  v_accvgpr_write_b32 a225, 0
  v_accvgpr_write_b32 a226, 0
  v_accvgpr_write_b32 a227, 0
  v_accvgpr_write_b32 a228, 0
  v_accvgpr_write_b32 a229, 0
  v_accvgpr_write_b32 a230, 0
  v_accvgpr_write_b32 a231, 0
  v_accvgpr_write_b32 a232, 0
  v_accvgpr_write_b32 a233, 0
  v_accvgpr_write_b32 a234, 0
  v_accvgpr_write_b32 a235, 0
  v_accvgpr_write_b32 a236, 0
  v_accvgpr_write_b32 a237, 0
  v_accvgpr_write_b32 a238, 0
  v_accvgpr_write_b32 a239, 0
  v_accvgpr_write_b32 a240, 0
  v_accvgpr_write_b32 a241, 0
  v_accvgpr_write_b32 a242, 0
  v_accvgpr_write_b32 a243, 0
  v_accvgpr_write_b32 a244, 0
  v_accvgpr_write_b32 a245, 0
  v_accvgpr_write_b32 a246, 0
  v_accvgpr_write_b32 a247, 0
  v_accvgpr_write_b32 a248, 0
  v_accvgpr_write_b32 a249, 0
  v_accvgpr_write_b32 a250, 0
  v_accvgpr_write_b32 a251, 0
  v_accvgpr_write_b32 a252, 0
  v_accvgpr_write_b32 a253, 0
  v_accvgpr_write_b32 a254, 0
  v_accvgpr_write_b32 a255, 0
  s_cmp_lg_u32 s3, 0
  s_cbranch_scc1 L_wdo_115
  s_mov_b32 s7, 0
  v_mbcnt_lo_u32_b32 v8, -1, 0
  v_and_b32 v8, 3, v8
  v_lshlrev_b32 v8, 6, v8
L_wd_114:
  buffer_load_dword v9, v8, s[12:15], 0 offen offset:16 sc1
  s_waitcnt vmcnt(0)
  v_cmp_ne_u32 vcc, 64, v9
  s_cbranch_vccz L_wdo_115
  s_add_u32 s7, s7, 1
  s_cmp_lt_u32 s7, 131072
  s_cbranch_scc1 L_wd_114
  s_mov_b32 s6, 40
  s_branch L_err
L_wdo_115:
  s_barrier
  v_and_b32 v4, 60, v4
  s_lshl_b32 s6, s5, 6
  s_add_u32 s34, s6, 0x710000
  s_mov_b32 s33, 127
  s_mov_b32 s7, 0
L_pl_116:
  buffer_load_dword v8, v4, s[8:11], s34 offen offset:0 sc1
  s_waitcnt vmcnt(0)
  v_cmp_gt_u32 vcc, s33, v8
  s_cbranch_vccz L_plo_117
  s_add_u32 s7, s7, 1
  s_cmp_lt_u32 s7, 131072
  s_cbranch_scc1 L_pl_116
  s_mov_b32 s6, 41
  s_branch L_err
L_plo_117:
  s_mul_i32 s34, s5, 73728
  s_mul_i32 s35, s3, 18432
  s_add_u32 s34, s34, s35
  s_add_u32 s34, s34, 0x400000
  s_add_u32 m0, s35, 0
  s_add_u32 s6, s34, 0
  buffer_load_dwordx4 v0, s[8:11], s6 offen offset:0 lds
  buffer_load_dwordx4 v0, s[8:11], s6 offen offset:1024 lds
  buffer_load_dwordx4 v0, s[8:11], s6 offen offset:2048 lds
  buffer_load_dwordx4 v0, s[8:11], s6 offen offset:3072 lds
  s_add_u32 m0, s35, 4096
  s_add_u32 s6, s34, 4096
  buffer_load_dwordx4 v0, s[8:11], s6 offen offset:0 lds
  buffer_load_dwordx4 v0, s[8:11], s6 offen offset:1024 lds
  buffer_load_dwordx4 v0, s[8:11], s6 offen offset:2048 lds
  buffer_load_dwordx4 v0, s[8:11], s6 offen offset:3072 lds
  s_add_u32 m0, s35, 8192
  s_add_u32 s6, s34, 8192
  buffer_load_dwordx4 v0, s[8:11], s6 offen offset:0 lds
  buffer_load_dwordx4 v0, s[8:11], s6 offen offset:1024 lds
  buffer_load_dwordx4 v0, s[8:11], s6 offen offset:2048 lds
  buffer_load_dwordx4 v0, s[8:11], s6 offen offset:3072 lds
  s_add_u32 m0, s35, 12288
  s_add_u32 s6, s34, 12288
  buffer_load_dwordx4 v0, s[8:11], s6 offen offset:0 lds
  buffer_load_dwordx4 v0, s[8:11], s6 offen offset:1024 lds
  buffer_load_dwordx4 v0, s[8:11], s6 offen offset:2048 lds
  buffer_load_dwordx4 v0, s[8:11], s6 offen offset:3072 lds
  s_add_u32 m0, s35, 16384
  s_add_u32 s6, s34, 16384
  buffer_load_dwordx4 v0, s[8:11], s6 offen offset:0 lds
  buffer_load_dwordx4 v0, s[8:11], s6 offen offset:1024 lds
  s_mov_b32 s32, 0
  s_waitcnt vmcnt(0) lgkmcnt(0)
  s_barrier
  s_cmp_ge_u32 s3, 2
  s_cbranch_scc1 L_c_res
  s_mov_b32 s16, s76
  s_mov_b32 s17, s77
  s_mov_b32 s18, 0x400
  s_mov_b32 s19, 0x20000
  v_bfe_u32 v16, v0, 4, 4
  v_lshrrev_b32 v17, 8, v0
  v_lshrrev_b32 v18, 7, v0
  s_lshl_b32 s6, s5, 5
  s_lshl_b32 s7, s3, 4
  s_add_u32 s6, s6, s7
  v_lshlrev_b32 v19, 1, v18
  buffer_load_ushort v12, v19, s[16:19], s6 offen
  s_mul_i32 s6, s3, 36864
  v_mul_u32_u24 v19, 4608, v18
  v_add_u32 v19, s6, v19
  ds_read_b32 v11, v19 offset:4576
  s_add_u32 s6, s6, 480
  v_lshlrev_b32 v19, 5, v16
  v_sub_u32 v19, s6, v19
  v_lshl_add_u32 v4, v17, 4, v19
  s_mul_i32 s6, s3, 33024
  s_add_u32 s6, s6, 73728
  v_lshlrev_b32 v19, 1, v16
  v_lshl_add_u32 v19, v17, 4, v19
  v_add_u32 v5, s6, v19
  v_mul_u32_u24 v19, 4128, v18
  v_bfe_u32 v20, v0, 1, 6
  v_add3_u32 v19, v19, v20, s6
  v_add_u32 v8, 32, v19
  s_lshl_b32 s6, s3, 10
  s_add_u32 s6, s6, 147968
  v_add_u32 v7, s6, v0
  v_and_b32 v19, 1, v16
  v_lshlrev_b32 v19, 6, v19
  v_lshl_add_u32 v19, v17, 4, v19
  v_add_u32 v6, s6, v19
  v_lshrrev_b32 v10, 1, v0
  s_lshl_b32 s6, s3, 9
  s_add_u32 s35, s6, 139776
  s_lshl_b32 s7, s5, 10
  s_add_u32 s6, s6, s7
  s_add_u32 s40, s6, 0x200000
  s_lshl_b32 s6, s5, 3
  s_lshl_b32 s7, s3, 2
  s_add_u32 s6, s6, s7
  s_add_u32 s39, s6, 0x710800
  v_add_u32 v14, s7, v2
  s_waitcnt vmcnt(0) lgkmcnt(0)
  v_lshlrev_b32 v12, 16, v12
  v_and_b32 v15, 2, v5
  v_and_b32 v5, -4, v5
  v_add_u32 v104, 0, v5
  v_add_u32 v105, 4128, v5
  v_add_u32 v106, 8256, v5
  v_add_u32 v107, 12384, v5
  v_add_u32 v108, 16512, v5
  v_add_u32 v109, 20640, v5
  v_add_u32 v110, 24768, v5
  v_add_u32 v111, 28896, v5
L_c_conv0:
  s_add_u32 s33, s32, 1
  s_and_b32 s6, s32, 7
  s_lshl_b32 s7, s6, 10
  s_add_u32 s7, s7, s35
  v_add_u32 v9, s7, v10
  s_lshl_b32 s6, s6, 1
  s_lshl_b32 s42, 0x30003, s6
  v_mov_b32 v13, s33
  ds_read_b128 v[48:51], v4 offset:3584
  ds_read_b128 v[52:55], v4 offset:8192
  ds_read_b128 v[56:59], v4 offset:12800
  ds_read_b128 v[60:63], v4 offset:17408
  ds_read_b128 v[64:67], v4 offset:22016
  ds_read_b128 v[68:71], v4 offset:26624
  ds_read_b128 v[72:75], v4 offset:31232
  ds_read_b128 v[76:79], v4 offset:35840
  s_mov_b32 s7, 0
L_lw_118:
  ds_read_b32 v88, v2 offset:0
  s_waitcnt lgkmcnt(0)
  v_cmp_gt_i32 vcc, s33, v88
  s_cbranch_vccz L_lwo_119
  s_add_u32 s7, s7, 1
  s_cmp_lt_u32 s7, 131072
  s_cbranch_scc1 L_lw_118
  s_mov_b32 s6, 42
  s_branch L_err
L_lwo_119:
  ds_read2_b32 v[112:113], v104 offset0:0 offset1:1
  ds_read2_b32 v[114:115], v104 offset0:2 offset1:3
  ds_read_b32 v116, v104 offset:16
  ds_read2_b32 v[118:119], v105 offset0:0 offset1:1
  ds_read2_b32 v[120:121], v105 offset0:2 offset1:3
  ds_read_b32 v122, v105 offset:16
  ds_read2_b32 v[124:125], v106 offset0:0 offset1:1
  ds_read2_b32 v[126:127], v106 offset0:2 offset1:3
  ds_read_b32 v128, v106 offset:16
  ds_read2_b32 v[130:131], v107 offset0:0 offset1:1
  ds_read2_b32 v[132:133], v107 offset0:2 offset1:3
  ds_read_b32 v134, v107 offset:16
  s_waitcnt lgkmcnt(9)
  v_alignbyte_b32 v16, v113, v112, v15
  v_alignbyte_b32 v17, v114, v113, v15
  v_alignbyte_b32 v18, v115, v114, v15
  v_alignbyte_b32 v19, v116, v115, v15
  ds_read2_b32 v[112:113], v108 offset0:0 offset1:1
  ds_read2_b32 v[114:115], v108 offset0:2 offset1:3
  ds_read_b32 v116, v108 offset:16
  s_waitcnt lgkmcnt(9)
  v_alignbyte_b32 v20, v119, v118, v15
  v_alignbyte_b32 v21, v120, v119, v15
  v_alignbyte_b32 v22, v121, v120, v15
  v_alignbyte_b32 v23, v122, v121, v15
  ds_read2_b32 v[118:119], v109 offset0:0 offset1:1
  ds_read2_b32 v[120:121], v109 offset0:2 offset1:3
  ds_read_b32 v122, v109 offset:16
  v_mfma_f32_16x16x32_bf16 a[0:3], v[16:19], v[48:51], a[0:3]
  s_waitcnt lgkmcnt(9)
  v_alignbyte_b32 v24, v125, v124, v15
  v_alignbyte_b32 v25, v126, v125, v15
  v_alignbyte_b32 v26, v127, v126, v15
  v_alignbyte_b32 v27, v128, v127, v15
  ds_read2_b32 v[124:125], v110 offset0:0 offset1:1
  ds_read2_b32 v[126:127], v110 offset0:2 offset1:3
  ds_read_b32 v128, v110 offset:16
  v_mfma_f32_16x16x32_bf16 a[32:35], v[20:23], v[52:55], a[32:35]
  s_waitcnt lgkmcnt(9)
  v_alignbyte_b32 v28, v131, v130, v15
  v_alignbyte_b32 v29, v132, v131, v15
  v_alignbyte_b32 v30, v133, v132, v15
  v_alignbyte_b32 v31, v134, v133, v15
  ds_read2_b32 v[130:131], v111 offset0:0 offset1:1
  ds_read2_b32 v[132:133], v111 offset0:2 offset1:3
  ds_read_b32 v134, v111 offset:16
  v_mfma_f32_16x16x32_bf16 a[64:67], v[24:27], v[56:59], a[64:67]
  s_waitcnt lgkmcnt(9)
  v_alignbyte_b32 v32, v113, v112, v15
  v_alignbyte_b32 v33, v114, v113, v15
  v_alignbyte_b32 v34, v115, v114, v15
  v_alignbyte_b32 v35, v116, v115, v15
  ds_read_b64 v[84:85], v8
  ds_read_b64 v[86:87], v9
  v_mfma_f32_16x16x32_bf16 a[96:99], v[28:31], v[60:63], a[96:99]
  s_waitcnt lgkmcnt(8)
  v_alignbyte_b32 v36, v119, v118, v15
  v_alignbyte_b32 v37, v120, v119, v15
  v_alignbyte_b32 v38, v121, v120, v15
  v_alignbyte_b32 v39, v122, v121, v15
  v_mfma_f32_16x16x32_bf16 a[128:131], v[32:35], v[64:67], a[128:131]
  s_waitcnt lgkmcnt(5)
  v_alignbyte_b32 v40, v125, v124, v15
  v_alignbyte_b32 v41, v126, v125, v15
  v_alignbyte_b32 v42, v127, v126, v15
  v_alignbyte_b32 v43, v128, v127, v15
  v_mfma_f32_16x16x32_bf16 a[160:163], v[36:39], v[68:71], a[160:163]
  s_waitcnt lgkmcnt(2)
  v_alignbyte_b32 v44, v131, v130, v15
  v_alignbyte_b32 v45, v132, v131, v15
  v_alignbyte_b32 v46, v133, v132, v15
  v_alignbyte_b32 v47, v134, v133, v15
  v_mfma_f32_16x16x32_bf16 a[192:195], v[40:43], v[72:75], a[192:195]
  s_nop 0
  v_mfma_f32_16x16x32_bf16 a[224:227], v[44:47], v[76:79], a[224:227]
  s_waitcnt lgkmcnt(0)
  ds_read_b128 v[48:51], v4 offset:3072
  ds_read_b128 v[52:55], v4 offset:7680
  ds_read_b128 v[56:59], v4 offset:12288
  ds_read_b128 v[60:63], v4 offset:16896
  ds_read_b128 v[64:67], v4 offset:21504
  ds_read_b128 v[68:71], v4 offset:26112
  ds_read_b128 v[72:75], v4 offset:30720
  ds_read_b128 v[76:79], v4 offset:35328
  s_mov_b32 exec_lo, s42
  s_mov_b32 exec_hi, s42
  ds_write_b128 v6, a[0:3] offset:0
  ds_write_b128 v6, a[32:35] offset:128
  ds_write_b128 v6, a[64:67] offset:256
  ds_write_b128 v6, a[96:99] offset:384
  ds_write_b128 v6, a[128:131] offset:512
  ds_write_b128 v6, a[160:163] offset:640
  ds_write_b128 v6, a[192:195] offset:768
  ds_write_b128 v6, a[224:227] offset:896
  s_mov_b64 exec, -1
  ds_read_b128 v[80:83], v7
  ds_write_b32 v14, v13 offset:8
  v_lshlrev_b32 v88, 16, v84
  v_and_b32 v89, 0xffff0000, v84
  v_lshlrev_b32 v90, 16, v85
  v_and_b32 v91, 0xffff0000, v85
  v_lshlrev_b32 v96, 16, v86
  v_and_b32 v97, 0xffff0000, v86
  v_lshlrev_b32 v98, 16, v87
  v_and_b32 v99, 0xffff0000, v87
  v_mul_f32 v92, v88, v12
  v_mul_f32 v93, v89, v12
  v_mul_f32 v94, v90, v12
  v_mul_f32 v95, v91, v12
  v_cvt_pk_bf16_f32 v84, v92, v93
  v_cvt_pk_bf16_f32 v85, v94, v95
  v_lshlrev_b32 v92, 16, v84
  v_and_b32 v93, 0xffff0000, v84
  v_lshlrev_b32 v94, 16, v85
  v_and_b32 v95, 0xffff0000, v85
  s_waitcnt lgkmcnt(1)
  v_fmac_f32 v80, v88, v11
  v_fmac_f32 v81, v89, v11
  v_fmac_f32 v82, v90, v11
  v_fmac_f32 v83, v91, v11
  v_cvt_pk_bf16_f32 v84, v80, v81
  v_cvt_pk_bf16_f32 v85, v82, v83
  v_lshlrev_b32 v80, 16, v84
  v_and_b32 v81, 0xffff0000, v84
  v_lshlrev_b32 v82, 16, v85
  v_and_b32 v83, 0xffff0000, v85
  v_add_f32 v80, v80, v92
  v_add_f32 v81, v81, v93
  v_add_f32 v82, v82, v94
  v_add_f32 v83, v83, v95
  v_cvt_pk_bf16_f32 v84, v80, v81
  v_cvt_pk_bf16_f32 v85, v82, v83
  v_lshlrev_b32 v80, 16, v84
  v_and_b32 v81, 0xffff0000, v84
  v_lshlrev_b32 v82, 16, v85
  v_and_b32 v83, 0xffff0000, v85
  v_add_f32 v80, v80, v96
  v_add_f32 v81, v81, v97
  v_add_f32 v82, v82, v98
  v_add_f32 v83, v83, v99
  v_cvt_pk_bf16_f32 v84, v80, v81
  v_cvt_pk_bf16_f32 v85, v82, v83
  buffer_store_dwordx2 v[84:85], v10, s[8:11], s40 offen sc1
  v_mfma_f32_16x16x32_bf16 a[4:7], v[16:19], v[48:51], a[4:7]
  ds_read_b128 v[48:51], v4 offset:2560
  v_mfma_f32_16x16x32_bf16 a[36:39], v[20:23], v[52:55], a[36:39]
  ds_read_b128 v[52:55], v4 offset:7168
  v_mfma_f32_16x16x32_bf16 a[68:71], v[24:27], v[56:59], a[68:71]
  ds_read_b128 v[56:59], v4 offset:11776
  v_mfma_f32_16x16x32_bf16 a[100:103], v[28:31], v[60:63], a[100:103]
  ds_read_b128 v[60:63], v4 offset:16384
  v_mfma_f32_16x16x32_bf16 a[132:135], v[32:35], v[64:67], a[132:135]
  ds_read_b128 v[64:67], v4 offset:20992
  v_mfma_f32_16x16x32_bf16 a[164:167], v[36:39], v[68:71], a[164:167]
  ds_read_b128 v[68:71], v4 offset:25600
  v_mfma_f32_16x16x32_bf16 a[196:199], v[40:43], v[72:75], a[196:199]
  ds_read_b128 v[72:75], v4 offset:30208
  v_mfma_f32_16x16x32_bf16 a[228:231], v[44:47], v[76:79], a[228:231]
  ds_read_b128 v[76:79], v4 offset:34816
  s_waitcnt lgkmcnt(7)
  v_mfma_f32_16x16x32_bf16 a[8:11], v[16:19], v[48:51], a[8:11]
  ds_read_b128 v[48:51], v4 offset:2048
  s_waitcnt lgkmcnt(7)
  v_mfma_f32_16x16x32_bf16 a[40:43], v[20:23], v[52:55], a[40:43]
  ds_read_b128 v[52:55], v4 offset:6656
  s_waitcnt lgkmcnt(7)
  v_mfma_f32_16x16x32_bf16 a[72:75], v[24:27], v[56:59], a[72:75]
  ds_read_b128 v[56:59], v4 offset:11264
  s_waitcnt lgkmcnt(7)
  v_mfma_f32_16x16x32_bf16 a[104:107], v[28:31], v[60:63], a[104:107]
  ds_read_b128 v[60:63], v4 offset:15872
  s_waitcnt lgkmcnt(7)
  v_mfma_f32_16x16x32_bf16 a[136:139], v[32:35], v[64:67], a[136:139]
  ds_read_b128 v[64:67], v4 offset:20480
  s_waitcnt lgkmcnt(7)
  v_mfma_f32_16x16x32_bf16 a[168:171], v[36:39], v[68:71], a[168:171]
  ds_read_b128 v[68:71], v4 offset:25088
  s_waitcnt lgkmcnt(7)
  v_mfma_f32_16x16x32_bf16 a[200:203], v[40:43], v[72:75], a[200:203]
  ds_read_b128 v[72:75], v4 offset:29696
  s_waitcnt lgkmcnt(7)
  v_mfma_f32_16x16x32_bf16 a[232:235], v[44:47], v[76:79], a[232:235]
  ds_read_b128 v[76:79], v4 offset:34304
  s_waitcnt lgkmcnt(7)
  v_mfma_f32_16x16x32_bf16 a[12:15], v[16:19], v[48:51], a[12:15]
  ds_read_b128 v[48:51], v4 offset:1536
  s_waitcnt lgkmcnt(7)
  v_mfma_f32_16x16x32_bf16 a[44:47], v[20:23], v[52:55], a[44:47]
  ds_read_b128 v[52:55], v4 offset:6144
  s_waitcnt lgkmcnt(7)
  v_mfma_f32_16x16x32_bf16 a[76:79], v[24:27], v[56:59], a[76:79]
  ds_read_b128 v[56:59], v4 offset:10752
  s_waitcnt lgkmcnt(7)
  v_mfma_f32_16x16x32_bf16 a[108:111], v[28:31], v[60:63], a[108:111]
  ds_read_b128 v[60:63], v4 offset:15360
  s_waitcnt lgkmcnt(7)
  v_mfma_f32_16x16x32_bf16 a[140:143], v[32:35], v[64:67], a[140:143]
  ds_read_b128 v[64:67], v4 offset:19968
  s_waitcnt lgkmcnt(7)
  v_mfma_f32_16x16x32_bf16 a[172:175], v[36:39], v[68:71], a[172:175]
  ds_read_b128 v[68:71], v4 offset:24576
  s_waitcnt lgkmcnt(7)
  v_mfma_f32_16x16x32_bf16 a[204:207], v[40:43], v[72:75], a[204:207]
  ds_read_b128 v[72:75], v4 offset:29184
  s_waitcnt lgkmcnt(7)
  v_mfma_f32_16x16x32_bf16 a[236:239], v[44:47], v[76:79], a[236:239]
  ds_read_b128 v[76:79], v4 offset:33792
  s_waitcnt lgkmcnt(7)
  v_mfma_f32_16x16x32_bf16 a[16:19], v[16:19], v[48:51], a[16:19]
  ds_read_b128 v[48:51], v4 offset:1024
  s_waitcnt lgkmcnt(7)
  v_mfma_f32_16x16x32_bf16 a[48:51], v[20:23], v[52:55], a[48:51]
  ds_read_b128 v[52:55], v4 offset:5632
  s_waitcnt lgkmcnt(7)
  v_mfma_f32_16x16x32_bf16 a[80:83], v[24:27], v[56:59], a[80:83]
  ds_read_b128 v[56:59], v4 offset:10240
  s_waitcnt lgkmcnt(7)
  v_mfma_f32_16x16x32_bf16 a[112:115], v[28:31], v[60:63], a[112:115]
  ds_read_b128 v[60:63], v4 offset:14848
  s_waitcnt lgkmcnt(7)
  v_mfma_f32_16x16x32_bf16 a[144:147], v[32:35], v[64:67], a[144:147]
  ds_read_b128 v[64:67], v4 offset:19456
  s_waitcnt lgkmcnt(7)
  v_mfma_f32_16x16x32_bf16 a[176:179], v[36:39], v[68:71], a[176:179]
  ds_read_b128 v[68:71], v4 offset:24064
  s_waitcnt lgkmcnt(7)
  v_mfma_f32_16x16x32_bf16 a[208:211], v[40:43], v[72:75], a[208:211]
  ds_read_b128 v[72:75], v4 offset:28672
  s_waitcnt lgkmcnt(7)
  v_mfma_f32_16x16x32_bf16 a[240:243], v[44:47], v[76:79], a[240:243]
  ds_read_b128 v[76:79], v4 offset:33280
  s_waitcnt lgkmcnt(7)
  v_mfma_f32_16x16x32_bf16 a[20:23], v[16:19], v[48:51], a[20:23]
  ds_read_b128 v[48:51], v4 offset:512
  s_waitcnt lgkmcnt(7)
  v_mfma_f32_16x16x32_bf16 a[52:55], v[20:23], v[52:55], a[52:55]
  ds_read_b128 v[52:55], v4 offset:5120
  s_waitcnt lgkmcnt(7)
  v_mfma_f32_16x16x32_bf16 a[84:87], v[24:27], v[56:59], a[84:87]
  ds_read_b128 v[56:59], v4 offset:9728
  s_waitcnt lgkmcnt(7)
  v_mfma_f32_16x16x32_bf16 a[116:119], v[28:31], v[60:63], a[116:119]
  ds_read_b128 v[60:63], v4 offset:14336
  s_waitcnt lgkmcnt(7)
  v_mfma_f32_16x16x32_bf16 a[148:151], v[32:35], v[64:67], a[148:151]
  ds_read_b128 v[64:67], v4 offset:18944
  s_waitcnt lgkmcnt(7)
  v_mfma_f32_16x16x32_bf16 a[180:183], v[36:39], v[68:71], a[180:183]
  ds_read_b128 v[68:71], v4 offset:23552
  s_waitcnt lgkmcnt(7)
  v_mfma_f32_16x16x32_bf16 a[212:215], v[40:43], v[72:75], a[212:215]
  ds_read_b128 v[72:75], v4 offset:28160
  s_waitcnt lgkmcnt(7)
  v_mfma_f32_16x16x32_bf16 a[244:247], v[44:47], v[76:79], a[244:247]
  ds_read_b128 v[76:79], v4 offset:32768
  s_waitcnt lgkmcnt(7)
  v_mfma_f32_16x16x32_bf16 a[24:27], v[16:19], v[48:51], a[24:27]
  ds_read_b128 v[48:51], v4 offset:0
  s_waitcnt lgkmcnt(7)
  v_mfma_f32_16x16x32_bf16 a[56:59], v[20:23], v[52:55], a[56:59]
  ds_read_b128 v[52:55], v4 offset:4608
  s_waitcnt lgkmcnt(7)
  v_mfma_f32_16x16x32_bf16 a[88:91], v[24:27], v[56:59], a[88:91]
  ds_read_b128 v[56:59], v4 offset:9216
  s_waitcnt lgkmcnt(7)
  v_mfma_f32_16x16x32_bf16 a[120:123], v[28:31], v[60:63], a[120:123]
  ds_read_b128 v[60:63], v4 offset:13824
  s_waitcnt lgkmcnt(7)
  v_mfma_f32_16x16x32_bf16 a[152:155], v[32:35], v[64:67], a[152:155]
  ds_read_b128 v[64:67], v4 offset:18432
  s_waitcnt lgkmcnt(7)
  v_mfma_f32_16x16x32_bf16 a[184:187], v[36:39], v[68:71], a[184:187]
  ds_read_b128 v[68:71], v4 offset:23040
  s_waitcnt lgkmcnt(7)
  v_mfma_f32_16x16x32_bf16 a[216:219], v[40:43], v[72:75], a[216:219]
  ds_read_b128 v[72:75], v4 offset:27648
  s_waitcnt lgkmcnt(7)
  v_mfma_f32_16x16x32_bf16 a[248:251], v[44:47], v[76:79], a[248:251]
  ds_read_b128 v[76:79], v4 offset:32256
  s_waitcnt lgkmcnt(7)
  v_mfma_f32_16x16x32_bf16 a[28:31], v[16:19], v[48:51], a[28:31]
  s_waitcnt lgkmcnt(6)
  v_mfma_f32_16x16x32_bf16 a[60:63], v[20:23], v[52:55], a[60:63]
  s_waitcnt lgkmcnt(5)
  v_mfma_f32_16x16x32_bf16 a[92:95], v[24:27], v[56:59], a[92:95]
  s_waitcnt lgkmcnt(4)
  v_mfma_f32_16x16x32_bf16 a[124:127], v[28:31], v[60:63], a[124:127]
  s_waitcnt lgkmcnt(3)
  v_mfma_f32_16x16x32_bf16 a[156:159], v[32:35], v[64:67], a[156:159]
  s_waitcnt lgkmcnt(2)
  v_mfma_f32_16x16x32_bf16 a[188:191], v[36:39], v[68:71], a[188:191]
  s_waitcnt lgkmcnt(1)
  v_mfma_f32_16x16x32_bf16 a[220:223], v[40:43], v[72:75], a[220:223]
  s_waitcnt lgkmcnt(0)
  v_mfma_f32_16x16x32_bf16 a[252:255], v[44:47], v[76:79], a[252:255]
  v_add_u32 v104, 64, v104
  v_add_u32 v105, 64, v105
  v_add_u32 v106, 64, v106
  v_add_u32 v107, 64, v107
  v_add_u32 v108, 64, v108
  v_add_u32 v109, 64, v109
  v_add_u32 v110, 64, v110
  v_add_u32 v111, 64, v111
  v_add_u32 v4, 64, v4
  v_add_u32 v8, 64, v8
  s_add_u32 s40, s40, 0x8000
  s_waitcnt vmcnt(0)
  s_mov_b64 exec, 1
  buffer_store_dword v13, v1, s[8:11], s39 offen sc1
  s_mov_b64 exec, -1
  ds_write_b32 v14, v13 offset:16
  s_add_u32 s32, s32, 1
  s_and_b32 s6, s32, 7
  s_cbranch_scc1 L_c_conv0
L_c_conv1:
  s_add_u32 s33, s32, 1
  s_and_b32 s6, s32, 7
  s_lshl_b32 s7, s6, 10
  s_add_u32 s7, s7, s35
  v_add_u32 v9, s7, v10
  s_lshl_b32 s6, s6, 1
  s_lshl_b32 s42, 0x30003, s6
  v_mov_b32 v13, s33
  ds_read_b128 v[48:51], v4 offset:3072
  ds_read_b128 v[52:55], v4 offset:7680
  ds_read_b128 v[56:59], v4 offset:12288
  ds_read_b128 v[60:63], v4 offset:16896
  ds_read_b128 v[64:67], v4 offset:21504
  ds_read_b128 v[68:71], v4 offset:26112
  ds_read_b128 v[72:75], v4 offset:30720
  ds_read_b128 v[76:79], v4 offset:35328
  s_mov_b32 s7, 0
L_lw_120:
  ds_read_b32 v88, v2 offset:0
  s_waitcnt lgkmcnt(0)
  v_cmp_gt_i32 vcc, s33, v88
  s_cbranch_vccz L_lwo_121
  s_add_u32 s7, s7, 1
  s_cmp_lt_u32 s7, 131072
  s_cbranch_scc1 L_lw_120
  s_mov_b32 s6, 42
  s_branch L_err
L_lwo_121:
  ds_read2_b32 v[112:113], v104 offset0:0 offset1:1
  ds_read2_b32 v[114:115], v104 offset0:2 offset1:3
  ds_read_b32 v116, v104 offset:16
  ds_read2_b32 v[118:119], v105 offset0:0 offset1:1
  ds_read2_b32 v[120:121], v105 offset0:2 offset1:3
  ds_read_b32 v122, v105 offset:16
  ds_read2_b32 v[124:125], v106 offset0:0 offset1:1
  ds_read2_b32 v[126:127], v106 offset0:2 offset1:3
  ds_read_b32 v128, v106 offset:16
  ds_read2_b32 v[130:131], v107 offset0:0 offset1:1
  ds_read2_b32 v[132:133], v107 offset0:2 offset1:3
  ds_read_b32 v134, v107 offset:16
  s_waitcnt lgkmcnt(9)
  v_alignbyte_b32 v16, v113, v112, v15
  v_alignbyte_b32 v17, v114, v113, v15
  v_alignbyte_b32 v18, v115, v114, v15
  v_alignbyte_b32 v19, v116, v115, v15
  ds_read2_b32 v[112:113], v108 offset0:0 offset1:1
  ds_read2_b32 v[114:115], v108 offset0:2 offset1:3
  ds_read_b32 v116, v108 offset:16
  s_waitcnt lgkmcnt(9)
  v_alignbyte_b32 v20, v119, v118, v15
  v_alignbyte_b32 v21, v120, v119, v15
  v_alignbyte_b32 v22, v121, v120, v15
  v_alignbyte_b32 v23, v122, v121, v15
  ds_read2_b32 v[118:119], v109 offset0:0 offset1:1
  ds_read2_b32 v[120:121], v109 offset0:2 offset1:3
  ds_read_b32 v122, v109 offset:16
  v_mfma_f32_16x16x32_bf16 a[4:7], v[16:19], v[48:51], a[4:7]
  s_waitcnt lgkmcnt(9)
  v_alignbyte_b32 v24, v125, v124, v15
  v_alignbyte_b32 v25, v126, v125, v15
  v_alignbyte_b32 v26, v127, v126, v15
  v_alignbyte_b32 v27, v128, v127, v15
  ds_read2_b32 v[124:125], v110 offset0:0 offset1:1
  ds_read2_b32 v[126:127], v110 offset0:2 offset1:3
  ds_read_b32 v128, v110 offset:16
  v_mfma_f32_16x16x32_bf16 a[36:39], v[20:23], v[52:55], a[36:39]
  s_waitcnt lgkmcnt(9)
  v_alignbyte_b32 v28, v131, v130, v15
  v_alignbyte_b32 v29, v132, v131, v15
  v_alignbyte_b32 v30, v133, v132, v15
  v_alignbyte_b32 v31, v134, v133, v15
  ds_read2_b32 v[130:131], v111 offset0:0 offset1:1
  ds_read2_b32 v[132:133], v111 offset0:2 offset1:3
  ds_read_b32 v134, v111 offset:16
  v_mfma_f32_16x16x32_bf16 a[68:71], v[24:27], v[56:59], a[68:71]
  s_waitcnt lgkmcnt(9)
  v_alignbyte_b32 v32, v113, v112, v15
  v_alignbyte_b32 v33, v114, v113, v15
  v_alignbyte_b32 v34, v115, v114, v15
  v_alignbyte_b32 v35, v116, v115, v15
  ds_read_b64 v[84:85], v8
  ds_read_b64 v[86:87], v9
  v_mfma_f32_16x16x32_bf16 a[100:103], v[28:31], v[60:63], a[100:103]
  s_waitcnt lgkmcnt(8)
  v_alignbyte_b32 v36, v119, v118, v15
  v_alignbyte_b32 v37, v120, v119, v15
  v_alignbyte_b32 v38, v121, v120, v15
  v_alignbyte_b32 v39, v122, v121, v15
  v_mfma_f32_16x16x32_bf16 a[132:135], v[32:35], v[64:67], a[132:135]
  s_waitcnt lgkmcnt(5)
  v_alignbyte_b32 v40, v125, v124, v15
  v_alignbyte_b32 v41, v126, v125, v15
  v_alignbyte_b32 v42, v127, v126, v15
  v_alignbyte_b32 v43, v128, v127, v15
  v_mfma_f32_16x16x32_bf16 a[164:167], v[36:39], v[68:71], a[164:167]
  s_waitcnt lgkmcnt(2)
  v_alignbyte_b32 v44, v131, v130, v15
  v_alignbyte_b32 v45, v132, v131, v15
  v_alignbyte_b32 v46, v133, v132, v15
  v_alignbyte_b32 v47, v134, v133, v15
  v_mfma_f32_16x16x32_bf16 a[196:199], v[40:43], v[72:75], a[196:199]
  s_nop 0
  v_mfma_f32_16x16x32_bf16 a[228:231], v[44:47], v[76:79], a[228:231]
  s_waitcnt lgkmcnt(0)
  ds_read_b128 v[48:51], v4 offset:2560
  ds_read_b128 v[52:55], v4 offset:7168
  ds_read_b128 v[56:59], v4 offset:11776
  ds_read_b128 v[60:63], v4 offset:16384
  ds_read_b128 v[64:67], v4 offset:20992
  ds_read_b128 v[68:71], v4 offset:25600
  ds_read_b128 v[72:75], v4 offset:30208
  ds_read_b128 v[76:79], v4 offset:34816
  s_mov_b32 exec_lo, s42
  s_mov_b32 exec_hi, s42
  ds_write_b128 v6, a[4:7] offset:0
  ds_write_b128 v6, a[36:39] offset:128
  ds_write_b128 v6, a[68:71] offset:256
  ds_write_b128 v6, a[100:103] offset:384
  ds_write_b128 v6, a[132:135] offset:512
  ds_write_b128 v6, a[164:167] offset:640
  ds_write_b128 v6, a[196:199] offset:768
  ds_write_b128 v6, a[228:231] offset:896
  s_mov_b64 exec, -1
  ds_read_b128 v[80:83], v7
  ds_write_b32 v14, v13 offset:8
  v_lshlrev_b32 v88, 16, v84
  v_and_b32 v89, 0xffff0000, v84
  v_lshlrev_b32 v90, 16, v85
  v_and_b32 v91, 0xffff0000, v85
  v_lshlrev_b32 v96, 16, v86
  v_and_b32 v97, 0xffff0000, v86
  v_lshlrev_b32 v98, 16, v87
  v_and_b32 v99, 0xffff0000, v87
  v_mul_f32 v92, v88, v12
  v_mul_f32 v93, v89, v12
  v_mul_f32 v94, v90, v12
  v_mul_f32 v95, v91, v12
  v_cvt_pk_bf16_f32 v84, v92, v93
  v_cvt_pk_bf16_f32 v85, v94, v95
  v_lshlrev_b32 v92, 16, v84
  v_and_b32 v93, 0xffff0000, v84
  v_lshlrev_b32 v94, 16, v85
  v_and_b32 v95, 0xffff0000, v85
  s_waitcnt lgkmcnt(1)
  v_fmac_f32 v80, v88, v11
  v_fmac_f32 v81, v89, v11
  v_fmac_f32 v82, v90, v11
  v_fmac_f32 v83, v91, v11
  v_cvt_pk_bf16_f32 v84, v80, v81
  v_cvt_pk_bf16_f32 v85, v82, v83
  v_lshlrev_b32 v80, 16, v84
  v_and_b32 v81, 0xffff0000, v84
  v_lshlrev_b32 v82, 16, v85
  v_and_b32 v83, 0xffff0000, v85
  v_add_f32 v80, v80, v92
  v_add_f32 v81, v81, v93
  v_add_f32 v82, v82, v94
  v_add_f32 v83, v83, v95
  v_cvt_pk_bf16_f32 v84, v80, v81
  v_cvt_pk_bf16_f32 v85, v82, v83
  v_lshlrev_b32 v80, 16, v84
  v_and_b32 v81, 0xffff0000, v84
  v_lshlrev_b32 v82, 16, v85
  v_and_b32 v83, 0xffff0000, v85
  v_add_f32 v80, v80, v96
  v_add_f32 v81, v81, v97
  v_add_f32 v82, v82, v98
  v_add_f32 v83, v83, v99
  v_cvt_pk_bf16_f32 v84, v80, v81
  v_cvt_pk_bf16_f32 v85, v82, v83
  buffer_store_dwordx2 v[84:85], v10, s[8:11], s40 offen sc1
  v_mfma_f32_16x16x32_bf16 a[8:11], v[16:19], v[48:51], a[8:11]
  ds_read_b128 v[48:51], v4 offset:2048
  v_mfma_f32_16x16x32_bf16 a[40:43], v[20:23], v[52:55], a[40:43]
  ds_read_b128 v[52:55], v4 offset:6656
  v_mfma_f32_16x16x32_bf16 a[72:75], v[24:27], v[56:59], a[72:75]
  ds_read_b128 v[56:59], v4 offset:11264
  v_mfma_f32_16x16x32_bf16 a[104:107], v[28:31], v[60:63], a[104:107]
  ds_read_b128 v[60:63], v4 offset:15872
  v_mfma_f32_16x16x32_bf16 a[136:139], v[32:35], v[64:67], a[136:139]
  ds_read_b128 v[64:67], v4 offset:20480
  v_mfma_f32_16x16x32_bf16 a[168:171], v[36:39], v[68:71], a[168:171]
  ds_read_b128 v[68:71], v4 offset:25088
  v_mfma_f32_16x16x32_bf16 a[200:203], v[40:43], v[72:75], a[200:203]
  ds_read_b128 v[72:75], v4 offset:29696
  v_mfma_f32_16x16x32_bf16 a[232:235], v[44:47], v[76:79], a[232:235]
  ds_read_b128 v[76:79], v4 offset:34304
  s_waitcnt lgkmcnt(7)
  v_mfma_f32_16x16x32_bf16 a[12:15], v[16:19], v[48:51], a[12:15]
  ds_read_b128 v[48:51], v4 offset:1536
  s_waitcnt lgkmcnt(7)
  v_mfma_f32_16x16x32_bf16 a[44:47], v[20:23], v[52:55], a[44:47]
  ds_read_b128 v[52:55], v4 offset:6144
  s_waitcnt lgkmcnt(7)
  v_mfma_f32_16x16x32_bf16 a[76:79], v[24:27], v[56:59], a[76:79]
  ds_read_b128 v[56:59], v4 offset:10752
  s_waitcnt lgkmcnt(7)
  v_mfma_f32_16x16x32_bf16 a[108:111], v[28:31], v[60:63], a[108:111]
  ds_read_b128 v[60:63], v4 offset:15360
  s_waitcnt lgkmcnt(7)
  v_mfma_f32_16x16x32_bf16 a[140:143], v[32:35], v[64:67], a[140:143]
  ds_read_b128 v[64:67], v4 offset:19968
  s_waitcnt lgkmcnt(7)
  v_mfma_f32_16x16x32_bf16 a[172:175], v[36:39], v[68:71], a[172:175]
  ds_read_b128 v[68:71], v4 offset:24576
  s_waitcnt lgkmcnt(7)
  v_mfma_f32_16x16x32_bf16 a[204:207], v[40:43], v[72:75], a[204:207]
  ds_read_b128 v[72:75], v4 offset:29184
  s_waitcnt lgkmcnt(7)
  v_mfma_f32_16x16x32_bf16 a[236:239], v[44:47], v[76:79], a[236:239]
  ds_read_b128 v[76:79], v4 offset:33792
  s_waitcnt lgkmcnt(7)
  v_mfma_f32_16x16x32_bf16 a[16:19], v[16:19], v[48:51], a[16:19]
  ds_read_b128 v[48:51], v4 offset:1024
  s_waitcnt lgkmcnt(7)
  v_mfma_f32_16x16x32_bf16 a[48:51], v[20:23], v[52:55], a[48:51]
  ds_read_b128 v[52:55], v4 offset:5632
  s_waitcnt lgkmcnt(7)
  v_mfma_f32_16x16x32_bf16 a[80:83], v[24:27], v[56:59], a[80:83]
  ds_read_b128 v[56:59], v4 offset:10240
  s_waitcnt lgkmcnt(7)
  v_mfma_f32_16x16x32_bf16 a[112:115], v[28:31], v[60:63], a[112:115]
  ds_read_b128 v[60:63], v4 offset:14848
  s_waitcnt lgkmcnt(7)
  v_mfma_f32_16x16x32_bf16 a[144:147], v[32:35], v[64:67], a[144:147]
  ds_read_b128 v[64:67], v4 offset:19456
  s_waitcnt lgkmcnt(7)
  v_mfma_f32_16x16x32_bf16 a[176:179], v[36:39], v[68:71], a[176:179]
  ds_read_b128 v[68:71], v4 offset:24064
  s_waitcnt lgkmcnt(7)
  v_mfma_f32_16x16x32_bf16 a[208:211], v[40:43], v[72:75], a[208:211]
  ds_read_b128 v[72:75], v4 offset:28672
  s_waitcnt lgkmcnt(7)
  v_mfma_f32_16x16x32_bf16 a[240:243], v[44:47], v[76:79], a[240:243]
  ds_read_b128 v[76:79], v4 offset:33280
  s_waitcnt lgkmcnt(7)
  v_mfma_f32_16x16x32_bf16 a[20:23], v[16:19], v[48:51], a[20:23]
  ds_read_b128 v[48:51], v4 offset:512
  s_waitcnt lgkmcnt(7)
  v_mfma_f32_16x16x32_bf16 a[52:55], v[20:23], v[52:55], a[52:55]
  ds_read_b128 v[52:55], v4 offset:5120
  s_waitcnt lgkmcnt(7)
  v_mfma_f32_16x16x32_bf16 a[84:87], v[24:27], v[56:59], a[84:87]
  ds_read_b128 v[56:59], v4 offset:9728
  s_waitcnt lgkmcnt(7)
  v_mfma_f32_16x16x32_bf16 a[116:119], v[28:31], v[60:63], a[116:119]
  ds_read_b128 v[60:63], v4 offset:14336
  s_waitcnt lgkmcnt(7)
  v_mfma_f32_16x16x32_bf16 a[148:151], v[32:35], v[64:67], a[148:151]
  ds_read_b128 v[64:67], v4 offset:18944
  s_waitcnt lgkmcnt(7)
  v_mfma_f32_16x16x32_bf16 a[180:183], v[36:39], v[68:71], a[180:183]
  ds_read_b128 v[68:71], v4 offset:23552
  s_waitcnt lgkmcnt(7)
  v_mfma_f32_16x16x32_bf16 a[212:215], v[40:43], v[72:75], a[212:215]
  ds_read_b128 v[72:75], v4 offset:28160
  s_waitcnt lgkmcnt(7)
  v_mfma_f32_16x16x32_bf16 a[244:247], v[44:47], v[76:79], a[244:247]
  ds_read_b128 v[76:79], v4 offset:32768
  s_waitcnt lgkmcnt(7)
  v_mfma_f32_16x16x32_bf16 a[24:27], v[16:19], v[48:51], a[24:27]
  ds_read_b128 v[48:51], v4 offset:0
  s_waitcnt lgkmcnt(7)
  v_mfma_f32_16x16x32_bf16 a[56:59], v[20:23], v[52:55], a[56:59]
  ds_read_b128 v[52:55], v4 offset:4608
  s_waitcnt lgkmcnt(7)
  v_mfma_f32_16x16x32_bf16 a[88:91], v[24:27], v[56:59], a[88:91]
  ds_read_b128 v[56:59], v4 offset:9216
  s_waitcnt lgkmcnt(7)
  v_mfma_f32_16x16x32_bf16 a[120:123], v[28:31], v[60:63], a[120:123]
  ds_read_b128 v[60:63], v4 offset:13824
  s_waitcnt lgkmcnt(7)
  v_mfma_f32_16x16x32_bf16 a[152:155], v[32:35], v[64:67], a[152:155]
  ds_read_b128 v[64:67], v4 offset:18432
  s_waitcnt lgkmcnt(7)
  v_mfma_f32_16x16x32_bf16 a[184:187], v[36:39], v[68:71], a[184:187]
  ds_read_b128 v[68:71], v4 offset:23040
  s_waitcnt lgkmcnt(7)
  v_mfma_f32_16x16x32_bf16 a[216:219], v[40:43], v[72:75], a[216:219]
  ds_read_b128 v[72:75], v4 offset:27648
  s_waitcnt lgkmcnt(7)
  v_mfma_f32_16x16x32_bf16 a[248:251], v[44:47], v[76:79], a[248:251]
  ds_read_b128 v[76:79], v4 offset:32256
  s_waitcnt lgkmcnt(7)
  v_mfma_f32_16x16x32_bf16 a[28:31], v[16:19], v[48:51], a[28:31]
  s_waitcnt lgkmcnt(6)
  v_mfma_f32_16x16x32_bf16 a[60:63], v[20:23], v[52:55], a[60:63]
  s_waitcnt lgkmcnt(5)
  v_mfma_f32_16x16x32_bf16 a[92:95], v[24:27], v[56:59], a[92:95]
  s_waitcnt lgkmcnt(4)
  v_mfma_f32_16x16x32_bf16 a[124:127], v[28:31], v[60:63], a[124:127]
  s_waitcnt lgkmcnt(3)
  v_mfma_f32_16x16x32_bf16 a[156:159], v[32:35], v[64:67], a[156:159]
  s_waitcnt lgkmcnt(2)
  v_mfma_f32_16x16x32_bf16 a[188:191], v[36:39], v[68:71], a[188:191]
  s_waitcnt lgkmcnt(1)
  v_mfma_f32_16x16x32_bf16 a[220:223], v[40:43], v[72:75], a[220:223]
  s_waitcnt lgkmcnt(0)
  v_mfma_f32_16x16x32_bf16 a[252:255], v[44:47], v[76:79], a[252:255]
  v_add_u32 v104, 64, v104
  v_add_u32 v105, 64, v105
  v_add_u32 v106, 64, v106
  v_add_u32 v107, 64, v107
  v_add_u32 v108, 64, v108
  v_add_u32 v109, 64, v109
  v_add_u32 v110, 64, v110
  v_add_u32 v111, 64, v111
  v_add_u32 v4, 64, v4
  v_add_u32 v8, 64, v8
  s_add_u32 s40, s40, 0x8000
  s_waitcnt vmcnt(0)
  s_mov_b64 exec, 1
  buffer_store_dword v13, v1, s[8:11], s39 offen sc1
  s_mov_b64 exec, -1
  ds_write_b32 v14, v13 offset:16
  s_add_u32 s32, s32, 1
  s_and_b32 s6, s32, 7
  s_cbranch_scc1 L_c_conv1
L_c_conv2:
  s_add_u32 s33, s32, 1
  s_and_b32 s6, s32, 7
  s_lshl_b32 s7, s6, 10
  s_add_u32 s7, s7, s35
  v_add_u32 v9, s7, v10
  s_lshl_b32 s6, s6, 1
  s_lshl_b32 s42, 0x30003, s6
  v_mov_b32 v13, s33
  ds_read_b128 v[48:51], v4 offset:2560
  ds_read_b128 v[52:55], v4 offset:7168
  ds_read_b128 v[56:59], v4 offset:11776
  ds_read_b128 v[60:63], v4 offset:16384
  ds_read_b128 v[64:67], v4 offset:20992
  ds_read_b128 v[68:71], v4 offset:25600
  ds_read_b128 v[72:75], v4 offset:30208
  ds_read_b128 v[76:79], v4 offset:34816
  s_mov_b32 s7, 0
L_lw_122:
  ds_read_b32 v88, v2 offset:0
  s_waitcnt lgkmcnt(0)
  v_cmp_gt_i32 vcc, s33, v88
  s_cbranch_vccz L_lwo_123
  s_add_u32 s7, s7, 1
  s_cmp_lt_u32 s7, 131072
  s_cbranch_scc1 L_lw_122
  s_mov_b32 s6, 42
  s_branch L_err
L_lwo_123:
  ds_read2_b32 v[112:113], v104 offset0:0 offset1:1
  ds_read2_b32 v[114:115], v104 offset0:2 offset1:3
  ds_read_b32 v116, v104 offset:16
  ds_read2_b32 v[118:119], v105 offset0:0 offset1:1
  ds_read2_b32 v[120:121], v105 offset0:2 offset1:3
  ds_read_b32 v122, v105 offset:16
  ds_read2_b32 v[124:125], v106 offset0:0 offset1:1
  ds_read2_b32 v[126:127], v106 offset0:2 offset1:3
  ds_read_b32 v128, v106 offset:16
  ds_read2_b32 v[130:131], v107 offset0:0 offset1:1
  ds_read2_b32 v[132:133], v107 offset0:2 offset1:3
  ds_read_b32 v134, v107 offset:16
  s_waitcnt lgkmcnt(9)
  v_alignbyte_b32 v16, v113, v112, v15
  v_alignbyte_b32 v17, v114, v113, v15
  v_alignbyte_b32 v18, v115, v114, v15
  v_alignbyte_b32 v19, v116, v115, v15
  ds_read2_b32 v[112:113], v108 offset0:0 offset1:1
  ds_read2_b32 v[114:115], v108 offset0:2 offset1:3
  ds_read_b32 v116, v108 offset:16
  s_waitcnt lgkmcnt(9)
  v_alignbyte_b32 v20, v119, v118, v15
  v_alignbyte_b32 v21, v120, v119, v15
  v_alignbyte_b32 v22, v121, v120, v15
  v_alignbyte_b32 v23, v122, v121, v15
  ds_read2_b32 v[118:119], v109 offset0:0 offset1:1
  ds_read2_b32 v[120:121], v109 offset0:2 offset1:3
  ds_read_b32 v122, v109 offset:16
  v_mfma_f32_16x16x32_bf16 a[8:11], v[16:19], v[48:51], a[8:11]
  s_waitcnt lgkmcnt(9)
  v_alignbyte_b32 v24, v125, v124, v15
  v_alignbyte_b32 v25, v126, v125, v15
  v_alignbyte_b32 v26, v127, v126, v15
  v_alignbyte_b32 v27, v128, v127, v15
  ds_read2_b32 v[124:125], v110 offset0:0 offset1:1
  ds_read2_b32 v[126:127], v110 offset0:2 offset1:3
  ds_read_b32 v128, v110 offset:16
  v_mfma_f32_16x16x32_bf16 a[40:43], v[20:23], v[52:55], a[40:43]
  s_waitcnt lgkmcnt(9)
  v_alignbyte_b32 v28, v131, v130, v15
  v_alignbyte_b32 v29, v132, v131, v15
  v_alignbyte_b32 v30, v133, v132, v15
  v_alignbyte_b32 v31, v134, v133, v15
  ds_read2_b32 v[130:131], v111 offset0:0 offset1:1
  ds_read2_b32 v[132:133], v111 offset0:2 offset1:3
  ds_read_b32 v134, v111 offset:16
  v_mfma_f32_16x16x32_bf16 a[72:75], v[24:27], v[56:59], a[72:75]
  s_waitcnt lgkmcnt(9)
  v_alignbyte_b32 v32, v113, v112, v15
  v_alignbyte_b32 v33, v114, v113, v15
  v_alignbyte_b32 v34, v115, v114, v15
  v_alignbyte_b32 v35, v116, v115, v15
  ds_read_b64 v[84:85], v8
  ds_read_b64 v[86:87], v9
  v_mfma_f32_16x16x32_bf16 a[104:107], v[28:31], v[60:63], a[104:107]
  s_waitcnt lgkmcnt(8)
  v_alignbyte_b32 v36, v119, v118, v15
  v_alignbyte_b32 v37, v120, v119, v15
  v_alignbyte_b32 v38, v121, v120, v15
  v_alignbyte_b32 v39, v122, v121, v15
  v_mfma_f32_16x16x32_bf16 a[136:139], v[32:35], v[64:67], a[136:139]
  s_waitcnt lgkmcnt(5)
  v_alignbyte_b32 v40, v125, v124, v15
  v_alignbyte_b32 v41, v126, v125, v15
  v_alignbyte_b32 v42, v127, v126, v15
  v_alignbyte_b32 v43, v128, v127, v15
  v_mfma_f32_16x16x32_bf16 a[168:171], v[36:39], v[68:71], a[168:171]
  s_waitcnt lgkmcnt(2)
  v_alignbyte_b32 v44, v131, v130, v15
  v_alignbyte_b32 v45, v132, v131, v15
  v_alignbyte_b32 v46, v133, v132, v15
  v_alignbyte_b32 v47, v134, v133, v15
  v_mfma_f32_16x16x32_bf16 a[200:203], v[40:43], v[72:75], a[200:203]
  s_nop 0
  v_mfma_f32_16x16x32_bf16 a[232:235], v[44:47], v[76:79], a[232:235]
  s_waitcnt lgkmcnt(0)
  ds_read_b128 v[48:51], v4 offset:2048
  ds_read_b128 v[52:55], v4 offset:6656
  ds_read_b128 v[56:59], v4 offset:11264
  ds_read_b128 v[60:63], v4 offset:15872
  ds_read_b128 v[64:67], v4 offset:20480
  ds_read_b128 v[68:71], v4 offset:25088
  ds_read_b128 v[72:75], v4 offset:29696
  ds_read_b128 v[76:79], v4 offset:34304
  s_mov_b32 exec_lo, s42
  s_mov_b32 exec_hi, s42
  ds_write_b128 v6, a[8:11] offset:0
  ds_write_b128 v6, a[40:43] offset:128
  ds_write_b128 v6, a[72:75] offset:256
  ds_write_b128 v6, a[104:107] offset:384
  ds_write_b128 v6, a[136:139] offset:512
  ds_write_b128 v6, a[168:171] offset:640
  ds_write_b128 v6, a[200:203] offset:768
  ds_write_b128 v6, a[232:235] offset:896
  s_mov_b64 exec, -1
  ds_read_b128 v[80:83], v7
  ds_write_b32 v14, v13 offset:8
  v_lshlrev_b32 v88, 16, v84
  v_and_b32 v89, 0xffff0000, v84
  v_lshlrev_b32 v90, 16, v85
  v_and_b32 v91, 0xffff0000, v85
  v_lshlrev_b32 v96, 16, v86
  v_and_b32 v97, 0xffff0000, v86
  v_lshlrev_b32 v98, 16, v87
  v_and_b32 v99, 0xffff0000, v87
  v_mul_f32 v92, v88, v12
  v_mul_f32 v93, v89, v12
  v_mul_f32 v94, v90, v12
  v_mul_f32 v95, v91, v12
  v_cvt_pk_bf16_f32 v84, v92, v93
  v_cvt_pk_bf16_f32 v85, v94, v95
  v_lshlrev_b32 v92, 16, v84
  v_and_b32 v93, 0xffff0000, v84
  v_lshlrev_b32 v94, 16, v85
  v_and_b32 v95, 0xffff0000, v85
  s_waitcnt lgkmcnt(1)
  v_fmac_f32 v80, v88, v11
  v_fmac_f32 v81, v89, v11
  v_fmac_f32 v82, v90, v11
  v_fmac_f32 v83, v91, v11
  v_cvt_pk_bf16_f32 v84, v80, v81
  v_cvt_pk_bf16_f32 v85, v82, v83
  v_lshlrev_b32 v80, 16, v84
  v_and_b32 v81, 0xffff0000, v84
  v_lshlrev_b32 v82, 16, v85
  v_and_b32 v83, 0xffff0000, v85
  v_add_f32 v80, v80, v92
  v_add_f32 v81, v81, v93
  v_add_f32 v82, v82, v94
  v_add_f32 v83, v83, v95
  v_cvt_pk_bf16_f32 v84, v80, v81
  v_cvt_pk_bf16_f32 v85, v82, v83
  v_lshlrev_b32 v80, 16, v84
  v_and_b32 v81, 0xffff0000, v84
  v_lshlrev_b32 v82, 16, v85
  v_and_b32 v83, 0xffff0000, v85
  v_add_f32 v80, v80, v96
  v_add_f32 v81, v81, v97
  v_add_f32 v82, v82, v98
  v_add_f32 v83, v83, v99
  v_cvt_pk_bf16_f32 v84, v80, v81
  v_cvt_pk_bf16_f32 v85, v82, v83
  buffer_store_dwordx2 v[84:85], v10, s[8:11], s40 offen sc1
  v_mfma_f32_16x16x32_bf16 a[12:15], v[16:19], v[48:51], a[12:15]
  ds_read_b128 v[48:51], v4 offset:1536
  v_mfma_f32_16x16x32_bf16 a[44:47], v[20:23], v[52:55], a[44:47]
  ds_read_b128 v[52:55], v4 offset:6144
  v_mfma_f32_16x16x32_bf16 a[76:79], v[24:27], v[56:59], a[76:79]
  ds_read_b128 v[56:59], v4 offset:10752
  v_mfma_f32_16x16x32_bf16 a[108:111], v[28:31], v[60:63], a[108:111]
  ds_read_b128 v[60:63], v4 offset:15360
  v_mfma_f32_16x16x32_bf16 a[140:143], v[32:35], v[64:67], a[140:143]
  ds_read_b128 v[64:67], v4 offset:19968
  v_mfma_f32_16x16x32_bf16 a[172:175], v[36:39], v[68:71], a[172:175]
  ds_read_b128 v[68:71], v4 offset:24576
  v_mfma_f32_16x16x32_bf16 a[204:207], v[40:43], v[72:75], a[204:207]
  ds_read_b128 v[72:75], v4 offset:29184
  v_mfma_f32_16x16x32_bf16 a[236:239], v[44:47], v[76:79], a[236:239]
  ds_read_b128 v[76:79], v4 offset:33792
  s_waitcnt lgkmcnt(7)
  v_mfma_f32_16x16x32_bf16 a[16:19], v[16:19], v[48:51], a[16:19]
  ds_read_b128 v[48:51], v4 offset:1024
  s_waitcnt lgkmcnt(7)
  v_mfma_f32_16x16x32_bf16 a[48:51], v[20:23], v[52:55], a[48:51]
  ds_read_b128 v[52:55], v4 offset:5632
  s_waitcnt lgkmcnt(7)
  v_mfma_f32_16x16x32_bf16 a[80:83], v[24:27], v[56:59], a[80:83]
  ds_read_b128 v[56:59], v4 offset:10240
  s_waitcnt lgkmcnt(7)
  v_mfma_f32_16x16x32_bf16 a[112:115], v[28:31], v[60:63], a[112:115]
  ds_read_b128 v[60:63], v4 offset:14848
  s_waitcnt lgkmcnt(7)
  v_mfma_f32_16x16x32_bf16 a[144:147], v[32:35], v[64:67], a[144:147]
  ds_read_b128 v[64:67], v4 offset:19456
  s_waitcnt lgkmcnt(7)
  v_mfma_f32_16x16x32_bf16 a[176:179], v[36:39], v[68:71], a[176:179]
  ds_read_b128 v[68:71], v4 offset:24064
  s_waitcnt lgkmcnt(7)
  v_mfma_f32_16x16x32_bf16 a[208:211], v[40:43], v[72:75], a[208:211]
  ds_read_b128 v[72:75], v4 offset:28672
  s_waitcnt lgkmcnt(7)
  v_mfma_f32_16x16x32_bf16 a[240:243], v[44:47], v[76:79], a[240:243]
  ds_read_b128 v[76:79], v4 offset:33280
  s_waitcnt lgkmcnt(7)
  v_mfma_f32_16x16x32_bf16 a[20:23], v[16:19], v[48:51], a[20:23]
  ds_read_b128 v[48:51], v4 offset:512
  s_waitcnt lgkmcnt(7)
  v_mfma_f32_16x16x32_bf16 a[52:55], v[20:23], v[52:55], a[52:55]
  ds_read_b128 v[52:55], v4 offset:5120
  s_waitcnt lgkmcnt(7)
  v_mfma_f32_16x16x32_bf16 a[84:87], v[24:27], v[56:59], a[84:87]
  ds_read_b128 v[56:59], v4 offset:9728
  s_waitcnt lgkmcnt(7)
  v_mfma_f32_16x16x32_bf16 a[116:119], v[28:31], v[60:63], a[116:119]
  ds_read_b128 v[60:63], v4 offset:14336
  s_waitcnt lgkmcnt(7)
  v_mfma_f32_16x16x32_bf16 a[148:151], v[32:35], v[64:67], a[148:151]
  ds_read_b128 v[64:67], v4 offset:18944
  s_waitcnt lgkmcnt(7)
  v_mfma_f32_16x16x32_bf16 a[180:183], v[36:39], v[68:71], a[180:183]
  ds_read_b128 v[68:71], v4 offset:23552
  s_waitcnt lgkmcnt(7)
  v_mfma_f32_16x16x32_bf16 a[212:215], v[40:43], v[72:75], a[212:215]
  ds_read_b128 v[72:75], v4 offset:28160
  s_waitcnt lgkmcnt(7)
  v_mfma_f32_16x16x32_bf16 a[244:247], v[44:47], v[76:79], a[244:247]
  ds_read_b128 v[76:79], v4 offset:32768
  s_waitcnt lgkmcnt(7)
  v_mfma_f32_16x16x32_bf16 a[24:27], v[16:19], v[48:51], a[24:27]
  ds_read_b128 v[48:51], v4 offset:0
  s_waitcnt lgkmcnt(7)
  v_mfma_f32_16x16x32_bf16 a[56:59], v[20:23], v[52:55], a[56:59]
  ds_read_b128 v[52:55], v4 offset:4608
  s_waitcnt lgkmcnt(7)
  v_mfma_f32_16x16x32_bf16 a[88:91], v[24:27], v[56:59], a[88:91]
  ds_read_b128 v[56:59], v4 offset:9216
  s_waitcnt lgkmcnt(7)
  v_mfma_f32_16x16x32_bf16 a[120:123], v[28:31], v[60:63], a[120:123]
  ds_read_b128 v[60:63], v4 offset:13824
  s_waitcnt lgkmcnt(7)
  v_mfma_f32_16x16x32_bf16 a[152:155], v[32:35], v[64:67], a[152:155]
  ds_read_b128 v[64:67], v4 offset:18432
  s_waitcnt lgkmcnt(7)
  v_mfma_f32_16x16x32_bf16 a[184:187], v[36:39], v[68:71], a[184:187]
  ds_read_b128 v[68:71], v4 offset:23040
  s_waitcnt lgkmcnt(7)
  v_mfma_f32_16x16x32_bf16 a[216:219], v[40:43], v[72:75], a[216:219]
  ds_read_b128 v[72:75], v4 offset:27648
  s_waitcnt lgkmcnt(7)
  v_mfma_f32_16x16x32_bf16 a[248:251], v[44:47], v[76:79], a[248:251]
  ds_read_b128 v[76:79], v4 offset:32256
  s_waitcnt lgkmcnt(7)
  v_mfma_f32_16x16x32_bf16 a[28:31], v[16:19], v[48:51], a[28:31]
  s_waitcnt lgkmcnt(6)
  v_mfma_f32_16x16x32_bf16 a[60:63], v[20:23], v[52:55], a[60:63]
  s_waitcnt lgkmcnt(5)
  v_mfma_f32_16x16x32_bf16 a[92:95], v[24:27], v[56:59], a[92:95]
  s_waitcnt lgkmcnt(4)
  v_mfma_f32_16x16x32_bf16 a[124:127], v[28:31], v[60:63], a[124:127]
  s_waitcnt lgkmcnt(3)
  v_mfma_f32_16x16x32_bf16 a[156:159], v[32:35], v[64:67], a[156:159]
  s_waitcnt lgkmcnt(2)
  v_mfma_f32_16x16x32_bf16 a[188:191], v[36:39], v[68:71], a[188:191]
  s_waitcnt lgkmcnt(1)
  v_mfma_f32_16x16x32_bf16 a[220:223], v[40:43], v[72:75], a[220:223]
  s_waitcnt lgkmcnt(0)
  v_mfma_f32_16x16x32_bf16 a[252:255], v[44:47], v[76:79], a[252:255]
  v_add_u32 v104, 64, v104
  v_add_u32 v105, 64, v105
  v_add_u32 v106, 64, v106
  v_add_u32 v107, 64, v107
  v_add_u32 v108, 64, v108
  v_add_u32 v109, 64, v109
  v_add_u32 v110, 64, v110
  v_add_u32 v111, 64, v111
  v_add_u32 v4, 64, v4
  v_add_u32 v8, 64, v8
  s_add_u32 s40, s40, 0x8000
  s_waitcnt vmcnt(0)
  s_mov_b64 exec, 1
  buffer_store_dword v13, v1, s[8:11], s39 offen sc1
  s_mov_b64 exec, -1
  ds_write_b32 v14, v13 offset:16
  s_add_u32 s32, s32, 1
  s_and_b32 s6, s32, 7
  s_cbranch_scc1 L_c_conv2
L_c_conv3:
  s_add_u32 s33, s32, 1
  s_and_b32 s6, s32, 7
  s_lshl_b32 s7, s6, 10
  s_add_u32 s7, s7, s35
  v_add_u32 v9, s7, v10
  s_lshl_b32 s6, s6, 1
  s_lshl_b32 s42, 0x30003, s6
  v_mov_b32 v13, s33
  ds_read_b128 v[48:51], v4 offset:2048
  ds_read_b128 v[52:55], v4 offset:6656
  ds_read_b128 v[56:59], v4 offset:11264
  ds_read_b128 v[60:63], v4 offset:15872
  ds_read_b128 v[64:67], v4 offset:20480
  ds_read_b128 v[68:71], v4 offset:25088
  ds_read_b128 v[72:75], v4 offset:29696
  ds_read_b128 v[76:79], v4 offset:34304
  s_mov_b32 s7, 0
L_lw_124:
  ds_read_b32 v88, v2 offset:0
  s_waitcnt lgkmcnt(0)
  v_cmp_gt_i32 vcc, s33, v88
  s_cbranch_vccz L_lwo_125
  s_add_u32 s7, s7, 1
  s_cmp_lt_u32 s7, 131072
  s_cbranch_scc1 L_lw_124
  s_mov_b32 s6, 42
  s_branch L_err
L_lwo_125:
  ds_read2_b32 v[112:113], v104 offset0:0 offset1:1
  ds_read2_b32 v[114:115], v104 offset0:2 offset1:3
  ds_read_b32 v116, v104 offset:16
  ds_read2_b32 v[118:119], v105 offset0:0 offset1:1
  ds_read2_b32 v[120:121], v105 offset0:2 offset1:3
  ds_read_b32 v122, v105 offset:16
  ds_read2_b32 v[124:125], v106 offset0:0 offset1:1
  ds_read2_b32 v[126:127], v106 offset0:2 offset1:3
  ds_read_b32 v128, v106 offset:16
  ds_read2_b32 v[130:131], v107 offset0:0 offset1:1
  ds_read2_b32 v[132:133], v107 offset0:2 offset1:3
  ds_read_b32 v134, v107 offset:16
  s_waitcnt lgkmcnt(9)
  v_alignbyte_b32 v16, v113, v112, v15
  v_alignbyte_b32 v17, v114, v113, v15
  v_alignbyte_b32 v18, v115, v114, v15
  v_alignbyte_b32 v19, v116, v115, v15
  ds_read2_b32 v[112:113], v108 offset0:0 offset1:1
  ds_read2_b32 v[114:115], v108 offset0:2 offset1:3
  ds_read_b32 v116, v108 offset:16
  s_waitcnt lgkmcnt(9)
  v_alignbyte_b32 v20, v119, v118, v15
  v_alignbyte_b32 v21, v120, v119, v15
  v_alignbyte_b32 v22, v121, v120, v15
  v_alignbyte_b32 v23, v122, v121, v15
  ds_read2_b32 v[118:119], v109 offset0:0 offset1:1
  ds_read2_b32 v[120:121], v109 offset0:2 offset1:3
  ds_read_b32 v122, v109 offset:16
  v_mfma_f32_16x16x32_bf16 a[12:15], v[16:19], v[48:51], a[12:15]
  s_waitcnt lgkmcnt(9)
  v_alignbyte_b32 v24, v125, v124, v15
  v_alignbyte_b32 v25, v126, v125, v15
  v_alignbyte_b32 v26, v127, v126, v15
  v_alignbyte_b32 v27, v128, v127, v15
  ds_read2_b32 v[124:125], v110 offset0:0 offset1:1
  ds_read2_b32 v[126:127], v110 offset0:2 offset1:3
  ds_read_b32 v128, v110 offset:16
  v_mfma_f32_16x16x32_bf16 a[44:47], v[20:23], v[52:55], a[44:47]
  s_waitcnt lgkmcnt(9)
  v_alignbyte_b32 v28, v131, v130, v15
  v_alignbyte_b32 v29, v132, v131, v15
  v_alignbyte_b32 v30, v133, v132, v15
  v_alignbyte_b32 v31, v134, v133, v15
  ds_read2_b32 v[130:131], v111 offset0:0 offset1:1
  ds_read2_b32 v[132:133], v111 offset0:2 offset1:3
  ds_read_b32 v134, v111 offset:16
  v_mfma_f32_16x16x32_bf16 a[76:79], v[24:27], v[56:59], a[76:79]
  s_waitcnt lgkmcnt(9)
  v_alignbyte_b32 v32, v113, v112, v15
  v_alignbyte_b32 v33, v114, v113, v15
  v_alignbyte_b32 v34, v115, v114, v15
  v_alignbyte_b32 v35, v116, v115, v15
  ds_read_b64 v[84:85], v8
  ds_read_b64 v[86:87], v9
  v_mfma_f32_16x16x32_bf16 a[108:111], v[28:31], v[60:63], a[108:111]
  s_waitcnt lgkmcnt(8)
  v_alignbyte_b32 v36, v119, v118, v15
  v_alignbyte_b32 v37, v120, v119, v15
  v_alignbyte_b32 v38, v121, v120, v15
  v_alignbyte_b32 v39, v122, v121, v15
  v_mfma_f32_16x16x32_bf16 a[140:143], v[32:35], v[64:67], a[140:143]
  s_waitcnt lgkmcnt(5)
  v_alignbyte_b32 v40, v125, v124, v15
  v_alignbyte_b32 v41, v126, v125, v15
  v_alignbyte_b32 v42, v127, v126, v15
  v_alignbyte_b32 v43, v128, v127, v15
  v_mfma_f32_16x16x32_bf16 a[172:175], v[36:39], v[68:71], a[172:175]
  s_waitcnt lgkmcnt(2)
  v_alignbyte_b32 v44, v131, v130, v15
  v_alignbyte_b32 v45, v132, v131, v15
  v_alignbyte_b32 v46, v133, v132, v15
  v_alignbyte_b32 v47, v134, v133, v15
  v_mfma_f32_16x16x32_bf16 a[204:207], v[40:43], v[72:75], a[204:207]
  s_nop 0
  v_mfma_f32_16x16x32_bf16 a[236:239], v[44:47], v[76:79], a[236:239]
  s_waitcnt lgkmcnt(0)
  ds_read_b128 v[48:51], v4 offset:1536
  ds_read_b128 v[52:55], v4 offset:6144
  ds_read_b128 v[56:59], v4 offset:10752
  ds_read_b128 v[60:63], v4 offset:15360
  ds_read_b128 v[64:67], v4 offset:19968
  ds_read_b128 v[68:71], v4 offset:24576
  ds_read_b128 v[72:75], v4 offset:29184
  ds_read_b128 v[76:79], v4 offset:33792
  s_mov_b32 exec_lo, s42
  s_mov_b32 exec_hi, s42
  ds_write_b128 v6, a[12:15] offset:0
  ds_write_b128 v6, a[44:47] offset:128
  ds_write_b128 v6, a[76:79] offset:256
  ds_write_b128 v6, a[108:111] offset:384
  ds_write_b128 v6, a[140:143] offset:512
  ds_write_b128 v6, a[172:175] offset:640
  ds_write_b128 v6, a[204:207] offset:768
  ds_write_b128 v6, a[236:239] offset:896
  s_mov_b64 exec, -1
  ds_read_b128 v[80:83], v7
  ds_write_b32 v14, v13 offset:8
  v_lshlrev_b32 v88, 16, v84
  v_and_b32 v89, 0xffff0000, v84
  v_lshlrev_b32 v90, 16, v85
  v_and_b32 v91, 0xffff0000, v85
  v_lshlrev_b32 v96, 16, v86
  v_and_b32 v97, 0xffff0000, v86
  v_lshlrev_b32 v98, 16, v87
  v_and_b32 v99, 0xffff0000, v87
  v_mul_f32 v92, v88, v12
  v_mul_f32 v93, v89, v12
  v_mul_f32 v94, v90, v12
  v_mul_f32 v95, v91, v12
  v_cvt_pk_bf16_f32 v84, v92, v93
  v_cvt_pk_bf16_f32 v85, v94, v95
  v_lshlrev_b32 v92, 16, v84
  v_and_b32 v93, 0xffff0000, v84
  v_lshlrev_b32 v94, 16, v85
  v_and_b32 v95, 0xffff0000, v85
  s_waitcnt lgkmcnt(1)
  v_fmac_f32 v80, v88, v11
  v_fmac_f32 v81, v89, v11
  v_fmac_f32 v82, v90, v11
  v_fmac_f32 v83, v91, v11
  v_cvt_pk_bf16_f32 v84, v80, v81
  v_cvt_pk_bf16_f32 v85, v82, v83
  v_lshlrev_b32 v80, 16, v84
  v_and_b32 v81, 0xffff0000, v84
  v_lshlrev_b32 v82, 16, v85
  v_and_b32 v83, 0xffff0000, v85
  v_add_f32 v80, v80, v92
  v_add_f32 v81, v81, v93
  v_add_f32 v82, v82, v94
  v_add_f32 v83, v83, v95
  v_cvt_pk_bf16_f32 v84, v80, v81
  v_cvt_pk_bf16_f32 v85, v82, v83
  v_lshlrev_b32 v80, 16, v84
  v_and_b32 v81, 0xffff0000, v84
  v_lshlrev_b32 v82, 16, v85
  v_and_b32 v83, 0xffff0000, v85
  v_add_f32 v80, v80, v96
  v_add_f32 v81, v81, v97
  v_add_f32 v82, v82, v98
  v_add_f32 v83, v83, v99
  v_cvt_pk_bf16_f32 v84, v80, v81
  v_cvt_pk_bf16_f32 v85, v82, v83
  buffer_store_dwordx2 v[84:85], v10, s[8:11], s40 offen sc1
  v_mfma_f32_16x16x32_bf16 a[16:19], v[16:19], v[48:51], a[16:19]
  ds_read_b128 v[48:51], v4 offset:1024
  v_mfma_f32_16x16x32_bf16 a[48:51], v[20:23], v[52:55], a[48:51]
  ds_read_b128 v[52:55], v4 offset:5632
  v_mfma_f32_16x16x32_bf16 a[80:83], v[24:27], v[56:59], a[80:83]
  ds_read_b128 v[56:59], v4 offset:10240
  v_mfma_f32_16x16x32_bf16 a[112:115], v[28:31], v[60:63], a[112:115]
  ds_read_b128 v[60:63], v4 offset:14848
  v_mfma_f32_16x16x32_bf16 a[144:147], v[32:35], v[64:67], a[144:147]
  ds_read_b128 v[64:67], v4 offset:19456
  v_mfma_f32_16x16x32_bf16 a[176:179], v[36:39], v[68:71], a[176:179]
  ds_read_b128 v[68:71], v4 offset:24064
  v_mfma_f32_16x16x32_bf16 a[208:211], v[40:43], v[72:75], a[208:211]
  ds_read_b128 v[72:75], v4 offset:28672
  v_mfma_f32_16x16x32_bf16 a[240:243], v[44:47], v[76:79], a[240:243]
  ds_read_b128 v[76:79], v4 offset:33280
  s_waitcnt lgkmcnt(7)
  v_mfma_f32_16x16x32_bf16 a[20:23], v[16:19], v[48:51], a[20:23]
  ds_read_b128 v[48:51], v4 offset:512
  s_waitcnt lgkmcnt(7)
  v_mfma_f32_16x16x32_bf16 a[52:55], v[20:23], v[52:55], a[52:55]
  ds_read_b128 v[52:55], v4 offset:5120
  s_waitcnt lgkmcnt(7)
  v_mfma_f32_16x16x32_bf16 a[84:87], v[24:27], v[56:59], a[84:87]
  ds_read_b128 v[56:59], v4 offset:9728
  s_waitcnt lgkmcnt(7)
  v_mfma_f32_16x16x32_bf16 a[116:119], v[28:31], v[60:63], a[116:119]
  ds_read_b128 v[60:63], v4 offset:14336
  s_waitcnt lgkmcnt(7)
  v_mfma_f32_16x16x32_bf16 a[148:151], v[32:35], v[64:67], a[148:151]
  ds_read_b128 v[64:67], v4 offset:18944
  s_waitcnt lgkmcnt(7)
  v_mfma_f32_16x16x32_bf16 a[180:183], v[36:39], v[68:71], a[180:183]
  ds_read_b128 v[68:71], v4 offset:23552
  s_waitcnt lgkmcnt(7)
  v_mfma_f32_16x16x32_bf16 a[212:215], v[40:43], v[72:75], a[212:215]
  ds_read_b128 v[72:75], v4 offset:28160
  s_waitcnt lgkmcnt(7)
  v_mfma_f32_16x16x32_bf16 a[244:247], v[44:47], v[76:79], a[244:247]
  ds_read_b128 v[76:79], v4 offset:32768
  s_waitcnt lgkmcnt(7)
  v_mfma_f32_16x16x32_bf16 a[24:27], v[16:19], v[48:51], a[24:27]
  ds_read_b128 v[48:51], v4 offset:0
  s_waitcnt lgkmcnt(7)
  v_mfma_f32_16x16x32_bf16 a[56:59], v[20:23], v[52:55], a[56:59]
  ds_read_b128 v[52:55], v4 offset:4608
  s_waitcnt lgkmcnt(7)
  v_mfma_f32_16x16x32_bf16 a[88:91], v[24:27], v[56:59], a[88:91]
  ds_read_b128 v[56:59], v4 offset:9216
  s_waitcnt lgkmcnt(7)
  v_mfma_f32_16x16x32_bf16 a[120:123], v[28:31], v[60:63], a[120:123]
  ds_read_b128 v[60:63], v4 offset:13824
  s_waitcnt lgkmcnt(7)
  v_mfma_f32_16x16x32_bf16 a[152:155], v[32:35], v[64:67], a[152:155]
  ds_read_b128 v[64:67], v4 offset:18432
  s_waitcnt lgkmcnt(7)
  v_mfma_f32_16x16x32_bf16 a[184:187], v[36:39], v[68:71], a[184:187]
  ds_read_b128 v[68:71], v4 offset:23040
  s_waitcnt lgkmcnt(7)
  v_mfma_f32_16x16x32_bf16 a[216:219], v[40:43], v[72:75], a[216:219]
  ds_read_b128 v[72:75], v4 offset:27648
  s_waitcnt lgkmcnt(7)
  v_mfma_f32_16x16x32_bf16 a[248:251], v[44:47], v[76:79], a[248:251]
  ds_read_b128 v[76:79], v4 offset:32256
  s_waitcnt lgkmcnt(7)
  v_mfma_f32_16x16x32_bf16 a[28:31], v[16:19], v[48:51], a[28:31]
  s_waitcnt lgkmcnt(6)
  v_mfma_f32_16x16x32_bf16 a[60:63], v[20:23], v[52:55], a[60:63]
  s_waitcnt lgkmcnt(5)
  v_mfma_f32_16x16x32_bf16 a[92:95], v[24:27], v[56:59], a[92:95]
  s_waitcnt lgkmcnt(4)
  v_mfma_f32_16x16x32_bf16 a[124:127], v[28:31], v[60:63], a[124:127]
  s_waitcnt lgkmcnt(3)
  v_mfma_f32_16x16x32_bf16 a[156:159], v[32:35], v[64:67], a[156:159]
  s_waitcnt lgkmcnt(2)
  v_mfma_f32_16x16x32_bf16 a[188:191], v[36:39], v[68:71], a[188:191]
  s_waitcnt lgkmcnt(1)
  v_mfma_f32_16x16x32_bf16 a[220:223], v[40:43], v[72:75], a[220:223]
  s_waitcnt lgkmcnt(0)
  v_mfma_f32_16x16x32_bf16 a[252:255], v[44:47], v[76:79], a[252:255]
  v_add_u32 v104, 64, v104
  v_add_u32 v105, 64, v105
  v_add_u32 v106, 64, v106
  v_add_u32 v107, 64, v107
  v_add_u32 v108, 64, v108
  v_add_u32 v109, 64, v109
  v_add_u32 v110, 64, v110
  v_add_u32 v111, 64, v111
  v_add_u32 v4, 64, v4
  v_add_u32 v8, 64, v8
  s_add_u32 s40, s40, 0x8000
  s_waitcnt vmcnt(0)
  s_mov_b64 exec, 1
  buffer_store_dword v13, v1, s[8:11], s39 offen sc1
  s_mov_b64 exec, -1
  ds_write_b32 v14, v13 offset:16
  s_add_u32 s32, s32, 1
  s_and_b32 s6, s32, 7
  s_cbranch_scc1 L_c_conv3
L_c_conv4:
  s_add_u32 s33, s32, 1
  s_and_b32 s6, s32, 7
  s_lshl_b32 s7, s6, 10
  s_add_u32 s7, s7, s35
  v_add_u32 v9, s7, v10
  s_lshl_b32 s6, s6, 1
  s_lshl_b32 s42, 0x30003, s6
  v_mov_b32 v13, s33
  ds_read_b128 v[48:51], v4 offset:1536
  ds_read_b128 v[52:55], v4 offset:6144
  ds_read_b128 v[56:59], v4 offset:10752
  ds_read_b128 v[60:63], v4 offset:15360
  ds_read_b128 v[64:67], v4 offset:19968
  ds_read_b128 v[68:71], v4 offset:24576
  ds_read_b128 v[72:75], v4 offset:29184
  ds_read_b128 v[76:79], v4 offset:33792
  s_mov_b32 s7, 0
L_lw_126:
  ds_read_b32 v88, v2 offset:0
  s_waitcnt lgkmcnt(0)
  v_cmp_gt_i32 vcc, s33, v88
  s_cbranch_vccz L_lwo_127
  s_add_u32 s7, s7, 1
  s_cmp_lt_u32 s7, 131072
  s_cbranch_scc1 L_lw_126
  s_mov_b32 s6, 42
  s_branch L_err
L_lwo_127:
  ds_read2_b32 v[112:113], v104 offset0:0 offset1:1
  ds_read2_b32 v[114:115], v104 offset0:2 offset1:3
  ds_read_b32 v116, v104 offset:16
  ds_read2_b32 v[118:119], v105 offset0:0 offset1:1
  ds_read2_b32 v[120:121], v105 offset0:2 offset1:3
  ds_read_b32 v122, v105 offset:16
  ds_read2_b32 v[124:125], v106 offset0:0 offset1:1
  ds_read2_b32 v[126:127], v106 offset0:2 offset1:3
  ds_read_b32 v128, v106 offset:16
  ds_read2_b32 v[130:131], v107 offset0:0 offset1:1
  ds_read2_b32 v[132:133], v107 offset0:2 offset1:3
  ds_read_b32 v134, v107 offset:16
  s_waitcnt lgkmcnt(9)
  v_alignbyte_b32 v16, v113, v112, v15
  v_alignbyte_b32 v17, v114, v113, v15
  v_alignbyte_b32 v18, v115, v114, v15
  v_alignbyte_b32 v19, v116, v115, v15
  ds_read2_b32 v[112:113], v108 offset0:0 offset1:1
  ds_read2_b32 v[114:115], v108 offset0:2 offset1:3
  ds_read_b32 v116, v108 offset:16
  s_waitcnt lgkmcnt(9)
  v_alignbyte_b32 v20, v119, v118, v15
  v_alignbyte_b32 v21, v120, v119, v15
  v_alignbyte_b32 v22, v121, v120, v15
  v_alignbyte_b32 v23, v122, v121, v15
  ds_read2_b32 v[118:119], v109 offset0:0 offset1:1
  ds_read2_b32 v[120:121], v109 offset0:2 offset1:3
  ds_read_b32 v122, v109 offset:16
  v_mfma_f32_16x16x32_bf16 a[16:19], v[16:19], v[48:51], a[16:19]
  s_waitcnt lgkmcnt(9)
  v_alignbyte_b32 v24, v125, v124, v15
  v_alignbyte_b32 v25, v126, v125, v15
  v_alignbyte_b32 v26, v127, v126, v15
  v_alignbyte_b32 v27, v128, v127, v15
  ds_read2_b32 v[124:125], v110 offset0:0 offset1:1
  ds_read2_b32 v[126:127], v110 offset0:2 offset1:3
  ds_read_b32 v128, v110 offset:16
  v_mfma_f32_16x16x32_bf16 a[48:51], v[20:23], v[52:55], a[48:51]
  s_waitcnt lgkmcnt(9)
  v_alignbyte_b32 v28, v131, v130, v15
  v_alignbyte_b32 v29, v132, v131, v15
  v_alignbyte_b32 v30, v133, v132, v15
  v_alignbyte_b32 v31, v134, v133, v15
  ds_read2_b32 v[130:131], v111 offset0:0 offset1:1
  ds_read2_b32 v[132:133], v111 offset0:2 offset1:3
  ds_read_b32 v134, v111 offset:16
  v_mfma_f32_16x16x32_bf16 a[80:83], v[24:27], v[56:59], a[80:83]
  s_waitcnt lgkmcnt(9)
  v_alignbyte_b32 v32, v113, v112, v15
  v_alignbyte_b32 v33, v114, v113, v15
  v_alignbyte_b32 v34, v115, v114, v15
  v_alignbyte_b32 v35, v116, v115, v15
  ds_read_b64 v[84:85], v8
  ds_read_b64 v[86:87], v9
  v_mfma_f32_16x16x32_bf16 a[112:115], v[28:31], v[60:63], a[112:115]
  s_waitcnt lgkmcnt(8)
  v_alignbyte_b32 v36, v119, v118, v15
  v_alignbyte_b32 v37, v120, v119, v15
  v_alignbyte_b32 v38, v121, v120, v15
  v_alignbyte_b32 v39, v122, v121, v15
  v_mfma_f32_16x16x32_bf16 a[144:147], v[32:35], v[64:67], a[144:147]
  s_waitcnt lgkmcnt(5)
  v_alignbyte_b32 v40, v125, v124, v15
  v_alignbyte_b32 v41, v126, v125, v15
  v_alignbyte_b32 v42, v127, v126, v15
  v_alignbyte_b32 v43, v128, v127, v15
  v_mfma_f32_16x16x32_bf16 a[176:179], v[36:39], v[68:71], a[176:179]
  s_waitcnt lgkmcnt(2)
  v_alignbyte_b32 v44, v131, v130, v15
  v_alignbyte_b32 v45, v132, v131, v15
  v_alignbyte_b32 v46, v133, v132, v15
  v_alignbyte_b32 v47, v134, v133, v15
  v_mfma_f32_16x16x32_bf16 a[208:211], v[40:43], v[72:75], a[208:211]
  s_nop 0
  v_mfma_f32_16x16x32_bf16 a[240:243], v[44:47], v[76:79], a[240:243]
  s_waitcnt lgkmcnt(0)
  ds_read_b128 v[48:51], v4 offset:1024
  ds_read_b128 v[52:55], v4 offset:5632
  ds_read_b128 v[56:59], v4 offset:10240
  ds_read_b128 v[60:63], v4 offset:14848
  ds_read_b128 v[64:67], v4 offset:19456
  ds_read_b128 v[68:71], v4 offset:24064
  ds_read_b128 v[72:75], v4 offset:28672
  ds_read_b128 v[76:79], v4 offset:33280
  s_mov_b32 exec_lo, s42
  s_mov_b32 exec_hi, s42
  ds_write_b128 v6, a[16:19] offset:0
  ds_write_b128 v6, a[48:51] offset:128
  ds_write_b128 v6, a[80:83] offset:256
  ds_write_b128 v6, a[112:115] offset:384
  ds_write_b128 v6, a[144:147] offset:512
  ds_write_b128 v6, a[176:179] offset:640
  ds_write_b128 v6, a[208:211] offset:768
  ds_write_b128 v6, a[240:243] offset:896
  s_mov_b64 exec, -1
  ds_read_b128 v[80:83], v7
  ds_write_b32 v14, v13 offset:8
  v_lshlrev_b32 v88, 16, v84
  v_and_b32 v89, 0xffff0000, v84
  v_lshlrev_b32 v90, 16, v85
  v_and_b32 v91, 0xffff0000, v85
  v_lshlrev_b32 v96, 16, v86
  v_and_b32 v97, 0xffff0000, v86
  v_lshlrev_b32 v98, 16, v87
  v_and_b32 v99, 0xffff0000, v87
  v_mul_f32 v92, v88, v12
  v_mul_f32 v93, v89, v12
  v_mul_f32 v94, v90, v12
  v_mul_f32 v95, v91, v12
  v_cvt_pk_bf16_f32 v84, v92, v93
  v_cvt_pk_bf16_f32 v85, v94, v95
  v_lshlrev_b32 v92, 16, v84
  v_and_b32 v93, 0xffff0000, v84
  v_lshlrev_b32 v94, 16, v85
  v_and_b32 v95, 0xffff0000, v85
  s_waitcnt lgkmcnt(1)
  v_fmac_f32 v80, v88, v11
  v_fmac_f32 v81, v89, v11
  v_fmac_f32 v82, v90, v11
  v_fmac_f32 v83, v91, v11
  v_cvt_pk_bf16_f32 v84, v80, v81
  v_cvt_pk_bf16_f32 v85, v82, v83
  v_lshlrev_b32 v80, 16, v84
  v_and_b32 v81, 0xffff0000, v84
  v_lshlrev_b32 v82, 16, v85
  v_and_b32 v83, 0xffff0000, v85
  v_add_f32 v80, v80, v92
  v_add_f32 v81, v81, v93
  v_add_f32 v82, v82, v94
  v_add_f32 v83, v83, v95
  v_cvt_pk_bf16_f32 v84, v80, v81
  v_cvt_pk_bf16_f32 v85, v82, v83
  v_lshlrev_b32 v80, 16, v84
  v_and_b32 v81, 0xffff0000, v84
  v_lshlrev_b32 v82, 16, v85
  v_and_b32 v83, 0xffff0000, v85
  v_add_f32 v80, v80, v96
  v_add_f32 v81, v81, v97
  v_add_f32 v82, v82, v98
  v_add_f32 v83, v83, v99
  v_cvt_pk_bf16_f32 v84, v80, v81
  v_cvt_pk_bf16_f32 v85, v82, v83
  buffer_store_dwordx2 v[84:85], v10, s[8:11], s40 offen sc1
  v_mfma_f32_16x16x32_bf16 a[20:23], v[16:19], v[48:51], a[20:23]
  ds_read_b128 v[48:51], v4 offset:512
  v_mfma_f32_16x16x32_bf16 a[52:55], v[20:23], v[52:55], a[52:55]
  ds_read_b128 v[52:55], v4 offset:5120
  v_mfma_f32_16x16x32_bf16 a[84:87], v[24:27], v[56:59], a[84:87]
  ds_read_b128 v[56:59], v4 offset:9728
  v_mfma_f32_16x16x32_bf16 a[116:119], v[28:31], v[60:63], a[116:119]
  ds_read_b128 v[60:63], v4 offset:14336
  v_mfma_f32_16x16x32_bf16 a[148:151], v[32:35], v[64:67], a[148:151]
  ds_read_b128 v[64:67], v4 offset:18944
  v_mfma_f32_16x16x32_bf16 a[180:183], v[36:39], v[68:71], a[180:183]
  ds_read_b128 v[68:71], v4 offset:23552
  v_mfma_f32_16x16x32_bf16 a[212:215], v[40:43], v[72:75], a[212:215]
  ds_read_b128 v[72:75], v4 offset:28160
  v_mfma_f32_16x16x32_bf16 a[244:247], v[44:47], v[76:79], a[244:247]
  ds_read_b128 v[76:79], v4 offset:32768
  s_waitcnt lgkmcnt(7)
  v_mfma_f32_16x16x32_bf16 a[24:27], v[16:19], v[48:51], a[24:27]
  ds_read_b128 v[48:51], v4 offset:0
  s_waitcnt lgkmcnt(7)
  v_mfma_f32_16x16x32_bf16 a[56:59], v[20:23], v[52:55], a[56:59]
  ds_read_b128 v[52:55], v4 offset:4608
  s_waitcnt lgkmcnt(7)
  v_mfma_f32_16x16x32_bf16 a[88:91], v[24:27], v[56:59], a[88:91]
  ds_read_b128 v[56:59], v4 offset:9216
  s_waitcnt lgkmcnt(7)
  v_mfma_f32_16x16x32_bf16 a[120:123], v[28:31], v[60:63], a[120:123]
  ds_read_b128 v[60:63], v4 offset:13824
  s_waitcnt lgkmcnt(7)
  v_mfma_f32_16x16x32_bf16 a[152:155], v[32:35], v[64:67], a[152:155]
  ds_read_b128 v[64:67], v4 offset:18432
  s_waitcnt lgkmcnt(7)
  v_mfma_f32_16x16x32_bf16 a[184:187], v[36:39], v[68:71], a[184:187]
  ds_read_b128 v[68:71], v4 offset:23040
  s_waitcnt lgkmcnt(7)
  v_mfma_f32_16x16x32_bf16 a[216:219], v[40:43], v[72:75], a[216:219]
  ds_read_b128 v[72:75], v4 offset:27648
  s_waitcnt lgkmcnt(7)
  v_mfma_f32_16x16x32_bf16 a[248:251], v[44:47], v[76:79], a[248:251]
  ds_read_b128 v[76:79], v4 offset:32256
  s_waitcnt lgkmcnt(7)
  v_mfma_f32_16x16x32_bf16 a[28:31], v[16:19], v[48:51], a[28:31]
  s_waitcnt lgkmcnt(6)
  v_mfma_f32_16x16x32_bf16 a[60:63], v[20:23], v[52:55], a[60:63]
  s_waitcnt lgkmcnt(5)
  v_mfma_f32_16x16x32_bf16 a[92:95], v[24:27], v[56:59], a[92:95]
  s_waitcnt lgkmcnt(4)
  v_mfma_f32_16x16x32_bf16 a[124:127], v[28:31], v[60:63], a[124:127]
  s_waitcnt lgkmcnt(3)
  v_mfma_f32_16x16x32_bf16 a[156:159], v[32:35], v[64:67], a[156:159]
  s_waitcnt lgkmcnt(2)
  v_mfma_f32_16x16x32_bf16 a[188:191], v[36:39], v[68:71], a[188:191]
  s_waitcnt lgkmcnt(1)
  v_mfma_f32_16x16x32_bf16 a[220:223], v[40:43], v[72:75], a[220:223]
  s_waitcnt lgkmcnt(0)
  v_mfma_f32_16x16x32_bf16 a[252:255], v[44:47], v[76:79], a[252:255]
  v_add_u32 v104, 64, v104
  v_add_u32 v105, 64, v105
  v_add_u32 v106, 64, v106
  v_add_u32 v107, 64, v107
  v_add_u32 v108, 64, v108
  v_add_u32 v109, 64, v109
  v_add_u32 v110, 64, v110
  v_add_u32 v111, 64, v111
  v_add_u32 v4, 64, v4
  v_add_u32 v8, 64, v8
  s_add_u32 s40, s40, 0x8000
  s_waitcnt vmcnt(0)
  s_mov_b64 exec, 1
  buffer_store_dword v13, v1, s[8:11], s39 offen sc1
  s_mov_b64 exec, -1
  ds_write_b32 v14, v13 offset:16
  s_add_u32 s32, s32, 1
  s_and_b32 s6, s32, 7
  s_cbranch_scc1 L_c_conv4
L_c_conv5:
  s_add_u32 s33, s32, 1
  s_and_b32 s6, s32, 7
  s_lshl_b32 s7, s6, 10
  s_add_u32 s7, s7, s35
  v_add_u32 v9, s7, v10
  s_lshl_b32 s6, s6, 1
  s_lshl_b32 s42, 0x30003, s6
  v_mov_b32 v13, s33
  ds_read_b128 v[48:51], v4 offset:1024
  ds_read_b128 v[52:55], v4 offset:5632
  ds_read_b128 v[56:59], v4 offset:10240
  ds_read_b128 v[60:63], v4 offset:14848
  ds_read_b128 v[64:67], v4 offset:19456
  ds_read_b128 v[68:71], v4 offset:24064
  ds_read_b128 v[72:75], v4 offset:28672
  ds_read_b128 v[76:79], v4 offset:33280
  s_mov_b32 s7, 0
L_lw_128:
  ds_read_b32 v88, v2 offset:0
  s_waitcnt lgkmcnt(0)
  v_cmp_gt_i32 vcc, s33, v88
  s_cbranch_vccz L_lwo_129
  s_add_u32 s7, s7, 1
  s_cmp_lt_u32 s7, 131072
  s_cbranch_scc1 L_lw_128
  s_mov_b32 s6, 42
  s_branch L_err
L_lwo_129:
  ds_read2_b32 v[112:113], v104 offset0:0 offset1:1
  ds_read2_b32 v[114:115], v104 offset0:2 offset1:3
  ds_read_b32 v116, v104 offset:16
  ds_read2_b32 v[118:119], v105 offset0:0 offset1:1
  ds_read2_b32 v[120:121], v105 offset0:2 offset1:3
  ds_read_b32 v122, v105 offset:16
  ds_read2_b32 v[124:125], v106 offset0:0 offset1:1
  ds_read2_b32 v[126:127], v106 offset0:2 offset1:3
  ds_read_b32 v128, v106 offset:16
  ds_read2_b32 v[130:131], v107 offset0:0 offset1:1
  ds_read2_b32 v[132:133], v107 offset0:2 offset1:3
  ds_read_b32 v134, v107 offset:16
  s_waitcnt lgkmcnt(9)
  v_alignbyte_b32 v16, v113, v112, v15
  v_alignbyte_b32 v17, v114, v113, v15
  v_alignbyte_b32 v18, v115, v114, v15
  v_alignbyte_b32 v19, v116, v115, v15
  ds_read2_b32 v[112:113], v108 offset0:0 offset1:1
  ds_read2_b32 v[114:115], v108 offset0:2 offset1:3
  ds_read_b32 v116, v108 offset:16
  s_waitcnt lgkmcnt(9)
  v_alignbyte_b32 v20, v119, v118, v15
  v_alignbyte_b32 v21, v120, v119, v15
  v_alignbyte_b32 v22, v121, v120, v15
  v_alignbyte_b32 v23, v122, v121, v15
  ds_read2_b32 v[118:119], v109 offset0:0 offset1:1
  ds_read2_b32 v[120:121], v109 offset0:2 offset1:3
  ds_read_b32 v122, v109 offset:16
  v_mfma_f32_16x16x32_bf16 a[20:23], v[16:19], v[48:51], a[20:23]
  s_waitcnt lgkmcnt(9)
  v_alignbyte_b32 v24, v125, v124, v15
  v_alignbyte_b32 v25, v126, v125, v15
  v_alignbyte_b32 v26, v127, v126, v15
  v_alignbyte_b32 v27, v128, v127, v15
  ds_read2_b32 v[124:125], v110 offset0:0 offset1:1
  ds_read2_b32 v[126:127], v110 offset0:2 offset1:3
  ds_read_b32 v128, v110 offset:16
  v_mfma_f32_16x16x32_bf16 a[52:55], v[20:23], v[52:55], a[52:55]
  s_waitcnt lgkmcnt(9)
  v_alignbyte_b32 v28, v131, v130, v15
  v_alignbyte_b32 v29, v132, v131, v15
  v_alignbyte_b32 v30, v133, v132, v15
  v_alignbyte_b32 v31, v134, v133, v15
  ds_read2_b32 v[130:131], v111 offset0:0 offset1:1
  ds_read2_b32 v[132:133], v111 offset0:2 offset1:3
  ds_read_b32 v134, v111 offset:16
  v_mfma_f32_16x16x32_bf16 a[84:87], v[24:27], v[56:59], a[84:87]
  s_waitcnt lgkmcnt(9)
  v_alignbyte_b32 v32, v113, v112, v15
  v_alignbyte_b32 v33, v114, v113, v15
  v_alignbyte_b32 v34, v115, v114, v15
  v_alignbyte_b32 v35, v116, v115, v15
  ds_read_b64 v[84:85], v8
  ds_read_b64 v[86:87], v9
  v_mfma_f32_16x16x32_bf16 a[116:119], v[28:31], v[60:63], a[116:119]
  s_waitcnt lgkmcnt(8)
  v_alignbyte_b32 v36, v119, v118, v15
  v_alignbyte_b32 v37, v120, v119, v15
  v_alignbyte_b32 v38, v121, v120, v15
  v_alignbyte_b32 v39, v122, v121, v15
  v_mfma_f32_16x16x32_bf16 a[148:151], v[32:35], v[64:67], a[148:151]
  s_waitcnt lgkmcnt(5)
  v_alignbyte_b32 v40, v125, v124, v15
  v_alignbyte_b32 v41, v126, v125, v15
  v_alignbyte_b32 v42, v127, v126, v15
  v_alignbyte_b32 v43, v128, v127, v15
  v_mfma_f32_16x16x32_bf16 a[180:183], v[36:39], v[68:71], a[180:183]
  s_waitcnt lgkmcnt(2)
  v_alignbyte_b32 v44, v131, v130, v15
  v_alignbyte_b32 v45, v132, v131, v15
  v_alignbyte_b32 v46, v133, v132, v15
  v_alignbyte_b32 v47, v134, v133, v15
  v_mfma_f32_16x16x32_bf16 a[212:215], v[40:43], v[72:75], a[212:215]
  s_nop 0
  v_mfma_f32_16x16x32_bf16 a[244:247], v[44:47], v[76:79], a[244:247]
  s_waitcnt lgkmcnt(0)
  ds_read_b128 v[48:51], v4 offset:512
  ds_read_b128 v[52:55], v4 offset:5120
  ds_read_b128 v[56:59], v4 offset:9728
  ds_read_b128 v[60:63], v4 offset:14336
  ds_read_b128 v[64:67], v4 offset:18944
  ds_read_b128 v[68:71], v4 offset:23552
  ds_read_b128 v[72:75], v4 offset:28160
  ds_read_b128 v[76:79], v4 offset:32768
  s_mov_b32 exec_lo, s42
  s_mov_b32 exec_hi, s42
  ds_write_b128 v6, a[20:23] offset:0
  ds_write_b128 v6, a[52:55] offset:128
  ds_write_b128 v6, a[84:87] offset:256
  ds_write_b128 v6, a[116:119] offset:384
  ds_write_b128 v6, a[148:151] offset:512
  ds_write_b128 v6, a[180:183] offset:640
  ds_write_b128 v6, a[212:215] offset:768
  ds_write_b128 v6, a[244:247] offset:896
  s_mov_b64 exec, -1
  ds_read_b128 v[80:83], v7
  ds_write_b32 v14, v13 offset:8
  v_lshlrev_b32 v88, 16, v84
  v_and_b32 v89, 0xffff0000, v84
  v_lshlrev_b32 v90, 16, v85
  v_and_b32 v91, 0xffff0000, v85
  v_lshlrev_b32 v96, 16, v86
  v_and_b32 v97, 0xffff0000, v86
  v_lshlrev_b32 v98, 16, v87
  v_and_b32 v99, 0xffff0000, v87
  v_mul_f32 v92, v88, v12
  v_mul_f32 v93, v89, v12
  v_mul_f32 v94, v90, v12
  v_mul_f32 v95, v91, v12
  v_cvt_pk_bf16_f32 v84, v92, v93
  v_cvt_pk_bf16_f32 v85, v94, v95
  v_lshlrev_b32 v92, 16, v84
  v_and_b32 v93, 0xffff0000, v84
  v_lshlrev_b32 v94, 16, v85
  v_and_b32 v95, 0xffff0000, v85
  s_waitcnt lgkmcnt(1)
  v_fmac_f32 v80, v88, v11
  v_fmac_f32 v81, v89, v11
  v_fmac_f32 v82, v90, v11
  v_fmac_f32 v83, v91, v11
  v_cvt_pk_bf16_f32 v84, v80, v81
  v_cvt_pk_bf16_f32 v85, v82, v83
  v_lshlrev_b32 v80, 16, v84
  v_and_b32 v81, 0xffff0000, v84
  v_lshlrev_b32 v82, 16, v85
  v_and_b32 v83, 0xffff0000, v85
  v_add_f32 v80, v80, v92
  v_add_f32 v81, v81, v93
  v_add_f32 v82, v82, v94
  v_add_f32 v83, v83, v95
  v_cvt_pk_bf16_f32 v84, v80, v81
  v_cvt_pk_bf16_f32 v85, v82, v83
  v_lshlrev_b32 v80, 16, v84
  v_and_b32 v81, 0xffff0000, v84
  v_lshlrev_b32 v82, 16, v85
  v_and_b32 v83, 0xffff0000, v85
  v_add_f32 v80, v80, v96
  v_add_f32 v81, v81, v97
  v_add_f32 v82, v82, v98
  v_add_f32 v83, v83, v99
  v_cvt_pk_bf16_f32 v84, v80, v81
  v_cvt_pk_bf16_f32 v85, v82, v83
  buffer_store_dwordx2 v[84:85], v10, s[8:11], s40 offen sc1
  v_mfma_f32_16x16x32_bf16 a[24:27], v[16:19], v[48:51], a[24:27]
  ds_read_b128 v[48:51], v4 offset:0
  v_mfma_f32_16x16x32_bf16 a[56:59], v[20:23], v[52:55], a[56:59]
  ds_read_b128 v[52:55], v4 offset:4608
  v_mfma_f32_16x16x32_bf16 a[88:91], v[24:27], v[56:59], a[88:91]
  ds_read_b128 v[56:59], v4 offset:9216
  v_mfma_f32_16x16x32_bf16 a[120:123], v[28:31], v[60:63], a[120:123]
  ds_read_b128 v[60:63], v4 offset:13824
  v_mfma_f32_16x16x32_bf16 a[152:155], v[32:35], v[64:67], a[152:155]
  ds_read_b128 v[64:67], v4 offset:18432
  v_mfma_f32_16x16x32_bf16 a[184:187], v[36:39], v[68:71], a[184:187]
  ds_read_b128 v[68:71], v4 offset:23040
  v_mfma_f32_16x16x32_bf16 a[216:219], v[40:43], v[72:75], a[216:219]
  ds_read_b128 v[72:75], v4 offset:27648
  v_mfma_f32_16x16x32_bf16 a[248:251], v[44:47], v[76:79], a[248:251]
  ds_read_b128 v[76:79], v4 offset:32256
  s_waitcnt lgkmcnt(7)
  v_mfma_f32_16x16x32_bf16 a[28:31], v[16:19], v[48:51], a[28:31]
  s_waitcnt lgkmcnt(6)
  v_mfma_f32_16x16x32_bf16 a[60:63], v[20:23], v[52:55], a[60:63]
  s_waitcnt lgkmcnt(5)
  v_mfma_f32_16x16x32_bf16 a[92:95], v[24:27], v[56:59], a[92:95]
  s_waitcnt lgkmcnt(4)
  v_mfma_f32_16x16x32_bf16 a[124:127], v[28:31], v[60:63], a[124:127]
  s_waitcnt lgkmcnt(3)
  v_mfma_f32_16x16x32_bf16 a[156:159], v[32:35], v[64:67], a[156:159]
  s_waitcnt lgkmcnt(2)
  v_mfma_f32_16x16x32_bf16 a[188:191], v[36:39], v[68:71], a[188:191]
  s_waitcnt lgkmcnt(1)
  v_mfma_f32_16x16x32_bf16 a[220:223], v[40:43], v[72:75], a[220:223]
  s_waitcnt lgkmcnt(0)
  v_mfma_f32_16x16x32_bf16 a[252:255], v[44:47], v[76:79], a[252:255]
  v_add_u32 v104, 64, v104
  v_add_u32 v105, 64, v105
  v_add_u32 v106, 64, v106
  v_add_u32 v107, 64, v107
  v_add_u32 v108, 64, v108
  v_add_u32 v109, 64, v109
  v_add_u32 v110, 64, v110
  v_add_u32 v111, 64, v111
  v_add_u32 v4, 64, v4
  v_add_u32 v8, 64, v8
  s_add_u32 s40, s40, 0x8000
  s_waitcnt vmcnt(0)
  s_mov_b64 exec, 1
  buffer_store_dword v13, v1, s[8:11], s39 offen sc1
  s_mov_b64 exec, -1
  ds_write_b32 v14, v13 offset:16
  s_add_u32 s32, s32, 1
  s_and_b32 s6, s32, 7
  s_cbranch_scc1 L_c_conv5
L_c_conv6:
  s_add_u32 s33, s32, 1
  s_and_b32 s6, s32, 7
  s_lshl_b32 s7, s6, 10
  s_add_u32 s7, s7, s35
  v_add_u32 v9, s7, v10
  s_lshl_b32 s6, s6, 1
  s_lshl_b32 s42, 0x30003, s6
  v_mov_b32 v13, s33
  ds_read_b128 v[48:51], v4 offset:512
  ds_read_b128 v[52:55], v4 offset:5120
  ds_read_b128 v[56:59], v4 offset:9728
  ds_read_b128 v[60:63], v4 offset:14336
  ds_read_b128 v[64:67], v4 offset:18944
  ds_read_b128 v[68:71], v4 offset:23552
  ds_read_b128 v[72:75], v4 offset:28160
  ds_read_b128 v[76:79], v4 offset:32768
  s_mov_b32 s7, 0
L_lw_130:
  ds_read_b32 v88, v2 offset:0
  s_waitcnt lgkmcnt(0)
  v_cmp_gt_i32 vcc, s33, v88
  s_cbranch_vccz L_lwo_131
  s_add_u32 s7, s7, 1
  s_cmp_lt_u32 s7, 131072
  s_cbranch_scc1 L_lw_130
  s_mov_b32 s6, 42
  s_branch L_err
L_lwo_131:
  ds_read2_b32 v[112:113], v104 offset0:0 offset1:1
  ds_read2_b32 v[114:115], v104 offset0:2 offset1:3
  ds_read_b32 v116, v104 offset:16
  ds_read2_b32 v[118:119], v105 offset0:0 offset1:1
  ds_read2_b32 v[120:121], v105 offset0:2 offset1:3
  ds_read_b32 v122, v105 offset:16
  ds_read2_b32 v[124:125], v106 offset0:0 offset1:1
  ds_read2_b32 v[126:127], v106 offset0:2 offset1:3
  ds_read_b32 v128, v106 offset:16
  ds_read2_b32 v[130:131], v107 offset0:0 offset1:1
  ds_read2_b32 v[132:133], v107 offset0:2 offset1:3
  ds_read_b32 v134, v107 offset:16
  s_waitcnt lgkmcnt(9)
  v_alignbyte_b32 v16, v113, v112, v15
  v_alignbyte_b32 v17, v114, v113, v15
  v_alignbyte_b32 v18, v115, v114, v15
  v_alignbyte_b32 v19, v116, v115, v15
  ds_read2_b32 v[112:113], v108 offset0:0 offset1:1
  ds_read2_b32 v[114:115], v108 offset0:2 offset1:3
  ds_read_b32 v116, v108 offset:16
  s_waitcnt lgkmcnt(9)
  v_alignbyte_b32 v20, v119, v118, v15
  v_alignbyte_b32 v21, v120, v119, v15
  v_alignbyte_b32 v22, v121, v120, v15
  v_alignbyte_b32 v23, v122, v121, v15
  ds_read2_b32 v[118:119], v109 offset0:0 offset1:1
  ds_read2_b32 v[120:121], v109 offset0:2 offset1:3
  ds_read_b32 v122, v109 offset:16
  v_mfma_f32_16x16x32_bf16 a[24:27], v[16:19], v[48:51], a[24:27]
  s_waitcnt lgkmcnt(9)
  v_alignbyte_b32 v24, v125, v124, v15
  v_alignbyte_b32 v25, v126, v125, v15
  v_alignbyte_b32 v26, v127, v126, v15
  v_alignbyte_b32 v27, v128, v127, v15
  ds_read2_b32 v[124:125], v110 offset0:0 offset1:1
  ds_read2_b32 v[126:127], v110 offset0:2 offset1:3
  ds_read_b32 v128, v110 offset:16
  v_mfma_f32_16x16x32_bf16 a[56:59], v[20:23], v[52:55], a[56:59]
  s_waitcnt lgkmcnt(9)
  v_alignbyte_b32 v28, v131, v130, v15
  v_alignbyte_b32 v29, v132, v131, v15
  v_alignbyte_b32 v30, v133, v132, v15
  v_alignbyte_b32 v31, v134, v133, v15
  ds_read2_b32 v[130:131], v111 offset0:0 offset1:1
  ds_read2_b32 v[132:133], v111 offset0:2 offset1:3
  ds_read_b32 v134, v111 offset:16
  v_mfma_f32_16x16x32_bf16 a[88:91], v[24:27], v[56:59], a[88:91]
  s_waitcnt lgkmcnt(9)
  v_alignbyte_b32 v32, v113, v112, v15
  v_alignbyte_b32 v33, v114, v113, v15
  v_alignbyte_b32 v34, v115, v114, v15
  v_alignbyte_b32 v35, v116, v115, v15
  ds_read_b64 v[84:85], v8
  ds_read_b64 v[86:87], v9
  v_mfma_f32_16x16x32_bf16 a[120:123], v[28:31], v[60:63], a[120:123]
  s_waitcnt lgkmcnt(8)
  v_alignbyte_b32 v36, v119, v118, v15
  v_alignbyte_b32 v37, v120, v119, v15
  v_alignbyte_b32 v38, v121, v120, v15
  v_alignbyte_b32 v39, v122, v121, v15
  v_mfma_f32_16x16x32_bf16 a[152:155], v[32:35], v[64:67], a[152:155]
  s_waitcnt lgkmcnt(5)
  v_alignbyte_b32 v40, v125, v124, v15
  v_alignbyte_b32 v41, v126, v125, v15
  v_alignbyte_b32 v42, v127, v126, v15
  v_alignbyte_b32 v43, v128, v127, v15
  v_mfma_f32_16x16x32_bf16 a[184:187], v[36:39], v[68:71], a[184:187]
  s_waitcnt lgkmcnt(2)
  v_alignbyte_b32 v44, v131, v130, v15
  v_alignbyte_b32 v45, v132, v131, v15
  v_alignbyte_b32 v46, v133, v132, v15
  v_alignbyte_b32 v47, v134, v133, v15
  v_mfma_f32_16x16x32_bf16 a[216:219], v[40:43], v[72:75], a[216:219]
  s_nop 0
  v_mfma_f32_16x16x32_bf16 a[248:251], v[44:47], v[76:79], a[248:251]
  s_waitcnt lgkmcnt(0)
  ds_read_b128 v[48:51], v4 offset:0
  ds_read_b128 v[52:55], v4 offset:4608
  ds_read_b128 v[56:59], v4 offset:9216
  ds_read_b128 v[60:63], v4 offset:13824
  ds_read_b128 v[64:67], v4 offset:18432
  ds_read_b128 v[68:71], v4 offset:23040
  ds_read_b128 v[72:75], v4 offset:27648
  ds_read_b128 v[76:79], v4 offset:32256
  s_mov_b32 exec_lo, s42
  s_mov_b32 exec_hi, s42
  ds_write_b128 v6, a[24:27] offset:0
  ds_write_b128 v6, a[56:59] offset:128
  ds_write_b128 v6, a[88:91] offset:256
  ds_write_b128 v6, a[120:123] offset:384
  ds_write_b128 v6, a[152:155] offset:512
  ds_write_b128 v6, a[184:187] offset:640
  ds_write_b128 v6, a[216:219] offset:768
  ds_write_b128 v6, a[248:251] offset:896
  s_mov_b64 exec, -1
  ds_read_b128 v[80:83], v7
  ds_write_b32 v14, v13 offset:8
  v_lshlrev_b32 v88, 16, v84
  v_and_b32 v89, 0xffff0000, v84
  v_lshlrev_b32 v90, 16, v85
  v_and_b32 v91, 0xffff0000, v85
  v_lshlrev_b32 v96, 16, v86
  v_and_b32 v97, 0xffff0000, v86
  v_lshlrev_b32 v98, 16, v87
  v_and_b32 v99, 0xffff0000, v87
  v_mul_f32 v92, v88, v12
  v_mul_f32 v93, v89, v12
  v_mul_f32 v94, v90, v12
  v_mul_f32 v95, v91, v12
  v_cvt_pk_bf16_f32 v84, v92, v93
  v_cvt_pk_bf16_f32 v85, v94, v95
  v_lshlrev_b32 v92, 16, v84
  v_and_b32 v93, 0xffff0000, v84
  v_lshlrev_b32 v94, 16, v85
  v_and_b32 v95, 0xffff0000, v85
  s_waitcnt lgkmcnt(1)
  v_fmac_f32 v80, v88, v11
  v_fmac_f32 v81, v89, v11
  v_fmac_f32 v82, v90, v11
  v_fmac_f32 v83, v91, v11
  v_cvt_pk_bf16_f32 v84, v80, v81
  v_cvt_pk_bf16_f32 v85, v82, v83
  v_lshlrev_b32 v80, 16, v84
  v_and_b32 v81, 0xffff0000, v84
  v_lshlrev_b32 v82, 16, v85
  v_and_b32 v83, 0xffff0000, v85
  v_add_f32 v80, v80, v92
  v_add_f32 v81, v81, v93
  v_add_f32 v82, v82, v94
  v_add_f32 v83, v83, v95
  v_cvt_pk_bf16_f32 v84, v80, v81
  v_cvt_pk_bf16_f32 v85, v82, v83
  v_lshlrev_b32 v80, 16, v84
  v_and_b32 v81, 0xffff0000, v84
  v_lshlrev_b32 v82, 16, v85
  v_and_b32 v83, 0xffff0000, v85
  v_add_f32 v80, v80, v96
  v_add_f32 v81, v81, v97
  v_add_f32 v82, v82, v98
  v_add_f32 v83, v83, v99
  v_cvt_pk_bf16_f32 v84, v80, v81
  v_cvt_pk_bf16_f32 v85, v82, v83
  buffer_store_dwordx2 v[84:85], v10, s[8:11], s40 offen sc1
  v_mfma_f32_16x16x32_bf16 a[28:31], v[16:19], v[48:51], a[28:31]
  v_mfma_f32_16x16x32_bf16 a[60:63], v[20:23], v[52:55], a[60:63]
  v_mfma_f32_16x16x32_bf16 a[92:95], v[24:27], v[56:59], a[92:95]
  v_mfma_f32_16x16x32_bf16 a[124:127], v[28:31], v[60:63], a[124:127]
  v_mfma_f32_16x16x32_bf16 a[156:159], v[32:35], v[64:67], a[156:159]
  v_mfma_f32_16x16x32_bf16 a[188:191], v[36:39], v[68:71], a[188:191]
  v_mfma_f32_16x16x32_bf16 a[220:223], v[40:43], v[72:75], a[220:223]
  v_mfma_f32_16x16x32_bf16 a[252:255], v[44:47], v[76:79], a[252:255]
  v_add_u32 v104, 64, v104
  v_add_u32 v105, 64, v105
  v_add_u32 v106, 64, v106
  v_add_u32 v107, 64, v107
  v_add_u32 v108, 64, v108
  v_add_u32 v109, 64, v109
  v_add_u32 v110, 64, v110
  v_add_u32 v111, 64, v111
  v_add_u32 v4, 64, v4
  v_add_u32 v8, 64, v8
  s_add_u32 s40, s40, 0x8000
  s_waitcnt vmcnt(0)
  s_mov_b64 exec, 1
  buffer_store_dword v13, v1, s[8:11], s39 offen sc1
  s_mov_b64 exec, -1
  ds_write_b32 v14, v13 offset:16
  s_add_u32 s32, s32, 1
  s_and_b32 s6, s32, 7
  s_cbranch_scc1 L_c_conv6
L_c_conv7:
  s_add_u32 s33, s32, 1
  s_and_b32 s6, s32, 7
  s_lshl_b32 s7, s6, 10
  s_add_u32 s7, s7, s35
  v_add_u32 v9, s7, v10
  s_lshl_b32 s6, s6, 1
  s_lshl_b32 s42, 0x30003, s6
  v_mov_b32 v13, s33
  ds_read_b128 v[48:51], v4 offset:0
  ds_read_b128 v[52:55], v4 offset:4608
  ds_read_b128 v[56:59], v4 offset:9216
  ds_read_b128 v[60:63], v4 offset:13824
  ds_read_b128 v[64:67], v4 offset:18432
  ds_read_b128 v[68:71], v4 offset:23040
  ds_read_b128 v[72:75], v4 offset:27648
  ds_read_b128 v[76:79], v4 offset:32256
  s_mov_b32 s7, 0
L_lw_132:
  ds_read_b32 v88, v2 offset:0
  s_waitcnt lgkmcnt(0)
  v_cmp_gt_i32 vcc, s33, v88
  s_cbranch_vccz L_lwo_133
  s_add_u32 s7, s7, 1
  s_cmp_lt_u32 s7, 131072
  s_cbranch_scc1 L_lw_132
  s_mov_b32 s6, 42
  s_branch L_err
L_lwo_133:
  ds_read2_b32 v[112:113], v104 offset0:0 offset1:1
  ds_read2_b32 v[114:115], v104 offset0:2 offset1:3
  ds_read_b32 v116, v104 offset:16
  ds_read2_b32 v[118:119], v105 offset0:0 offset1:1
  ds_read2_b32 v[120:121], v105 offset0:2 offset1:3
  ds_read_b32 v122, v105 offset:16
  ds_read2_b32 v[124:125], v106 offset0:0 offset1:1
  ds_read2_b32 v[126:127], v106 offset0:2 offset1:3
  ds_read_b32 v128, v106 offset:16
  ds_read2_b32 v[130:131], v107 offset0:0 offset1:1
  ds_read2_b32 v[132:133], v107 offset0:2 offset1:3
  ds_read_b32 v134, v107 offset:16
  s_waitcnt lgkmcnt(9)
  v_alignbyte_b32 v16, v113, v112, v15
  v_alignbyte_b32 v17, v114, v113, v15
  v_alignbyte_b32 v18, v115, v114, v15
  v_alignbyte_b32 v19, v116, v115, v15
  ds_read2_b32 v[112:113], v108 offset0:0 offset1:1
  ds_read2_b32 v[114:115], v108 offset0:2 offset1:3
  ds_read_b32 v116, v108 offset:16
  s_waitcnt lgkmcnt(9)
  v_alignbyte_b32 v20, v119, v118, v15
  v_alignbyte_b32 v21, v120, v119, v15
  v_alignbyte_b32 v22, v121, v120, v15
  v_alignbyte_b32 v23, v122, v121, v15
  ds_read2_b32 v[118:119], v109 offset0:0 offset1:1
  ds_read2_b32 v[120:121], v109 offset0:2 offset1:3
  ds_read_b32 v122, v109 offset:16
  v_mfma_f32_16x16x32_bf16 a[28:31], v[16:19], v[48:51], a[28:31]
  s_waitcnt lgkmcnt(9)
  v_alignbyte_b32 v24, v125, v124, v15
  v_alignbyte_b32 v25, v126, v125, v15
  v_alignbyte_b32 v26, v127, v126, v15
  v_alignbyte_b32 v27, v128, v127, v15
  ds_read2_b32 v[124:125], v110 offset0:0 offset1:1
  ds_read2_b32 v[126:127], v110 offset0:2 offset1:3
  ds_read_b32 v128, v110 offset:16
  v_mfma_f32_16x16x32_bf16 a[60:63], v[20:23], v[52:55], a[60:63]
  s_waitcnt lgkmcnt(9)
  v_alignbyte_b32 v28, v131, v130, v15
  v_alignbyte_b32 v29, v132, v131, v15
  v_alignbyte_b32 v30, v133, v132, v15
  v_alignbyte_b32 v31, v134, v133, v15
  ds_read2_b32 v[130:131], v111 offset0:0 offset1:1
  ds_read2_b32 v[132:133], v111 offset0:2 offset1:3
  ds_read_b32 v134, v111 offset:16
  v_mfma_f32_16x16x32_bf16 a[92:95], v[24:27], v[56:59], a[92:95]
  s_waitcnt lgkmcnt(9)
  v_alignbyte_b32 v32, v113, v112, v15
  v_alignbyte_b32 v33, v114, v113, v15
  v_alignbyte_b32 v34, v115, v114, v15
  v_alignbyte_b32 v35, v116, v115, v15
  ds_read_b64 v[84:85], v8
  ds_read_b64 v[86:87], v9
  v_mfma_f32_16x16x32_bf16 a[124:127], v[28:31], v[60:63], a[124:127]
  s_waitcnt lgkmcnt(8)
  v_alignbyte_b32 v36, v119, v118, v15
  v_alignbyte_b32 v37, v120, v119, v15
  v_alignbyte_b32 v38, v121, v120, v15
  v_alignbyte_b32 v39, v122, v121, v15
  v_mfma_f32_16x16x32_bf16 a[156:159], v[32:35], v[64:67], a[156:159]
  s_waitcnt lgkmcnt(5)
  v_alignbyte_b32 v40, v125, v124, v15
  v_alignbyte_b32 v41, v126, v125, v15
  v_alignbyte_b32 v42, v127, v126, v15
  v_alignbyte_b32 v43, v128, v127, v15
  v_mfma_f32_16x16x32_bf16 a[188:191], v[36:39], v[68:71], a[188:191]
  s_waitcnt lgkmcnt(2)
  v_alignbyte_b32 v44, v131, v130, v15
  v_alignbyte_b32 v45, v132, v131, v15
  v_alignbyte_b32 v46, v133, v132, v15
  v_alignbyte_b32 v47, v134, v133, v15
  v_mfma_f32_16x16x32_bf16 a[220:223], v[40:43], v[72:75], a[220:223]
  s_nop 0
  v_mfma_f32_16x16x32_bf16 a[252:255], v[44:47], v[76:79], a[252:255]
  s_waitcnt lgkmcnt(0)
  s_mov_b32 exec_lo, s42
  s_mov_b32 exec_hi, s42
  ds_write_b128 v6, a[28:31] offset:0
  ds_write_b128 v6, a[60:63] offset:128
  ds_write_b128 v6, a[92:95] offset:256
  ds_write_b128 v6, a[124:127] offset:384
  ds_write_b128 v6, a[156:159] offset:512
  ds_write_b128 v6, a[188:191] offset:640
  ds_write_b128 v6, a[220:223] offset:768
  ds_write_b128 v6, a[252:255] offset:896
  s_mov_b64 exec, -1
  ds_read_b128 v[80:83], v7
  ds_write_b32 v14, v13 offset:8
  v_lshlrev_b32 v88, 16, v84
  v_and_b32 v89, 0xffff0000, v84
  v_lshlrev_b32 v90, 16, v85
  v_and_b32 v91, 0xffff0000, v85
  v_lshlrev_b32 v96, 16, v86
  v_and_b32 v97, 0xffff0000, v86
  v_lshlrev_b32 v98, 16, v87
  v_and_b32 v99, 0xffff0000, v87
  v_mul_f32 v92, v88, v12
  v_mul_f32 v93, v89, v12
  v_mul_f32 v94, v90, v12
  v_mul_f32 v95, v91, v12
  v_cvt_pk_bf16_f32 v84, v92, v93
  v_cvt_pk_bf16_f32 v85, v94, v95
  v_lshlrev_b32 v92, 16, v84
  v_and_b32 v93, 0xffff0000, v84
  v_lshlrev_b32 v94, 16, v85
  v_and_b32 v95, 0xffff0000, v85
  s_waitcnt lgkmcnt(1)
  v_fmac_f32 v80, v88, v11
  v_fmac_f32 v81, v89, v11
  v_fmac_f32 v82, v90, v11
  v_fmac_f32 v83, v91, v11
  v_cvt_pk_bf16_f32 v84, v80, v81
  v_cvt_pk_bf16_f32 v85, v82, v83
  v_lshlrev_b32 v80, 16, v84
  v_and_b32 v81, 0xffff0000, v84
  v_lshlrev_b32 v82, 16, v85
  v_and_b32 v83, 0xffff0000, v85
  v_add_f32 v80, v80, v92
  v_add_f32 v81, v81, v93
  v_add_f32 v82, v82, v94
  v_add_f32 v83, v83, v95
  v_cvt_pk_bf16_f32 v84, v80, v81
  v_cvt_pk_bf16_f32 v85, v82, v83
  v_lshlrev_b32 v80, 16, v84
  v_and_b32 v81, 0xffff0000, v84
  v_lshlrev_b32 v82, 16, v85
  v_and_b32 v83, 0xffff0000, v85
  v_add_f32 v80, v80, v96
  v_add_f32 v81, v81, v97
  v_add_f32 v82, v82, v98
  v_add_f32 v83, v83, v99
  v_cvt_pk_bf16_f32 v84, v80, v81
  v_cvt_pk_bf16_f32 v85, v82, v83
  buffer_store_dwordx2 v[84:85], v10, s[8:11], s40 offen sc1
  v_add_u32 v104, 64, v104
  v_add_u32 v105, 64, v105
  v_add_u32 v106, 64, v106
  v_add_u32 v107, 64, v107
  v_add_u32 v108, 64, v108
  v_add_u32 v109, 64, v109
  v_add_u32 v110, 64, v110
  v_add_u32 v111, 64, v111
  v_add_u32 v4, 64, v4
  v_add_u32 v8, 64, v8
  s_add_u32 s40, s40, 0x8000
  s_waitcnt vmcnt(0)
  s_mov_b64 exec, 1
  buffer_store_dword v13, v1, s[8:11], s39 offen sc1
  s_mov_b64 exec, -1
  ds_write_b32 v14, v13 offset:16
  s_add_u32 s32, s32, 1
  s_and_b32 s6, s32, 7
  s_cbranch_scc1 L_c_conv7
  s_waitcnt vmcnt(0)
  s_endpgm
L_c_res:
  s_mov_b32 s16, s92
  s_mov_b32 s17, s93
  s_mov_b32 s18, 0x200000
  s_mov_b32 s19, 0x20000
  s_and_b32 s6, s3, 1
  s_mul_i32 s37, s6, 0x200000
  s_mul_i32 s38, s6, 0x800000
  s_lshl_b32 s7, s5, 10
  s_add_u32 s37, s37, s7
  s_add_u32 s37, s37, 0x0
  s_add_u32 s38, s38, s7
  s_add_u32 s38, s38, 0x8800000
  s_lshl_b32 s6, s5, 3
  s_add_u32 s39, s6, 0x710900
  s_lshl_b32 s41, s5, 5
  v_bfe_u32 v16, v0, 4, 5
  v_lshrrev_b32 v17, 9, v0
  v_lshlrev_b32 v18, 1, v16
  v_lshl_or_b32 v4, v17, 8, v18
  v_add_u32 v8, 139776, v4
  v_mul_u32_u24 v19, 16512, v17
  v_add_u32 v19, v19, v18
  v_add_u32 v7, 73760, v19
  v_bfe_u32 v5, v0, 2, 3
  v_bfe_u32 v6, v0, 8, 1
  v_lshlrev_b32 v6, 3, v6
  v_and_b32 v19, 0xf0, v0
  v_or_b32 v6, v19, v6
  v_lshlrev_b32 v19, 10, v16
  v_lshl_or_b32 v9, v17, 3, v19
  s_mov_b32 s43, 0
  s_mov_b32 s46, 0
  s_mov_b32 s23, 0
  s_mov_b32 s20, 0x3f80
  s_mov_b32 s21, 0x3f800000
  s_mov_b32 s22, 0x3f803f80
  v_bfe_u32 v10, v0, 4, 2
  v_lshlrev_b32 v10, 15, v10
  v_mov_b32 v32, 0
  v_mov_b32 v33, 0
  v_mov_b32 v34, 0
  v_mov_b32 v35, 0
  v_mov_b32 v36, 0
  v_mov_b32 v37, 0
  v_mov_b32 v38, 0
  v_mov_b32 v39, 0
  s_cmp_eq_u32 s3, 2
  s_cbranch_scc0 L_c_r5
L_c_rf:
  s_cmp_eq_u32 s3, 2
  s_cbranch_scc1 L_ga_134
  s_mov_b32 s47, 0
L_gl_136:
  ds_read_b32 v52, v2 offset:24
  s_waitcnt lgkmcnt(0)
  v_readfirstlane_b32 s6, v52
  s_cmp_gt_i32 s6, s46
  s_cbranch_scc1 L_gb_135
  s_add_u32 s47, s47, 1
  s_cmp_lt_u32 s47, 131072
  s_cbranch_scc1 L_gl_136
  s_mov_b32 s6, 47
  s_branch L_err
L_ga_134:
  s_add_u32 s6, s46, 1
  v_mov_b32 v52, s6
  ds_write_b32 v2, v52 offset:24
L_gb_135:
  s_min_i32 s46, s6, 0x7ffffffe
  buffer_load_short_d16_hi v32, v4, s[8:11], s37 offen offset:0
  buffer_load_short_d16_hi v33, v4, s[8:11], s37 offen offset:64
  buffer_load_short_d16_hi v34, v4, s[8:11], s37 offen offset:128
  buffer_load_short_d16_hi v35, v4, s[8:11], s37 offen offset:192
  buffer_load_short_d16_hi v36, v4, s[8:11], s37 offen offset:512
  buffer_load_short_d16_hi v37, v4, s[8:11], s37 offen offset:576
  buffer_load_short_d16_hi v38, v4, s[8:11], s37 offen offset:640
  buffer_load_short_d16_hi v39, v4, s[8:11], s37 offen offset:704
  s_and_b32 s6, s43, 3
  s_lshl_b32 s6, s6, 17
  s_add_u32 s44, s38, s6
  s_lshr_b32 s6, s43, 2
  s_andn2_b32 s45, 1, s6
  s_add_u32 s6, s44, 0
  buffer_load_dwordx4 v[16:19], v0, s[8:11], s6 offen sc1
  s_add_u32 s6, s44, 32768
  buffer_load_dwordx4 v[20:23], v0, s[8:11], s6 offen sc1
  s_add_u32 s6, s44, 65536
  buffer_load_dwordx4 v[24:27], v0, s[8:11], s6 offen sc1
  s_add_u32 s6, s44, 98304
  buffer_load_dwordx4 v[28:31], v0, s[8:11], s6 offen sc1
  s_add_u32 s37, s37, 0x8000
  s_add_u32 s43, s43, 1
L_c_rloop:
  s_mov_b32 s7, 0
L_c_rp:
  s_waitcnt vmcnt(0)
  v_bitop3_b32 v52, v16, v20, s45 bitop3:0x7e
  v_bitop3_b32 v53, v24, v28, s45 bitop3:0x7e
  v_bitop3_b32 v52, v52, v53, 1 bitop3:0xa8
  v_cmp_ne_u32 vcc, 0, v52
  s_cbranch_vccz L_c_rok
  s_cmp_eq_u32 s3, 2
  s_cbranch_scc1 L_ga_137
  s_mov_b32 s47, 0
L_gl_139:
  ds_read_b32 v52, v2 offset:24
  s_waitcnt lgkmcnt(0)
  v_readfirstlane_b32 s6, v52
  s_cmp_gt_i32 s6, s46
  s_cbranch_scc1 L_gb_138
  s_add_u32 s47, s47, 1
  s_cmp_lt_u32 s47, 131072
  s_cbranch_scc1 L_gl_139
  s_mov_b32 s6, 47
  s_branch L_err
L_gb_138:
  s_min_i32 s46, s6, 0x7ffffffe
L_ga_137:
  s_add_u32 s6, s44, 0
  s_nop 0
  buffer_load_dwordx4 v[16:19], v0, s[8:11], s6 offen sc1
  s_add_u32 s6, s44, 32768
  buffer_load_dwordx4 v[20:23], v0, s[8:11], s6 offen sc1
  s_add_u32 s6, s44, 65536
  buffer_load_dwordx4 v[24:27], v0, s[8:11], s6 offen sc1
  s_add_u32 s6, s44, 98304
  buffer_load_dwordx4 v[28:31], v0, s[8:11], s6 offen sc1
  s_add_u32 s7, s7, 1
  s_cmp_lt_u32 s7, 131072
  s_cbranch_scc1 L_c_rp
  s_mov_b32 s6, 43
  s_branch L_err
L_c_rok:
  v_dot2_f32_bf16 v40, v16, s20, 0
  v_dot2_f32_bf16 v41, v16, s21, 0
  v_dot2_f32_bf16 v42, v17, s20, 0
  v_dot2_f32_bf16 v43, v17, s21, 0
  v_dot2_f32_bf16 v44, v18, s20, 0
  v_dot2_f32_bf16 v45, v18, s21, 0
  v_dot2_f32_bf16 v46, v19, s20, 0
  v_dot2_f32_bf16 v47, v19, s21, 0
  v_dot2_f32_bf16 v40, v20, s20, v40
  v_dot2_f32_bf16 v41, v20, s21, v41
  v_dot2_f32_bf16 v42, v21, s20, v42
  v_dot2_f32_bf16 v43, v21, s21, v43
  v_dot2_f32_bf16 v44, v22, s20, v44
  v_dot2_f32_bf16 v45, v22, s21, v45
  v_dot2_f32_bf16 v46, v23, s20, v46
  v_dot2_f32_bf16 v47, v23, s21, v47
  v_dot2_f32_bf16 v40, v24, s20, v40
  v_dot2_f32_bf16 v41, v24, s21, v41
  v_dot2_f32_bf16 v42, v25, s20, v42
  v_dot2_f32_bf16 v43, v25, s21, v43
  v_dot2_f32_bf16 v44, v26, s20, v44
  v_dot2_f32_bf16 v45, v26, s21, v45
  v_dot2_f32_bf16 v46, v27, s20, v46
  v_dot2_f32_bf16 v47, v27, s21, v47
  v_dot2_f32_bf16 v40, v28, s20, v40
  v_dot2_f32_bf16 v41, v28, s21, v41
  v_dot2_f32_bf16 v42, v29, s20, v42
  v_dot2_f32_bf16 v43, v29, s21, v43
  v_dot2_f32_bf16 v44, v30, s20, v44
  v_dot2_f32_bf16 v45, v30, s21, v45
  v_dot2_f32_bf16 v46, v31, s20, v46
  v_dot2_f32_bf16 v47, v31, s21, v47
  v_cvt_pk_bf16_f32 v48, v40, v41
  v_cvt_pk_bf16_f32 v49, v42, v43
  v_cvt_pk_bf16_f32 v50, v44, v45
  v_cvt_pk_bf16_f32 v51, v46, v47
  v_dot2_f32_bf16 v40, v48, s20, v32
  v_dot2_f32_bf16 v41, v48, s21, v33
  v_dot2_f32_bf16 v42, v49, s20, v34
  v_dot2_f32_bf16 v43, v49, s21, v35
  v_dot2_f32_bf16 v44, v50, s20, v36
  v_dot2_f32_bf16 v45, v50, s21, v37
  v_dot2_f32_bf16 v46, v51, s20, v38
  v_dot2_f32_bf16 v47, v51, s21, v39
  v_cvt_pk_bf16_f32 v48, v40, v41
  v_cvt_pk_bf16_f32 v49, v42, v43
  v_cvt_pk_bf16_f32 v50, v44, v45
  v_cvt_pk_bf16_f32 v51, v46, v47
  s_cmp_eq_u32 s3, 2
  s_cbranch_scc1 L_c_ln
  buffer_store_dwordx2 v[48:49], v9, s[16:19], s41 offen
  buffer_store_dwordx2 v[50:51], v9, s[16:19], s41 offen offset:16
  s_add_u32 s41, s41, 0x8000
  v_mov_b32 v52, s43
  s_mov_b64 exec, 3
  buffer_store_dword v52, v5, s[8:11], s39 offen sc1
  s_mov_b64 exec, -1
  s_add_u32 s32, s32, 1
  s_cmp_eq_u32 s32, 64
  s_cbranch_scc1 L_c_rend
L_c_r5:
  s_add_u32 s33, s32, 1
  s_mov_b32 s7, 0
L_lw_140:
  ds_read_b64 v[52:53], v2 offset:16
  s_waitcnt lgkmcnt(0)
  v_min_i32 v52, v52, v53
  v_cmp_gt_i32 vcc, s33, v52
  s_cbranch_vccz L_lwo_141
  s_add_u32 s7, s7, 1
  s_cmp_lt_u32 s7, 131072
  s_cbranch_scc1 L_lw_140
  s_mov_b32 s6, 46
  s_branch L_err
L_lwo_141:
  s_branch L_c_rf
L_c_ln:
  s_cmp_eq_u32 s32, 63
  s_cbranch_scc0 L_cf_142
  v_mov_b32 v52, 0x7fffffff
  ds_write_b32 v2, v52 offset:24
  s_branch L_cnf_143
L_cf_142:
L_ga_144:
  s_add_u32 s6, s46, 1
  v_mov_b32 v52, s6
  ds_write_b32 v2, v52 offset:24
L_gb_145:
  s_min_i32 s46, s6, 0x7ffffffe
  buffer_load_short_d16_hi v32, v4, s[8:11], s37 offen offset:0
  buffer_load_short_d16_hi v33, v4, s[8:11], s37 offen offset:64
  buffer_load_short_d16_hi v34, v4, s[8:11], s37 offen offset:128
  buffer_load_short_d16_hi v35, v4, s[8:11], s37 offen offset:192
  buffer_load_short_d16_hi v36, v4, s[8:11], s37 offen offset:512
  buffer_load_short_d16_hi v37, v4, s[8:11], s37 offen offset:576
  buffer_load_short_d16_hi v38, v4, s[8:11], s37 offen offset:640
  buffer_load_short_d16_hi v39, v4, s[8:11], s37 offen offset:704
  s_and_b32 s6, s43, 3
  s_lshl_b32 s6, s6, 17
  s_add_u32 s44, s38, s6
  s_lshr_b32 s6, s43, 2
  s_andn2_b32 s45, 1, s6
  s_add_u32 s6, s44, 0
  buffer_load_dwordx4 v[16:19], v0, s[8:11], s6 offen sc1
  s_add_u32 s6, s44, 32768
  buffer_load_dwordx4 v[20:23], v0, s[8:11], s6 offen sc1
  s_add_u32 s6, s44, 65536
  buffer_load_dwordx4 v[24:27], v0, s[8:11], s6 offen sc1
  s_add_u32 s6, s44, 98304
  buffer_load_dwordx4 v[28:31], v0, s[8:11], s6 offen sc1
  s_add_u32 s37, s37, 0x8000
  s_add_u32 s43, s43, 1
L_cnf_143:
  v_dot2_f32_bf16 v52, v48, s22, 0
  v_dot2_f32_bf16 v53, v48, v48, 0
  v_dot2_f32_bf16 v52, v49, s22, v52
  v_dot2_f32_bf16 v53, v49, v49, v53
  v_dot2_f32_bf16 v52, v50, s22, v52
  v_dot2_f32_bf16 v53, v50, v50, v53
  v_dot2_f32_bf16 v52, v51, s22, v52
  v_dot2_f32_bf16 v53, v51, v51, v53
  s_lshr_b32 s6, s32, 2
  s_andn2_b32 s36, 1, s6
  s_and_b32 s6, s32, 3
  s_lshl_b32 s6, s6, 13
  s_add_u32 s34, s6, 0x738000
  s_lshl_b32 s6, s5, 8
  s_add_u32 s6, s6, s34
  v_mov_b32 v54, v52
  v_mov_b32 v55, v53
  s_nop 0
  v_permlane32_swap_b32 v52, v54
  v_permlane32_swap_b32 v53, v55
  v_add_f32 v52, v52, v54
  v_add_f32 v53, v53, v55
  v_bfi_b32 v53, 1, s36, v53
  s_mov_b32 exec_hi, 0
  buffer_store_dwordx2 v[52:53], v6, s[8:11], s6 offen
  s_cmp_lt_u32 s32, 62
  s_cbranch_scc1 L_cnl_147
  buffer_store_dwordx2 v[52:53], v6, s[8:11], s6 offen sc1
L_cnl_147:
  s_mov_b32 exec_hi, -1
  s_add_u32 s35, s34, 4096
  s_sub_u32 s33, s32, 7
  s_mov_b32 s7, 0
L_lw_148:
  ds_read_b64 v[52:53], v2 offset:8
  s_waitcnt lgkmcnt(0)
  v_min_i32 v52, v52, v53
  v_cmp_gt_i32 vcc, s33, v52
  s_cbranch_vccz L_lwo_149
  s_add_u32 s7, s7, 1
  s_cmp_lt_u32 s7, 131072
  s_cbranch_scc1 L_lw_148
  s_mov_b32 s6, 44
  s_branch L_err
L_lwo_149:
  s_and_b32 s6, s32, 7
  s_lshl_b32 s6, s6, 10
  v_add_u32 v52, s6, v8
  ds_write_b16 v52, v48 offset:0
  ds_write_b16_d16_hi v52, v48 offset:64
  ds_write_b16 v52, v49 offset:128
  ds_write_b16_d16_hi v52, v49 offset:192
  ds_write_b16 v52, v50 offset:512
  ds_write_b16_d16_hi v52, v50 offset:576
  ds_write_b16 v52, v51 offset:640
  ds_write_b16_d16_hi v52, v51 offset:704
  buffer_load_dwordx4 v[64:67], v0, s[8:11], s34 offen offset:0 sc1
  buffer_load_dwordx4 v[68:71], v0, s[8:11], s34 offen offset:1024 sc1
  buffer_load_dwordx4 v[72:75], v0, s[8:11], s34 offen offset:2048 sc1
  buffer_load_dwordx4 v[76:79], v0, s[8:11], s34 offen offset:3072 sc1
  buffer_load_dwordx4 v[80:83], v0, s[8:11], s35 offen offset:0 sc1
  buffer_load_dwordx4 v[84:87], v0, s[8:11], s35 offen offset:1024 sc1
  buffer_load_dwordx4 v[88:91], v0, s[8:11], s35 offen offset:2048 sc1
  buffer_load_dwordx4 v[92:95], v0, s[8:11], s35 offen offset:3072 sc1
  s_mov_b32 s7, 0
L_c_g:
  s_waitcnt vmcnt(0)
L_c_g1:
  v_bitop3_b32 v56, v65, v67, s36 bitop3:0x7e
  v_bitop3_b32 v57, v69, v71, s36 bitop3:0x7e
  v_bitop3_b32 v58, v73, v75, s36 bitop3:0x7e
  v_bitop3_b32 v59, v77, v79, s36 bitop3:0x7e
  v_bitop3_b32 v60, v81, v83, s36 bitop3:0x7e
  v_bitop3_b32 v61, v85, v87, s36 bitop3:0x7e
  v_bitop3_b32 v62, v89, v91, s36 bitop3:0x7e
  v_bitop3_b32 v63, v93, v95, s36 bitop3:0x7e
  v_or3_b32 v52, v56, v57, v58
  v_or3_b32 v53, v59, v60, v61
  v_or3_b32 v52, v52, v62, v63
  v_bitop3_b32 v52, v52, v53, 1 bitop3:0xa8
  v_cmp_ne_u32 vcc, 0, v52
  s_cbranch_vccz L_c_gok0
  v_and_b32 v56, 1, v56
  v_and_b32 v57, 1, v57
  v_and_b32 v58, 1, v58
  v_and_b32 v59, 1, v59
  v_and_b32 v60, 1, v60
  v_and_b32 v61, 1, v61
  v_and_b32 v62, 1, v62
  v_and_b32 v63, 1, v63
  v_cmp_ne_u32 s[48:49], 0, v56
  v_cmp_ne_u32 s[50:51], 0, v57
  v_cmp_ne_u32 s[52:53], 0, v58
  v_cmp_ne_u32 s[54:55], 0, v59
  v_cmp_ne_u32 s[56:57], 0, v60
  v_cmp_ne_u32 s[58:59], 0, v61
  v_cmp_ne_u32 s[60:61], 0, v62
  v_cmp_ne_u32 s[62:63], 0, v63
  s_or_b64 exec, s[48:49], 1
  buffer_load_dwordx4 v[64:67], v0, s[8:11], s34 offen offset:0 sc1
  s_or_b64 exec, s[50:51], 1
  buffer_load_dwordx4 v[68:71], v0, s[8:11], s34 offen offset:1024 sc1
  s_or_b64 exec, s[52:53], 1
  buffer_load_dwordx4 v[72:75], v0, s[8:11], s34 offen offset:2048 sc1
  s_or_b64 exec, s[54:55], 1
  buffer_load_dwordx4 v[76:79], v0, s[8:11], s34 offen offset:3072 sc1
  s_or_b64 exec, s[56:57], 1
  buffer_load_dwordx4 v[80:83], v0, s[8:11], s35 offen offset:0 sc1
  s_or_b64 exec, s[58:59], 1
  buffer_load_dwordx4 v[84:87], v0, s[8:11], s35 offen offset:1024 sc1
  s_or_b64 exec, s[60:61], 1
  buffer_load_dwordx4 v[88:91], v0, s[8:11], s35 offen offset:2048 sc1
  s_or_b64 exec, s[62:63], 1
  buffer_load_dwordx4 v[92:95], v0, s[8:11], s35 offen offset:3072 sc1
  s_mov_b64 exec, -1
  s_cmp_lg_u32 s23, 0
  s_cbranch_scc1 L_c_na
  s_cmp_eq_u32 s32, 63
  s_cbranch_scc1 L_c_na
  s_waitcnt vmcnt(8)
  v_bitop3_b32 v52, v16, v20, s45 bitop3:0x7e
  v_bitop3_b32 v53, v24, v28, s45 bitop3:0x7e
  v_bitop3_b32 v52, v52, v53, 1 bitop3:0xa8
  v_cmp_ne_u32 vcc, 0, v52
  s_cbranch_vccz L_c_pa
  s_cmp_lg_u32 s7, 0
  s_cbranch_scc1 L_c_na
  s_add_u32 s6, s44, 0
  buffer_load_dwordx4 v[16:19], v0, s[8:11], s6 offen sc1
  s_add_u32 s6, s44, 32768
  buffer_load_dwordx4 v[20:23], v0, s[8:11], s6 offen sc1
  s_add_u32 s6, s44, 65536
  buffer_load_dwordx4 v[24:27], v0, s[8:11], s6 offen sc1
  s_add_u32 s6, s44, 98304
  buffer_load_dwordx4 v[28:31], v0, s[8:11], s6 offen sc1
  s_mov_b32 s7, 1
  s_waitcnt vmcnt(4)
  s_branch L_c_g1
L_c_pa:
  s_cbranch_vccnz L_c_na
  s_add_u32 s26, s32, 1
  s_mov_b32 s23, 1
  v_dot2_f32_bf16 v40, v16, s20, 0
  v_dot2_f32_bf16 v41, v16, s21, 0
  v_dot2_f32_bf16 v42, v17, s20, 0
  v_dot2_f32_bf16 v43, v17, s21, 0
  v_dot2_f32_bf16 v44, v18, s20, 0
  v_dot2_f32_bf16 v45, v18, s21, 0
  v_dot2_f32_bf16 v46, v19, s20, 0
  v_dot2_f32_bf16 v47, v19, s21, 0
  v_dot2_f32_bf16 v40, v20, s20, v40
  v_dot2_f32_bf16 v41, v20, s21, v41
  v_dot2_f32_bf16 v42, v21, s20, v42
  v_dot2_f32_bf16 v43, v21, s21, v43
  v_dot2_f32_bf16 v44, v22, s20, v44
  v_dot2_f32_bf16 v45, v22, s21, v45
  v_dot2_f32_bf16 v46, v23, s20, v46
  v_dot2_f32_bf16 v47, v23, s21, v47
  v_dot2_f32_bf16 v40, v24, s20, v40
  v_dot2_f32_bf16 v41, v24, s21, v41
  v_dot2_f32_bf16 v42, v25, s20, v42
  v_dot2_f32_bf16 v43, v25, s21, v43
  v_dot2_f32_bf16 v44, v26, s20, v44
  v_dot2_f32_bf16 v45, v26, s21, v45
  v_dot2_f32_bf16 v46, v27, s20, v46
  v_dot2_f32_bf16 v47, v27, s21, v47
  v_dot2_f32_bf16 v40, v28, s20, v40
  v_dot2_f32_bf16 v41, v28, s21, v41
  v_dot2_f32_bf16 v42, v29, s20, v42
  v_dot2_f32_bf16 v43, v29, s21, v43
  v_dot2_f32_bf16 v44, v30, s20, v44
  v_dot2_f32_bf16 v45, v30, s21, v45
  v_dot2_f32_bf16 v46, v31, s20, v46
  v_dot2_f32_bf16 v47, v31, s21, v47
  v_cvt_pk_bf16_f32 v96, v40, v41
  v_cvt_pk_bf16_f32 v97, v42, v43
  v_cvt_pk_bf16_f32 v98, v44, v45
  v_cvt_pk_bf16_f32 v99, v46, v47
  v_dot2_f32_bf16 v40, v96, s20, v32
  v_dot2_f32_bf16 v41, v96, s21, v33
  v_dot2_f32_bf16 v42, v97, s20, v34
  v_dot2_f32_bf16 v43, v97, s21, v35
  v_dot2_f32_bf16 v44, v98, s20, v36
  v_dot2_f32_bf16 v45, v98, s21, v37
  v_dot2_f32_bf16 v46, v99, s20, v38
  v_dot2_f32_bf16 v47, v99, s21, v39
  v_cvt_pk_bf16_f32 v96, v40, v41
  v_cvt_pk_bf16_f32 v97, v42, v43
  v_cvt_pk_bf16_f32 v98, v44, v45
  v_cvt_pk_bf16_f32 v99, v46, v47
  v_dot2_f32_bf16 v52, v96, s22, 0
  v_dot2_f32_bf16 v53, v96, v96, 0
  v_dot2_f32_bf16 v52, v97, s22, v52
  v_dot2_f32_bf16 v53, v97, v97, v53
  v_dot2_f32_bf16 v52, v98, s22, v52
  v_dot2_f32_bf16 v53, v98, v98, v53
  v_dot2_f32_bf16 v52, v99, s22, v52
  v_dot2_f32_bf16 v53, v99, v99, v53
  s_lshr_b32 s6, s26, 2
  s_andn2_b32 s24, 1, s6
  s_and_b32 s6, s26, 3
  s_lshl_b32 s6, s6, 13
  s_add_u32 s25, s6, 0x738000
  s_lshl_b32 s6, s5, 8
  s_add_u32 s6, s6, s25
  v_mov_b32 v54, v52
  v_mov_b32 v55, v53
  s_nop 0
  v_permlane32_swap_b32 v52, v54
  v_permlane32_swap_b32 v53, v55
  v_add_f32 v52, v52, v54
  v_add_f32 v53, v53, v55
  v_bfi_b32 v53, 1, s24, v53
  s_mov_b32 exec_hi, 0
  buffer_store_dwordx2 v[52:53], v6, s[8:11], s6 offen
  s_cmp_lt_u32 s26, 62
  s_cbranch_scc1 L_cnl_150
  buffer_store_dwordx2 v[52:53], v6, s[8:11], s6 offen sc1
  s_waitcnt vmcnt(1)
L_cnl_150:
  s_mov_b32 exec_hi, -1
  s_sub_u32 s33, s26, 7
  s_mov_b32 s7, 0
L_lw_151:
  ds_read_b64 v[52:53], v2 offset:8
  s_waitcnt lgkmcnt(0)
  v_min_i32 v52, v52, v53
  v_cmp_gt_i32 vcc, s33, v52
  s_cbranch_vccz L_lwo_152
  s_add_u32 s7, s7, 1
  s_cmp_lt_u32 s7, 131072
  s_cbranch_scc1 L_lw_151
  s_mov_b32 s6, 44
  s_branch L_err
L_lwo_152:
  s_and_b32 s6, s26, 7
  s_lshl_b32 s6, s6, 10
  v_add_u32 v52, s6, v8
  ds_write_b16 v52, v96 offset:0
  ds_write_b16_d16_hi v52, v96 offset:64
  ds_write_b16 v52, v97 offset:128
  ds_write_b16_d16_hi v52, v97 offset:192
  ds_write_b16 v52, v98 offset:512
  ds_write_b16_d16_hi v52, v98 offset:576
  ds_write_b16 v52, v99 offset:640
  ds_write_b16_d16_hi v52, v99 offset:704
  s_waitcnt vmcnt(1)
  s_branch L_c_g1
L_c_pre:
  s_mov_b32 s23, 0
  s_mov_b32 s36, s24
  s_mov_b32 s34, s25
  s_add_u32 s35, s25, 4096
  s_mov_b32 s7, 0
  buffer_load_dwordx4 v[64:67], v0, s[8:11], s34 offen offset:0 sc1
  buffer_load_dwordx4 v[68:71], v0, s[8:11], s34 offen offset:1024 sc1
  buffer_load_dwordx4 v[72:75], v0, s[8:11], s34 offen offset:2048 sc1
  buffer_load_dwordx4 v[76:79], v0, s[8:11], s34 offen offset:3072 sc1
  buffer_load_dwordx4 v[80:83], v0, s[8:11], s35 offen offset:0 sc1
  buffer_load_dwordx4 v[84:87], v0, s[8:11], s35 offen offset:1024 sc1
  buffer_load_dwordx4 v[88:91], v0, s[8:11], s35 offen offset:2048 sc1
  buffer_load_dwordx4 v[92:95], v0, s[8:11], s35 offen offset:3072 sc1
  v_mov_b32 v48, v96
  v_mov_b32 v49, v97
  v_mov_b32 v50, v98
  v_mov_b32 v51, v99
  s_cmp_eq_u32 s32, 63
  s_cbranch_scc0 L_cf_153
  v_mov_b32 v52, 0x7fffffff
  ds_write_b32 v2, v52 offset:24
  s_waitcnt vmcnt(0)
  s_branch L_cnf_154
L_cf_153:
L_ga_155:
  s_add_u32 s6, s46, 1
  v_mov_b32 v52, s6
  ds_write_b32 v2, v52 offset:24
L_gb_156:
  s_min_i32 s46, s6, 0x7ffffffe
  buffer_load_short_d16_hi v32, v4, s[8:11], s37 offen offset:0
  buffer_load_short_d16_hi v33, v4, s[8:11], s37 offen offset:64
  buffer_load_short_d16_hi v34, v4, s[8:11], s37 offen offset:128
  buffer_load_short_d16_hi v35, v4, s[8:11], s37 offen offset:192
  buffer_load_short_d16_hi v36, v4, s[8:11], s37 offen offset:512
  buffer_load_short_d16_hi v37, v4, s[8:11], s37 offen offset:576
  buffer_load_short_d16_hi v38, v4, s[8:11], s37 offen offset:640
  buffer_load_short_d16_hi v39, v4, s[8:11], s37 offen offset:704
  s_and_b32 s6, s43, 3
  s_lshl_b32 s6, s6, 17
  s_add_u32 s44, s38, s6
  s_lshr_b32 s6, s43, 2
  s_andn2_b32 s45, 1, s6
  s_add_u32 s6, s44, 0
  buffer_load_dwordx4 v[16:19], v0, s[8:11], s6 offen sc1
  s_add_u32 s6, s44, 32768
  buffer_load_dwordx4 v[20:23], v0, s[8:11], s6 offen sc1
  s_add_u32 s6, s44, 65536
  buffer_load_dwordx4 v[24:27], v0, s[8:11], s6 offen sc1
  s_add_u32 s6, s44, 98304
  buffer_load_dwordx4 v[28:31], v0, s[8:11], s6 offen sc1
  s_add_u32 s37, s37, 0x8000
  s_add_u32 s43, s43, 1
L_cnf_154:
  s_waitcnt vmcnt(12)
  s_branch L_c_g1
L_c_na:
  s_and_b32 s6, s7, 31
  s_cmp_lg_u32 s6, 31
  s_cbranch_scc1 L_tf_158
  buffer_wbl2 sc1
  s_waitcnt vmcnt(0)
  buffer_inv sc1
  s_waitcnt vmcnt(0)
L_tf_158:
  s_add_u32 s7, s7, 1
  s_cmp_lt_u32 s7, 131072
  s_cbranch_scc1 L_c_g
  s_mov_b32 s6, 45
  s_branch L_err
L_c_gok0:
  v_pk_add_f32 v[64:65], v[64:65], v[80:81]
  v_pk_add_f32 v[66:67], v[66:67], v[82:83]
  v_pk_add_f32 v[68:69], v[68:69], v[84:85]
  v_pk_add_f32 v[70:71], v[70:71], v[86:87]
  v_pk_add_f32 v[72:73], v[72:73], v[88:89]
  v_pk_add_f32 v[74:75], v[74:75], v[90:91]
  v_pk_add_f32 v[76:77], v[76:77], v[92:93]
  v_pk_add_f32 v[78:79], v[78:79], v[94:95]
L_c_gok:
  v_pk_add_f32 v[64:65], v[64:65], v[72:73]
  v_pk_add_f32 v[66:67], v[66:67], v[74:75]
  v_pk_add_f32 v[68:69], v[68:69], v[76:77]
  v_pk_add_f32 v[70:71], v[70:71], v[78:79]
  v_pk_add_f32 v[64:65], v[64:65], v[68:69]
  v_pk_add_f32 v[66:67], v[66:67], v[70:71]
  s_nop 1
  v_permlane16_swap_b32 v64, v66
  v_permlane16_swap_b32 v65, v67
  v_pk_add_f32 v[52:53], v[64:65], v[66:67]
  v_mov_b32 v54, v52
  v_mov_b32 v55, v53
  s_nop 0
  v_permlane32_swap_b32 v52, v54
  v_permlane32_swap_b32 v53, v55
  v_add_f32 v52, v52, v54
  v_add_f32 v53, v53, v55
  v_mul_f32 v52, 0x3b000000, v52
  v_mul_f32 v54, v52, v52
  v_mul_f32 v53, 0x3b000000, v53
  v_sub_f32 v53, v53, v54
  v_max_f32 v53, 0, v53
  v_cvt_pk_bf16_f32 v53, v53, v53
  v_and_b32 v53, 0xffff0000, v53
  v_add_f32 v53, 0x3727c5ac, v53
  v_cvt_pk_bf16_f32 v53, v53, v53
  v_and_b32 v53, 0xffff0000, v53
  v_sqrt_f32 v53, v53
  v_cvt_pk_bf16_f32 v52, v52, v52
  v_and_b32 v52, 0xffff0000, v52
  v_cvt_pk_bf16_f32 v53, v53, v53
  v_and_b32 v53, 0xffff0000, v53
  v_rcp_f32 v53, v53
  v_dot2_f32_bf16 v40, v48, s20, v52 neg_lo:[0,0,1]
  v_dot2_f32_bf16 v41, v48, s21, v52 neg_lo:[0,0,1]
  v_dot2_f32_bf16 v42, v49, s20, v52 neg_lo:[0,0,1]
  v_dot2_f32_bf16 v43, v49, s21, v52 neg_lo:[0,0,1]
  v_dot2_f32_bf16 v44, v50, s20, v52 neg_lo:[0,0,1]
  v_dot2_f32_bf16 v45, v50, s21, v52 neg_lo:[0,0,1]
  v_dot2_f32_bf16 v46, v51, s20, v52 neg_lo:[0,0,1]
  v_dot2_f32_bf16 v47, v51, s21, v52 neg_lo:[0,0,1]
  v_cvt_pk_bf16_f32 v48, v40, v41
  v_cvt_pk_bf16_f32 v49, v42, v43
  v_cvt_pk_bf16_f32 v50, v44, v45
  v_cvt_pk_bf16_f32 v51, v46, v47
  v_lshlrev_b32 v40, 16, v48
  v_and_b32 v41, 0xffff0000, v48
  v_lshlrev_b32 v42, 16, v49
  v_and_b32 v43, 0xffff0000, v49
  v_lshlrev_b32 v44, 16, v50
  v_and_b32 v45, 0xffff0000, v50
  v_lshlrev_b32 v46, 16, v51
  v_and_b32 v47, 0xffff0000, v51
  v_mul_f32 v40, v40, v53
  v_mul_f32 v41, v41, v53
  v_mul_f32 v42, v42, v53
  v_mul_f32 v43, v43, v53
  v_mul_f32 v44, v44, v53
  v_mul_f32 v45, v45, v53
  v_mul_f32 v46, v46, v53
  v_mul_f32 v47, v47, v53
  v_cvt_pk_bf16_f32 v48, v40, v41
  v_cvt_pk_bf16_f32 v49, v42, v43
  v_cvt_pk_bf16_f32 v50, v44, v45
  v_cvt_pk_bf16_f32 v51, v46, v47
  s_add_u32 s6, s32, 1
  v_mov_b32 v52, s6
  ds_write_b16 v7, v48 offset:0
  ds_write_b16_d16_hi v7, v48 offset:4128
  ds_write_b16 v7, v49 offset:8256
  ds_write_b16_d16_hi v7, v49 offset:12384
  ds_write_b16 v7, v50 offset:33024
  ds_write_b16_d16_hi v7, v50 offset:37152
  ds_write_b16 v7, v51 offset:41280
  ds_write_b16_d16_hi v7, v51 offset:45408
  ds_write_b32 v2, v52
  v_add_u32 v7, 64, v7
  s_add_u32 s32, s32, 1
  s_cmp_lg_u32 s23, 0
  s_cbranch_scc1 L_c_pre
  s_cmp_lt_u32 s32, 64
  s_cbranch_scc1 L_c_rloop
L_c_rend:
  s_waitcnt vmcnt(0)
  s_endpgm
.section .rodata,"a"
.p2align 6
.amdhsa_kernel interleave_layers__ssm_conv_s4d__memory_aug_recurrent_mem_tr__prompt_kernel
  .amdhsa_next_free_vgpr 512
  .amdhsa_next_free_sgpr 102
  .amdhsa_accum_offset 256
  .amdhsa_group_segment_fixed_size 0
  .amdhsa_kernarg_size 136
  .amdhsa_user_sgpr_count 2
  .amdhsa_user_sgpr_kernarg_segment_ptr 1
  .amdhsa_system_sgpr_workgroup_id_x 1
.end_amdhsa_kernel
```

```asm
; @launch grid=(256,1,1) block=(256,1,1) lds=163840
.amdgcn_target "amdgcn-amd-amdhsa--gfx950"
.text
.globl interleave_layers__ssm_conv_s4d__memory_aug_recurrent_mem_tr__prompt_kernel
.p2align 8
.type interleave_layers__ssm_conv_s4d__memory_aug_recurrent_mem_tr__prompt_kernel,@function
interleave_layers__ssm_conv_s4d__memory_aug_recurrent_mem_tr__prompt_kernel:
  s_cmp_ge_u32 s2, 256
  s_cbranch_scc1 L_end
  s_load_dwordx16 s[64:79], s[0:1], 0
  s_load_dwordx16 s[80:95], s[0:1], 64
  s_load_dwordx2 s[96:97], s[0:1], 128
  s_getreg_b32 s4, hwreg(HW_REG_XCC_ID,0,4)
  v_lshrrev_b32 v1, 6, v0
  v_and_b32 v0, 63, v0
  s_and_b32 s4, s4, 7
  v_readfirstlane_b32 s3, v1
  s_lshl_b32 s4, s4, 2
  s_lshr_b32 s4, 0x10673254, s4
  s_and_b32 s4, s4, 7
  s_waitcnt lgkmcnt(0)
  s_mov_b32 s12, s94
  s_mov_b32 s13, s95
  s_mov_b32 s14, 0x100
  s_mov_b32 s15, 0x20000
  s_mov_b32 s8, s96
  s_mov_b32 s9, s97
  s_mov_b32 s10, 0x10000000
  s_mov_b32 s11, 0x20000
  s_mov_b32 s16, s64
  s_mov_b32 s17, s65
  s_mov_b32 s18, 0x200000
  s_mov_b32 s19, 0x20000
  s_lshl_b32 s6, s2, 3
  s_lshl_b32 s7, s3, 1
  s_add_u32 s32, s6, s7
  s_lshl_b32 s6, s32, 10
  v_lshlrev_b32 v4, 5, v0
  buffer_load_dwordx4 v[40:43], v4, s[16:19], s6 offen
  buffer_load_dwordx4 v[44:47], v4, s[16:19], s6 offen offset:16
  s_cmp_lg_u32 s3, 0
  s_cbranch_scc1 L_tk_1
  s_and_b32 s6, s4, 3
  s_lshl_b32 s6, s6, 6
  s_and_b32 s7, s4, 4
  s_add_u32 s6, s6, s7
  s_mov_b64 exec, 1
  v_mov_b32 v2, s6
  v_mov_b32 v3, 1
  buffer_atomic_add v3, v2, s[12:15], 0 offen sc0 sc1
  s_mov_b64 exec, -1
L_tk_1:
  s_cmp_lg_u32 s3, 0
  s_waitcnt vmcnt(1)
  s_cbranch_scc0 L_xw_2
  s_waitcnt vmcnt(0)
L_xw_2:
  v_mov_b32 v5, 0
  v_mov_b32 v6, 0
  v_mov_b32 v7, 0x3f803f80
  v_dot2c_f32_bf16 v5, v40, v7
  v_dot2c_f32_bf16 v6, v40, v40
  v_dot2c_f32_bf16 v5, v41, v7
  v_dot2c_f32_bf16 v6, v41, v41
  v_dot2c_f32_bf16 v5, v42, v7
  v_dot2c_f32_bf16 v6, v42, v42
  v_dot2c_f32_bf16 v5, v43, v7
  v_dot2c_f32_bf16 v6, v43, v43
  v_dot2c_f32_bf16 v5, v44, v7
  v_dot2c_f32_bf16 v6, v44, v44
  v_dot2c_f32_bf16 v5, v45, v7
  v_dot2c_f32_bf16 v6, v45, v45
  v_dot2c_f32_bf16 v5, v46, v7
  v_dot2c_f32_bf16 v6, v46, v46
  v_dot2c_f32_bf16 v5, v47, v7
  v_dot2c_f32_bf16 v6, v47, v47
  s_nop 1
  v_add_f32_dpp v5, v5, v5 quad_perm:[1,0,3,2] row_mask:0xf bank_mask:0xf
  v_add_f32_dpp v6, v6, v6 quad_perm:[1,0,3,2] row_mask:0xf bank_mask:0xf
  s_nop 0
  v_add_f32_dpp v5, v5, v5 quad_perm:[2,3,0,1] row_mask:0xf bank_mask:0xf
  v_add_f32_dpp v6, v6, v6 quad_perm:[2,3,0,1] row_mask:0xf bank_mask:0xf
  s_nop 0
  v_add_f32_dpp v5, v5, v5 row_half_mirror row_mask:0xf bank_mask:0xf
  v_add_f32_dpp v6, v6, v6 row_half_mirror row_mask:0xf bank_mask:0xf
  s_nop 0
  v_add_f32_dpp v5, v5, v5 row_mirror row_mask:0xf bank_mask:0xf
  v_add_f32_dpp v6, v6, v6 row_mirror row_mask:0xf bank_mask:0xf
  v_mov_b32 v8, v5
  v_mov_b32 v9, v6
  s_nop 0
  v_permlane16_swap_b32 v5, v8
  v_permlane16_swap_b32 v6, v9
  v_add_f32 v8, v5, v8
  v_add_f32 v9, v6, v9
  v_mul_f32 v8, 0x3b000000, v8
  v_mul_f32 v10, v8, v8
  v_mul_f32 v9, 0x3b000000, v9
  v_sub_f32 v9, v9, v10
  v_max_f32 v9, 0, v9
  v_cvt_pk_bf16_f32 v9, v9, v9
  v_and_b32 v9, 0xffff0000, v9
  v_add_f32 v9, 0x3727c5ac, v9
  v_cvt_pk_bf16_f32 v9, v9, v9
  v_and_b32 v9, 0xffff0000, v9
  v_sqrt_f32 v9, v9
  v_cvt_pk_bf16_f32 v8, v8, v8
  v_and_b32 v8, 0xffff0000, v8
  v_cvt_pk_bf16_f32 v9, v9, v9
  v_and_b32 v9, 0xffff0000, v9
  v_rcp_f32 v9, v9
  v_lshlrev_b32 v16, 16, v40
  v_and_b32 v17, 0xffff0000, v40
  v_lshlrev_b32 v18, 16, v41
  v_and_b32 v19, 0xffff0000, v41
  v_lshlrev_b32 v20, 16, v42
  v_and_b32 v21, 0xffff0000, v42
  v_lshlrev_b32 v22, 16, v43
  v_and_b32 v23, 0xffff0000, v43
  v_lshlrev_b32 v24, 16, v44
  v_and_b32 v25, 0xffff0000, v44
  v_lshlrev_b32 v26, 16, v45
  v_and_b32 v27, 0xffff0000, v45
  v_lshlrev_b32 v28, 16, v46
  v_and_b32 v29, 0xffff0000, v46
  v_lshlrev_b32 v30, 16, v47
  v_and_b32 v31, 0xffff0000, v47
  v_sub_f32 v16, v16, v8
  v_sub_f32 v17, v17, v8
  v_sub_f32 v18, v18, v8
  v_sub_f32 v19, v19, v8
  v_sub_f32 v20, v20, v8
  v_sub_f32 v21, v21, v8
  v_sub_f32 v22, v22, v8
  v_sub_f32 v23, v23, v8
  v_sub_f32 v24, v24, v8
  v_sub_f32 v25, v25, v8
  v_sub_f32 v26, v26, v8
  v_sub_f32 v27, v27, v8
  v_sub_f32 v28, v28, v8
  v_sub_f32 v29, v29, v8
  v_sub_f32 v30, v30, v8
  v_sub_f32 v31, v31, v8
  v_cvt_pk_bf16_f32 v32, v16, v17
  v_cvt_pk_bf16_f32 v33, v18, v19
  v_cvt_pk_bf16_f32 v34, v20, v21
  v_cvt_pk_bf16_f32 v35, v22, v23
  v_cvt_pk_bf16_f32 v36, v24, v25
  v_cvt_pk_bf16_f32 v37, v26, v27
  v_cvt_pk_bf16_f32 v38, v28, v29
  v_cvt_pk_bf16_f32 v39, v30, v31
  v_lshlrev_b32 v16, 16, v32
  v_and_b32 v17, 0xffff0000, v32
  v_lshlrev_b32 v18, 16, v33
  v_and_b32 v19, 0xffff0000, v33
  v_lshlrev_b32 v20, 16, v34
  v_and_b32 v21, 0xffff0000, v34
  v_lshlrev_b32 v22, 16, v35
  v_and_b32 v23, 0xffff0000, v35
  v_lshlrev_b32 v24, 16, v36
  v_and_b32 v25, 0xffff0000, v36
  v_lshlrev_b32 v26, 16, v37
  v_and_b32 v27, 0xffff0000, v37
  v_lshlrev_b32 v28, 16, v38
  v_and_b32 v29, 0xffff0000, v38
  v_lshlrev_b32 v30, 16, v39
  v_and_b32 v31, 0xffff0000, v39
  v_mul_f32 v16, v16, v9
  v_mul_f32 v17, v17, v9
  v_mul_f32 v18, v18, v9
  v_mul_f32 v19, v19, v9
  v_mul_f32 v20, v20, v9
  v_mul_f32 v21, v21, v9
  v_mul_f32 v22, v22, v9
  v_mul_f32 v23, v23, v9
  v_mul_f32 v24, v24, v9
  v_mul_f32 v25, v25, v9
  v_mul_f32 v26, v26, v9
  v_mul_f32 v27, v27, v9
  v_mul_f32 v28, v28, v9
  v_mul_f32 v29, v29, v9
  v_mul_f32 v30, v30, v9
  v_mul_f32 v31, v31, v9
  v_cvt_pk_bf16_f32 v32, v16, v17
  v_cvt_pk_bf16_f32 v33, v18, v19
  v_cvt_pk_bf16_f32 v34, v20, v21
  v_cvt_pk_bf16_f32 v35, v22, v23
  v_cvt_pk_bf16_f32 v36, v24, v25
  v_cvt_pk_bf16_f32 v37, v26, v27
  v_cvt_pk_bf16_f32 v38, v28, v29
  v_cvt_pk_bf16_f32 v39, v30, v31
  s_mov_b32 s6, 0x05040100
  s_mov_b32 s7, 0x07060302
  v_and_b32 v4, 31, v0
  v_mul_u32_u24 v4, 528, v4
  v_lshrrev_b32 v5, 5, v0
  v_lshl_add_u32 v4, v5, 8, v4
  s_lshl_b32 s34, s3, 2
  s_add_u32 s34, s34, 64
  v_add_u32 v4, s34, v4
  v_permlane32_swap_b32 v32, v36
  v_permlane32_swap_b32 v33, v37
  v_permlane32_swap_b32 v34, v38
  v_permlane32_swap_b32 v35, v39
  v_perm_b32 v16, v36, v32, s6
  ds_write_b32 v4, v16 offset:0
  v_perm_b32 v17, v36, v32, s7
  ds_write_b32 v4, v17 offset:16
  v_perm_b32 v18, v37, v33, s6
  ds_write_b32 v4, v18 offset:32
  v_perm_b32 v19, v37, v33, s7
  ds_write_b32 v4, v19 offset:48
  v_perm_b32 v20, v38, v34, s6
  ds_write_b32 v4, v20 offset:128
  v_perm_b32 v21, v38, v34, s7
  ds_write_b32 v4, v21 offset:144
  v_perm_b32 v22, v39, v35, s6
  ds_write_b32 v4, v22 offset:160
  v_perm_b32 v23, v39, v35, s7
  ds_write_b32 v4, v23 offset:176
  v_permlane32_swap_b32 v40, v44
  v_permlane32_swap_b32 v41, v45
  v_permlane32_swap_b32 v42, v46
  v_permlane32_swap_b32 v43, v47
  v_perm_b32 v24, v44, v40, s6
  ds_write_b32 v4, v24 offset:64
  v_perm_b32 v25, v44, v40, s7
  ds_write_b32 v4, v25 offset:80
  v_perm_b32 v26, v45, v41, s6
  ds_write_b32 v4, v26 offset:96
  v_perm_b32 v27, v45, v41, s7
  ds_write_b32 v4, v27 offset:112
  v_perm_b32 v28, v46, v42, s6
  ds_write_b32 v4, v28 offset:192
  v_perm_b32 v29, v46, v42, s7
  ds_write_b32 v4, v29 offset:208
  v_perm_b32 v30, v47, v43, s6
  ds_write_b32 v4, v30 offset:224
  v_perm_b32 v31, v47, v43, s7
  ds_write_b32 v4, v31 offset:240
  s_cmp_lg_u32 s3, 0
  s_cbranch_scc1 L_rl_3
  s_waitcnt vmcnt(0)
  v_readfirstlane_b32 s5, v3
  s_cmp_lt_u32 s5, 32
  s_cbranch_scc1 L_rok_4
  s_mov_b64 exec, 1
  v_mov_b32 v2, 32
  v_mov_b32 v3, 1
  buffer_atomic_add v3, v2, s[12:15], 0 offen sc0 sc1
  s_waitcnt vmcnt(0)
  v_readfirstlane_b32 s33, v3
  s_mov_b64 exec, -1
  s_mov_b32 s7, 0
  v_lshlrev_b32 v2, 2, v0
L_row_5:
  buffer_load_dword v3, v2, s[12:15], 0 offen sc1
  s_waitcnt vmcnt(0)
  s_mov_b32 s34, 0
  v_readlane_b32 s40, v3, 0
  v_readlane_b32 s41, v3, 16
  v_readlane_b32 s42, v3, 32
  v_readlane_b32 s43, v3, 48
  v_readlane_b32 s44, v3, 1
  v_readlane_b32 s45, v3, 17
  v_readlane_b32 s46, v3, 33
  v_readlane_b32 s47, v3, 49
  s_add_u32 s34, s34, s40
  s_add_u32 s34, s34, s41
  s_add_u32 s34, s34, s42
  s_add_u32 s34, s34, s43
  s_add_u32 s34, s34, s44
  s_add_u32 s34, s34, s45
  s_add_u32 s34, s34, s46
  s_add_u32 s34, s34, s47
  s_cmp_eq_u32 s34, 256
  s_cbranch_scc1 L_row2_6
  s_add_u32 s7, s7, 1
  s_cmp_lt_u32 s7, 131072
  s_cbranch_scc1 L_row_5
  s_mov_b32 s6, 1
  s_branch L_err
L_row2_6:
  s_min_u32 s5, s40, 32
  s_sub_u32 s35, 32, s5
  s_cmp_ge_u32 s33, s35
  s_cbranch_scc1 L_ovn_7
  s_add_u32 s5, s5, s33
  s_mov_b32 s4, 0
  s_branch L_rok_4
L_ovn_7:
  s_sub_u32 s33, s33, s35
  s_min_u32 s5, s41, 32
  s_sub_u32 s35, 32, s5
  s_cmp_ge_u32 s33, s35
  s_cbranch_scc1 L_ovn_8
  s_add_u32 s5, s5, s33
  s_mov_b32 s4, 1
  s_branch L_rok_4
L_ovn_8:
  s_sub_u32 s33, s33, s35
  s_min_u32 s5, s42, 32
  s_sub_u32 s35, 32, s5
  s_cmp_ge_u32 s33, s35
  s_cbranch_scc1 L_ovn_9
  s_add_u32 s5, s5, s33
  s_mov_b32 s4, 2
  s_branch L_rok_4
L_ovn_9:
  s_sub_u32 s33, s33, s35
  s_min_u32 s5, s43, 32
  s_sub_u32 s35, 32, s5
  s_cmp_ge_u32 s33, s35
  s_cbranch_scc1 L_ovn_10
  s_add_u32 s5, s5, s33
  s_mov_b32 s4, 3
  s_branch L_rok_4
L_ovn_10:
  s_sub_u32 s33, s33, s35
  s_min_u32 s5, s44, 32
  s_sub_u32 s35, 32, s5
  s_cmp_ge_u32 s33, s35
  s_cbranch_scc1 L_ovn_11
  s_add_u32 s5, s5, s33
  s_mov_b32 s4, 4
  s_branch L_rok_4
L_ovn_11:
  s_sub_u32 s33, s33, s35
  s_min_u32 s5, s45, 32
  s_sub_u32 s35, 32, s5
  s_cmp_ge_u32 s33, s35
  s_cbranch_scc1 L_ovn_12
  s_add_u32 s5, s5, s33
  s_mov_b32 s4, 5
  s_branch L_rok_4
L_ovn_12:
  s_sub_u32 s33, s33, s35
  s_min_u32 s5, s46, 32
  s_sub_u32 s35, 32, s5
  s_cmp_ge_u32 s33, s35
  s_cbranch_scc1 L_ovn_13
  s_add_u32 s5, s5, s33
  s_mov_b32 s4, 6
  s_branch L_rok_4
L_ovn_13:
  s_sub_u32 s33, s33, s35
  s_min_u32 s5, s47, 32
  s_sub_u32 s35, 32, s5
  s_cmp_ge_u32 s33, s35
  s_cbranch_scc1 L_ovn_14
  s_add_u32 s5, s5, s33
  s_mov_b32 s4, 7
  s_branch L_rok_4
L_ovn_14:
  s_sub_u32 s33, s33, s35
  s_mov_b32 s6, 2
  s_branch L_err
L_rok_4:
  s_lshl_b32 s6, s4, 5
  s_add_u32 s6, s6, s5
  v_mov_b32 v2, 0
  v_mov_b32 v3, s6
  ds_write_b32 v2, v3
L_rl_3:
  v_lshrrev_b32 v4, 5, v0
  s_lshl_b32 s6, s3, 1
  v_add_u32 v4, s6, v4
  v_mul_u32_u24 v4, 528, v4
  v_and_b32 v5, 31, v0
  v_lshl_add_u32 v4, v5, 4, v4
  v_lshrrev_b32 v5, 3, v0
  v_lshlrev_b32 v5, 15, v5
  v_and_b32 v6, 7, v0
  v_lshl_or_b32 v5, v6, 4, v5
  s_lshl_b32 s6, s3, 18
  s_lshl_b32 s7, s2, 7
  s_add_u32 s6, s6, s7
  s_add_u32 s6, s6, 0xb000000
  s_waitcnt lgkmcnt(0)
  s_barrier
  ds_read_b128 v[16:19], v4 offset:64
  ds_read_b128 v[20:23], v4 offset:4288
  ds_read_b128 v[24:27], v4 offset:8512
  ds_read_b128 v[28:31], v4 offset:12736
  s_waitcnt lgkmcnt(3)
  buffer_store_dwordx4 v[16:19], v5, s[8:11], s6 offen sc1
  s_add_u32 s6, s6, 1048576
  s_waitcnt lgkmcnt(2)
  buffer_store_dwordx4 v[20:23], v5, s[8:11], s6 offen sc1
  s_add_u32 s6, s6, 1048576
  s_waitcnt lgkmcnt(1)
  buffer_store_dwordx4 v[24:27], v5, s[8:11], s6 offen sc1
  s_add_u32 s6, s6, 1048576
  s_waitcnt lgkmcnt(0)
  buffer_store_dwordx4 v[28:31], v5, s[8:11], s6 offen sc1
  s_add_u32 s6, s6, 1048576
  v_mov_b32 v2, 0
  ds_read_b32 v3, v2
  s_waitcnt lgkmcnt(0)
  v_readfirstlane_b32 s6, v3
  s_barrier
  s_lshr_b32 s4, s6, 5
  s_and_b32 s4, s4, 7
  s_and_b32 s5, s6, 31
  s_cmp_eq_u32 s4, 0
  s_cbranch_scc1 L_rec
  s_cmp_eq_u32 s4, 1
  s_cbranch_scc1 L_rec
  s_cmp_eq_u32 s4, 2
  s_cbranch_scc1 L_p
  s_cmp_eq_u32 s4, 3
  s_cbranch_scc1 L_p
  s_cmp_eq_u32 s4, 4
  s_cbranch_scc1 L_p
  s_cmp_eq_u32 s4, 5
  s_cbranch_scc1 L_p
  s_cmp_eq_u32 s4, 6
  s_cbranch_scc1 L_o
  s_cmp_eq_u32 s4, 7
  s_cbranch_scc1 L_c
  s_waitcnt vmcnt(0)
  s_barrier
  s_cmp_lg_u32 s3, 0
  s_cbranch_scc1 L_sd_15
  s_mov_b64 exec, 1
  s_and_b32 s6, s4, 3
  s_lshl_b32 s6, s6, 6
  v_mov_b32 v2, 16
  v_mov_b32 v3, 1
  buffer_atomic_add v3, v2, s[12:15], s6 offen sc1
  s_mov_b64 exec, -1
L_sd_15:
  s_waitcnt vmcnt(0)
  s_endpgm
L_err:
  s_mov_b64 exec, 1
  s_lshl_b32 s7, s4, 2
  s_add_u32 s7, s7, 160
  v_mov_b32 v2, s7
  v_mov_b32 v3, s6
  buffer_store_dword v3, v2, s[12:15], 0 offen sc1
  s_waitcnt vmcnt(0)
L_end:
  s_endpgm
L_rec:
  s_and_b32 s58, s4, 1
  s_mul_i32 s35, s58, 0x2000000
  s_add_u32 s35, s35, 0x800000
  s_mul_i32 s36, s58, 0x1000000
  s_add_u32 s36, s36, 0x4800000
  s_mul_i32 s39, s58, 0x40000
  s_add_u32 s39, s39, 0x740000
  s_mul_i32 s44, s58, 0x2000
  s_add_u32 s44, s44, 0x708000
  s_lshl_b32 s6, s5, 14
  s_lshl_b32 s7, s3, 11
  s_add_u32 s35, s35, s6
  s_add_u32 s35, s35, s7
  s_mov_b32 s48, s7
  s_lshl_b32 s6, s5, 8
  s_add_u32 s43, s44, s6
  s_add_u32 s44, s44, s7
  s_lshl_b32 s7, s5, 13
  s_add_u32 s41, s39, s7
  s_add_u32 s42, s41, 4096
  s_add_u32 s39, s39, s6
  s_add_u32 s40, s39, 32768
  s_lshl_b32 s7, s5, 12
  s_add_u32 s36, s36, s7
  s_lshl_b32 s7, s3, 10
  s_add_u32 s36, s36, s7
  s_add_u32 s53, s48, 8192
  s_add_u32 s37, s48, 16384
  s_lshl_b32 s6, s58, 13
  s_lshl_b32 s7, s5, 7
  s_add_u32 s38, s6, s7
  s_add_u32 s38, s38, 0x714000
  s_mov_b32 s54, 0x00ff00ff
  s_mov_b32 s55, 0x00ff00ff
  s_mov_b32 s56, 0x33333333
  s_mov_b32 s57, 0x33333333
  s_mov_b32 s34, 0x3e0293ee
  s_add_u32 s6, s3, 1
  s_and_b32 s6, s6, 3
  s_lshl_b32 s45, s6, 11
  s_add_u32 s6, s3, 2
  s_and_b32 s6, s6, 3
  s_lshl_b32 s46, s6, 11
  s_add_u32 s6, s3, 3
  s_and_b32 s6, s6, 3
  s_lshl_b32 s47, s6, 11
  v_and_b32 v16, 15, v0
  v_lshrrev_b32 v17, 4, v0
  v_lshlrev_b32 v1, 4, v0
  s_lshl_b32 s6, s3, 8
  s_add_u32 s6, s6, 24576
  v_mul_u32_u24 v18, 1088, v17
  v_lshl_add_u32 v18, v16, 3, v18
  v_add_u32 v2, s6, v18
  v_and_b32 v18, 3, v0
  v_mul_u32_u24 v18, 1088, v18
  v_bfe_u32 v19, v0, 2, 3
  v_lshl_add_u32 v18, v19, 3, v18
  v_lshrrev_b32 v19, 5, v0
  v_lshl_add_u32 v18, v19, 7, v18
  v_add_u32 v3, 24576, v18
  v_and_b32 v18, 7, v0
  v_bfe_u32 v19, v0, 3, 1
  v_lshl_or_b32 v18, v19, 4, v18
  v_lshlrev_b32 v18, 4, v18
  v_lshl_add_u32 v18, v17, 9, v18
  v_add_u32 v4, 8192, v18
  v_lshrrev_b32 v18, 2, v16
  v_and_b32 v19, 1, v0
  v_lshl_or_b32 v18, v18, 1, v19
  v_mul_u32_u24 v18, 288, v18
  v_lshl_add_u32 v18, v17, 2, v18
  s_lshl_b32 s6, s3, 6
  s_add_u32 s6, s6, 28928
  v_add_u32 v5, s6, v18
  v_lshrrev_b32 v18, 1, v16
  v_mul_u32_u24 v18, 288, v18
  v_lshl_add_u32 v18, v17, 5, v18
  v_lshl_add_u32 v18, v19, 4, v18
  v_add_u32 v6, 28928, v18
  s_lshl_b32 s6, s3, 15
  s_add_u32 s6, s6, 32768
  v_add_u32 v7, s6, v1
  v_lshrrev_b32 v18, 2, v16
  v_lshlrev_b32 v18, 13, v18
  v_and_b32 v19, 3, v0
  v_lshl_or_b32 v19, v17, 2, v19
  v_lshl_or_b32 v18, v19, 4, v18
  s_lshl_b32 s6, s3, 16
  v_add_u32 v8, s6, v18
  v_lshlrev_b32 v18, 4, v16
  v_lshl_or_b32 v18, v17, 9, v18
  v_add_u32 v9, s37, v18
  v_mov_b32 v10, 0x3f803f80
  v_mov_b32 v11, 0x3f803f80
  v_mov_b32 v12, 0
  v_mov_b32 v13, 0
  v_mov_b32 v14, 0
  v_mov_b32 v15, 0
  buffer_store_dwordx4 v[12:15], v8, s[8:11], s39 offen sc1
  buffer_store_dwordx4 v[12:15], v8, s[8:11], s40 offen sc1
  s_add_u32 s6, s36, 0
  buffer_store_dwordx4 v[12:15], v1, s[8:11], s6 offen sc1
  s_add_u32 s6, s36, 131072
  buffer_store_dwordx4 v[12:15], v1, s[8:11], s6 offen sc1
  s_add_u32 s6, s36, 262144
  buffer_store_dwordx4 v[12:15], v1, s[8:11], s6 offen sc1
  s_add_u32 s6, s36, 393216
  buffer_store_dwordx4 v[12:15], v1, s[8:11], s6 offen sc1
  s_mov_b64 exec, 0xffff
  buffer_store_dwordx4 v[12:15], v1, s[8:11], s43 offen sc1
  s_mov_b64 exec, -1
  s_cmp_eq_u32 s4, 1
  s_cbranch_scc1 L_pro
  s_branch L_rec3
L_rec2:
  v_and_b32 v16, 15, v0
  v_lshrrev_b32 v17, 4, v0
  v_lshlrev_b32 v1, 4, v0
  s_lshl_b32 s6, s3, 8
  s_add_u32 s6, s6, 24576
  v_mul_u32_u24 v18, 1088, v17
  v_lshl_add_u32 v18, v16, 3, v18
  v_add_u32 v2, s6, v18
  v_and_b32 v18, 3, v0
  v_mul_u32_u24 v18, 1088, v18
  v_bfe_u32 v19, v0, 2, 3
  v_lshl_add_u32 v18, v19, 3, v18
  v_lshrrev_b32 v19, 5, v0
  v_lshl_add_u32 v18, v19, 7, v18
  v_add_u32 v3, 24576, v18
  v_and_b32 v18, 7, v0
  v_bfe_u32 v19, v0, 3, 1
  v_lshl_or_b32 v18, v19, 4, v18
  v_lshlrev_b32 v18, 4, v18
  v_lshl_add_u32 v18, v17, 9, v18
  v_add_u32 v4, 8192, v18
  v_lshrrev_b32 v18, 2, v16
  v_and_b32 v19, 1, v0
  v_lshl_or_b32 v18, v18, 1, v19
  v_mul_u32_u24 v18, 288, v18
  v_lshl_add_u32 v18, v17, 2, v18
  s_lshl_b32 s6, s3, 6
  s_add_u32 s6, s6, 28928
  v_add_u32 v5, s6, v18
  v_lshrrev_b32 v18, 1, v16
  v_mul_u32_u24 v18, 288, v18
  v_lshl_add_u32 v18, v17, 5, v18
  v_lshl_add_u32 v18, v19, 4, v18
  v_add_u32 v6, 28928, v18
  s_lshl_b32 s6, s3, 15
  s_add_u32 s6, s6, 32768
  v_add_u32 v7, s6, v1
  v_lshrrev_b32 v18, 2, v16
  v_lshlrev_b32 v18, 13, v18
  v_and_b32 v19, 3, v0
  v_lshl_or_b32 v19, v17, 2, v19
  v_lshl_or_b32 v18, v19, 4, v18
  s_lshl_b32 s6, s3, 16
  v_add_u32 v8, s6, v18
  v_lshlrev_b32 v18, 4, v16
  v_lshl_or_b32 v18, v17, 9, v18
  v_add_u32 v9, s37, v18
  v_mov_b32 v10, 0x3f803f80
  v_mov_b32 v11, 0x3f803f80
  v_mov_b32 v12, 0
  v_mov_b32 v13, 0
  v_mov_b32 v14, 0
  v_mov_b32 v15, 0
L_rec3:
  s_mov_b32 s16, s82
  s_mov_b32 s17, s83
  s_mov_b32 s18, 0x400000
  s_mov_b32 s19, 0x20000
  s_mov_b32 s20, s84
  s_mov_b32 s21, s85
  s_mov_b32 s22, 0x400000
  s_mov_b32 s23, 0x20000
  s_mov_b32 s24, s86
  s_mov_b32 s25, s87
  s_mov_b32 s26, 0x400000
  s_mov_b32 s27, 0x20000
  s_mov_b32 s28, s88
  s_mov_b32 s29, s89
  s_mov_b32 s30, 0x400000
  s_mov_b32 s31, 0x20000
  s_lshr_b32 s6, 0x72, s4
  s_bitcmp1_b32 s6, 0
  s_cbranch_scc1 L_rdn_16
  s_waitcnt vmcnt(0)
  s_barrier
  s_cmp_lg_u32 s3, 0
  s_cbranch_scc1 L_sd_17
  s_mov_b64 exec, 1
  s_and_b32 s6, s4, 3
  s_lshl_b32 s6, s6, 6
  v_mov_b32 v18, 16
  v_mov_b32 v19, 1
  buffer_atomic_add v19, v18, s[12:15], s6 offen sc1
  s_mov_b64 exec, -1
L_sd_17:
L_rdn_16:
  v_bfe_u32 v16, v0, 4, 1
  v_lshrrev_b32 v17, 5, v0
  v_lshl_or_b32 v18, v17, 5, v16
  s_and_b32 s6, s3, 1
  s_lshr_b32 s7, s3, 1
  s_lshl_b32 s60, s6, 4
  s_lshl_b32 s7, s7, 6
  s_add_u32 s7, s7, s60
  v_add_u32 v18, s7, v18
  v_lshlrev_b32 v18, 13, v18
  v_lshrrev_b32 v19, 4, v0
  s_lshl_b32 s6, s6, 2
  v_or_b32 v19, s6, v19
  v_lshlrev_b32 v19, 1, v19
  v_and_b32 v116, 15, v0
  v_xor_b32 v19, v19, v116
  v_lshl_or_b32 v116, v19, 4, v18
  v_bfe_u32 v18, v0, 2, 2
  v_lshl_or_b32 v19, v16, 2, v18
  v_lshl_or_b32 v18, v17, 3, v18
  v_lshl_or_b32 v18, v16, 5, v18
  v_lshlrev_b32 v18, 8, v18
  s_lshl_b32 s6, s3, 1
  v_xor_b32 v19, s6, v19
  v_lshl_or_b32 v18, v19, 5, v18
  v_and_b32 v19, 3, v0
  v_lshl_or_b32 v18, v19, 3, v18
  v_add_u32 v120, 32768, v18
  v_xor_b32 v121, 32, v120
  v_add_u32 v122, 0x10000, v120
  v_add_u32 v123, 0x10000, v121
  v_lshrrev_b32 v16, 4, v0
  v_and_b32 v17, 15, v0
  v_lshlrev_b32 v18, 1, v16
  v_xor_b32 v17, v17, v18
  v_lshlrev_b32 v17, 4, v17
  v_lshl_or_b32 v118, v16, 10, v17
  v_xor_b32 v119, 0x80, v118
  s_lshl_b32 s60, s3, 13
  s_add_u32 s60, s60, 32768
  v_bfe_u32 v17, v0, 2, 2
  v_bfe_u32 v18, v0, 4, 1
  v_lshl_or_b32 v18, v18, 2, v17
  v_lshl_or_b32 v17, v16, 3, v17
  v_lshlrev_b32 v17, 8, v17
  v_lshl_or_b32 v17, v18, 5, v17
  v_lshl_or_b32 v17, v19, 3, v17
  v_add_u32 v124, s60, v17
  v_add_u32 v127, s60, v1
  s_lshl_b32 s63, s5, 8
  s_add_u32 s61, s63, 0
  s_add_u32 m0, s60, 0
  s_add_u32 s62, s61, 0
  buffer_load_dwordx4 v116, s[16:19], s62 offen lds
  s_add_u32 m0, s60, 1024
  s_add_u32 s62, s61, 16384
  buffer_load_dwordx4 v116, s[16:19], s62 offen lds
  s_add_u32 m0, s60, 2048
  s_add_u32 s62, s61, 32768
  buffer_load_dwordx4 v116, s[16:19], s62 offen lds
  s_add_u32 m0, s60, 3072
  s_add_u32 s62, s61, 49152
  buffer_load_dwordx4 v116, s[16:19], s62 offen lds
  s_add_u32 m0, s60, 4096
  s_add_u32 s62, s61, 65536
  buffer_load_dwordx4 v116, s[16:19], s62 offen lds
  s_add_u32 m0, s60, 5120
  s_add_u32 s62, s61, 81920
  buffer_load_dwordx4 v116, s[16:19], s62 offen lds
  s_add_u32 m0, s60, 6144
  s_add_u32 s62, s61, 98304
  buffer_load_dwordx4 v116, s[16:19], s62 offen lds
  s_add_u32 m0, s60, 7168
  s_add_u32 s62, s61, 114688
  buffer_load_dwordx4 v116, s[16:19], s62 offen lds
  s_add_u32 s61, s63, 1048576
  s_add_u32 m0, s60, 32768
  s_add_u32 s62, s61, 0
  buffer_load_dwordx4 v116, s[16:19], s62 offen lds
  s_add_u32 m0, s60, 33792
  s_add_u32 s62, s61, 16384
  buffer_load_dwordx4 v116, s[16:19], s62 offen lds
  s_add_u32 m0, s60, 34816
  s_add_u32 s62, s61, 32768
  buffer_load_dwordx4 v116, s[16:19], s62 offen lds
  s_add_u32 m0, s60, 35840
  s_add_u32 s62, s61, 49152
  buffer_load_dwordx4 v116, s[16:19], s62 offen lds
  s_add_u32 m0, s60, 36864
  s_add_u32 s62, s61, 65536
  buffer_load_dwordx4 v116, s[16:19], s62 offen lds
  s_add_u32 m0, s60, 37888
  s_add_u32 s62, s61, 81920
  buffer_load_dwordx4 v116, s[16:19], s62 offen lds
  s_add_u32 m0, s60, 38912
  s_add_u32 s62, s61, 98304
  buffer_load_dwordx4 v116, s[16:19], s62 offen lds
  s_add_u32 m0, s60, 39936
  s_add_u32 s62, s61, 114688
  buffer_load_dwordx4 v116, s[16:19], s62 offen lds
  s_add_u32 s61, s63, 2097152
  s_add_u32 m0, s60, 65536
  s_add_u32 s62, s61, 0
  buffer_load_dwordx4 v116, s[16:19], s62 offen lds
  s_add_u32 m0, s60, 66560
  s_add_u32 s62, s61, 16384
  buffer_load_dwordx4 v116, s[16:19], s62 offen lds
  s_add_u32 m0, s60, 67584
  s_add_u32 s62, s61, 32768
  buffer_load_dwordx4 v116, s[16:19], s62 offen lds
  s_add_u32 m0, s60, 68608
  s_add_u32 s62, s61, 49152
  buffer_load_dwordx4 v116, s[16:19], s62 offen lds
  s_add_u32 m0, s60, 69632
  s_add_u32 s62, s61, 65536
  buffer_load_dwordx4 v116, s[16:19], s62 offen lds
  s_add_u32 m0, s60, 70656
  s_add_u32 s62, s61, 81920
  buffer_load_dwordx4 v116, s[16:19], s62 offen lds
  s_add_u32 m0, s60, 71680
  s_add_u32 s62, s61, 98304
  buffer_load_dwordx4 v116, s[16:19], s62 offen lds
  s_add_u32 m0, s60, 72704
  s_add_u32 s62, s61, 114688
  buffer_load_dwordx4 v116, s[16:19], s62 offen lds
  s_waitcnt vmcnt(16)
  s_barrier
  s_add_u32 s61, s63, 3145728
  s_add_u32 m0, s60, 98304
  s_add_u32 s62, s61, 0
  buffer_load_dwordx4 v116, s[16:19], s62 offen lds
  s_add_u32 m0, s60, 99328
  s_add_u32 s62, s61, 16384
  buffer_load_dwordx4 v116, s[16:19], s62 offen lds
  s_add_u32 m0, s60, 100352
  s_add_u32 s62, s61, 32768
  buffer_load_dwordx4 v116, s[16:19], s62 offen lds
  s_add_u32 m0, s60, 101376
  s_add_u32 s62, s61, 49152
  buffer_load_dwordx4 v116, s[16:19], s62 offen lds
  s_add_u32 m0, s60, 102400
  s_add_u32 s62, s61, 65536
  buffer_load_dwordx4 v116, s[16:19], s62 offen lds
  s_add_u32 m0, s60, 103424
  s_add_u32 s62, s61, 81920
  buffer_load_dwordx4 v116, s[16:19], s62 offen lds
  s_add_u32 m0, s60, 104448
  s_add_u32 s62, s61, 98304
  buffer_load_dwordx4 v116, s[16:19], s62 offen lds
  s_add_u32 m0, s60, 105472
  s_add_u32 s62, s61, 114688
  buffer_load_dwordx4 v116, s[16:19], s62 offen lds
  s_cmp_eq_u32 s3, 1
  s_cbranch_scc1 L_lv_20
  s_cmp_eq_u32 s3, 2
  s_cbranch_scc1 L_lv_21
  s_cmp_eq_u32 s3, 3
  s_cbranch_scc1 L_lv_22
L_lv_19:
  ds_read_b64_tr_b16 a[0:1], v120 offset:0
  ds_read_b64_tr_b16 a[2:3], v120 offset:1024
  ds_read_b64_tr_b16 a[4:5], v120 offset:4096
  ds_read_b64_tr_b16 a[6:7], v120 offset:5120
  ds_read_b64_tr_b16 a[8:9], v121 offset:0
  ds_read_b64_tr_b16 a[10:11], v121 offset:1024
  ds_read_b64_tr_b16 a[12:13], v121 offset:4096
  ds_read_b64_tr_b16 a[14:15], v121 offset:5120
  ds_read_b64_tr_b16 a[16:17], v120 offset:16384
  ds_read_b64_tr_b16 a[18:19], v120 offset:17408
  ds_read_b64_tr_b16 a[20:21], v120 offset:20480
  ds_read_b64_tr_b16 a[22:23], v120 offset:21504
  ds_read_b64_tr_b16 a[24:25], v121 offset:16384
  ds_read_b64_tr_b16 a[26:27], v121 offset:17408
  ds_read_b64_tr_b16 a[28:29], v121 offset:20480
  ds_read_b64_tr_b16 a[30:31], v121 offset:21504
  s_branch L_lw_18
L_lv_20:
  ds_read_b64_tr_b16 a[96:97], v120 offset:0
  ds_read_b64_tr_b16 a[98:99], v120 offset:1024
  ds_read_b64_tr_b16 a[100:101], v120 offset:4096
  ds_read_b64_tr_b16 a[102:103], v120 offset:5120
  ds_read_b64_tr_b16 a[104:105], v121 offset:0
  ds_read_b64_tr_b16 a[106:107], v121 offset:1024
  ds_read_b64_tr_b16 a[108:109], v121 offset:4096
  ds_read_b64_tr_b16 a[110:111], v121 offset:5120
  ds_read_b64_tr_b16 a[112:113], v120 offset:16384
  ds_read_b64_tr_b16 a[114:115], v120 offset:17408
  ds_read_b64_tr_b16 a[116:117], v120 offset:20480
  ds_read_b64_tr_b16 a[118:119], v120 offset:21504
  ds_read_b64_tr_b16 a[120:121], v121 offset:16384
  ds_read_b64_tr_b16 a[122:123], v121 offset:17408
  ds_read_b64_tr_b16 a[124:125], v121 offset:20480
  ds_read_b64_tr_b16 a[126:127], v121 offset:21504
  s_branch L_lw_18
L_lv_21:
  ds_read_b64_tr_b16 a[64:65], v120 offset:0
  ds_read_b64_tr_b16 a[66:67], v120 offset:1024
  ds_read_b64_tr_b16 a[68:69], v120 offset:4096
  ds_read_b64_tr_b16 a[70:71], v120 offset:5120
  ds_read_b64_tr_b16 a[72:73], v121 offset:0
  ds_read_b64_tr_b16 a[74:75], v121 offset:1024
  ds_read_b64_tr_b16 a[76:77], v121 offset:4096
  ds_read_b64_tr_b16 a[78:79], v121 offset:5120
  ds_read_b64_tr_b16 a[80:81], v120 offset:16384
  ds_read_b64_tr_b16 a[82:83], v120 offset:17408
  ds_read_b64_tr_b16 a[84:85], v120 offset:20480
  ds_read_b64_tr_b16 a[86:87], v120 offset:21504
  ds_read_b64_tr_b16 a[88:89], v121 offset:16384
  ds_read_b64_tr_b16 a[90:91], v121 offset:17408
  ds_read_b64_tr_b16 a[92:93], v121 offset:20480
  ds_read_b64_tr_b16 a[94:95], v121 offset:21504
  s_branch L_lw_18
L_lv_22:
  ds_read_b64_tr_b16 a[32:33], v120 offset:0
  ds_read_b64_tr_b16 a[34:35], v120 offset:1024
  ds_read_b64_tr_b16 a[36:37], v120 offset:4096
  ds_read_b64_tr_b16 a[38:39], v120 offset:5120
  ds_read_b64_tr_b16 a[40:41], v121 offset:0
  ds_read_b64_tr_b16 a[42:43], v121 offset:1024
  ds_read_b64_tr_b16 a[44:45], v121 offset:4096
  ds_read_b64_tr_b16 a[46:47], v121 offset:5120
  ds_read_b64_tr_b16 a[48:49], v120 offset:16384
  ds_read_b64_tr_b16 a[50:51], v120 offset:17408
  ds_read_b64_tr_b16 a[52:53], v120 offset:20480
  ds_read_b64_tr_b16 a[54:55], v120 offset:21504
  ds_read_b64_tr_b16 a[56:57], v121 offset:16384
  ds_read_b64_tr_b16 a[58:59], v121 offset:17408
  ds_read_b64_tr_b16 a[60:61], v121 offset:20480
  ds_read_b64_tr_b16 a[62:63], v121 offset:21504
L_lw_18:
  s_waitcnt lgkmcnt(0)
  s_waitcnt vmcnt(16)
  s_barrier
  s_add_u32 s61, s63, 0
  s_add_u32 m0, s60, 0
  s_add_u32 s62, s61, 0
  buffer_load_dwordx4 v116, s[20:23], s62 offen lds
  s_add_u32 m0, s60, 1024
  s_add_u32 s62, s61, 16384
  buffer_load_dwordx4 v116, s[20:23], s62 offen lds
  s_add_u32 m0, s60, 2048
  s_add_u32 s62, s61, 32768
  buffer_load_dwordx4 v116, s[20:23], s62 offen lds
  s_add_u32 m0, s60, 3072
  s_add_u32 s62, s61, 49152
  buffer_load_dwordx4 v116, s[20:23], s62 offen lds
  s_add_u32 m0, s60, 4096
  s_add_u32 s62, s61, 65536
  buffer_load_dwordx4 v116, s[20:23], s62 offen lds
  s_add_u32 m0, s60, 5120
  s_add_u32 s62, s61, 81920
  buffer_load_dwordx4 v116, s[20:23], s62 offen lds
  s_add_u32 m0, s60, 6144
  s_add_u32 s62, s61, 98304
  buffer_load_dwordx4 v116, s[20:23], s62 offen lds
  s_add_u32 m0, s60, 7168
  s_add_u32 s62, s61, 114688
  buffer_load_dwordx4 v116, s[20:23], s62 offen lds
  s_cmp_eq_u32 s3, 1
  s_cbranch_scc1 L_lv_25
  s_cmp_eq_u32 s3, 2
  s_cbranch_scc1 L_lv_26
  s_cmp_eq_u32 s3, 3
  s_cbranch_scc1 L_lv_27
L_lv_24:
  ds_read_b64_tr_b16 a[32:33], v120 offset:32768
  ds_read_b64_tr_b16 a[34:35], v120 offset:33792
  ds_read_b64_tr_b16 a[36:37], v120 offset:36864
  ds_read_b64_tr_b16 a[38:39], v120 offset:37888
  ds_read_b64_tr_b16 a[40:41], v121 offset:32768
  ds_read_b64_tr_b16 a[42:43], v121 offset:33792
  ds_read_b64_tr_b16 a[44:45], v121 offset:36864
  ds_read_b64_tr_b16 a[46:47], v121 offset:37888
  ds_read_b64_tr_b16 a[48:49], v120 offset:49152
  ds_read_b64_tr_b16 a[50:51], v120 offset:50176
  ds_read_b64_tr_b16 a[52:53], v120 offset:53248
  ds_read_b64_tr_b16 a[54:55], v120 offset:54272
  ds_read_b64_tr_b16 a[56:57], v121 offset:49152
  ds_read_b64_tr_b16 a[58:59], v121 offset:50176
  ds_read_b64_tr_b16 a[60:61], v121 offset:53248
  ds_read_b64_tr_b16 a[62:63], v121 offset:54272
  s_branch L_lw_23
L_lv_25:
  ds_read_b64_tr_b16 a[0:1], v120 offset:32768
  ds_read_b64_tr_b16 a[2:3], v120 offset:33792
  ds_read_b64_tr_b16 a[4:5], v120 offset:36864
  ds_read_b64_tr_b16 a[6:7], v120 offset:37888
  ds_read_b64_tr_b16 a[8:9], v121 offset:32768
  ds_read_b64_tr_b16 a[10:11], v121 offset:33792
  ds_read_b64_tr_b16 a[12:13], v121 offset:36864
  ds_read_b64_tr_b16 a[14:15], v121 offset:37888
  ds_read_b64_tr_b16 a[16:17], v120 offset:49152
  ds_read_b64_tr_b16 a[18:19], v120 offset:50176
  ds_read_b64_tr_b16 a[20:21], v120 offset:53248
  ds_read_b64_tr_b16 a[22:23], v120 offset:54272
  ds_read_b64_tr_b16 a[24:25], v121 offset:49152
  ds_read_b64_tr_b16 a[26:27], v121 offset:50176
  ds_read_b64_tr_b16 a[28:29], v121 offset:53248
  ds_read_b64_tr_b16 a[30:31], v121 offset:54272
  s_branch L_lw_23
L_lv_26:
  ds_read_b64_tr_b16 a[96:97], v120 offset:32768
  ds_read_b64_tr_b16 a[98:99], v120 offset:33792
  ds_read_b64_tr_b16 a[100:101], v120 offset:36864
  ds_read_b64_tr_b16 a[102:103], v120 offset:37888
  ds_read_b64_tr_b16 a[104:105], v121 offset:32768
  ds_read_b64_tr_b16 a[106:107], v121 offset:33792
  ds_read_b64_tr_b16 a[108:109], v121 offset:36864
  ds_read_b64_tr_b16 a[110:111], v121 offset:37888
  ds_read_b64_tr_b16 a[112:113], v120 offset:49152
  ds_read_b64_tr_b16 a[114:115], v120 offset:50176
  ds_read_b64_tr_b16 a[116:117], v120 offset:53248
  ds_read_b64_tr_b16 a[118:119], v120 offset:54272
  ds_read_b64_tr_b16 a[120:121], v121 offset:49152
  ds_read_b64_tr_b16 a[122:123], v121 offset:50176
  ds_read_b64_tr_b16 a[124:125], v121 offset:53248
  ds_read_b64_tr_b16 a[126:127], v121 offset:54272
  s_branch L_lw_23
L_lv_27:
  ds_read_b64_tr_b16 a[64:65], v120 offset:32768
  ds_read_b64_tr_b16 a[66:67], v120 offset:33792
  ds_read_b64_tr_b16 a[68:69], v120 offset:36864
  ds_read_b64_tr_b16 a[70:71], v120 offset:37888
  ds_read_b64_tr_b16 a[72:73], v121 offset:32768
  ds_read_b64_tr_b16 a[74:75], v121 offset:33792
  ds_read_b64_tr_b16 a[76:77], v121 offset:36864
  ds_read_b64_tr_b16 a[78:79], v121 offset:37888
  ds_read_b64_tr_b16 a[80:81], v120 offset:49152
  ds_read_b64_tr_b16 a[82:83], v120 offset:50176
  ds_read_b64_tr_b16 a[84:85], v120 offset:53248
  ds_read_b64_tr_b16 a[86:87], v120 offset:54272
  ds_read_b64_tr_b16 a[88:89], v121 offset:49152
  ds_read_b64_tr_b16 a[90:91], v121 offset:50176
  ds_read_b64_tr_b16 a[92:93], v121 offset:53248
  ds_read_b64_tr_b16 a[94:95], v121 offset:54272
L_lw_23:
  s_waitcnt lgkmcnt(0)
  s_waitcnt vmcnt(16)
  s_barrier
  s_add_u32 s61, s63, 1048576
  s_add_u32 m0, s60, 32768
  s_add_u32 s62, s61, 0
  buffer_load_dwordx4 v116, s[20:23], s62 offen lds
  s_add_u32 m0, s60, 33792
  s_add_u32 s62, s61, 16384
  buffer_load_dwordx4 v116, s[20:23], s62 offen lds
  s_add_u32 m0, s60, 34816
  s_add_u32 s62, s61, 32768
  buffer_load_dwordx4 v116, s[20:23], s62 offen lds
  s_add_u32 m0, s60, 35840
  s_add_u32 s62, s61, 49152
  buffer_load_dwordx4 v116, s[20:23], s62 offen lds
  s_add_u32 m0, s60, 36864
  s_add_u32 s62, s61, 65536
  buffer_load_dwordx4 v116, s[20:23], s62 offen lds
  s_add_u32 m0, s60, 37888
  s_add_u32 s62, s61, 81920
  buffer_load_dwordx4 v116, s[20:23], s62 offen lds
  s_add_u32 m0, s60, 38912
  s_add_u32 s62, s61, 98304
  buffer_load_dwordx4 v116, s[20:23], s62 offen lds
  s_add_u32 m0, s60, 39936
  s_add_u32 s62, s61, 114688
  buffer_load_dwordx4 v116, s[20:23], s62 offen lds
  s_cmp_eq_u32 s3, 1
  s_cbranch_scc1 L_lv_30
  s_cmp_eq_u32 s3, 2
  s_cbranch_scc1 L_lv_31
  s_cmp_eq_u32 s3, 3
  s_cbranch_scc1 L_lv_32
L_lv_29:
  ds_read_b64_tr_b16 a[64:65], v122 offset:0
  ds_read_b64_tr_b16 a[66:67], v122 offset:1024
  ds_read_b64_tr_b16 a[68:69], v122 offset:4096
  ds_read_b64_tr_b16 a[70:71], v122 offset:5120
  ds_read_b64_tr_b16 a[72:73], v123 offset:0
  ds_read_b64_tr_b16 a[74:75], v123 offset:1024
  ds_read_b64_tr_b16 a[76:77], v123 offset:4096
  ds_read_b64_tr_b16 a[78:79], v123 offset:5120
  ds_read_b64_tr_b16 a[80:81], v122 offset:16384
  ds_read_b64_tr_b16 a[82:83], v122 offset:17408
  ds_read_b64_tr_b16 a[84:85], v122 offset:20480
  ds_read_b64_tr_b16 a[86:87], v122 offset:21504
  ds_read_b64_tr_b16 a[88:89], v123 offset:16384
  ds_read_b64_tr_b16 a[90:91], v123 offset:17408
  ds_read_b64_tr_b16 a[92:93], v123 offset:20480
  ds_read_b64_tr_b16 a[94:95], v123 offset:21504
  s_branch L_lw_28
L_lv_30:
  ds_read_b64_tr_b16 a[32:33], v122 offset:0
  ds_read_b64_tr_b16 a[34:35], v122 offset:1024
  ds_read_b64_tr_b16 a[36:37], v122 offset:4096
  ds_read_b64_tr_b16 a[38:39], v122 offset:5120
  ds_read_b64_tr_b16 a[40:41], v123 offset:0
  ds_read_b64_tr_b16 a[42:43], v123 offset:1024
  ds_read_b64_tr_b16 a[44:45], v123 offset:4096
  ds_read_b64_tr_b16 a[46:47], v123 offset:5120
  ds_read_b64_tr_b16 a[48:49], v122 offset:16384
  ds_read_b64_tr_b16 a[50:51], v122 offset:17408
  ds_read_b64_tr_b16 a[52:53], v122 offset:20480
  ds_read_b64_tr_b16 a[54:55], v122 offset:21504
  ds_read_b64_tr_b16 a[56:57], v123 offset:16384
  ds_read_b64_tr_b16 a[58:59], v123 offset:17408
  ds_read_b64_tr_b16 a[60:61], v123 offset:20480
  ds_read_b64_tr_b16 a[62:63], v123 offset:21504
  s_branch L_lw_28
L_lv_31:
  ds_read_b64_tr_b16 a[0:1], v122 offset:0
  ds_read_b64_tr_b16 a[2:3], v122 offset:1024
  ds_read_b64_tr_b16 a[4:5], v122 offset:4096
  ds_read_b64_tr_b16 a[6:7], v122 offset:5120
  ds_read_b64_tr_b16 a[8:9], v123 offset:0
  ds_read_b64_tr_b16 a[10:11], v123 offset:1024
  ds_read_b64_tr_b16 a[12:13], v123 offset:4096
  ds_read_b64_tr_b16 a[14:15], v123 offset:5120
  ds_read_b64_tr_b16 a[16:17], v122 offset:16384
  ds_read_b64_tr_b16 a[18:19], v122 offset:17408
  ds_read_b64_tr_b16 a[20:21], v122 offset:20480
  ds_read_b64_tr_b16 a[22:23], v122 offset:21504
  ds_read_b64_tr_b16 a[24:25], v123 offset:16384
  ds_read_b64_tr_b16 a[26:27], v123 offset:17408
  ds_read_b64_tr_b16 a[28:29], v123 offset:20480
  ds_read_b64_tr_b16 a[30:31], v123 offset:21504
  s_branch L_lw_28
L_lv_32:
  ds_read_b64_tr_b16 a[96:97], v122 offset:0
  ds_read_b64_tr_b16 a[98:99], v122 offset:1024
  ds_read_b64_tr_b16 a[100:101], v122 offset:4096
  ds_read_b64_tr_b16 a[102:103], v122 offset:5120
  ds_read_b64_tr_b16 a[104:105], v123 offset:0
  ds_read_b64_tr_b16 a[106:107], v123 offset:1024
  ds_read_b64_tr_b16 a[108:109], v123 offset:4096
  ds_read_b64_tr_b16 a[110:111], v123 offset:5120
  ds_read_b64_tr_b16 a[112:113], v122 offset:16384
  ds_read_b64_tr_b16 a[114:115], v122 offset:17408
  ds_read_b64_tr_b16 a[116:117], v122 offset:20480
  ds_read_b64_tr_b16 a[118:119], v122 offset:21504
  ds_read_b64_tr_b16 a[120:121], v123 offset:16384
  ds_read_b64_tr_b16 a[122:123], v123 offset:17408
  ds_read_b64_tr_b16 a[124:125], v123 offset:20480
  ds_read_b64_tr_b16 a[126:127], v123 offset:21504
L_lw_28:
  s_waitcnt lgkmcnt(0)
  s_waitcnt vmcnt(16)
  s_barrier
  s_add_u32 s61, s63, 2097152
  s_add_u32 m0, s60, 65536
  s_add_u32 s62, s61, 0
  buffer_load_dwordx4 v116, s[20:23], s62 offen lds
  s_add_u32 m0, s60, 66560
  s_add_u32 s62, s61, 16384
  buffer_load_dwordx4 v116, s[20:23], s62 offen lds
  s_add_u32 m0, s60, 67584
  s_add_u32 s62, s61, 32768
  buffer_load_dwordx4 v116, s[20:23], s62 offen lds
  s_add_u32 m0, s60, 68608
  s_add_u32 s62, s61, 49152
  buffer_load_dwordx4 v116, s[20:23], s62 offen lds
  s_add_u32 m0, s60, 69632
  s_add_u32 s62, s61, 65536
  buffer_load_dwordx4 v116, s[20:23], s62 offen lds
  s_add_u32 m0, s60, 70656
  s_add_u32 s62, s61, 81920
  buffer_load_dwordx4 v116, s[20:23], s62 offen lds
  s_add_u32 m0, s60, 71680
  s_add_u32 s62, s61, 98304
  buffer_load_dwordx4 v116, s[20:23], s62 offen lds
  s_add_u32 m0, s60, 72704
  s_add_u32 s62, s61, 114688
  buffer_load_dwordx4 v116, s[20:23], s62 offen lds
  s_cmp_eq_u32 s3, 1
  s_cbranch_scc1 L_lv_35
  s_cmp_eq_u32 s3, 2
  s_cbranch_scc1 L_lv_36
  s_cmp_eq_u32 s3, 3
  s_cbranch_scc1 L_lv_37
L_lv_34:
  ds_read_b64_tr_b16 a[96:97], v122 offset:32768
  ds_read_b64_tr_b16 a[98:99], v122 offset:33792
  ds_read_b64_tr_b16 a[100:101], v122 offset:36864
  ds_read_b64_tr_b16 a[102:103], v122 offset:37888
  ds_read_b64_tr_b16 a[104:105], v123 offset:32768
  ds_read_b64_tr_b16 a[106:107], v123 offset:33792
  ds_read_b64_tr_b16 a[108:109], v123 offset:36864
  ds_read_b64_tr_b16 a[110:111], v123 offset:37888
  ds_read_b64_tr_b16 a[112:113], v122 offset:49152
  ds_read_b64_tr_b16 a[114:115], v122 offset:50176
  ds_read_b64_tr_b16 a[116:117], v122 offset:53248
  ds_read_b64_tr_b16 a[118:119], v122 offset:54272
  ds_read_b64_tr_b16 a[120:121], v123 offset:49152
  ds_read_b64_tr_b16 a[122:123], v123 offset:50176
  ds_read_b64_tr_b16 a[124:125], v123 offset:53248
  ds_read_b64_tr_b16 a[126:127], v123 offset:54272
  s_branch L_lw_33
L_lv_35:
  ds_read_b64_tr_b16 a[64:65], v122 offset:32768
  ds_read_b64_tr_b16 a[66:67], v122 offset:33792
  ds_read_b64_tr_b16 a[68:69], v122 offset:36864
  ds_read_b64_tr_b16 a[70:71], v122 offset:37888
  ds_read_b64_tr_b16 a[72:73], v123 offset:32768
  ds_read_b64_tr_b16 a[74:75], v123 offset:33792
  ds_read_b64_tr_b16 a[76:77], v123 offset:36864
  ds_read_b64_tr_b16 a[78:79], v123 offset:37888
  ds_read_b64_tr_b16 a[80:81], v122 offset:49152
  ds_read_b64_tr_b16 a[82:83], v122 offset:50176
  ds_read_b64_tr_b16 a[84:85], v122 offset:53248
  ds_read_b64_tr_b16 a[86:87], v122 offset:54272
  ds_read_b64_tr_b16 a[88:89], v123 offset:49152
  ds_read_b64_tr_b16 a[90:91], v123 offset:50176
  ds_read_b64_tr_b16 a[92:93], v123 offset:53248
  ds_read_b64_tr_b16 a[94:95], v123 offset:54272
  s_branch L_lw_33
L_lv_36:
  ds_read_b64_tr_b16 a[32:33], v122 offset:32768
  ds_read_b64_tr_b16 a[34:35], v122 offset:33792
  ds_read_b64_tr_b16 a[36:37], v122 offset:36864
  ds_read_b64_tr_b16 a[38:39], v122 offset:37888
  ds_read_b64_tr_b16 a[40:41], v123 offset:32768
  ds_read_b64_tr_b16 a[42:43], v123 offset:33792
  ds_read_b64_tr_b16 a[44:45], v123 offset:36864
  ds_read_b64_tr_b16 a[46:47], v123 offset:37888
  ds_read_b64_tr_b16 a[48:49], v122 offset:49152
  ds_read_b64_tr_b16 a[50:51], v122 offset:50176
  ds_read_b64_tr_b16 a[52:53], v122 offset:53248
  ds_read_b64_tr_b16 a[54:55], v122 offset:54272
  ds_read_b64_tr_b16 a[56:57], v123 offset:49152
  ds_read_b64_tr_b16 a[58:59], v123 offset:50176
  ds_read_b64_tr_b16 a[60:61], v123 offset:53248
  ds_read_b64_tr_b16 a[62:63], v123 offset:54272
  s_branch L_lw_33
L_lv_37:
  ds_read_b64_tr_b16 a[0:1], v122 offset:32768
  ds_read_b64_tr_b16 a[2:3], v122 offset:33792
  ds_read_b64_tr_b16 a[4:5], v122 offset:36864
  ds_read_b64_tr_b16 a[6:7], v122 offset:37888
  ds_read_b64_tr_b16 a[8:9], v123 offset:32768
  ds_read_b64_tr_b16 a[10:11], v123 offset:33792
  ds_read_b64_tr_b16 a[12:13], v123 offset:36864
  ds_read_b64_tr_b16 a[14:15], v123 offset:37888
  ds_read_b64_tr_b16 a[16:17], v122 offset:49152
  ds_read_b64_tr_b16 a[18:19], v122 offset:50176
  ds_read_b64_tr_b16 a[20:21], v122 offset:53248
  ds_read_b64_tr_b16 a[22:23], v122 offset:54272
  ds_read_b64_tr_b16 a[24:25], v123 offset:49152
  ds_read_b64_tr_b16 a[26:27], v123 offset:50176
  ds_read_b64_tr_b16 a[28:29], v123 offset:53248
  ds_read_b64_tr_b16 a[30:31], v123 offset:54272
L_lw_33:
  s_waitcnt lgkmcnt(0)
  s_waitcnt vmcnt(16)
  s_barrier
  s_add_u32 s61, s63, 3145728
  s_add_u32 m0, s60, 98304
  s_add_u32 s62, s61, 0
  buffer_load_dwordx4 v116, s[20:23], s62 offen lds
  s_add_u32 m0, s60, 99328
  s_add_u32 s62, s61, 16384
  buffer_load_dwordx4 v116, s[20:23], s62 offen lds
  s_add_u32 m0, s60, 100352
  s_add_u32 s62, s61, 32768
  buffer_load_dwordx4 v116, s[20:23], s62 offen lds
  s_add_u32 m0, s60, 101376
  s_add_u32 s62, s61, 49152
  buffer_load_dwordx4 v116, s[20:23], s62 offen lds
  s_add_u32 m0, s60, 102400
  s_add_u32 s62, s61, 65536
  buffer_load_dwordx4 v116, s[20:23], s62 offen lds
  s_add_u32 m0, s60, 103424
  s_add_u32 s62, s61, 81920
  buffer_load_dwordx4 v116, s[20:23], s62 offen lds
  s_add_u32 m0, s60, 104448
  s_add_u32 s62, s61, 98304
  buffer_load_dwordx4 v116, s[20:23], s62 offen lds
  s_add_u32 m0, s60, 105472
  s_add_u32 s62, s61, 114688
  buffer_load_dwordx4 v116, s[20:23], s62 offen lds
  s_cmp_eq_u32 s3, 1
  s_cbranch_scc1 L_lv_40
  s_cmp_eq_u32 s3, 2
  s_cbranch_scc1 L_lv_41
  s_cmp_eq_u32 s3, 3
  s_cbranch_scc1 L_lv_42
L_lv_39:
  ds_read_b64_tr_b16 a[128:129], v120 offset:0
  ds_read_b64_tr_b16 a[130:131], v120 offset:1024
  ds_read_b64_tr_b16 a[132:133], v120 offset:4096
  ds_read_b64_tr_b16 a[134:135], v120 offset:5120
  ds_read_b64_tr_b16 a[136:137], v121 offset:0
  ds_read_b64_tr_b16 a[138:139], v121 offset:1024
  ds_read_b64_tr_b16 a[140:141], v121 offset:4096
  ds_read_b64_tr_b16 a[142:143], v121 offset:5120
  ds_read_b64_tr_b16 a[144:145], v120 offset:16384
  ds_read_b64_tr_b16 a[146:147], v120 offset:17408
  ds_read_b64_tr_b16 a[148:149], v120 offset:20480
  ds_read_b64_tr_b16 a[150:151], v120 offset:21504
  ds_read_b64_tr_b16 a[152:153], v121 offset:16384
  ds_read_b64_tr_b16 a[154:155], v121 offset:17408
  ds_read_b64_tr_b16 a[156:157], v121 offset:20480
  ds_read_b64_tr_b16 a[158:159], v121 offset:21504
  s_branch L_lw_38
L_lv_40:
  ds_read_b64_tr_b16 a[224:225], v120 offset:0
  ds_read_b64_tr_b16 a[226:227], v120 offset:1024
  ds_read_b64_tr_b16 a[228:229], v120 offset:4096
  ds_read_b64_tr_b16 a[230:231], v120 offset:5120
  ds_read_b64_tr_b16 a[232:233], v121 offset:0
  ds_read_b64_tr_b16 a[234:235], v121 offset:1024
  ds_read_b64_tr_b16 a[236:237], v121 offset:4096
  ds_read_b64_tr_b16 a[238:239], v121 offset:5120
  ds_read_b64_tr_b16 a[240:241], v120 offset:16384
  ds_read_b64_tr_b16 a[242:243], v120 offset:17408
  ds_read_b64_tr_b16 a[244:245], v120 offset:20480
  ds_read_b64_tr_b16 a[246:247], v120 offset:21504
  ds_read_b64_tr_b16 a[248:249], v121 offset:16384
  ds_read_b64_tr_b16 a[250:251], v121 offset:17408
  ds_read_b64_tr_b16 a[252:253], v121 offset:20480
  ds_read_b64_tr_b16 a[254:255], v121 offset:21504
  s_branch L_lw_38
L_lv_41:
  ds_read_b64_tr_b16 a[192:193], v120 offset:0
  ds_read_b64_tr_b16 a[194:195], v120 offset:1024
  ds_read_b64_tr_b16 a[196:197], v120 offset:4096
  ds_read_b64_tr_b16 a[198:199], v120 offset:5120
  ds_read_b64_tr_b16 a[200:201], v121 offset:0
  ds_read_b64_tr_b16 a[202:203], v121 offset:1024
  ds_read_b64_tr_b16 a[204:205], v121 offset:4096
  ds_read_b64_tr_b16 a[206:207], v121 offset:5120
  ds_read_b64_tr_b16 a[208:209], v120 offset:16384
  ds_read_b64_tr_b16 a[210:211], v120 offset:17408
  ds_read_b64_tr_b16 a[212:213], v120 offset:20480
  ds_read_b64_tr_b16 a[214:215], v120 offset:21504
  ds_read_b64_tr_b16 a[216:217], v121 offset:16384
  ds_read_b64_tr_b16 a[218:219], v121 offset:17408
  ds_read_b64_tr_b16 a[220:221], v121 offset:20480
  ds_read_b64_tr_b16 a[222:223], v121 offset:21504
  s_branch L_lw_38
L_lv_42:
  ds_read_b64_tr_b16 a[160:161], v120 offset:0
  ds_read_b64_tr_b16 a[162:163], v120 offset:1024
  ds_read_b64_tr_b16 a[164:165], v120 offset:4096
  ds_read_b64_tr_b16 a[166:167], v120 offset:5120
  ds_read_b64_tr_b16 a[168:169], v121 offset:0
  ds_read_b64_tr_b16 a[170:171], v121 offset:1024
  ds_read_b64_tr_b16 a[172:173], v121 offset:4096
  ds_read_b64_tr_b16 a[174:175], v121 offset:5120
  ds_read_b64_tr_b16 a[176:177], v120 offset:16384
  ds_read_b64_tr_b16 a[178:179], v120 offset:17408
  ds_read_b64_tr_b16 a[180:181], v120 offset:20480
  ds_read_b64_tr_b16 a[182:183], v120 offset:21504
  ds_read_b64_tr_b16 a[184:185], v121 offset:16384
  ds_read_b64_tr_b16 a[186:187], v121 offset:17408
  ds_read_b64_tr_b16 a[188:189], v121 offset:20480
  ds_read_b64_tr_b16 a[190:191], v121 offset:21504
L_lw_38:
  s_waitcnt lgkmcnt(0)
  s_waitcnt vmcnt(16)
  s_barrier
  s_add_u32 s61, s63, 0
  s_add_u32 m0, s60, 0
  s_add_u32 s62, s61, 0
  buffer_load_dwordx4 v116, s[24:27], s62 offen lds
  s_add_u32 m0, s60, 1024
  s_add_u32 s62, s61, 16384
  buffer_load_dwordx4 v116, s[24:27], s62 offen lds
  s_add_u32 m0, s60, 2048
  s_add_u32 s62, s61, 32768
  buffer_load_dwordx4 v116, s[24:27], s62 offen lds
  s_add_u32 m0, s60, 3072
  s_add_u32 s62, s61, 49152
  buffer_load_dwordx4 v116, s[24:27], s62 offen lds
  s_add_u32 m0, s60, 4096
  s_add_u32 s62, s61, 65536
  buffer_load_dwordx4 v116, s[24:27], s62 offen lds
  s_add_u32 m0, s60, 5120
  s_add_u32 s62, s61, 81920
  buffer_load_dwordx4 v116, s[24:27], s62 offen lds
  s_add_u32 m0, s60, 6144
  s_add_u32 s62, s61, 98304
  buffer_load_dwordx4 v116, s[24:27], s62 offen lds
  s_add_u32 m0, s60, 7168
  s_add_u32 s62, s61, 114688
  buffer_load_dwordx4 v116, s[24:27], s62 offen lds
  s_cmp_eq_u32 s3, 1
  s_cbranch_scc1 L_lv_45
  s_cmp_eq_u32 s3, 2
  s_cbranch_scc1 L_lv_46
  s_cmp_eq_u32 s3, 3
  s_cbranch_scc1 L_lv_47
L_lv_44:
  ds_read_b64_tr_b16 a[160:161], v120 offset:32768
  ds_read_b64_tr_b16 a[162:163], v120 offset:33792
  ds_read_b64_tr_b16 a[164:165], v120 offset:36864
  ds_read_b64_tr_b16 a[166:167], v120 offset:37888
  ds_read_b64_tr_b16 a[168:169], v121 offset:32768
  ds_read_b64_tr_b16 a[170:171], v121 offset:33792
  ds_read_b64_tr_b16 a[172:173], v121 offset:36864
  ds_read_b64_tr_b16 a[174:175], v121 offset:37888
  ds_read_b64_tr_b16 a[176:177], v120 offset:49152
  ds_read_b64_tr_b16 a[178:179], v120 offset:50176
  ds_read_b64_tr_b16 a[180:181], v120 offset:53248
  ds_read_b64_tr_b16 a[182:183], v120 offset:54272
  ds_read_b64_tr_b16 a[184:185], v121 offset:49152
  ds_read_b64_tr_b16 a[186:187], v121 offset:50176
  ds_read_b64_tr_b16 a[188:189], v121 offset:53248
  ds_read_b64_tr_b16 a[190:191], v121 offset:54272
  s_branch L_lw_43
L_lv_45:
  ds_read_b64_tr_b16 a[128:129], v120 offset:32768
  ds_read_b64_tr_b16 a[130:131], v120 offset:33792
  ds_read_b64_tr_b16 a[132:133], v120 offset:36864
  ds_read_b64_tr_b16 a[134:135], v120 offset:37888
  ds_read_b64_tr_b16 a[136:137], v121 offset:32768
  ds_read_b64_tr_b16 a[138:139], v121 offset:33792
  ds_read_b64_tr_b16 a[140:141], v121 offset:36864
  ds_read_b64_tr_b16 a[142:143], v121 offset:37888
  ds_read_b64_tr_b16 a[144:145], v120 offset:49152
  ds_read_b64_tr_b16 a[146:147], v120 offset:50176
  ds_read_b64_tr_b16 a[148:149], v120 offset:53248
  ds_read_b64_tr_b16 a[150:151], v120 offset:54272
  ds_read_b64_tr_b16 a[152:153], v121 offset:49152
  ds_read_b64_tr_b16 a[154:155], v121 offset:50176
  ds_read_b64_tr_b16 a[156:157], v121 offset:53248
  ds_read_b64_tr_b16 a[158:159], v121 offset:54272
  s_branch L_lw_43
L_lv_46:
  ds_read_b64_tr_b16 a[224:225], v120 offset:32768
  ds_read_b64_tr_b16 a[226:227], v120 offset:33792
  ds_read_b64_tr_b16 a[228:229], v120 offset:36864
  ds_read_b64_tr_b16 a[230:231], v120 offset:37888
  ds_read_b64_tr_b16 a[232:233], v121 offset:32768
  ds_read_b64_tr_b16 a[234:235], v121 offset:33792
  ds_read_b64_tr_b16 a[236:237], v121 offset:36864
  ds_read_b64_tr_b16 a[238:239], v121 offset:37888
  ds_read_b64_tr_b16 a[240:241], v120 offset:49152
  ds_read_b64_tr_b16 a[242:243], v120 offset:50176
  ds_read_b64_tr_b16 a[244:245], v120 offset:53248
  ds_read_b64_tr_b16 a[246:247], v120 offset:54272
  ds_read_b64_tr_b16 a[248:249], v121 offset:49152
  ds_read_b64_tr_b16 a[250:251], v121 offset:50176
  ds_read_b64_tr_b16 a[252:253], v121 offset:53248
  ds_read_b64_tr_b16 a[254:255], v121 offset:54272
  s_branch L_lw_43
L_lv_47:
  ds_read_b64_tr_b16 a[192:193], v120 offset:32768
  ds_read_b64_tr_b16 a[194:195], v120 offset:33792
  ds_read_b64_tr_b16 a[196:197], v120 offset:36864
  ds_read_b64_tr_b16 a[198:199], v120 offset:37888
  ds_read_b64_tr_b16 a[200:201], v121 offset:32768
  ds_read_b64_tr_b16 a[202:203], v121 offset:33792
  ds_read_b64_tr_b16 a[204:205], v121 offset:36864
  ds_read_b64_tr_b16 a[206:207], v121 offset:37888
  ds_read_b64_tr_b16 a[208:209], v120 offset:49152
  ds_read_b64_tr_b16 a[210:211], v120 offset:50176
  ds_read_b64_tr_b16 a[212:213], v120 offset:53248
  ds_read_b64_tr_b16 a[214:215], v120 offset:54272
  ds_read_b64_tr_b16 a[216:217], v121 offset:49152
  ds_read_b64_tr_b16 a[218:219], v121 offset:50176
  ds_read_b64_tr_b16 a[220:221], v121 offset:53248
  ds_read_b64_tr_b16 a[222:223], v121 offset:54272
L_lw_43:
  s_waitcnt lgkmcnt(0)
  s_waitcnt vmcnt(16)
  s_barrier
  s_add_u32 s61, s63, 1048576
  s_add_u32 m0, s60, 32768
  s_add_u32 s62, s61, 0
  buffer_load_dwordx4 v116, s[24:27], s62 offen lds
  s_add_u32 m0, s60, 33792
  s_add_u32 s62, s61, 16384
  buffer_load_dwordx4 v116, s[24:27], s62 offen lds
  s_add_u32 m0, s60, 34816
  s_add_u32 s62, s61, 32768
  buffer_load_dwordx4 v116, s[24:27], s62 offen lds
  s_add_u32 m0, s60, 35840
  s_add_u32 s62, s61, 49152
  buffer_load_dwordx4 v116, s[24:27], s62 offen lds
  s_add_u32 m0, s60, 36864
  s_add_u32 s62, s61, 65536
  buffer_load_dwordx4 v116, s[24:27], s62 offen lds
  s_add_u32 m0, s60, 37888
  s_add_u32 s62, s61, 81920
  buffer_load_dwordx4 v116, s[24:27], s62 offen lds
  s_add_u32 m0, s60, 38912
  s_add_u32 s62, s61, 98304
  buffer_load_dwordx4 v116, s[24:27], s62 offen lds
  s_add_u32 m0, s60, 39936
  s_add_u32 s62, s61, 114688
  buffer_load_dwordx4 v116, s[24:27], s62 offen lds
  s_cmp_eq_u32 s3, 1
  s_cbranch_scc1 L_lv_50
  s_cmp_eq_u32 s3, 2
  s_cbranch_scc1 L_lv_51
  s_cmp_eq_u32 s3, 3
  s_cbranch_scc1 L_lv_52
L_lv_49:
  ds_read_b64_tr_b16 a[192:193], v122 offset:0
  ds_read_b64_tr_b16 a[194:195], v122 offset:1024
  ds_read_b64_tr_b16 a[196:197], v122 offset:4096
  ds_read_b64_tr_b16 a[198:199], v122 offset:5120
  ds_read_b64_tr_b16 a[200:201], v123 offset:0
  ds_read_b64_tr_b16 a[202:203], v123 offset:1024
  ds_read_b64_tr_b16 a[204:205], v123 offset:4096
  ds_read_b64_tr_b16 a[206:207], v123 offset:5120
  ds_read_b64_tr_b16 a[208:209], v122 offset:16384
  ds_read_b64_tr_b16 a[210:211], v122 offset:17408
  ds_read_b64_tr_b16 a[212:213], v122 offset:20480
  ds_read_b64_tr_b16 a[214:215], v122 offset:21504
  ds_read_b64_tr_b16 a[216:217], v123 offset:16384
  ds_read_b64_tr_b16 a[218:219], v123 offset:17408
  ds_read_b64_tr_b16 a[220:221], v123 offset:20480
  ds_read_b64_tr_b16 a[222:223], v123 offset:21504
  s_branch L_lw_48
L_lv_50:
  ds_read_b64_tr_b16 a[160:161], v122 offset:0
  ds_read_b64_tr_b16 a[162:163], v122 offset:1024
  ds_read_b64_tr_b16 a[164:165], v122 offset:4096
  ds_read_b64_tr_b16 a[166:167], v122 offset:5120
  ds_read_b64_tr_b16 a[168:169], v123 offset:0
  ds_read_b64_tr_b16 a[170:171], v123 offset:1024
  ds_read_b64_tr_b16 a[172:173], v123 offset:4096
  ds_read_b64_tr_b16 a[174:175], v123 offset:5120
  ds_read_b64_tr_b16 a[176:177], v122 offset:16384
  ds_read_b64_tr_b16 a[178:179], v122 offset:17408
  ds_read_b64_tr_b16 a[180:181], v122 offset:20480
  ds_read_b64_tr_b16 a[182:183], v122 offset:21504
  ds_read_b64_tr_b16 a[184:185], v123 offset:16384
  ds_read_b64_tr_b16 a[186:187], v123 offset:17408
  ds_read_b64_tr_b16 a[188:189], v123 offset:20480
  ds_read_b64_tr_b16 a[190:191], v123 offset:21504
  s_branch L_lw_48
L_lv_51:
  ds_read_b64_tr_b16 a[128:129], v122 offset:0
  ds_read_b64_tr_b16 a[130:131], v122 offset:1024
  ds_read_b64_tr_b16 a[132:133], v122 offset:4096
  ds_read_b64_tr_b16 a[134:135], v122 offset:5120
  ds_read_b64_tr_b16 a[136:137], v123 offset:0
  ds_read_b64_tr_b16 a[138:139], v123 offset:1024
  ds_read_b64_tr_b16 a[140:141], v123 offset:4096
  ds_read_b64_tr_b16 a[142:143], v123 offset:5120
  ds_read_b64_tr_b16 a[144:145], v122 offset:16384
  ds_read_b64_tr_b16 a[146:147], v122 offset:17408
  ds_read_b64_tr_b16 a[148:149], v122 offset:20480
  ds_read_b64_tr_b16 a[150:151], v122 offset:21504
  ds_read_b64_tr_b16 a[152:153], v123 offset:16384
  ds_read_b64_tr_b16 a[154:155], v123 offset:17408
  ds_read_b64_tr_b16 a[156:157], v123 offset:20480
  ds_read_b64_tr_b16 a[158:159], v123 offset:21504
  s_branch L_lw_48
L_lv_52:
  ds_read_b64_tr_b16 a[224:225], v122 offset:0
  ds_read_b64_tr_b16 a[226:227], v122 offset:1024
  ds_read_b64_tr_b16 a[228:229], v122 offset:4096
  ds_read_b64_tr_b16 a[230:231], v122 offset:5120
  ds_read_b64_tr_b16 a[232:233], v123 offset:0
  ds_read_b64_tr_b16 a[234:235], v123 offset:1024
  ds_read_b64_tr_b16 a[236:237], v123 offset:4096
  ds_read_b64_tr_b16 a[238:239], v123 offset:5120
  ds_read_b64_tr_b16 a[240:241], v122 offset:16384
  ds_read_b64_tr_b16 a[242:243], v122 offset:17408
  ds_read_b64_tr_b16 a[244:245], v122 offset:20480
  ds_read_b64_tr_b16 a[246:247], v122 offset:21504
  ds_read_b64_tr_b16 a[248:249], v123 offset:16384
  ds_read_b64_tr_b16 a[250:251], v123 offset:17408
  ds_read_b64_tr_b16 a[252:253], v123 offset:20480
  ds_read_b64_tr_b16 a[254:255], v123 offset:21504
L_lw_48:
  s_waitcnt lgkmcnt(0)
  s_waitcnt vmcnt(16)
  s_barrier
  s_add_u32 s61, s63, 2097152
  s_add_u32 m0, s60, 65536
  s_add_u32 s62, s61, 0
  buffer_load_dwordx4 v116, s[24:27], s62 offen lds
  s_add_u32 m0, s60, 66560
  s_add_u32 s62, s61, 16384
  buffer_load_dwordx4 v116, s[24:27], s62 offen lds
  s_add_u32 m0, s60, 67584
  s_add_u32 s62, s61, 32768
  buffer_load_dwordx4 v116, s[24:27], s62 offen lds
  s_add_u32 m0, s60, 68608
  s_add_u32 s62, s61, 49152
  buffer_load_dwordx4 v116, s[24:27], s62 offen lds
  s_add_u32 m0, s60, 69632
  s_add_u32 s62, s61, 65536
  buffer_load_dwordx4 v116, s[24:27], s62 offen lds
  s_add_u32 m0, s60, 70656
  s_add_u32 s62, s61, 81920
  buffer_load_dwordx4 v116, s[24:27], s62 offen lds
  s_add_u32 m0, s60, 71680
  s_add_u32 s62, s61, 98304
  buffer_load_dwordx4 v116, s[24:27], s62 offen lds
  s_add_u32 m0, s60, 72704
  s_add_u32 s62, s61, 114688
  buffer_load_dwordx4 v116, s[24:27], s62 offen lds
  s_cmp_eq_u32 s3, 1
  s_cbranch_scc1 L_lv_55
  s_cmp_eq_u32 s3, 2
  s_cbranch_scc1 L_lv_56
  s_cmp_eq_u32 s3, 3
  s_cbranch_scc1 L_lv_57
L_lv_54:
  ds_read_b64_tr_b16 a[224:225], v122 offset:32768
  ds_read_b64_tr_b16 a[226:227], v122 offset:33792
  ds_read_b64_tr_b16 a[228:229], v122 offset:36864
  ds_read_b64_tr_b16 a[230:231], v122 offset:37888
  ds_read_b64_tr_b16 a[232:233], v123 offset:32768
  ds_read_b64_tr_b16 a[234:235], v123 offset:33792
  ds_read_b64_tr_b16 a[236:237], v123 offset:36864
  ds_read_b64_tr_b16 a[238:239], v123 offset:37888
  ds_read_b64_tr_b16 a[240:241], v122 offset:49152
  ds_read_b64_tr_b16 a[242:243], v122 offset:50176
  ds_read_b64_tr_b16 a[244:245], v122 offset:53248
  ds_read_b64_tr_b16 a[246:247], v122 offset:54272
  ds_read_b64_tr_b16 a[248:249], v123 offset:49152
  ds_read_b64_tr_b16 a[250:251], v123 offset:50176
  ds_read_b64_tr_b16 a[252:253], v123 offset:53248
  ds_read_b64_tr_b16 a[254:255], v123 offset:54272
  s_branch L_lw_53
L_lv_55:
  ds_read_b64_tr_b16 a[192:193], v122 offset:32768
  ds_read_b64_tr_b16 a[194:195], v122 offset:33792
  ds_read_b64_tr_b16 a[196:197], v122 offset:36864
  ds_read_b64_tr_b16 a[198:199], v122 offset:37888
  ds_read_b64_tr_b16 a[200:201], v123 offset:32768
  ds_read_b64_tr_b16 a[202:203], v123 offset:33792
  ds_read_b64_tr_b16 a[204:205], v123 offset:36864
  ds_read_b64_tr_b16 a[206:207], v123 offset:37888
  ds_read_b64_tr_b16 a[208:209], v122 offset:49152
  ds_read_b64_tr_b16 a[210:211], v122 offset:50176
  ds_read_b64_tr_b16 a[212:213], v122 offset:53248
  ds_read_b64_tr_b16 a[214:215], v122 offset:54272
  ds_read_b64_tr_b16 a[216:217], v123 offset:49152
  ds_read_b64_tr_b16 a[218:219], v123 offset:50176
  ds_read_b64_tr_b16 a[220:221], v123 offset:53248
  ds_read_b64_tr_b16 a[222:223], v123 offset:54272
  s_branch L_lw_53
L_lv_56:
  ds_read_b64_tr_b16 a[160:161], v122 offset:32768
  ds_read_b64_tr_b16 a[162:163], v122 offset:33792
  ds_read_b64_tr_b16 a[164:165], v122 offset:36864
  ds_read_b64_tr_b16 a[166:167], v122 offset:37888
  ds_read_b64_tr_b16 a[168:169], v123 offset:32768
  ds_read_b64_tr_b16 a[170:171], v123 offset:33792
  ds_read_b64_tr_b16 a[172:173], v123 offset:36864
  ds_read_b64_tr_b16 a[174:175], v123 offset:37888
  ds_read_b64_tr_b16 a[176:177], v122 offset:49152
  ds_read_b64_tr_b16 a[178:179], v122 offset:50176
  ds_read_b64_tr_b16 a[180:181], v122 offset:53248
  ds_read_b64_tr_b16 a[182:183], v122 offset:54272
  ds_read_b64_tr_b16 a[184:185], v123 offset:49152
  ds_read_b64_tr_b16 a[186:187], v123 offset:50176
  ds_read_b64_tr_b16 a[188:189], v123 offset:53248
  ds_read_b64_tr_b16 a[190:191], v123 offset:54272
  s_branch L_lw_53
L_lv_57:
  ds_read_b64_tr_b16 a[128:129], v122 offset:32768
  ds_read_b64_tr_b16 a[130:131], v122 offset:33792
  ds_read_b64_tr_b16 a[132:133], v122 offset:36864
  ds_read_b64_tr_b16 a[134:135], v122 offset:37888
  ds_read_b64_tr_b16 a[136:137], v123 offset:32768
  ds_read_b64_tr_b16 a[138:139], v123 offset:33792
  ds_read_b64_tr_b16 a[140:141], v123 offset:36864
  ds_read_b64_tr_b16 a[142:143], v123 offset:37888
  ds_read_b64_tr_b16 a[144:145], v122 offset:49152
  ds_read_b64_tr_b16 a[146:147], v122 offset:50176
  ds_read_b64_tr_b16 a[148:149], v122 offset:53248
  ds_read_b64_tr_b16 a[150:151], v122 offset:54272
  ds_read_b64_tr_b16 a[152:153], v123 offset:49152
  ds_read_b64_tr_b16 a[154:155], v123 offset:50176
  ds_read_b64_tr_b16 a[156:157], v123 offset:53248
  ds_read_b64_tr_b16 a[158:159], v123 offset:54272
L_lw_53:
  s_waitcnt lgkmcnt(0)
  s_waitcnt vmcnt(16)
  s_barrier
  s_add_u32 s61, s63, 3145728
  s_add_u32 m0, s60, 98304
  s_add_u32 s62, s61, 0
  buffer_load_dwordx4 v116, s[24:27], s62 offen lds
  s_add_u32 m0, s60, 99328
  s_add_u32 s62, s61, 16384
  buffer_load_dwordx4 v116, s[24:27], s62 offen lds
  s_add_u32 m0, s60, 100352
  s_add_u32 s62, s61, 32768
  buffer_load_dwordx4 v116, s[24:27], s62 offen lds
  s_add_u32 m0, s60, 101376
  s_add_u32 s62, s61, 49152
  buffer_load_dwordx4 v116, s[24:27], s62 offen lds
  s_add_u32 m0, s60, 102400
  s_add_u32 s62, s61, 65536
  buffer_load_dwordx4 v116, s[24:27], s62 offen lds
  s_add_u32 m0, s60, 103424
  s_add_u32 s62, s61, 81920
  buffer_load_dwordx4 v116, s[24:27], s62 offen lds
  s_add_u32 m0, s60, 104448
  s_add_u32 s62, s61, 98304
  buffer_load_dwordx4 v116, s[24:27], s62 offen lds
  s_add_u32 m0, s60, 105472
  s_add_u32 s62, s61, 114688
  buffer_load_dwordx4 v116, s[24:27], s62 offen lds
  s_mov_b32 s16, s80
  s_mov_b32 s17, s81
  s_mov_b32 s18, 0x2000
  s_mov_b32 s19, 0x20000
  v_and_b32 v16, 15, v0
  v_lshrrev_b32 v17, 1, v16
  v_lshlrev_b32 v17, 10, v17
  v_and_b32 v18, 1, v0
  v_lshl_or_b32 v17, v18, 6, v17
  v_lshrrev_b32 v19, 4, v0
  v_lshl_or_b32 v17, v19, 3, v17
  s_lshl_b32 s6, s3, 8
  buffer_load_dwordx2 v[84:85], v17, s[16:19], s6 offen offset:0
  buffer_load_dwordx2 v[86:87], v17, s[16:19], s6 offen offset:32
  buffer_load_dwordx2 v[88:89], v17, s[16:19], s6 offen offset:128
  buffer_load_dwordx2 v[90:91], v17, s[16:19], s6 offen offset:160
  v_mov_b32 v19, 0x4444
  v_mov_b32 v16, 0xeeee
  v_cmp_eq_u32 vcc, 0, v18
  s_nop 1
  v_cndmask_b32 v0, v16, v19, vcc
  v_mbcnt_lo_u32_b32 v16, -1, 0
  v_and_b32 v16, 3, v16
  v_lshlrev_b32 v16, 6, v16
  buffer_load_dword v17, v16, s[12:15], 0 offen offset:16 sc1
  s_cmp_eq_u32 s3, 1
  s_cbranch_scc1 L_lv_60
  s_cmp_eq_u32 s3, 2
  s_cbranch_scc1 L_lv_61
  s_cmp_eq_u32 s3, 3
  s_cbranch_scc1 L_lv_62
L_lv_59:
  ds_read_b64_tr_b16 v[128:129], v120 offset:0
  ds_read_b64_tr_b16 v[130:131], v120 offset:1024
  ds_read_b64_tr_b16 v[132:133], v120 offset:4096
  ds_read_b64_tr_b16 v[134:135], v120 offset:5120
  ds_read_b64_tr_b16 v[136:137], v121 offset:0
  ds_read_b64_tr_b16 v[138:139], v121 offset:1024
  ds_read_b64_tr_b16 v[140:141], v121 offset:4096
  ds_read_b64_tr_b16 v[142:143], v121 offset:5120
  ds_read_b64_tr_b16 v[144:145], v120 offset:16384
  ds_read_b64_tr_b16 v[146:147], v120 offset:17408
  ds_read_b64_tr_b16 v[148:149], v120 offset:20480
  ds_read_b64_tr_b16 v[150:151], v120 offset:21504
  ds_read_b64_tr_b16 v[152:153], v121 offset:16384
  ds_read_b64_tr_b16 v[154:155], v121 offset:17408
  ds_read_b64_tr_b16 v[156:157], v121 offset:20480
  ds_read_b64_tr_b16 v[158:159], v121 offset:21504
  s_branch L_lw_58
L_lv_60:
  ds_read_b64_tr_b16 v[224:225], v120 offset:0
  ds_read_b64_tr_b16 v[226:227], v120 offset:1024
  ds_read_b64_tr_b16 v[228:229], v120 offset:4096
  ds_read_b64_tr_b16 v[230:231], v120 offset:5120
  ds_read_b64_tr_b16 v[232:233], v121 offset:0
  ds_read_b64_tr_b16 v[234:235], v121 offset:1024
  ds_read_b64_tr_b16 v[236:237], v121 offset:4096
  ds_read_b64_tr_b16 v[238:239], v121 offset:5120
  ds_read_b64_tr_b16 v[240:241], v120 offset:16384
  ds_read_b64_tr_b16 v[242:243], v120 offset:17408
  ds_read_b64_tr_b16 v[244:245], v120 offset:20480
  ds_read_b64_tr_b16 v[246:247], v120 offset:21504
  ds_read_b64_tr_b16 v[248:249], v121 offset:16384
  ds_read_b64_tr_b16 v[250:251], v121 offset:17408
  ds_read_b64_tr_b16 v[252:253], v121 offset:20480
  ds_read_b64_tr_b16 v[254:255], v121 offset:21504
  s_branch L_lw_58
L_lv_61:
  ds_read_b64_tr_b16 v[192:193], v120 offset:0
  ds_read_b64_tr_b16 v[194:195], v120 offset:1024
  ds_read_b64_tr_b16 v[196:197], v120 offset:4096
  ds_read_b64_tr_b16 v[198:199], v120 offset:5120
  ds_read_b64_tr_b16 v[200:201], v121 offset:0
  ds_read_b64_tr_b16 v[202:203], v121 offset:1024
  ds_read_b64_tr_b16 v[204:205], v121 offset:4096
  ds_read_b64_tr_b16 v[206:207], v121 offset:5120
  ds_read_b64_tr_b16 v[208:209], v120 offset:16384
  ds_read_b64_tr_b16 v[210:211], v120 offset:17408
  ds_read_b64_tr_b16 v[212:213], v120 offset:20480
  ds_read_b64_tr_b16 v[214:215], v120 offset:21504
  ds_read_b64_tr_b16 v[216:217], v121 offset:16384
  ds_read_b64_tr_b16 v[218:219], v121 offset:17408
  ds_read_b64_tr_b16 v[220:221], v121 offset:20480
  ds_read_b64_tr_b16 v[222:223], v121 offset:21504
  s_branch L_lw_58
L_lv_62:
  ds_read_b64_tr_b16 v[160:161], v120 offset:0
  ds_read_b64_tr_b16 v[162:163], v120 offset:1024
  ds_read_b64_tr_b16 v[164:165], v120 offset:4096
  ds_read_b64_tr_b16 v[166:167], v120 offset:5120
  ds_read_b64_tr_b16 v[168:169], v121 offset:0
  ds_read_b64_tr_b16 v[170:171], v121 offset:1024
  ds_read_b64_tr_b16 v[172:173], v121 offset:4096
  ds_read_b64_tr_b16 v[174:175], v121 offset:5120
  ds_read_b64_tr_b16 v[176:177], v120 offset:16384
  ds_read_b64_tr_b16 v[178:179], v120 offset:17408
  ds_read_b64_tr_b16 v[180:181], v120 offset:20480
  ds_read_b64_tr_b16 v[182:183], v120 offset:21504
  ds_read_b64_tr_b16 v[184:185], v121 offset:16384
  ds_read_b64_tr_b16 v[186:187], v121 offset:17408
  ds_read_b64_tr_b16 v[188:189], v121 offset:20480
  ds_read_b64_tr_b16 v[190:191], v121 offset:21504
L_lw_58:
  s_waitcnt lgkmcnt(0)
  s_waitcnt vmcnt(16)
  s_barrier
  s_lshl_b32 s61, s5, 17
  s_lshl_b32 s62, s3, 15
  s_add_u32 s61, s61, s62
  s_add_u32 s61, s61, 0
  s_add_u32 m0, s60, 0
  s_add_u32 s62, s61, 0
  buffer_load_dwordx4 v118, s[28:31], s62 offen lds
  s_add_u32 m0, s60, 1024
  s_add_u32 s62, s61, 4096
  buffer_load_dwordx4 v118, s[28:31], s62 offen lds
  s_add_u32 m0, s60, 2048
  s_add_u32 s62, s61, 8192
  buffer_load_dwordx4 v119, s[28:31], s62 offen lds
  s_add_u32 m0, s60, 3072
  s_add_u32 s62, s61, 12288
  buffer_load_dwordx4 v119, s[28:31], s62 offen lds
  s_add_u32 m0, s60, 4096
  s_add_u32 s62, s61, 16384
  buffer_load_dwordx4 v118, s[28:31], s62 offen lds
  s_add_u32 m0, s60, 5120
  s_add_u32 s62, s61, 20480
  buffer_load_dwordx4 v118, s[28:31], s62 offen lds
  s_add_u32 m0, s60, 6144
  s_add_u32 s62, s61, 24576
  buffer_load_dwordx4 v119, s[28:31], s62 offen lds
  s_add_u32 m0, s60, 7168
  s_add_u32 s62, s61, 28672
  buffer_load_dwordx4 v119, s[28:31], s62 offen lds
  s_cmp_eq_u32 s3, 1
  s_cbranch_scc1 L_lv_65
  s_cmp_eq_u32 s3, 2
  s_cbranch_scc1 L_lv_66
  s_cmp_eq_u32 s3, 3
  s_cbranch_scc1 L_lv_67
L_lv_64:
  ds_read_b64_tr_b16 v[160:161], v120 offset:32768
  ds_read_b64_tr_b16 v[162:163], v120 offset:33792
  ds_read_b64_tr_b16 v[164:165], v120 offset:36864
  ds_read_b64_tr_b16 v[166:167], v120 offset:37888
  ds_read_b64_tr_b16 v[168:169], v121 offset:32768
  ds_read_b64_tr_b16 v[170:171], v121 offset:33792
  ds_read_b64_tr_b16 v[172:173], v121 offset:36864
  ds_read_b64_tr_b16 v[174:175], v121 offset:37888
  ds_read_b64_tr_b16 v[176:177], v120 offset:49152
  ds_read_b64_tr_b16 v[178:179], v120 offset:50176
  ds_read_b64_tr_b16 v[180:181], v120 offset:53248
  ds_read_b64_tr_b16 v[182:183], v120 offset:54272
  ds_read_b64_tr_b16 v[184:185], v121 offset:49152
  ds_read_b64_tr_b16 v[186:187], v121 offset:50176
  ds_read_b64_tr_b16 v[188:189], v121 offset:53248
  ds_read_b64_tr_b16 v[190:191], v121 offset:54272
  s_branch L_lw_63
L_lv_65:
  ds_read_b64_tr_b16 v[128:129], v120 offset:32768
  ds_read_b64_tr_b16 v[130:131], v120 offset:33792
  ds_read_b64_tr_b16 v[132:133], v120 offset:36864
  ds_read_b64_tr_b16 v[134:135], v120 offset:37888
  ds_read_b64_tr_b16 v[136:137], v121 offset:32768
  ds_read_b64_tr_b16 v[138:139], v121 offset:33792
  ds_read_b64_tr_b16 v[140:141], v121 offset:36864
  ds_read_b64_tr_b16 v[142:143], v121 offset:37888
  ds_read_b64_tr_b16 v[144:145], v120 offset:49152
  ds_read_b64_tr_b16 v[146:147], v120 offset:50176
  ds_read_b64_tr_b16 v[148:149], v120 offset:53248
  ds_read_b64_tr_b16 v[150:151], v120 offset:54272
  ds_read_b64_tr_b16 v[152:153], v121 offset:49152
  ds_read_b64_tr_b16 v[154:155], v121 offset:50176
  ds_read_b64_tr_b16 v[156:157], v121 offset:53248
  ds_read_b64_tr_b16 v[158:159], v121 offset:54272
  s_branch L_lw_63
L_lv_66:
  ds_read_b64_tr_b16 v[224:225], v120 offset:32768
  ds_read_b64_tr_b16 v[226:227], v120 offset:33792
  ds_read_b64_tr_b16 v[228:229], v120 offset:36864
  ds_read_b64_tr_b16 v[230:231], v120 offset:37888
  ds_read_b64_tr_b16 v[232:233], v121 offset:32768
  ds_read_b64_tr_b16 v[234:235], v121 offset:33792
  ds_read_b64_tr_b16 v[236:237], v121 offset:36864
  ds_read_b64_tr_b16 v[238:239], v121 offset:37888
  ds_read_b64_tr_b16 v[240:241], v120 offset:49152
  ds_read_b64_tr_b16 v[242:243], v120 offset:50176
  ds_read_b64_tr_b16 v[244:245], v120 offset:53248
  ds_read_b64_tr_b16 v[246:247], v120 offset:54272
  ds_read_b64_tr_b16 v[248:249], v121 offset:49152
  ds_read_b64_tr_b16 v[250:251], v121 offset:50176
  ds_read_b64_tr_b16 v[252:253], v121 offset:53248
  ds_read_b64_tr_b16 v[254:255], v121 offset:54272
  s_branch L_lw_63
L_lv_67:
  ds_read_b64_tr_b16 v[192:193], v120 offset:32768
  ds_read_b64_tr_b16 v[194:195], v120 offset:33792
  ds_read_b64_tr_b16 v[196:197], v120 offset:36864
  ds_read_b64_tr_b16 v[198:199], v120 offset:37888
  ds_read_b64_tr_b16 v[200:201], v121 offset:32768
  ds_read_b64_tr_b16 v[202:203], v121 offset:33792
  ds_read_b64_tr_b16 v[204:205], v121 offset:36864
  ds_read_b64_tr_b16 v[206:207], v121 offset:37888
  ds_read_b64_tr_b16 v[208:209], v120 offset:49152
  ds_read_b64_tr_b16 v[210:211], v120 offset:50176
  ds_read_b64_tr_b16 v[212:213], v120 offset:53248
  ds_read_b64_tr_b16 v[214:215], v120 offset:54272
  ds_read_b64_tr_b16 v[216:217], v121 offset:49152
  ds_read_b64_tr_b16 v[218:219], v121 offset:50176
  ds_read_b64_tr_b16 v[220:221], v121 offset:53248
  ds_read_b64_tr_b16 v[222:223], v121 offset:54272
L_lw_63:
  s_waitcnt lgkmcnt(0)
  s_waitcnt vmcnt(16)
  s_barrier
  s_lshl_b32 s61, s5, 17
  s_lshl_b32 s62, s3, 15
  s_add_u32 s61, s61, s62
  s_add_u32 s61, s61, 256
  s_add_u32 m0, s60, 32768
  s_add_u32 s62, s61, 0
  buffer_load_dwordx4 v118, s[28:31], s62 offen lds
  s_add_u32 m0, s60, 33792
  s_add_u32 s62, s61, 4096
  buffer_load_dwordx4 v118, s[28:31], s62 offen lds
  s_add_u32 m0, s60, 34816
  s_add_u32 s62, s61, 8192
  buffer_load_dwordx4 v119, s[28:31], s62 offen lds
  s_add_u32 m0, s60, 35840
  s_add_u32 s62, s61, 12288
  buffer_load_dwordx4 v119, s[28:31], s62 offen lds
  s_add_u32 m0, s60, 36864
  s_add_u32 s62, s61, 16384
  buffer_load_dwordx4 v118, s[28:31], s62 offen lds
  s_add_u32 m0, s60, 37888
  s_add_u32 s62, s61, 20480
  buffer_load_dwordx4 v118, s[28:31], s62 offen lds
  s_add_u32 m0, s60, 38912
  s_add_u32 s62, s61, 24576
  buffer_load_dwordx4 v119, s[28:31], s62 offen lds
  s_add_u32 m0, s60, 39936
  s_add_u32 s62, s61, 28672
  buffer_load_dwordx4 v119, s[28:31], s62 offen lds
  s_cmp_eq_u32 s3, 1
  s_cbranch_scc1 L_lv_70
  s_cmp_eq_u32 s3, 2
  s_cbranch_scc1 L_lv_71
  s_cmp_eq_u32 s3, 3
  s_cbranch_scc1 L_lv_72
L_lv_69:
  ds_read_b64_tr_b16 v[192:193], v122 offset:0
  ds_read_b64_tr_b16 v[194:195], v122 offset:1024
  ds_read_b64_tr_b16 v[196:197], v122 offset:4096
  ds_read_b64_tr_b16 v[198:199], v122 offset:5120
  ds_read_b64_tr_b16 v[200:201], v123 offset:0
  ds_read_b64_tr_b16 v[202:203], v123 offset:1024
  ds_read_b64_tr_b16 v[204:205], v123 offset:4096
  ds_read_b64_tr_b16 v[206:207], v123 offset:5120
  ds_read_b64_tr_b16 v[208:209], v122 offset:16384
  ds_read_b64_tr_b16 v[210:211], v122 offset:17408
  ds_read_b64_tr_b16 v[212:213], v122 offset:20480
  ds_read_b64_tr_b16 v[214:215], v122 offset:21504
  ds_read_b64_tr_b16 v[216:217], v123 offset:16384
  ds_read_b64_tr_b16 v[218:219], v123 offset:17408
  ds_read_b64_tr_b16 v[220:221], v123 offset:20480
  ds_read_b64_tr_b16 v[222:223], v123 offset:21504
  s_branch L_lw_68
L_lv_70:
  ds_read_b64_tr_b16 v[160:161], v122 offset:0
  ds_read_b64_tr_b16 v[162:163], v122 offset:1024
  ds_read_b64_tr_b16 v[164:165], v122 offset:4096
  ds_read_b64_tr_b16 v[166:167], v122 offset:5120
  ds_read_b64_tr_b16 v[168:169], v123 offset:0
  ds_read_b64_tr_b16 v[170:171], v123 offset:1024
  ds_read_b64_tr_b16 v[172:173], v123 offset:4096
  ds_read_b64_tr_b16 v[174:175], v123 offset:5120
  ds_read_b64_tr_b16 v[176:177], v122 offset:16384
  ds_read_b64_tr_b16 v[178:179], v122 offset:17408
  ds_read_b64_tr_b16 v[180:181], v122 offset:20480
  ds_read_b64_tr_b16 v[182:183], v122 offset:21504
  ds_read_b64_tr_b16 v[184:185], v123 offset:16384
  ds_read_b64_tr_b16 v[186:187], v123 offset:17408
  ds_read_b64_tr_b16 v[188:189], v123 offset:20480
  ds_read_b64_tr_b16 v[190:191], v123 offset:21504
  s_branch L_lw_68
L_lv_71:
  ds_read_b64_tr_b16 v[128:129], v122 offset:0
  ds_read_b64_tr_b16 v[130:131], v122 offset:1024
  ds_read_b64_tr_b16 v[132:133], v122 offset:4096
  ds_read_b64_tr_b16 v[134:135], v122 offset:5120
  ds_read_b64_tr_b16 v[136:137], v123 offset:0
  ds_read_b64_tr_b16 v[138:139], v123 offset:1024
  ds_read_b64_tr_b16 v[140:141], v123 offset:4096
  ds_read_b64_tr_b16 v[142:143], v123 offset:5120
  ds_read_b64_tr_b16 v[144:145], v122 offset:16384
  ds_read_b64_tr_b16 v[146:147], v122 offset:17408
  ds_read_b64_tr_b16 v[148:149], v122 offset:20480
  ds_read_b64_tr_b16 v[150:151], v122 offset:21504
  ds_read_b64_tr_b16 v[152:153], v123 offset:16384
  ds_read_b64_tr_b16 v[154:155], v123 offset:17408
  ds_read_b64_tr_b16 v[156:157], v123 offset:20480
  ds_read_b64_tr_b16 v[158:159], v123 offset:21504
  s_branch L_lw_68
L_lv_72:
  ds_read_b64_tr_b16 v[224:225], v122 offset:0
  ds_read_b64_tr_b16 v[226:227], v122 offset:1024
  ds_read_b64_tr_b16 v[228:229], v122 offset:4096
  ds_read_b64_tr_b16 v[230:231], v122 offset:5120
  ds_read_b64_tr_b16 v[232:233], v123 offset:0
  ds_read_b64_tr_b16 v[234:235], v123 offset:1024
  ds_read_b64_tr_b16 v[236:237], v123 offset:4096
  ds_read_b64_tr_b16 v[238:239], v123 offset:5120
  ds_read_b64_tr_b16 v[240:241], v122 offset:16384
  ds_read_b64_tr_b16 v[242:243], v122 offset:17408
  ds_read_b64_tr_b16 v[244:245], v122 offset:20480
  ds_read_b64_tr_b16 v[246:247], v122 offset:21504
  ds_read_b64_tr_b16 v[248:249], v123 offset:16384
  ds_read_b64_tr_b16 v[250:251], v123 offset:17408
  ds_read_b64_tr_b16 v[252:253], v123 offset:20480
  ds_read_b64_tr_b16 v[254:255], v123 offset:21504
L_lw_68:
  s_waitcnt lgkmcnt(0)
  s_waitcnt vmcnt(16)
  s_barrier
  s_lshl_b32 s61, s5, 17
  s_lshl_b32 s62, s3, 15
  s_add_u32 s61, s61, s62
  s_add_u32 s61, s61, 512
  s_add_u32 m0, s60, 65536
  s_add_u32 s62, s61, 0
  buffer_load_dwordx4 v118, s[28:31], s62 offen lds
  s_add_u32 m0, s60, 66560
  s_add_u32 s62, s61, 4096
  buffer_load_dwordx4 v118, s[28:31], s62 offen lds
  s_add_u32 m0, s60, 67584
  s_add_u32 s62, s61, 8192
  buffer_load_dwordx4 v119, s[28:31], s62 offen lds
  s_add_u32 m0, s60, 68608
  s_add_u32 s62, s61, 12288
  buffer_load_dwordx4 v119, s[28:31], s62 offen lds
  s_add_u32 m0, s60, 69632
  s_add_u32 s62, s61, 16384
  buffer_load_dwordx4 v118, s[28:31], s62 offen lds
  s_add_u32 m0, s60, 70656
  s_add_u32 s62, s61, 20480
  buffer_load_dwordx4 v118, s[28:31], s62 offen lds
  s_add_u32 m0, s60, 71680
  s_add_u32 s62, s61, 24576
  buffer_load_dwordx4 v119, s[28:31], s62 offen lds
  s_add_u32 m0, s60, 72704
  s_add_u32 s62, s61, 28672
  buffer_load_dwordx4 v119, s[28:31], s62 offen lds
  s_cmp_eq_u32 s3, 1
  s_cbranch_scc1 L_lv_75
  s_cmp_eq_u32 s3, 2
  s_cbranch_scc1 L_lv_76
  s_cmp_eq_u32 s3, 3
  s_cbranch_scc1 L_lv_77
L_lv_74:
  ds_read_b64_tr_b16 v[224:225], v122 offset:32768
  ds_read_b64_tr_b16 v[226:227], v122 offset:33792
  ds_read_b64_tr_b16 v[228:229], v122 offset:36864
  ds_read_b64_tr_b16 v[230:231], v122 offset:37888
  ds_read_b64_tr_b16 v[232:233], v123 offset:32768
  ds_read_b64_tr_b16 v[234:235], v123 offset:33792
  ds_read_b64_tr_b16 v[236:237], v123 offset:36864
  ds_read_b64_tr_b16 v[238:239], v123 offset:37888
  ds_read_b64_tr_b16 v[240:241], v122 offset:49152
  ds_read_b64_tr_b16 v[242:243], v122 offset:50176
  ds_read_b64_tr_b16 v[244:245], v122 offset:53248
  ds_read_b64_tr_b16 v[246:247], v122 offset:54272
  ds_read_b64_tr_b16 v[248:249], v123 offset:49152
  ds_read_b64_tr_b16 v[250:251], v123 offset:50176
  ds_read_b64_tr_b16 v[252:253], v123 offset:53248
  ds_read_b64_tr_b16 v[254:255], v123 offset:54272
  s_branch L_lw_73
L_lv_75:
  ds_read_b64_tr_b16 v[192:193], v122 offset:32768
  ds_read_b64_tr_b16 v[194:195], v122 offset:33792
  ds_read_b64_tr_b16 v[196:197], v122 offset:36864
  ds_read_b64_tr_b16 v[198:199], v122 offset:37888
  ds_read_b64_tr_b16 v[200:201], v123 offset:32768
  ds_read_b64_tr_b16 v[202:203], v123 offset:33792
  ds_read_b64_tr_b16 v[204:205], v123 offset:36864
  ds_read_b64_tr_b16 v[206:207], v123 offset:37888
  ds_read_b64_tr_b16 v[208:209], v122 offset:49152
  ds_read_b64_tr_b16 v[210:211], v122 offset:50176
  ds_read_b64_tr_b16 v[212:213], v122 offset:53248
  ds_read_b64_tr_b16 v[214:215], v122 offset:54272
  ds_read_b64_tr_b16 v[216:217], v123 offset:49152
  ds_read_b64_tr_b16 v[218:219], v123 offset:50176
  ds_read_b64_tr_b16 v[220:221], v123 offset:53248
  ds_read_b64_tr_b16 v[222:223], v123 offset:54272
  s_branch L_lw_73
L_lv_76:
  ds_read_b64_tr_b16 v[160:161], v122 offset:32768
  ds_read_b64_tr_b16 v[162:163], v122 offset:33792
  ds_read_b64_tr_b16 v[164:165], v122 offset:36864
  ds_read_b64_tr_b16 v[166:167], v122 offset:37888
  ds_read_b64_tr_b16 v[168:169], v123 offset:32768
  ds_read_b64_tr_b16 v[170:171], v123 offset:33792
  ds_read_b64_tr_b16 v[172:173], v123 offset:36864
  ds_read_b64_tr_b16 v[174:175], v123 offset:37888
  ds_read_b64_tr_b16 v[176:177], v122 offset:49152
  ds_read_b64_tr_b16 v[178:179], v122 offset:50176
  ds_read_b64_tr_b16 v[180:181], v122 offset:53248
  ds_read_b64_tr_b16 v[182:183], v122 offset:54272
  ds_read_b64_tr_b16 v[184:185], v123 offset:49152
  ds_read_b64_tr_b16 v[186:187], v123 offset:50176
  ds_read_b64_tr_b16 v[188:189], v123 offset:53248
  ds_read_b64_tr_b16 v[190:191], v123 offset:54272
  s_branch L_lw_73
L_lv_77:
  ds_read_b64_tr_b16 v[128:129], v122 offset:32768
  ds_read_b64_tr_b16 v[130:131], v122 offset:33792
  ds_read_b64_tr_b16 v[132:133], v122 offset:36864
  ds_read_b64_tr_b16 v[134:135], v122 offset:37888
  ds_read_b64_tr_b16 v[136:137], v123 offset:32768
  ds_read_b64_tr_b16 v[138:139], v123 offset:33792
  ds_read_b64_tr_b16 v[140:141], v123 offset:36864
  ds_read_b64_tr_b16 v[142:143], v123 offset:37888
  ds_read_b64_tr_b16 v[144:145], v122 offset:49152
  ds_read_b64_tr_b16 v[146:147], v122 offset:50176
  ds_read_b64_tr_b16 v[148:149], v122 offset:53248
  ds_read_b64_tr_b16 v[150:151], v122 offset:54272
  ds_read_b64_tr_b16 v[152:153], v123 offset:49152
  ds_read_b64_tr_b16 v[154:155], v123 offset:50176
  ds_read_b64_tr_b16 v[156:157], v123 offset:53248
  ds_read_b64_tr_b16 v[158:159], v123 offset:54272
L_lw_73:
  s_waitcnt lgkmcnt(0)
  s_waitcnt vmcnt(16)
  s_barrier
  s_lshl_b32 s61, s5, 17
  s_lshl_b32 s62, s3, 15
  s_add_u32 s61, s61, s62
  s_add_u32 s61, s61, 768
  s_add_u32 m0, s60, 98304
  s_add_u32 s62, s61, 0
  buffer_load_dwordx4 v118, s[28:31], s62 offen lds
  s_add_u32 m0, s60, 99328
  s_add_u32 s62, s61, 4096
  buffer_load_dwordx4 v118, s[28:31], s62 offen lds
  s_add_u32 m0, s60, 100352
  s_add_u32 s62, s61, 8192
  buffer_load_dwordx4 v119, s[28:31], s62 offen lds
  s_add_u32 m0, s60, 101376
  s_add_u32 s62, s61, 12288
  buffer_load_dwordx4 v119, s[28:31], s62 offen lds
  s_add_u32 m0, s60, 102400
  s_add_u32 s62, s61, 16384
  buffer_load_dwordx4 v118, s[28:31], s62 offen lds
  s_add_u32 m0, s60, 103424
  s_add_u32 s62, s61, 20480
  buffer_load_dwordx4 v118, s[28:31], s62 offen lds
  s_add_u32 m0, s60, 104448
  s_add_u32 s62, s61, 24576
  buffer_load_dwordx4 v119, s[28:31], s62 offen lds
  s_add_u32 m0, s60, 105472
  s_add_u32 s62, s61, 28672
  buffer_load_dwordx4 v119, s[28:31], s62 offen lds
  v_xor_b32 v126, 0, v124
  ds_read_b64_tr_b16 v[20:21], v126 offset:0
  ds_read_b64_tr_b16 v[22:23], v126 offset:1024
  v_xor_b32 v126, 32, v124
  ds_read_b64_tr_b16 v[24:25], v126 offset:0
  ds_read_b64_tr_b16 v[26:27], v126 offset:1024
  v_xor_b32 v126, 64, v124
  ds_read_b64_tr_b16 v[28:29], v126 offset:0
  ds_read_b64_tr_b16 v[30:31], v126 offset:1024
  v_xor_b32 v126, 96, v124
  ds_read_b64_tr_b16 v[32:33], v126 offset:0
  ds_read_b64_tr_b16 v[34:35], v126 offset:1024
  v_xor_b32 v126, 128, v124
  ds_read_b64_tr_b16 v[36:37], v126 offset:0
  ds_read_b64_tr_b16 v[38:39], v126 offset:1024
  v_xor_b32 v126, 160, v124
  ds_read_b64_tr_b16 v[40:41], v126 offset:0
  ds_read_b64_tr_b16 v[42:43], v126 offset:1024
  v_xor_b32 v126, 192, v124
  ds_read_b64_tr_b16 v[44:45], v126 offset:0
  ds_read_b64_tr_b16 v[46:47], v126 offset:1024
  v_xor_b32 v126, 224, v124
  ds_read_b64_tr_b16 v[48:49], v126 offset:0
  ds_read_b64_tr_b16 v[50:51], v126 offset:1024
  s_waitcnt lgkmcnt(0)
  ds_write_b128 v127, v[20:23] offset:0
  ds_write_b128 v127, v[24:27] offset:1024
  ds_write_b128 v127, v[28:31] offset:2048
  ds_write_b128 v127, v[32:35] offset:3072
  ds_write_b128 v127, v[36:39] offset:4096
  ds_write_b128 v127, v[40:43] offset:5120
  ds_write_b128 v127, v[44:47] offset:6144
  ds_write_b128 v127, v[48:51] offset:7168
  s_waitcnt lgkmcnt(0)
  v_add_u32 v124, 0x8000, v124
  v_add_u32 v127, 0x8000, v127
  s_waitcnt vmcnt(16)
  v_xor_b32 v126, 0, v124
  ds_read_b64_tr_b16 v[20:21], v126 offset:0
  ds_read_b64_tr_b16 v[22:23], v126 offset:1024
  v_xor_b32 v126, 32, v124
  ds_read_b64_tr_b16 v[24:25], v126 offset:0
  ds_read_b64_tr_b16 v[26:27], v126 offset:1024
  v_xor_b32 v126, 64, v124
  ds_read_b64_tr_b16 v[28:29], v126 offset:0
  ds_read_b64_tr_b16 v[30:31], v126 offset:1024
  v_xor_b32 v126, 96, v124
  ds_read_b64_tr_b16 v[32:33], v126 offset:0
  ds_read_b64_tr_b16 v[34:35], v126 offset:1024
  v_xor_b32 v126, 128, v124
  ds_read_b64_tr_b16 v[36:37], v126 offset:0
  ds_read_b64_tr_b16 v[38:39], v126 offset:1024
  v_xor_b32 v126, 160, v124
  ds_read_b64_tr_b16 v[40:41], v126 offset:0
  ds_read_b64_tr_b16 v[42:43], v126 offset:1024
  v_xor_b32 v126, 192, v124
  ds_read_b64_tr_b16 v[44:45], v126 offset:0
  ds_read_b64_tr_b16 v[46:47], v126 offset:1024
  v_xor_b32 v126, 224, v124
  ds_read_b64_tr_b16 v[48:49], v126 offset:0
  ds_read_b64_tr_b16 v[50:51], v126 offset:1024
  s_waitcnt lgkmcnt(0)
  ds_write_b128 v127, v[20:23] offset:0
  ds_write_b128 v127, v[24:27] offset:1024
  ds_write_b128 v127, v[28:31] offset:2048
  ds_write_b128 v127, v[32:35] offset:3072
  ds_write_b128 v127, v[36:39] offset:4096
  ds_write_b128 v127, v[40:43] offset:5120
  ds_write_b128 v127, v[44:47] offset:6144
  ds_write_b128 v127, v[48:51] offset:7168
  s_waitcnt lgkmcnt(0)
  v_add_u32 v124, 0x8000, v124
  v_add_u32 v127, 0x8000, v127
  s_waitcnt vmcnt(8)
  v_xor_b32 v126, 0, v124
  ds_read_b64_tr_b16 v[20:21], v126 offset:0
  ds_read_b64_tr_b16 v[22:23], v126 offset:1024
  v_xor_b32 v126, 32, v124
  ds_read_b64_tr_b16 v[24:25], v126 offset:0
  ds_read_b64_tr_b16 v[26:27], v126 offset:1024
  v_xor_b32 v126, 64, v124
  ds_read_b64_tr_b16 v[28:29], v126 offset:0
  ds_read_b64_tr_b16 v[30:31], v126 offset:1024
  v_xor_b32 v126, 96, v124
  ds_read_b64_tr_b16 v[32:33], v126 offset:0
  ds_read_b64_tr_b16 v[34:35], v126 offset:1024
  v_xor_b32 v126, 128, v124
  ds_read_b64_tr_b16 v[36:37], v126 offset:0
  ds_read_b64_tr_b16 v[38:39], v126 offset:1024
  v_xor_b32 v126, 160, v124
  ds_read_b64_tr_b16 v[40:41], v126 offset:0
  ds_read_b64_tr_b16 v[42:43], v126 offset:1024
  v_xor_b32 v126, 192, v124
  ds_read_b64_tr_b16 v[44:45], v126 offset:0
  ds_read_b64_tr_b16 v[46:47], v126 offset:1024
  v_xor_b32 v126, 224, v124
  ds_read_b64_tr_b16 v[48:49], v126 offset:0
  ds_read_b64_tr_b16 v[50:51], v126 offset:1024
  s_waitcnt lgkmcnt(0)
  ds_write_b128 v127, v[20:23] offset:0
  ds_write_b128 v127, v[24:27] offset:1024
  ds_write_b128 v127, v[28:31] offset:2048
  ds_write_b128 v127, v[32:35] offset:3072
  ds_write_b128 v127, v[36:39] offset:4096
  ds_write_b128 v127, v[40:43] offset:5120
  ds_write_b128 v127, v[44:47] offset:6144
  ds_write_b128 v127, v[48:51] offset:7168
  s_waitcnt lgkmcnt(0)
  v_add_u32 v124, 0x8000, v124
  v_add_u32 v127, 0x8000, v127
  s_waitcnt vmcnt(0)
  v_cmp_ne_u32 vcc, 64, v17
  s_cbranch_vccz L_rec_dn
  s_mov_b32 s7, 0
  v_mbcnt_lo_u32_b32 v16, -1, 0
  v_and_b32 v16, 3, v16
  v_lshlrev_b32 v16, 6, v16
L_wd_78:
  buffer_load_dword v17, v16, s[12:15], 0 offen offset:16 sc1
  s_waitcnt vmcnt(0)
  v_cmp_ne_u32 vcc, 64, v17
  s_cbranch_vccz L_wdo_79
  s_add_u32 s7, s7, 1
  s_cmp_lt_u32 s7, 131072
  s_cbranch_scc1 L_wd_78
  s_mov_b32 s6, 10
  s_branch L_err
L_wdo_79:
L_rec_dn:
  s_sub_u32 s60, s35, s53
  s_add_u32 s61, s60, 4096
  buffer_load_dwordx4 v[52:55], v4, s[8:11], s60 offen offset:0 sc1
  buffer_load_dwordx4 v[68:71], v4, s[8:11], s60 offen offset:128 sc1
  buffer_load_dwordx4 v[56:59], v4, s[8:11], s60 offen offset:2048 sc1
  buffer_load_dwordx4 v[72:75], v4, s[8:11], s60 offen offset:2176 sc1
  buffer_load_dwordx4 v[60:63], v4, s[8:11], s61 offen offset:0 sc1
  buffer_load_dwordx4 v[76:79], v4, s[8:11], s61 offen offset:128 sc1
  buffer_load_dwordx4 v[64:67], v4, s[8:11], s61 offen offset:2048 sc1
  buffer_load_dwordx4 v[80:83], v4, s[8:11], s61 offen offset:2176 sc1
  buffer_load_dwordx4 v[108:111], v9, s[8:11], s60 offen offset:0 sc1
  buffer_load_dwordx4 v[112:115], v9, s[8:11], s60 offen offset:256 sc1
  v_xor_b32 v126, 0, v124
  ds_read_b64_tr_b16 v[20:21], v126 offset:0
  ds_read_b64_tr_b16 v[22:23], v126 offset:1024
  v_xor_b32 v126, 32, v124
  ds_read_b64_tr_b16 v[24:25], v126 offset:0
  ds_read_b64_tr_b16 v[26:27], v126 offset:1024
  v_xor_b32 v126, 64, v124
  ds_read_b64_tr_b16 v[28:29], v126 offset:0
  ds_read_b64_tr_b16 v[30:31], v126 offset:1024
  v_xor_b32 v126, 96, v124
  ds_read_b64_tr_b16 v[32:33], v126 offset:0
  ds_read_b64_tr_b16 v[34:35], v126 offset:1024
  v_xor_b32 v126, 128, v124
  ds_read_b64_tr_b16 v[36:37], v126 offset:0
  ds_read_b64_tr_b16 v[38:39], v126 offset:1024
  v_xor_b32 v126, 160, v124
  ds_read_b64_tr_b16 v[40:41], v126 offset:0
  ds_read_b64_tr_b16 v[42:43], v126 offset:1024
  v_xor_b32 v126, 192, v124
  ds_read_b64_tr_b16 v[44:45], v126 offset:0
  ds_read_b64_tr_b16 v[46:47], v126 offset:1024
  v_xor_b32 v126, 224, v124
  ds_read_b64_tr_b16 v[48:49], v126 offset:0
  ds_read_b64_tr_b16 v[50:51], v126 offset:1024
  s_waitcnt lgkmcnt(0)
  ds_write_b128 v127, v[20:23] offset:0
  ds_write_b128 v127, v[24:27] offset:1024
  ds_write_b128 v127, v[28:31] offset:2048
  ds_write_b128 v127, v[32:35] offset:3072
  ds_write_b128 v127, v[36:39] offset:4096
  ds_write_b128 v127, v[40:43] offset:5120
  ds_write_b128 v127, v[44:47] offset:6144
  ds_write_b128 v127, v[48:51] offset:7168
  s_waitcnt lgkmcnt(0)
  v_add_u32 v124, 0x8000, v124
  v_add_u32 v127, 0x8000, v127
  v_mov_b64 v[20:21], v[84:85]
  v_mov_b64 v[22:23], v[86:87]
  v_mov_b64 v[24:25], v[88:89]
  v_mov_b64 v[26:27], v[90:91]
  s_mov_b32 s32, 0
  s_mov_b32 s49, 1
  s_mov_b32 s33, 1
  s_mov_b32 s59, 1
  s_and_b32 s6, s32, 3
  s_lshl_b32 s6, s6, 19
  s_add_u32 s6, s6, s35
  s_sub_u32 s60, s6, s53
  s_add_u32 s61, s60, 4096
  s_mov_b32 s7, 0
  s_branch L_kvt_81
L_kvs_80:
  buffer_load_dwordx4 v[52:55], v4, s[8:11], s60 offen offset:0 sc1
  buffer_load_dwordx4 v[68:71], v4, s[8:11], s60 offen offset:128 sc1
  buffer_load_dwordx4 v[56:59], v4, s[8:11], s60 offen offset:2048 sc1
  buffer_load_dwordx4 v[72:75], v4, s[8:11], s60 offen offset:2176 sc1
  buffer_load_dwordx4 v[60:63], v4, s[8:11], s61 offen offset:0 sc1
  buffer_load_dwordx4 v[76:79], v4, s[8:11], s61 offen offset:128 sc1
  buffer_load_dwordx4 v[64:67], v4, s[8:11], s61 offen offset:2048 sc1
  buffer_load_dwordx4 v[80:83], v4, s[8:11], s61 offen offset:2176 sc1
  buffer_load_dwordx4 v[108:111], v9, s[8:11], s60 offen offset:0 sc1
  buffer_load_dwordx4 v[112:115], v9, s[8:11], s60 offen offset:256 sc1
L_kvt_81:
  s_waitcnt vmcnt(0)
  v_bitop3_b32 v16, v52, v56, s59 bitop3:0x7e
  v_bitop3_b32 v17, v60, v64, s59 bitop3:0x7e
  v_bitop3_b32 v18, v68, v72, s59 bitop3:0x7e
  v_bitop3_b32 v19, v76, v80, s59 bitop3:0x7e
  v_or3_b32 v16, v16, v17, v18
  v_bitop3_b32 v17, v108, v112, s59 bitop3:0x7e
  v_or3_b32 v16, v16, v17, v19
  v_and_b32 v16, 1, v16
  v_cmp_ne_u32 vcc, 0, v16
  s_cbranch_vccz L_rec_go
  s_add_u32 s7, s7, 1
  s_cmp_lt_u32 s7, 131072
  s_cbranch_scc1 L_kvs_80
  s_mov_b32 s6, 13
  s_branch L_err
L_rec_go:
  s_add_u32 s6, s32, 1
  s_and_b32 s6, s6, 3
  s_lshl_b32 s6, s6, 19
  s_add_u32 s50, s35, s6
  s_add_u32 s51, s50, 0x2000
  v_add_u32 v116, s48, v1
  v_add_u32 v117, s45, v1
  v_add_u32 v118, s46, v1
  v_add_u32 v119, s47, v1
  v_mov_b64 v[84:85], 0
  v_mov_b64 v[86:87], 0
  v_mov_b64 v[88:89], 0
  v_mov_b64 v[90:91], 0
  v_mov_b64 v[92:93], 0
  v_mov_b64 v[94:95], 0
  v_mov_b64 v[96:97], 0
  v_mov_b64 v[98:99], 0
  v_mov_b64 v[100:101], 0
  v_mov_b64 v[102:103], 0
  v_mov_b64 v[104:105], 0
  v_mov_b64 v[106:107], 0
  s_mov_b64 s[60:61], 0
  s_branch L_rec_step
L_rec_loop:
  buffer_load_dwordx4 v[20:23], v1, s[8:11], s44 offen sc1
  buffer_load_dwordx4 v[24:27], v1, s[8:11], s44 offen offset:1024 sc1
  s_mov_b32 s7, 0
  v_add_u32 v116, s48, v1
  v_add_u32 v117, s45, v1
  v_add_u32 v118, s46, v1
  v_add_u32 v119, s47, v1
  v_mov_b64 v[84:85], 0
  v_mov_b64 v[86:87], 0
  v_mov_b64 v[88:89], 0
  v_mov_b64 v[90:91], 0
  v_mov_b64 v[92:93], 0
  v_mov_b64 v[94:95], 0
  v_mov_b64 v[96:97], 0
  v_mov_b64 v[98:99], 0
  v_mov_b64 v[100:101], 0
  v_mov_b64 v[102:103], 0
  v_mov_b64 v[104:105], 0
  v_mov_b64 v[106:107], 0
  buffer_load_dwordx4 v[120:123], v1, s[8:11], s44 offen sc1
  buffer_load_dwordx4 v[124:127], v1, s[8:11], s44 offen offset:1024 sc1
  s_branch L_rec_gather1
L_rec_gather:
  buffer_load_dwordx4 v[120:123], v1, s[8:11], s44 offen sc1
  buffer_load_dwordx4 v[124:127], v1, s[8:11], s44 offen offset:1024 sc1
L_rec_gather1:
  s_waitcnt vmcnt(2)
  v_bitop3_b32 v16, v20, v22, s33 bitop3:0x7e
  v_bitop3_b32 v17, v24, v26, s33 bitop3:0x7e
  v_bitop3_b32 v16, v16, v17, 1 bitop3:0xa8
  v_cmp_ne_u32 vcc, 0, v16
  s_cbranch_vccz L_rec_got
  buffer_load_dwordx4 v[20:23], v1, s[8:11], s44 offen sc1
  buffer_load_dwordx4 v[24:27], v1, s[8:11], s44 offen offset:1024 sc1
  s_waitcnt vmcnt(2)
  v_bitop3_b32 v16, v120, v122, s33 bitop3:0x7e
  v_bitop3_b32 v17, v124, v126, s33 bitop3:0x7e
  v_bitop3_b32 v16, v16, v17, 1 bitop3:0xa8
  v_cmp_ne_u32 vcc, 0, v16
  s_cbranch_vccz L_rec_got1
  s_and_b32 s6, s7, 31
  s_cmp_lg_u32 s6, 31
  s_cbranch_scc1 L_tf_82
  buffer_wbl2 sc1
  s_waitcnt vmcnt(0)
  buffer_inv sc1
  s_waitcnt vmcnt(0)
L_tf_82:
  s_add_u32 s7, s7, 1
  s_cmp_lt_u32 s7, 131072
  s_cbranch_scc1 L_rec_gather
  s_mov_b32 s6, 12
  s_branch L_err
L_rec_got1:
  v_mov_b64 v[20:21], v[120:121]
  v_mov_b64 v[22:23], v[122:123]
  v_mov_b64 v[24:25], v[124:125]
  v_mov_b64 v[26:27], v[126:127]
L_rec_got:
  s_mov_b32 s63, s7
  s_xor_b32 s33, s33, 1
L_rec_step:
  ds_write_b128 v116, v[20:23]
  ds_write_b128 v116, v[24:27] offset:1024
  v_smfmac_f32_16x16x64_bf16 v[84:87], v[20:23], a[0:7], v0
  s_and_b32 s6, s32, 3
  v_smfmac_f32_16x16x64_bf16 v[88:91], v[20:23], a[8:15], v0
  s_lshl_b32 s6, s6, 17
  v_smfmac_f32_16x16x64_bf16 v[84:87], v[24:27], a[16:23], v0
  s_add_u32 s52, s36, s6
  v_smfmac_f32_16x16x64_bf16 v[88:91], v[24:27], a[24:31], v0
  s_cmp_lg_u64 s[60:61], 0
  s_waitcnt lgkmcnt(0)
  s_barrier
  ds_read_b128 v[28:31], v117 offset:0
  ds_read_b128 v[32:35], v117 offset:1024
  v_smfmac_f32_16x16x64_bf16 v[92:95], v[20:23], a[128:135], v0
  ds_read_b128 v[36:39], v118 offset:0
  ds_read_b128 v[40:43], v118 offset:1024
  v_smfmac_f32_16x16x64_bf16 v[96:99], v[20:23], a[136:143], v0
  ds_read_b128 v[44:47], v119 offset:0
  ds_read_b128 v[48:51], v119 offset:1024
  v_smfmac_f32_16x16x64_bf16 v[92:95], v[24:27], a[144:151], v0
  v_smfmac_f32_16x16x64_bf16 v[96:99], v[24:27], a[152:159], v0
  v_smfmac_f32_16x16x64_bf16 v[100:103], v[20:23], v[128:135], v0
  v_smfmac_f32_16x16x64_bf16 v[104:107], v[20:23], v[136:143], v0
  v_smfmac_f32_16x16x64_bf16 v[100:103], v[24:27], v[144:151], v0
  v_smfmac_f32_16x16x64_bf16 v[104:107], v[24:27], v[152:159], v0
  s_cbranch_scc1 L_rec_kvwait
L_rec_kvok:
  s_waitcnt lgkmcnt(5)
  v_smfmac_f32_16x16x64_bf16 v[84:87], v[28:31], a[32:39], v0
  v_smfmac_f32_16x16x64_bf16 v[88:91], v[28:31], a[40:47], v0
  s_mov_b32 m0, s53
  s_waitcnt lgkmcnt(4)
  v_smfmac_f32_16x16x64_bf16 v[84:87], v[32:35], a[48:55], v0
  v_smfmac_f32_16x16x64_bf16 v[88:91], v[32:35], a[56:63], v0
  buffer_load_dwordx4 v1, s[8:11], s50 offen sc1 lds
  s_waitcnt lgkmcnt(3)
  v_smfmac_f32_16x16x64_bf16 v[84:87], v[36:39], a[64:71], v0
  v_smfmac_f32_16x16x64_bf16 v[88:91], v[36:39], a[72:79], v0
  buffer_load_dwordx4 v1, s[8:11], s50 offen offset:1024 sc1 lds
  s_waitcnt lgkmcnt(2)
  v_smfmac_f32_16x16x64_bf16 v[84:87], v[40:43], a[80:87], v0
  v_smfmac_f32_16x16x64_bf16 v[88:91], v[40:43], a[88:95], v0
  s_mov_b32 m0, s37
  s_waitcnt lgkmcnt(1)
  v_smfmac_f32_16x16x64_bf16 v[84:87], v[44:47], a[96:103], v0
  v_smfmac_f32_16x16x64_bf16 v[88:91], v[44:47], a[104:111], v0
  buffer_load_dwordx4 v1, s[8:11], s51 offen sc1 lds
  s_waitcnt lgkmcnt(0)
  v_smfmac_f32_16x16x64_bf16 v[84:87], v[48:51], a[112:119], v0
  v_smfmac_f32_16x16x64_bf16 v[88:91], v[48:51], a[120:127], v0
  buffer_load_dwordx4 v1, s[8:11], s51 offen offset:1024 sc1 lds
  v_smfmac_f32_16x16x64_bf16 v[92:95], v[28:31], a[160:167], v0
  v_smfmac_f32_16x16x64_bf16 v[92:95], v[32:35], a[176:183], v0
  v_smfmac_f32_16x16x64_bf16 v[92:95], v[36:39], a[192:199], v0
  v_smfmac_f32_16x16x64_bf16 v[92:95], v[40:43], a[208:215], v0
  v_smfmac_f32_16x16x64_bf16 v[92:95], v[44:47], a[224:231], v0
  s_nop 0
  v_add_f32 v84, v84, v85
  v_add_f32 v86, v86, v87
  v_smfmac_f32_16x16x64_bf16 v[92:95], v[48:51], a[240:247], v0
  v_cvt_pk_bf16_f32 v16, v84, v86
  v_add_f32 v88, v88, v89
  v_smfmac_f32_16x16x64_bf16 v[96:99], v[28:31], a[168:175], v0
  v_add_f32 v90, v90, v91
  v_cvt_pk_bf16_f32 v18, v88, v90
  v_smfmac_f32_16x16x64_bf16 v[96:99], v[32:35], a[184:191], v0
  v_smfmac_f32_16x16x64_bf16 v[96:99], v[36:39], a[200:207], v0
  s_nop 0
  v_add_f32 v92, v92, v93
  v_smfmac_f32_16x16x64_bf16 v[96:99], v[40:43], a[216:223], v0
  v_add_f32 v94, v94, v95
  v_smfmac_f32_16x16x64_bf16 v[96:99], v[44:47], a[232:239], v0
  v_cvt_pk_bf16_f32 v17, v92, v94
  v_smfmac_f32_16x16x64_bf16 v[96:99], v[48:51], a[248:255], v0
  ds_write_b64 v2, v[16:17]
  v_smfmac_f32_16x16x64_bf16 v[100:103], v[28:31], v[160:167], v0
  v_smfmac_f32_16x16x64_bf16 v[104:107], v[28:31], v[168:175], v0
  s_nop 4
  v_add_f32 v96, v96, v97
  v_add_f32 v98, v98, v99
  v_cvt_pk_bf16_f32 v19, v96, v98
  ds_write_b64 v2, v[18:19] offset:128
  v_smfmac_f32_16x16x64_bf16 v[100:103], v[32:35], v[176:183], v0
  v_smfmac_f32_16x16x64_bf16 v[104:107], v[32:35], v[184:191], v0
  s_waitcnt lgkmcnt(0)
  s_barrier
  ds_read_b64_tr_b16 v[84:85], v3 offset:0
  ds_read_b64_tr_b16 v[86:87], v3 offset:64
  v_smfmac_f32_16x16x64_bf16 v[100:103], v[36:39], v[192:199], v0
  ds_read_b64_tr_b16 v[88:89], v3 offset:256
  ds_read_b64_tr_b16 v[90:91], v3 offset:320
  v_smfmac_f32_16x16x64_bf16 v[104:107], v[36:39], v[200:207], v0
  ds_read_b64_tr_b16 v[92:93], v3 offset:512
  ds_read_b64_tr_b16 v[94:95], v3 offset:576
  v_smfmac_f32_16x16x64_bf16 v[100:103], v[40:43], v[208:215], v0
  ds_read_b64_tr_b16 v[96:97], v3 offset:768
  ds_read_b64_tr_b16 v[98:99], v3 offset:832
  v_smfmac_f32_16x16x64_bf16 v[104:107], v[40:43], v[216:223], v0
  s_waitcnt vmcnt(4)
  s_waitcnt lgkmcnt(6)
  v_mfma_f32_16x16x32_bf16 v[116:119], v[52:55], v[84:87], 0
  v_mfma_f32_16x16x32_bf16 v[120:123], v[68:71], v[84:87], 0
  v_mfma_f32_16x16x32_bf16 v[124:127], v[84:87], v[84:87], 0
  s_waitcnt lgkmcnt(4)
  v_mfma_f32_16x16x32_bf16 v[116:119], v[56:59], v[88:91], v[116:119]
  v_mfma_f32_16x16x32_bf16 v[120:123], v[72:75], v[88:91], v[120:123]
  v_mfma_f32_16x16x32_bf16 v[124:127], v[88:91], v[88:91], v[124:127]
  s_waitcnt lgkmcnt(2)
  v_mfma_f32_16x16x32_bf16 v[116:119], v[60:63], v[92:95], v[116:119]
  v_mfma_f32_16x16x32_bf16 v[120:123], v[76:79], v[92:95], v[120:123]
  v_mfma_f32_16x16x32_bf16 v[124:127], v[92:95], v[92:95], v[124:127]
  s_waitcnt lgkmcnt(0)
  v_mfma_f32_16x16x32_bf16 v[116:119], v[64:67], v[96:99], v[116:119]
  v_mfma_f32_16x16x32_bf16 v[120:123], v[80:83], v[96:99], v[120:123]
  v_mfma_f32_16x16x32_bf16 v[124:127], v[96:99], v[96:99], v[124:127]
  v_smfmac_f32_16x16x64_bf16 v[100:103], v[44:47], v[224:231], v0
  ds_read_b128 v[52:55], v7 offset:0
  ds_read_b128 v[56:59], v7 offset:8192
  s_nop 2
  v_max3_f32 v88, v116, v117, v118
  v_max3_f32 v89, v120, v121, v122
  v_max3_f32 v88, v88, v119, v123
  v_max3_f32 v89, v89, v126, v127
  v_max_f32 v88, v88, v89
  v_max_f32 v89, v88, v89
  v_smfmac_f32_16x16x64_bf16 v[104:107], v[44:47], v[232:239], v0
  ds_read_b128 v[60:63], v7 offset:1024
  v_permlane32_swap_b32 v88, v89
  v_max_f32 v88, v88, v89
  v_max_f32 v89, v88, v89
  v_smfmac_f32_16x16x64_bf16 v[100:103], v[48:51], v[240:247], v0
  ds_read_b128 v[64:67], v7 offset:9216
  v_permlane16_swap_b32 v88, v89
  v_max_f32 v88, v88, v89
  v_mul_f32 v88, s34, v88
  v_smfmac_f32_16x16x64_bf16 v[104:107], v[48:51], v[248:255], v0
  v_fma_f32 v126, v126, s34, -v88
  v_fma_f32 v127, v127, s34, -v88
  v_exp_f32 v126, v126
  ds_read_b128 v[68:71], v7 offset:16384
  v_exp_f32 v127, v127
  ds_read_b128 v[72:75], v7 offset:24576
  v_fma_f32 v116, v116, s34, -v88
  v_fma_f32 v117, v117, s34, -v88
  v_fma_f32 v118, v118, s34, -v88
  v_fma_f32 v119, v119, s34, -v88
  v_cvt_pk_bf16_f32 v12, v126, v127
  v_exp_f32 v116, v116
  ds_read_b128 v[76:79], v7 offset:17408
  v_exp_f32 v117, v117
  ds_read_b128 v[80:83], v7 offset:25600
  v_mfma_f32_16x16x16_bf16 v[124:127], v[10:11], v[12:13], 0
  v_exp_f32 v118, v118
  ds_read_b128 v[20:23], v7 offset:2048
  v_exp_f32 v119, v119
  ds_read_b128 v[24:27], v7 offset:10240
  v_add_f32 v100, v100, v101
  v_add_f32 v102, v102, v103
  v_cvt_pk_bf16_f32 v16, v100, v102
  v_cvt_pk_bf16_f32 v92, v116, v117
  v_cvt_pk_bf16_f32 v93, v118, v119
  v_add_f32 v104, v104, v105
  v_add_f32 v106, v106, v107
  v_cvt_pk_bf16_f32 v18, v104, v106
  v_mfma_f32_16x16x16_bf16 v[124:127], v[10:11], v[92:93], v[124:127]
  v_bfi_b32 v16, 1, s59, v16
  v_fma_f32 v120, v120, s34, -v88
  v_fma_f32 v121, v121, s34, -v88
  buffer_store_dwordx4 v[16:19], v1, s[8:11], s52 offen sc1
  v_mfma_f32_16x16x16_bf16 v[100:103], v[16:17], v[12:13], 0
  v_fma_f32 v122, v122, s34, -v88
  v_fma_f32 v123, v123, s34, -v88
  v_mfma_f32_16x16x16_bf16 v[104:107], v[18:19], v[12:13], 0
  v_exp_f32 v120, v120
  ds_read_b128 v[28:31], v7 offset:3072
  v_exp_f32 v121, v121
  ds_read_b128 v[32:35], v7 offset:11264
  v_exp_f32 v122, v122
  ds_read_b128 v[36:39], v7 offset:18432
  v_exp_f32 v123, v123
  ds_read_b128 v[40:43], v7 offset:26624
  s_cmp_eq_u32 s32, 63
  v_cvt_pk_bf16_f32 v94, v120, v121
  v_cvt_pk_bf16_f32 v95, v122, v123
  s_cbranch_scc1 L_rec_last
  s_nop 0
  v_mfma_f32_16x16x16_bf16 v[124:127], v[10:11], v[94:95], v[124:127]
  v_mfma_f32_16x16x32_bf16 v[100:103], v[108:111], v[92:95], v[100:103]
  v_mfma_f32_16x16x32_bf16 v[104:107], v[112:115], v[92:95], v[104:107]
  ds_read_b128 v[44:47], v7 offset:19456
  ds_read_b128 v[48:51], v7 offset:27648
  s_nop 3
  v_rcp_f32 v124, v124
  s_nop 0
  v_pk_mul_f32 v[100:101], v[100:101], v[124:125] op_sel_hi:[1,0]
  v_pk_mul_f32 v[102:103], v[102:103], v[124:125] op_sel_hi:[1,0]
  v_cvt_pk_bf16_f32 v116, v100, v101
  v_cvt_pk_bf16_f32 v117, v102, v103
  v_pk_mul_f32 v[104:105], v[104:105], v[124:125] op_sel_hi:[1,0]
  v_pk_mul_f32 v[106:107], v[106:107], v[124:125] op_sel_hi:[1,0]
  v_cvt_pk_bf16_f32 v118, v104, v105
  v_cvt_pk_bf16_f32 v119, v106, v107
  s_mov_b64 exec, s[56:57]
  ds_write2_b32 v5, v116, v117 offset0:0 offset1:4
  ds_write2_b32 v5, v118, v119 offset0:8 offset1:12
  s_mov_b64 exec, -1
  v_mfma_f32_32x32x8_bf16 v[84:99], v[12:13], v[14:15], 0
  v_mfma_f32_32x32x8_bf16 v[100:115], v[12:13], v[14:15], 0
  s_waitcnt vmcnt(1) lgkmcnt(0)
  s_barrier
  ds_read_b128 v[116:119], v6
  ds_read_b128 v[120:123], v6 offset:128
  s_waitcnt lgkmcnt(1)
  s_nop 3
  v_smfmac_f32_16x16x64_bf16 v[84:87], v[116:119], v[52:59], v0
  ds_read_b128 v[52:55], v7 offset:4096
  ds_read_b128 v[56:59], v7 offset:12288
  v_smfmac_f32_16x16x64_bf16 v[88:91], v[116:119], v[60:67], v0
  ds_read_b128 v[60:63], v7 offset:5120
  ds_read_b128 v[64:67], v7 offset:13312
  s_waitcnt lgkmcnt(4)
  v_smfmac_f32_16x16x64_bf16 v[84:87], v[120:123], v[68:75], v0
  ds_read_b128 v[68:71], v7 offset:20480
  ds_read_b128 v[72:75], v7 offset:28672
  v_smfmac_f32_16x16x64_bf16 v[88:91], v[120:123], v[76:83], v0
  ds_read_b128 v[76:79], v7 offset:21504
  ds_read_b128 v[80:83], v7 offset:29696
  v_smfmac_f32_16x16x64_bf16 v[92:95], v[116:119], v[20:27], v0
  ds_read_b128 v[20:23], v7 offset:6144
  ds_read_b128 v[24:27], v7 offset:14336
  v_smfmac_f32_16x16x64_bf16 v[96:99], v[116:119], v[28:35], v0
  ds_read_b128 v[28:31], v7 offset:7168
  ds_read_b128 v[32:35], v7 offset:15360
  v_add_f32 v84, v84, v85
  v_smfmac_f32_16x16x64_bf16 v[92:95], v[120:123], v[36:43], v0
  ds_read_b128 v[36:39], v7 offset:22528
  ds_read_b128 v[40:43], v7 offset:30720
  v_add_f32 v86, v86, v87
  v_smfmac_f32_16x16x64_bf16 v[96:99], v[120:123], v[44:51], v0
  ds_read_b128 v[44:47], v7 offset:23552
  ds_read_b128 v[48:51], v7 offset:31744
  v_cvt_pk_bf16_f32 v124, v84, v86
  s_waitcnt lgkmcnt(14)
  v_smfmac_f32_16x16x64_bf16 v[100:103], v[116:119], v[52:59], v0
  v_add_f32 v88, v88, v89
  v_add_f32 v90, v90, v91
  s_waitcnt lgkmcnt(12)
  v_smfmac_f32_16x16x64_bf16 v[104:107], v[116:119], v[60:67], v0
  v_cvt_pk_bf16_f32 v125, v88, v90
  v_add_f32 v92, v92, v93
  s_waitcnt lgkmcnt(10)
  v_smfmac_f32_16x16x64_bf16 v[100:103], v[120:123], v[68:75], v0
  v_add_f32 v94, v94, v95
  v_cvt_pk_bf16_f32 v126, v92, v94
  s_waitcnt lgkmcnt(8)
  v_smfmac_f32_16x16x64_bf16 v[104:107], v[120:123], v[76:83], v0
  v_add_f32 v96, v96, v97
  v_add_f32 v98, v98, v99
  s_waitcnt lgkmcnt(6)
  v_smfmac_f32_16x16x64_bf16 v[108:111], v[116:119], v[20:27], v0
  v_cvt_pk_bf16_f32 v127, v96, v98
  v_bfi_b32 v124, 1, s33, v124
  s_waitcnt lgkmcnt(4)
  v_smfmac_f32_16x16x64_bf16 v[112:115], v[116:119], v[28:35], v0
  buffer_store_dwordx4 v[124:127], v8, s[8:11], s39 offen
  v_add_f32 v100, v100, v101
  s_waitcnt lgkmcnt(2)
  v_smfmac_f32_16x16x64_bf16 v[108:111], v[120:123], v[36:43], v0
  v_add_f32 v102, v102, v103
  v_cvt_pk_bf16_f32 v16, v100, v102
  s_waitcnt lgkmcnt(0)
  v_smfmac_f32_16x16x64_bf16 v[112:115], v[120:123], v[44:51], v0
  v_add_f32 v104, v104, v105
  v_add_f32 v106, v106, v107
  v_cvt_pk_bf16_f32 v17, v104, v106
  s_nop 0
  v_add_f32 v108, v108, v109
  v_add_f32 v110, v110, v111
  v_cvt_pk_bf16_f32 v18, v108, v110
  s_nop 0
  v_add_f32 v112, v112, v113
  v_add_f32 v114, v114, v115
  v_cvt_pk_bf16_f32 v19, v112, v114
  v_bfi_b32 v16, 1, s33, v16
  buffer_store_dwordx4 v[16:19], v8, s[8:11], s40 offen
  s_add_u32 s32, s32, 1
  ds_read_b128 v[52:55], v4 offset:0
  ds_read_b128 v[68:71], v4 offset:128
  ds_read_b128 v[56:59], v4 offset:2048
  ds_read_b128 v[72:75], v4 offset:2176
  ds_read_b128 v[60:63], v4 offset:4096
  ds_read_b128 v[76:79], v4 offset:4224
  ds_read_b128 v[64:67], v4 offset:6144
  ds_read_b128 v[80:83], v4 offset:6272
  ds_read_b128 v[108:111], v9
  ds_read_b128 v[112:115], v9 offset:256
  s_lshr_b32 s6, s32, 2
  s_andn2_b32 s59, 1, s6
  s_add_u32 s6, s32, 1
  s_and_b32 s6, s6, 3
  s_lshl_b32 s6, s6, 19
  s_add_u32 s50, s35, s6
  s_add_u32 s51, s50, 0x2000
  v_bfe_u32 v19, v1, 4, 4
  v_and_b32 v16, 1, v19
  v_lshlrev_b32 v17, 4, v16
  v_mov_b32 v18, 0x3f80
  v_lshlrev_b32 v17, v17, v18
  v_lshrrev_b32 v18, 1, v19
  v_cmp_eq_u32 vcc, 0, v18
  s_nop 1
  v_cndmask_b32 v120, 0, v17, vcc
  v_cmp_eq_u32 vcc, 1, v18
  s_nop 1
  v_cndmask_b32 v121, 0, v17, vcc
  v_cmp_eq_u32 vcc, 2, v18
  s_nop 1
  v_cndmask_b32 v122, 0, v17, vcc
  v_cmp_eq_u32 vcc, 3, v18
  s_nop 1
  v_cndmask_b32 v123, 0, v17, vcc
  v_lshlrev_b32 v16, 5, v16
  v_bfe_u32 v17, v19, 2, 1
  v_lshl_or_b32 v16, v17, 4, v16
  v_bfe_u32 v17, v19, 1, 1
  v_lshl_or_b32 v16, v17, 3, v16
  v_lshrrev_b32 v17, 8, v1
  v_lshl_or_b32 v124, v17, 6, v16
  s_waitcnt lgkmcnt(0)
  v_bitop3_b32 v16, v52, v56, s59 bitop3:0x7e
  v_bitop3_b32 v17, v60, v64, s59 bitop3:0x7e
  v_bitop3_b32 v18, v68, v72, s59 bitop3:0x7e
  v_bitop3_b32 v19, v76, v80, s59 bitop3:0x7e
  v_or3_b32 v16, v16, v17, v18
  v_bitop3_b32 v17, v108, v112, s59 bitop3:0x7e
  v_or3_b32 v16, v16, v17, v19
  v_and_b32 v16, 1, v16
  v_cmp_ne_u32 s[60:61], 0, v16
  v_mov_b32 v19, v124
  s_cmp_lg_u32 s3, 0
  s_cbranch_scc1 L_rec_nored
  s_mov_b32 s7, 0
L_rec_rr:
  buffer_load_dwordx4 v[20:23], v1, s[8:11], s41 offen offset:0 sc1
  buffer_load_dwordx4 v[24:27], v1, s[8:11], s41 offen offset:1024 sc1
  buffer_load_dwordx4 v[28:31], v1, s[8:11], s41 offen offset:2048 sc1
  buffer_load_dwordx4 v[32:35], v1, s[8:11], s41 offen offset:3072 sc1
  buffer_load_dwordx4 v[36:39], v1, s[8:11], s42 offen offset:0 sc1
  buffer_load_dwordx4 v[40:43], v1, s[8:11], s42 offen offset:1024 sc1
  buffer_load_dwordx4 v[44:47], v1, s[8:11], s42 offen offset:2048 sc1
  buffer_load_dwordx4 v[48:51], v1, s[8:11], s42 offen offset:3072 sc1
  s_waitcnt vmcnt(7)
  v_mfma_f32_16x16x32_bf16 v[124:127], v[20:23], v[120:123], 0
  s_waitcnt vmcnt(6)
  v_mfma_f32_16x16x32_bf16 v[124:127], v[24:27], v[120:123], v[124:127]
  v_bitop3_b32 v16, v20, v24, s33 bitop3:0x7e
  s_waitcnt vmcnt(5)
  v_mfma_f32_16x16x32_bf16 v[124:127], v[28:31], v[120:123], v[124:127]
  s_waitcnt vmcnt(4)
  v_mfma_f32_16x16x32_bf16 v[124:127], v[32:35], v[120:123], v[124:127]
  v_bitop3_b32 v17, v28, v32, s33 bitop3:0x7e
  s_waitcnt vmcnt(3)
  v_mfma_f32_16x16x32_bf16 v[124:127], v[36:39], v[120:123], v[124:127]
  s_waitcnt vmcnt(2)
  v_mfma_f32_16x16x32_bf16 v[124:127], v[40:43], v[120:123], v[124:127]
  v_bitop3_b32 v18, v36, v40, s33 bitop3:0x7e
  s_waitcnt vmcnt(1)
  v_mfma_f32_16x16x32_bf16 v[124:127], v[44:47], v[120:123], v[124:127]
  v_or3_b32 v16, v16, v17, v18
  s_waitcnt vmcnt(0)
  v_mfma_f32_16x16x32_bf16 v[124:127], v[48:51], v[120:123], v[124:127]
  v_bitop3_b32 v17, v44, v48, s33 bitop3:0x7e
  v_bitop3_b32 v16, v16, v17, 1 bitop3:0xa8
  v_cmp_ne_u32 vcc, 0, v16
  s_cbranch_vccz L_rec_red
  s_and_b32 s6, s7, 31
  s_cmp_lg_u32 s6, 31
  s_cbranch_scc1 L_tf_83
  buffer_wbl2 sc1
  s_waitcnt vmcnt(0)
  buffer_inv sc1
  s_waitcnt vmcnt(0)
L_tf_83:
  s_add_u32 s7, s7, 1
  s_cmp_lt_u32 s7, 131072
  s_cbranch_scc1 L_rec_rr
  s_mov_b32 s6, 14
  s_branch L_err
L_rec_red:
  s_nop 3
  v_cvt_pk_bf16_f32 v124, v124, v125
  v_cvt_pk_bf16_f32 v125, v126, v127
  v_bfi_b32 v124, 1, s33, v124
  s_mov_b64 exec, s[54:55]
  buffer_store_dwordx2 v[124:125], v19, s[8:11], s43 offen
  s_cmp_lg_u32 s32, 63
  s_cbranch_scc1 L_rec_nl
  buffer_store_dwordx2 v[124:125], v19, s[8:11], s43 offen sc1
L_rec_nl:
  s_mov_b64 exec, -1
  s_barrier
  s_cmp_lg_u64 s[60:61], 0
  s_cbranch_scc0 L_ke_84
  s_and_b32 s6, s32, 3
  s_lshl_b32 s6, s6, 19
  s_add_u32 s6, s6, s35
  s_sub_u32 s60, s6, s53
  s_add_u32 s61, s60, 4096
  buffer_load_dwordx4 v[52:55], v4, s[8:11], s60 offen offset:0 sc1
  buffer_load_dwordx4 v[68:71], v4, s[8:11], s60 offen offset:128 sc1
  buffer_load_dwordx4 v[56:59], v4, s[8:11], s60 offen offset:2048 sc1
  buffer_load_dwordx4 v[72:75], v4, s[8:11], s60 offen offset:2176 sc1
  buffer_load_dwordx4 v[60:63], v4, s[8:11], s61 offen offset:0 sc1
  buffer_load_dwordx4 v[76:79], v4, s[8:11], s61 offen offset:128 sc1
  buffer_load_dwordx4 v[64:67], v4, s[8:11], s61 offen offset:2048 sc1
  buffer_load_dwordx4 v[80:83], v4, s[8:11], s61 offen offset:2176 sc1
  buffer_load_dwordx4 v[108:111], v9, s[8:11], s60 offen offset:0 sc1
  buffer_load_dwordx4 v[112:115], v9, s[8:11], s60 offen offset:256 sc1
L_ke_84:
  s_branch L_rec_loop
L_rec_nored:
  s_cmp_lg_u64 s[60:61], 0
  s_cbranch_scc0 L_ke_85
  s_and_b32 s6, s32, 3
  s_lshl_b32 s6, s6, 19
  s_add_u32 s6, s6, s35
  s_sub_u32 s60, s6, s53
  s_add_u32 s61, s60, 4096
  buffer_load_dwordx4 v[52:55], v4, s[8:11], s60 offen offset:0 sc1
  buffer_load_dwordx4 v[68:71], v4, s[8:11], s60 offen offset:128 sc1
  buffer_load_dwordx4 v[56:59], v4, s[8:11], s60 offen offset:2048 sc1
  buffer_load_dwordx4 v[72:75], v4, s[8:11], s60 offen offset:2176 sc1
  buffer_load_dwordx4 v[60:63], v4, s[8:11], s61 offen offset:0 sc1
  buffer_load_dwordx4 v[76:79], v4, s[8:11], s61 offen offset:128 sc1
  buffer_load_dwordx4 v[64:67], v4, s[8:11], s61 offen offset:2048 sc1
  buffer_load_dwordx4 v[80:83], v4, s[8:11], s61 offen offset:2176 sc1
  buffer_load_dwordx4 v[108:111], v9, s[8:11], s60 offen offset:0 sc1
  buffer_load_dwordx4 v[112:115], v9, s[8:11], s60 offen offset:256 sc1
L_ke_85:
  s_barrier
  s_branch L_rec_loop
L_rec_kvwait:
  s_and_b32 s6, s32, 3
  s_lshl_b32 s6, s6, 19
  s_add_u32 s6, s6, s35
  s_sub_u32 s60, s6, s53
  s_add_u32 s61, s60, 4096
  s_mov_b32 s7, 0
  s_branch L_kvt_87
L_kvs_86:
  buffer_load_dwordx4 v[52:55], v4, s[8:11], s60 offen offset:0 sc1
  buffer_load_dwordx4 v[68:71], v4, s[8:11], s60 offen offset:128 sc1
  buffer_load_dwordx4 v[56:59], v4, s[8:11], s60 offen offset:2048 sc1
  buffer_load_dwordx4 v[72:75], v4, s[8:11], s60 offen offset:2176 sc1
  buffer_load_dwordx4 v[60:63], v4, s[8:11], s61 offen offset:0 sc1
  buffer_load_dwordx4 v[76:79], v4, s[8:11], s61 offen offset:128 sc1
  buffer_load_dwordx4 v[64:67], v4, s[8:11], s61 offen offset:2048 sc1
  buffer_load_dwordx4 v[80:83], v4, s[8:11], s61 offen offset:2176 sc1
  buffer_load_dwordx4 v[108:111], v9, s[8:11], s60 offen offset:0 sc1
  buffer_load_dwordx4 v[112:115], v9, s[8:11], s60 offen offset:256 sc1
L_kvt_87:
  s_waitcnt vmcnt(0)
  v_bitop3_b32 v16, v52, v56, s59 bitop3:0x7e
  v_bitop3_b32 v17, v60, v64, s59 bitop3:0x7e
  v_bitop3_b32 v18, v68, v72, s59 bitop3:0x7e
  v_bitop3_b32 v19, v76, v80, s59 bitop3:0x7e
  v_or3_b32 v16, v16, v17, v18
  v_bitop3_b32 v17, v108, v112, s59 bitop3:0x7e
  v_or3_b32 v16, v16, v17, v19
  v_and_b32 v16, 1, v16
  v_cmp_ne_u32 vcc, 0, v16
  s_cbranch_vccz L_rec_kvok
  s_add_u32 s7, s7, 1
  s_cmp_lt_u32 s7, 131072
  s_cbranch_scc1 L_kvs_86
  s_mov_b32 s6, 13
  s_branch L_err
L_rec_last:
  s_waitcnt vmcnt(0)
  s_endpgm
L_p:
  s_sub_u32 s35, s4, 2
  s_lshr_b32 s35, s35, 1
  s_and_b32 s6, s4, 1
  s_lshl_b32 s6, s6, 4
  s_and_b32 s36, s5, 15
  s_add_u32 s36, s36, s6
  s_lshr_b32 s37, s5, 4
  s_mul_i32 s38, s35, 0x200000
  s_add_u32 s38, s38, 0x0
  s_mul_i32 s39, s35, 0x2000000
  s_add_u32 s39, s39, 0x800000
  s_mul_i32 s40, s35, 0x1000000
  s_add_u32 s40, s40, 0x4800000
  s_mul_i32 s41, s35, 0x1000000
  s_add_u32 s41, s41, 0x6800000
  s_mul_i32 s44, s35, 0x800
  s_add_u32 s44, s44, 0x710000
  s_lshl_b32 s6, s3, 13
  s_add_u32 s38, s38, s6
  s_add_u32 s53, s6, 0
  s_lshl_b32 s6, s36, 14
  s_lshl_b32 s7, s3, 11
  s_add_u32 s39, s39, s6
  s_add_u32 s39, s39, s7
  s_lshl_b32 s6, s36, 12
  s_lshl_b32 s7, s3, 10
  s_add_u32 s40, s40, s6
  s_add_u32 s40, s40, s7
  s_lshl_b32 s6, s36, 13
  s_lshr_b32 s7, s3, 1
  s_lshl_b32 s7, s7, 12
  s_add_u32 s41, s41, s6
  s_add_u32 s41, s41, s7
  s_lshl_b32 s6, s35, 13
  s_lshl_b32 s7, s37, 12
  s_add_u32 s6, s6, s7
  s_lshl_b32 s7, s36, 7
  s_add_u32 s6, s6, s7
  s_lshl_b32 s7, s3, 2
  s_add_u32 s6, s6, s7
  s_add_u32 s43, s6, 0x718000
  s_mov_b32 s34, 0x3e0293ee
  v_mov_b32 v12, 0
  v_mov_b32 v13, 0
  v_mov_b32 v14, 0
  v_mov_b32 v15, 0
  v_lshlrev_b32 v16, 4, v0
  s_lshl_b32 s6, s37, 19
  s_add_u32 s6, s6, s39
  s_mov_b64 exec, 1
  buffer_store_dword v12, v12, s[8:11], s43 offen sc1
  s_mov_b64 exec, -1
  buffer_store_dwordx4 v[12:15], v16, s[8:11], s6 offen offset:0 sc1
  buffer_store_dwordx4 v[12:15], v16, s[8:11], s6 offen offset:1024 sc1
  s_add_u32 s6, s6, 8192
  buffer_store_dwordx4 v[12:15], v16, s[8:11], s6 offen offset:0 sc1
  buffer_store_dwordx4 v[12:15], v16, s[8:11], s6 offen offset:1024 sc1
  s_add_u32 s6, s6, 1040384
  buffer_store_dwordx4 v[12:15], v16, s[8:11], s6 offen offset:0 sc1
  buffer_store_dwordx4 v[12:15], v16, s[8:11], s6 offen offset:1024 sc1
  s_add_u32 s6, s6, 8192
  buffer_store_dwordx4 v[12:15], v16, s[8:11], s6 offen offset:0 sc1
  buffer_store_dwordx4 v[12:15], v16, s[8:11], s6 offen offset:1024 sc1
  s_cmp_ge_u32 s4, 4
  s_cbranch_scc1 L_pro
L_p2:
  v_mov_b32 v12, 0
  v_mov_b32 v13, 0
  v_lshlrev_b32 v0, 4, v0
  s_mov_b32 s16, s82
  s_mov_b32 s17, s83
  s_mov_b32 s18, 0x400000
  s_mov_b32 s19, 0x20000
  s_mov_b32 s20, s84
  s_mov_b32 s21, s85
  s_mov_b32 s22, 0x400000
  s_mov_b32 s23, 0x20000
  s_mov_b32 s24, s86
  s_mov_b32 s25, s87
  s_mov_b32 s26, 0x400000
  s_mov_b32 s27, 0x20000
  v_mov_b32 v80, 0x3f803f80
  v_mov_b32 v81, 0x3f803f80
  v_mov_b32 v82, 0x3f803f80
  v_mov_b32 v83, 0x3f803f80
  v_lshrrev_b32 v104, 4, v0
  v_lshrrev_b32 v100, 8, v0
  v_lshlrev_b32 v105, 2, v100
  v_and_b32 v104, 15, v104
  v_xor_b32 v104, v104, v105
  v_mul_u32_u24 v100, 8192, v100
  v_lshl_add_u32 v100, v104, 4, v100
  v_bfe_u32 v104, v0, 6, 2
  v_lshlrev_b32 v105, 2, v104
  v_bfe_u32 v106, v0, 8, 1
  v_lshlrev_b32 v106, 1, v106
  v_bfe_u32 v107, v0, 5, 1
  v_or_b32 v106, v106, v107
  s_lshl_b32 s6, s3, 2
  v_or_b32 v106, s6, v106
  v_xor_b32 v106, v106, v105
  v_lshlrev_b32 v106, 4, v106
  v_bfe_u32 v107, v0, 4, 1
  v_lshl_or_b32 v106, v107, 3, v106
  v_bfe_u32 v107, v0, 9, 1
  v_lshl_or_b32 v104, v107, 3, v104
  v_lshl_or_b32 v104, v104, 8, v106
  v_add_u32 v105, 0x10000, v104
  s_lshl_b32 s60, s3, 13
  s_mul_i32 s63, s3, 262144
  s_lshr_b32 s6, 0x72, s4
  s_bitcmp1_b32 s6, 0
  s_cbranch_scc1 L_rdn_88
  s_waitcnt vmcnt(0)
  s_barrier
  s_cmp_lg_u32 s3, 0
  s_cbranch_scc1 L_sd_89
  s_mov_b64 exec, 1
  s_and_b32 s6, s4, 3
  s_lshl_b32 s6, s6, 6
  v_mov_b32 v18, 16
  v_mov_b32 v19, 1
  buffer_atomic_add v19, v18, s[12:15], s6 offen sc1
  s_mov_b64 exec, -1
L_sd_89:
L_rdn_88:
  s_lshl_b32 s61, s36, 8
  s_add_u32 s61, s61, 0
  s_add_u32 s61, s61, s63
  s_add_u32 m0, s60, 0
  s_add_u32 s62, s61, 0
  buffer_load_dwordx4 v100, s[16:19], s62 offen lds
  s_add_u32 m0, s60, 1024
  s_add_u32 s62, s61, 32768
  buffer_load_dwordx4 v100, s[16:19], s62 offen lds
  s_add_u32 m0, s60, 2048
  s_add_u32 s62, s61, 65536
  buffer_load_dwordx4 v100, s[16:19], s62 offen lds
  s_add_u32 m0, s60, 3072
  s_add_u32 s62, s61, 98304
  buffer_load_dwordx4 v100, s[16:19], s62 offen lds
  s_add_u32 m0, s60, 4096
  s_add_u32 s62, s61, 131072
  buffer_load_dwordx4 v100, s[16:19], s62 offen lds
  s_add_u32 m0, s60, 5120
  s_add_u32 s62, s61, 163840
  buffer_load_dwordx4 v100, s[16:19], s62 offen lds
  s_add_u32 m0, s60, 6144
  s_add_u32 s62, s61, 196608
  buffer_load_dwordx4 v100, s[16:19], s62 offen lds
  s_add_u32 m0, s60, 7168
  s_add_u32 s62, s61, 229376
  buffer_load_dwordx4 v100, s[16:19], s62 offen lds
  s_lshl_b32 s61, s36, 8
  s_add_u32 s61, s61, 1048576
  s_add_u32 s61, s61, s63
  s_add_u32 m0, s60, 32768
  s_add_u32 s62, s61, 0
  buffer_load_dwordx4 v100, s[16:19], s62 offen lds
  s_add_u32 m0, s60, 33792
  s_add_u32 s62, s61, 32768
  buffer_load_dwordx4 v100, s[16:19], s62 offen lds
  s_add_u32 m0, s60, 34816
  s_add_u32 s62, s61, 65536
  buffer_load_dwordx4 v100, s[16:19], s62 offen lds
  s_add_u32 m0, s60, 35840
  s_add_u32 s62, s61, 98304
  buffer_load_dwordx4 v100, s[16:19], s62 offen lds
  s_add_u32 m0, s60, 36864
  s_add_u32 s62, s61, 131072
  buffer_load_dwordx4 v100, s[16:19], s62 offen lds
  s_add_u32 m0, s60, 37888
  s_add_u32 s62, s61, 163840
  buffer_load_dwordx4 v100, s[16:19], s62 offen lds
  s_add_u32 m0, s60, 38912
  s_add_u32 s62, s61, 196608
  buffer_load_dwordx4 v100, s[16:19], s62 offen lds
  s_add_u32 m0, s60, 39936
  s_add_u32 s62, s61, 229376
  buffer_load_dwordx4 v100, s[16:19], s62 offen lds
  s_lshl_b32 s61, s36, 8
  s_add_u32 s61, s61, 2097152
  s_add_u32 s61, s61, s63
  s_add_u32 m0, s60, 65536
  s_add_u32 s62, s61, 0
  buffer_load_dwordx4 v100, s[16:19], s62 offen lds
  s_add_u32 m0, s60, 66560
  s_add_u32 s62, s61, 32768
  buffer_load_dwordx4 v100, s[16:19], s62 offen lds
  s_add_u32 m0, s60, 67584
  s_add_u32 s62, s61, 65536
  buffer_load_dwordx4 v100, s[16:19], s62 offen lds
  s_add_u32 m0, s60, 68608
  s_add_u32 s62, s61, 98304
  buffer_load_dwordx4 v100, s[16:19], s62 offen lds
  s_add_u32 m0, s60, 69632
  s_add_u32 s62, s61, 131072
  buffer_load_dwordx4 v100, s[16:19], s62 offen lds
  s_add_u32 m0, s60, 70656
  s_add_u32 s62, s61, 163840
  buffer_load_dwordx4 v100, s[16:19], s62 offen lds
  s_add_u32 m0, s60, 71680
  s_add_u32 s62, s61, 196608
  buffer_load_dwordx4 v100, s[16:19], s62 offen lds
  s_add_u32 m0, s60, 72704
  s_add_u32 s62, s61, 229376
  buffer_load_dwordx4 v100, s[16:19], s62 offen lds
  s_waitcnt vmcnt(16)
  s_barrier
  s_lshl_b32 s61, s36, 8
  s_add_u32 s61, s61, 3145728
  s_add_u32 s61, s61, s63
  s_add_u32 m0, s60, 98304
  s_add_u32 s62, s61, 0
  buffer_load_dwordx4 v100, s[16:19], s62 offen lds
  s_add_u32 m0, s60, 99328
  s_add_u32 s62, s61, 32768
  buffer_load_dwordx4 v100, s[16:19], s62 offen lds
  s_add_u32 m0, s60, 100352
  s_add_u32 s62, s61, 65536
  buffer_load_dwordx4 v100, s[16:19], s62 offen lds
  s_add_u32 m0, s60, 101376
  s_add_u32 s62, s61, 98304
  buffer_load_dwordx4 v100, s[16:19], s62 offen lds
  s_add_u32 m0, s60, 102400
  s_add_u32 s62, s61, 131072
  buffer_load_dwordx4 v100, s[16:19], s62 offen lds
  s_add_u32 m0, s60, 103424
  s_add_u32 s62, s61, 163840
  buffer_load_dwordx4 v100, s[16:19], s62 offen lds
  s_add_u32 m0, s60, 104448
  s_add_u32 s62, s61, 196608
  buffer_load_dwordx4 v100, s[16:19], s62 offen lds
  s_add_u32 m0, s60, 105472
  s_add_u32 s62, s61, 229376
  buffer_load_dwordx4 v100, s[16:19], s62 offen lds
  ds_read_b64_tr_b16 a[0:1], v104 offset:0
  ds_read_b64_tr_b16 a[2:3], v104 offset:1024
  ds_read_b64_tr_b16 a[4:5], v104 offset:4096
  ds_read_b64_tr_b16 a[6:7], v104 offset:5120
  ds_read_b64_tr_b16 a[8:9], v104 offset:8192
  ds_read_b64_tr_b16 a[10:11], v104 offset:9216
  ds_read_b64_tr_b16 a[12:13], v104 offset:12288
  ds_read_b64_tr_b16 a[14:15], v104 offset:13312
  ds_read_b64_tr_b16 a[16:17], v104 offset:16384
  ds_read_b64_tr_b16 a[18:19], v104 offset:17408
  ds_read_b64_tr_b16 a[20:21], v104 offset:20480
  ds_read_b64_tr_b16 a[22:23], v104 offset:21504
  ds_read_b64_tr_b16 a[24:25], v104 offset:24576
  ds_read_b64_tr_b16 a[26:27], v104 offset:25600
  ds_read_b64_tr_b16 a[28:29], v104 offset:28672
  ds_read_b64_tr_b16 a[30:31], v104 offset:29696
  s_waitcnt lgkmcnt(0)
  v_mfma_f32_32x32x16_bf16 v[32:47], v[80:83], a[0:3], 0
  v_mfma_f32_32x32x16_bf16 v[32:47], v[80:83], a[4:7], v[32:47]
  v_mfma_f32_32x32x16_bf16 v[32:47], v[80:83], a[8:11], v[32:47]
  v_mfma_f32_32x32x16_bf16 v[32:47], v[80:83], a[12:15], v[32:47]
  v_mfma_f32_32x32x16_bf16 v[32:47], v[80:83], a[16:19], v[32:47]
  v_mfma_f32_32x32x16_bf16 v[32:47], v[80:83], a[20:23], v[32:47]
  v_mfma_f32_32x32x16_bf16 v[32:47], v[80:83], a[24:27], v[32:47]
  v_mfma_f32_32x32x16_bf16 v[32:47], v[80:83], a[28:31], v[32:47]
  s_waitcnt vmcnt(16)
  s_barrier
  s_lshl_b32 s61, s36, 8
  s_add_u32 s61, s61, 0
  s_add_u32 s61, s61, s63
  s_add_u32 m0, s60, 0
  s_add_u32 s62, s61, 0
  buffer_load_dwordx4 v100, s[20:23], s62 offen lds
  s_add_u32 m0, s60, 1024
  s_add_u32 s62, s61, 32768
  buffer_load_dwordx4 v100, s[20:23], s62 offen lds
  s_add_u32 m0, s60, 2048
  s_add_u32 s62, s61, 65536
  buffer_load_dwordx4 v100, s[20:23], s62 offen lds
  s_add_u32 m0, s60, 3072
  s_add_u32 s62, s61, 98304
  buffer_load_dwordx4 v100, s[20:23], s62 offen lds
  s_add_u32 m0, s60, 4096
  s_add_u32 s62, s61, 131072
  buffer_load_dwordx4 v100, s[20:23], s62 offen lds
  s_add_u32 m0, s60, 5120
  s_add_u32 s62, s61, 163840
  buffer_load_dwordx4 v100, s[20:23], s62 offen lds
  s_add_u32 m0, s60, 6144
  s_add_u32 s62, s61, 196608
  buffer_load_dwordx4 v100, s[20:23], s62 offen lds
  s_add_u32 m0, s60, 7168
  s_add_u32 s62, s61, 229376
  buffer_load_dwordx4 v100, s[20:23], s62 offen lds
  ds_read_b64_tr_b16 a[32:33], v104 offset:32768
  ds_read_b64_tr_b16 a[34:35], v104 offset:33792
  ds_read_b64_tr_b16 a[36:37], v104 offset:36864
  ds_read_b64_tr_b16 a[38:39], v104 offset:37888
  ds_read_b64_tr_b16 a[40:41], v104 offset:40960
  ds_read_b64_tr_b16 a[42:43], v104 offset:41984
  ds_read_b64_tr_b16 a[44:45], v104 offset:45056
  ds_read_b64_tr_b16 a[46:47], v104 offset:46080
  ds_read_b64_tr_b16 a[48:49], v104 offset:49152
  ds_read_b64_tr_b16 a[50:51], v104 offset:50176
  ds_read_b64_tr_b16 a[52:53], v104 offset:53248
  ds_read_b64_tr_b16 a[54:55], v104 offset:54272
  ds_read_b64_tr_b16 a[56:57], v104 offset:57344
  ds_read_b64_tr_b16 a[58:59], v104 offset:58368
  ds_read_b64_tr_b16 a[60:61], v104 offset:61440
  ds_read_b64_tr_b16 a[62:63], v104 offset:62464
  s_waitcnt lgkmcnt(0)
  v_mfma_f32_32x32x16_bf16 v[32:47], v[80:83], a[32:35], v[32:47]
  v_mfma_f32_32x32x16_bf16 v[32:47], v[80:83], a[36:39], v[32:47]
  v_mfma_f32_32x32x16_bf16 v[32:47], v[80:83], a[40:43], v[32:47]
  v_mfma_f32_32x32x16_bf16 v[32:47], v[80:83], a[44:47], v[32:47]
  v_mfma_f32_32x32x16_bf16 v[32:47], v[80:83], a[48:51], v[32:47]
  v_mfma_f32_32x32x16_bf16 v[32:47], v[80:83], a[52:55], v[32:47]
  v_mfma_f32_32x32x16_bf16 v[32:47], v[80:83], a[56:59], v[32:47]
  v_mfma_f32_32x32x16_bf16 v[32:47], v[80:83], a[60:63], v[32:47]
  s_waitcnt vmcnt(16)
  s_barrier
  s_lshl_b32 s61, s36, 8
  s_add_u32 s61, s61, 1048576
  s_add_u32 s61, s61, s63
  s_add_u32 m0, s60, 32768
  s_add_u32 s62, s61, 0
  buffer_load_dwordx4 v100, s[20:23], s62 offen lds
  s_add_u32 m0, s60, 33792
  s_add_u32 s62, s61, 32768
  buffer_load_dwordx4 v100, s[20:23], s62 offen lds
  s_add_u32 m0, s60, 34816
  s_add_u32 s62, s61, 65536
  buffer_load_dwordx4 v100, s[20:23], s62 offen lds
  s_add_u32 m0, s60, 35840
  s_add_u32 s62, s61, 98304
  buffer_load_dwordx4 v100, s[20:23], s62 offen lds
  s_add_u32 m0, s60, 36864
  s_add_u32 s62, s61, 131072
  buffer_load_dwordx4 v100, s[20:23], s62 offen lds
  s_add_u32 m0, s60, 37888
  s_add_u32 s62, s61, 163840
  buffer_load_dwordx4 v100, s[20:23], s62 offen lds
  s_add_u32 m0, s60, 38912
  s_add_u32 s62, s61, 196608
  buffer_load_dwordx4 v100, s[20:23], s62 offen lds
  s_add_u32 m0, s60, 39936
  s_add_u32 s62, s61, 229376
  buffer_load_dwordx4 v100, s[20:23], s62 offen lds
  ds_read_b64_tr_b16 a[64:65], v105 offset:0
  ds_read_b64_tr_b16 a[66:67], v105 offset:1024
  ds_read_b64_tr_b16 a[68:69], v105 offset:4096
  ds_read_b64_tr_b16 a[70:71], v105 offset:5120
  ds_read_b64_tr_b16 a[72:73], v105 offset:8192
  ds_read_b64_tr_b16 a[74:75], v105 offset:9216
  ds_read_b64_tr_b16 a[76:77], v105 offset:12288
  ds_read_b64_tr_b16 a[78:79], v105 offset:13312
  ds_read_b64_tr_b16 a[80:81], v105 offset:16384
  ds_read_b64_tr_b16 a[82:83], v105 offset:17408
  ds_read_b64_tr_b16 a[84:85], v105 offset:20480
  ds_read_b64_tr_b16 a[86:87], v105 offset:21504
  ds_read_b64_tr_b16 a[88:89], v105 offset:24576
  ds_read_b64_tr_b16 a[90:91], v105 offset:25600
  ds_read_b64_tr_b16 a[92:93], v105 offset:28672
  ds_read_b64_tr_b16 a[94:95], v105 offset:29696
  s_waitcnt lgkmcnt(0)
  v_mfma_f32_32x32x16_bf16 v[32:47], v[80:83], a[64:67], v[32:47]
  v_mfma_f32_32x32x16_bf16 v[32:47], v[80:83], a[68:71], v[32:47]
  v_mfma_f32_32x32x16_bf16 v[32:47], v[80:83], a[72:75], v[32:47]
  v_mfma_f32_32x32x16_bf16 v[32:47], v[80:83], a[76:79], v[32:47]
  v_mfma_f32_32x32x16_bf16 v[32:47], v[80:83], a[80:83], v[32:47]
  v_mfma_f32_32x32x16_bf16 v[32:47], v[80:83], a[84:87], v[32:47]
  v_mfma_f32_32x32x16_bf16 v[32:47], v[80:83], a[88:91], v[32:47]
  v_mfma_f32_32x32x16_bf16 v[32:47], v[80:83], a[92:95], v[32:47]
  s_waitcnt vmcnt(16)
  s_barrier
  s_lshl_b32 s61, s36, 8
  s_add_u32 s61, s61, 2097152
  s_add_u32 s61, s61, s63
  s_add_u32 m0, s60, 65536
  s_add_u32 s62, s61, 0
  buffer_load_dwordx4 v100, s[20:23], s62 offen lds
  s_add_u32 m0, s60, 66560
  s_add_u32 s62, s61, 32768
  buffer_load_dwordx4 v100, s[20:23], s62 offen lds
  s_add_u32 m0, s60, 67584
  s_add_u32 s62, s61, 65536
  buffer_load_dwordx4 v100, s[20:23], s62 offen lds
  s_add_u32 m0, s60, 68608
  s_add_u32 s62, s61, 98304
  buffer_load_dwordx4 v100, s[20:23], s62 offen lds
  s_add_u32 m0, s60, 69632
  s_add_u32 s62, s61, 131072
  buffer_load_dwordx4 v100, s[20:23], s62 offen lds
  s_add_u32 m0, s60, 70656
  s_add_u32 s62, s61, 163840
  buffer_load_dwordx4 v100, s[20:23], s62 offen lds
  s_add_u32 m0, s60, 71680
  s_add_u32 s62, s61, 196608
  buffer_load_dwordx4 v100, s[20:23], s62 offen lds
  s_add_u32 m0, s60, 72704
  s_add_u32 s62, s61, 229376
  buffer_load_dwordx4 v100, s[20:23], s62 offen lds
  ds_read_b64_tr_b16 a[96:97], v105 offset:32768
  ds_read_b64_tr_b16 a[98:99], v105 offset:33792
  ds_read_b64_tr_b16 a[100:101], v105 offset:36864
  ds_read_b64_tr_b16 a[102:103], v105 offset:37888
  ds_read_b64_tr_b16 a[104:105], v105 offset:40960
  ds_read_b64_tr_b16 a[106:107], v105 offset:41984
  ds_read_b64_tr_b16 a[108:109], v105 offset:45056
  ds_read_b64_tr_b16 a[110:111], v105 offset:46080
  ds_read_b64_tr_b16 a[112:113], v105 offset:49152
  ds_read_b64_tr_b16 a[114:115], v105 offset:50176
  ds_read_b64_tr_b16 a[116:117], v105 offset:53248
  ds_read_b64_tr_b16 a[118:119], v105 offset:54272
  ds_read_b64_tr_b16 a[120:121], v105 offset:57344
  ds_read_b64_tr_b16 a[122:123], v105 offset:58368
  ds_read_b64_tr_b16 a[124:125], v105 offset:61440
  ds_read_b64_tr_b16 a[126:127], v105 offset:62464
  s_waitcnt lgkmcnt(0)
  v_mfma_f32_32x32x16_bf16 v[32:47], v[80:83], a[96:99], v[32:47]
  v_mfma_f32_32x32x16_bf16 v[32:47], v[80:83], a[100:103], v[32:47]
  v_mfma_f32_32x32x16_bf16 v[32:47], v[80:83], a[104:107], v[32:47]
  v_mfma_f32_32x32x16_bf16 v[32:47], v[80:83], a[108:111], v[32:47]
  v_mfma_f32_32x32x16_bf16 v[32:47], v[80:83], a[112:115], v[32:47]
  v_mfma_f32_32x32x16_bf16 v[32:47], v[80:83], a[116:119], v[32:47]
  v_mfma_f32_32x32x16_bf16 v[32:47], v[80:83], a[120:123], v[32:47]
  v_mfma_f32_32x32x16_bf16 v[32:47], v[80:83], a[124:127], v[32:47]
  s_waitcnt vmcnt(16)
  s_barrier
  s_lshl_b32 s61, s36, 8
  s_add_u32 s61, s61, 3145728
  s_add_u32 s61, s61, s63
  s_add_u32 m0, s60, 98304
  s_add_u32 s62, s61, 0
  buffer_load_dwordx4 v100, s[20:23], s62 offen lds
  s_add_u32 m0, s60, 99328
  s_add_u32 s62, s61, 32768
  buffer_load_dwordx4 v100, s[20:23], s62 offen lds
  s_add_u32 m0, s60, 100352
  s_add_u32 s62, s61, 65536
  buffer_load_dwordx4 v100, s[20:23], s62 offen lds
  s_add_u32 m0, s60, 101376
  s_add_u32 s62, s61, 98304
  buffer_load_dwordx4 v100, s[20:23], s62 offen lds
  s_add_u32 m0, s60, 102400
  s_add_u32 s62, s61, 131072
  buffer_load_dwordx4 v100, s[20:23], s62 offen lds
  s_add_u32 m0, s60, 103424
  s_add_u32 s62, s61, 163840
  buffer_load_dwordx4 v100, s[20:23], s62 offen lds
  s_add_u32 m0, s60, 104448
  s_add_u32 s62, s61, 196608
  buffer_load_dwordx4 v100, s[20:23], s62 offen lds
  s_add_u32 m0, s60, 105472
  s_add_u32 s62, s61, 229376
  buffer_load_dwordx4 v100, s[20:23], s62 offen lds
  ds_read_b64_tr_b16 a[128:129], v104 offset:0
  ds_read_b64_tr_b16 a[130:131], v104 offset:1024
  ds_read_b64_tr_b16 a[132:133], v104 offset:4096
  ds_read_b64_tr_b16 a[134:135], v104 offset:5120
  ds_read_b64_tr_b16 a[136:137], v104 offset:8192
  ds_read_b64_tr_b16 a[138:139], v104 offset:9216
  ds_read_b64_tr_b16 a[140:141], v104 offset:12288
  ds_read_b64_tr_b16 a[142:143], v104 offset:13312
  ds_read_b64_tr_b16 a[144:145], v104 offset:16384
  ds_read_b64_tr_b16 a[146:147], v104 offset:17408
  ds_read_b64_tr_b16 a[148:149], v104 offset:20480
  ds_read_b64_tr_b16 a[150:151], v104 offset:21504
  ds_read_b64_tr_b16 a[152:153], v104 offset:24576
  ds_read_b64_tr_b16 a[154:155], v104 offset:25600
  ds_read_b64_tr_b16 a[156:157], v104 offset:28672
  ds_read_b64_tr_b16 a[158:159], v104 offset:29696
  s_waitcnt lgkmcnt(0)
  v_mfma_f32_32x32x16_bf16 v[48:63], v[80:83], a[128:131], 0
  v_mfma_f32_32x32x16_bf16 v[48:63], v[80:83], a[132:135], v[48:63]
  v_mfma_f32_32x32x16_bf16 v[48:63], v[80:83], a[136:139], v[48:63]
  v_mfma_f32_32x32x16_bf16 v[48:63], v[80:83], a[140:143], v[48:63]
  v_mfma_f32_32x32x16_bf16 v[48:63], v[80:83], a[144:147], v[48:63]
  v_mfma_f32_32x32x16_bf16 v[48:63], v[80:83], a[148:151], v[48:63]
  v_mfma_f32_32x32x16_bf16 v[48:63], v[80:83], a[152:155], v[48:63]
  v_mfma_f32_32x32x16_bf16 v[48:63], v[80:83], a[156:159], v[48:63]
  s_waitcnt vmcnt(16)
  s_barrier
  s_lshl_b32 s61, s36, 8
  s_add_u32 s61, s61, 0
  s_add_u32 s61, s61, s63
  s_add_u32 m0, s60, 0
  s_add_u32 s62, s61, 0
  buffer_load_dwordx4 v100, s[24:27], s62 offen lds
  s_add_u32 m0, s60, 1024
  s_add_u32 s62, s61, 32768
  buffer_load_dwordx4 v100, s[24:27], s62 offen lds
  s_add_u32 m0, s60, 2048
  s_add_u32 s62, s61, 65536
  buffer_load_dwordx4 v100, s[24:27], s62 offen lds
  s_add_u32 m0, s60, 3072
  s_add_u32 s62, s61, 98304
  buffer_load_dwordx4 v100, s[24:27], s62 offen lds
  s_add_u32 m0, s60, 4096
  s_add_u32 s62, s61, 131072
  buffer_load_dwordx4 v100, s[24:27], s62 offen lds
  s_add_u32 m0, s60, 5120
  s_add_u32 s62, s61, 163840
  buffer_load_dwordx4 v100, s[24:27], s62 offen lds
  s_add_u32 m0, s60, 6144
  s_add_u32 s62, s61, 196608
  buffer_load_dwordx4 v100, s[24:27], s62 offen lds
  s_add_u32 m0, s60, 7168
  s_add_u32 s62, s61, 229376
  buffer_load_dwordx4 v100, s[24:27], s62 offen lds
  ds_read_b64_tr_b16 a[160:161], v104 offset:32768
  ds_read_b64_tr_b16 a[162:163], v104 offset:33792
  ds_read_b64_tr_b16 a[164:165], v104 offset:36864
  ds_read_b64_tr_b16 a[166:167], v104 offset:37888
  ds_read_b64_tr_b16 a[168:169], v104 offset:40960
  ds_read_b64_tr_b16 a[170:171], v104 offset:41984
  ds_read_b64_tr_b16 a[172:173], v104 offset:45056
  ds_read_b64_tr_b16 a[174:175], v104 offset:46080
  ds_read_b64_tr_b16 a[176:177], v104 offset:49152
  ds_read_b64_tr_b16 a[178:179], v104 offset:50176
  ds_read_b64_tr_b16 a[180:181], v104 offset:53248
  ds_read_b64_tr_b16 a[182:183], v104 offset:54272
  ds_read_b64_tr_b16 a[184:185], v104 offset:57344
  ds_read_b64_tr_b16 a[186:187], v104 offset:58368
  ds_read_b64_tr_b16 a[188:189], v104 offset:61440
  ds_read_b64_tr_b16 a[190:191], v104 offset:62464
  s_waitcnt lgkmcnt(0)
  v_mfma_f32_32x32x16_bf16 v[48:63], v[80:83], a[160:163], v[48:63]
  v_mfma_f32_32x32x16_bf16 v[48:63], v[80:83], a[164:167], v[48:63]
  v_mfma_f32_32x32x16_bf16 v[48:63], v[80:83], a[168:171], v[48:63]
  v_mfma_f32_32x32x16_bf16 v[48:63], v[80:83], a[172:175], v[48:63]
  v_mfma_f32_32x32x16_bf16 v[48:63], v[80:83], a[176:179], v[48:63]
  v_mfma_f32_32x32x16_bf16 v[48:63], v[80:83], a[180:183], v[48:63]
  v_mfma_f32_32x32x16_bf16 v[48:63], v[80:83], a[184:187], v[48:63]
  v_mfma_f32_32x32x16_bf16 v[48:63], v[80:83], a[188:191], v[48:63]
  s_waitcnt vmcnt(16)
  s_barrier
  s_lshl_b32 s61, s36, 8
  s_add_u32 s61, s61, 1048576
  s_add_u32 s61, s61, s63
  s_add_u32 m0, s60, 32768
  s_add_u32 s62, s61, 0
  buffer_load_dwordx4 v100, s[24:27], s62 offen lds
  s_add_u32 m0, s60, 33792
  s_add_u32 s62, s61, 32768
  buffer_load_dwordx4 v100, s[24:27], s62 offen lds
  s_add_u32 m0, s60, 34816
  s_add_u32 s62, s61, 65536
  buffer_load_dwordx4 v100, s[24:27], s62 offen lds
  s_add_u32 m0, s60, 35840
  s_add_u32 s62, s61, 98304
  buffer_load_dwordx4 v100, s[24:27], s62 offen lds
  s_add_u32 m0, s60, 36864
  s_add_u32 s62, s61, 131072
  buffer_load_dwordx4 v100, s[24:27], s62 offen lds
  s_add_u32 m0, s60, 37888
  s_add_u32 s62, s61, 163840
  buffer_load_dwordx4 v100, s[24:27], s62 offen lds
  s_add_u32 m0, s60, 38912
  s_add_u32 s62, s61, 196608
  buffer_load_dwordx4 v100, s[24:27], s62 offen lds
  s_add_u32 m0, s60, 39936
  s_add_u32 s62, s61, 229376
  buffer_load_dwordx4 v100, s[24:27], s62 offen lds
  ds_read_b64_tr_b16 a[192:193], v105 offset:0
  ds_read_b64_tr_b16 a[194:195], v105 offset:1024
  ds_read_b64_tr_b16 a[196:197], v105 offset:4096
  ds_read_b64_tr_b16 a[198:199], v105 offset:5120
  ds_read_b64_tr_b16 a[200:201], v105 offset:8192
  ds_read_b64_tr_b16 a[202:203], v105 offset:9216
  ds_read_b64_tr_b16 a[204:205], v105 offset:12288
  ds_read_b64_tr_b16 a[206:207], v105 offset:13312
  ds_read_b64_tr_b16 a[208:209], v105 offset:16384
  ds_read_b64_tr_b16 a[210:211], v105 offset:17408
  ds_read_b64_tr_b16 a[212:213], v105 offset:20480
  ds_read_b64_tr_b16 a[214:215], v105 offset:21504
  ds_read_b64_tr_b16 a[216:217], v105 offset:24576
  ds_read_b64_tr_b16 a[218:219], v105 offset:25600
  ds_read_b64_tr_b16 a[220:221], v105 offset:28672
  ds_read_b64_tr_b16 a[222:223], v105 offset:29696
  s_waitcnt lgkmcnt(0)
  v_mfma_f32_32x32x16_bf16 v[48:63], v[80:83], a[192:195], v[48:63]
  v_mfma_f32_32x32x16_bf16 v[48:63], v[80:83], a[196:199], v[48:63]
  v_mfma_f32_32x32x16_bf16 v[48:63], v[80:83], a[200:203], v[48:63]
  v_mfma_f32_32x32x16_bf16 v[48:63], v[80:83], a[204:207], v[48:63]
  v_mfma_f32_32x32x16_bf16 v[48:63], v[80:83], a[208:211], v[48:63]
  v_mfma_f32_32x32x16_bf16 v[48:63], v[80:83], a[212:215], v[48:63]
  v_mfma_f32_32x32x16_bf16 v[48:63], v[80:83], a[216:219], v[48:63]
  v_mfma_f32_32x32x16_bf16 v[48:63], v[80:83], a[220:223], v[48:63]
  s_waitcnt vmcnt(16)
  s_barrier
  s_lshl_b32 s61, s36, 8
  s_add_u32 s61, s61, 2097152
  s_add_u32 s61, s61, s63
  s_add_u32 m0, s60, 65536
  s_add_u32 s62, s61, 0
  buffer_load_dwordx4 v100, s[24:27], s62 offen lds
  s_add_u32 m0, s60, 66560
  s_add_u32 s62, s61, 32768
  buffer_load_dwordx4 v100, s[24:27], s62 offen lds
  s_add_u32 m0, s60, 67584
  s_add_u32 s62, s61, 65536
  buffer_load_dwordx4 v100, s[24:27], s62 offen lds
  s_add_u32 m0, s60, 68608
  s_add_u32 s62, s61, 98304
  buffer_load_dwordx4 v100, s[24:27], s62 offen lds
  s_add_u32 m0, s60, 69632
  s_add_u32 s62, s61, 131072
  buffer_load_dwordx4 v100, s[24:27], s62 offen lds
  s_add_u32 m0, s60, 70656
  s_add_u32 s62, s61, 163840
  buffer_load_dwordx4 v100, s[24:27], s62 offen lds
  s_add_u32 m0, s60, 71680
  s_add_u32 s62, s61, 196608
  buffer_load_dwordx4 v100, s[24:27], s62 offen lds
  s_add_u32 m0, s60, 72704
  s_add_u32 s62, s61, 229376
  buffer_load_dwordx4 v100, s[24:27], s62 offen lds
  ds_read_b64_tr_b16 a[224:225], v105 offset:32768
  ds_read_b64_tr_b16 a[226:227], v105 offset:33792
  ds_read_b64_tr_b16 a[228:229], v105 offset:36864
  ds_read_b64_tr_b16 a[230:231], v105 offset:37888
  ds_read_b64_tr_b16 a[232:233], v105 offset:40960
  ds_read_b64_tr_b16 a[234:235], v105 offset:41984
  ds_read_b64_tr_b16 a[236:237], v105 offset:45056
  ds_read_b64_tr_b16 a[238:239], v105 offset:46080
  ds_read_b64_tr_b16 a[240:241], v105 offset:49152
  ds_read_b64_tr_b16 a[242:243], v105 offset:50176
  ds_read_b64_tr_b16 a[244:245], v105 offset:53248
  ds_read_b64_tr_b16 a[246:247], v105 offset:54272
  ds_read_b64_tr_b16 a[248:249], v105 offset:57344
  ds_read_b64_tr_b16 a[250:251], v105 offset:58368
  ds_read_b64_tr_b16 a[252:253], v105 offset:61440
  ds_read_b64_tr_b16 a[254:255], v105 offset:62464
  s_waitcnt lgkmcnt(0)
  v_mfma_f32_32x32x16_bf16 v[48:63], v[80:83], a[224:227], v[48:63]
  v_mfma_f32_32x32x16_bf16 v[48:63], v[80:83], a[228:231], v[48:63]
  v_mfma_f32_32x32x16_bf16 v[48:63], v[80:83], a[232:235], v[48:63]
  v_mfma_f32_32x32x16_bf16 v[48:63], v[80:83], a[236:239], v[48:63]
  v_mfma_f32_32x32x16_bf16 v[48:63], v[80:83], a[240:243], v[48:63]
  v_mfma_f32_32x32x16_bf16 v[48:63], v[80:83], a[244:247], v[48:63]
  v_mfma_f32_32x32x16_bf16 v[48:63], v[80:83], a[248:251], v[48:63]
  v_mfma_f32_32x32x16_bf16 v[48:63], v[80:83], a[252:255], v[48:63]
  s_waitcnt vmcnt(16)
  s_barrier
  s_lshl_b32 s61, s36, 8
  s_add_u32 s61, s61, 3145728
  s_add_u32 s61, s61, s63
  s_add_u32 m0, s60, 98304
  s_add_u32 s62, s61, 0
  buffer_load_dwordx4 v100, s[24:27], s62 offen lds
  s_add_u32 m0, s60, 99328
  s_add_u32 s62, s61, 32768
  buffer_load_dwordx4 v100, s[24:27], s62 offen lds
  s_add_u32 m0, s60, 100352
  s_add_u32 s62, s61, 65536
  buffer_load_dwordx4 v100, s[24:27], s62 offen lds
  s_add_u32 m0, s60, 101376
  s_add_u32 s62, s61, 98304
  buffer_load_dwordx4 v100, s[24:27], s62 offen lds
  s_add_u32 m0, s60, 102400
  s_add_u32 s62, s61, 131072
  buffer_load_dwordx4 v100, s[24:27], s62 offen lds
  s_add_u32 m0, s60, 103424
  s_add_u32 s62, s61, 163840
  buffer_load_dwordx4 v100, s[24:27], s62 offen lds
  s_add_u32 m0, s60, 104448
  s_add_u32 s62, s61, 196608
  buffer_load_dwordx4 v100, s[24:27], s62 offen lds
  s_add_u32 m0, s60, 105472
  s_add_u32 s62, s61, 229376
  buffer_load_dwordx4 v100, s[24:27], s62 offen lds
  ds_read_b64_tr_b16 v[128:129], v104 offset:0
  ds_read_b64_tr_b16 v[130:131], v104 offset:1024
  ds_read_b64_tr_b16 v[132:133], v104 offset:4096
  ds_read_b64_tr_b16 v[134:135], v104 offset:5120
  ds_read_b64_tr_b16 v[136:137], v104 offset:8192
  ds_read_b64_tr_b16 v[138:139], v104 offset:9216
  ds_read_b64_tr_b16 v[140:141], v104 offset:12288
  ds_read_b64_tr_b16 v[142:143], v104 offset:13312
  ds_read_b64_tr_b16 v[144:145], v104 offset:16384
  ds_read_b64_tr_b16 v[146:147], v104 offset:17408
  ds_read_b64_tr_b16 v[148:149], v104 offset:20480
  ds_read_b64_tr_b16 v[150:151], v104 offset:21504
  ds_read_b64_tr_b16 v[152:153], v104 offset:24576
  ds_read_b64_tr_b16 v[154:155], v104 offset:25600
  ds_read_b64_tr_b16 v[156:157], v104 offset:28672
  ds_read_b64_tr_b16 v[158:159], v104 offset:29696
  s_waitcnt lgkmcnt(0)
  v_mfma_f32_32x32x16_bf16 v[64:79], v[80:83], v[128:131], 0
  v_mfma_f32_32x32x16_bf16 v[64:79], v[80:83], v[132:135], v[64:79]
  v_mfma_f32_32x32x16_bf16 v[64:79], v[80:83], v[136:139], v[64:79]
  v_mfma_f32_32x32x16_bf16 v[64:79], v[80:83], v[140:143], v[64:79]
  v_mfma_f32_32x32x16_bf16 v[64:79], v[80:83], v[144:147], v[64:79]
  v_mfma_f32_32x32x16_bf16 v[64:79], v[80:83], v[148:151], v[64:79]
  v_mfma_f32_32x32x16_bf16 v[64:79], v[80:83], v[152:155], v[64:79]
  v_mfma_f32_32x32x16_bf16 v[64:79], v[80:83], v[156:159], v[64:79]
  s_waitcnt vmcnt(16)
  s_barrier
  ds_read_b64_tr_b16 v[160:161], v104 offset:32768
  ds_read_b64_tr_b16 v[162:163], v104 offset:33792
  ds_read_b64_tr_b16 v[164:165], v104 offset:36864
  ds_read_b64_tr_b16 v[166:167], v104 offset:37888
  ds_read_b64_tr_b16 v[168:169], v104 offset:40960
  ds_read_b64_tr_b16 v[170:171], v104 offset:41984
  ds_read_b64_tr_b16 v[172:173], v104 offset:45056
  ds_read_b64_tr_b16 v[174:175], v104 offset:46080
  ds_read_b64_tr_b16 v[176:177], v104 offset:49152
  ds_read_b64_tr_b16 v[178:179], v104 offset:50176
  ds_read_b64_tr_b16 v[180:181], v104 offset:53248
  ds_read_b64_tr_b16 v[182:183], v104 offset:54272
  ds_read_b64_tr_b16 v[184:185], v104 offset:57344
  ds_read_b64_tr_b16 v[186:187], v104 offset:58368
  ds_read_b64_tr_b16 v[188:189], v104 offset:61440
  ds_read_b64_tr_b16 v[190:191], v104 offset:62464
  s_waitcnt lgkmcnt(0)
  v_mfma_f32_32x32x16_bf16 v[64:79], v[80:83], v[160:163], v[64:79]
  v_mfma_f32_32x32x16_bf16 v[64:79], v[80:83], v[164:167], v[64:79]
  v_mfma_f32_32x32x16_bf16 v[64:79], v[80:83], v[168:171], v[64:79]
  v_mfma_f32_32x32x16_bf16 v[64:79], v[80:83], v[172:175], v[64:79]
  v_mfma_f32_32x32x16_bf16 v[64:79], v[80:83], v[176:179], v[64:79]
  v_mfma_f32_32x32x16_bf16 v[64:79], v[80:83], v[180:183], v[64:79]
  v_mfma_f32_32x32x16_bf16 v[64:79], v[80:83], v[184:187], v[64:79]
  v_mfma_f32_32x32x16_bf16 v[64:79], v[80:83], v[188:191], v[64:79]
  s_waitcnt vmcnt(8)
  s_barrier
  ds_read_b64_tr_b16 v[192:193], v105 offset:0
  ds_read_b64_tr_b16 v[194:195], v105 offset:1024
  ds_read_b64_tr_b16 v[196:197], v105 offset:4096
  ds_read_b64_tr_b16 v[198:199], v105 offset:5120
  ds_read_b64_tr_b16 v[200:201], v105 offset:8192
  ds_read_b64_tr_b16 v[202:203], v105 offset:9216
  ds_read_b64_tr_b16 v[204:205], v105 offset:12288
  ds_read_b64_tr_b16 v[206:207], v105 offset:13312
  ds_read_b64_tr_b16 v[208:209], v105 offset:16384
  ds_read_b64_tr_b16 v[210:211], v105 offset:17408
  ds_read_b64_tr_b16 v[212:213], v105 offset:20480
  ds_read_b64_tr_b16 v[214:215], v105 offset:21504
  ds_read_b64_tr_b16 v[216:217], v105 offset:24576
  ds_read_b64_tr_b16 v[218:219], v105 offset:25600
  ds_read_b64_tr_b16 v[220:221], v105 offset:28672
  ds_read_b64_tr_b16 v[222:223], v105 offset:29696
  s_waitcnt lgkmcnt(0)
  v_mfma_f32_32x32x16_bf16 v[64:79], v[80:83], v[192:195], v[64:79]
  v_mfma_f32_32x32x16_bf16 v[64:79], v[80:83], v[196:199], v[64:79]
  v_mfma_f32_32x32x16_bf16 v[64:79], v[80:83], v[200:203], v[64:79]
  v_mfma_f32_32x32x16_bf16 v[64:79], v[80:83], v[204:207], v[64:79]
  v_mfma_f32_32x32x16_bf16 v[64:79], v[80:83], v[208:211], v[64:79]
  v_mfma_f32_32x32x16_bf16 v[64:79], v[80:83], v[212:215], v[64:79]
  v_mfma_f32_32x32x16_bf16 v[64:79], v[80:83], v[216:219], v[64:79]
  v_mfma_f32_32x32x16_bf16 v[64:79], v[80:83], v[220:223], v[64:79]
  s_waitcnt vmcnt(0)
  s_barrier
  ds_read_b64_tr_b16 v[224:225], v105 offset:32768
  ds_read_b64_tr_b16 v[226:227], v105 offset:33792
  ds_read_b64_tr_b16 v[228:229], v105 offset:36864
  ds_read_b64_tr_b16 v[230:231], v105 offset:37888
  ds_read_b64_tr_b16 v[232:233], v105 offset:40960
  ds_read_b64_tr_b16 v[234:235], v105 offset:41984
  ds_read_b64_tr_b16 v[236:237], v105 offset:45056
  ds_read_b64_tr_b16 v[238:239], v105 offset:46080
  ds_read_b64_tr_b16 v[240:241], v105 offset:49152
  ds_read_b64_tr_b16 v[242:243], v105 offset:50176
  ds_read_b64_tr_b16 v[244:245], v105 offset:53248
  ds_read_b64_tr_b16 v[246:247], v105 offset:54272
  ds_read_b64_tr_b16 v[248:249], v105 offset:57344
  ds_read_b64_tr_b16 v[250:251], v105 offset:58368
  ds_read_b64_tr_b16 v[252:253], v105 offset:61440
  ds_read_b64_tr_b16 v[254:255], v105 offset:62464
  s_waitcnt lgkmcnt(0)
  v_mfma_f32_32x32x16_bf16 v[64:79], v[80:83], v[224:227], v[64:79]
  v_mfma_f32_32x32x16_bf16 v[64:79], v[80:83], v[228:231], v[64:79]
  v_mfma_f32_32x32x16_bf16 v[64:79], v[80:83], v[232:235], v[64:79]
  v_mfma_f32_32x32x16_bf16 v[64:79], v[80:83], v[236:239], v[64:79]
  v_mfma_f32_32x32x16_bf16 v[64:79], v[80:83], v[240:243], v[64:79]
  v_mfma_f32_32x32x16_bf16 v[64:79], v[80:83], v[244:247], v[64:79]
  v_mfma_f32_32x32x16_bf16 v[64:79], v[80:83], v[248:251], v[64:79]
  v_mfma_f32_32x32x16_bf16 v[64:79], v[80:83], v[252:255], v[64:79]
  s_barrier
  v_bfe_u32 v16, v0, 4, 4
  v_lshrrev_b32 v17, 8, v0
  v_lshrrev_b32 v114, 2, v0
  v_bfe_u32 v18, v0, 6, 2
  v_lshrrev_b32 v19, 9, v0
  v_lshl_or_b32 v18, v19, 3, v18
  v_lshlrev_b32 v18, 6, v18
  v_and_b32 v20, 1, v17
  v_lshl_or_b32 v18, v20, 5, v18
  v_and_b32 v20, 3, v16
  v_lshl_or_b32 v1, v20, 3, v18
  v_and_b32 v18, 7, v16
  v_lshrrev_b32 v20, 3, v16
  v_lshl_or_b32 v18, v20, 4, v18
  v_lshlrev_b32 v18, 4, v18
  v_lshl_add_u32 v18, v17, 9, v18
  v_add_u32 v2, 73728, v18
  s_and_b32 s6, s3, 1
  s_lshl_b32 s6, s6, 8
  v_lshlrev_b32 v18, 4, v16
  v_lshl_or_b32 v18, v17, 9, v18
  v_add_u32 v113, s6, v18
  v_add_u32 v3, 65536, v113
  s_lshr_b32 s7, s3, 1
  s_lshl_b32 s6, s7, 12
  s_add_u32 s6, s6, 81920
  v_add_u32 v4, s6, v18
  s_lshl_b32 s6, s3, 11
  s_add_u32 s6, s6, 32768
  v_add_u32 v112, s6, v0
  v_mul_u32_u24 v18, 1088, v17
  v_lshl_add_u32 v18, v16, 3, v18
  s_lshl_b32 s6, s3, 8
  s_add_u32 s6, s6, 57344
  v_add_u32 v5, s6, v18
  s_lshl_b32 s6, s7, 9
  s_add_u32 s6, s6, 57344
  v_add_u32 v7, s6, v18
  v_and_b32 v18, 3, v16
  v_mul_u32_u24 v18, 1088, v18
  v_bfe_u32 v20, v0, 6, 3
  v_lshl_add_u32 v18, v20, 3, v18
  v_lshl_add_u32 v18, v19, 7, v18
  v_add_u32 v6, 57344, v18
  s_lshl_b32 s6, s3, 7
  s_add_u32 s6, s6, 61952
  v_lshlrev_b32 v18, 4, v19
  v_add_u32 v8, s6, v18
  v_and_b32 v18, 0x7c, v114
  v_add_u32 v9, s6, v18
  v_lshlrev_b32 v18, 1, v18
  v_add_u32 v15, 62464, v18
  s_lshl_b32 s6, s3, 13
  v_add_u32 v14, s6, v1
  v_mov_b32 v10, 0x3f803f80
  v_mov_b32 v11, 0x3f803f80
  s_and_b32 s6, s3, 1
  s_lshl_b32 s6, s6, 4
  v_add_u32 v16, s6, v16
  v_lshlrev_b32 v18, 4, v19
  v_and_b32 v20, 1, v17
  v_lshl_or_b32 v18, v20, 2, v18
  v_sub_u32 v16, v16, v18
  v_mov_b32 v17, 0xf149f2ca
  v_cmp_gt_i32 vcc, 0, v16
  s_nop 1
  v_cndmask_b32 v24, 0, v17, vcc
  v_cmp_gt_i32 vcc, 1, v16
  s_nop 1
  v_cndmask_b32 v25, 0, v17, vcc
  v_cmp_gt_i32 vcc, 2, v16
  s_nop 1
  v_cndmask_b32 v26, 0, v17, vcc
  v_cmp_gt_i32 vcc, 3, v16
  s_nop 1
  v_cndmask_b32 v27, 0, v17, vcc
  v_cmp_gt_i32 vcc, 8, v16
  s_nop 1
  v_cndmask_b32 v28, 0, v17, vcc
  v_cmp_gt_i32 vcc, 9, v16
  s_nop 1
  v_cndmask_b32 v29, 0, v17, vcc
  v_cmp_gt_i32 vcc, 10, v16
  s_nop 1
  v_cndmask_b32 v30, 0, v17, vcc
  v_cmp_gt_i32 vcc, 11, v16
  s_nop 1
  v_cndmask_b32 v31, 0, v17, vcc
  v_cmp_gt_u32 vcc, 512, v0
  v_cvt_pk_bf16_f32 v33, v32, v32
  v_and_b32 v33, 0xffff0000, v33
  v_sub_f32 v32, v32, v33
  v_cvt_pk_bf16_f32 v32, v32, v33
  v_cndmask_b32 v16, 0, v32, vcc
  v_cvt_pk_bf16_f32 v49, v48, v48
  v_and_b32 v49, 0xffff0000, v49
  v_sub_f32 v48, v48, v49
  v_cvt_pk_bf16_f32 v48, v48, v49
  v_cndmask_b32 v17, 0, v48, vcc
  v_cvt_pk_bf16_f32 v65, v64, v64
  v_and_b32 v65, 0xffff0000, v65
  v_sub_f32 v64, v64, v65
  v_cvt_pk_bf16_f32 v64, v64, v65
  v_cndmask_b32 v18, 0, v64, vcc
  v_mov_b32 v19, 0
  v_mov_b32 v21, 0
  v_mov_b32 v22, 0
  s_mov_b32 s7, 0
  v_mbcnt_lo_u32_b32 v92, -1, 0
  v_and_b32 v92, 3, v92
  v_lshlrev_b32 v92, 6, v92
L_wd_90:
  buffer_load_dword v93, v92, s[12:15], 0 offen offset:16 sc1
  s_waitcnt vmcnt(0)
  v_cmp_ne_u32 vcc, 64, v93
  s_cbranch_vccz L_wdo_91
  s_add_u32 s7, s7, 1
  s_cmp_lt_u32 s7, 131072
  s_cbranch_scc1 L_wd_90
  s_mov_b32 s6, 20
  s_branch L_err
L_wdo_91:
  s_mov_b32 s32, 0
  s_mov_b32 s52, 0
  s_mov_b32 s33, s37
  s_add_u32 s49, s33, 1
  s_cmp_lg_u32 s35, 0
  s_cbranch_scc1 L_p1_92
  s_mov_b32 s7, 0
L_pl_93:
  buffer_load_dwordx4 v[32:35], v0, s[8:11], s44 offen offset:0 sc1
  buffer_load_dwordx4 v[36:39], v0, s[8:11], s44 offen offset:1024 sc1
  s_waitcnt vmcnt(0)
  v_min3_u32 v32, v32, v33, v34
  v_min3_u32 v35, v35, v36, v37
  v_min3_u32 v32, v32, v38, v39
  v_min_u32 v32, v32, v35
  v_cmp_gt_u32 vcc, s49, v32
  s_cbranch_vccz L_plo_94
  s_add_u32 s7, s7, 1
  s_cmp_lt_u32 s7, 131072
  s_cbranch_scc1 L_pl_93
  s_mov_b32 s6, 21
  s_branch L_err
L_plo_94:
L_p1_92:
L_p_xwait:
  s_mov_b32 s7, 0
L_pl_95:
  buffer_load_dword v92, v114, s[8:11], s44 offen offset:0 sc1
  s_waitcnt vmcnt(0)
  v_cmp_gt_u32 vcc, s49, v92
  s_cbranch_vccz L_plo_96
  s_add_u32 s7, s7, 1
  s_cmp_lt_u32 s7, 131072
  s_cbranch_scc1 L_pl_95
  s_mov_b32 s6, 22
  s_branch L_err
L_plo_96:
  s_sub_u32 s6, s49, 1
  s_lshl_b32 s6, s6, 15
  s_add_u32 s45, s38, s6
  s_mov_b32 m0, s53
  s_add_u32 s6, s45, 4096
  buffer_load_dwordx4 v0, s[8:11], s45 offen offset:0 lds
  buffer_load_dwordx4 v0, s[8:11], s45 offen offset:1024 lds
  buffer_load_dwordx4 v0, s[8:11], s45 offen offset:2048 lds
  buffer_load_dwordx4 v0, s[8:11], s45 offen offset:3072 lds
  s_add_u32 m0, s53, 4096
  s_nop 0
  buffer_load_dwordx4 v0, s[8:11], s6 offen offset:0 lds
  buffer_load_dwordx4 v0, s[8:11], s6 offen offset:1024 lds
  buffer_load_dwordx4 v0, s[8:11], s6 offen offset:2048 lds
  buffer_load_dwordx4 v0, s[8:11], s6 offen offset:3072 lds
  s_waitcnt vmcnt(0)
L_p_loop:
  s_barrier
  s_and_b32 s6, s33, 3
  s_lshl_b32 s6, s6, 19
  s_add_u32 s46, s39, s6
  s_lshr_b32 s6, s33, 2
  s_andn2_b32 s42, 1, s6
  s_add_u32 s49, s33, 3
  s_lshl_b32 s7, s3, 8
  ds_read_b64_tr_b16 v[80:81], v1 offset:0
  ds_read_b64_tr_b16 v[82:83], v1 offset:256
  ds_read_b64_tr_b16 v[84:85], v1 offset:1024
  ds_read_b64_tr_b16 v[86:87], v1 offset:1280
  ds_read_b64_tr_b16 v[96:97], v14 offset:0
  ds_read_b64_tr_b16 v[98:99], v14 offset:256
  v_mov_b32 v92, 0
  v_mov_b32 v93, 0
  v_add_u32 v108, s7, v15
  s_waitcnt lgkmcnt(4)
  v_mfma_f32_32x32x16_bf16 v[48:63], a[128:131], v[80:83], 0
  ds_read_b64_tr_b16 v[88:89], v1 offset:2048
  ds_read_b64_tr_b16 v[90:91], v1 offset:2304
  s_waitcnt lgkmcnt(2)
  ds_read_b64_tr_b16 v[100:101], v14 offset:1024
  ds_read_b64_tr_b16 v[102:103], v14 offset:1280
  v_lshlrev_b32 v104, 16, v96
  v_and_b32 v105, 0xffff0000, v96
  v_add_f32 v92, v92, v104
  v_mfma_f32_32x32x16_bf16 v[64:79], v[80:83], v[128:131], 0
  v_fmac_f32 v93, v104, v104
  v_add_f32 v92, v92, v105
  v_fmac_f32 v93, v105, v105
  v_lshlrev_b32 v106, 16, v97
  v_and_b32 v107, 0xffff0000, v97
  v_mfma_f32_32x32x16_bf16 v[48:63], a[132:135], v[84:87], v[48:63]
  ds_read_b64_tr_b16 v[80:81], v1 offset:3072
  ds_read_b64_tr_b16 v[82:83], v1 offset:3328
  v_add_f32 v92, v92, v106
  v_fmac_f32 v93, v106, v106
  v_add_f32 v92, v92, v107
  v_fmac_f32 v93, v107, v107
  v_mfma_f32_32x32x16_bf16 v[64:79], v[84:87], v[132:135], v[64:79]
  v_lshlrev_b32 v104, 16, v98
  v_and_b32 v105, 0xffff0000, v98
  v_add_f32 v92, v92, v104
  v_fmac_f32 v93, v104, v104
  s_waitcnt lgkmcnt(4)
  v_mfma_f32_32x32x16_bf16 v[48:63], a[136:139], v[88:91], v[48:63]
  ds_read_b64_tr_b16 v[84:85], v1 offset:4096
  ds_read_b64_tr_b16 v[86:87], v1 offset:4352
  v_add_f32 v92, v92, v105
  v_fmac_f32 v93, v105, v105
  v_lshlrev_b32 v106, 16, v99
  v_and_b32 v107, 0xffff0000, v99
  v_mfma_f32_32x32x16_bf16 v[64:79], v[88:91], v[136:139], v[64:79]
  v_add_f32 v92, v92, v106
  v_fmac_f32 v93, v106, v106
  v_add_f32 v92, v92, v107
  v_fmac_f32 v93, v107, v107
  s_waitcnt lgkmcnt(2)
  v_mfma_f32_32x32x16_bf16 v[48:63], a[140:143], v[80:83], v[48:63]
  ds_read_b64_tr_b16 v[88:89], v1 offset:5120
  ds_read_b64_tr_b16 v[90:91], v1 offset:5376
  ds_read_b64_tr_b16 v[96:97], v14 offset:2048
  ds_read_b64_tr_b16 v[98:99], v14 offset:2304
  v_lshlrev_b32 v104, 16, v100
  v_and_b32 v105, 0xffff0000, v100
  v_add_f32 v92, v92, v104
  v_mfma_f32_32x32x16_bf16 v[64:79], v[80:83], v[140:143], v[64:79]
  v_fmac_f32 v93, v104, v104
  v_add_f32 v92, v92, v105
  v_fmac_f32 v93, v105, v105
  v_lshlrev_b32 v106, 16, v101
  v_and_b32 v107, 0xffff0000, v101
  s_waitcnt lgkmcnt(4)
  v_mfma_f32_32x32x16_bf16 v[48:63], a[144:147], v[84:87], v[48:63]
  ds_read_b64_tr_b16 v[80:81], v1 offset:6144
  ds_read_b64_tr_b16 v[82:83], v1 offset:6400
  v_add_f32 v92, v92, v106
  v_fmac_f32 v93, v106, v106
  v_add_f32 v92, v92, v107
  v_fmac_f32 v93, v107, v107
  v_mfma_f32_32x32x16_bf16 v[64:79], v[84:87], v[144:147], v[64:79]
  v_lshlrev_b32 v104, 16, v102
  v_and_b32 v105, 0xffff0000, v102
  v_add_f32 v92, v92, v104
  v_fmac_f32 v93, v104, v104
  s_cmp_eq_u32 s52, 2
  s_cbranch_scc0 L_p_nof
  s_waitcnt vmcnt(0)
  s_mov_b64 exec, 1
  buffer_store_dword v126, v13, s[8:11], s43 offen sc1
  s_mov_b64 exec, -1
L_p_nof:
  s_waitcnt lgkmcnt(4)
  v_mfma_f32_32x32x16_bf16 v[48:63], a[148:151], v[88:91], v[48:63]
  ds_read_b64_tr_b16 v[84:85], v1 offset:7168
  ds_read_b64_tr_b16 v[86:87], v1 offset:7424
  v_add_f32 v92, v92, v105
  v_fmac_f32 v93, v105, v105
  v_lshlrev_b32 v106, 16, v103
  v_and_b32 v107, 0xffff0000, v103
  v_mfma_f32_32x32x16_bf16 v[64:79], v[88:91], v[148:151], v[64:79]
  v_add_f32 v92, v92, v106
  v_fmac_f32 v93, v106, v106
  v_add_f32 v92, v92, v107
  v_fmac_f32 v93, v107, v107
  s_waitcnt lgkmcnt(2)
  v_mfma_f32_32x32x16_bf16 v[48:63], a[152:155], v[80:83], v[48:63]
  ds_read_b64_tr_b16 v[88:89], v1 offset:8192
  ds_read_b64_tr_b16 v[90:91], v1 offset:8448
  ds_read_b64_tr_b16 v[100:101], v14 offset:3072
  ds_read_b64_tr_b16 v[102:103], v14 offset:3328
  v_lshlrev_b32 v104, 16, v96
  v_and_b32 v105, 0xffff0000, v96
  v_add_f32 v92, v92, v104
  v_mfma_f32_32x32x16_bf16 v[64:79], v[80:83], v[152:155], v[64:79]
  v_fmac_f32 v93, v104, v104
  v_add_f32 v92, v92, v105
  v_fmac_f32 v93, v105, v105
  v_lshlrev_b32 v106, 16, v97
  v_and_b32 v107, 0xffff0000, v97
  s_waitcnt lgkmcnt(4)
  v_mfma_f32_32x32x16_bf16 v[48:63], a[156:159], v[84:87], v[48:63]
  ds_read_b64_tr_b16 v[80:81], v1 offset:9216
  ds_read_b64_tr_b16 v[82:83], v1 offset:9472
  v_add_f32 v92, v92, v106
  v_fmac_f32 v93, v106, v106
  v_add_f32 v92, v92, v107
  v_fmac_f32 v93, v107, v107
  v_mfma_f32_32x32x16_bf16 v[64:79], v[84:87], v[156:159], v[64:79]
  v_lshlrev_b32 v104, 16, v98
  v_and_b32 v105, 0xffff0000, v98
  v_add_f32 v92, v92, v104
  v_fmac_f32 v93, v104, v104
  s_waitcnt lgkmcnt(4)
  v_mfma_f32_32x32x16_bf16 v[48:63], a[160:163], v[88:91], v[48:63]
  ds_read_b64_tr_b16 v[84:85], v1 offset:10240
  ds_read_b64_tr_b16 v[86:87], v1 offset:10496
  v_add_f32 v92, v92, v105
  v_fmac_f32 v93, v105, v105
  v_lshlrev_b32 v106, 16, v99
  v_and_b32 v107, 0xffff0000, v99
  v_mfma_f32_32x32x16_bf16 v[64:79], v[88:91], v[160:163], v[64:79]
  v_add_f32 v92, v92, v106
  v_fmac_f32 v93, v106, v106
  v_add_f32 v92, v92, v107
  v_fmac_f32 v93, v107, v107
  s_waitcnt lgkmcnt(2)
  v_mfma_f32_32x32x16_bf16 v[48:63], a[164:167], v[80:83], v[48:63]
  ds_read_b64_tr_b16 v[88:89], v1 offset:11264
  ds_read_b64_tr_b16 v[90:91], v1 offset:11520
  ds_read_b64_tr_b16 v[96:97], v14 offset:4096
  ds_read_b64_tr_b16 v[98:99], v14 offset:4352
  v_lshlrev_b32 v104, 16, v100
  v_and_b32 v105, 0xffff0000, v100
  v_add_f32 v92, v92, v104
  v_mfma_f32_32x32x16_bf16 v[64:79], v[80:83], v[164:167], v[64:79]
  v_fmac_f32 v93, v104, v104
  v_add_f32 v92, v92, v105
  v_fmac_f32 v93, v105, v105
  v_lshlrev_b32 v106, 16, v101
  v_and_b32 v107, 0xffff0000, v101
  s_waitcnt lgkmcnt(4)
  v_mfma_f32_32x32x16_bf16 v[48:63], a[168:171], v[84:87], v[48:63]
  ds_read_b64_tr_b16 v[80:81], v1 offset:12288
  ds_read_b64_tr_b16 v[82:83], v1 offset:12544
  v_add_f32 v92, v92, v106
  v_fmac_f32 v93, v106, v106
  v_add_f32 v92, v92, v107
  v_fmac_f32 v93, v107, v107
  v_mfma_f32_32x32x16_bf16 v[64:79], v[84:87], v[168:171], v[64:79]
  v_lshlrev_b32 v104, 16, v102
  v_and_b32 v105, 0xffff0000, v102
  v_add_f32 v92, v92, v104
  v_fmac_f32 v93, v104, v104
  s_waitcnt lgkmcnt(4)
  v_mfma_f32_32x32x16_bf16 v[48:63], a[172:175], v[88:91], v[48:63]
  ds_read_b64_tr_b16 v[84:85], v1 offset:13312
  ds_read_b64_tr_b16 v[86:87], v1 offset:13568
  v_add_f32 v92, v92, v105
  v_fmac_f32 v93, v105, v105
  v_lshlrev_b32 v106, 16, v103
  v_and_b32 v107, 0xffff0000, v103
  v_mfma_f32_32x32x16_bf16 v[64:79], v[88:91], v[172:175], v[64:79]
  v_add_f32 v92, v92, v106
  v_fmac_f32 v93, v106, v106
  v_add_f32 v92, v92, v107
  v_fmac_f32 v93, v107, v107
  s_waitcnt lgkmcnt(2)
  v_mfma_f32_32x32x16_bf16 v[48:63], a[176:179], v[80:83], v[48:63]
  ds_read_b64_tr_b16 v[88:89], v1 offset:14336
  ds_read_b64_tr_b16 v[90:91], v1 offset:14592
  ds_read_b64_tr_b16 v[100:101], v14 offset:5120
  ds_read_b64_tr_b16 v[102:103], v14 offset:5376
  v_lshlrev_b32 v104, 16, v96
  v_and_b32 v105, 0xffff0000, v96
  v_add_f32 v92, v92, v104
  v_mfma_f32_32x32x16_bf16 v[64:79], v[80:83], v[176:179], v[64:79]
  v_fmac_f32 v93, v104, v104
  v_add_f32 v92, v92, v105
  v_fmac_f32 v93, v105, v105
  v_lshlrev_b32 v106, 16, v97
  v_and_b32 v107, 0xffff0000, v97
  s_waitcnt lgkmcnt(4)
  v_mfma_f32_32x32x16_bf16 v[48:63], a[180:183], v[84:87], v[48:63]
  ds_read_b64_tr_b16 v[80:81], v1 offset:15360
  ds_read_b64_tr_b16 v[82:83], v1 offset:15616
  v_add_f32 v92, v92, v106
  v_fmac_f32 v93, v106, v106
  v_add_f32 v92, v92, v107
  v_fmac_f32 v93, v107, v107
  v_mfma_f32_32x32x16_bf16 v[64:79], v[84:87], v[180:183], v[64:79]
  v_lshlrev_b32 v104, 16, v98
  v_and_b32 v105, 0xffff0000, v98
  v_add_f32 v92, v92, v104
  v_fmac_f32 v93, v104, v104
  s_waitcnt lgkmcnt(4)
  v_mfma_f32_32x32x16_bf16 v[48:63], a[184:187], v[88:91], v[48:63]
  ds_read_b64_tr_b16 v[84:85], v1 offset:16384
  ds_read_b64_tr_b16 v[86:87], v1 offset:16640
  v_add_f32 v92, v92, v105
  v_fmac_f32 v93, v105, v105
  v_lshlrev_b32 v106, 16, v99
  v_and_b32 v107, 0xffff0000, v99
  v_mfma_f32_32x32x16_bf16 v[64:79], v[88:91], v[184:187], v[64:79]
  v_add_f32 v92, v92, v106
  v_fmac_f32 v93, v106, v106
  v_add_f32 v92, v92, v107
  v_fmac_f32 v93, v107, v107
  s_waitcnt lgkmcnt(2)
  v_mfma_f32_32x32x16_bf16 v[48:63], a[188:191], v[80:83], v[48:63]
  ds_read_b64_tr_b16 v[88:89], v1 offset:17408
  ds_read_b64_tr_b16 v[90:91], v1 offset:17664
  ds_read_b64_tr_b16 v[96:97], v14 offset:6144
  ds_read_b64_tr_b16 v[98:99], v14 offset:6400
  v_lshlrev_b32 v104, 16, v100
  v_and_b32 v105, 0xffff0000, v100
  v_add_f32 v92, v92, v104
  v_mfma_f32_32x32x16_bf16 v[64:79], v[80:83], v[188:191], v[64:79]
  v_fmac_f32 v93, v104, v104
  v_add_f32 v92, v92, v105
  v_fmac_f32 v93, v105, v105
  v_lshlrev_b32 v106, 16, v101
  v_and_b32 v107, 0xffff0000, v101
  s_waitcnt lgkmcnt(4)
  v_mfma_f32_32x32x16_bf16 v[48:63], a[192:195], v[84:87], v[48:63]
  ds_read_b64_tr_b16 v[80:81], v1 offset:18432
  ds_read_b64_tr_b16 v[82:83], v1 offset:18688
  v_add_f32 v92, v92, v106
  v_fmac_f32 v93, v106, v106
  v_add_f32 v92, v92, v107
  v_fmac_f32 v93, v107, v107
  v_mfma_f32_32x32x16_bf16 v[64:79], v[84:87], v[192:195], v[64:79]
  v_lshlrev_b32 v104, 16, v102
  v_and_b32 v105, 0xffff0000, v102
  v_add_f32 v92, v92, v104
  v_fmac_f32 v93, v104, v104
  s_waitcnt lgkmcnt(4)
  v_mfma_f32_32x32x16_bf16 v[48:63], a[196:199], v[88:91], v[48:63]
  ds_read_b64_tr_b16 v[84:85], v1 offset:19456
  ds_read_b64_tr_b16 v[86:87], v1 offset:19712
  v_add_f32 v92, v92, v105
  v_fmac_f32 v93, v105, v105
  v_lshlrev_b32 v106, 16, v103
  v_and_b32 v107, 0xffff0000, v103
  v_mfma_f32_32x32x16_bf16 v[64:79], v[88:91], v[196:199], v[64:79]
  v_add_f32 v92, v92, v106
  v_fmac_f32 v93, v106, v106
  v_add_f32 v92, v92, v107
  v_fmac_f32 v93, v107, v107
  s_waitcnt lgkmcnt(2)
  v_mfma_f32_32x32x16_bf16 v[48:63], a[200:203], v[80:83], v[48:63]
  ds_read_b64_tr_b16 v[88:89], v1 offset:20480
  ds_read_b64_tr_b16 v[90:91], v1 offset:20736
  ds_read_b64_tr_b16 v[100:101], v14 offset:7168
  ds_read_b64_tr_b16 v[102:103], v14 offset:7424
  v_lshlrev_b32 v104, 16, v96
  v_and_b32 v105, 0xffff0000, v96
  v_add_f32 v92, v92, v104
  v_mfma_f32_32x32x16_bf16 v[64:79], v[80:83], v[200:203], v[64:79]
  v_fmac_f32 v93, v104, v104
  v_add_f32 v92, v92, v105
  v_fmac_f32 v93, v105, v105
  v_lshlrev_b32 v106, 16, v97
  v_and_b32 v107, 0xffff0000, v97
  s_waitcnt lgkmcnt(4)
  v_mfma_f32_32x32x16_bf16 v[48:63], a[204:207], v[84:87], v[48:63]
  ds_read_b64_tr_b16 v[80:81], v1 offset:21504
  ds_read_b64_tr_b16 v[82:83], v1 offset:21760
  v_add_f32 v92, v92, v106
  v_fmac_f32 v93, v106, v106
  v_add_f32 v92, v92, v107
  v_fmac_f32 v93, v107, v107
  v_mfma_f32_32x32x16_bf16 v[64:79], v[84:87], v[204:207], v[64:79]
  v_lshlrev_b32 v104, 16, v98
  v_and_b32 v105, 0xffff0000, v98
  v_add_f32 v92, v92, v104
  v_fmac_f32 v93, v104, v104
  s_waitcnt lgkmcnt(4)
  v_mfma_f32_32x32x16_bf16 v[48:63], a[208:211], v[88:91], v[48:63]
  ds_read_b64_tr_b16 v[84:85], v1 offset:22528
  ds_read_b64_tr_b16 v[86:87], v1 offset:22784
  v_add_f32 v92, v92, v105
  v_fmac_f32 v93, v105, v105
  v_lshlrev_b32 v106, 16, v99
  v_and_b32 v107, 0xffff0000, v99
  v_mfma_f32_32x32x16_bf16 v[64:79], v[88:91], v[208:211], v[64:79]
  v_add_f32 v92, v92, v106
  v_fmac_f32 v93, v106, v106
  v_add_f32 v92, v92, v107
  v_fmac_f32 v93, v107, v107
  s_waitcnt lgkmcnt(2)
  v_mfma_f32_32x32x16_bf16 v[48:63], a[212:215], v[80:83], v[48:63]
  ds_read_b64_tr_b16 v[88:89], v1 offset:23552
  ds_read_b64_tr_b16 v[90:91], v1 offset:23808
  v_lshlrev_b32 v104, 16, v100
  v_and_b32 v105, 0xffff0000, v100
  v_add_f32 v92, v92, v104
  v_fmac_f32 v93, v104, v104
  v_mfma_f32_32x32x16_bf16 v[64:79], v[80:83], v[212:215], v[64:79]
  v_add_f32 v92, v92, v105
  v_fmac_f32 v93, v105, v105
  v_lshlrev_b32 v106, 16, v101
  v_and_b32 v107, 0xffff0000, v101
  s_waitcnt lgkmcnt(2)
  v_mfma_f32_32x32x16_bf16 v[48:63], a[216:219], v[84:87], v[48:63]
  ds_read_b64_tr_b16 v[80:81], v1 offset:24576
  ds_read_b64_tr_b16 v[82:83], v1 offset:24832
  v_add_f32 v92, v92, v106
  v_fmac_f32 v93, v106, v106
  v_add_f32 v92, v92, v107
  v_fmac_f32 v93, v107, v107
  v_mfma_f32_32x32x16_bf16 v[64:79], v[84:87], v[216:219], v[64:79]
  v_lshlrev_b32 v104, 16, v102
  v_and_b32 v105, 0xffff0000, v102
  v_add_f32 v92, v92, v104
  v_fmac_f32 v93, v104, v104
  s_waitcnt lgkmcnt(2)
  v_mfma_f32_32x32x16_bf16 v[48:63], a[220:223], v[88:91], v[48:63]
  ds_read_b64_tr_b16 v[84:85], v1 offset:25600
  ds_read_b64_tr_b16 v[86:87], v1 offset:25856
  v_add_f32 v92, v92, v105
  v_fmac_f32 v93, v105, v105
  v_lshlrev_b32 v106, 16, v103
  v_and_b32 v107, 0xffff0000, v103
  v_mfma_f32_32x32x16_bf16 v[64:79], v[88:91], v[220:223], v[64:79]
  v_add_f32 v92, v92, v106
  v_fmac_f32 v93, v106, v106
  v_add_f32 v92, v92, v107
  v_fmac_f32 v93, v107, v107
  s_waitcnt lgkmcnt(2)
  v_mfma_f32_32x32x16_bf16 v[48:63], a[224:227], v[80:83], v[48:63]
  ds_read_b64_tr_b16 v[88:89], v1 offset:26624
  ds_read_b64_tr_b16 v[90:91], v1 offset:26880
  v_mov_b32 v94, v92
  v_mov_b32 v95, v93
  s_nop 0
  v_permlane32_swap_b32 v92, v94
  v_permlane32_swap_b32 v93, v95
  v_mfma_f32_32x32x16_bf16 v[64:79], v[80:83], v[224:227], v[64:79]
  v_add_f32 v92, v92, v94
  v_add_f32 v93, v93, v95
  ds_write_b64 v108, v[92:93]
  s_waitcnt lgkmcnt(3)
  v_mfma_f32_32x32x16_bf16 v[48:63], a[228:231], v[84:87], v[48:63]
  ds_read_b64_tr_b16 v[80:81], v1 offset:27648
  ds_read_b64_tr_b16 v[82:83], v1 offset:27904
  s_waitcnt lgkmcnt(2)
  s_barrier
  ds_read_b64 v[96:97], v15 offset:0
  v_mfma_f32_32x32x16_bf16 v[64:79], v[84:87], v[228:231], v[64:79]
  ds_read_b64 v[98:99], v15 offset:256
  ds_read_b64 v[100:101], v15 offset:512
  ds_read_b64 v[102:103], v15 offset:768
  v_mfma_f32_32x32x16_bf16 v[48:63], a[232:235], v[88:91], v[48:63]
  ds_read_b64_tr_b16 v[84:85], v1 offset:28672
  ds_read_b64_tr_b16 v[86:87], v1 offset:28928
  v_mfma_f32_32x32x16_bf16 v[64:79], v[88:91], v[232:235], v[64:79]
  s_waitcnt lgkmcnt(6)
  v_mfma_f32_32x32x16_bf16 v[48:63], a[236:239], v[80:83], v[48:63]
  ds_read_b64_tr_b16 v[88:89], v1 offset:29696
  ds_read_b64_tr_b16 v[90:91], v1 offset:29952
  s_waitcnt lgkmcnt(4)
  v_add_f32 v92, v96, v98
  v_add_f32 v93, v97, v99
  v_add_f32 v94, v100, v102
  v_mfma_f32_32x32x16_bf16 v[64:79], v[80:83], v[236:239], v[64:79]
  v_add_f32 v95, v101, v103
  v_add_f32 v92, v92, v94
  v_add_f32 v93, v93, v95
  v_mul_f32 v92, 0x3b000000, v92
  s_waitcnt lgkmcnt(2)
  v_mfma_f32_32x32x16_bf16 v[48:63], a[240:243], v[84:87], v[48:63]
  ds_read_b64_tr_b16 v[80:81], v1 offset:30720
  ds_read_b64_tr_b16 v[82:83], v1 offset:30976
  v_mul_f32 v94, v92, v92
  v_mul_f32 v93, 0x3b000000, v93
  v_sub_f32 v93, v93, v94
  v_max_f32 v93, 0, v93
  v_mfma_f32_32x32x16_bf16 v[64:79], v[84:87], v[240:243], v[64:79]
  v_cvt_pk_bf16_f32 v93, v93, v93
  v_and_b32 v93, 0xffff0000, v93
  v_add_f32 v93, 0x3727c5ac, v93
  v_cvt_pk_bf16_f32 v93, v93, v93
  s_waitcnt lgkmcnt(2)
  v_mfma_f32_32x32x16_bf16 v[48:63], a[244:247], v[88:91], v[48:63]
  ds_read_b64_tr_b16 v[84:85], v1 offset:31744
  ds_read_b64_tr_b16 v[86:87], v1 offset:32000
  v_and_b32 v93, 0xffff0000, v93
  v_sqrt_f32 v93, v93
  v_cvt_pk_bf16_f32 v92, v92, v92
  v_and_b32 v92, 0xffff0000, v92
  v_mfma_f32_32x32x16_bf16 v[64:79], v[88:91], v[244:247], v[64:79]
  v_cvt_pk_bf16_f32 v93, v93, v93
  v_and_b32 v93, 0xffff0000, v93
  v_rcp_f32 v93, v93
  v_xor_b32 v92, 0x80000000, v92
  s_waitcnt lgkmcnt(2)
  v_mfma_f32_32x32x16_bf16 v[48:63], a[248:251], v[80:83], v[48:63]
  ds_read_b64_tr_b16 v[88:89], v1 offset:0
  ds_read_b64_tr_b16 v[90:91], v1 offset:256
  v_lshrrev_b32 v94, 16, v92
  v_or_b32 v20, v92, v94
  v_or_b32 v23, v92, v94
  v_mfma_f32_32x32x16_bf16 v[64:79], v[80:83], v[248:251], v[64:79]
  v_mov_b32 v92, v93
  ds_write_b32 v9, v93
  s_waitcnt lgkmcnt(3)
  v_mfma_f32_32x32x16_bf16 v[48:63], a[252:255], v[84:87], v[48:63]
  ds_read_b64_tr_b16 v[80:81], v1 offset:1024
  ds_read_b64_tr_b16 v[82:83], v1 offset:1280
  ds_read_b128 v[96:99], v8 offset:0
  ds_read_b128 v[100:103], v8 offset:32
  v_mfma_f32_32x32x16_bf16 v[64:79], v[84:87], v[252:255], v[64:79]
  ds_read_b128 v[104:107], v8 offset:64
  ds_read_b128 v[108:111], v8 offset:96
  s_add_u32 s7, s46, 0x2000
  v_mfma_f32_32x32x8_bf16 v[48:63], v[16:17], v[22:23], v[48:63]
  v_mfma_f32_32x32x8_bf16 v[64:79], v[20:21], v[18:19], v[64:79]
  s_waitcnt lgkmcnt(7)
  v_mfma_f32_32x32x16_bf16 v[32:47], a[0:3], v[88:91], 0
  ds_read_b64_tr_b16 v[84:85], v1 offset:2048
  ds_read_b64_tr_b16 v[86:87], v1 offset:2304
  s_waitcnt lgkmcnt(6)
  v_mfma_f32_32x32x16_bf16 v[32:47], a[4:7], v[80:83], v[32:47]
  ds_read_b64_tr_b16 v[88:89], v1 offset:3072
  ds_read_b64_tr_b16 v[90:91], v1 offset:3328
  s_nop 2
  v_pk_mul_f32 v[48:49], v[48:49], v[92:93]
  v_pk_mul_f32 v[50:51], v[50:51], v[92:93]
  v_pk_mul_f32 v[52:53], v[52:53], v[92:93]
  v_pk_mul_f32 v[54:55], v[54:55], v[92:93]
  s_waitcnt lgkmcnt(2)
  v_mfma_f32_32x32x16_bf16 v[32:47], a[8:11], v[84:87], v[32:47]
  ds_read_b64_tr_b16 v[80:81], v1 offset:4096
  ds_read_b64_tr_b16 v[82:83], v1 offset:4352
  v_pk_mul_f32 v[56:57], v[56:57], v[92:93]
  v_pk_mul_f32 v[58:59], v[58:59], v[92:93]
  v_pk_mul_f32 v[60:61], v[60:61], v[92:93]
  v_pk_mul_f32 v[62:63], v[62:63], v[92:93]
  s_waitcnt lgkmcnt(2)
  v_mfma_f32_32x32x16_bf16 v[32:47], a[12:15], v[88:91], v[32:47]
  ds_read_b64_tr_b16 v[84:85], v1 offset:5120
  ds_read_b64_tr_b16 v[86:87], v1 offset:5376
  v_cvt_pk_bf16_f32 v48, v48, v49
  v_cvt_pk_bf16_f32 v49, v50, v51
  v_cvt_pk_bf16_f32 v50, v52, v53
  v_cvt_pk_bf16_f32 v51, v54, v55
  s_waitcnt lgkmcnt(2)
  v_mfma_f32_32x32x16_bf16 v[32:47], a[16:19], v[80:83], v[32:47]
  ds_read_b64_tr_b16 v[88:89], v1 offset:6144
  ds_read_b64_tr_b16 v[90:91], v1 offset:6400
  v_cvt_pk_bf16_f32 v52, v56, v57
  v_cvt_pk_bf16_f32 v53, v58, v59
  v_cvt_pk_bf16_f32 v54, v60, v61
  v_cvt_pk_bf16_f32 v55, v62, v63
  s_waitcnt lgkmcnt(2)
  v_mfma_f32_32x32x16_bf16 v[32:47], a[20:23], v[84:87], v[32:47]
  ds_read_b64_tr_b16 v[80:81], v1 offset:7168
  ds_read_b64_tr_b16 v[82:83], v1 offset:7424
  v_bfi_b32 v48, 1, s42, v48
  v_bfi_b32 v52, 1, s42, v52
  buffer_store_dwordx4 v[48:51], v0, s[8:11], s46 offen offset:0 sc1
  ds_write_b128 v112, v[48:51] offset:8192
  s_waitcnt lgkmcnt(3)
  v_mfma_f32_32x32x16_bf16 v[32:47], a[24:27], v[88:91], v[32:47]
  ds_read_b64_tr_b16 v[84:85], v1 offset:8192
  ds_read_b64_tr_b16 v[86:87], v1 offset:8448
  buffer_store_dwordx4 v[52:55], v0, s[8:11], s46 offen offset:1024 sc1
  ds_write_b128 v112, v[52:55] offset:9216
  v_pk_mul_f32 v[64:65], v[64:65], v[96:97]
  s_waitcnt lgkmcnt(4)
  v_mfma_f32_32x32x16_bf16 v[32:47], a[28:31], v[80:83], v[32:47]
  ds_read_b64_tr_b16 v[88:89], v1 offset:9216
  ds_read_b64_tr_b16 v[90:91], v1 offset:9472
  v_pk_mul_f32 v[66:67], v[66:67], v[98:99]
  v_pk_mul_f32 v[68:69], v[68:69], v[100:101]
  v_pk_mul_f32 v[70:71], v[70:71], v[102:103]
  v_pk_mul_f32 v[72:73], v[72:73], v[104:105]
  s_waitcnt lgkmcnt(3)
  v_mfma_f32_32x32x16_bf16 v[32:47], a[32:35], v[84:87], v[32:47]
  ds_read_b64_tr_b16 v[80:81], v1 offset:10240
  ds_read_b64_tr_b16 v[82:83], v1 offset:10496
  v_pk_mul_f32 v[74:75], v[74:75], v[106:107]
  v_pk_mul_f32 v[76:77], v[76:77], v[108:109]
  v_pk_mul_f32 v[78:79], v[78:79], v[110:111]
  v_cvt_pk_bf16_f32 v64, v64, v65
  s_waitcnt lgkmcnt(2)
  v_mfma_f32_32x32x16_bf16 v[32:47], a[36:39], v[88:91], v[32:47]
  ds_read_b64_tr_b16 v[84:85], v1 offset:11264
  ds_read_b64_tr_b16 v[86:87], v1 offset:11520
  v_cvt_pk_bf16_f32 v65, v66, v67
  v_cvt_pk_bf16_f32 v66, v68, v69
  v_cvt_pk_bf16_f32 v67, v70, v71
  v_cvt_pk_bf16_f32 v68, v72, v73
  s_waitcnt lgkmcnt(2)
  v_mfma_f32_32x32x16_bf16 v[32:47], a[40:43], v[80:83], v[32:47]
  ds_read_b64_tr_b16 v[88:89], v1 offset:12288
  ds_read_b64_tr_b16 v[90:91], v1 offset:12544
  v_cvt_pk_bf16_f32 v69, v74, v75
  v_cvt_pk_bf16_f32 v70, v76, v77
  v_cvt_pk_bf16_f32 v71, v78, v79
  v_bfi_b32 v64, 1, s42, v64
  s_waitcnt lgkmcnt(2)
  v_mfma_f32_32x32x16_bf16 v[32:47], a[44:47], v[84:87], v[32:47]
  ds_read_b64_tr_b16 v[80:81], v1 offset:13312
  ds_read_b64_tr_b16 v[82:83], v1 offset:13568
  v_bfi_b32 v68, 1, s42, v68
  buffer_store_dwordx4 v[64:67], v0, s[8:11], s7 offen offset:0 sc1
  ds_write_b128 v112, v[64:67] offset:16384
  buffer_store_dwordx4 v[68:71], v0, s[8:11], s7 offen offset:1024 sc1
  s_waitcnt lgkmcnt(3)
  v_mfma_f32_32x32x16_bf16 v[32:47], a[48:51], v[88:91], v[32:47]
  ds_read_b64_tr_b16 v[84:85], v1 offset:14336
  ds_read_b64_tr_b16 v[86:87], v1 offset:14592
  ds_write_b128 v112, v[68:71] offset:17408
  s_waitcnt lgkmcnt(4)
  v_mfma_f32_32x32x16_bf16 v[32:47], a[52:55], v[80:83], v[32:47]
  ds_read_b64_tr_b16 v[88:89], v1 offset:15360
  ds_read_b64_tr_b16 v[90:91], v1 offset:15616
  s_waitcnt lgkmcnt(3)
  v_mfma_f32_32x32x16_bf16 v[32:47], a[56:59], v[84:87], v[32:47]
  ds_read_b64_tr_b16 v[80:81], v1 offset:16384
  ds_read_b64_tr_b16 v[82:83], v1 offset:16640
  s_waitcnt lgkmcnt(2)
  v_mfma_f32_32x32x16_bf16 v[32:47], a[60:63], v[88:91], v[32:47]
  ds_read_b64_tr_b16 v[84:85], v1 offset:17408
  ds_read_b64_tr_b16 v[86:87], v1 offset:17664
  s_waitcnt lgkmcnt(2)
  v_mfma_f32_32x32x16_bf16 v[32:47], a[64:67], v[80:83], v[32:47]
  ds_read_b64_tr_b16 v[88:89], v1 offset:18432
  ds_read_b64_tr_b16 v[90:91], v1 offset:18688
  s_waitcnt lgkmcnt(2)
  v_mfma_f32_32x32x16_bf16 v[32:47], a[68:71], v[84:87], v[32:47]
  ds_read_b64_tr_b16 v[80:81], v1 offset:19456
  ds_read_b64_tr_b16 v[82:83], v1 offset:19712
  s_waitcnt lgkmcnt(2)
  v_mfma_f32_32x32x16_bf16 v[32:47], a[72:75], v[88:91], v[32:47]
  ds_read_b64_tr_b16 v[84:85], v1 offset:20480
  ds_read_b64_tr_b16 v[86:87], v1 offset:20736
  s_waitcnt lgkmcnt(2)
  v_mfma_f32_32x32x16_bf16 v[32:47], a[76:79], v[80:83], v[32:47]
  ds_read_b64_tr_b16 v[88:89], v1 offset:21504
  ds_read_b64_tr_b16 v[90:91], v1 offset:21760
  s_waitcnt lgkmcnt(2)
  v_mfma_f32_32x32x16_bf16 v[32:47], a[80:83], v[84:87], v[32:47]
  ds_read_b64_tr_b16 v[80:81], v1 offset:22528
  ds_read_b64_tr_b16 v[82:83], v1 offset:22784
  s_waitcnt lgkmcnt(2)
  v_mfma_f32_32x32x16_bf16 v[32:47], a[84:87], v[88:91], v[32:47]
  ds_read_b64_tr_b16 v[84:85], v1 offset:23552
  ds_read_b64_tr_b16 v[86:87], v1 offset:23808
  s_waitcnt lgkmcnt(2)
  v_mfma_f32_32x32x16_bf16 v[32:47], a[88:91], v[80:83], v[32:47]
  ds_read_b64_tr_b16 v[88:89], v1 offset:24576
  ds_read_b64_tr_b16 v[90:91], v1 offset:24832
  s_waitcnt lgkmcnt(2)
  v_mfma_f32_32x32x16_bf16 v[32:47], a[92:95], v[84:87], v[32:47]
  ds_read_b64_tr_b16 v[80:81], v1 offset:25600
  ds_read_b64_tr_b16 v[82:83], v1 offset:25856
  s_waitcnt lgkmcnt(2)
  v_mfma_f32_32x32x16_bf16 v[32:47], a[96:99], v[88:91], v[32:47]
  ds_read_b64_tr_b16 v[84:85], v1 offset:26624
  ds_read_b64_tr_b16 v[86:87], v1 offset:26880
  s_waitcnt lgkmcnt(2)
  v_mfma_f32_32x32x16_bf16 v[32:47], a[100:103], v[80:83], v[32:47]
  ds_read_b64_tr_b16 v[88:89], v1 offset:27648
  ds_read_b64_tr_b16 v[90:91], v1 offset:27904
  s_waitcnt lgkmcnt(2)
  v_mfma_f32_32x32x16_bf16 v[32:47], a[104:107], v[84:87], v[32:47]
  ds_read_b64_tr_b16 v[80:81], v1 offset:28672
  ds_read_b64_tr_b16 v[82:83], v1 offset:28928
  s_waitcnt lgkmcnt(2)
  v_mfma_f32_32x32x16_bf16 v[32:47], a[108:111], v[88:91], v[32:47]
  ds_read_b64_tr_b16 v[84:85], v1 offset:29696
  ds_read_b64_tr_b16 v[86:87], v1 offset:29952
  s_waitcnt lgkmcnt(2)
  v_mfma_f32_32x32x16_bf16 v[32:47], a[112:115], v[80:83], v[32:47]
  ds_read_b64_tr_b16 v[88:89], v1 offset:30720
  ds_read_b64_tr_b16 v[90:91], v1 offset:30976
  s_waitcnt lgkmcnt(2)
  v_mfma_f32_32x32x16_bf16 v[32:47], a[116:119], v[84:87], v[32:47]
  ds_read_b64_tr_b16 v[80:81], v1 offset:31744
  ds_read_b64_tr_b16 v[82:83], v1 offset:32000
  s_waitcnt lgkmcnt(2)
  v_mfma_f32_32x32x16_bf16 v[32:47], a[120:123], v[88:91], v[32:47]
  s_waitcnt lgkmcnt(0)
  v_mfma_f32_32x32x16_bf16 v[32:47], a[124:127], v[80:83], v[32:47]
  s_sub_u32 s51, s33, 2
  s_and_b32 s6, s51, 3
  s_lshl_b32 s6, s6, 17
  s_add_u32 s47, s40, s6
  s_lshr_b32 s6, s51, 2
  s_andn2_b32 s50, 1, s6
  s_lshl_b32 s6, s51, 18
  s_add_u32 s48, s41, s6
  s_add_u32 s51, s51, 1
  buffer_load_dwordx4 v[116:119], v0, s[8:11], s47 offen sc1
  buffer_load_dword v115, v114, s[8:11], s44 offen sc1
  v_mfma_f32_32x32x8_bf16 v[32:47], v[16:17], v[20:21], v[32:47]
  s_nop 11
  v_pk_mul_f32 v[32:33], v[32:33], v[92:93]
  v_pk_mul_f32 v[34:35], v[34:35], v[92:93]
  v_pk_mul_f32 v[36:37], v[36:37], v[92:93]
  v_pk_mul_f32 v[38:39], v[38:39], v[92:93]
  v_pk_mul_f32 v[40:41], v[40:41], v[92:93]
  v_pk_mul_f32 v[42:43], v[42:43], v[92:93]
  v_pk_mul_f32 v[44:45], v[44:45], v[92:93]
  v_pk_mul_f32 v[46:47], v[46:47], v[92:93]
  v_cvt_pk_bf16_f32 v32, v32, v33
  v_cvt_pk_bf16_f32 v33, v34, v35
  v_cvt_pk_bf16_f32 v34, v36, v37
  v_cvt_pk_bf16_f32 v35, v38, v39
  v_cvt_pk_bf16_f32 v36, v40, v41
  v_cvt_pk_bf16_f32 v37, v42, v43
  v_cvt_pk_bf16_f32 v38, v44, v45
  v_cvt_pk_bf16_f32 v39, v46, v47
  ds_write_b128 v112, v[32:35] offset:0
  ds_write_b128 v112, v[36:39] offset:1024
  s_cmp_eq_u32 s32, 0
  s_cbranch_scc1 L_p_first
L_p_att:
  ds_read_b128 v[64:67], v3 offset:0
  ds_read_b128 v[32:35], v2 offset:0
  ds_read_b128 v[48:51], v2 offset:128
  ds_read_b128 v[68:71], v3 offset:2048
  ds_read_b128 v[36:39], v2 offset:2048
  ds_read_b128 v[52:55], v2 offset:2176
  ds_read_b128 v[72:75], v3 offset:4096
  ds_read_b128 v[40:43], v2 offset:4096
  ds_read_b128 v[56:59], v2 offset:4224
  ds_read_b128 v[76:79], v3 offset:6144
  ds_read_b128 v[44:47], v2 offset:6144
  ds_read_b128 v[60:63], v2 offset:6272
  s_waitcnt lgkmcnt(9)
  v_mfma_f32_16x16x32_bf16 v[96:99], v[32:35], v[64:67], v[24:27]
  v_mfma_f32_16x16x32_bf16 v[100:103], v[48:51], v[64:67], v[28:31]
  s_waitcnt lgkmcnt(6)
  v_mfma_f32_16x16x32_bf16 v[96:99], v[36:39], v[68:71], v[96:99]
  v_mfma_f32_16x16x32_bf16 v[100:103], v[52:55], v[68:71], v[100:103]
  s_waitcnt lgkmcnt(3)
  v_mfma_f32_16x16x32_bf16 v[96:99], v[40:43], v[72:75], v[96:99]
  v_mfma_f32_16x16x32_bf16 v[100:103], v[56:59], v[72:75], v[100:103]
  s_waitcnt lgkmcnt(0)
  v_mfma_f32_16x16x32_bf16 v[96:99], v[44:47], v[76:79], v[96:99]
  v_mfma_f32_16x16x32_bf16 v[100:103], v[60:63], v[76:79], v[100:103]
  ds_read_b128 v[80:83], v4 offset:0
  ds_read_b128 v[84:87], v4 offset:256
  ds_read_b128 v[88:91], v4 offset:2048
  ds_read_b128 v[92:95], v4 offset:2304
  s_mov_b32 s52, 0
  s_barrier
  s_mov_b32 s7, 0
  s_waitcnt vmcnt(0)
L_p_km:
  v_bitop3_b32 v126, v116, s50, 1 bitop3:0x28
  v_cmp_ne_u32 vcc, 0, v126
  s_cbranch_vccz L_p_kmok
  buffer_load_dwordx4 v[116:119], v0, s[8:11], s47 offen sc1
  s_cmp_lg_u32 s52, 0
  s_cbranch_scc1 L_p_k0
  s_cmp_ge_u32 s32, 31
  s_cbranch_scc1 L_p_k0
  v_cmp_gt_u32 vcc, s49, v115
  s_cbranch_vccnz L_p_k1
  s_mov_b32 s52, 1
  s_sub_u32 s6, s49, 1
  s_lshl_b32 s6, s6, 15
  s_add_u32 s45, s38, s6
  s_mov_b32 m0, s53
  s_add_u32 s6, s45, 4096
  buffer_load_dwordx4 v0, s[8:11], s45 offen offset:0 lds
  buffer_load_dwordx4 v0, s[8:11], s45 offen offset:1024 lds
  buffer_load_dwordx4 v0, s[8:11], s45 offen offset:2048 lds
  buffer_load_dwordx4 v0, s[8:11], s45 offen offset:3072 lds
  s_add_u32 m0, s53, 4096
  s_nop 0
  buffer_load_dwordx4 v0, s[8:11], s6 offen offset:0 lds
  buffer_load_dwordx4 v0, s[8:11], s6 offen offset:1024 lds
  buffer_load_dwordx4 v0, s[8:11], s6 offen offset:2048 lds
  buffer_load_dwordx4 v0, s[8:11], s6 offen offset:3072 lds
  s_waitcnt vmcnt(8)
  s_branch L_p_k2
L_p_k1:
  buffer_load_dword v115, v114, s[8:11], s44 offen sc1
L_p_k0:
  s_waitcnt vmcnt(0)
L_p_k2:
  s_add_u32 s7, s7, 1
  s_cmp_lt_u32 s7, 131072
  s_cbranch_scc1 L_p_km
  s_mov_b32 s6, 23
  s_branch L_err
L_p_kmok:
  s_cmp_lg_u32 s52, 0
  s_cbranch_scc1 L_nx_97
  s_cmp_ge_u32 s32, 31
  s_cbranch_scc1 L_nx_97
  v_cmp_gt_u32 vcc, s49, v115
  s_cbranch_vccnz L_nx_98
  s_mov_b32 s52, 1
  s_sub_u32 s6, s49, 1
  s_lshl_b32 s6, s6, 15
  s_add_u32 s45, s38, s6
  s_mov_b32 m0, s53
  s_add_u32 s6, s45, 4096
  buffer_load_dwordx4 v0, s[8:11], s45 offen offset:0 lds
  buffer_load_dwordx4 v0, s[8:11], s45 offen offset:1024 lds
  buffer_load_dwordx4 v0, s[8:11], s45 offen offset:2048 lds
  buffer_load_dwordx4 v0, s[8:11], s45 offen offset:3072 lds
  s_add_u32 m0, s53, 4096
  s_nop 0
  buffer_load_dwordx4 v0, s[8:11], s6 offen offset:0 lds
  buffer_load_dwordx4 v0, s[8:11], s6 offen offset:1024 lds
  buffer_load_dwordx4 v0, s[8:11], s6 offen offset:2048 lds
  buffer_load_dwordx4 v0, s[8:11], s6 offen offset:3072 lds
  s_branch L_nx_97
L_nx_98:
  buffer_load_dword v115, v114, s[8:11], s44 offen sc1
L_nx_97:
  ds_write_b64 v5, v[116:117]
  ds_write_b64 v5, v[118:119] offset:128
  v_max3_f32 v124, v96, v97, v98
  v_max3_f32 v125, v100, v101, v102
  v_max3_f32 v124, v124, v99, v103
  s_waitcnt lgkmcnt(0)
  s_barrier
  ds_read_b64_tr_b16 v[32:33], v6 offset:0
  ds_read_b64_tr_b16 v[34:35], v6 offset:64
  ds_read_b64_tr_b16 v[36:37], v6 offset:256
  ds_read_b64_tr_b16 v[38:39], v6 offset:320
  ds_read_b64_tr_b16 v[40:41], v6 offset:512
  ds_read_b64_tr_b16 v[42:43], v6 offset:576
  ds_read_b64_tr_b16 v[44:45], v6 offset:768
  ds_read_b64_tr_b16 v[46:47], v6 offset:832
  ds_read_b64 v[48:49], v7 offset:0
  ds_read_b64 v[50:51], v7 offset:128
  ds_read_b64 v[52:53], v7 offset:256
  ds_read_b64 v[54:55], v7 offset:384
  s_waitcnt lgkmcnt(10)
  v_mfma_f32_16x16x32_bf16 v[104:107], v[32:35], v[64:67], 0
  s_waitcnt lgkmcnt(8)
  v_mfma_f32_16x16x32_bf16 v[104:107], v[36:39], v[68:71], v[104:107]
  s_waitcnt lgkmcnt(6)
  v_mfma_f32_16x16x32_bf16 v[104:107], v[40:43], v[72:75], v[104:107]
  s_waitcnt lgkmcnt(4)
  v_mfma_f32_16x16x32_bf16 v[104:107], v[44:47], v[76:79], v[104:107]
  v_max_f32 v124, v124, v125
  s_nop 6
  v_max3_f32 v124, v124, v106, v107
  v_mov_b32 v125, v124
  s_nop 1
  v_permlane32_swap_b32 v124, v125
  v_max_f32 v124, v124, v125
  v_max_f32 v125, v124, v125
  s_nop 1
  v_permlane16_swap_b32 v124, v125
  v_max_f32 v124, v124, v125
  v_mul_f32 v124, s34, v124
  v_fma_f32 v106, v106, s34, -v124
  v_fma_f32 v107, v107, s34, -v124
  v_fma_f32 v96, v96, s34, -v124
  v_fma_f32 v97, v97, s34, -v124
  v_fma_f32 v98, v98, s34, -v124
  v_fma_f32 v99, v99, s34, -v124
  v_fma_f32 v100, v100, s34, -v124
  v_fma_f32 v101, v101, s34, -v124
  v_fma_f32 v102, v102, s34, -v124
  v_fma_f32 v103, v103, s34, -v124
  v_exp_f32 v106, v106
  v_exp_f32 v107, v107
  v_exp_f32 v96, v96
  v_cvt_pk_bf16_f32 v12, v106, v107
  v_exp_f32 v97, v97
  s_waitcnt lgkmcnt(0)
  v_mfma_f32_16x16x16_bf16 v[108:111], v[10:11], v[12:13], 0
  v_mfma_f32_16x16x16_bf16 v[56:59], v[48:49], v[12:13], 0
  v_exp_f32 v98, v98
  v_exp_f32 v99, v99
  v_mfma_f32_16x16x16_bf16 v[60:63], v[50:51], v[12:13], 0
  v_exp_f32 v100, v100
  v_exp_f32 v101, v101
  v_mfma_f32_16x16x16_bf16 v[64:67], v[52:53], v[12:13], 0
  v_exp_f32 v102, v102
  v_exp_f32 v103, v103
  v_mfma_f32_16x16x16_bf16 v[68:71], v[54:55], v[12:13], 0
  v_cvt_pk_bf16_f32 v120, v96, v97
  v_cvt_pk_bf16_f32 v121, v98, v99
  v_cvt_pk_bf16_f32 v122, v100, v101
  v_cvt_pk_bf16_f32 v123, v102, v103
  v_mfma_f32_16x16x16_bf16 v[108:111], v[10:11], v[120:121], v[108:111]
  s_nop 0
  v_mfma_f32_16x16x16_bf16 v[108:111], v[10:11], v[122:123], v[108:111]
  v_mfma_f32_16x16x32_bf16 v[56:59], v[80:83], v[120:123], v[56:59]
  v_mfma_f32_16x16x32_bf16 v[60:63], v[84:87], v[120:123], v[60:63]
  v_mfma_f32_16x16x32_bf16 v[64:67], v[88:91], v[120:123], v[64:67]
  v_mfma_f32_16x16x32_bf16 v[68:71], v[92:95], v[120:123], v[68:71]
  s_nop 3
  v_rcp_f32 v108, v108
  v_mov_b32 v126, s51
  v_pk_mul_f32 v[56:57], v[56:57], v[108:109] op_sel_hi:[1,0]
  v_pk_mul_f32 v[58:59], v[58:59], v[108:109] op_sel_hi:[1,0]
  v_pk_mul_f32 v[60:61], v[60:61], v[108:109] op_sel_hi:[1,0]
  v_pk_mul_f32 v[62:63], v[62:63], v[108:109] op_sel_hi:[1,0]
  v_cvt_pk_bf16_f32 v56, v56, v57
  v_cvt_pk_bf16_f32 v57, v58, v59
  v_cvt_pk_bf16_f32 v58, v60, v61
  v_cvt_pk_bf16_f32 v59, v62, v63
  buffer_store_dwordx4 v[56:59], v113, s[8:11], s48 offen offset:0 sc1
  v_pk_mul_f32 v[64:65], v[64:65], v[108:109] op_sel_hi:[1,0]
  v_pk_mul_f32 v[66:67], v[66:67], v[108:109] op_sel_hi:[1,0]
  v_pk_mul_f32 v[68:69], v[68:69], v[108:109] op_sel_hi:[1,0]
  v_pk_mul_f32 v[70:71], v[70:71], v[108:109] op_sel_hi:[1,0]
  v_cvt_pk_bf16_f32 v64, v64, v65
  v_cvt_pk_bf16_f32 v65, v66, v67
  v_cvt_pk_bf16_f32 v66, v68, v69
  v_cvt_pk_bf16_f32 v67, v70, v71
  buffer_store_dwordx4 v[64:67], v113, s[8:11], s48 offen offset:2048 sc1
  s_cmp_ge_u32 s32, 31
  s_cbranch_scc1 L_p_of
  s_cmp_lg_u32 s52, 0
  s_cbranch_scc1 L_p_of3
  s_waitcnt vmcnt(2)
  v_cmp_gt_u32 vcc, s49, v115
  s_cbranch_vccnz L_p_of
  s_mov_b32 s52, 1
  s_sub_u32 s6, s49, 1
  s_lshl_b32 s6, s6, 15
  s_add_u32 s45, s38, s6
  s_mov_b32 m0, s53
  s_add_u32 s6, s45, 4096
  buffer_load_dwordx4 v0, s[8:11], s45 offen offset:0 lds
  buffer_load_dwordx4 v0, s[8:11], s45 offen offset:1024 lds
  buffer_load_dwordx4 v0, s[8:11], s45 offen offset:2048 lds
  buffer_load_dwordx4 v0, s[8:11], s45 offen offset:3072 lds
  s_add_u32 m0, s53, 4096
  s_nop 0
  buffer_load_dwordx4 v0, s[8:11], s6 offen offset:0 lds
  buffer_load_dwordx4 v0, s[8:11], s6 offen offset:1024 lds
  buffer_load_dwordx4 v0, s[8:11], s6 offen offset:2048 lds
  buffer_load_dwordx4 v0, s[8:11], s6 offen offset:3072 lds
  s_waitcnt vmcnt(8)
  s_mov_b64 exec, 1
  buffer_store_dword v126, v13, s[8:11], s43 offen sc1
  s_mov_b64 exec, -1
  s_waitcnt vmcnt(1)
  s_branch L_p_of2
L_p_of3:
  s_mov_b32 s52, 2
  s_waitcnt vmcnt(2)
  s_branch L_p_of2
L_p_of:
  s_waitcnt vmcnt(0)
  s_mov_b64 exec, 1
  buffer_store_dword v126, v13, s[8:11], s43 offen sc1
  s_mov_b64 exec, -1
L_p_of2:
L_p_next:
  v_xor_b32 v2, 0x18000, v2
  v_xor_b32 v3, 0x18000, v3
  v_xor_b32 v4, 0x18000, v4
  v_xor_b32 v112, 0x18000, v112
  s_add_u32 s32, s32, 1
  s_add_u32 s33, s33, 2
  s_cmp_gt_u32 s32, 32
  s_cbranch_scc1 L_p_end
  s_cmp_eq_u32 s32, 32
  s_cbranch_scc1 L_p_tail
  s_cmp_eq_u32 s52, 0
  s_cbranch_scc1 L_p_xwait
  s_branch L_p_loop
L_p_tail:
  s_sub_u32 s51, s33, 2
  s_and_b32 s6, s51, 3
  s_lshl_b32 s6, s6, 17
  s_add_u32 s47, s40, s6
  s_lshr_b32 s6, s51, 2
  s_andn2_b32 s50, 1, s6
  s_lshl_b32 s6, s51, 18
  s_add_u32 s48, s41, s6
  s_add_u32 s51, s51, 1
  buffer_load_dwordx4 v[116:119], v0, s[8:11], s47 offen sc1
  s_waitcnt vmcnt(0) lgkmcnt(0)
  s_barrier
  s_branch L_p_att
L_p_first:
  s_waitcnt vmcnt(0) lgkmcnt(0)
  s_barrier
  s_mov_b32 s52, 0
  s_cmp_ge_u32 s32, 31
  s_cbranch_scc1 L_nx_99
  v_cmp_gt_u32 vcc, s49, v115
  s_cbranch_vccnz L_nx_99
  s_mov_b32 s52, 1
  s_sub_u32 s6, s49, 1
  s_lshl_b32 s6, s6, 15
  s_add_u32 s45, s38, s6
  s_mov_b32 m0, s53
  s_add_u32 s6, s45, 4096
  buffer_load_dwordx4 v0, s[8:11], s45 offen offset:0 lds
  buffer_load_dwordx4 v0, s[8:11], s45 offen offset:1024 lds
  buffer_load_dwordx4 v0, s[8:11], s45 offen offset:2048 lds
  buffer_load_dwordx4 v0, s[8:11], s45 offen offset:3072 lds
  s_add_u32 m0, s53, 4096
  s_nop 0
  buffer_load_dwordx4 v0, s[8:11], s6 offen offset:0 lds
  buffer_load_dwordx4 v0, s[8:11], s6 offen offset:1024 lds
  buffer_load_dwordx4 v0, s[8:11], s6 offen offset:2048 lds
  buffer_load_dwordx4 v0, s[8:11], s6 offen offset:3072 lds
L_nx_99:
  s_cmp_lg_u32 s35, 0
  s_cbranch_scc1 L_p_f2
  s_mov_b32 s51, 127
  s_mov_b32 s7, 0
L_pl_101:
  buffer_load_dwordx4 v[32:35], v0, s[8:11], s44 offen offset:0 sc1
  buffer_load_dwordx4 v[36:39], v0, s[8:11], s44 offen offset:1024 sc1
  s_waitcnt vmcnt(0)
  v_min3_u32 v32, v32, v33, v34
  v_min3_u32 v35, v35, v36, v37
  v_min3_u32 v32, v32, v38, v39
  v_min_u32 v32, v32, v35
  v_cmp_gt_u32 vcc, s51, v32
  s_cbranch_vccz L_plo_102
  s_add_u32 s7, s7, 1
  s_cmp_lt_u32 s7, 131072
  s_cbranch_scc1 L_pl_101
  s_mov_b32 s6, 24
  s_branch L_err
L_plo_102:
L_p_f2:
  s_waitcnt vmcnt(0)
  s_branch L_p_next
L_p_end:
  s_waitcnt vmcnt(0)
  s_endpgm
L_o:
  s_lshr_b32 s33, s5, 4
  s_bfe_u32 s34, s5, 0x20002
  s_and_b32 s35, s5, 3
  s_mul_i32 s36, s33, 0x1000000
  s_add_u32 s36, s36, 0x6800000
  s_lshl_b32 s6, s34, 3
  s_lshl_b32 s7, s3, 1
  s_add_u32 s6, s6, s7
  s_lshl_b32 s7, s6, 13
  s_add_u32 s36, s36, s7
  s_lshl_b32 s6, s6, 7
  s_lshl_b32 s7, s33, 13
  s_add_u32 s6, s6, s7
  s_add_u32 s38, s6, 0x718000
  s_mul_i32 s37, s33, 0x800000
  s_add_u32 s37, s37, 0x8800000
  s_lshl_b32 s6, s34, 15
  s_add_u32 s37, s37, s6
  s_lshl_b32 s6, s35, 13
  s_add_u32 s37, s37, s6
  s_lshl_b32 s6, s3, 11
  s_add_u32 s37, s37, s6
  s_lshl_b32 s6, s35, 6
  s_lshl_b32 s7, s3, 4
  s_add_u32 s6, s6, s7
  s_lshl_b32 s7, s33, 8
  s_add_u32 s6, s6, s7
  s_add_u32 s39, s6, 0x710800
  s_lshl_b32 s42, s3, 14
  s_branch L_pro
L_o2:
  v_lshlrev_b32 v0, 4, v0
  s_mov_b32 s16, s88
  s_mov_b32 s17, s89
  s_mov_b32 s18, 0x400000
  s_mov_b32 s19, 0x20000
  v_lshrrev_b32 v104, 4, v0
  v_lshrrev_b32 v100, 8, v0
  v_lshlrev_b32 v105, 2, v100
  v_and_b32 v104, 15, v104
  v_xor_b32 v104, v104, v105
  v_mul_u32_u24 v100, 1024, v100
  v_lshl_add_u32 v100, v104, 4, v100
  v_bfe_u32 v104, v0, 6, 2
  v_lshlrev_b32 v105, 2, v104
  v_bfe_u32 v106, v0, 8, 1
  v_lshlrev_b32 v106, 1, v106
  v_bfe_u32 v107, v0, 5, 1
  v_or_b32 v106, v106, v107
  s_lshl_b32 s6, s3, 2
  v_or_b32 v106, s6, v106
  v_xor_b32 v106, v106, v105
  v_lshlrev_b32 v106, 4, v106
  v_bfe_u32 v107, v0, 4, 1
  v_lshl_or_b32 v106, v107, 3, v106
  v_bfe_u32 v107, v0, 9, 1
  v_lshl_or_b32 v104, v107, 2, v104
  v_lshl_or_b32 v104, v104, 8, v106
  v_add_u32 v105, 0x10000, v104
  s_lshl_b32 s60, s3, 13
  s_mul_i32 s63, s3, 32768
  s_lshl_b32 s61, s34, 20
  s_lshl_b32 s62, s35, 8
  s_add_u32 s61, s61, s62
  s_add_u32 s61, s61, 0
  s_add_u32 s61, s61, s63
  s_add_u32 m0, s60, 0
  s_add_u32 s62, s61, 0
  buffer_load_dwordx4 v100, s[16:19], s62 offen lds
  s_add_u32 m0, s60, 1024
  s_add_u32 s62, s61, 4096
  buffer_load_dwordx4 v100, s[16:19], s62 offen lds
  s_add_u32 m0, s60, 2048
  s_add_u32 s62, s61, 8192
  buffer_load_dwordx4 v100, s[16:19], s62 offen lds
  s_add_u32 m0, s60, 3072
  s_add_u32 s62, s61, 12288
  buffer_load_dwordx4 v100, s[16:19], s62 offen lds
  s_add_u32 m0, s60, 4096
  s_add_u32 s62, s61, 16384
  buffer_load_dwordx4 v100, s[16:19], s62 offen lds
  s_add_u32 m0, s60, 5120
  s_add_u32 s62, s61, 20480
  buffer_load_dwordx4 v100, s[16:19], s62 offen lds
  s_add_u32 m0, s60, 6144
  s_add_u32 s62, s61, 24576
  buffer_load_dwordx4 v100, s[16:19], s62 offen lds
  s_add_u32 m0, s60, 7168
  s_add_u32 s62, s61, 28672
  buffer_load_dwordx4 v100, s[16:19], s62 offen lds
  s_lshl_b32 s61, s34, 20
  s_lshl_b32 s62, s35, 8
  s_add_u32 s61, s61, s62
  s_add_u32 s61, s61, 131072
  s_add_u32 s61, s61, s63
  s_add_u32 m0, s60, 32768
  s_add_u32 s62, s61, 0
  buffer_load_dwordx4 v100, s[16:19], s62 offen lds
  s_add_u32 m0, s60, 33792
  s_add_u32 s62, s61, 4096
  buffer_load_dwordx4 v100, s[16:19], s62 offen lds
  s_add_u32 m0, s60, 34816
  s_add_u32 s62, s61, 8192
  buffer_load_dwordx4 v100, s[16:19], s62 offen lds
  s_add_u32 m0, s60, 35840
  s_add_u32 s62, s61, 12288
  buffer_load_dwordx4 v100, s[16:19], s62 offen lds
  s_add_u32 m0, s60, 36864
  s_add_u32 s62, s61, 16384
  buffer_load_dwordx4 v100, s[16:19], s62 offen lds
  s_add_u32 m0, s60, 37888
  s_add_u32 s62, s61, 20480
  buffer_load_dwordx4 v100, s[16:19], s62 offen lds
  s_add_u32 m0, s60, 38912
  s_add_u32 s62, s61, 24576
  buffer_load_dwordx4 v100, s[16:19], s62 offen lds
  s_add_u32 m0, s60, 39936
  s_add_u32 s62, s61, 28672
  buffer_load_dwordx4 v100, s[16:19], s62 offen lds
  s_lshl_b32 s61, s34, 20
  s_lshl_b32 s62, s35, 8
  s_add_u32 s61, s61, s62
  s_add_u32 s61, s61, 262144
  s_add_u32 s61, s61, s63
  s_add_u32 m0, s60, 65536
  s_add_u32 s62, s61, 0
  buffer_load_dwordx4 v100, s[16:19], s62 offen lds
  s_add_u32 m0, s60, 66560
  s_add_u32 s62, s61, 4096
  buffer_load_dwordx4 v100, s[16:19], s62 offen lds
  s_add_u32 m0, s60, 67584
  s_add_u32 s62, s61, 8192
  buffer_load_dwordx4 v100, s[16:19], s62 offen lds
  s_add_u32 m0, s60, 68608
  s_add_u32 s62, s61, 12288
  buffer_load_dwordx4 v100, s[16:19], s62 offen lds
  s_add_u32 m0, s60, 69632
  s_add_u32 s62, s61, 16384
  buffer_load_dwordx4 v100, s[16:19], s62 offen lds
  s_add_u32 m0, s60, 70656
  s_add_u32 s62, s61, 20480
  buffer_load_dwordx4 v100, s[16:19], s62 offen lds
  s_add_u32 m0, s60, 71680
  s_add_u32 s62, s61, 24576
  buffer_load_dwordx4 v100, s[16:19], s62 offen lds
  s_add_u32 m0, s60, 72704
  s_add_u32 s62, s61, 28672
  buffer_load_dwordx4 v100, s[16:19], s62 offen lds
  s_waitcnt vmcnt(16)
  s_barrier
  s_lshl_b32 s61, s34, 20
  s_lshl_b32 s62, s35, 8
  s_add_u32 s61, s61, s62
  s_add_u32 s61, s61, 393216
  s_add_u32 s61, s61, s63
  s_add_u32 m0, s60, 98304
  s_add_u32 s62, s61, 0
  buffer_load_dwordx4 v100, s[16:19], s62 offen lds
  s_add_u32 m0, s60, 99328
  s_add_u32 s62, s61, 4096
  buffer_load_dwordx4 v100, s[16:19], s62 offen lds
  s_add_u32 m0, s60, 100352
  s_add_u32 s62, s61, 8192
  buffer_load_dwordx4 v100, s[16:19], s62 offen lds
  s_add_u32 m0, s60, 101376
  s_add_u32 s62, s61, 12288
  buffer_load_dwordx4 v100, s[16:19], s62 offen lds
  s_add_u32 m0, s60, 102400
  s_add_u32 s62, s61, 16384
  buffer_load_dwordx4 v100, s[16:19], s62 offen lds
  s_add_u32 m0, s60, 103424
  s_add_u32 s62, s61, 20480
  buffer_load_dwordx4 v100, s[16:19], s62 offen lds
  s_add_u32 m0, s60, 104448
  s_add_u32 s62, s61, 24576
  buffer_load_dwordx4 v100, s[16:19], s62 offen lds
  s_add_u32 m0, s60, 105472
  s_add_u32 s62, s61, 28672
  buffer_load_dwordx4 v100, s[16:19], s62 offen lds
  ds_read_b64_tr_b16 a[0:1], v104 offset:0
  ds_read_b64_tr_b16 a[2:3], v104 offset:4096
  ds_read_b64_tr_b16 a[4:5], v104 offset:2048
  ds_read_b64_tr_b16 a[6:7], v104 offset:6144
  ds_read_b64_tr_b16 a[8:9], v104 offset:8192
  ds_read_b64_tr_b16 a[10:11], v104 offset:12288
  ds_read_b64_tr_b16 a[12:13], v104 offset:10240
  ds_read_b64_tr_b16 a[14:15], v104 offset:14336
  ds_read_b64_tr_b16 a[16:17], v104 offset:16384
  ds_read_b64_tr_b16 a[18:19], v104 offset:20480
  ds_read_b64_tr_b16 a[20:21], v104 offset:18432
  ds_read_b64_tr_b16 a[22:23], v104 offset:22528
  ds_read_b64_tr_b16 a[24:25], v104 offset:24576
  ds_read_b64_tr_b16 a[26:27], v104 offset:28672
  ds_read_b64_tr_b16 a[28:29], v104 offset:26624
  ds_read_b64_tr_b16 a[30:31], v104 offset:30720
  s_waitcnt lgkmcnt(0)
  s_waitcnt vmcnt(16)
  s_barrier
  s_lshl_b32 s61, s34, 20
  s_lshl_b32 s62, s35, 8
  s_add_u32 s61, s61, s62
  s_add_u32 s61, s61, 524288
  s_add_u32 s61, s61, s63
  s_add_u32 m0, s60, 0
  s_add_u32 s62, s61, 0
  buffer_load_dwordx4 v100, s[16:19], s62 offen lds
  s_add_u32 m0, s60, 1024
  s_add_u32 s62, s61, 4096
  buffer_load_dwordx4 v100, s[16:19], s62 offen lds
  s_add_u32 m0, s60, 2048
  s_add_u32 s62, s61, 8192
  buffer_load_dwordx4 v100, s[16:19], s62 offen lds
  s_add_u32 m0, s60, 3072
  s_add_u32 s62, s61, 12288
  buffer_load_dwordx4 v100, s[16:19], s62 offen lds
  s_add_u32 m0, s60, 4096
  s_add_u32 s62, s61, 16384
  buffer_load_dwordx4 v100, s[16:19], s62 offen lds
  s_add_u32 m0, s60, 5120
  s_add_u32 s62, s61, 20480
  buffer_load_dwordx4 v100, s[16:19], s62 offen lds
  s_add_u32 m0, s60, 6144
  s_add_u32 s62, s61, 24576
  buffer_load_dwordx4 v100, s[16:19], s62 offen lds
  s_add_u32 m0, s60, 7168
  s_add_u32 s62, s61, 28672
  buffer_load_dwordx4 v100, s[16:19], s62 offen lds
  ds_read_b64_tr_b16 a[32:33], v104 offset:32768
  ds_read_b64_tr_b16 a[34:35], v104 offset:36864
  ds_read_b64_tr_b16 a[36:37], v104 offset:34816
  ds_read_b64_tr_b16 a[38:39], v104 offset:38912
  ds_read_b64_tr_b16 a[40:41], v104 offset:40960
  ds_read_b64_tr_b16 a[42:43], v104 offset:45056
  ds_read_b64_tr_b16 a[44:45], v104 offset:43008
  ds_read_b64_tr_b16 a[46:47], v104 offset:47104
  ds_read_b64_tr_b16 a[48:49], v104 offset:49152
  ds_read_b64_tr_b16 a[50:51], v104 offset:53248
  ds_read_b64_tr_b16 a[52:53], v104 offset:51200
  ds_read_b64_tr_b16 a[54:55], v104 offset:55296
  ds_read_b64_tr_b16 a[56:57], v104 offset:57344
  ds_read_b64_tr_b16 a[58:59], v104 offset:61440
  ds_read_b64_tr_b16 a[60:61], v104 offset:59392
  ds_read_b64_tr_b16 a[62:63], v104 offset:63488
  s_waitcnt lgkmcnt(0)
  s_waitcnt vmcnt(16)
  s_barrier
  s_lshl_b32 s61, s34, 20
  s_lshl_b32 s62, s35, 8
  s_add_u32 s61, s61, s62
  s_add_u32 s61, s61, 655360
  s_add_u32 s61, s61, s63
  s_add_u32 m0, s60, 32768
  s_add_u32 s62, s61, 0
  buffer_load_dwordx4 v100, s[16:19], s62 offen lds
  s_add_u32 m0, s60, 33792
  s_add_u32 s62, s61, 4096
  buffer_load_dwordx4 v100, s[16:19], s62 offen lds
  s_add_u32 m0, s60, 34816
  s_add_u32 s62, s61, 8192
  buffer_load_dwordx4 v100, s[16:19], s62 offen lds
  s_add_u32 m0, s60, 35840
  s_add_u32 s62, s61, 12288
  buffer_load_dwordx4 v100, s[16:19], s62 offen lds
  s_add_u32 m0, s60, 36864
  s_add_u32 s62, s61, 16384
  buffer_load_dwordx4 v100, s[16:19], s62 offen lds
  s_add_u32 m0, s60, 37888
  s_add_u32 s62, s61, 20480
  buffer_load_dwordx4 v100, s[16:19], s62 offen lds
  s_add_u32 m0, s60, 38912
  s_add_u32 s62, s61, 24576
  buffer_load_dwordx4 v100, s[16:19], s62 offen lds
  s_add_u32 m0, s60, 39936
  s_add_u32 s62, s61, 28672
  buffer_load_dwordx4 v100, s[16:19], s62 offen lds
  ds_read_b64_tr_b16 a[64:65], v105 offset:0
  ds_read_b64_tr_b16 a[66:67], v105 offset:4096
  ds_read_b64_tr_b16 a[68:69], v105 offset:2048
  ds_read_b64_tr_b16 a[70:71], v105 offset:6144
  ds_read_b64_tr_b16 a[72:73], v105 offset:8192
  ds_read_b64_tr_b16 a[74:75], v105 offset:12288
  ds_read_b64_tr_b16 a[76:77], v105 offset:10240
  ds_read_b64_tr_b16 a[78:79], v105 offset:14336
  ds_read_b64_tr_b16 a[80:81], v105 offset:16384
  ds_read_b64_tr_b16 a[82:83], v105 offset:20480
  ds_read_b64_tr_b16 a[84:85], v105 offset:18432
  ds_read_b64_tr_b16 a[86:87], v105 offset:22528
  ds_read_b64_tr_b16 a[88:89], v105 offset:24576
  ds_read_b64_tr_b16 a[90:91], v105 offset:28672
  ds_read_b64_tr_b16 a[92:93], v105 offset:26624
  ds_read_b64_tr_b16 a[94:95], v105 offset:30720
  s_waitcnt lgkmcnt(0)
  s_waitcnt vmcnt(16)
  s_barrier
  s_lshl_b32 s61, s34, 20
  s_lshl_b32 s62, s35, 8
  s_add_u32 s61, s61, s62
  s_add_u32 s61, s61, 786432
  s_add_u32 s61, s61, s63
  s_add_u32 m0, s60, 65536
  s_add_u32 s62, s61, 0
  buffer_load_dwordx4 v100, s[16:19], s62 offen lds
  s_add_u32 m0, s60, 66560
  s_add_u32 s62, s61, 4096
  buffer_load_dwordx4 v100, s[16:19], s62 offen lds
  s_add_u32 m0, s60, 67584
  s_add_u32 s62, s61, 8192
  buffer_load_dwordx4 v100, s[16:19], s62 offen lds
  s_add_u32 m0, s60, 68608
  s_add_u32 s62, s61, 12288
  buffer_load_dwordx4 v100, s[16:19], s62 offen lds
  s_add_u32 m0, s60, 69632
  s_add_u32 s62, s61, 16384
  buffer_load_dwordx4 v100, s[16:19], s62 offen lds
  s_add_u32 m0, s60, 70656
  s_add_u32 s62, s61, 20480
  buffer_load_dwordx4 v100, s[16:19], s62 offen lds
  s_add_u32 m0, s60, 71680
  s_add_u32 s62, s61, 24576
  buffer_load_dwordx4 v100, s[16:19], s62 offen lds
  s_add_u32 m0, s60, 72704
  s_add_u32 s62, s61, 28672
  buffer_load_dwordx4 v100, s[16:19], s62 offen lds
  ds_read_b64_tr_b16 a[96:97], v105 offset:32768
  ds_read_b64_tr_b16 a[98:99], v105 offset:36864
  ds_read_b64_tr_b16 a[100:101], v105 offset:34816
  ds_read_b64_tr_b16 a[102:103], v105 offset:38912
  ds_read_b64_tr_b16 a[104:105], v105 offset:40960
  ds_read_b64_tr_b16 a[106:107], v105 offset:45056
  ds_read_b64_tr_b16 a[108:109], v105 offset:43008
  ds_read_b64_tr_b16 a[110:111], v105 offset:47104
  ds_read_b64_tr_b16 a[112:113], v105 offset:49152
  ds_read_b64_tr_b16 a[114:115], v105 offset:53248
  ds_read_b64_tr_b16 a[116:117], v105 offset:51200
  ds_read_b64_tr_b16 a[118:119], v105 offset:55296
  ds_read_b64_tr_b16 a[120:121], v105 offset:57344
  ds_read_b64_tr_b16 a[122:123], v105 offset:61440
  ds_read_b64_tr_b16 a[124:125], v105 offset:59392
  ds_read_b64_tr_b16 a[126:127], v105 offset:63488
  s_waitcnt lgkmcnt(0)
  s_waitcnt vmcnt(16)
  s_barrier
  s_lshl_b32 s61, s34, 20
  s_lshl_b32 s62, s35, 8
  s_add_u32 s61, s61, s62
  s_add_u32 s61, s61, 917504
  s_add_u32 s61, s61, s63
  s_add_u32 m0, s60, 98304
  s_add_u32 s62, s61, 0
  buffer_load_dwordx4 v100, s[16:19], s62 offen lds
  s_add_u32 m0, s60, 99328
  s_add_u32 s62, s61, 4096
  buffer_load_dwordx4 v100, s[16:19], s62 offen lds
  s_add_u32 m0, s60, 100352
  s_add_u32 s62, s61, 8192
  buffer_load_dwordx4 v100, s[16:19], s62 offen lds
  s_add_u32 m0, s60, 101376
  s_add_u32 s62, s61, 12288
  buffer_load_dwordx4 v100, s[16:19], s62 offen lds
  s_add_u32 m0, s60, 102400
  s_add_u32 s62, s61, 16384
  buffer_load_dwordx4 v100, s[16:19], s62 offen lds
  s_add_u32 m0, s60, 103424
  s_add_u32 s62, s61, 20480
  buffer_load_dwordx4 v100, s[16:19], s62 offen lds
  s_add_u32 m0, s60, 104448
  s_add_u32 s62, s61, 24576
  buffer_load_dwordx4 v100, s[16:19], s62 offen lds
  s_add_u32 m0, s60, 105472
  s_add_u32 s62, s61, 28672
  buffer_load_dwordx4 v100, s[16:19], s62 offen lds
  ds_read_b64_tr_b16 a[128:129], v104 offset:0
  ds_read_b64_tr_b16 a[130:131], v104 offset:4096
  ds_read_b64_tr_b16 a[132:133], v104 offset:2048
  ds_read_b64_tr_b16 a[134:135], v104 offset:6144
  ds_read_b64_tr_b16 a[136:137], v104 offset:8192
  ds_read_b64_tr_b16 a[138:139], v104 offset:12288
  ds_read_b64_tr_b16 a[140:141], v104 offset:10240
  ds_read_b64_tr_b16 a[142:143], v104 offset:14336
  ds_read_b64_tr_b16 a[144:145], v104 offset:16384
  ds_read_b64_tr_b16 a[146:147], v104 offset:20480
  ds_read_b64_tr_b16 a[148:149], v104 offset:18432
  ds_read_b64_tr_b16 a[150:151], v104 offset:22528
  ds_read_b64_tr_b16 a[152:153], v104 offset:24576
  ds_read_b64_tr_b16 a[154:155], v104 offset:28672
  ds_read_b64_tr_b16 a[156:157], v104 offset:26624
  ds_read_b64_tr_b16 a[158:159], v104 offset:30720
  s_waitcnt lgkmcnt(0)
  s_waitcnt vmcnt(16)
  s_barrier
  ds_read_b64_tr_b16 a[160:161], v104 offset:32768
  ds_read_b64_tr_b16 a[162:163], v104 offset:36864
  ds_read_b64_tr_b16 a[164:165], v104 offset:34816
  ds_read_b64_tr_b16 a[166:167], v104 offset:38912
  ds_read_b64_tr_b16 a[168:169], v104 offset:40960
  ds_read_b64_tr_b16 a[170:171], v104 offset:45056
  ds_read_b64_tr_b16 a[172:173], v104 offset:43008
  ds_read_b64_tr_b16 a[174:175], v104 offset:47104
  ds_read_b64_tr_b16 a[176:177], v104 offset:49152
  ds_read_b64_tr_b16 a[178:179], v104 offset:53248
  ds_read_b64_tr_b16 a[180:181], v104 offset:51200
  ds_read_b64_tr_b16 a[182:183], v104 offset:55296
  ds_read_b64_tr_b16 a[184:185], v104 offset:57344
  ds_read_b64_tr_b16 a[186:187], v104 offset:61440
  ds_read_b64_tr_b16 a[188:189], v104 offset:59392
  ds_read_b64_tr_b16 a[190:191], v104 offset:63488
  s_waitcnt lgkmcnt(0)
  s_waitcnt vmcnt(8)
  s_barrier
  ds_read_b64_tr_b16 a[192:193], v105 offset:0
  ds_read_b64_tr_b16 a[194:195], v105 offset:4096
  ds_read_b64_tr_b16 a[196:197], v105 offset:2048
  ds_read_b64_tr_b16 a[198:199], v105 offset:6144
  ds_read_b64_tr_b16 a[200:201], v105 offset:8192
  ds_read_b64_tr_b16 a[202:203], v105 offset:12288
  ds_read_b64_tr_b16 a[204:205], v105 offset:10240
  ds_read_b64_tr_b16 a[206:207], v105 offset:14336
  ds_read_b64_tr_b16 a[208:209], v105 offset:16384
  ds_read_b64_tr_b16 a[210:211], v105 offset:20480
  ds_read_b64_tr_b16 a[212:213], v105 offset:18432
  ds_read_b64_tr_b16 a[214:215], v105 offset:22528
  ds_read_b64_tr_b16 a[216:217], v105 offset:24576
  ds_read_b64_tr_b16 a[218:219], v105 offset:28672
  ds_read_b64_tr_b16 a[220:221], v105 offset:26624
  ds_read_b64_tr_b16 a[222:223], v105 offset:30720
  s_waitcnt lgkmcnt(0)
  s_waitcnt vmcnt(0)
  s_barrier
  ds_read_b64_tr_b16 a[224:225], v105 offset:32768
  ds_read_b64_tr_b16 a[226:227], v105 offset:36864
  ds_read_b64_tr_b16 a[228:229], v105 offset:34816
  ds_read_b64_tr_b16 a[230:231], v105 offset:38912
  ds_read_b64_tr_b16 a[232:233], v105 offset:40960
  ds_read_b64_tr_b16 a[234:235], v105 offset:45056
  ds_read_b64_tr_b16 a[236:237], v105 offset:43008
  ds_read_b64_tr_b16 a[238:239], v105 offset:47104
  ds_read_b64_tr_b16 a[240:241], v105 offset:49152
  ds_read_b64_tr_b16 a[242:243], v105 offset:53248
  ds_read_b64_tr_b16 a[244:245], v105 offset:51200
  ds_read_b64_tr_b16 a[246:247], v105 offset:55296
  ds_read_b64_tr_b16 a[248:249], v105 offset:57344
  ds_read_b64_tr_b16 a[250:251], v105 offset:61440
  ds_read_b64_tr_b16 a[252:253], v105 offset:59392
  ds_read_b64_tr_b16 a[254:255], v105 offset:63488
  s_waitcnt lgkmcnt(0)
  s_barrier
  v_mov_b32 v3, 0
  v_mov_b32 v1, v0
  v_bfe_u32 v2, v0, 6, 1
  v_lshlrev_b32 v2, 7, v2
  v_bfe_u32 v4, v0, 2, 4
  v_or_b32 v2, v2, v4
  v_bfe_u32 v6, v0, 2, 4
  v_and_b32 v6, 12, v6
  s_mov_b32 s7, 0
  v_mbcnt_lo_u32_b32 v16, -1, 0
  v_and_b32 v16, 3, v16
  v_lshlrev_b32 v16, 6, v16
L_wd_103:
  buffer_load_dword v17, v16, s[12:15], 0 offen offset:16 sc1
  s_waitcnt vmcnt(0)
  v_cmp_ne_u32 vcc, 64, v17
  s_cbranch_vccz L_wdo_104
  s_add_u32 s7, s7, 1
  s_cmp_lt_u32 s7, 131072
  s_cbranch_scc1 L_wd_103
  s_mov_b32 s6, 30
  s_branch L_err
L_wdo_104:
  s_mov_b32 s32, 0
  s_mov_b32 s41, 1
  s_mov_b32 s40, s38
L_o_wait:
  s_mov_b32 s7, 0
L_pl_105:
  buffer_load_dword v4, v2, s[8:11], s40 offen offset:0 sc1
  s_waitcnt vmcnt(0)
  v_cmp_gt_u32 vcc, s41, v4
  s_cbranch_vccz L_plo_106
  s_add_u32 s7, s7, 1
  s_cmp_lt_u32 s7, 131072
  s_cbranch_scc1 L_pl_105
  s_mov_b32 s6, 31
  s_branch L_err
L_plo_106:
L_o_go:
  s_sub_u32 s6, s41, 1
  s_lshl_b32 s6, s6, 18
  s_add_u32 s44, s36, s6
  s_add_u32 m0, s42, 0
  s_add_u32 s45, s44, 0
  buffer_load_dwordx4 v0, s[8:11], s45 offen offset:0 lds
  buffer_load_dwordx4 v0, s[8:11], s45 offen offset:1024 lds
  buffer_load_dwordx4 v0, s[8:11], s45 offen offset:2048 lds
  buffer_load_dwordx4 v0, s[8:11], s45 offen offset:3072 lds
  s_add_u32 m0, s42, 4096
  s_add_u32 s45, s44, 4096
  buffer_load_dwordx4 v0, s[8:11], s45 offen offset:0 lds
  buffer_load_dwordx4 v0, s[8:11], s45 offen offset:1024 lds
  buffer_load_dwordx4 v0, s[8:11], s45 offen offset:2048 lds
  buffer_load_dwordx4 v0, s[8:11], s45 offen offset:3072 lds
  s_add_u32 m0, s42, 8192
  s_add_u32 s45, s44, 8192
  buffer_load_dwordx4 v0, s[8:11], s45 offen offset:0 lds
  buffer_load_dwordx4 v0, s[8:11], s45 offen offset:1024 lds
  buffer_load_dwordx4 v0, s[8:11], s45 offen offset:2048 lds
  buffer_load_dwordx4 v0, s[8:11], s45 offen offset:3072 lds
  s_add_u32 m0, s42, 12288
  s_add_u32 s45, s44, 12288
  buffer_load_dwordx4 v0, s[8:11], s45 offen offset:0 lds
  buffer_load_dwordx4 v0, s[8:11], s45 offen offset:1024 lds
  buffer_load_dwordx4 v0, s[8:11], s45 offen offset:2048 lds
  buffer_load_dwordx4 v0, s[8:11], s45 offen offset:3072 lds
  s_xor_b32 s42, s42, 0x10000
  s_mov_b32 s43, 0
  s_waitcnt vmcnt(8)
L_o_loop:
  s_barrier
  ds_read_b128 v[32:35], v1 offset:0
  ds_read_b128 v[36:39], v1 offset:1024
  ds_read_b128 v[40:43], v1 offset:2048
  s_add_u32 s41, s32, 2
  s_xor_b32 s40, s40, 0x1000
  buffer_load_dword v4, v2, s[8:11], s40 offen sc1
  buffer_load_dword v5, v6, s[8:11], s39 offen sc1
  s_waitcnt lgkmcnt(2)
  v_mfma_f32_32x32x16_bf16 v[16:31], a[0:3], v[32:35], 0
  ds_read_b128 v[44:47], v1 offset:3072
  s_waitcnt lgkmcnt(2)
  v_mfma_f32_32x32x16_bf16 v[16:31], a[4:7], v[36:39], v[16:31]
  ds_read_b128 v[32:35], v1 offset:4096
  s_waitcnt lgkmcnt(2)
  v_mfma_f32_32x32x16_bf16 v[16:31], a[8:11], v[40:43], v[16:31]
  ds_read_b128 v[36:39], v1 offset:5120
  s_waitcnt lgkmcnt(2)
  v_mfma_f32_32x32x16_bf16 v[16:31], a[12:15], v[44:47], v[16:31]
  ds_read_b128 v[40:43], v1 offset:6144
  s_waitcnt lgkmcnt(2)
  v_mfma_f32_32x32x16_bf16 v[16:31], a[16:19], v[32:35], v[16:31]
  ds_read_b128 v[44:47], v1 offset:7168
  s_waitcnt lgkmcnt(2)
  v_mfma_f32_32x32x16_bf16 v[16:31], a[20:23], v[36:39], v[16:31]
  ds_read_b128 v[32:35], v1 offset:16384
  s_waitcnt lgkmcnt(2)
  v_mfma_f32_32x32x16_bf16 v[16:31], a[24:27], v[40:43], v[16:31]
  ds_read_b128 v[36:39], v1 offset:17408
  s_waitcnt lgkmcnt(2)
  v_mfma_f32_32x32x16_bf16 v[16:31], a[28:31], v[44:47], v[16:31]
  ds_read_b128 v[40:43], v1 offset:18432
  s_waitcnt lgkmcnt(2)
  v_mfma_f32_32x32x16_bf16 v[16:31], a[64:67], v[32:35], v[16:31]
  ds_read_b128 v[44:47], v1 offset:19456
  s_waitcnt lgkmcnt(2)
  v_mfma_f32_32x32x16_bf16 v[16:31], a[68:71], v[36:39], v[16:31]
  ds_read_b128 v[32:35], v1 offset:20480
  s_waitcnt lgkmcnt(2)
  v_mfma_f32_32x32x16_bf16 v[16:31], a[72:75], v[40:43], v[16:31]
  ds_read_b128 v[36:39], v1 offset:21504
  s_waitcnt lgkmcnt(2)
  v_mfma_f32_32x32x16_bf16 v[16:31], a[76:79], v[44:47], v[16:31]
  ds_read_b128 v[40:43], v1 offset:22528
  s_waitcnt lgkmcnt(2)
  v_mfma_f32_32x32x16_bf16 v[16:31], a[80:83], v[32:35], v[16:31]
  ds_read_b128 v[44:47], v1 offset:23552
  s_waitcnt lgkmcnt(2)
  v_mfma_f32_32x32x16_bf16 v[16:31], a[84:87], v[36:39], v[16:31]
  ds_read_b128 v[32:35], v1 offset:32768
  s_waitcnt lgkmcnt(2)
  v_mfma_f32_32x32x16_bf16 v[16:31], a[88:91], v[40:43], v[16:31]
  ds_read_b128 v[36:39], v1 offset:33792
  s_waitcnt lgkmcnt(2)
  v_mfma_f32_32x32x16_bf16 v[16:31], a[92:95], v[44:47], v[16:31]
  ds_read_b128 v[40:43], v1 offset:34816
  s_waitcnt lgkmcnt(2)
  v_mfma_f32_32x32x16_bf16 v[16:31], a[128:131], v[32:35], v[16:31]
  ds_read_b128 v[44:47], v1 offset:35840
  s_waitcnt lgkmcnt(2)
  v_mfma_f32_32x32x16_bf16 v[16:31], a[132:135], v[36:39], v[16:31]
  ds_read_b128 v[32:35], v1 offset:36864
  s_waitcnt lgkmcnt(2)
  v_mfma_f32_32x32x16_bf16 v[16:31], a[136:139], v[40:43], v[16:31]
  ds_read_b128 v[36:39], v1 offset:37888
  s_waitcnt lgkmcnt(2)
  v_mfma_f32_32x32x16_bf16 v[16:31], a[140:143], v[44:47], v[16:31]
  ds_read_b128 v[40:43], v1 offset:38912
  s_waitcnt lgkmcnt(2)
  v_mfma_f32_32x32x16_bf16 v[16:31], a[144:147], v[32:35], v[16:31]
  ds_read_b128 v[44:47], v1 offset:39936
  s_waitcnt lgkmcnt(2)
  v_mfma_f32_32x32x16_bf16 v[16:31], a[148:151], v[36:39], v[16:31]
  ds_read_b128 v[32:35], v1 offset:49152
  s_waitcnt lgkmcnt(2)
  v_mfma_f32_32x32x16_bf16 v[16:31], a[152:155], v[40:43], v[16:31]
  ds_read_b128 v[36:39], v1 offset:50176
  s_waitcnt lgkmcnt(2)
  v_mfma_f32_32x32x16_bf16 v[16:31], a[156:159], v[44:47], v[16:31]
  ds_read_b128 v[40:43], v1 offset:51200
  s_waitcnt lgkmcnt(2)
  v_mfma_f32_32x32x16_bf16 v[16:31], a[192:195], v[32:35], v[16:31]
  ds_read_b128 v[44:47], v1 offset:52224
  s_waitcnt lgkmcnt(2)
  v_mfma_f32_32x32x16_bf16 v[16:31], a[196:199], v[36:39], v[16:31]
  ds_read_b128 v[32:35], v1 offset:53248
  s_waitcnt lgkmcnt(2)
  v_mfma_f32_32x32x16_bf16 v[16:31], a[200:203], v[40:43], v[16:31]
  ds_read_b128 v[36:39], v1 offset:54272
  s_waitcnt lgkmcnt(2)
  v_mfma_f32_32x32x16_bf16 v[16:31], a[204:207], v[44:47], v[16:31]
  ds_read_b128 v[40:43], v1 offset:55296
  s_waitcnt lgkmcnt(2)
  v_mfma_f32_32x32x16_bf16 v[16:31], a[208:211], v[32:35], v[16:31]
  ds_read_b128 v[44:47], v1 offset:56320
  s_waitcnt lgkmcnt(2)
  v_mfma_f32_32x32x16_bf16 v[16:31], a[212:215], v[36:39], v[16:31]
  s_waitcnt lgkmcnt(1)
  v_mfma_f32_32x32x16_bf16 v[16:31], a[216:219], v[40:43], v[16:31]
  s_waitcnt lgkmcnt(0)
  v_mfma_f32_32x32x16_bf16 v[16:31], a[220:223], v[44:47], v[16:31]
  s_waitcnt vmcnt(0)
  s_barrier
  ds_read_b128 v[32:35], v1 offset:8192
  ds_read_b128 v[36:39], v1 offset:9216
  ds_read_b128 v[40:43], v1 offset:10240
  s_mov_b32 s43, 0
  s_cmp_eq_u32 s32, 63
  s_cbranch_scc1 L_on_107
  v_cmp_gt_u32 vcc, s41, v4
  s_cbranch_vccnz L_on_107
  s_mov_b32 s43, 1
  s_waitcnt lgkmcnt(2)
  v_mfma_f32_32x32x16_bf16 v[16:31], a[32:35], v[32:35], v[16:31]
  ds_read_b128 v[44:47], v1 offset:11264
  s_sub_u32 s6, s41, 1
  s_lshl_b32 s6, s6, 18
  s_add_u32 s44, s36, s6
  s_waitcnt lgkmcnt(2)
  v_mfma_f32_32x32x16_bf16 v[16:31], a[36:39], v[36:39], v[16:31]
  ds_read_b128 v[32:35], v1 offset:12288
  s_add_u32 m0, s42, 0
  s_add_u32 s45, s44, 0
  buffer_load_dwordx4 v0, s[8:11], s45 offen offset:0 lds
  s_waitcnt lgkmcnt(2)
  v_mfma_f32_32x32x16_bf16 v[16:31], a[40:43], v[40:43], v[16:31]
  ds_read_b128 v[36:39], v1 offset:13312
  buffer_load_dwordx4 v0, s[8:11], s45 offen offset:1024 lds
  s_waitcnt lgkmcnt(2)
  v_mfma_f32_32x32x16_bf16 v[16:31], a[44:47], v[44:47], v[16:31]
  ds_read_b128 v[40:43], v1 offset:14336
  buffer_load_dwordx4 v0, s[8:11], s45 offen offset:2048 lds
  s_waitcnt lgkmcnt(2)
  v_mfma_f32_32x32x16_bf16 v[16:31], a[48:51], v[32:35], v[16:31]
  ds_read_b128 v[44:47], v1 offset:15360
  buffer_load_dwordx4 v0, s[8:11], s45 offen offset:3072 lds
  s_waitcnt lgkmcnt(2)
  v_mfma_f32_32x32x16_bf16 v[16:31], a[52:55], v[36:39], v[16:31]
  ds_read_b128 v[32:35], v1 offset:24576
  s_waitcnt lgkmcnt(2)
  v_mfma_f32_32x32x16_bf16 v[16:31], a[56:59], v[40:43], v[16:31]
  ds_read_b128 v[36:39], v1 offset:25600
  s_add_u32 m0, s42, 4096
  s_add_u32 s45, s44, 4096
  buffer_load_dwordx4 v0, s[8:11], s45 offen offset:0 lds
  s_waitcnt lgkmcnt(2)
  v_mfma_f32_32x32x16_bf16 v[16:31], a[60:63], v[44:47], v[16:31]
  ds_read_b128 v[40:43], v1 offset:26624
  s_waitcnt lgkmcnt(2)
  v_mfma_f32_32x32x16_bf16 v[16:31], a[96:99], v[32:35], v[16:31]
  ds_read_b128 v[44:47], v1 offset:27648
  buffer_load_dwordx4 v0, s[8:11], s45 offen offset:1024 lds
  s_waitcnt lgkmcnt(2)
  v_mfma_f32_32x32x16_bf16 v[16:31], a[100:103], v[36:39], v[16:31]
  ds_read_b128 v[32:35], v1 offset:28672
  s_waitcnt lgkmcnt(2)
  v_mfma_f32_32x32x16_bf16 v[16:31], a[104:107], v[40:43], v[16:31]
  ds_read_b128 v[36:39], v1 offset:29696
  buffer_load_dwordx4 v0, s[8:11], s45 offen offset:2048 lds
  s_waitcnt lgkmcnt(2)
  v_mfma_f32_32x32x16_bf16 v[16:31], a[108:111], v[44:47], v[16:31]
  ds_read_b128 v[40:43], v1 offset:30720
  s_waitcnt lgkmcnt(2)
  v_mfma_f32_32x32x16_bf16 v[16:31], a[112:115], v[32:35], v[16:31]
  ds_read_b128 v[44:47], v1 offset:31744
  buffer_load_dwordx4 v0, s[8:11], s45 offen offset:3072 lds
  s_waitcnt lgkmcnt(2)
  v_mfma_f32_32x32x16_bf16 v[16:31], a[116:119], v[36:39], v[16:31]
  ds_read_b128 v[32:35], v1 offset:40960
  s_waitcnt lgkmcnt(2)
  v_mfma_f32_32x32x16_bf16 v[16:31], a[120:123], v[40:43], v[16:31]
  ds_read_b128 v[36:39], v1 offset:41984
  s_add_u32 m0, s42, 8192
  s_add_u32 s45, s44, 8192
  buffer_load_dwordx4 v0, s[8:11], s45 offen offset:0 lds
  s_waitcnt lgkmcnt(2)
  v_mfma_f32_32x32x16_bf16 v[16:31], a[124:127], v[44:47], v[16:31]
  ds_read_b128 v[40:43], v1 offset:43008
  s_waitcnt lgkmcnt(2)
  v_mfma_f32_32x32x16_bf16 v[16:31], a[160:163], v[32:35], v[16:31]
  ds_read_b128 v[44:47], v1 offset:44032
  buffer_load_dwordx4 v0, s[8:11], s45 offen offset:1024 lds
  s_waitcnt lgkmcnt(2)
  v_mfma_f32_32x32x16_bf16 v[16:31], a[164:167], v[36:39], v[16:31]
  ds_read_b128 v[32:35], v1 offset:45056
  s_waitcnt lgkmcnt(2)
  v_mfma_f32_32x32x16_bf16 v[16:31], a[168:171], v[40:43], v[16:31]
  ds_read_b128 v[36:39], v1 offset:46080
  buffer_load_dwordx4 v0, s[8:11], s45 offen offset:2048 lds
  s_waitcnt lgkmcnt(2)
  v_mfma_f32_32x32x16_bf16 v[16:31], a[172:175], v[44:47], v[16:31]
  ds_read_b128 v[40:43], v1 offset:47104
  s_waitcnt lgkmcnt(2)
  v_mfma_f32_32x32x16_bf16 v[16:31], a[176:179], v[32:35], v[16:31]
  ds_read_b128 v[44:47], v1 offset:48128
  buffer_load_dwordx4 v0, s[8:11], s45 offen offset:3072 lds
  s_waitcnt lgkmcnt(2)
  v_mfma_f32_32x32x16_bf16 v[16:31], a[180:183], v[36:39], v[16:31]
  ds_read_b128 v[32:35], v1 offset:57344
  s_waitcnt lgkmcnt(2)
  v_mfma_f32_32x32x16_bf16 v[16:31], a[184:187], v[40:43], v[16:31]
  ds_read_b128 v[36:39], v1 offset:58368
  s_add_u32 m0, s42, 12288
  s_add_u32 s45, s44, 12288
  buffer_load_dwordx4 v0, s[8:11], s45 offen offset:0 lds
  s_waitcnt lgkmcnt(2)
  v_mfma_f32_32x32x16_bf16 v[16:31], a[188:191], v[44:47], v[16:31]
  ds_read_b128 v[40:43], v1 offset:59392
  s_waitcnt lgkmcnt(2)
  v_mfma_f32_32x32x16_bf16 v[16:31], a[224:227], v[32:35], v[16:31]
  ds_read_b128 v[44:47], v1 offset:60416
  buffer_load_dwordx4 v0, s[8:11], s45 offen offset:1024 lds
  s_waitcnt lgkmcnt(2)
  v_mfma_f32_32x32x16_bf16 v[16:31], a[228:231], v[36:39], v[16:31]
  ds_read_b128 v[32:35], v1 offset:61440
  s_waitcnt lgkmcnt(2)
  v_mfma_f32_32x32x16_bf16 v[16:31], a[232:235], v[40:43], v[16:31]
  ds_read_b128 v[36:39], v1 offset:62464
  buffer_load_dwordx4 v0, s[8:11], s45 offen offset:2048 lds
  s_waitcnt lgkmcnt(2)
  v_mfma_f32_32x32x16_bf16 v[16:31], a[236:239], v[44:47], v[16:31]
  ds_read_b128 v[40:43], v1 offset:63488
  s_waitcnt lgkmcnt(2)
  v_mfma_f32_32x32x16_bf16 v[16:31], a[240:243], v[32:35], v[16:31]
  ds_read_b128 v[44:47], v1 offset:64512
  buffer_load_dwordx4 v0, s[8:11], s45 offen offset:3072 lds
  s_waitcnt lgkmcnt(2)
  v_mfma_f32_32x32x16_bf16 v[16:31], a[244:247], v[36:39], v[16:31]
  s_waitcnt lgkmcnt(1)
  v_mfma_f32_32x32x16_bf16 v[16:31], a[248:251], v[40:43], v[16:31]
  s_xor_b32 s42, s42, 0x10000
  s_waitcnt lgkmcnt(0)
  v_mfma_f32_32x32x16_bf16 v[16:31], a[252:255], v[44:47], v[16:31]
  s_branch L_o_h2
L_on_107:
  s_waitcnt lgkmcnt(2)
  v_mfma_f32_32x32x16_bf16 v[16:31], a[32:35], v[32:35], v[16:31]
  ds_read_b128 v[44:47], v1 offset:11264
  s_waitcnt lgkmcnt(2)
  v_mfma_f32_32x32x16_bf16 v[16:31], a[36:39], v[36:39], v[16:31]
  ds_read_b128 v[32:35], v1 offset:12288
  s_waitcnt lgkmcnt(2)
  v_mfma_f32_32x32x16_bf16 v[16:31], a[40:43], v[40:43], v[16:31]
  ds_read_b128 v[36:39], v1 offset:13312
  s_waitcnt lgkmcnt(2)
  v_mfma_f32_32x32x16_bf16 v[16:31], a[44:47], v[44:47], v[16:31]
  ds_read_b128 v[40:43], v1 offset:14336
  s_waitcnt lgkmcnt(2)
  v_mfma_f32_32x32x16_bf16 v[16:31], a[48:51], v[32:35], v[16:31]
  ds_read_b128 v[44:47], v1 offset:15360
  buffer_load_dword v4, v2, s[8:11], s40 offen sc1
  s_waitcnt lgkmcnt(2)
  v_mfma_f32_32x32x16_bf16 v[16:31], a[52:55], v[36:39], v[16:31]
  ds_read_b128 v[32:35], v1 offset:24576
  s_waitcnt lgkmcnt(2)
  v_mfma_f32_32x32x16_bf16 v[16:31], a[56:59], v[40:43], v[16:31]
  ds_read_b128 v[36:39], v1 offset:25600
  s_waitcnt lgkmcnt(2)
  v_mfma_f32_32x32x16_bf16 v[16:31], a[60:63], v[44:47], v[16:31]
  ds_read_b128 v[40:43], v1 offset:26624
  s_waitcnt lgkmcnt(2)
  v_mfma_f32_32x32x16_bf16 v[16:31], a[96:99], v[32:35], v[16:31]
  ds_read_b128 v[44:47], v1 offset:27648
  s_waitcnt lgkmcnt(2)
  v_mfma_f32_32x32x16_bf16 v[16:31], a[100:103], v[36:39], v[16:31]
  ds_read_b128 v[32:35], v1 offset:28672
  s_waitcnt lgkmcnt(2)
  v_mfma_f32_32x32x16_bf16 v[16:31], a[104:107], v[40:43], v[16:31]
  ds_read_b128 v[36:39], v1 offset:29696
  s_waitcnt lgkmcnt(2)
  v_mfma_f32_32x32x16_bf16 v[16:31], a[108:111], v[44:47], v[16:31]
  ds_read_b128 v[40:43], v1 offset:30720
  s_waitcnt lgkmcnt(2)
  v_mfma_f32_32x32x16_bf16 v[16:31], a[112:115], v[32:35], v[16:31]
  ds_read_b128 v[44:47], v1 offset:31744
  s_waitcnt lgkmcnt(2)
  v_mfma_f32_32x32x16_bf16 v[16:31], a[116:119], v[36:39], v[16:31]
  ds_read_b128 v[32:35], v1 offset:40960
  s_waitcnt lgkmcnt(2)
  v_mfma_f32_32x32x16_bf16 v[16:31], a[120:123], v[40:43], v[16:31]
  ds_read_b128 v[36:39], v1 offset:41984
  s_waitcnt lgkmcnt(2)
  v_mfma_f32_32x32x16_bf16 v[16:31], a[124:127], v[44:47], v[16:31]
  ds_read_b128 v[40:43], v1 offset:43008
  s_waitcnt lgkmcnt(2)
  v_mfma_f32_32x32x16_bf16 v[16:31], a[160:163], v[32:35], v[16:31]
  ds_read_b128 v[44:47], v1 offset:44032
  s_waitcnt lgkmcnt(2)
  v_mfma_f32_32x32x16_bf16 v[16:31], a[164:167], v[36:39], v[16:31]
  ds_read_b128 v[32:35], v1 offset:45056
  s_waitcnt lgkmcnt(2)
  v_mfma_f32_32x32x16_bf16 v[16:31], a[168:171], v[40:43], v[16:31]
  ds_read_b128 v[36:39], v1 offset:46080
  s_waitcnt lgkmcnt(2)
  v_mfma_f32_32x32x16_bf16 v[16:31], a[172:175], v[44:47], v[16:31]
  ds_read_b128 v[40:43], v1 offset:47104
  s_waitcnt lgkmcnt(2)
  v_mfma_f32_32x32x16_bf16 v[16:31], a[176:179], v[32:35], v[16:31]
  ds_read_b128 v[44:47], v1 offset:48128
  s_waitcnt lgkmcnt(2)
  v_mfma_f32_32x32x16_bf16 v[16:31], a[180:183], v[36:39], v[16:31]
  ds_read_b128 v[32:35], v1 offset:57344
  s_waitcnt lgkmcnt(2)
  v_mfma_f32_32x32x16_bf16 v[16:31], a[184:187], v[40:43], v[16:31]
  ds_read_b128 v[36:39], v1 offset:58368
  s_waitcnt lgkmcnt(2)
  v_mfma_f32_32x32x16_bf16 v[16:31], a[188:191], v[44:47], v[16:31]
  ds_read_b128 v[40:43], v1 offset:59392
  s_waitcnt lgkmcnt(2)
  v_mfma_f32_32x32x16_bf16 v[16:31], a[224:227], v[32:35], v[16:31]
  ds_read_b128 v[44:47], v1 offset:60416
  s_waitcnt lgkmcnt(2)
  v_mfma_f32_32x32x16_bf16 v[16:31], a[228:231], v[36:39], v[16:31]
  ds_read_b128 v[32:35], v1 offset:61440
  s_waitcnt lgkmcnt(2)
  v_mfma_f32_32x32x16_bf16 v[16:31], a[232:235], v[40:43], v[16:31]
  ds_read_b128 v[36:39], v1 offset:62464
  s_waitcnt lgkmcnt(2)
  v_mfma_f32_32x32x16_bf16 v[16:31], a[236:239], v[44:47], v[16:31]
  ds_read_b128 v[40:43], v1 offset:63488
  s_waitcnt lgkmcnt(2)
  v_mfma_f32_32x32x16_bf16 v[16:31], a[240:243], v[32:35], v[16:31]
  ds_read_b128 v[44:47], v1 offset:64512
  s_waitcnt lgkmcnt(2)
  v_mfma_f32_32x32x16_bf16 v[16:31], a[244:247], v[36:39], v[16:31]
  s_waitcnt lgkmcnt(1)
  v_mfma_f32_32x32x16_bf16 v[16:31], a[248:251], v[40:43], v[16:31]
  s_waitcnt lgkmcnt(0)
  v_mfma_f32_32x32x16_bf16 v[16:31], a[252:255], v[44:47], v[16:31]
L_o_h2:
  s_sub_u32 s45, s32, 3
  v_cmp_gt_i32 vcc, s45, v5
  s_cbranch_vccz L_o_free
  s_mov_b32 s7, 0
L_o_bp:
  buffer_load_dword v5, v6, s[8:11], s39 offen sc1
  s_waitcnt vmcnt(0)
  v_cmp_gt_i32 vcc, s45, v5
  s_cbranch_vccz L_o_free
  s_add_u32 s7, s7, 1
  s_cmp_lt_u32 s7, 131072
  s_cbranch_scc1 L_o_bp
  s_mov_b32 s6, 32
  s_branch L_err
L_o_free:
  s_and_b32 s6, s32, 3
  s_lshl_b32 s6, s6, 17
  s_add_u32 s44, s37, s6
  s_lshr_b32 s6, s32, 2
  s_andn2_b32 s45, 1, s6
  s_add_u32 s32, s32, 1
  v_xor_b32 v1, 0x10000, v1
  s_nop 1
  v_cvt_pk_bf16_f32 v48, v16, v17
  v_cvt_pk_bf16_f32 v49, v18, v19
  v_cvt_pk_bf16_f32 v50, v20, v21
  v_cvt_pk_bf16_f32 v51, v22, v23
  v_bfi_b32 v48, 1, s45, v48
  buffer_store_dwordx4 v[48:51], v0, s[8:11], s44 offen offset:0 sc1
  v_cvt_pk_bf16_f32 v52, v24, v25
  v_cvt_pk_bf16_f32 v53, v26, v27
  v_cvt_pk_bf16_f32 v54, v28, v29
  v_cvt_pk_bf16_f32 v55, v30, v31
  v_bfi_b32 v52, 1, s45, v52
  buffer_store_dwordx4 v[52:55], v0, s[8:11], s44 offen offset:1024 sc1
  s_cmp_eq_u32 s43, 0
  s_waitcnt vmcnt(10)
  s_cbranch_scc0 L_o_loop
  s_cmp_eq_u32 s32, 64
  s_cbranch_scc1 L_o_end
  s_waitcnt vmcnt(2)
  v_cmp_gt_u32 vcc, s41, v4
  s_cbranch_vccz L_o_go
  s_branch L_o_wait
L_o_end:
  s_waitcnt vmcnt(0)
  s_endpgm
L_pro:
  s_max_u32 s6, s4, 3
  s_sub_u32 s6, s6, 3
  s_lshl_b32 s6, s6, 5
  s_add_u32 s6, s6, s5
  s_lshl_b32 s62, s6, 15
  s_lshl_b32 s6, s6, 2
  s_add_u32 s60, s6, s3
  s_lshl_b32 s6, s60, 2
  s_add_u32 s6, s6, 0x710000
  v_mov_b32 v1, 0
  v_lshlrev_b32 v2, 4, v0
  s_mov_b64 exec, 1
  buffer_store_dword v1, v1, s[8:11], s6 offen sc1
  s_mov_b64 exec, -1
  v_lshlrev_b32 v16, 2, v0
  s_lshl_b32 s6, s60, 8
  s_lshl_b32 s7, s60, 1
  s_mov_b32 s16, s66
  s_mov_b32 s17, s67
  s_mov_b32 s18, 0x20000
  s_mov_b32 s19, 0x20000
  buffer_load_dword v20, v16, s[16:19], s6 offen
  s_mov_b32 s20, s68
  s_mov_b32 s21, s69
  s_mov_b32 s22, 0x20000
  s_mov_b32 s23, 0x20000
  buffer_load_dword v21, v16, s[20:23], s6 offen
  s_mov_b32 s24, s70
  s_mov_b32 s25, s71
  s_mov_b32 s26, 0x20000
  s_mov_b32 s27, 0x20000
  buffer_load_dword v22, v16, s[24:27], s6 offen
  s_mov_b32 s28, s72
  s_mov_b32 s29, s73
  s_mov_b32 s30, 0x20000
  s_mov_b32 s31, 0x20000
  buffer_load_dword v23, v16, s[28:31], s6 offen
  s_mov_b32 s16, s74
  s_mov_b32 s17, s75
  s_mov_b32 s18, 0x400
  s_mov_b32 s19, 0x20000
  buffer_load_ushort v24, v1, s[16:19], s7 offen
  s_mov_b32 s20, s76
  s_mov_b32 s21, s77
  s_mov_b32 s22, 0x400
  s_mov_b32 s23, 0x20000
  buffer_load_ushort v232, v1, s[20:23], s7 offen
  s_waitcnt vmcnt(6)
  s_barrier
  s_cmp_lg_u32 s3, 0
  s_cbranch_scc1 L_sd_108
  s_mov_b64 exec, 1
  s_and_b32 s6, s4, 3
  s_lshl_b32 s6, s6, 6
  v_mov_b32 v18, 16
  v_mov_b32 v19, 1
  buffer_atomic_add v19, v18, s[12:15], s6 offen sc1
  s_mov_b64 exec, -1
L_sd_108:
  v_and_b32 v16, 15, v0
  v_and_b32 v17, 7, v16
  v_lshrrev_b32 v18, 3, v16
  v_lshl_add_u32 v19, v18, 7, v17
  v_add_u32 v19, 1, v19
  v_cvt_f32_u32 v4, v19
  v_and_b32 v19, 3, v16
  v_lshrrev_b32 v25, 2, v16
  v_lshlrev_b32 v25, 6, v25
  v_add_u32 v19, v19, v25
  v_lshlrev_b32 v19, 1, v19
  v_add_u32 v19, 258, v19
  v_cmp_gt_u32 vcc, 8, v16
  s_nop 1
  v_cndmask_b32 v19, 0, v19, vcc
  v_cvt_f32_u32 v5, v19
  v_and_b32 v19, 1, v16
  v_lshrrev_b32 v25, 1, v17
  v_lshlrev_b32 v25, 7, v25
  v_lshl_add_u32 v19, v19, 2, v25
  v_add_u32 v19, 516, v19
  v_lshlrev_b32 v25, 7, v17
  v_add_u32 v25, 1032, v25
  v_cndmask_b32 v19, v25, v19, vcc
  v_cvt_f32_u32 v6, v19
  v_lshlrev_b32 v19, 3, v16
  v_cvt_f32_u32 v7, v19
  v_lshrrev_b32 v19, 4, v0
  s_lshl_b32 s6, s3, 11
  v_lshl_add_u32 v3, v19, 6, s6
  v_lshlrev_b32 v16, 4, v0
  v_cvt_f32_u32 v16, v16
  s_mul_i32 s63, s3, 4352
  s_add_u32 s63, s63, 8192
  v_sub_f32 v17, 0x45800000, v16
  v_sub_f32 v18, 0x457fe000, v16
  v_cvt_pk_bf16_f32 v17, v17, v18
  v_lshlrev_b32 v160, 16, v17
  v_and_b32 v161, 0xffff0000, v17
  v_cvt_u32_f32 v160, v160
  v_cvt_u32_f32 v161, v161
  v_add_u32 v160, s63, v160
  v_add_u32 v161, s63, v161
  v_sub_f32 v17, 0x457fc000, v16
  v_sub_f32 v18, 0x457fa000, v16
  v_cvt_pk_bf16_f32 v17, v17, v18
  v_lshlrev_b32 v162, 16, v17
  v_and_b32 v163, 0xffff0000, v17
  v_cvt_u32_f32 v162, v162
  v_cvt_u32_f32 v163, v163
  v_add_u32 v162, s63, v162
  v_add_u32 v163, s63, v163
  v_sub_f32 v17, 0x457f8000, v16
  v_sub_f32 v18, 0x457f6000, v16
  v_cvt_pk_bf16_f32 v17, v17, v18
  v_lshlrev_b32 v164, 16, v17
  v_and_b32 v165, 0xffff0000, v17
  v_cvt_u32_f32 v164, v164
  v_cvt_u32_f32 v165, v165
  v_add_u32 v164, s63, v164
  v_add_u32 v165, s63, v165
  v_sub_f32 v17, 0x457f4000, v16
  v_sub_f32 v18, 0x457f2000, v16
  v_cvt_pk_bf16_f32 v17, v17, v18
  v_lshlrev_b32 v166, 16, v17
  v_and_b32 v167, 0xffff0000, v17
  v_cvt_u32_f32 v166, v166
  v_cvt_u32_f32 v167, v167
  v_add_u32 v166, s63, v166
  v_add_u32 v167, s63, v167
  v_sub_f32 v17, 0x45400000, v16
  v_sub_f32 v18, 0x453fe000, v16
  v_cvt_pk_bf16_f32 v17, v17, v18
  v_lshlrev_b32 v168, 16, v17
  v_and_b32 v169, 0xffff0000, v17
  v_cvt_u32_f32 v168, v168
  v_cvt_u32_f32 v169, v169
  v_add_u32 v168, s63, v168
  v_add_u32 v169, s63, v169
  v_sub_f32 v17, 0x453fc000, v16
  v_sub_f32 v18, 0x453fa000, v16
  v_cvt_pk_bf16_f32 v17, v17, v18
  v_lshlrev_b32 v170, 16, v17
  v_and_b32 v171, 0xffff0000, v17
  v_cvt_u32_f32 v170, v170
  v_cvt_u32_f32 v171, v171
  v_add_u32 v170, s63, v170
  v_add_u32 v171, s63, v171
  v_sub_f32 v17, 0x453f8000, v16
  v_sub_f32 v18, 0x453f6000, v16
  v_cvt_pk_bf16_f32 v17, v17, v18
  v_lshlrev_b32 v172, 16, v17
  v_and_b32 v173, 0xffff0000, v17
  v_cvt_u32_f32 v172, v172
  v_cvt_u32_f32 v173, v173
  v_add_u32 v172, s63, v172
  v_add_u32 v173, s63, v173
  v_sub_f32 v17, 0x453f4000, v16
  v_sub_f32 v18, 0x453f2000, v16
  v_cvt_pk_bf16_f32 v17, v17, v18
  v_lshlrev_b32 v174, 16, v17
  v_and_b32 v175, 0xffff0000, v17
  v_cvt_u32_f32 v174, v174
  v_cvt_u32_f32 v175, v175
  v_add_u32 v174, s63, v174
  v_add_u32 v175, s63, v175
  v_sub_f32 v17, 0x45000000, v16
  v_sub_f32 v18, 0x44ffc000, v16
  v_cvt_pk_bf16_f32 v17, v17, v18
  v_lshlrev_b32 v176, 16, v17
  v_and_b32 v177, 0xffff0000, v17
  v_cvt_u32_f32 v176, v176
  v_cvt_u32_f32 v177, v177
  v_add_u32 v176, s63, v176
  v_add_u32 v177, s63, v177
  v_sub_f32 v17, 0x44ff8000, v16
  v_sub_f32 v18, 0x44ff4000, v16
  v_cvt_pk_bf16_f32 v17, v17, v18
  v_lshlrev_b32 v178, 16, v17
  v_and_b32 v179, 0xffff0000, v17
  v_cvt_u32_f32 v178, v178
  v_cvt_u32_f32 v179, v179
  v_add_u32 v178, s63, v178
  v_add_u32 v179, s63, v179
  v_sub_f32 v17, 0x44ff0000, v16
  v_sub_f32 v18, 0x44fec000, v16
  v_cvt_pk_bf16_f32 v17, v17, v18
  v_lshlrev_b32 v180, 16, v17
  v_and_b32 v181, 0xffff0000, v17
  v_cvt_u32_f32 v180, v180
  v_cvt_u32_f32 v181, v181
  v_add_u32 v180, s63, v180
  v_add_u32 v181, s63, v181
  v_sub_f32 v17, 0x44fe8000, v16
  v_sub_f32 v18, 0x44fe4000, v16
  v_cvt_pk_bf16_f32 v17, v17, v18
  v_lshlrev_b32 v182, 16, v17
  v_and_b32 v183, 0xffff0000, v17
  v_cvt_u32_f32 v182, v182
  v_cvt_u32_f32 v183, v183
  v_add_u32 v182, s63, v182
  v_add_u32 v183, s63, v183
  v_sub_f32 v17, 0x44800000, v16
  v_sub_f32 v18, 0x447f8000, v16
  v_cvt_pk_bf16_f32 v17, v17, v18
  v_lshlrev_b32 v184, 16, v17
  v_and_b32 v185, 0xffff0000, v17
  v_cvt_u32_f32 v184, v184
  v_cvt_u32_f32 v185, v185
  v_add_u32 v184, s63, v184
  v_add_u32 v185, s63, v185
  v_sub_f32 v17, 0x447f0000, v16
  v_sub_f32 v18, 0x447e8000, v16
  v_cvt_pk_bf16_f32 v17, v17, v18
  v_lshlrev_b32 v186, 16, v17
  v_and_b32 v187, 0xffff0000, v17
  v_cvt_u32_f32 v186, v186
  v_cvt_u32_f32 v187, v187
  v_add_u32 v186, s63, v186
  v_add_u32 v187, s63, v187
  v_sub_f32 v17, 0x447e0000, v16
  v_sub_f32 v18, 0x447d8000, v16
  v_cvt_pk_bf16_f32 v17, v17, v18
  v_lshlrev_b32 v188, 16, v17
  v_and_b32 v189, 0xffff0000, v17
  v_cvt_u32_f32 v188, v188
  v_cvt_u32_f32 v189, v189
  v_add_u32 v188, s63, v188
  v_add_u32 v189, s63, v189
  v_sub_f32 v17, 0x447d0000, v16
  v_sub_f32 v18, 0x447c8000, v16
  v_cvt_pk_bf16_f32 v17, v17, v18
  v_lshlrev_b32 v190, 16, v17
  v_and_b32 v191, 0xffff0000, v17
  v_cvt_u32_f32 v190, v190
  v_cvt_u32_f32 v191, v191
  v_add_u32 v190, s63, v190
  v_add_u32 v191, s63, v191
  s_waitcnt vmcnt(1)
  v_lshlrev_b32 v24, 16, v24
  v_mul_f32 v26, 0x3fb8aa3b, v24
  v_mov_b32 v27, 0x3fb8aa3b
  v_fma_f32 v27, v24, v27, -v26
  v_fmac_f32 v27, 0x32a57060, v24
  v_exp_f32 v26, v26
  v_mul_f32 v27, 0x3f317218, v27
  v_fma_f32 v24, v26, v27, v26
  v_cvt_pk_bf16_f32 v24, v24, v24
  v_and_b32 v24, 0xffff0000, v24
  v_lshlrev_b32 v32, 16, v20
  v_and_b32 v36, 0xffff0000, v20
  v_lshlrev_b32 v33, 16, v21
  v_and_b32 v37, 0xffff0000, v21
  v_lshlrev_b32 v34, 16, v22
  v_and_b32 v38, 0xffff0000, v22
  v_lshlrev_b32 v35, 16, v23
  v_and_b32 v39, 0xffff0000, v23
  v_max3_f32 v28, |v34|, |v35|, |v38|
  v_max_f32 v28, |v39|, v28
  s_nop 1
  v_max_f32_dpp v28, v28, v28 quad_perm:[1,0,3,2] row_mask:0xf bank_mask:0xf
  s_nop 1
  v_max_f32_dpp v28, v28, v28 quad_perm:[2,3,0,1] row_mask:0xf bank_mask:0xf
  s_nop 1
  v_max_f32_dpp v28, v28, v28 row_half_mirror row_mask:0xf bank_mask:0xf
  s_nop 1
  v_max_f32_dpp v28, v28, v28 row_mirror row_mask:0xf bank_mask:0xf
  v_mov_b32 v29, v28
  s_nop 1
  v_permlane16_swap_b32 v28, v29
  v_max_f32 v28, v28, v29
  v_mov_b32 v29, v28
  s_nop 1
  v_permlane32_swap_b32 v28, v29
  v_max_f32 v28, v28, v29
  v_frexp_exp_i32_f32 v28, v28
  v_sub_u32 v29, 0, v28
  v_mul_f32 v26, 0x3fb8aa3b, v32
  v_mov_b32 v27, 0x3fb8aa3b
  v_fma_f32 v27, v32, v27, -v26
  v_fmac_f32 v27, 0x32a57060, v32
  v_exp_f32 v26, v26
  v_mul_f32 v27, 0x3f317218, v27
  v_fma_f32 v32, v26, v27, v26
  v_cvt_pk_bf16_f32 v32, v32, v32
  v_and_b32 v32, 0xffff0000, v32
  v_mul_f32 v32, v32, v24
  v_mul_f32 v33, v33, v24
  v_ldexp_f32 v34, v34, v29
  v_ldexp_f32 v35, v35, v29
  v_mul_f32 v32, 0xbfb8aa3b, v32
  v_mul_f32 v33, 0x3e22f983, v33
  v_mul_f32 v26, 0x3fb8aa3b, v36
  v_mov_b32 v27, 0x3fb8aa3b
  v_fma_f32 v27, v36, v27, -v26
  v_fmac_f32 v27, 0x32a57060, v36
  v_exp_f32 v26, v26
  v_mul_f32 v27, 0x3f317218, v27
  v_fma_f32 v36, v26, v27, v26
  v_cvt_pk_bf16_f32 v36, v36, v36
  v_and_b32 v36, 0xffff0000, v36
  v_mul_f32 v36, v36, v24
  v_mul_f32 v37, v37, v24
  v_ldexp_f32 v38, v38, v29
  v_ldexp_f32 v39, v39, v29
  v_mul_f32 v36, 0xbfb8aa3b, v36
  v_mul_f32 v37, 0x3e22f983, v37
  v_add_f32 v24, v24, v24
  v_ldexp_f32 v233, v24, v28
  s_lshl_b32 s6, s3, 11
  v_lshl_add_u32 v16, v0, 5, s6
  ds_write_b128 v16, v[32:35] offset:0
  ds_write_b128 v16, v[36:39] offset:16
  ds_read_b128 v[8:11], v3 offset:0
  v_mov_b32 v48, 0
  v_mov_b32 v49, 0
  v_mov_b32 v50, 0
  v_mov_b32 v51, 0
  v_mov_b32 v52, 0
  v_mov_b32 v53, 0
  v_mov_b32 v54, 0
  v_mov_b32 v55, 0
  v_mov_b32 v56, 0
  v_mov_b32 v57, 0
  v_mov_b32 v58, 0
  v_mov_b32 v59, 0
  v_mov_b32 v16, 0
  v_mov_b32 v17, 0
  v_mov_b32 v18, 0
  v_mov_b32 v19, 0
  v_mov_b32 v20, 0
  v_mov_b32 v21, 0
  v_mov_b32 v22, 0
  v_mov_b32 v23, 0
  v_mov_b32 v24, 0
  v_mov_b32 v25, 0
  v_mov_b32 v26, 0
  v_mov_b32 v27, 0
  v_mov_b32 v28, 0
  v_mov_b32 v29, 0
  v_mov_b32 v30, 0
  v_mov_b32 v31, 0
  s_mov_b32 s6, 2
L_kg_109:
  s_waitcnt lgkmcnt(0)
  ds_read_b128 v[12:15], v3 offset:16
  v_mfma_f32_16x16x32_f16 v[48:51], v[16:19], v[28:31], v[48:51]
  v_pk_mul_f32 v[38:39], v[8:9], v[6:7] op_sel:[0,1] op_sel_hi:[1,1]
  v_mfma_f32_16x16x32_f16 v[52:55], v[20:23], v[28:31], v[52:55]
  v_pk_mul_f32 v[32:33], v[8:9], v[4:5] op_sel:[0,0] op_sel_hi:[1,0]
  v_mfma_f32_16x16x32_f16 v[56:59], v[24:27], v[28:31], v[56:59]
  v_pk_mul_f32 v[34:35], v[8:9], v[4:5] op_sel:[0,1] op_sel_hi:[1,1]
  v_pk_mul_f32 v[36:37], v[8:9], v[6:7] op_sel:[0,0] op_sel_hi:[1,0]
  v_fract_f32 v39, v39
  v_fract_f32 v33, v33
  v_fract_f32 v35, v35
  v_fract_f32 v37, v37
  v_exp_f32 v38, v38
  v_cos_f32 v46, v39
  v_sin_f32 v47, v39
  v_exp_f32 v32, v32
  v_cos_f32 v40, v33
  v_sin_f32 v41, v33
  v_exp_f32 v34, v34
  v_cos_f32 v42, v35
  v_sin_f32 v43, v35
  v_exp_f32 v36, v36
  v_cos_f32 v44, v37
  v_sin_f32 v45, v37
  v_pk_mul_f32 v[46:47], v[46:47], v[38:39] op_sel_hi:[1,0]
  v_pk_mul_f32 v[40:41], v[40:41], v[32:33] op_sel_hi:[1,0]
  v_pk_mul_f32 v[42:43], v[42:43], v[34:35] op_sel_hi:[1,0]
  v_pk_mul_f32 v[44:45], v[44:45], v[36:37] op_sel_hi:[1,0]
  v_pk_mul_f32 v[32:33], v[46:47], v[10:11] op_sel_hi:[1,0] neg_hi:[1,0]
  v_cvt_pk_f16_f32 v16, v40, v41
  v_pk_fma_f32 v[32:33], v[46:47], v[10:11], v[32:33] op_sel:[1,1,0] op_sel_hi:[0,1,1] neg_lo:[1,0,0] neg_hi:[1,0,0]
  v_cvt_pk_f16_f32 v20, v42, v43
  v_cvt_pk_f16_f32 v24, v44, v45
  v_cvt_pk_f16_f32 v28, v32, v33
  s_waitcnt lgkmcnt(0)
  ds_read_b128 v[8:11], v3 offset:32
  v_pk_mul_f32 v[38:39], v[12:13], v[6:7] op_sel:[0,1] op_sel_hi:[1,1]
  v_pk_mul_f32 v[32:33], v[12:13], v[4:5] op_sel:[0,0] op_sel_hi:[1,0]
  v_pk_mul_f32 v[34:35], v[12:13], v[4:5] op_sel:[0,1] op_sel_hi:[1,1]
  v_pk_mul_f32 v[36:37], v[12:13], v[6:7] op_sel:[0,0] op_sel_hi:[1,0]
  v_fract_f32 v39, v39
  v_fract_f32 v33, v33
  v_fract_f32 v35, v35
  v_fract_f32 v37, v37
  v_exp_f32 v38, v38
  v_cos_f32 v46, v39
  v_sin_f32 v47, v39
  v_exp_f32 v32, v32
  v_cos_f32 v40, v33
  v_sin_f32 v41, v33
  v_exp_f32 v34, v34
  v_cos_f32 v42, v35
  v_sin_f32 v43, v35
  v_exp_f32 v36, v36
  v_cos_f32 v44, v37
  v_sin_f32 v45, v37
  v_pk_mul_f32 v[46:47], v[46:47], v[38:39] op_sel_hi:[1,0]
  v_pk_mul_f32 v[40:41], v[40:41], v[32:33] op_sel_hi:[1,0]
  v_pk_mul_f32 v[42:43], v[42:43], v[34:35] op_sel_hi:[1,0]
  v_pk_mul_f32 v[44:45], v[44:45], v[36:37] op_sel_hi:[1,0]
  v_pk_mul_f32 v[32:33], v[46:47], v[14:15] op_sel_hi:[1,0] neg_hi:[1,0]
  v_cvt_pk_f16_f32 v17, v40, v41
  v_pk_fma_f32 v[32:33], v[46:47], v[14:15], v[32:33] op_sel:[1,1,0] op_sel_hi:[0,1,1] neg_lo:[1,0,0] neg_hi:[1,0,0]
  v_cvt_pk_f16_f32 v21, v42, v43
  v_cvt_pk_f16_f32 v25, v44, v45
  v_cvt_pk_f16_f32 v29, v32, v33
  s_waitcnt lgkmcnt(0)
  ds_read_b128 v[12:15], v3 offset:48
  v_pk_mul_f32 v[38:39], v[8:9], v[6:7] op_sel:[0,1] op_sel_hi:[1,1]
  v_pk_mul_f32 v[32:33], v[8:9], v[4:5] op_sel:[0,0] op_sel_hi:[1,0]
  v_pk_mul_f32 v[34:35], v[8:9], v[4:5] op_sel:[0,1] op_sel_hi:[1,1]
  v_pk_mul_f32 v[36:37], v[8:9], v[6:7] op_sel:[0,0] op_sel_hi:[1,0]
  v_fract_f32 v39, v39
  v_fract_f32 v33, v33
  v_fract_f32 v35, v35
  v_fract_f32 v37, v37
  v_exp_f32 v38, v38
  v_cos_f32 v46, v39
  v_sin_f32 v47, v39
  v_exp_f32 v32, v32
  v_cos_f32 v40, v33
  v_sin_f32 v41, v33
  v_exp_f32 v34, v34
  v_cos_f32 v42, v35
  v_sin_f32 v43, v35
  v_exp_f32 v36, v36
  v_cos_f32 v44, v37
  v_sin_f32 v45, v37
  v_pk_mul_f32 v[46:47], v[46:47], v[38:39] op_sel_hi:[1,0]
  v_pk_mul_f32 v[40:41], v[40:41], v[32:33] op_sel_hi:[1,0]
  v_pk_mul_f32 v[42:43], v[42:43], v[34:35] op_sel_hi:[1,0]
  v_pk_mul_f32 v[44:45], v[44:45], v[36:37] op_sel_hi:[1,0]
  v_pk_mul_f32 v[32:33], v[46:47], v[10:11] op_sel_hi:[1,0] neg_hi:[1,0]
  v_cvt_pk_f16_f32 v18, v40, v41
  v_pk_fma_f32 v[32:33], v[46:47], v[10:11], v[32:33] op_sel:[1,1,0] op_sel_hi:[0,1,1] neg_lo:[1,0,0] neg_hi:[1,0,0]
  v_cvt_pk_f16_f32 v22, v42, v43
  v_cvt_pk_f16_f32 v26, v44, v45
  v_cvt_pk_f16_f32 v30, v32, v33
  s_waitcnt lgkmcnt(0)
  ds_read_b128 v[8:11], v3 offset:256
  v_pk_mul_f32 v[38:39], v[12:13], v[6:7] op_sel:[0,1] op_sel_hi:[1,1]
  v_pk_mul_f32 v[32:33], v[12:13], v[4:5] op_sel:[0,0] op_sel_hi:[1,0]
  v_pk_mul_f32 v[34:35], v[12:13], v[4:5] op_sel:[0,1] op_sel_hi:[1,1]
  v_pk_mul_f32 v[36:37], v[12:13], v[6:7] op_sel:[0,0] op_sel_hi:[1,0]
  v_fract_f32 v39, v39
  v_fract_f32 v33, v33
  v_fract_f32 v35, v35
  v_fract_f32 v37, v37
  v_exp_f32 v38, v38
  v_cos_f32 v46, v39
  v_sin_f32 v47, v39
  v_exp_f32 v32, v32
  v_cos_f32 v40, v33
  v_sin_f32 v41, v33
  v_exp_f32 v34, v34
  v_cos_f32 v42, v35
  v_sin_f32 v43, v35
  v_exp_f32 v36, v36
  v_cos_f32 v44, v37
  v_sin_f32 v45, v37
  v_pk_mul_f32 v[46:47], v[46:47], v[38:39] op_sel_hi:[1,0]
  v_pk_mul_f32 v[40:41], v[40:41], v[32:33] op_sel_hi:[1,0]
  v_pk_mul_f32 v[42:43], v[42:43], v[34:35] op_sel_hi:[1,0]
  v_pk_mul_f32 v[44:45], v[44:45], v[36:37] op_sel_hi:[1,0]
  v_pk_mul_f32 v[32:33], v[46:47], v[14:15] op_sel_hi:[1,0] neg_hi:[1,0]
  v_cvt_pk_f16_f32 v19, v40, v41
  v_pk_fma_f32 v[32:33], v[46:47], v[14:15], v[32:33] op_sel:[1,1,0] op_sel_hi:[0,1,1] neg_lo:[1,0,0] neg_hi:[1,0,0]
  v_cvt_pk_f16_f32 v23, v42, v43
  v_cvt_pk_f16_f32 v27, v44, v45
  v_cvt_pk_f16_f32 v31, v32, v33
  v_add_u32 v3, 256, v3
  s_sub_u32 s6, s6, 1
  s_cmp_lg_u32 s6, 0
  s_cbranch_scc1 L_kg_109
  s_mov_b32 s6, 2
L_kg_110:
  s_waitcnt lgkmcnt(0)
  ds_read_b128 v[12:15], v3 offset:16
  v_mfma_f32_16x16x32_f16 v[48:51], v[16:19], v[28:31], v[48:51]
  v_pk_mul_f32 v[38:39], v[8:9], v[6:7] op_sel:[0,1] op_sel_hi:[1,1]
  v_mfma_f32_16x16x32_f16 v[52:55], v[20:23], v[28:31], v[52:55]
  v_pk_mul_f32 v[32:33], v[8:9], v[4:5] op_sel:[0,0] op_sel_hi:[1,0]
  v_mfma_f32_16x16x32_f16 v[56:59], v[24:27], v[28:31], v[56:59]
  v_pk_mul_f32 v[34:35], v[8:9], v[4:5] op_sel:[0,1] op_sel_hi:[1,1]
  v_pk_mul_f32 v[36:37], v[8:9], v[6:7] op_sel:[0,0] op_sel_hi:[1,0]
  v_fract_f32 v39, v39
  v_fract_f32 v33, v33
  v_fract_f32 v35, v35
  v_fract_f32 v37, v37
  v_exp_f32 v38, v38
  v_cos_f32 v46, v39
  v_sin_f32 v47, v39
  v_exp_f32 v32, v32
  v_cos_f32 v40, v33
  v_sin_f32 v41, v33
  v_exp_f32 v34, v34
  v_cos_f32 v42, v35
  v_sin_f32 v43, v35
  v_exp_f32 v36, v36
  v_cos_f32 v44, v37
  v_sin_f32 v45, v37
  v_pk_mul_f32 v[46:47], v[46:47], v[38:39] op_sel_hi:[1,0]
  v_pk_mul_f32 v[40:41], v[40:41], v[32:33] op_sel_hi:[1,0]
  v_pk_mul_f32 v[42:43], v[42:43], v[34:35] op_sel_hi:[1,0]
  v_pk_mul_f32 v[44:45], v[44:45], v[36:37] op_sel_hi:[1,0]
  v_pk_mul_f32 v[32:33], v[46:47], v[10:11] op_sel_hi:[1,0] neg_hi:[1,0]
  v_cvt_pk_f16_f32 v16, v40, v41
  v_pk_fma_f32 v[32:33], v[46:47], v[10:11], v[32:33] op_sel:[1,1,0] op_sel_hi:[0,1,1] neg_lo:[1,0,0] neg_hi:[1,0,0]
  v_cvt_pk_f16_f32 v20, v42, v43
  v_cvt_pk_f16_f32 v24, v44, v45
  v_cvt_pk_f16_f32 v28, v32, v33
  s_waitcnt lgkmcnt(0)
  ds_read_b128 v[8:11], v3 offset:32
  v_pk_mul_f32 v[38:39], v[12:13], v[6:7] op_sel:[0,1] op_sel_hi:[1,1]
  v_pk_mul_f32 v[32:33], v[12:13], v[4:5] op_sel:[0,0] op_sel_hi:[1,0]
  v_pk_mul_f32 v[34:35], v[12:13], v[4:5] op_sel:[0,1] op_sel_hi:[1,1]
  v_pk_mul_f32 v[36:37], v[12:13], v[6:7] op_sel:[0,0] op_sel_hi:[1,0]
  v_fract_f32 v39, v39
  v_fract_f32 v33, v33
  v_fract_f32 v35, v35
  v_fract_f32 v37, v37
  v_exp_f32 v38, v38
  v_cos_f32 v46, v39
  v_sin_f32 v47, v39
  v_exp_f32 v32, v32
  v_cos_f32 v40, v33
  v_sin_f32 v41, v33
  v_exp_f32 v34, v34
  v_cos_f32 v42, v35
  v_sin_f32 v43, v35
  v_exp_f32 v36, v36
  v_cos_f32 v44, v37
  v_sin_f32 v45, v37
  v_pk_mul_f32 v[46:47], v[46:47], v[38:39] op_sel_hi:[1,0]
  v_pk_mul_f32 v[40:41], v[40:41], v[32:33] op_sel_hi:[1,0]
  v_pk_mul_f32 v[42:43], v[42:43], v[34:35] op_sel_hi:[1,0]
  v_pk_mul_f32 v[44:45], v[44:45], v[36:37] op_sel_hi:[1,0]
  v_pk_mul_f32 v[32:33], v[46:47], v[14:15] op_sel_hi:[1,0] neg_hi:[1,0]
  v_cvt_pk_f16_f32 v17, v40, v41
  v_pk_fma_f32 v[32:33], v[46:47], v[14:15], v[32:33] op_sel:[1,1,0] op_sel_hi:[0,1,1] neg_lo:[1,0,0] neg_hi:[1,0,0]
  v_cvt_pk_f16_f32 v21, v42, v43
  v_cvt_pk_f16_f32 v25, v44, v45
  v_cvt_pk_f16_f32 v29, v32, v33
  s_waitcnt lgkmcnt(0)
  ds_read_b128 v[12:15], v3 offset:48
  v_pk_mul_f32 v[38:39], v[8:9], v[6:7] op_sel:[0,1] op_sel_hi:[1,1]
  v_pk_mul_f32 v[32:33], v[8:9], v[4:5] op_sel:[0,0] op_sel_hi:[1,0]
  v_pk_mul_f32 v[34:35], v[8:9], v[4:5] op_sel:[0,1] op_sel_hi:[1,1]
  v_pk_mul_f32 v[36:37], v[8:9], v[6:7] op_sel:[0,0] op_sel_hi:[1,0]
  v_fract_f32 v39, v39
  v_fract_f32 v33, v33
  v_fract_f32 v35, v35
  v_fract_f32 v37, v37
  v_exp_f32 v38, v38
  v_cos_f32 v46, v39
  v_sin_f32 v47, v39
  v_exp_f32 v32, v32
  v_cos_f32 v40, v33
  v_sin_f32 v41, v33
  v_exp_f32 v34, v34
  v_cos_f32 v42, v35
  v_sin_f32 v43, v35
  v_exp_f32 v36, v36
  v_cos_f32 v44, v37
  v_sin_f32 v45, v37
  v_pk_mul_f32 v[46:47], v[46:47], v[38:39] op_sel_hi:[1,0]
  v_pk_mul_f32 v[40:41], v[40:41], v[32:33] op_sel_hi:[1,0]
  v_pk_mul_f32 v[42:43], v[42:43], v[34:35] op_sel_hi:[1,0]
  v_pk_mul_f32 v[44:45], v[44:45], v[36:37] op_sel_hi:[1,0]
  v_pk_mul_f32 v[32:33], v[46:47], v[10:11] op_sel_hi:[1,0] neg_hi:[1,0]
  v_cvt_pk_f16_f32 v18, v40, v41
  v_pk_fma_f32 v[32:33], v[46:47], v[10:11], v[32:33] op_sel:[1,1,0] op_sel_hi:[0,1,1] neg_lo:[1,0,0] neg_hi:[1,0,0]
  v_cvt_pk_f16_f32 v22, v42, v43
  v_cvt_pk_f16_f32 v26, v44, v45
  v_cvt_pk_f16_f32 v30, v32, v33
  s_waitcnt lgkmcnt(0)
  ds_read_b128 v[8:11], v3 offset:256
  v_pk_mul_f32 v[38:39], v[12:13], v[6:7] op_sel:[0,1] op_sel_hi:[1,1]
  v_pk_mul_f32 v[32:33], v[12:13], v[4:5] op_sel:[0,0] op_sel_hi:[1,0]
  v_pk_mul_f32 v[34:35], v[12:13], v[4:5] op_sel:[0,1] op_sel_hi:[1,1]
  v_pk_mul_f32 v[36:37], v[12:13], v[6:7] op_sel:[0,0] op_sel_hi:[1,0]
  v_fract_f32 v39, v39
  v_fract_f32 v33, v33
  v_fract_f32 v35, v35
  v_fract_f32 v37, v37
  v_exp_f32 v38, v38
  v_cos_f32 v46, v39
  v_sin_f32 v47, v39
  v_exp_f32 v32, v32
  v_cos_f32 v40, v33
  v_sin_f32 v41, v33
  v_exp_f32 v34, v34
  v_cos_f32 v42, v35
  v_sin_f32 v43, v35
  v_exp_f32 v36, v36
  v_cos_f32 v44, v37
  v_sin_f32 v45, v37
  v_pk_mul_f32 v[46:47], v[46:47], v[38:39] op_sel_hi:[1,0]
  v_pk_mul_f32 v[40:41], v[40:41], v[32:33] op_sel_hi:[1,0]
  v_pk_mul_f32 v[42:43], v[42:43], v[34:35] op_sel_hi:[1,0]
  v_pk_mul_f32 v[44:45], v[44:45], v[36:37] op_sel_hi:[1,0]
  v_pk_mul_f32 v[32:33], v[46:47], v[14:15] op_sel_hi:[1,0] neg_hi:[1,0]
  v_cvt_pk_f16_f32 v19, v40, v41
  v_pk_fma_f32 v[32:33], v[46:47], v[14:15], v[32:33] op_sel:[1,1,0] op_sel_hi:[0,1,1] neg_lo:[1,0,0] neg_hi:[1,0,0]
  v_cvt_pk_f16_f32 v23, v42, v43
  v_cvt_pk_f16_f32 v27, v44, v45
  v_cvt_pk_f16_f32 v31, v32, v33
  v_add_u32 v3, 256, v3
  s_sub_u32 s6, s6, 1
  s_cmp_lg_u32 s6, 0
  s_cbranch_scc1 L_kg_110
  s_mov_b32 s6, 2
L_kg_111:
  s_waitcnt lgkmcnt(0)
  ds_read_b128 v[12:15], v3 offset:16
  v_mfma_f32_16x16x32_f16 v[48:51], v[16:19], v[28:31], v[48:51]
  v_pk_mul_f32 v[38:39], v[8:9], v[6:7] op_sel:[0,1] op_sel_hi:[1,1]
  v_mfma_f32_16x16x32_f16 v[52:55], v[20:23], v[28:31], v[52:55]
  v_pk_mul_f32 v[32:33], v[8:9], v[4:5] op_sel:[0,0] op_sel_hi:[1,0]
  v_mfma_f32_16x16x32_f16 v[56:59], v[24:27], v[28:31], v[56:59]
  v_pk_mul_f32 v[34:35], v[8:9], v[4:5] op_sel:[0,1] op_sel_hi:[1,1]
  v_pk_mul_f32 v[36:37], v[8:9], v[6:7] op_sel:[0,0] op_sel_hi:[1,0]
  v_fract_f32 v39, v39
  v_fract_f32 v33, v33
  v_fract_f32 v35, v35
  v_fract_f32 v37, v37
  v_exp_f32 v38, v38
  v_cos_f32 v46, v39
  v_sin_f32 v47, v39
  v_exp_f32 v32, v32
  v_cos_f32 v40, v33
  v_sin_f32 v41, v33
  v_exp_f32 v34, v34
  v_cos_f32 v42, v35
  v_sin_f32 v43, v35
  v_exp_f32 v36, v36
  v_cos_f32 v44, v37
  v_sin_f32 v45, v37
  v_pk_mul_f32 v[46:47], v[46:47], v[38:39] op_sel_hi:[1,0]
  v_pk_mul_f32 v[40:41], v[40:41], v[32:33] op_sel_hi:[1,0]
  v_pk_mul_f32 v[42:43], v[42:43], v[34:35] op_sel_hi:[1,0]
  v_pk_mul_f32 v[44:45], v[44:45], v[36:37] op_sel_hi:[1,0]
  v_pk_mul_f32 v[32:33], v[46:47], v[10:11] op_sel_hi:[1,0] neg_hi:[1,0]
  v_cvt_pk_f16_f32 v16, v40, v41
  v_pk_fma_f32 v[32:33], v[46:47], v[10:11], v[32:33] op_sel:[1,1,0] op_sel_hi:[0,1,1] neg_lo:[1,0,0] neg_hi:[1,0,0]
  v_cvt_pk_f16_f32 v20, v42, v43
  v_cvt_pk_f16_f32 v24, v44, v45
  v_cvt_pk_f16_f32 v28, v32, v33
  s_waitcnt lgkmcnt(0)
  ds_read_b128 v[8:11], v3 offset:32
  v_pk_mul_f32 v[38:39], v[12:13], v[6:7] op_sel:[0,1] op_sel_hi:[1,1]
  v_pk_mul_f32 v[32:33], v[12:13], v[4:5] op_sel:[0,0] op_sel_hi:[1,0]
  v_pk_mul_f32 v[34:35], v[12:13], v[4:5] op_sel:[0,1] op_sel_hi:[1,1]
  v_pk_mul_f32 v[36:37], v[12:13], v[6:7] op_sel:[0,0] op_sel_hi:[1,0]
  v_fract_f32 v39, v39
  v_fract_f32 v33, v33
  v_fract_f32 v35, v35
  v_fract_f32 v37, v37
  v_exp_f32 v38, v38
  v_cos_f32 v46, v39
  v_sin_f32 v47, v39
  v_exp_f32 v32, v32
  v_cos_f32 v40, v33
  v_sin_f32 v41, v33
  v_exp_f32 v34, v34
  v_cos_f32 v42, v35
  v_sin_f32 v43, v35
  v_exp_f32 v36, v36
  v_cos_f32 v44, v37
  v_sin_f32 v45, v37
  v_pk_mul_f32 v[46:47], v[46:47], v[38:39] op_sel_hi:[1,0]
  v_pk_mul_f32 v[40:41], v[40:41], v[32:33] op_sel_hi:[1,0]
  v_pk_mul_f32 v[42:43], v[42:43], v[34:35] op_sel_hi:[1,0]
  v_pk_mul_f32 v[44:45], v[44:45], v[36:37] op_sel_hi:[1,0]
  v_pk_mul_f32 v[32:33], v[46:47], v[14:15] op_sel_hi:[1,0] neg_hi:[1,0]
  v_cvt_pk_f16_f32 v17, v40, v41
  v_pk_fma_f32 v[32:33], v[46:47], v[14:15], v[32:33] op_sel:[1,1,0] op_sel_hi:[0,1,1] neg_lo:[1,0,0] neg_hi:[1,0,0]
  v_cvt_pk_f16_f32 v21, v42, v43
  v_cvt_pk_f16_f32 v25, v44, v45
  v_cvt_pk_f16_f32 v29, v32, v33
  s_waitcnt lgkmcnt(0)
  ds_read_b128 v[12:15], v3 offset:48
  v_pk_mul_f32 v[38:39], v[8:9], v[6:7] op_sel:[0,1] op_sel_hi:[1,1]
  v_pk_mul_f32 v[32:33], v[8:9], v[4:5] op_sel:[0,0] op_sel_hi:[1,0]
  v_pk_mul_f32 v[34:35], v[8:9], v[4:5] op_sel:[0,1] op_sel_hi:[1,1]
  v_pk_mul_f32 v[36:37], v[8:9], v[6:7] op_sel:[0,0] op_sel_hi:[1,0]
  v_fract_f32 v39, v39
  v_fract_f32 v33, v33
  v_fract_f32 v35, v35
  v_fract_f32 v37, v37
  v_exp_f32 v38, v38
  v_cos_f32 v46, v39
  v_sin_f32 v47, v39
  v_exp_f32 v32, v32
  v_cos_f32 v40, v33
  v_sin_f32 v41, v33
  v_exp_f32 v34, v34
  v_cos_f32 v42, v35
  v_sin_f32 v43, v35
  v_exp_f32 v36, v36
  v_cos_f32 v44, v37
  v_sin_f32 v45, v37
  v_pk_mul_f32 v[46:47], v[46:47], v[38:39] op_sel_hi:[1,0]
  v_pk_mul_f32 v[40:41], v[40:41], v[32:33] op_sel_hi:[1,0]
  v_pk_mul_f32 v[42:43], v[42:43], v[34:35] op_sel_hi:[1,0]
  v_pk_mul_f32 v[44:45], v[44:45], v[36:37] op_sel_hi:[1,0]
  v_pk_mul_f32 v[32:33], v[46:47], v[10:11] op_sel_hi:[1,0] neg_hi:[1,0]
  v_cvt_pk_f16_f32 v18, v40, v41
  v_pk_fma_f32 v[32:33], v[46:47], v[10:11], v[32:33] op_sel:[1,1,0] op_sel_hi:[0,1,1] neg_lo:[1,0,0] neg_hi:[1,0,0]
  v_cvt_pk_f16_f32 v22, v42, v43
  v_cvt_pk_f16_f32 v26, v44, v45
  v_cvt_pk_f16_f32 v30, v32, v33
  s_waitcnt lgkmcnt(0)
  ds_read_b128 v[8:11], v3 offset:256
  v_pk_mul_f32 v[38:39], v[12:13], v[6:7] op_sel:[0,1] op_sel_hi:[1,1]
  v_pk_mul_f32 v[32:33], v[12:13], v[4:5] op_sel:[0,0] op_sel_hi:[1,0]
  v_pk_mul_f32 v[34:35], v[12:13], v[4:5] op_sel:[0,1] op_sel_hi:[1,1]
  v_pk_mul_f32 v[36:37], v[12:13], v[6:7] op_sel:[0,0] op_sel_hi:[1,0]
  v_fract_f32 v39, v39
  v_fract_f32 v33, v33
  v_fract_f32 v35, v35
  v_fract_f32 v37, v37
  v_exp_f32 v38, v38
  v_cos_f32 v46, v39
  v_sin_f32 v47, v39
  v_exp_f32 v32, v32
  v_cos_f32 v40, v33
  v_sin_f32 v41, v33
  v_exp_f32 v34, v34
  v_cos_f32 v42, v35
  v_sin_f32 v43, v35
  v_exp_f32 v36, v36
  v_cos_f32 v44, v37
  v_sin_f32 v45, v37
  v_pk_mul_f32 v[46:47], v[46:47], v[38:39] op_sel_hi:[1,0]
  v_pk_mul_f32 v[40:41], v[40:41], v[32:33] op_sel_hi:[1,0]
  v_pk_mul_f32 v[42:43], v[42:43], v[34:35] op_sel_hi:[1,0]
  v_pk_mul_f32 v[44:45], v[44:45], v[36:37] op_sel_hi:[1,0]
  v_pk_mul_f32 v[32:33], v[46:47], v[14:15] op_sel_hi:[1,0] neg_hi:[1,0]
  v_cvt_pk_f16_f32 v19, v40, v41
  v_pk_fma_f32 v[32:33], v[46:47], v[14:15], v[32:33] op_sel:[1,1,0] op_sel_hi:[0,1,1] neg_lo:[1,0,0] neg_hi:[1,0,0]
  v_cvt_pk_f16_f32 v23, v42, v43
  v_cvt_pk_f16_f32 v27, v44, v45
  v_cvt_pk_f16_f32 v31, v32, v33
  v_add_u32 v3, 256, v3
  s_sub_u32 s6, s6, 1
  s_cmp_lg_u32 s6, 0
  s_cbranch_scc1 L_kg_111
  s_cmp_lg_u32 s3, 0
  s_cbranch_scc1 L_wdo_113
  s_mov_b32 s7, 0
  v_mbcnt_lo_u32_b32 v216, -1, 0
  v_and_b32 v216, 3, v216
  v_lshlrev_b32 v216, 6, v216
L_wd_112:
  buffer_load_dword v217, v216, s[12:15], 0 offen offset:16 sc1
  s_waitcnt vmcnt(0)
  v_cmp_ne_u32 vcc, 64, v217
  s_cbranch_vccz L_wdo_113
  s_add_u32 s7, s7, 1
  s_cmp_lt_u32 s7, 131072
  s_cbranch_scc1 L_wd_112
  s_mov_b32 s6, 50
  s_branch L_err
L_wdo_113:
  s_barrier
  s_lshl_b32 s6, s3, 13
  s_add_u32 s6, s6, s62
  s_add_u32 s6, s6, 0xb000000
  s_lshl_b32 s7, s3, 10
  v_lshlrev_b32 v216, 7, v0
  s_add_u32 m0, s7, 44064
  s_nop 0
  buffer_load_dwordx4 v216, s[8:11], s6 offen lds
  s_add_u32 s6, s6, 16
  s_add_u32 m0, s7, 48192
  s_nop 0
  buffer_load_dwordx4 v216, s[8:11], s6 offen lds
  s_add_u32 s6, s6, 16
  s_add_u32 m0, s7, 52320
  s_nop 0
  buffer_load_dwordx4 v216, s[8:11], s6 offen lds
  s_add_u32 s6, s6, 16
  s_add_u32 m0, s7, 56448
  s_nop 0
  buffer_load_dwordx4 v216, s[8:11], s6 offen lds
  s_add_u32 s6, s6, 16
  s_add_u32 m0, s7, 60544
  s_nop 0
  buffer_load_dwordx4 v216, s[8:11], s6 offen lds
  s_add_u32 s6, s6, 16
  s_add_u32 m0, s7, 64640
  s_nop 0
  buffer_load_dwordx4 v216, s[8:11], s6 offen lds
  s_add_u32 s6, s6, 16
  s_add_u32 m0, s7, 68736
  s_nop 0
  buffer_load_dwordx4 v216, s[8:11], s6 offen lds
  s_add_u32 s6, s6, 16
  s_add_u32 m0, s7, 72832
  s_nop 0
  buffer_load_dwordx4 v216, s[8:11], s6 offen lds
  s_add_u32 s6, s6, 16
  s_mov_b32 s6, 2
L_kg_114:
  s_waitcnt lgkmcnt(0)
  ds_read_b128 v[12:15], v3 offset:16
  v_mfma_f32_16x16x32_f16 v[48:51], v[16:19], v[28:31], v[48:51]
  v_pk_mul_f32 v[38:39], v[8:9], v[6:7] op_sel:[0,1] op_sel_hi:[1,1]
  v_mfma_f32_16x16x32_f16 v[52:55], v[20:23], v[28:31], v[52:55]
  v_pk_mul_f32 v[32:33], v[8:9], v[4:5] op_sel:[0,0] op_sel_hi:[1,0]
  v_mfma_f32_16x16x32_f16 v[56:59], v[24:27], v[28:31], v[56:59]
  v_pk_mul_f32 v[34:35], v[8:9], v[4:5] op_sel:[0,1] op_sel_hi:[1,1]
  v_pk_mul_f32 v[36:37], v[8:9], v[6:7] op_sel:[0,0] op_sel_hi:[1,0]
  v_fract_f32 v39, v39
  v_fract_f32 v33, v33
  v_fract_f32 v35, v35
  v_fract_f32 v37, v37
  v_exp_f32 v38, v38
  v_cos_f32 v46, v39
  v_sin_f32 v47, v39
  v_exp_f32 v32, v32
  v_cos_f32 v40, v33
  v_sin_f32 v41, v33
  v_exp_f32 v34, v34
  v_cos_f32 v42, v35
  v_sin_f32 v43, v35
  v_exp_f32 v36, v36
  v_cos_f32 v44, v37
  v_sin_f32 v45, v37
  v_pk_mul_f32 v[46:47], v[46:47], v[38:39] op_sel_hi:[1,0]
  v_pk_mul_f32 v[40:41], v[40:41], v[32:33] op_sel_hi:[1,0]
  v_pk_mul_f32 v[42:43], v[42:43], v[34:35] op_sel_hi:[1,0]
  v_pk_mul_f32 v[44:45], v[44:45], v[36:37] op_sel_hi:[1,0]
  v_pk_mul_f32 v[32:33], v[46:47], v[10:11] op_sel_hi:[1,0] neg_hi:[1,0]
  v_cvt_pk_f16_f32 v16, v40, v41
  v_pk_fma_f32 v[32:33], v[46:47], v[10:11], v[32:33] op_sel:[1,1,0] op_sel_hi:[0,1,1] neg_lo:[1,0,0] neg_hi:[1,0,0]
  v_cvt_pk_f16_f32 v20, v42, v43
  v_cvt_pk_f16_f32 v24, v44, v45
  v_cvt_pk_f16_f32 v28, v32, v33
  s_waitcnt lgkmcnt(0)
  ds_read_b128 v[8:11], v3 offset:32
  v_pk_mul_f32 v[38:39], v[12:13], v[6:7] op_sel:[0,1] op_sel_hi:[1,1]
  v_pk_mul_f32 v[32:33], v[12:13], v[4:5] op_sel:[0,0] op_sel_hi:[1,0]
  v_pk_mul_f32 v[34:35], v[12:13], v[4:5] op_sel:[0,1] op_sel_hi:[1,1]
  v_pk_mul_f32 v[36:37], v[12:13], v[6:7] op_sel:[0,0] op_sel_hi:[1,0]
  v_fract_f32 v39, v39
  v_fract_f32 v33, v33
  v_fract_f32 v35, v35
  v_fract_f32 v37, v37
  v_exp_f32 v38, v38
  v_cos_f32 v46, v39
  v_sin_f32 v47, v39
  v_exp_f32 v32, v32
  v_cos_f32 v40, v33
  v_sin_f32 v41, v33
  v_exp_f32 v34, v34
  v_cos_f32 v42, v35
  v_sin_f32 v43, v35
  v_exp_f32 v36, v36
  v_cos_f32 v44, v37
  v_sin_f32 v45, v37
  v_pk_mul_f32 v[46:47], v[46:47], v[38:39] op_sel_hi:[1,0]
  v_pk_mul_f32 v[40:41], v[40:41], v[32:33] op_sel_hi:[1,0]
  v_pk_mul_f32 v[42:43], v[42:43], v[34:35] op_sel_hi:[1,0]
  v_pk_mul_f32 v[44:45], v[44:45], v[36:37] op_sel_hi:[1,0]
  v_pk_mul_f32 v[32:33], v[46:47], v[14:15] op_sel_hi:[1,0] neg_hi:[1,0]
  v_cvt_pk_f16_f32 v17, v40, v41
  v_pk_fma_f32 v[32:33], v[46:47], v[14:15], v[32:33] op_sel:[1,1,0] op_sel_hi:[0,1,1] neg_lo:[1,0,0] neg_hi:[1,0,0]
  v_cvt_pk_f16_f32 v21, v42, v43
  v_cvt_pk_f16_f32 v25, v44, v45
  v_cvt_pk_f16_f32 v29, v32, v33
  s_waitcnt lgkmcnt(0)
  ds_read_b128 v[12:15], v3 offset:48
  v_pk_mul_f32 v[38:39], v[8:9], v[6:7] op_sel:[0,1] op_sel_hi:[1,1]
  v_pk_mul_f32 v[32:33], v[8:9], v[4:5] op_sel:[0,0] op_sel_hi:[1,0]
  v_pk_mul_f32 v[34:35], v[8:9], v[4:5] op_sel:[0,1] op_sel_hi:[1,1]
  v_pk_mul_f32 v[36:37], v[8:9], v[6:7] op_sel:[0,0] op_sel_hi:[1,0]
  v_fract_f32 v39, v39
  v_fract_f32 v33, v33
  v_fract_f32 v35, v35
  v_fract_f32 v37, v37
  v_exp_f32 v38, v38
  v_cos_f32 v46, v39
  v_sin_f32 v47, v39
  v_exp_f32 v32, v32
  v_cos_f32 v40, v33
  v_sin_f32 v41, v33
  v_exp_f32 v34, v34
  v_cos_f32 v42, v35
  v_sin_f32 v43, v35
  v_exp_f32 v36, v36
  v_cos_f32 v44, v37
  v_sin_f32 v45, v37
  v_pk_mul_f32 v[46:47], v[46:47], v[38:39] op_sel_hi:[1,0]
  v_pk_mul_f32 v[40:41], v[40:41], v[32:33] op_sel_hi:[1,0]
  v_pk_mul_f32 v[42:43], v[42:43], v[34:35] op_sel_hi:[1,0]
  v_pk_mul_f32 v[44:45], v[44:45], v[36:37] op_sel_hi:[1,0]
  v_pk_mul_f32 v[32:33], v[46:47], v[10:11] op_sel_hi:[1,0] neg_hi:[1,0]
  v_cvt_pk_f16_f32 v18, v40, v41
  v_pk_fma_f32 v[32:33], v[46:47], v[10:11], v[32:33] op_sel:[1,1,0] op_sel_hi:[0,1,1] neg_lo:[1,0,0] neg_hi:[1,0,0]
  v_cvt_pk_f16_f32 v22, v42, v43
  v_cvt_pk_f16_f32 v26, v44, v45
  v_cvt_pk_f16_f32 v30, v32, v33
  s_waitcnt lgkmcnt(0)
  ds_read_b128 v[8:11], v3 offset:256
  v_pk_mul_f32 v[38:39], v[12:13], v[6:7] op_sel:[0,1] op_sel_hi:[1,1]
  v_pk_mul_f32 v[32:33], v[12:13], v[4:5] op_sel:[0,0] op_sel_hi:[1,0]
  v_pk_mul_f32 v[34:35], v[12:13], v[4:5] op_sel:[0,1] op_sel_hi:[1,1]
  v_pk_mul_f32 v[36:37], v[12:13], v[6:7] op_sel:[0,0] op_sel_hi:[1,0]
  v_fract_f32 v39, v39
  v_fract_f32 v33, v33
  v_fract_f32 v35, v35
  v_fract_f32 v37, v37
  v_exp_f32 v38, v38
  v_cos_f32 v46, v39
  v_sin_f32 v47, v39
  v_exp_f32 v32, v32
  v_cos_f32 v40, v33
  v_sin_f32 v41, v33
  v_exp_f32 v34, v34
  v_cos_f32 v42, v35
  v_sin_f32 v43, v35
  v_exp_f32 v36, v36
  v_cos_f32 v44, v37
  v_sin_f32 v45, v37
  v_pk_mul_f32 v[46:47], v[46:47], v[38:39] op_sel_hi:[1,0]
  v_pk_mul_f32 v[40:41], v[40:41], v[32:33] op_sel_hi:[1,0]
  v_pk_mul_f32 v[42:43], v[42:43], v[34:35] op_sel_hi:[1,0]
  v_pk_mul_f32 v[44:45], v[44:45], v[36:37] op_sel_hi:[1,0]
  v_pk_mul_f32 v[32:33], v[46:47], v[14:15] op_sel_hi:[1,0] neg_hi:[1,0]
  v_cvt_pk_f16_f32 v19, v40, v41
  v_pk_fma_f32 v[32:33], v[46:47], v[14:15], v[32:33] op_sel:[1,1,0] op_sel_hi:[0,1,1] neg_lo:[1,0,0] neg_hi:[1,0,0]
  v_cvt_pk_f16_f32 v23, v42, v43
  v_cvt_pk_f16_f32 v27, v44, v45
  v_cvt_pk_f16_f32 v31, v32, v33
  v_add_u32 v3, 256, v3
  s_sub_u32 s6, s6, 1
  s_cmp_lg_u32 s6, 0
  s_cbranch_scc1 L_kg_114
  v_mfma_f32_16x16x32_f16 v[48:51], v[16:19], v[28:31], v[48:51]
  v_mfma_f32_16x16x32_f16 v[52:55], v[20:23], v[28:31], v[52:55]
  v_mfma_f32_16x16x32_f16 v[56:59], v[24:27], v[28:31], v[56:59]
  s_waitcnt lgkmcnt(0)
  s_nop 4
  v_mul_f32 v48, v48, v233
  v_mul_f32 v49, v49, v233
  v_mul_f32 v50, v50, v233
  v_mul_f32 v51, v51, v233
  v_mul_f32 v52, v52, v233
  v_mul_f32 v53, v53, v233
  v_mul_f32 v54, v54, v233
  v_mul_f32 v55, v55, v233
  v_mul_f32 v56, v56, v233
  v_mul_f32 v57, v57, v233
  v_mul_f32 v58, v58, v233
  v_mul_f32 v59, v59, v233
  v_readlane_b32 s61, v52, 32
  v_lshrrev_b32 v16, 4, v0
  v_and_b32 v17, 15, v0
  v_lshlrev_b32 v17, 4, v17
  v_add_u32 v17, s63, v17
  v_lshrrev_b32 v18, 1, v16
  v_and_b32 v19, 1, v16
  v_lshlrev_b32 v20, 8, v18
  v_lshl_add_u32 v20, v19, 3, v20
  v_add3_u32 v20, v20, v17, 2
  v_lshlrev_b32 v21, 8, v19
  v_add_u32 v21, 516, v21
  v_cmp_eq_u32 vcc, 0, v18
  s_nop 1
  v_cndmask_b32 v21, 0, v21, vcc
  v_cndmask_b32 v22, 0, 4, vcc
  v_add_u32 v21, v21, v17
  v_lshlrev_b32 v23, 9, v19
  v_add_u32 v23, 1032, v23
  v_lshlrev_b32 v24, 10, v19
  v_add_u32 v24, 2064, v24
  v_cndmask_b32 v23, v24, v23, vcc
  v_add_u32 v23, v23, v17
  v_mov_b32 v24, 0x100
  v_cndmask_b32 v24, v24, 8, vcc
  v_mov_b32 v25, 0x200
  v_cndmask_b32 v25, v25, v24, vcc
  v_mov_b32 v26, 0x100
  v_cndmask_b32 v25, v25, v26, vcc
  v_cvt_pk_bf16_f32 v32, v48, v49
  v_cvt_pk_bf16_f32 v33, v50, v51
  v_cvt_pk_bf16_f32 v34, v52, v53
  v_cvt_pk_bf16_f32 v35, v54, v55
  v_cvt_pk_bf16_f32 v36, v56, v57
  v_cvt_pk_bf16_f32 v37, v58, v59
  ds_write_b16 v21, v34
  v_add_u32 v21, v21, v22
  ds_write_b16_d16_hi v21, v34
  v_add_u32 v21, v21, v22
  ds_write_b16 v21, v35
  v_add_u32 v21, v21, v22
  ds_write_b16_d16_hi v21, v35
  ds_write_b16 v20, v32 offset:0
  ds_write_b16_d16_hi v20, v32 offset:2
  ds_write_b16 v20, v33 offset:4
  ds_write_b16_d16_hi v20, v33 offset:6
  ds_write_b16 v23, v36
  v_add_u32 v26, v23, v24
  v_add_u32 v23, v23, v25
  ds_write_b16_d16_hi v26, v36
  ds_write_b16 v23, v37
  v_add_u32 v23, v23, v24
  ds_write_b16_d16_hi v23, v37
  ds_read_u16 v160, v160
  ds_read_u16 v161, v161
  ds_read_u16 v162, v162
  ds_read_u16 v163, v163
  ds_read_u16 v164, v164
  ds_read_u16 v165, v165
  ds_read_u16 v166, v166
  ds_read_u16 v167, v167
  ds_read_u16 v168, v168
  ds_read_u16 v169, v169
  ds_read_u16 v170, v170
  ds_read_u16 v171, v171
  ds_read_u16 v172, v172
  ds_read_u16 v173, v173
  ds_read_u16 v174, v174
  ds_read_u16 v175, v175
  ds_read_u16 v176, v176
  ds_read_u16 v177, v177
  ds_read_u16 v178, v178
  ds_read_u16 v179, v179
  ds_read_u16 v180, v180
  ds_read_u16 v181, v181
  ds_read_u16 v182, v182
  ds_read_u16 v183, v183
  ds_read_u16 v184, v184
  ds_read_u16 v185, v185
  ds_read_u16 v186, v186
  ds_read_u16 v187, v187
  ds_read_u16 v188, v188
  ds_read_u16 v189, v189
  ds_read_u16 v190, v190
  ds_read_u16 v191, v191
  s_mul_i32 s6, s3, 4608
  s_add_u32 s6, s6, 25600
  v_add_u32 v16, s6, v2
  s_mul_i32 s7, s60, 4608
  s_add_u32 s7, s7, 0x400000
  v_mov_b32 v21, 0
  v_mov_b32 v22, 0
  v_mov_b32 v23, 0
  v_mov_b32 v20, s61
  v_cmp_eq_u32 vcc, 30, v0
  s_nop 1
  v_cndmask_b32 v20, 0, v20, vcc
  s_mul_i32 s62, s3, 4128
  s_add_u32 s62, s62, 44032
  v_and_b32 v24, 16, v2
  v_add_u32 v24, s62, v24
  v_mov_b32 v28, 0
  v_mov_b32 v29, 0
  v_mov_b32 v30, 0
  v_mov_b32 v31, 0
  s_waitcnt lgkmcnt(15)
  v_lshl_or_b32 v160, v161, 16, v160
  v_lshl_or_b32 v161, v163, 16, v162
  v_lshl_or_b32 v162, v165, 16, v164
  v_lshl_or_b32 v163, v167, 16, v166
  ds_write_b128 v16, v[160:163] offset:0
  buffer_store_dwordx4 v[160:163], v2, s[8:11], s7 offen offset:0 sc1
  s_waitcnt lgkmcnt(15)
  s_waitcnt lgkmcnt(15)
  v_lshl_or_b32 v168, v169, 16, v168
  v_lshl_or_b32 v169, v171, 16, v170
  v_lshl_or_b32 v170, v173, 16, v172
  v_lshl_or_b32 v171, v175, 16, v174
  ds_write_b128 v16, v[168:171] offset:1024
  buffer_store_dwordx4 v[168:171], v2, s[8:11], s7 offen offset:1024 sc1
  s_waitcnt lgkmcnt(10)
  v_lshl_or_b32 v176, v177, 16, v176
  v_lshl_or_b32 v177, v179, 16, v178
  v_lshl_or_b32 v178, v181, 16, v180
  v_lshl_or_b32 v179, v183, 16, v182
  ds_write_b128 v16, v[176:179] offset:2048
  buffer_store_dwordx4 v[176:179], v2, s[8:11], s7 offen offset:2048 sc1
  s_waitcnt lgkmcnt(3)
  v_lshl_or_b32 v184, v185, 16, v184
  v_lshl_or_b32 v185, v187, 16, v186
  v_lshl_or_b32 v186, v189, 16, v188
  v_lshl_or_b32 v187, v191, 16, v190
  ds_write_b128 v16, v[184:187] offset:3072
  buffer_store_dwordx4 v[184:187], v2, s[8:11], s7 offen offset:3072 sc1
  s_add_u32 s7, s7, 4096
  ds_write_b128 v24, v[28:31]
  s_mov_b32 exec_hi, 0
  ds_write_b128 v16, v[20:23] offset:4096
  buffer_store_dwordx4 v[20:23], v2, s[8:11], s7 offen sc1
  s_mov_b32 exec_hi, -1
  v_and_b32 v16, 15, v0
  v_lshrrev_b32 v17, 4, v0
  v_lshlrev_b32 v18, 5, v16
  s_add_u32 s6, s6, 480
  v_sub_u32 v18, s6, v18
  v_lshl_add_u32 v4, v17, 4, v18
  v_lshlrev_b32 v18, 1, v16
  v_lshl_add_u32 v18, v17, 4, v18
  v_and_b32 v6, 2, v18
  v_and_b32 v18, -4, v18
  v_add_u32 v5, s62, v18
  v_lshlrev_b32 v18, 5, v16
  v_lshl_add_u32 v18, v17, 3, v18
  v_add3_u32 v7, v18, s62, 32
  s_lshl_b32 s7, s3, 12
  s_add_u32 s7, s7, 60544
  v_add_u32 v8, s7, v18
  v_lshrrev_b32 v18, 1, v16
  v_lshlrev_b32 v18, 15, v18
  v_and_b32 v19, 1, v16
  v_lshl_or_b32 v18, v19, 5, v18
  v_lshl_or_b32 v9, v17, 3, v18
  v_lshlrev_b32 v31, 16, v232
  v_add_u32 v60, 1024, v5
  v_add_u32 v61, 2048, v5
  v_add_u32 v62, 3072, v5
  s_lshl_b32 s62, s60, 6
  s_add_u32 s62, s62, 0x0
  s_waitcnt vmcnt(5) lgkmcnt(0)
  s_barrier
  ds_read_b128 a[32:35], v4 offset:4032
  ds_read_b128 a[36:39], v4 offset:3968
  ds_read_b128 a[40:43], v4 offset:3904
  ds_read2_b32 v[10:11], v5 offset0:112 offset1:113
  ds_read2_b32 v[12:13], v5 offset0:114 offset1:115
  ds_read_b32 v14, v5 offset:464
  ds_read2_b32 v[16:17], v5 offset0:96 offset1:97
  ds_read2_b32 v[18:19], v5 offset0:98 offset1:99
  ds_read_b32 v20, v5 offset:400
  ds_read2_b32 v[32:33], v5 offset0:80 offset1:81
  ds_read2_b32 v[34:35], v5 offset0:82 offset1:83
  ds_read_b32 v36, v5 offset:336
  ds_read2_b32 v[38:39], v5 offset0:64 offset1:65
  ds_read2_b32 v[40:41], v5 offset0:66 offset1:67
  ds_read_b32 v42, v5 offset:272
  ds_read2_b32 v[44:45], v5 offset0:48 offset1:49
  ds_read2_b32 v[46:47], v5 offset0:50 offset1:51
  ds_read_b32 v48, v5 offset:208
  s_waitcnt lgkmcnt(12)
  v_alignbyte_b32 v92, v11, v10, v6
  v_alignbyte_b32 v93, v12, v11, v6
  v_alignbyte_b32 v94, v13, v12, v6
  v_alignbyte_b32 v95, v14, v13, v6
  s_waitcnt lgkmcnt(9)
  v_alignbyte_b32 v88, v17, v16, v6
  v_alignbyte_b32 v89, v18, v17, v6
  v_alignbyte_b32 v90, v19, v18, v6
  v_alignbyte_b32 v91, v20, v19, v6
  v_mfma_f32_16x16x32_bf16 a[0:3], v[92:95], a[32:35], 0
  ds_read2_b32 v[10:11], v5 offset0:32 offset1:33
  ds_read2_b32 v[12:13], v5 offset0:34 offset1:35
  ds_read_b32 v14, v5 offset:144
  ds_read_b128 a[44:47], v4 offset:3840
  s_waitcnt lgkmcnt(10)
  v_alignbyte_b32 v84, v33, v32, v6
  v_alignbyte_b32 v85, v34, v33, v6
  v_alignbyte_b32 v86, v35, v34, v6
  v_alignbyte_b32 v87, v36, v35, v6
  v_mfma_f32_16x16x32_bf16 a[0:3], v[88:91], a[36:39], a[0:3]
  ds_read2_b32 v[16:17], v5 offset0:16 offset1:17
  ds_read2_b32 v[18:19], v5 offset0:18 offset1:19
  ds_read_b32 v20, v5 offset:80
  ds_read_b128 a[32:35], v4 offset:3776
  s_waitcnt lgkmcnt(11)
  v_alignbyte_b32 v80, v39, v38, v6
  v_alignbyte_b32 v81, v40, v39, v6
  v_alignbyte_b32 v82, v41, v40, v6
  v_alignbyte_b32 v83, v42, v41, v6
  v_mfma_f32_16x16x32_bf16 a[0:3], v[84:87], a[40:43], a[0:3]
  ds_read2_b32 v[32:33], v5 offset0:0 offset1:1
  ds_read2_b32 v[34:35], v5 offset0:2 offset1:3
  ds_read_b32 v36, v5 offset:16
  ds_read_b128 a[36:39], v4 offset:3712
  s_waitcnt lgkmcnt(12)
  v_alignbyte_b32 v76, v45, v44, v6
  v_alignbyte_b32 v77, v46, v45, v6
  v_alignbyte_b32 v78, v47, v46, v6
  v_alignbyte_b32 v79, v48, v47, v6
  s_waitcnt lgkmcnt(8)
  v_mfma_f32_16x16x32_bf16 a[0:3], v[80:83], a[44:47], a[0:3]
  ds_read2_b32 v[38:39], v62 offset0:240 offset1:241
  ds_read2_b32 v[40:41], v62 offset0:242 offset1:243
  ds_read_b32 v42, v62 offset:976
  ds_read_b128 a[40:43], v4 offset:3648
  v_alignbyte_b32 v72, v11, v10, v6
  v_alignbyte_b32 v73, v12, v11, v6
  v_alignbyte_b32 v74, v13, v12, v6
  v_alignbyte_b32 v75, v14, v13, v6
  s_waitcnt lgkmcnt(8)
  v_mfma_f32_16x16x32_bf16 a[0:3], v[76:79], a[32:35], a[0:3]
  ds_read2_b32 v[44:45], v62 offset0:112 offset1:113
  ds_read2_b32 v[46:47], v62 offset0:114 offset1:115
  ds_read_b32 v48, v62 offset:464
  ds_read_b128 a[44:47], v4 offset:3584
  v_alignbyte_b32 v68, v17, v16, v6
  v_alignbyte_b32 v69, v18, v17, v6
  v_alignbyte_b32 v70, v19, v18, v6
  v_alignbyte_b32 v71, v20, v19, v6
  s_waitcnt lgkmcnt(8)
  v_mfma_f32_16x16x32_bf16 a[0:3], v[72:75], a[36:39], a[0:3]
  ds_read2_b32 v[10:11], v61 offset0:240 offset1:241
  ds_read2_b32 v[12:13], v61 offset0:242 offset1:243
  ds_read_b32 v14, v61 offset:976
  ds_read_b128 a[32:35], v4 offset:4032
  v_alignbyte_b32 v64, v33, v32, v6
  v_alignbyte_b32 v65, v34, v33, v6
  v_alignbyte_b32 v66, v35, v34, v6
  v_alignbyte_b32 v67, v36, v35, v6
  s_waitcnt lgkmcnt(8)
  v_mfma_f32_16x16x32_bf16 a[0:3], v[68:71], a[40:43], a[0:3]
  ds_read2_b32 v[16:17], v61 offset0:112 offset1:113
  ds_read2_b32 v[18:19], v61 offset0:114 offset1:115
  ds_read_b32 v20, v61 offset:464
  ds_read_b128 a[36:39], v4 offset:3968
  v_alignbyte_b32 v26, v39, v38, v6
  v_alignbyte_b32 v27, v40, v39, v6
  v_alignbyte_b32 v28, v41, v40, v6
  v_alignbyte_b32 v29, v42, v41, v6
  s_waitcnt lgkmcnt(8)
  v_mfma_f32_16x16x32_bf16 a[0:3], v[64:67], a[44:47], a[0:3]
  ds_read2_b32 v[32:33], v60 offset0:240 offset1:241
  ds_read2_b32 v[34:35], v60 offset0:242 offset1:243
  ds_read_b32 v36, v60 offset:976
  ds_read_b128 a[40:43], v4 offset:3904
  v_alignbyte_b32 v56, v45, v44, v6
  v_alignbyte_b32 v57, v46, v45, v6
  v_alignbyte_b32 v58, v47, v46, v6
  v_alignbyte_b32 v59, v48, v47, v6
  v_accvgpr_write_b32 a92, v56
  v_accvgpr_write_b32 a93, v57
  v_accvgpr_write_b32 a94, v58
  v_accvgpr_write_b32 a95, v59
  s_waitcnt lgkmcnt(8)
  v_mfma_f32_16x16x32_bf16 a[28:31], v[26:29], a[32:35], 0
  ds_read2_b32 v[38:39], v60 offset0:112 offset1:113
  ds_read2_b32 v[40:41], v60 offset0:114 offset1:115
  ds_read_b32 v42, v60 offset:464
  ds_read_b128 a[44:47], v4 offset:3840
  ds_read_b64 v[224:225], v7 offset:0
  ds_read_b64 v[226:227], v8 offset:0
  v_accvgpr_read_b32 v96, a0
  v_accvgpr_read_b32 v97, a1
  v_accvgpr_read_b32 v98, a2
  v_accvgpr_read_b32 v99, a3
  s_waitcnt lgkmcnt(0)
  v_lshlrev_b32 v128, 16, v224
  v_and_b32 v129, 0xffff0000, v224
  v_lshlrev_b32 v130, 16, v225
  v_and_b32 v131, 0xffff0000, v225
  v_lshlrev_b32 v192, 16, v226
  v_and_b32 v193, 0xffff0000, v226
  v_lshlrev_b32 v194, 16, v227
  v_and_b32 v195, 0xffff0000, v227
  v_mul_f32 v160, v128, v31
  v_mul_f32 v161, v129, v31
  v_mul_f32 v162, v130, v31
  v_mul_f32 v163, v131, v31
  v_fmac_f32 v96, s61, v128
  v_fmac_f32 v97, s61, v129
  v_fmac_f32 v98, s61, v130
  v_fmac_f32 v99, s61, v131
  v_cvt_pk_bf16_f32 v224, v160, v161
  v_cvt_pk_bf16_f32 v225, v162, v163
  v_lshlrev_b32 v160, 16, v224
  v_and_b32 v161, 0xffff0000, v224
  v_lshlrev_b32 v162, 16, v225
  v_and_b32 v163, 0xffff0000, v225
  v_cvt_pk_bf16_f32 v224, v96, v97
  v_cvt_pk_bf16_f32 v225, v98, v99
  v_lshlrev_b32 v96, 16, v224
  v_and_b32 v97, 0xffff0000, v224
  v_lshlrev_b32 v98, 16, v225
  v_and_b32 v99, 0xffff0000, v225
  v_add_f32 v96, v96, v160
  v_add_f32 v97, v97, v161
  v_add_f32 v98, v98, v162
  v_add_f32 v99, v99, v163
  v_cvt_pk_bf16_f32 v224, v96, v97
  v_cvt_pk_bf16_f32 v225, v98, v99
  v_lshlrev_b32 v96, 16, v224
  v_and_b32 v97, 0xffff0000, v224
  v_lshlrev_b32 v98, 16, v225
  v_and_b32 v99, 0xffff0000, v225
  v_add_f32 v96, v96, v192
  v_add_f32 v97, v97, v193
  v_add_f32 v98, v98, v194
  v_add_f32 v99, v99, v195
  v_cvt_pk_bf16_f32 v224, v96, v97
  v_cvt_pk_bf16_f32 v225, v98, v99
  s_add_u32 s6, s62, 0
  buffer_store_dwordx2 v[224:225], v9, s[8:11], s6 offen sc1
  v_alignbyte_b32 v252, v11, v10, v6
  v_alignbyte_b32 v253, v12, v11, v6
  v_alignbyte_b32 v254, v13, v12, v6
  v_alignbyte_b32 v255, v14, v13, v6
  v_mfma_f32_16x16x32_bf16 a[24:27], a[92:95], a[32:35], 0
  ds_read2_b32 v[44:45], v5 offset0:240 offset1:241
  ds_read2_b32 v[46:47], v5 offset0:242 offset1:243
  ds_read_b32 v48, v5 offset:976
  v_alignbyte_b32 v220, v17, v16, v6
  v_alignbyte_b32 v221, v18, v17, v6
  v_alignbyte_b32 v222, v19, v18, v6
  v_alignbyte_b32 v223, v20, v19, v6
  v_mfma_f32_16x16x32_bf16 a[20:23], v[252:255], a[32:35], 0
  ds_read2_b32 v[10:11], v62 offset0:224 offset1:225
  ds_read2_b32 v[12:13], v62 offset0:226 offset1:227
  ds_read_b32 v14, v62 offset:912
  v_alignbyte_b32 v188, v33, v32, v6
  v_alignbyte_b32 v189, v34, v33, v6
  v_alignbyte_b32 v190, v35, v34, v6
  v_alignbyte_b32 v191, v36, v35, v6
  v_mfma_f32_16x16x32_bf16 a[16:19], v[220:223], a[32:35], 0
  ds_read2_b32 v[16:17], v62 offset0:96 offset1:97
  ds_read2_b32 v[18:19], v62 offset0:98 offset1:99
  ds_read_b32 v20, v62 offset:400
  v_alignbyte_b32 v156, v39, v38, v6
  v_alignbyte_b32 v157, v40, v39, v6
  v_alignbyte_b32 v158, v41, v40, v6
  v_alignbyte_b32 v159, v42, v41, v6
  v_mfma_f32_16x16x32_bf16 a[12:15], v[188:191], a[32:35], 0
  ds_read2_b32 v[32:33], v61 offset0:224 offset1:225
  ds_read2_b32 v[34:35], v61 offset0:226 offset1:227
  ds_read_b32 v36, v61 offset:912
  s_waitcnt lgkmcnt(9)
  v_alignbyte_b32 v124, v45, v44, v6
  v_alignbyte_b32 v125, v46, v45, v6
  v_alignbyte_b32 v126, v47, v46, v6
  v_alignbyte_b32 v127, v48, v47, v6
  v_mfma_f32_16x16x32_bf16 a[8:11], v[156:159], a[32:35], 0
  ds_read2_b32 v[38:39], v61 offset0:96 offset1:97
  ds_read2_b32 v[40:41], v61 offset0:98 offset1:99
  ds_read_b32 v42, v61 offset:400
  s_waitcnt lgkmcnt(9)
  v_alignbyte_b32 v22, v11, v10, v6
  v_alignbyte_b32 v23, v12, v11, v6
  v_alignbyte_b32 v24, v13, v12, v6
  v_alignbyte_b32 v25, v14, v13, v6
  v_mfma_f32_16x16x32_bf16 a[4:7], v[124:127], a[32:35], 0
  ds_read2_b32 v[44:45], v60 offset0:224 offset1:225
  ds_read2_b32 v[46:47], v60 offset0:226 offset1:227
  ds_read_b32 v48, v60 offset:912
  s_waitcnt lgkmcnt(9)
  v_alignbyte_b32 v56, v17, v16, v6
  v_alignbyte_b32 v57, v18, v17, v6
  v_alignbyte_b32 v58, v19, v18, v6
  v_alignbyte_b32 v59, v20, v19, v6
  v_accvgpr_write_b32 a88, v56
  v_accvgpr_write_b32 a89, v57
  v_accvgpr_write_b32 a90, v58
  v_accvgpr_write_b32 a91, v59
  v_mfma_f32_16x16x32_bf16 a[28:31], v[22:25], a[36:39], a[28:31]
  ds_read2_b32 v[10:11], v60 offset0:96 offset1:97
  ds_read2_b32 v[12:13], v60 offset0:98 offset1:99
  ds_read_b32 v14, v60 offset:400
  ds_read_b128 a[32:35], v4 offset:3776
  s_waitcnt lgkmcnt(10)
  v_alignbyte_b32 v248, v33, v32, v6
  v_alignbyte_b32 v249, v34, v33, v6
  v_alignbyte_b32 v250, v35, v34, v6
  v_alignbyte_b32 v251, v36, v35, v6
  v_mfma_f32_16x16x32_bf16 a[24:27], a[88:91], a[36:39], a[24:27]
  ds_read2_b32 v[16:17], v5 offset0:224 offset1:225
  ds_read2_b32 v[18:19], v5 offset0:226 offset1:227
  ds_read_b32 v20, v5 offset:912
  s_waitcnt lgkmcnt(10)
  v_alignbyte_b32 v216, v39, v38, v6
  v_alignbyte_b32 v217, v40, v39, v6
  v_alignbyte_b32 v218, v41, v40, v6
  v_alignbyte_b32 v219, v42, v41, v6
  v_mfma_f32_16x16x32_bf16 a[20:23], v[248:251], a[36:39], a[20:23]
  ds_read2_b32 v[32:33], v62 offset0:208 offset1:209
  ds_read2_b32 v[34:35], v62 offset0:210 offset1:211
  ds_read_b32 v36, v62 offset:848
  s_waitcnt lgkmcnt(10)
  v_alignbyte_b32 v184, v45, v44, v6
  v_alignbyte_b32 v185, v46, v45, v6
  v_alignbyte_b32 v186, v47, v46, v6
  v_alignbyte_b32 v187, v48, v47, v6
  v_mfma_f32_16x16x32_bf16 a[16:19], v[216:219], a[36:39], a[16:19]
  ds_read2_b32 v[38:39], v62 offset0:80 offset1:81
  ds_read2_b32 v[40:41], v62 offset0:82 offset1:83
  ds_read_b32 v42, v62 offset:336
  s_waitcnt lgkmcnt(10)
  v_alignbyte_b32 v152, v11, v10, v6
  v_alignbyte_b32 v153, v12, v11, v6
  v_alignbyte_b32 v154, v13, v12, v6
  v_alignbyte_b32 v155, v14, v13, v6
  v_mfma_f32_16x16x32_bf16 a[12:15], v[184:187], a[36:39], a[12:15]
  ds_read2_b32 v[44:45], v61 offset0:208 offset1:209
  ds_read2_b32 v[46:47], v61 offset0:210 offset1:211
  ds_read_b32 v48, v61 offset:848
  s_waitcnt lgkmcnt(9)
  v_alignbyte_b32 v120, v17, v16, v6
  v_alignbyte_b32 v121, v18, v17, v6
  v_alignbyte_b32 v122, v19, v18, v6
  v_alignbyte_b32 v123, v20, v19, v6
  v_mfma_f32_16x16x32_bf16 a[8:11], v[152:155], a[36:39], a[8:11]
  ds_read2_b32 v[10:11], v61 offset0:80 offset1:81
  ds_read2_b32 v[12:13], v61 offset0:82 offset1:83
  ds_read_b32 v14, v61 offset:336
  s_waitcnt lgkmcnt(9)
  v_alignbyte_b32 v26, v33, v32, v6
  v_alignbyte_b32 v27, v34, v33, v6
  v_alignbyte_b32 v28, v35, v34, v6
  v_alignbyte_b32 v29, v36, v35, v6
  v_mfma_f32_16x16x32_bf16 a[4:7], v[120:123], a[36:39], a[4:7]
  ds_read2_b32 v[16:17], v60 offset0:208 offset1:209
  ds_read2_b32 v[18:19], v60 offset0:210 offset1:211
  ds_read_b32 v20, v60 offset:848
  s_waitcnt lgkmcnt(9)
  v_alignbyte_b32 v56, v39, v38, v6
  v_alignbyte_b32 v57, v40, v39, v6
  v_alignbyte_b32 v58, v41, v40, v6
  v_alignbyte_b32 v59, v42, v41, v6
  v_accvgpr_write_b32 a84, v56
  v_accvgpr_write_b32 a85, v57
  v_accvgpr_write_b32 a86, v58
  v_accvgpr_write_b32 a87, v59
  v_mfma_f32_16x16x32_bf16 a[28:31], v[26:29], a[40:43], a[28:31]
  ds_read2_b32 v[32:33], v60 offset0:80 offset1:81
  ds_read2_b32 v[34:35], v60 offset0:82 offset1:83
  ds_read_b32 v36, v60 offset:336
  ds_read_b128 a[36:39], v4 offset:3712
  s_lshl_b32 s6, s60, 2
  s_add_u32 s6, s6, 0x710000
  v_mov_b32 v226, 8
  s_waitcnt vmcnt(0)
  s_mov_b64 exec, 1
  buffer_store_dword v226, v1, s[8:11], s6 offen sc1
  s_mov_b64 exec, -1
  s_waitcnt lgkmcnt(10)
  v_alignbyte_b32 v244, v45, v44, v6
  v_alignbyte_b32 v245, v46, v45, v6
  v_alignbyte_b32 v246, v47, v46, v6
  v_alignbyte_b32 v247, v48, v47, v6
  v_mfma_f32_16x16x32_bf16 a[24:27], a[84:87], a[40:43], a[24:27]
  ds_read2_b32 v[38:39], v5 offset0:208 offset1:209
  ds_read2_b32 v[40:41], v5 offset0:210 offset1:211
  ds_read_b32 v42, v5 offset:848
  s_waitcnt lgkmcnt(10)
  v_alignbyte_b32 v212, v11, v10, v6
  v_alignbyte_b32 v213, v12, v11, v6
  v_alignbyte_b32 v214, v13, v12, v6
  v_alignbyte_b32 v215, v14, v13, v6
  v_mfma_f32_16x16x32_bf16 a[20:23], v[244:247], a[40:43], a[20:23]
  ds_read2_b32 v[44:45], v62 offset0:192 offset1:193
  ds_read2_b32 v[46:47], v62 offset0:194 offset1:195
  ds_read_b32 v48, v62 offset:784
  s_waitcnt lgkmcnt(10)
  v_alignbyte_b32 v180, v17, v16, v6
  v_alignbyte_b32 v181, v18, v17, v6
  v_alignbyte_b32 v182, v19, v18, v6
  v_alignbyte_b32 v183, v20, v19, v6
  v_mfma_f32_16x16x32_bf16 a[16:19], v[212:215], a[40:43], a[16:19]
  ds_read2_b32 v[10:11], v62 offset0:64 offset1:65
  ds_read2_b32 v[12:13], v62 offset0:66 offset1:67
  ds_read_b32 v14, v62 offset:272
  s_waitcnt lgkmcnt(10)
  v_alignbyte_b32 v148, v33, v32, v6
  v_alignbyte_b32 v149, v34, v33, v6
  v_alignbyte_b32 v150, v35, v34, v6
  v_alignbyte_b32 v151, v36, v35, v6
  v_mfma_f32_16x16x32_bf16 a[12:15], v[180:183], a[40:43], a[12:15]
  ds_read2_b32 v[16:17], v61 offset0:192 offset1:193
  ds_read2_b32 v[18:19], v61 offset0:194 offset1:195
  ds_read_b32 v20, v61 offset:784
  s_waitcnt lgkmcnt(9)
  v_alignbyte_b32 v116, v39, v38, v6
  v_alignbyte_b32 v117, v40, v39, v6
  v_alignbyte_b32 v118, v41, v40, v6
  v_alignbyte_b32 v119, v42, v41, v6
  v_mfma_f32_16x16x32_bf16 a[8:11], v[148:151], a[40:43], a[8:11]
  ds_read2_b32 v[32:33], v61 offset0:64 offset1:65
  ds_read2_b32 v[34:35], v61 offset0:66 offset1:67
  ds_read_b32 v36, v61 offset:272
  s_waitcnt lgkmcnt(9)
  v_alignbyte_b32 v22, v45, v44, v6
  v_alignbyte_b32 v23, v46, v45, v6
  v_alignbyte_b32 v24, v47, v46, v6
  v_alignbyte_b32 v25, v48, v47, v6
  v_mfma_f32_16x16x32_bf16 a[4:7], v[116:119], a[40:43], a[4:7]
  ds_read2_b32 v[38:39], v60 offset0:192 offset1:193
  ds_read2_b32 v[40:41], v60 offset0:194 offset1:195
  ds_read_b32 v42, v60 offset:784
  s_waitcnt lgkmcnt(9)
  v_alignbyte_b32 v56, v11, v10, v6
  v_alignbyte_b32 v57, v12, v11, v6
  v_alignbyte_b32 v58, v13, v12, v6
  v_alignbyte_b32 v59, v14, v13, v6
  v_accvgpr_write_b32 a80, v56
  v_accvgpr_write_b32 a81, v57
  v_accvgpr_write_b32 a82, v58
  v_accvgpr_write_b32 a83, v59
  v_mfma_f32_16x16x32_bf16 a[28:31], v[22:25], a[44:47], a[28:31]
  ds_read2_b32 v[44:45], v60 offset0:64 offset1:65
  ds_read2_b32 v[46:47], v60 offset0:66 offset1:67
  ds_read_b32 v48, v60 offset:272
  ds_read_b128 a[40:43], v4 offset:3648
  s_waitcnt lgkmcnt(10)
  v_alignbyte_b32 v240, v17, v16, v6
  v_alignbyte_b32 v241, v18, v17, v6
  v_alignbyte_b32 v242, v19, v18, v6
  v_alignbyte_b32 v243, v20, v19, v6
  v_mfma_f32_16x16x32_bf16 a[24:27], a[80:83], a[44:47], a[24:27]
  ds_read2_b32 v[10:11], v5 offset0:192 offset1:193
  ds_read2_b32 v[12:13], v5 offset0:194 offset1:195
  ds_read_b32 v14, v5 offset:784
  s_waitcnt lgkmcnt(10)
  v_alignbyte_b32 v208, v33, v32, v6
  v_alignbyte_b32 v209, v34, v33, v6
  v_alignbyte_b32 v210, v35, v34, v6
  v_alignbyte_b32 v211, v36, v35, v6
  v_mfma_f32_16x16x32_bf16 a[20:23], v[240:243], a[44:47], a[20:23]
  ds_read2_b32 v[16:17], v62 offset0:176 offset1:177
  ds_read2_b32 v[18:19], v62 offset0:178 offset1:179
  ds_read_b32 v20, v62 offset:720
  s_waitcnt lgkmcnt(10)
  v_alignbyte_b32 v176, v39, v38, v6
  v_alignbyte_b32 v177, v40, v39, v6
  v_alignbyte_b32 v178, v41, v40, v6
  v_alignbyte_b32 v179, v42, v41, v6
  v_mfma_f32_16x16x32_bf16 a[16:19], v[208:211], a[44:47], a[16:19]
  ds_read2_b32 v[32:33], v62 offset0:48 offset1:49
  ds_read2_b32 v[34:35], v62 offset0:50 offset1:51
  ds_read_b32 v36, v62 offset:208
  s_waitcnt lgkmcnt(10)
  v_alignbyte_b32 v144, v45, v44, v6
  v_alignbyte_b32 v145, v46, v45, v6
  v_alignbyte_b32 v146, v47, v46, v6
  v_alignbyte_b32 v147, v48, v47, v6
  v_mfma_f32_16x16x32_bf16 a[12:15], v[176:179], a[44:47], a[12:15]
  ds_read2_b32 v[38:39], v61 offset0:176 offset1:177
  ds_read2_b32 v[40:41], v61 offset0:178 offset1:179
  ds_read_b32 v42, v61 offset:720
  s_waitcnt lgkmcnt(9)
  v_alignbyte_b32 v112, v11, v10, v6
  v_alignbyte_b32 v113, v12, v11, v6
  v_alignbyte_b32 v114, v13, v12, v6
  v_alignbyte_b32 v115, v14, v13, v6
  v_mfma_f32_16x16x32_bf16 a[8:11], v[144:147], a[44:47], a[8:11]
  ds_read2_b32 v[44:45], v61 offset0:48 offset1:49
  ds_read2_b32 v[46:47], v61 offset0:50 offset1:51
  ds_read_b32 v48, v61 offset:208
  s_waitcnt lgkmcnt(9)
  v_alignbyte_b32 v26, v17, v16, v6
  v_alignbyte_b32 v27, v18, v17, v6
  v_alignbyte_b32 v28, v19, v18, v6
  v_alignbyte_b32 v29, v20, v19, v6
  v_mfma_f32_16x16x32_bf16 a[4:7], v[112:115], a[44:47], a[4:7]
  ds_read2_b32 v[10:11], v60 offset0:176 offset1:177
  ds_read2_b32 v[12:13], v60 offset0:178 offset1:179
  ds_read_b32 v14, v60 offset:720
  s_waitcnt lgkmcnt(9)
  v_alignbyte_b32 v56, v33, v32, v6
  v_alignbyte_b32 v57, v34, v33, v6
  v_alignbyte_b32 v58, v35, v34, v6
  v_alignbyte_b32 v59, v36, v35, v6
  v_accvgpr_write_b32 a76, v56
  v_accvgpr_write_b32 a77, v57
  v_accvgpr_write_b32 a78, v58
  v_accvgpr_write_b32 a79, v59
  v_mfma_f32_16x16x32_bf16 a[28:31], v[26:29], a[32:35], a[28:31]
  ds_read2_b32 v[16:17], v60 offset0:48 offset1:49
  ds_read2_b32 v[18:19], v60 offset0:50 offset1:51
  ds_read_b32 v20, v60 offset:208
  ds_read_b128 a[44:47], v4 offset:3584
  s_waitcnt lgkmcnt(10)
  v_alignbyte_b32 v236, v39, v38, v6
  v_alignbyte_b32 v237, v40, v39, v6
  v_alignbyte_b32 v238, v41, v40, v6
  v_alignbyte_b32 v239, v42, v41, v6
  v_mfma_f32_16x16x32_bf16 a[24:27], a[76:79], a[32:35], a[24:27]
  ds_read2_b32 v[32:33], v5 offset0:176 offset1:177
  ds_read2_b32 v[34:35], v5 offset0:178 offset1:179
  ds_read_b32 v36, v5 offset:720
  s_waitcnt lgkmcnt(10)
  v_alignbyte_b32 v204, v45, v44, v6
  v_alignbyte_b32 v205, v46, v45, v6
  v_alignbyte_b32 v206, v47, v46, v6
  v_alignbyte_b32 v207, v48, v47, v6
  v_mfma_f32_16x16x32_bf16 a[20:23], v[236:239], a[32:35], a[20:23]
  ds_read2_b32 v[38:39], v62 offset0:160 offset1:161
  ds_read2_b32 v[40:41], v62 offset0:162 offset1:163
  ds_read_b32 v42, v62 offset:656
  s_waitcnt lgkmcnt(10)
  v_alignbyte_b32 v172, v11, v10, v6
  v_alignbyte_b32 v173, v12, v11, v6
  v_alignbyte_b32 v174, v13, v12, v6
  v_alignbyte_b32 v175, v14, v13, v6
  v_mfma_f32_16x16x32_bf16 a[16:19], v[204:207], a[32:35], a[16:19]
  ds_read2_b32 v[44:45], v62 offset0:32 offset1:33
  ds_read2_b32 v[46:47], v62 offset0:34 offset1:35
  ds_read_b32 v48, v62 offset:144
  s_waitcnt lgkmcnt(10)
  v_alignbyte_b32 v140, v17, v16, v6
  v_alignbyte_b32 v141, v18, v17, v6
  v_alignbyte_b32 v142, v19, v18, v6
  v_alignbyte_b32 v143, v20, v19, v6
  v_mfma_f32_16x16x32_bf16 a[12:15], v[172:175], a[32:35], a[12:15]
  ds_read2_b32 v[10:11], v61 offset0:160 offset1:161
  ds_read2_b32 v[12:13], v61 offset0:162 offset1:163
  ds_read_b32 v14, v61 offset:656
  s_waitcnt lgkmcnt(9)
  v_alignbyte_b32 v108, v33, v32, v6
  v_alignbyte_b32 v109, v34, v33, v6
  v_alignbyte_b32 v110, v35, v34, v6
  v_alignbyte_b32 v111, v36, v35, v6
  v_mfma_f32_16x16x32_bf16 a[8:11], v[140:143], a[32:35], a[8:11]
  ds_read2_b32 v[16:17], v61 offset0:32 offset1:33
  ds_read2_b32 v[18:19], v61 offset0:34 offset1:35
  ds_read_b32 v20, v61 offset:144
  s_waitcnt lgkmcnt(9)
  v_alignbyte_b32 v22, v39, v38, v6
  v_alignbyte_b32 v23, v40, v39, v6
  v_alignbyte_b32 v24, v41, v40, v6
  v_alignbyte_b32 v25, v42, v41, v6
  v_mfma_f32_16x16x32_bf16 a[4:7], v[108:111], a[32:35], a[4:7]
  ds_read2_b32 v[32:33], v60 offset0:160 offset1:161
  ds_read2_b32 v[34:35], v60 offset0:162 offset1:163
  ds_read_b32 v36, v60 offset:656
  s_waitcnt lgkmcnt(9)
  v_alignbyte_b32 v56, v45, v44, v6
  v_alignbyte_b32 v57, v46, v45, v6
  v_alignbyte_b32 v58, v47, v46, v6
  v_alignbyte_b32 v59, v48, v47, v6
  v_accvgpr_write_b32 a72, v56
  v_accvgpr_write_b32 a73, v57
  v_accvgpr_write_b32 a74, v58
  v_accvgpr_write_b32 a75, v59
  v_mfma_f32_16x16x32_bf16 a[28:31], v[22:25], a[36:39], a[28:31]
  ds_read2_b32 v[38:39], v60 offset0:32 offset1:33
  ds_read2_b32 v[40:41], v60 offset0:34 offset1:35
  ds_read_b32 v42, v60 offset:144
  ds_read_b128 a[32:35], v4 offset:3520
  s_waitcnt lgkmcnt(10)
  v_alignbyte_b32 v232, v11, v10, v6
  v_alignbyte_b32 v233, v12, v11, v6
  v_alignbyte_b32 v234, v13, v12, v6
  v_alignbyte_b32 v235, v14, v13, v6
  v_mfma_f32_16x16x32_bf16 a[24:27], a[72:75], a[36:39], a[24:27]
  ds_read2_b32 v[44:45], v5 offset0:160 offset1:161
  ds_read2_b32 v[46:47], v5 offset0:162 offset1:163
  ds_read_b32 v48, v5 offset:656
  s_waitcnt lgkmcnt(10)
  v_alignbyte_b32 v200, v17, v16, v6
  v_alignbyte_b32 v201, v18, v17, v6
  v_alignbyte_b32 v202, v19, v18, v6
  v_alignbyte_b32 v203, v20, v19, v6
  v_mfma_f32_16x16x32_bf16 a[20:23], v[232:235], a[36:39], a[20:23]
  ds_read2_b32 v[10:11], v62 offset0:144 offset1:145
  ds_read2_b32 v[12:13], v62 offset0:146 offset1:147
  ds_read_b32 v14, v62 offset:592
  s_waitcnt lgkmcnt(10)
  v_alignbyte_b32 v168, v33, v32, v6
  v_alignbyte_b32 v169, v34, v33, v6
  v_alignbyte_b32 v170, v35, v34, v6
  v_alignbyte_b32 v171, v36, v35, v6
  v_mfma_f32_16x16x32_bf16 a[16:19], v[200:203], a[36:39], a[16:19]
  ds_read2_b32 v[16:17], v62 offset0:16 offset1:17
  ds_read2_b32 v[18:19], v62 offset0:18 offset1:19
  ds_read_b32 v20, v62 offset:80
  s_waitcnt lgkmcnt(10)
  v_alignbyte_b32 v136, v39, v38, v6
  v_alignbyte_b32 v137, v40, v39, v6
  v_alignbyte_b32 v138, v41, v40, v6
  v_alignbyte_b32 v139, v42, v41, v6
  v_mfma_f32_16x16x32_bf16 a[12:15], v[168:171], a[36:39], a[12:15]
  ds_read2_b32 v[32:33], v61 offset0:144 offset1:145
  ds_read2_b32 v[34:35], v61 offset0:146 offset1:147
  ds_read_b32 v36, v61 offset:592
  s_waitcnt lgkmcnt(9)
  v_alignbyte_b32 v104, v45, v44, v6
  v_alignbyte_b32 v105, v46, v45, v6
  v_alignbyte_b32 v106, v47, v46, v6
  v_alignbyte_b32 v107, v48, v47, v6
  v_mfma_f32_16x16x32_bf16 a[8:11], v[136:139], a[36:39], a[8:11]
  ds_read2_b32 v[38:39], v61 offset0:16 offset1:17
  ds_read2_b32 v[40:41], v61 offset0:18 offset1:19
  ds_read_b32 v42, v61 offset:80
  s_waitcnt lgkmcnt(9)
  v_alignbyte_b32 v26, v11, v10, v6
  v_alignbyte_b32 v27, v12, v11, v6
  v_alignbyte_b32 v28, v13, v12, v6
  v_alignbyte_b32 v29, v14, v13, v6
  v_mfma_f32_16x16x32_bf16 a[4:7], v[104:107], a[36:39], a[4:7]
  ds_read2_b32 v[44:45], v60 offset0:144 offset1:145
  ds_read2_b32 v[46:47], v60 offset0:146 offset1:147
  ds_read_b32 v48, v60 offset:592
  s_waitcnt lgkmcnt(9)
  v_alignbyte_b32 v56, v17, v16, v6
  v_alignbyte_b32 v57, v18, v17, v6
  v_alignbyte_b32 v58, v19, v18, v6
  v_alignbyte_b32 v59, v20, v19, v6
  v_accvgpr_write_b32 a68, v56
  v_accvgpr_write_b32 a69, v57
  v_accvgpr_write_b32 a70, v58
  v_accvgpr_write_b32 a71, v59
  v_mfma_f32_16x16x32_bf16 a[28:31], v[26:29], a[40:43], a[28:31]
  ds_read2_b32 v[10:11], v60 offset0:16 offset1:17
  ds_read2_b32 v[12:13], v60 offset0:18 offset1:19
  ds_read_b32 v14, v60 offset:80
  ds_read_b128 a[36:39], v4 offset:3456
  s_waitcnt lgkmcnt(10)
  v_alignbyte_b32 v228, v33, v32, v6
  v_alignbyte_b32 v229, v34, v33, v6
  v_alignbyte_b32 v230, v35, v34, v6
  v_alignbyte_b32 v231, v36, v35, v6
  v_mfma_f32_16x16x32_bf16 a[24:27], a[68:71], a[40:43], a[24:27]
  ds_read2_b32 v[16:17], v5 offset0:144 offset1:145
  ds_read2_b32 v[18:19], v5 offset0:146 offset1:147
  ds_read_b32 v20, v5 offset:592
  s_waitcnt lgkmcnt(10)
  v_alignbyte_b32 v196, v39, v38, v6
  v_alignbyte_b32 v197, v40, v39, v6
  v_alignbyte_b32 v198, v41, v40, v6
  v_alignbyte_b32 v199, v42, v41, v6
  v_mfma_f32_16x16x32_bf16 a[20:23], v[228:231], a[40:43], a[20:23]
  ds_read2_b32 v[32:33], v62 offset0:128 offset1:129
  ds_read2_b32 v[34:35], v62 offset0:130 offset1:131
  ds_read_b32 v36, v62 offset:528
  s_waitcnt lgkmcnt(10)
  v_alignbyte_b32 v164, v45, v44, v6
  v_alignbyte_b32 v165, v46, v45, v6
  v_alignbyte_b32 v166, v47, v46, v6
  v_alignbyte_b32 v167, v48, v47, v6
  v_mfma_f32_16x16x32_bf16 a[16:19], v[196:199], a[40:43], a[16:19]
  ds_read2_b32 v[38:39], v62 offset0:0 offset1:1
  ds_read2_b32 v[40:41], v62 offset0:2 offset1:3
  ds_read_b32 v42, v62 offset:16
  s_waitcnt lgkmcnt(10)
  v_alignbyte_b32 v132, v11, v10, v6
  v_alignbyte_b32 v133, v12, v11, v6
  v_alignbyte_b32 v134, v13, v12, v6
  v_alignbyte_b32 v135, v14, v13, v6
  v_mfma_f32_16x16x32_bf16 a[12:15], v[164:167], a[40:43], a[12:15]
  ds_read2_b32 v[44:45], v61 offset0:128 offset1:129
  ds_read2_b32 v[46:47], v61 offset0:130 offset1:131
  ds_read_b32 v48, v61 offset:528
  s_waitcnt lgkmcnt(9)
  v_alignbyte_b32 v100, v17, v16, v6
  v_alignbyte_b32 v101, v18, v17, v6
  v_alignbyte_b32 v102, v19, v18, v6
  v_alignbyte_b32 v103, v20, v19, v6
  v_mfma_f32_16x16x32_bf16 a[8:11], v[132:135], a[40:43], a[8:11]
  ds_read2_b32 v[10:11], v61 offset0:0 offset1:1
  ds_read2_b32 v[12:13], v61 offset0:2 offset1:3
  ds_read_b32 v14, v61 offset:16
  s_waitcnt lgkmcnt(9)
  v_alignbyte_b32 v22, v33, v32, v6
  v_alignbyte_b32 v23, v34, v33, v6
  v_alignbyte_b32 v24, v35, v34, v6
  v_alignbyte_b32 v25, v36, v35, v6
  v_mfma_f32_16x16x32_bf16 a[4:7], v[100:103], a[40:43], a[4:7]
  ds_read2_b32 v[16:17], v60 offset0:128 offset1:129
  ds_read2_b32 v[18:19], v60 offset0:130 offset1:131
  ds_read_b32 v20, v60 offset:528
  s_waitcnt lgkmcnt(9)
  v_alignbyte_b32 v56, v39, v38, v6
  v_alignbyte_b32 v57, v40, v39, v6
  v_alignbyte_b32 v58, v41, v40, v6
  v_alignbyte_b32 v59, v42, v41, v6
  v_accvgpr_write_b32 a64, v56
  v_accvgpr_write_b32 a65, v57
  v_accvgpr_write_b32 a66, v58
  v_accvgpr_write_b32 a67, v59
  v_mfma_f32_16x16x32_bf16 a[28:31], v[22:25], a[44:47], a[28:31]
  ds_read2_b32 v[32:33], v60 offset0:0 offset1:1
  ds_read2_b32 v[34:35], v60 offset0:2 offset1:3
  ds_read_b32 v36, v60 offset:16
  ds_read_b128 a[40:43], v4 offset:3392
  s_waitcnt lgkmcnt(10)
  v_alignbyte_b32 v224, v45, v44, v6
  v_alignbyte_b32 v225, v46, v45, v6
  v_alignbyte_b32 v226, v47, v46, v6
  v_alignbyte_b32 v227, v48, v47, v6
  v_mfma_f32_16x16x32_bf16 a[24:27], a[64:67], a[44:47], a[24:27]
  ds_read2_b32 v[38:39], v5 offset0:128 offset1:129
  ds_read2_b32 v[40:41], v5 offset0:130 offset1:131
  ds_read_b32 v42, v5 offset:528
  s_waitcnt lgkmcnt(10)
  v_alignbyte_b32 v192, v11, v10, v6
  v_alignbyte_b32 v193, v12, v11, v6
  v_alignbyte_b32 v194, v13, v12, v6
  v_alignbyte_b32 v195, v14, v13, v6
  v_mfma_f32_16x16x32_bf16 a[20:23], v[224:227], a[44:47], a[20:23]
  s_waitcnt lgkmcnt(7)
  v_alignbyte_b32 v160, v17, v16, v6
  v_alignbyte_b32 v161, v18, v17, v6
  v_alignbyte_b32 v162, v19, v18, v6
  v_alignbyte_b32 v163, v20, v19, v6
  v_mfma_f32_16x16x32_bf16 a[16:19], v[192:195], a[44:47], a[16:19]
  s_waitcnt lgkmcnt(4)
  v_alignbyte_b32 v128, v33, v32, v6
  v_alignbyte_b32 v129, v34, v33, v6
  v_alignbyte_b32 v130, v35, v34, v6
  v_alignbyte_b32 v131, v36, v35, v6
  v_mfma_f32_16x16x32_bf16 a[12:15], v[160:163], a[44:47], a[12:15]
  s_waitcnt lgkmcnt(0)
  v_alignbyte_b32 v96, v39, v38, v6
  v_alignbyte_b32 v97, v40, v39, v6
  v_alignbyte_b32 v98, v41, v40, v6
  v_alignbyte_b32 v99, v42, v41, v6
  v_mfma_f32_16x16x32_bf16 a[8:11], v[128:131], a[44:47], a[8:11]
  s_nop 0
  v_mfma_f32_16x16x32_bf16 a[4:7], v[96:99], a[44:47], a[4:7]
  v_mfma_f32_16x16x32_bf16 a[28:31], a[92:95], a[32:35], a[28:31]
  ds_read_b128 a[44:47], v4 offset:3328
  v_mfma_f32_16x16x32_bf16 a[24:27], v[252:255], a[32:35], a[24:27]
  v_mfma_f32_16x16x32_bf16 a[20:23], v[220:223], a[32:35], a[20:23]
  v_mfma_f32_16x16x32_bf16 a[16:19], v[188:191], a[32:35], a[16:19]
  v_mfma_f32_16x16x32_bf16 a[12:15], v[156:159], a[32:35], a[12:15]
  v_mfma_f32_16x16x32_bf16 a[8:11], v[124:127], a[32:35], a[8:11]
  v_mfma_f32_16x16x32_bf16 a[4:7], v[92:95], a[32:35], a[4:7]
  v_mfma_f32_16x16x32_bf16 a[28:31], a[88:91], a[36:39], a[28:31]
  ds_read_b128 a[32:35], v4 offset:3264
  v_mfma_f32_16x16x32_bf16 a[24:27], v[248:251], a[36:39], a[24:27]
  v_mfma_f32_16x16x32_bf16 a[20:23], v[216:219], a[36:39], a[20:23]
  v_mfma_f32_16x16x32_bf16 a[16:19], v[184:187], a[36:39], a[16:19]
  v_mfma_f32_16x16x32_bf16 a[12:15], v[152:155], a[36:39], a[12:15]
  v_mfma_f32_16x16x32_bf16 a[8:11], v[120:123], a[36:39], a[8:11]
  v_mfma_f32_16x16x32_bf16 a[4:7], v[88:91], a[36:39], a[4:7]
  v_mfma_f32_16x16x32_bf16 a[28:31], a[84:87], a[40:43], a[28:31]
  ds_read_b128 a[36:39], v4 offset:3200
  v_mfma_f32_16x16x32_bf16 a[24:27], v[244:247], a[40:43], a[24:27]
  v_mfma_f32_16x16x32_bf16 a[20:23], v[212:215], a[40:43], a[20:23]
  v_mfma_f32_16x16x32_bf16 a[16:19], v[180:183], a[40:43], a[16:19]
  v_mfma_f32_16x16x32_bf16 a[12:15], v[148:151], a[40:43], a[12:15]
  v_mfma_f32_16x16x32_bf16 a[8:11], v[116:119], a[40:43], a[8:11]
  v_mfma_f32_16x16x32_bf16 a[4:7], v[84:87], a[40:43], a[4:7]
  s_waitcnt lgkmcnt(2)
  v_mfma_f32_16x16x32_bf16 a[28:31], a[80:83], a[44:47], a[28:31]
  ds_read_b128 a[40:43], v4 offset:3136
  v_mfma_f32_16x16x32_bf16 a[24:27], v[240:243], a[44:47], a[24:27]
  v_mfma_f32_16x16x32_bf16 a[20:23], v[208:211], a[44:47], a[20:23]
  v_mfma_f32_16x16x32_bf16 a[16:19], v[176:179], a[44:47], a[16:19]
  v_mfma_f32_16x16x32_bf16 a[12:15], v[144:147], a[44:47], a[12:15]
  v_mfma_f32_16x16x32_bf16 a[8:11], v[112:115], a[44:47], a[8:11]
  v_mfma_f32_16x16x32_bf16 a[4:7], v[80:83], a[44:47], a[4:7]
  s_waitcnt lgkmcnt(2)
  v_mfma_f32_16x16x32_bf16 a[28:31], a[76:79], a[32:35], a[28:31]
  ds_read_b128 a[44:47], v4 offset:3072
  v_mfma_f32_16x16x32_bf16 a[24:27], v[236:239], a[32:35], a[24:27]
  v_mfma_f32_16x16x32_bf16 a[20:23], v[204:207], a[32:35], a[20:23]
  v_mfma_f32_16x16x32_bf16 a[16:19], v[172:175], a[32:35], a[16:19]
  v_mfma_f32_16x16x32_bf16 a[12:15], v[140:143], a[32:35], a[12:15]
  v_mfma_f32_16x16x32_bf16 a[8:11], v[108:111], a[32:35], a[8:11]
  v_mfma_f32_16x16x32_bf16 a[4:7], v[76:79], a[32:35], a[4:7]
  s_waitcnt lgkmcnt(2)
  v_mfma_f32_16x16x32_bf16 a[28:31], a[72:75], a[36:39], a[28:31]
  ds_read_b128 a[32:35], v4 offset:3008
  v_mfma_f32_16x16x32_bf16 a[24:27], v[232:235], a[36:39], a[24:27]
  v_mfma_f32_16x16x32_bf16 a[20:23], v[200:203], a[36:39], a[20:23]
  v_mfma_f32_16x16x32_bf16 a[16:19], v[168:171], a[36:39], a[16:19]
  v_mfma_f32_16x16x32_bf16 a[12:15], v[136:139], a[36:39], a[12:15]
  v_mfma_f32_16x16x32_bf16 a[8:11], v[104:107], a[36:39], a[8:11]
  v_mfma_f32_16x16x32_bf16 a[4:7], v[72:75], a[36:39], a[4:7]
  s_waitcnt lgkmcnt(2)
  v_mfma_f32_16x16x32_bf16 a[28:31], a[68:71], a[40:43], a[28:31]
  ds_read_b128 a[36:39], v4 offset:2944
  v_mfma_f32_16x16x32_bf16 a[24:27], v[228:231], a[40:43], a[24:27]
  v_mfma_f32_16x16x32_bf16 a[20:23], v[196:199], a[40:43], a[20:23]
  v_mfma_f32_16x16x32_bf16 a[16:19], v[164:167], a[40:43], a[16:19]
  v_mfma_f32_16x16x32_bf16 a[12:15], v[132:135], a[40:43], a[12:15]
  v_mfma_f32_16x16x32_bf16 a[8:11], v[100:103], a[40:43], a[8:11]
  v_mfma_f32_16x16x32_bf16 a[4:7], v[68:71], a[40:43], a[4:7]
  s_waitcnt lgkmcnt(2)
  v_mfma_f32_16x16x32_bf16 a[28:31], a[64:67], a[44:47], a[28:31]
  ds_read_b128 a[40:43], v4 offset:2880
  v_mfma_f32_16x16x32_bf16 a[24:27], v[224:227], a[44:47], a[24:27]
  v_mfma_f32_16x16x32_bf16 a[20:23], v[192:195], a[44:47], a[20:23]
  v_mfma_f32_16x16x32_bf16 a[16:19], v[160:163], a[44:47], a[16:19]
  v_mfma_f32_16x16x32_bf16 a[12:15], v[128:131], a[44:47], a[12:15]
  v_mfma_f32_16x16x32_bf16 a[8:11], v[96:99], a[44:47], a[8:11]
  v_mfma_f32_16x16x32_bf16 a[4:7], v[64:67], a[44:47], a[4:7]
  s_waitcnt lgkmcnt(2)
  v_mfma_f32_16x16x32_bf16 a[28:31], v[252:255], a[32:35], a[28:31]
  ds_read_b128 a[44:47], v4 offset:2816
  ds_read_b64 v[36:37], v7 offset:512
  ds_read_b64 v[38:39], v8 offset:512
  s_nop 2
  v_accvgpr_read_b32 v44, a4
  v_accvgpr_read_b32 v45, a5
  v_mfma_f32_16x16x32_bf16 a[24:27], v[220:223], a[32:35], a[24:27]
  v_accvgpr_read_b32 v46, a6
  v_accvgpr_read_b32 v47, a7
  v_mfma_f32_16x16x32_bf16 a[20:23], v[188:191], a[32:35], a[20:23]
  s_waitcnt lgkmcnt(0)
  v_lshlrev_b32 v48, 16, v36
  v_and_b32 v49, 0xffff0000, v36
  v_mfma_f32_16x16x32_bf16 a[16:19], v[156:159], a[32:35], a[16:19]
  v_lshlrev_b32 v50, 16, v37
  v_and_b32 v51, 0xffff0000, v37
  v_mfma_f32_16x16x32_bf16 a[12:15], v[124:127], a[32:35], a[12:15]
  v_lshlrev_b32 v32, 16, v38
  v_and_b32 v33, 0xffff0000, v38
  v_mfma_f32_16x16x32_bf16 a[8:11], v[92:95], a[32:35], a[8:11]
  v_lshlrev_b32 v34, 16, v39
  v_and_b32 v35, 0xffff0000, v39
  v_mfma_f32_16x16x32_bf16 a[28:31], v[248:251], a[36:39], a[28:31]
  ds_read_b128 a[32:35], v4 offset:2752
  v_mul_f32 v52, v48, v31
  v_mul_f32 v53, v49, v31
  v_mfma_f32_16x16x32_bf16 a[24:27], v[216:219], a[36:39], a[24:27]
  v_mul_f32 v54, v50, v31
  v_mul_f32 v55, v51, v31
  v_mfma_f32_16x16x32_bf16 a[20:23], v[184:187], a[36:39], a[20:23]
  v_fmac_f32 v44, s61, v48
  v_fmac_f32 v45, s61, v49
  v_mfma_f32_16x16x32_bf16 a[16:19], v[152:155], a[36:39], a[16:19]
  v_fmac_f32 v46, s61, v50
  v_fmac_f32 v47, s61, v51
  v_mfma_f32_16x16x32_bf16 a[12:15], v[120:123], a[36:39], a[12:15]
  v_cvt_pk_bf16_f32 v36, v52, v53
  v_cvt_pk_bf16_f32 v37, v54, v55
  v_mfma_f32_16x16x32_bf16 a[8:11], v[88:91], a[36:39], a[8:11]
  v_lshlrev_b32 v52, 16, v36
  v_and_b32 v53, 0xffff0000, v36
  v_mfma_f32_16x16x32_bf16 a[28:31], v[244:247], a[40:43], a[28:31]
  ds_read_b128 a[36:39], v4 offset:2688
  v_lshlrev_b32 v54, 16, v37
  v_and_b32 v55, 0xffff0000, v37
  v_mfma_f32_16x16x32_bf16 a[24:27], v[212:215], a[40:43], a[24:27]
  v_cvt_pk_bf16_f32 v36, v44, v45
  v_cvt_pk_bf16_f32 v37, v46, v47
  v_mfma_f32_16x16x32_bf16 a[20:23], v[180:183], a[40:43], a[20:23]
  v_lshlrev_b32 v44, 16, v36
  v_and_b32 v45, 0xffff0000, v36
  v_mfma_f32_16x16x32_bf16 a[16:19], v[148:151], a[40:43], a[16:19]
  v_lshlrev_b32 v46, 16, v37
  v_and_b32 v47, 0xffff0000, v37
  v_mfma_f32_16x16x32_bf16 a[12:15], v[116:119], a[40:43], a[12:15]
  v_add_f32 v44, v44, v52
  v_add_f32 v45, v45, v53
  v_mfma_f32_16x16x32_bf16 a[8:11], v[84:87], a[40:43], a[8:11]
  v_add_f32 v46, v46, v54
  v_add_f32 v47, v47, v55
  v_mfma_f32_16x16x32_bf16 a[28:31], v[240:243], a[44:47], a[28:31]
  ds_read_b128 a[40:43], v4 offset:2624
  v_cvt_pk_bf16_f32 v36, v44, v45
  v_cvt_pk_bf16_f32 v37, v46, v47
  v_mfma_f32_16x16x32_bf16 a[24:27], v[208:211], a[44:47], a[24:27]
  v_lshlrev_b32 v44, 16, v36
  v_and_b32 v45, 0xffff0000, v36
  v_mfma_f32_16x16x32_bf16 a[20:23], v[176:179], a[44:47], a[20:23]
  v_lshlrev_b32 v46, 16, v37
  v_and_b32 v47, 0xffff0000, v37
  v_mfma_f32_16x16x32_bf16 a[16:19], v[144:147], a[44:47], a[16:19]
  v_add_f32 v44, v44, v32
  v_add_f32 v45, v45, v33
  v_mfma_f32_16x16x32_bf16 a[12:15], v[112:115], a[44:47], a[12:15]
  v_add_f32 v46, v46, v34
  v_add_f32 v47, v47, v35
  v_mfma_f32_16x16x32_bf16 a[8:11], v[80:83], a[44:47], a[8:11]
  v_cvt_pk_bf16_f32 v36, v44, v45
  v_cvt_pk_bf16_f32 v37, v46, v47
  s_waitcnt lgkmcnt(2)
  v_mfma_f32_16x16x32_bf16 a[28:31], v[236:239], a[32:35], a[28:31]
  ds_read_b128 a[44:47], v4 offset:2560
  s_add_u32 s6, s62, 262144
  buffer_store_dwordx2 v[36:37], v9, s[8:11], s6 offen sc1
  v_mfma_f32_16x16x32_bf16 a[24:27], v[204:207], a[32:35], a[24:27]
  v_mfma_f32_16x16x32_bf16 a[20:23], v[172:175], a[32:35], a[20:23]
  v_mfma_f32_16x16x32_bf16 a[16:19], v[140:143], a[32:35], a[16:19]
  v_mfma_f32_16x16x32_bf16 a[12:15], v[108:111], a[32:35], a[12:15]
  v_mfma_f32_16x16x32_bf16 a[8:11], v[76:79], a[32:35], a[8:11]
  s_waitcnt lgkmcnt(2)
  v_mfma_f32_16x16x32_bf16 a[28:31], v[232:235], a[36:39], a[28:31]
  ds_read_b128 a[32:35], v4 offset:2496
  v_mfma_f32_16x16x32_bf16 a[24:27], v[200:203], a[36:39], a[24:27]
  v_mfma_f32_16x16x32_bf16 a[20:23], v[168:171], a[36:39], a[20:23]
  v_mfma_f32_16x16x32_bf16 a[16:19], v[136:139], a[36:39], a[16:19]
  v_mfma_f32_16x16x32_bf16 a[12:15], v[104:107], a[36:39], a[12:15]
  v_mfma_f32_16x16x32_bf16 a[8:11], v[72:75], a[36:39], a[8:11]
  s_waitcnt lgkmcnt(2)
  v_mfma_f32_16x16x32_bf16 a[28:31], v[228:231], a[40:43], a[28:31]
  ds_read_b128 a[36:39], v4 offset:2432
  v_mfma_f32_16x16x32_bf16 a[24:27], v[196:199], a[40:43], a[24:27]
  v_mfma_f32_16x16x32_bf16 a[20:23], v[164:167], a[40:43], a[20:23]
  v_mfma_f32_16x16x32_bf16 a[16:19], v[132:135], a[40:43], a[16:19]
  v_mfma_f32_16x16x32_bf16 a[12:15], v[100:103], a[40:43], a[12:15]
  v_mfma_f32_16x16x32_bf16 a[8:11], v[68:71], a[40:43], a[8:11]
  s_waitcnt lgkmcnt(2)
  v_mfma_f32_16x16x32_bf16 a[28:31], v[224:227], a[44:47], a[28:31]
  ds_read_b128 a[40:43], v4 offset:2368
  v_mfma_f32_16x16x32_bf16 a[24:27], v[192:195], a[44:47], a[24:27]
  v_mfma_f32_16x16x32_bf16 a[20:23], v[160:163], a[44:47], a[20:23]
  v_mfma_f32_16x16x32_bf16 a[16:19], v[128:131], a[44:47], a[16:19]
  v_mfma_f32_16x16x32_bf16 a[12:15], v[96:99], a[44:47], a[12:15]
  v_mfma_f32_16x16x32_bf16 a[8:11], v[64:67], a[44:47], a[8:11]
  s_waitcnt lgkmcnt(2)
  v_mfma_f32_16x16x32_bf16 a[28:31], v[220:223], a[32:35], a[28:31]
  ds_read_b128 a[44:47], v4 offset:2304
  ds_read_b64 v[36:37], v7 offset:1024
  ds_read_b64 v[38:39], v8 offset:1024
  s_nop 2
  v_accvgpr_read_b32 v44, a8
  v_accvgpr_read_b32 v45, a9
  v_mfma_f32_16x16x32_bf16 a[24:27], v[188:191], a[32:35], a[24:27]
  v_accvgpr_read_b32 v46, a10
  v_accvgpr_read_b32 v47, a11
  v_mfma_f32_16x16x32_bf16 a[20:23], v[156:159], a[32:35], a[20:23]
  s_waitcnt lgkmcnt(0)
  v_lshlrev_b32 v48, 16, v36
  v_and_b32 v49, 0xffff0000, v36
  v_mfma_f32_16x16x32_bf16 a[16:19], v[124:127], a[32:35], a[16:19]
  v_lshlrev_b32 v50, 16, v37
  v_and_b32 v51, 0xffff0000, v37
  v_mfma_f32_16x16x32_bf16 a[12:15], v[92:95], a[32:35], a[12:15]
  v_lshlrev_b32 v32, 16, v38
  v_and_b32 v33, 0xffff0000, v38
  v_mfma_f32_16x16x32_bf16 a[28:31], v[216:219], a[36:39], a[28:31]
  ds_read_b128 a[32:35], v4 offset:2240
  v_lshlrev_b32 v34, 16, v39
  v_and_b32 v35, 0xffff0000, v39
  v_mfma_f32_16x16x32_bf16 a[24:27], v[184:187], a[36:39], a[24:27]
  v_mul_f32 v52, v48, v31
  v_mul_f32 v53, v49, v31
  v_mfma_f32_16x16x32_bf16 a[20:23], v[152:155], a[36:39], a[20:23]
  v_mul_f32 v54, v50, v31
  v_mul_f32 v55, v51, v31
  v_mfma_f32_16x16x32_bf16 a[16:19], v[120:123], a[36:39], a[16:19]
  v_fmac_f32 v44, s61, v48
  v_fmac_f32 v45, s61, v49
  v_mfma_f32_16x16x32_bf16 a[12:15], v[88:91], a[36:39], a[12:15]
  v_fmac_f32 v46, s61, v50
  v_fmac_f32 v47, s61, v51
  v_mfma_f32_16x16x32_bf16 a[28:31], v[212:215], a[40:43], a[28:31]
  ds_read_b128 a[36:39], v4 offset:2176
  v_cvt_pk_bf16_f32 v36, v52, v53
  v_cvt_pk_bf16_f32 v37, v54, v55
  v_mfma_f32_16x16x32_bf16 a[24:27], v[180:183], a[40:43], a[24:27]
  v_lshlrev_b32 v52, 16, v36
  v_and_b32 v53, 0xffff0000, v36
  v_mfma_f32_16x16x32_bf16 a[20:23], v[148:151], a[40:43], a[20:23]
  v_lshlrev_b32 v54, 16, v37
  v_and_b32 v55, 0xffff0000, v37
  v_mfma_f32_16x16x32_bf16 a[16:19], v[116:119], a[40:43], a[16:19]
  v_cvt_pk_bf16_f32 v36, v44, v45
  v_cvt_pk_bf16_f32 v37, v46, v47
  v_mfma_f32_16x16x32_bf16 a[12:15], v[84:87], a[40:43], a[12:15]
  v_lshlrev_b32 v44, 16, v36
  v_and_b32 v45, 0xffff0000, v36
  v_mfma_f32_16x16x32_bf16 a[28:31], v[208:211], a[44:47], a[28:31]
  ds_read_b128 a[40:43], v4 offset:2112
  v_lshlrev_b32 v46, 16, v37
  v_and_b32 v47, 0xffff0000, v37
  v_mfma_f32_16x16x32_bf16 a[24:27], v[176:179], a[44:47], a[24:27]
  v_add_f32 v44, v44, v52
  v_add_f32 v45, v45, v53
  v_mfma_f32_16x16x32_bf16 a[20:23], v[144:147], a[44:47], a[20:23]
  v_add_f32 v46, v46, v54
  v_add_f32 v47, v47, v55
  v_mfma_f32_16x16x32_bf16 a[16:19], v[112:115], a[44:47], a[16:19]
  v_cvt_pk_bf16_f32 v36, v44, v45
  v_cvt_pk_bf16_f32 v37, v46, v47
  v_mfma_f32_16x16x32_bf16 a[12:15], v[80:83], a[44:47], a[12:15]
  v_lshlrev_b32 v44, 16, v36
  v_and_b32 v45, 0xffff0000, v36
  s_waitcnt lgkmcnt(2)
  v_mfma_f32_16x16x32_bf16 a[28:31], v[204:207], a[32:35], a[28:31]
  ds_read_b128 a[44:47], v4 offset:2048
  v_lshlrev_b32 v46, 16, v37
  v_and_b32 v47, 0xffff0000, v37
  v_mfma_f32_16x16x32_bf16 a[24:27], v[172:175], a[32:35], a[24:27]
  v_add_f32 v44, v44, v32
  v_add_f32 v45, v45, v33
  v_mfma_f32_16x16x32_bf16 a[20:23], v[140:143], a[32:35], a[20:23]
  v_add_f32 v46, v46, v34
  v_add_f32 v47, v47, v35
  v_mfma_f32_16x16x32_bf16 a[16:19], v[108:111], a[32:35], a[16:19]
  v_cvt_pk_bf16_f32 v36, v44, v45
  v_cvt_pk_bf16_f32 v37, v46, v47
  v_mfma_f32_16x16x32_bf16 a[12:15], v[76:79], a[32:35], a[12:15]
  s_add_u32 s6, s62, 524288
  buffer_store_dwordx2 v[36:37], v9, s[8:11], s6 offen sc1
  s_waitcnt lgkmcnt(2)
  v_mfma_f32_16x16x32_bf16 a[28:31], v[200:203], a[36:39], a[28:31]
  ds_read_b128 a[32:35], v4 offset:1984
  v_mfma_f32_16x16x32_bf16 a[24:27], v[168:171], a[36:39], a[24:27]
  v_mfma_f32_16x16x32_bf16 a[20:23], v[136:139], a[36:39], a[20:23]
  v_mfma_f32_16x16x32_bf16 a[16:19], v[104:107], a[36:39], a[16:19]
  v_mfma_f32_16x16x32_bf16 a[12:15], v[72:75], a[36:39], a[12:15]
  s_waitcnt lgkmcnt(2)
  v_mfma_f32_16x16x32_bf16 a[28:31], v[196:199], a[40:43], a[28:31]
  ds_read_b128 a[36:39], v4 offset:1920
  v_mfma_f32_16x16x32_bf16 a[24:27], v[164:167], a[40:43], a[24:27]
  v_mfma_f32_16x16x32_bf16 a[20:23], v[132:135], a[40:43], a[20:23]
  v_mfma_f32_16x16x32_bf16 a[16:19], v[100:103], a[40:43], a[16:19]
  v_mfma_f32_16x16x32_bf16 a[12:15], v[68:71], a[40:43], a[12:15]
  s_waitcnt lgkmcnt(2)
  v_mfma_f32_16x16x32_bf16 a[28:31], v[192:195], a[44:47], a[28:31]
  ds_read_b128 a[40:43], v4 offset:1856
  v_mfma_f32_16x16x32_bf16 a[24:27], v[160:163], a[44:47], a[24:27]
  v_mfma_f32_16x16x32_bf16 a[20:23], v[128:131], a[44:47], a[20:23]
  v_mfma_f32_16x16x32_bf16 a[16:19], v[96:99], a[44:47], a[16:19]
  v_mfma_f32_16x16x32_bf16 a[12:15], v[64:67], a[44:47], a[12:15]
  s_waitcnt lgkmcnt(2)
  v_mfma_f32_16x16x32_bf16 a[28:31], v[188:191], a[32:35], a[28:31]
  ds_read_b128 a[44:47], v4 offset:1792
  ds_read_b64 v[36:37], v7 offset:1536
  ds_read_b64 v[38:39], v8 offset:1536
  s_nop 2
  v_accvgpr_read_b32 v44, a12
  v_accvgpr_read_b32 v45, a13
  v_mfma_f32_16x16x32_bf16 a[24:27], v[156:159], a[32:35], a[24:27]
  v_accvgpr_read_b32 v46, a14
  v_accvgpr_read_b32 v47, a15
  v_mfma_f32_16x16x32_bf16 a[20:23], v[124:127], a[32:35], a[20:23]
  s_waitcnt lgkmcnt(0)
  v_lshlrev_b32 v48, 16, v36
  v_and_b32 v49, 0xffff0000, v36
  v_mfma_f32_16x16x32_bf16 a[16:19], v[92:95], a[32:35], a[16:19]
  v_lshlrev_b32 v50, 16, v37
  v_and_b32 v51, 0xffff0000, v37
  v_mfma_f32_16x16x32_bf16 a[28:31], v[184:187], a[36:39], a[28:31]
  ds_read_b128 a[32:35], v4 offset:1728
  v_lshlrev_b32 v32, 16, v38
  v_and_b32 v33, 0xffff0000, v38
  v_mfma_f32_16x16x32_bf16 a[24:27], v[152:155], a[36:39], a[24:27]
  v_lshlrev_b32 v34, 16, v39
  v_and_b32 v35, 0xffff0000, v39
  v_mfma_f32_16x16x32_bf16 a[20:23], v[120:123], a[36:39], a[20:23]
  v_mul_f32 v52, v48, v31
  v_mul_f32 v53, v49, v31
  v_mfma_f32_16x16x32_bf16 a[16:19], v[88:91], a[36:39], a[16:19]
  v_mul_f32 v54, v50, v31
  v_mul_f32 v55, v51, v31
  v_mfma_f32_16x16x32_bf16 a[28:31], v[180:183], a[40:43], a[28:31]
  ds_read_b128 a[36:39], v4 offset:1664
  v_fmac_f32 v44, s61, v48
  v_fmac_f32 v45, s61, v49
  v_mfma_f32_16x16x32_bf16 a[24:27], v[148:151], a[40:43], a[24:27]
  v_fmac_f32 v46, s61, v50
  v_fmac_f32 v47, s61, v51
  v_mfma_f32_16x16x32_bf16 a[20:23], v[116:119], a[40:43], a[20:23]
  v_cvt_pk_bf16_f32 v36, v52, v53
  v_cvt_pk_bf16_f32 v37, v54, v55
  v_mfma_f32_16x16x32_bf16 a[16:19], v[84:87], a[40:43], a[16:19]
  v_lshlrev_b32 v52, 16, v36
  v_and_b32 v53, 0xffff0000, v36
  v_mfma_f32_16x16x32_bf16 a[28:31], v[176:179], a[44:47], a[28:31]
  ds_read_b128 a[40:43], v4 offset:1600
  v_lshlrev_b32 v54, 16, v37
  v_and_b32 v55, 0xffff0000, v37
  v_mfma_f32_16x16x32_bf16 a[24:27], v[144:147], a[44:47], a[24:27]
  v_cvt_pk_bf16_f32 v36, v44, v45
  v_cvt_pk_bf16_f32 v37, v46, v47
  v_mfma_f32_16x16x32_bf16 a[20:23], v[112:115], a[44:47], a[20:23]
  v_lshlrev_b32 v44, 16, v36
  v_and_b32 v45, 0xffff0000, v36
  v_mfma_f32_16x16x32_bf16 a[16:19], v[80:83], a[44:47], a[16:19]
  v_lshlrev_b32 v46, 16, v37
  v_and_b32 v47, 0xffff0000, v37
  s_waitcnt lgkmcnt(2)
  v_mfma_f32_16x16x32_bf16 a[28:31], v[172:175], a[32:35], a[28:31]
  ds_read_b128 a[44:47], v4 offset:1536
  v_add_f32 v44, v44, v52
  v_add_f32 v45, v45, v53
  v_mfma_f32_16x16x32_bf16 a[24:27], v[140:143], a[32:35], a[24:27]
  v_add_f32 v46, v46, v54
  v_add_f32 v47, v47, v55
  v_mfma_f32_16x16x32_bf16 a[20:23], v[108:111], a[32:35], a[20:23]
  v_cvt_pk_bf16_f32 v36, v44, v45
  v_cvt_pk_bf16_f32 v37, v46, v47
  v_mfma_f32_16x16x32_bf16 a[16:19], v[76:79], a[32:35], a[16:19]
  v_lshlrev_b32 v44, 16, v36
  v_and_b32 v45, 0xffff0000, v36
  s_waitcnt lgkmcnt(2)
  v_mfma_f32_16x16x32_bf16 a[28:31], v[168:171], a[36:39], a[28:31]
  ds_read_b128 a[32:35], v4 offset:1472
  v_lshlrev_b32 v46, 16, v37
  v_and_b32 v47, 0xffff0000, v37
  v_mfma_f32_16x16x32_bf16 a[24:27], v[136:139], a[36:39], a[24:27]
  v_add_f32 v44, v44, v32
  v_add_f32 v45, v45, v33
  v_mfma_f32_16x16x32_bf16 a[20:23], v[104:107], a[36:39], a[20:23]
  v_add_f32 v46, v46, v34
  v_add_f32 v47, v47, v35
  v_mfma_f32_16x16x32_bf16 a[16:19], v[72:75], a[36:39], a[16:19]
  v_cvt_pk_bf16_f32 v36, v44, v45
  v_cvt_pk_bf16_f32 v37, v46, v47
  s_waitcnt lgkmcnt(2)
  v_mfma_f32_16x16x32_bf16 a[28:31], v[164:167], a[40:43], a[28:31]
  ds_read_b128 a[36:39], v4 offset:1408
  s_add_u32 s6, s62, 786432
  buffer_store_dwordx2 v[36:37], v9, s[8:11], s6 offen sc1
  v_mfma_f32_16x16x32_bf16 a[24:27], v[132:135], a[40:43], a[24:27]
  v_mfma_f32_16x16x32_bf16 a[20:23], v[100:103], a[40:43], a[20:23]
  v_mfma_f32_16x16x32_bf16 a[16:19], v[68:71], a[40:43], a[16:19]
  s_waitcnt lgkmcnt(2)
  v_mfma_f32_16x16x32_bf16 a[28:31], v[160:163], a[44:47], a[28:31]
  ds_read_b128 a[40:43], v4 offset:1344
  v_mfma_f32_16x16x32_bf16 a[24:27], v[128:131], a[44:47], a[24:27]
  v_mfma_f32_16x16x32_bf16 a[20:23], v[96:99], a[44:47], a[20:23]
  v_mfma_f32_16x16x32_bf16 a[16:19], v[64:67], a[44:47], a[16:19]
  s_waitcnt lgkmcnt(2)
  v_mfma_f32_16x16x32_bf16 a[28:31], v[156:159], a[32:35], a[28:31]
  ds_read_b128 a[44:47], v4 offset:1280
  ds_read_b64 v[36:37], v7 offset:2048
  ds_read_b64 v[38:39], v8 offset:2048
  s_nop 2
  v_accvgpr_read_b32 v44, a16
  v_accvgpr_read_b32 v45, a17
  v_mfma_f32_16x16x32_bf16 a[24:27], v[124:127], a[32:35], a[24:27]
  v_accvgpr_read_b32 v46, a18
  v_accvgpr_read_b32 v47, a19
  v_mfma_f32_16x16x32_bf16 a[20:23], v[92:95], a[32:35], a[20:23]
  s_waitcnt lgkmcnt(0)
  v_lshlrev_b32 v48, 16, v36
  v_and_b32 v49, 0xffff0000, v36
  v_mfma_f32_16x16x32_bf16 a[28:31], v[152:155], a[36:39], a[28:31]
  ds_read_b128 a[32:35], v4 offset:1216
  v_lshlrev_b32 v50, 16, v37
  v_and_b32 v51, 0xffff0000, v37
  v_mfma_f32_16x16x32_bf16 a[24:27], v[120:123], a[36:39], a[24:27]
  v_lshlrev_b32 v32, 16, v38
  v_and_b32 v33, 0xffff0000, v38
  v_mfma_f32_16x16x32_bf16 a[20:23], v[88:91], a[36:39], a[20:23]
  v_lshlrev_b32 v34, 16, v39
  v_and_b32 v35, 0xffff0000, v39
  v_mfma_f32_16x16x32_bf16 a[28:31], v[148:151], a[40:43], a[28:31]
  ds_read_b128 a[36:39], v4 offset:1152
  v_mul_f32 v52, v48, v31
  v_mul_f32 v53, v49, v31
  v_mfma_f32_16x16x32_bf16 a[24:27], v[116:119], a[40:43], a[24:27]
  v_mul_f32 v54, v50, v31
  v_mul_f32 v55, v51, v31
  v_mfma_f32_16x16x32_bf16 a[20:23], v[84:87], a[40:43], a[20:23]
  v_fmac_f32 v44, s61, v48
  v_fmac_f32 v45, s61, v49
  v_mfma_f32_16x16x32_bf16 a[28:31], v[144:147], a[44:47], a[28:31]
  ds_read_b128 a[40:43], v4 offset:1088
  v_fmac_f32 v46, s61, v50
  v_fmac_f32 v47, s61, v51
  v_mfma_f32_16x16x32_bf16 a[24:27], v[112:115], a[44:47], a[24:27]
  v_cvt_pk_bf16_f32 v36, v52, v53
  v_cvt_pk_bf16_f32 v37, v54, v55
  v_mfma_f32_16x16x32_bf16 a[20:23], v[80:83], a[44:47], a[20:23]
  v_lshlrev_b32 v52, 16, v36
  v_and_b32 v53, 0xffff0000, v36
  s_waitcnt lgkmcnt(2)
  v_mfma_f32_16x16x32_bf16 a[28:31], v[140:143], a[32:35], a[28:31]
  ds_read_b128 a[44:47], v4 offset:1024
  v_lshlrev_b32 v54, 16, v37
  v_and_b32 v55, 0xffff0000, v37
  v_mfma_f32_16x16x32_bf16 a[24:27], v[108:111], a[32:35], a[24:27]
  v_cvt_pk_bf16_f32 v36, v44, v45
  v_cvt_pk_bf16_f32 v37, v46, v47
  v_mfma_f32_16x16x32_bf16 a[20:23], v[76:79], a[32:35], a[20:23]
  v_lshlrev_b32 v44, 16, v36
  v_and_b32 v45, 0xffff0000, v36
  s_waitcnt lgkmcnt(2)
  v_mfma_f32_16x16x32_bf16 a[28:31], v[136:139], a[36:39], a[28:31]
  ds_read_b128 a[32:35], v4 offset:960
  v_lshlrev_b32 v46, 16, v37
  v_and_b32 v47, 0xffff0000, v37
  v_mfma_f32_16x16x32_bf16 a[24:27], v[104:107], a[36:39], a[24:27]
  v_add_f32 v44, v44, v52
  v_add_f32 v45, v45, v53
  v_mfma_f32_16x16x32_bf16 a[20:23], v[72:75], a[36:39], a[20:23]
  v_add_f32 v46, v46, v54
  v_add_f32 v47, v47, v55
  s_waitcnt lgkmcnt(2)
  v_mfma_f32_16x16x32_bf16 a[28:31], v[132:135], a[40:43], a[28:31]
  ds_read_b128 a[36:39], v4 offset:896
  v_cvt_pk_bf16_f32 v36, v44, v45
  v_cvt_pk_bf16_f32 v37, v46, v47
  v_mfma_f32_16x16x32_bf16 a[24:27], v[100:103], a[40:43], a[24:27]
  v_lshlrev_b32 v44, 16, v36
  v_and_b32 v45, 0xffff0000, v36
  v_mfma_f32_16x16x32_bf16 a[20:23], v[68:71], a[40:43], a[20:23]
  v_lshlrev_b32 v46, 16, v37
  v_and_b32 v47, 0xffff0000, v37
  s_waitcnt lgkmcnt(2)
  v_mfma_f32_16x16x32_bf16 a[28:31], v[128:131], a[44:47], a[28:31]
  ds_read_b128 a[40:43], v4 offset:832
  v_add_f32 v44, v44, v32
  v_add_f32 v45, v45, v33
  v_mfma_f32_16x16x32_bf16 a[24:27], v[96:99], a[44:47], a[24:27]
  v_add_f32 v46, v46, v34
  v_add_f32 v47, v47, v35
  v_mfma_f32_16x16x32_bf16 a[20:23], v[64:67], a[44:47], a[20:23]
  v_cvt_pk_bf16_f32 v36, v44, v45
  v_cvt_pk_bf16_f32 v37, v46, v47
  s_waitcnt lgkmcnt(2)
  v_mfma_f32_16x16x32_bf16 a[28:31], v[124:127], a[32:35], a[28:31]
  ds_read_b128 a[44:47], v4 offset:768
  s_add_u32 s6, s62, 1048576
  buffer_store_dwordx2 v[36:37], v9, s[8:11], s6 offen sc1
  v_mfma_f32_16x16x32_bf16 a[24:27], v[92:95], a[32:35], a[24:27]
  ds_read_b64 v[36:37], v7 offset:2560
  ds_read_b64 v[38:39], v8 offset:2560
  v_accvgpr_read_b32 v44, a20
  v_accvgpr_read_b32 v45, a21
  s_waitcnt lgkmcnt(4)
  v_mfma_f32_16x16x32_bf16 a[28:31], v[120:123], a[36:39], a[28:31]
  ds_read_b128 a[32:35], v4 offset:704
  v_accvgpr_read_b32 v46, a22
  v_accvgpr_read_b32 v47, a23
  v_mfma_f32_16x16x32_bf16 a[24:27], v[88:91], a[36:39], a[24:27]
  s_waitcnt lgkmcnt(1)
  v_lshlrev_b32 v48, 16, v36
  v_and_b32 v49, 0xffff0000, v36
  v_mfma_f32_16x16x32_bf16 a[28:31], v[116:119], a[40:43], a[28:31]
  ds_read_b128 a[36:39], v4 offset:640
  v_lshlrev_b32 v50, 16, v37
  v_and_b32 v51, 0xffff0000, v37
  v_mfma_f32_16x16x32_bf16 a[24:27], v[84:87], a[40:43], a[24:27]
  v_lshlrev_b32 v32, 16, v38
  v_and_b32 v33, 0xffff0000, v38
  v_mfma_f32_16x16x32_bf16 a[28:31], v[112:115], a[44:47], a[28:31]
  ds_read_b128 a[40:43], v4 offset:576
  v_lshlrev_b32 v34, 16, v39
  v_and_b32 v35, 0xffff0000, v39
  v_mfma_f32_16x16x32_bf16 a[24:27], v[80:83], a[44:47], a[24:27]
  v_mul_f32 v52, v48, v31
  v_mul_f32 v53, v49, v31
  s_waitcnt lgkmcnt(2)
  v_mfma_f32_16x16x32_bf16 a[28:31], v[108:111], a[32:35], a[28:31]
  ds_read_b128 a[44:47], v4 offset:512
  v_mul_f32 v54, v50, v31
  v_mul_f32 v55, v51, v31
  v_mfma_f32_16x16x32_bf16 a[24:27], v[76:79], a[32:35], a[24:27]
  v_fmac_f32 v44, s61, v48
  v_fmac_f32 v45, s61, v49
  s_waitcnt lgkmcnt(2)
  v_mfma_f32_16x16x32_bf16 a[28:31], v[104:107], a[36:39], a[28:31]
  ds_read_b128 a[32:35], v4 offset:448
  v_fmac_f32 v46, s61, v50
  v_fmac_f32 v47, s61, v51
  v_mfma_f32_16x16x32_bf16 a[24:27], v[72:75], a[36:39], a[24:27]
  v_cvt_pk_bf16_f32 v36, v52, v53
  v_cvt_pk_bf16_f32 v37, v54, v55
  s_waitcnt lgkmcnt(2)
  v_mfma_f32_16x16x32_bf16 a[28:31], v[100:103], a[40:43], a[28:31]
  ds_read_b128 a[36:39], v4 offset:384
  v_lshlrev_b32 v52, 16, v36
  v_and_b32 v53, 0xffff0000, v36
  v_mfma_f32_16x16x32_bf16 a[24:27], v[68:71], a[40:43], a[24:27]
  v_lshlrev_b32 v54, 16, v37
  v_and_b32 v55, 0xffff0000, v37
  s_waitcnt lgkmcnt(2)
  v_mfma_f32_16x16x32_bf16 a[28:31], v[96:99], a[44:47], a[28:31]
  ds_read_b128 a[40:43], v4 offset:320
  v_cvt_pk_bf16_f32 v36, v44, v45
  v_cvt_pk_bf16_f32 v37, v46, v47
  v_mfma_f32_16x16x32_bf16 a[24:27], v[64:67], a[44:47], a[24:27]
  v_lshlrev_b32 v44, 16, v36
  v_and_b32 v45, 0xffff0000, v36
  s_waitcnt lgkmcnt(2)
  v_mfma_f32_16x16x32_bf16 a[28:31], v[92:95], a[32:35], a[28:31]
  ds_read_b128 a[44:47], v4 offset:256
  v_lshlrev_b32 v46, 16, v37
  v_and_b32 v47, 0xffff0000, v37
  s_waitcnt lgkmcnt(2)
  v_mfma_f32_16x16x32_bf16 a[28:31], v[88:91], a[36:39], a[28:31]
  ds_read_b128 a[32:35], v4 offset:192
  v_add_f32 v44, v44, v52
  v_add_f32 v45, v45, v53
  s_waitcnt lgkmcnt(2)
  v_mfma_f32_16x16x32_bf16 a[28:31], v[84:87], a[40:43], a[28:31]
  ds_read_b128 a[36:39], v4 offset:128
  v_add_f32 v46, v46, v54
  v_add_f32 v47, v47, v55
  s_waitcnt lgkmcnt(2)
  v_mfma_f32_16x16x32_bf16 a[28:31], v[80:83], a[44:47], a[28:31]
  ds_read_b128 a[40:43], v4 offset:64
  v_cvt_pk_bf16_f32 v36, v44, v45
  v_cvt_pk_bf16_f32 v37, v46, v47
  s_waitcnt lgkmcnt(2)
  v_mfma_f32_16x16x32_bf16 a[28:31], v[76:79], a[32:35], a[28:31]
  ds_read_b128 a[44:47], v4 offset:0
  v_lshlrev_b32 v44, 16, v36
  v_and_b32 v45, 0xffff0000, v36
  s_waitcnt lgkmcnt(2)
  v_mfma_f32_16x16x32_bf16 a[28:31], v[72:75], a[36:39], a[28:31]
  v_lshlrev_b32 v46, 16, v37
  v_and_b32 v47, 0xffff0000, v37
  s_waitcnt lgkmcnt(1)
  v_mfma_f32_16x16x32_bf16 a[28:31], v[68:71], a[40:43], a[28:31]
  v_add_f32 v44, v44, v32
  v_add_f32 v45, v45, v33
  s_waitcnt lgkmcnt(0)
  v_mfma_f32_16x16x32_bf16 a[28:31], v[64:67], a[44:47], a[28:31]
  v_add_f32 v46, v46, v34
  v_add_f32 v47, v47, v35
  v_cvt_pk_bf16_f32 v36, v44, v45
  v_cvt_pk_bf16_f32 v37, v46, v47
  s_add_u32 s6, s62, 1310720
  buffer_store_dwordx2 v[36:37], v9, s[8:11], s6 offen sc1
  ds_read_b64 v[36:37], v7 offset:3072
  ds_read_b64 v[38:39], v8 offset:3072
  v_accvgpr_read_b32 v44, a24
  v_accvgpr_read_b32 v45, a25
  v_accvgpr_read_b32 v46, a26
  v_accvgpr_read_b32 v47, a27
  s_waitcnt lgkmcnt(0)
  v_lshlrev_b32 v48, 16, v36
  v_and_b32 v49, 0xffff0000, v36
  v_lshlrev_b32 v50, 16, v37
  v_and_b32 v51, 0xffff0000, v37
  v_lshlrev_b32 v32, 16, v38
  v_and_b32 v33, 0xffff0000, v38
  v_lshlrev_b32 v34, 16, v39
  v_and_b32 v35, 0xffff0000, v39
  v_mul_f32 v52, v48, v31
  v_mul_f32 v53, v49, v31
  v_mul_f32 v54, v50, v31
  v_mul_f32 v55, v51, v31
  v_fmac_f32 v44, s61, v48
  v_fmac_f32 v45, s61, v49
  v_fmac_f32 v46, s61, v50
  v_fmac_f32 v47, s61, v51
  v_cvt_pk_bf16_f32 v36, v52, v53
  v_cvt_pk_bf16_f32 v37, v54, v55
  v_lshlrev_b32 v52, 16, v36
  v_and_b32 v53, 0xffff0000, v36
  v_lshlrev_b32 v54, 16, v37
  v_and_b32 v55, 0xffff0000, v37
  v_cvt_pk_bf16_f32 v36, v44, v45
  v_cvt_pk_bf16_f32 v37, v46, v47
  v_lshlrev_b32 v44, 16, v36
  v_and_b32 v45, 0xffff0000, v36
  v_lshlrev_b32 v46, 16, v37
  v_and_b32 v47, 0xffff0000, v37
  v_add_f32 v44, v44, v52
  v_add_f32 v45, v45, v53
  v_add_f32 v46, v46, v54
  v_add_f32 v47, v47, v55
  v_cvt_pk_bf16_f32 v36, v44, v45
  v_cvt_pk_bf16_f32 v37, v46, v47
  v_lshlrev_b32 v44, 16, v36
  v_and_b32 v45, 0xffff0000, v36
  v_lshlrev_b32 v46, 16, v37
  v_and_b32 v47, 0xffff0000, v37
  v_add_f32 v44, v44, v32
  v_add_f32 v45, v45, v33
  v_add_f32 v46, v46, v34
  v_add_f32 v47, v47, v35
  v_cvt_pk_bf16_f32 v36, v44, v45
  v_cvt_pk_bf16_f32 v37, v46, v47
  s_add_u32 s6, s62, 1572864
  buffer_store_dwordx2 v[36:37], v9, s[8:11], s6 offen sc1
  ds_read_b64 v[36:37], v7 offset:3584
  ds_read_b64 v[38:39], v8 offset:3584
  v_accvgpr_read_b32 v44, a28
  v_accvgpr_read_b32 v45, a29
  v_accvgpr_read_b32 v46, a30
  v_accvgpr_read_b32 v47, a31
  s_waitcnt lgkmcnt(0)
  v_lshlrev_b32 v48, 16, v36
  v_and_b32 v49, 0xffff0000, v36
  v_lshlrev_b32 v50, 16, v37
  v_and_b32 v51, 0xffff0000, v37
  v_lshlrev_b32 v32, 16, v38
  v_and_b32 v33, 0xffff0000, v38
  v_lshlrev_b32 v34, 16, v39
  v_and_b32 v35, 0xffff0000, v39
  v_mul_f32 v52, v48, v31
  v_mul_f32 v53, v49, v31
  v_mul_f32 v54, v50, v31
  v_mul_f32 v55, v51, v31
  v_fmac_f32 v44, s61, v48
  v_fmac_f32 v45, s61, v49
  v_fmac_f32 v46, s61, v50
  v_fmac_f32 v47, s61, v51
  v_cvt_pk_bf16_f32 v36, v52, v53
  v_cvt_pk_bf16_f32 v37, v54, v55
  v_lshlrev_b32 v52, 16, v36
  v_and_b32 v53, 0xffff0000, v36
  v_lshlrev_b32 v54, 16, v37
  v_and_b32 v55, 0xffff0000, v37
  v_cvt_pk_bf16_f32 v36, v44, v45
  v_cvt_pk_bf16_f32 v37, v46, v47
  v_lshlrev_b32 v44, 16, v36
  v_and_b32 v45, 0xffff0000, v36
  v_lshlrev_b32 v46, 16, v37
  v_and_b32 v47, 0xffff0000, v37
  v_add_f32 v44, v44, v52
  v_add_f32 v45, v45, v53
  v_add_f32 v46, v46, v54
  v_add_f32 v47, v47, v55
  v_cvt_pk_bf16_f32 v36, v44, v45
  v_cvt_pk_bf16_f32 v37, v46, v47
  v_lshlrev_b32 v44, 16, v36
  v_and_b32 v45, 0xffff0000, v36
  v_lshlrev_b32 v46, 16, v37
  v_and_b32 v47, 0xffff0000, v37
  v_add_f32 v44, v44, v32
  v_add_f32 v45, v45, v33
  v_add_f32 v46, v46, v34
  v_add_f32 v47, v47, v35
  v_cvt_pk_bf16_f32 v36, v44, v45
  v_cvt_pk_bf16_f32 v37, v46, v47
  s_add_u32 s6, s62, 1835008
  buffer_store_dwordx2 v[36:37], v9, s[8:11], s6 offen sc1
  s_lshl_b32 s6, s60, 2
  s_add_u32 s6, s6, 0x710000
  v_mov_b32 v16, 127
  s_waitcnt vmcnt(0)
  s_mov_b64 exec, 1
  buffer_store_dword v16, v1, s[8:11], s6 offen sc1
  s_mov_b64 exec, -1
  s_barrier
  s_cmp_eq_u32 s4, 1
  s_cbranch_scc1 L_rec2
  s_cmp_eq_u32 s4, 6
  s_cbranch_scc1 L_o2
  s_branch L_p2
L_c:
  v_lshlrev_b32 v4, 2, v0
  v_lshlrev_b32 v0, 4, v0
  v_mov_b32 v1, 0
  v_mov_b32 v2, 150016
  s_lshl_b32 s6, s5, 8
  s_lshl_b32 s7, s3, 13
  s_add_u32 s6, s6, s7
  s_add_u32 s6, s6, 0x738000
  buffer_store_dword v1, v4, s[8:11], s6 offen sc1
  s_lshl_b32 s6, s5, 3
  s_add_u32 s6, s6, 0x710800
  s_mov_b64 exec, 3
  buffer_store_dword v1, v4, s[8:11], s6 offen sc1
  buffer_store_dword v1, v4, s[8:11], s6 offen offset:256 sc1
  s_mov_b64 exec, -1
  s_lshl_b32 s6, s5, 10
  s_lshl_b32 s7, s3, 15
  s_add_u32 s6, s6, s7
  s_add_u32 s6, s6, 0x8800000
  v_mov_b32 v8, 0
  v_mov_b32 v9, 0
  v_mov_b32 v10, 0
  v_mov_b32 v11, 0
  buffer_store_dwordx4 v[8:11], v0, s[8:11], s6 offen sc1
  s_add_u32 s6, s6, 0x20000
  buffer_store_dwordx4 v[8:11], v0, s[8:11], s6 offen sc1
  s_add_u32 s6, s6, 0x20000
  buffer_store_dwordx4 v[8:11], v0, s[8:11], s6 offen sc1
  s_add_u32 s6, s6, 0x20000
  buffer_store_dwordx4 v[8:11], v0, s[8:11], s6 offen sc1
  s_add_u32 s6, s6, 0x7a0000
  buffer_store_dwordx4 v[8:11], v0, s[8:11], s6 offen sc1
  s_add_u32 s6, s6, 0x20000
  buffer_store_dwordx4 v[8:11], v0, s[8:11], s6 offen sc1
  s_add_u32 s6, s6, 0x20000
  buffer_store_dwordx4 v[8:11], v0, s[8:11], s6 offen sc1
  s_add_u32 s6, s6, 0x20000
  buffer_store_dwordx4 v[8:11], v0, s[8:11], s6 offen sc1
  s_waitcnt vmcnt(0)
  s_barrier
  s_cmp_lg_u32 s3, 0
  s_cbranch_scc1 L_sd_115
  s_mov_b64 exec, 1
  s_and_b32 s6, s4, 3
  s_lshl_b32 s6, s6, 6
  v_mov_b32 v6, 16
  v_mov_b32 v7, 1
  buffer_atomic_add v7, v6, s[12:15], s6 offen sc1
  s_mov_b64 exec, -1
L_sd_115:
  v_bfe_u32 v5, v0, 5, 4
  v_mul_u32_u24 v5, 4128, v5
  v_and_b32 v6, 16, v0
  v_add3_u32 v5, v5, v6, v1
  v_add_u32 v5, 73728, v5
  ds_write_b128 v5, v[8:11]
  ds_write_b128 v2, v[8:11]
  ds_write_b128 v2, v[8:11] offset:16
  v_accvgpr_write_b32 a0, 0
  v_accvgpr_write_b32 a1, 0
  v_accvgpr_write_b32 a2, 0
  v_accvgpr_write_b32 a3, 0
  v_accvgpr_write_b32 a4, 0
  v_accvgpr_write_b32 a5, 0
  v_accvgpr_write_b32 a6, 0
  v_accvgpr_write_b32 a7, 0
  v_accvgpr_write_b32 a8, 0
  v_accvgpr_write_b32 a9, 0
  v_accvgpr_write_b32 a10, 0
  v_accvgpr_write_b32 a11, 0
  v_accvgpr_write_b32 a12, 0
  v_accvgpr_write_b32 a13, 0
  v_accvgpr_write_b32 a14, 0
  v_accvgpr_write_b32 a15, 0
  v_accvgpr_write_b32 a16, 0
  v_accvgpr_write_b32 a17, 0
  v_accvgpr_write_b32 a18, 0
  v_accvgpr_write_b32 a19, 0
  v_accvgpr_write_b32 a20, 0
  v_accvgpr_write_b32 a21, 0
  v_accvgpr_write_b32 a22, 0
  v_accvgpr_write_b32 a23, 0
  v_accvgpr_write_b32 a24, 0
  v_accvgpr_write_b32 a25, 0
  v_accvgpr_write_b32 a26, 0
  v_accvgpr_write_b32 a27, 0
  v_accvgpr_write_b32 a28, 0
  v_accvgpr_write_b32 a29, 0
  v_accvgpr_write_b32 a30, 0
  v_accvgpr_write_b32 a31, 0
  v_accvgpr_write_b32 a32, 0
  v_accvgpr_write_b32 a33, 0
  v_accvgpr_write_b32 a34, 0
  v_accvgpr_write_b32 a35, 0
  v_accvgpr_write_b32 a36, 0
  v_accvgpr_write_b32 a37, 0
  v_accvgpr_write_b32 a38, 0
  v_accvgpr_write_b32 a39, 0
  v_accvgpr_write_b32 a40, 0
  v_accvgpr_write_b32 a41, 0
  v_accvgpr_write_b32 a42, 0
  v_accvgpr_write_b32 a43, 0
  v_accvgpr_write_b32 a44, 0
  v_accvgpr_write_b32 a45, 0
  v_accvgpr_write_b32 a46, 0
  v_accvgpr_write_b32 a47, 0
  v_accvgpr_write_b32 a48, 0
  v_accvgpr_write_b32 a49, 0
  v_accvgpr_write_b32 a50, 0
  v_accvgpr_write_b32 a51, 0
  v_accvgpr_write_b32 a52, 0
  v_accvgpr_write_b32 a53, 0
  v_accvgpr_write_b32 a54, 0
  v_accvgpr_write_b32 a55, 0
  v_accvgpr_write_b32 a56, 0
  v_accvgpr_write_b32 a57, 0
  v_accvgpr_write_b32 a58, 0
  v_accvgpr_write_b32 a59, 0
  v_accvgpr_write_b32 a60, 0
  v_accvgpr_write_b32 a61, 0
  v_accvgpr_write_b32 a62, 0
  v_accvgpr_write_b32 a63, 0
  v_accvgpr_write_b32 a64, 0
  v_accvgpr_write_b32 a65, 0
  v_accvgpr_write_b32 a66, 0
  v_accvgpr_write_b32 a67, 0
  v_accvgpr_write_b32 a68, 0
  v_accvgpr_write_b32 a69, 0
  v_accvgpr_write_b32 a70, 0
  v_accvgpr_write_b32 a71, 0
  v_accvgpr_write_b32 a72, 0
  v_accvgpr_write_b32 a73, 0
  v_accvgpr_write_b32 a74, 0
  v_accvgpr_write_b32 a75, 0
  v_accvgpr_write_b32 a76, 0
  v_accvgpr_write_b32 a77, 0
  v_accvgpr_write_b32 a78, 0
  v_accvgpr_write_b32 a79, 0
  v_accvgpr_write_b32 a80, 0
  v_accvgpr_write_b32 a81, 0
  v_accvgpr_write_b32 a82, 0
  v_accvgpr_write_b32 a83, 0
  v_accvgpr_write_b32 a84, 0
  v_accvgpr_write_b32 a85, 0
  v_accvgpr_write_b32 a86, 0
  v_accvgpr_write_b32 a87, 0
  v_accvgpr_write_b32 a88, 0
  v_accvgpr_write_b32 a89, 0
  v_accvgpr_write_b32 a90, 0
  v_accvgpr_write_b32 a91, 0
  v_accvgpr_write_b32 a92, 0
  v_accvgpr_write_b32 a93, 0
  v_accvgpr_write_b32 a94, 0
  v_accvgpr_write_b32 a95, 0
  v_accvgpr_write_b32 a96, 0
  v_accvgpr_write_b32 a97, 0
  v_accvgpr_write_b32 a98, 0
  v_accvgpr_write_b32 a99, 0
  v_accvgpr_write_b32 a100, 0
  v_accvgpr_write_b32 a101, 0
  v_accvgpr_write_b32 a102, 0
  v_accvgpr_write_b32 a103, 0
  v_accvgpr_write_b32 a104, 0
  v_accvgpr_write_b32 a105, 0
  v_accvgpr_write_b32 a106, 0
  v_accvgpr_write_b32 a107, 0
  v_accvgpr_write_b32 a108, 0
  v_accvgpr_write_b32 a109, 0
  v_accvgpr_write_b32 a110, 0
  v_accvgpr_write_b32 a111, 0
  v_accvgpr_write_b32 a112, 0
  v_accvgpr_write_b32 a113, 0
  v_accvgpr_write_b32 a114, 0
  v_accvgpr_write_b32 a115, 0
  v_accvgpr_write_b32 a116, 0
  v_accvgpr_write_b32 a117, 0
  v_accvgpr_write_b32 a118, 0
  v_accvgpr_write_b32 a119, 0
  v_accvgpr_write_b32 a120, 0
  v_accvgpr_write_b32 a121, 0
  v_accvgpr_write_b32 a122, 0
  v_accvgpr_write_b32 a123, 0
  v_accvgpr_write_b32 a124, 0
  v_accvgpr_write_b32 a125, 0
  v_accvgpr_write_b32 a126, 0
  v_accvgpr_write_b32 a127, 0
  v_accvgpr_write_b32 a128, 0
  v_accvgpr_write_b32 a129, 0
  v_accvgpr_write_b32 a130, 0
  v_accvgpr_write_b32 a131, 0
  v_accvgpr_write_b32 a132, 0
  v_accvgpr_write_b32 a133, 0
  v_accvgpr_write_b32 a134, 0
  v_accvgpr_write_b32 a135, 0
  v_accvgpr_write_b32 a136, 0
  v_accvgpr_write_b32 a137, 0
  v_accvgpr_write_b32 a138, 0
  v_accvgpr_write_b32 a139, 0
  v_accvgpr_write_b32 a140, 0
  v_accvgpr_write_b32 a141, 0
  v_accvgpr_write_b32 a142, 0
  v_accvgpr_write_b32 a143, 0
  v_accvgpr_write_b32 a144, 0
  v_accvgpr_write_b32 a145, 0
  v_accvgpr_write_b32 a146, 0
  v_accvgpr_write_b32 a147, 0
  v_accvgpr_write_b32 a148, 0
  v_accvgpr_write_b32 a149, 0
  v_accvgpr_write_b32 a150, 0
  v_accvgpr_write_b32 a151, 0
  v_accvgpr_write_b32 a152, 0
  v_accvgpr_write_b32 a153, 0
  v_accvgpr_write_b32 a154, 0
  v_accvgpr_write_b32 a155, 0
  v_accvgpr_write_b32 a156, 0
  v_accvgpr_write_b32 a157, 0
  v_accvgpr_write_b32 a158, 0
  v_accvgpr_write_b32 a159, 0
  v_accvgpr_write_b32 a160, 0
  v_accvgpr_write_b32 a161, 0
  v_accvgpr_write_b32 a162, 0
  v_accvgpr_write_b32 a163, 0
  v_accvgpr_write_b32 a164, 0
  v_accvgpr_write_b32 a165, 0
  v_accvgpr_write_b32 a166, 0
  v_accvgpr_write_b32 a167, 0
  v_accvgpr_write_b32 a168, 0
  v_accvgpr_write_b32 a169, 0
  v_accvgpr_write_b32 a170, 0
  v_accvgpr_write_b32 a171, 0
  v_accvgpr_write_b32 a172, 0
  v_accvgpr_write_b32 a173, 0
  v_accvgpr_write_b32 a174, 0
  v_accvgpr_write_b32 a175, 0
  v_accvgpr_write_b32 a176, 0
  v_accvgpr_write_b32 a177, 0
  v_accvgpr_write_b32 a178, 0
  v_accvgpr_write_b32 a179, 0
  v_accvgpr_write_b32 a180, 0
  v_accvgpr_write_b32 a181, 0
  v_accvgpr_write_b32 a182, 0
  v_accvgpr_write_b32 a183, 0
  v_accvgpr_write_b32 a184, 0
  v_accvgpr_write_b32 a185, 0
  v_accvgpr_write_b32 a186, 0
  v_accvgpr_write_b32 a187, 0
  v_accvgpr_write_b32 a188, 0
  v_accvgpr_write_b32 a189, 0
  v_accvgpr_write_b32 a190, 0
  v_accvgpr_write_b32 a191, 0
  v_accvgpr_write_b32 a192, 0
  v_accvgpr_write_b32 a193, 0
  v_accvgpr_write_b32 a194, 0
  v_accvgpr_write_b32 a195, 0
  v_accvgpr_write_b32 a196, 0
  v_accvgpr_write_b32 a197, 0
  v_accvgpr_write_b32 a198, 0
  v_accvgpr_write_b32 a199, 0
  v_accvgpr_write_b32 a200, 0
  v_accvgpr_write_b32 a201, 0
  v_accvgpr_write_b32 a202, 0
  v_accvgpr_write_b32 a203, 0
  v_accvgpr_write_b32 a204, 0
  v_accvgpr_write_b32 a205, 0
  v_accvgpr_write_b32 a206, 0
  v_accvgpr_write_b32 a207, 0
  v_accvgpr_write_b32 a208, 0
  v_accvgpr_write_b32 a209, 0
  v_accvgpr_write_b32 a210, 0
  v_accvgpr_write_b32 a211, 0
  v_accvgpr_write_b32 a212, 0
  v_accvgpr_write_b32 a213, 0
  v_accvgpr_write_b32 a214, 0
  v_accvgpr_write_b32 a215, 0
  v_accvgpr_write_b32 a216, 0
  v_accvgpr_write_b32 a217, 0
  v_accvgpr_write_b32 a218, 0
  v_accvgpr_write_b32 a219, 0
  v_accvgpr_write_b32 a220, 0
  v_accvgpr_write_b32 a221, 0
  v_accvgpr_write_b32 a222, 0
  v_accvgpr_write_b32 a223, 0
  v_accvgpr_write_b32 a224, 0
  v_accvgpr_write_b32 a225, 0
  v_accvgpr_write_b32 a226, 0
  v_accvgpr_write_b32 a227, 0
  v_accvgpr_write_b32 a228, 0
  v_accvgpr_write_b32 a229, 0
  v_accvgpr_write_b32 a230, 0
  v_accvgpr_write_b32 a231, 0
  v_accvgpr_write_b32 a232, 0
  v_accvgpr_write_b32 a233, 0
  v_accvgpr_write_b32 a234, 0
  v_accvgpr_write_b32 a235, 0
  v_accvgpr_write_b32 a236, 0
  v_accvgpr_write_b32 a237, 0
  v_accvgpr_write_b32 a238, 0
  v_accvgpr_write_b32 a239, 0
  v_accvgpr_write_b32 a240, 0
  v_accvgpr_write_b32 a241, 0
  v_accvgpr_write_b32 a242, 0
  v_accvgpr_write_b32 a243, 0
  v_accvgpr_write_b32 a244, 0
  v_accvgpr_write_b32 a245, 0
  v_accvgpr_write_b32 a246, 0
  v_accvgpr_write_b32 a247, 0
  v_accvgpr_write_b32 a248, 0
  v_accvgpr_write_b32 a249, 0
  v_accvgpr_write_b32 a250, 0
  v_accvgpr_write_b32 a251, 0
  v_accvgpr_write_b32 a252, 0
  v_accvgpr_write_b32 a253, 0
  v_accvgpr_write_b32 a254, 0
  v_accvgpr_write_b32 a255, 0
  s_cmp_lg_u32 s3, 0
  s_cbranch_scc1 L_wdo_117
  s_mov_b32 s7, 0
  v_mbcnt_lo_u32_b32 v8, -1, 0
  v_and_b32 v8, 3, v8
  v_lshlrev_b32 v8, 6, v8
L_wd_116:
  buffer_load_dword v9, v8, s[12:15], 0 offen offset:16 sc1
  s_waitcnt vmcnt(0)
  v_cmp_ne_u32 vcc, 64, v9
  s_cbranch_vccz L_wdo_117
  s_add_u32 s7, s7, 1
  s_cmp_lt_u32 s7, 131072
  s_cbranch_scc1 L_wd_116
  s_mov_b32 s6, 40
  s_branch L_err
L_wdo_117:
  s_barrier
  v_and_b32 v4, 60, v4
  s_lshl_b32 s6, s5, 6
  s_add_u32 s34, s6, 0x710000
  s_mov_b32 s33, 127
  s_mov_b32 s7, 0
L_pl_118:
  buffer_load_dword v8, v4, s[8:11], s34 offen offset:0 sc1
  s_waitcnt vmcnt(0)
  v_cmp_gt_u32 vcc, s33, v8
  s_cbranch_vccz L_plo_119
  s_add_u32 s7, s7, 1
  s_cmp_lt_u32 s7, 131072
  s_cbranch_scc1 L_pl_118
  s_mov_b32 s6, 41
  s_branch L_err
L_plo_119:
  s_mul_i32 s34, s5, 73728
  s_mul_i32 s35, s3, 18432
  s_add_u32 s34, s34, s35
  s_add_u32 s34, s34, 0x400000
  s_add_u32 m0, s35, 0
  s_add_u32 s6, s34, 0
  buffer_load_dwordx4 v0, s[8:11], s6 offen offset:0 lds
  buffer_load_dwordx4 v0, s[8:11], s6 offen offset:1024 lds
  buffer_load_dwordx4 v0, s[8:11], s6 offen offset:2048 lds
  buffer_load_dwordx4 v0, s[8:11], s6 offen offset:3072 lds
  s_add_u32 m0, s35, 4096
  s_add_u32 s6, s34, 4096
  buffer_load_dwordx4 v0, s[8:11], s6 offen offset:0 lds
  buffer_load_dwordx4 v0, s[8:11], s6 offen offset:1024 lds
  buffer_load_dwordx4 v0, s[8:11], s6 offen offset:2048 lds
  buffer_load_dwordx4 v0, s[8:11], s6 offen offset:3072 lds
  s_add_u32 m0, s35, 8192
  s_add_u32 s6, s34, 8192
  buffer_load_dwordx4 v0, s[8:11], s6 offen offset:0 lds
  buffer_load_dwordx4 v0, s[8:11], s6 offen offset:1024 lds
  buffer_load_dwordx4 v0, s[8:11], s6 offen offset:2048 lds
  buffer_load_dwordx4 v0, s[8:11], s6 offen offset:3072 lds
  s_add_u32 m0, s35, 12288
  s_add_u32 s6, s34, 12288
  buffer_load_dwordx4 v0, s[8:11], s6 offen offset:0 lds
  buffer_load_dwordx4 v0, s[8:11], s6 offen offset:1024 lds
  buffer_load_dwordx4 v0, s[8:11], s6 offen offset:2048 lds
  buffer_load_dwordx4 v0, s[8:11], s6 offen offset:3072 lds
  s_add_u32 m0, s35, 16384
  s_add_u32 s6, s34, 16384
  buffer_load_dwordx4 v0, s[8:11], s6 offen offset:0 lds
  buffer_load_dwordx4 v0, s[8:11], s6 offen offset:1024 lds
  s_mov_b32 s32, 0
  s_waitcnt vmcnt(0) lgkmcnt(0)
  s_barrier
  s_cmp_ge_u32 s3, 2
  s_cbranch_scc1 L_c_res
  s_mov_b32 s16, s76
  s_mov_b32 s17, s77
  s_mov_b32 s18, 0x400
  s_mov_b32 s19, 0x20000
  v_bfe_u32 v16, v0, 4, 4
  v_lshrrev_b32 v17, 8, v0
  v_lshrrev_b32 v18, 7, v0
  s_lshl_b32 s6, s5, 5
  s_lshl_b32 s7, s3, 4
  s_add_u32 s6, s6, s7
  v_lshlrev_b32 v19, 1, v18
  buffer_load_ushort v12, v19, s[16:19], s6 offen
  s_mul_i32 s6, s3, 36864
  v_mul_u32_u24 v19, 4608, v18
  v_add_u32 v19, s6, v19
  ds_read_b32 v11, v19 offset:4576
  s_add_u32 s6, s6, 480
  v_lshlrev_b32 v19, 5, v16
  v_sub_u32 v19, s6, v19
  v_lshl_add_u32 v4, v17, 4, v19
  s_mul_i32 s6, s3, 33024
  s_add_u32 s6, s6, 73728
  v_lshlrev_b32 v19, 1, v16
  v_lshl_add_u32 v19, v17, 4, v19
  v_add_u32 v5, s6, v19
  v_mul_u32_u24 v19, 4128, v18
  v_bfe_u32 v20, v0, 1, 6
  v_add3_u32 v19, v19, v20, s6
  v_add_u32 v8, 32, v19
  s_lshl_b32 s6, s3, 10
  s_add_u32 s6, s6, 147968
  v_add_u32 v7, s6, v0
  v_and_b32 v19, 1, v16
  v_lshlrev_b32 v19, 6, v19
  v_lshl_add_u32 v19, v17, 4, v19
  v_add_u32 v6, s6, v19
  v_lshrrev_b32 v10, 1, v0
  s_lshl_b32 s6, s3, 9
  s_add_u32 s35, s6, 139776
  s_lshl_b32 s7, s5, 10
  s_add_u32 s6, s6, s7
  s_add_u32 s40, s6, 0x200000
  s_lshl_b32 s6, s5, 3
  s_lshl_b32 s7, s3, 2
  s_add_u32 s6, s6, s7
  s_add_u32 s39, s6, 0x710800
  v_add_u32 v14, s7, v2
  s_waitcnt vmcnt(0) lgkmcnt(0)
  v_lshlrev_b32 v12, 16, v12
  v_and_b32 v15, 2, v5
  v_and_b32 v5, -4, v5
  v_add_u32 v104, 0, v5
  v_add_u32 v105, 4128, v5
  v_add_u32 v106, 8256, v5
  v_add_u32 v107, 12384, v5
  v_add_u32 v108, 16512, v5
  v_add_u32 v109, 20640, v5
  v_add_u32 v110, 24768, v5
  v_add_u32 v111, 28896, v5
L_c_conv0:
  s_add_u32 s33, s32, 1
  s_and_b32 s6, s32, 7
  s_lshl_b32 s7, s6, 10
  s_add_u32 s7, s7, s35
  v_add_u32 v9, s7, v10
  s_lshl_b32 s6, s6, 1
  s_lshl_b32 s42, 0x30003, s6
  v_mov_b32 v13, s33
  ds_read_b128 v[48:51], v4 offset:3584
  ds_read_b128 v[52:55], v4 offset:8192
  ds_read_b128 v[56:59], v4 offset:12800
  ds_read_b128 v[60:63], v4 offset:17408
  ds_read_b128 v[64:67], v4 offset:22016
  ds_read_b128 v[68:71], v4 offset:26624
  ds_read_b128 v[72:75], v4 offset:31232
  ds_read_b128 v[76:79], v4 offset:35840
  s_mov_b32 s7, 0
L_lw_120:
  ds_read_b32 v88, v2 offset:0
  s_waitcnt lgkmcnt(0)
  v_cmp_gt_i32 vcc, s33, v88
  s_cbranch_vccz L_lwo_121
  s_add_u32 s7, s7, 1
  s_cmp_lt_u32 s7, 131072
  s_cbranch_scc1 L_lw_120
  s_mov_b32 s6, 42
  s_branch L_err
L_lwo_121:
  ds_read2_b32 v[112:113], v104 offset0:0 offset1:1
  ds_read2_b32 v[114:115], v104 offset0:2 offset1:3
  ds_read_b32 v116, v104 offset:16
  ds_read2_b32 v[118:119], v105 offset0:0 offset1:1
  ds_read2_b32 v[120:121], v105 offset0:2 offset1:3
  ds_read_b32 v122, v105 offset:16
  ds_read2_b32 v[124:125], v106 offset0:0 offset1:1
  ds_read2_b32 v[126:127], v106 offset0:2 offset1:3
  ds_read_b32 v128, v106 offset:16
  ds_read2_b32 v[130:131], v107 offset0:0 offset1:1
  ds_read2_b32 v[132:133], v107 offset0:2 offset1:3
  ds_read_b32 v134, v107 offset:16
  s_waitcnt lgkmcnt(9)
  v_alignbyte_b32 v16, v113, v112, v15
  v_alignbyte_b32 v17, v114, v113, v15
  v_alignbyte_b32 v18, v115, v114, v15
  v_alignbyte_b32 v19, v116, v115, v15
  ds_read2_b32 v[112:113], v108 offset0:0 offset1:1
  ds_read2_b32 v[114:115], v108 offset0:2 offset1:3
  ds_read_b32 v116, v108 offset:16
  s_waitcnt lgkmcnt(9)
  v_alignbyte_b32 v20, v119, v118, v15
  v_alignbyte_b32 v21, v120, v119, v15
  v_alignbyte_b32 v22, v121, v120, v15
  v_alignbyte_b32 v23, v122, v121, v15
  ds_read2_b32 v[118:119], v109 offset0:0 offset1:1
  ds_read2_b32 v[120:121], v109 offset0:2 offset1:3
  ds_read_b32 v122, v109 offset:16
  v_mfma_f32_16x16x32_bf16 a[0:3], v[16:19], v[48:51], a[0:3]
  s_waitcnt lgkmcnt(9)
  v_alignbyte_b32 v24, v125, v124, v15
  v_alignbyte_b32 v25, v126, v125, v15
  v_alignbyte_b32 v26, v127, v126, v15
  v_alignbyte_b32 v27, v128, v127, v15
  ds_read2_b32 v[124:125], v110 offset0:0 offset1:1
  ds_read2_b32 v[126:127], v110 offset0:2 offset1:3
  ds_read_b32 v128, v110 offset:16
  v_mfma_f32_16x16x32_bf16 a[32:35], v[20:23], v[52:55], a[32:35]
  s_waitcnt lgkmcnt(9)
  v_alignbyte_b32 v28, v131, v130, v15
  v_alignbyte_b32 v29, v132, v131, v15
  v_alignbyte_b32 v30, v133, v132, v15
  v_alignbyte_b32 v31, v134, v133, v15
  ds_read2_b32 v[130:131], v111 offset0:0 offset1:1
  ds_read2_b32 v[132:133], v111 offset0:2 offset1:3
  ds_read_b32 v134, v111 offset:16
  v_mfma_f32_16x16x32_bf16 a[64:67], v[24:27], v[56:59], a[64:67]
  s_waitcnt lgkmcnt(9)
  v_alignbyte_b32 v32, v113, v112, v15
  v_alignbyte_b32 v33, v114, v113, v15
  v_alignbyte_b32 v34, v115, v114, v15
  v_alignbyte_b32 v35, v116, v115, v15
  ds_read_b64 v[84:85], v8
  ds_read_b64 v[86:87], v9
  v_mfma_f32_16x16x32_bf16 a[96:99], v[28:31], v[60:63], a[96:99]
  s_waitcnt lgkmcnt(8)
  v_alignbyte_b32 v36, v119, v118, v15
  v_alignbyte_b32 v37, v120, v119, v15
  v_alignbyte_b32 v38, v121, v120, v15
  v_alignbyte_b32 v39, v122, v121, v15
  v_mfma_f32_16x16x32_bf16 a[128:131], v[32:35], v[64:67], a[128:131]
  s_waitcnt lgkmcnt(5)
  v_alignbyte_b32 v40, v125, v124, v15
  v_alignbyte_b32 v41, v126, v125, v15
  v_alignbyte_b32 v42, v127, v126, v15
  v_alignbyte_b32 v43, v128, v127, v15
  v_mfma_f32_16x16x32_bf16 a[160:163], v[36:39], v[68:71], a[160:163]
  s_waitcnt lgkmcnt(2)
  v_alignbyte_b32 v44, v131, v130, v15
  v_alignbyte_b32 v45, v132, v131, v15
  v_alignbyte_b32 v46, v133, v132, v15
  v_alignbyte_b32 v47, v134, v133, v15
  v_mfma_f32_16x16x32_bf16 a[192:195], v[40:43], v[72:75], a[192:195]
  s_nop 0
  v_mfma_f32_16x16x32_bf16 a[224:227], v[44:47], v[76:79], a[224:227]
  s_waitcnt lgkmcnt(0)
  ds_read_b128 v[48:51], v4 offset:3072
  ds_read_b128 v[52:55], v4 offset:7680
  ds_read_b128 v[56:59], v4 offset:12288
  ds_read_b128 v[60:63], v4 offset:16896
  ds_read_b128 v[64:67], v4 offset:21504
  ds_read_b128 v[68:71], v4 offset:26112
  ds_read_b128 v[72:75], v4 offset:30720
  ds_read_b128 v[76:79], v4 offset:35328
  s_mov_b32 exec_lo, s42
  s_mov_b32 exec_hi, s42
  ds_write_b128 v6, a[0:3] offset:0
  ds_write_b128 v6, a[32:35] offset:128
  ds_write_b128 v6, a[64:67] offset:256
  ds_write_b128 v6, a[96:99] offset:384
  ds_write_b128 v6, a[128:131] offset:512
  ds_write_b128 v6, a[160:163] offset:640
  ds_write_b128 v6, a[192:195] offset:768
  ds_write_b128 v6, a[224:227] offset:896
  s_mov_b64 exec, -1
  ds_read_b128 v[80:83], v7
  ds_write_b32 v14, v13 offset:8
  v_lshlrev_b32 v88, 16, v84
  v_and_b32 v89, 0xffff0000, v84
  v_lshlrev_b32 v90, 16, v85
  v_and_b32 v91, 0xffff0000, v85
  v_lshlrev_b32 v96, 16, v86
  v_and_b32 v97, 0xffff0000, v86
  v_lshlrev_b32 v98, 16, v87
  v_and_b32 v99, 0xffff0000, v87
  v_mul_f32 v92, v88, v12
  v_mul_f32 v93, v89, v12
  v_mul_f32 v94, v90, v12
  v_mul_f32 v95, v91, v12
  v_cvt_pk_bf16_f32 v84, v92, v93
  v_cvt_pk_bf16_f32 v85, v94, v95
  v_lshlrev_b32 v92, 16, v84
  v_and_b32 v93, 0xffff0000, v84
  v_lshlrev_b32 v94, 16, v85
  v_and_b32 v95, 0xffff0000, v85
  s_waitcnt lgkmcnt(1)
  v_fmac_f32 v80, v88, v11
  v_fmac_f32 v81, v89, v11
  v_fmac_f32 v82, v90, v11
  v_fmac_f32 v83, v91, v11
  v_cvt_pk_bf16_f32 v84, v80, v81
  v_cvt_pk_bf16_f32 v85, v82, v83
  v_lshlrev_b32 v80, 16, v84
  v_and_b32 v81, 0xffff0000, v84
  v_lshlrev_b32 v82, 16, v85
  v_and_b32 v83, 0xffff0000, v85
  v_add_f32 v80, v80, v92
  v_add_f32 v81, v81, v93
  v_add_f32 v82, v82, v94
  v_add_f32 v83, v83, v95
  v_cvt_pk_bf16_f32 v84, v80, v81
  v_cvt_pk_bf16_f32 v85, v82, v83
  v_lshlrev_b32 v80, 16, v84
  v_and_b32 v81, 0xffff0000, v84
  v_lshlrev_b32 v82, 16, v85
  v_and_b32 v83, 0xffff0000, v85
  v_add_f32 v80, v80, v96
  v_add_f32 v81, v81, v97
  v_add_f32 v82, v82, v98
  v_add_f32 v83, v83, v99
  v_cvt_pk_bf16_f32 v84, v80, v81
  v_cvt_pk_bf16_f32 v85, v82, v83
  buffer_store_dwordx2 v[84:85], v10, s[8:11], s40 offen sc1
  v_mfma_f32_16x16x32_bf16 a[4:7], v[16:19], v[48:51], a[4:7]
  ds_read_b128 v[48:51], v4 offset:2560
  v_mfma_f32_16x16x32_bf16 a[36:39], v[20:23], v[52:55], a[36:39]
  ds_read_b128 v[52:55], v4 offset:7168
  v_mfma_f32_16x16x32_bf16 a[68:71], v[24:27], v[56:59], a[68:71]
  ds_read_b128 v[56:59], v4 offset:11776
  v_mfma_f32_16x16x32_bf16 a[100:103], v[28:31], v[60:63], a[100:103]
  ds_read_b128 v[60:63], v4 offset:16384
  v_mfma_f32_16x16x32_bf16 a[132:135], v[32:35], v[64:67], a[132:135]
  ds_read_b128 v[64:67], v4 offset:20992
  v_mfma_f32_16x16x32_bf16 a[164:167], v[36:39], v[68:71], a[164:167]
  ds_read_b128 v[68:71], v4 offset:25600
  v_mfma_f32_16x16x32_bf16 a[196:199], v[40:43], v[72:75], a[196:199]
  ds_read_b128 v[72:75], v4 offset:30208
  v_mfma_f32_16x16x32_bf16 a[228:231], v[44:47], v[76:79], a[228:231]
  ds_read_b128 v[76:79], v4 offset:34816
  s_waitcnt lgkmcnt(7)
  v_mfma_f32_16x16x32_bf16 a[8:11], v[16:19], v[48:51], a[8:11]
  ds_read_b128 v[48:51], v4 offset:2048
  s_waitcnt lgkmcnt(7)
  v_mfma_f32_16x16x32_bf16 a[40:43], v[20:23], v[52:55], a[40:43]
  ds_read_b128 v[52:55], v4 offset:6656
  s_waitcnt lgkmcnt(7)
  v_mfma_f32_16x16x32_bf16 a[72:75], v[24:27], v[56:59], a[72:75]
  ds_read_b128 v[56:59], v4 offset:11264
  s_waitcnt lgkmcnt(7)
  v_mfma_f32_16x16x32_bf16 a[104:107], v[28:31], v[60:63], a[104:107]
  ds_read_b128 v[60:63], v4 offset:15872
  s_waitcnt lgkmcnt(7)
  v_mfma_f32_16x16x32_bf16 a[136:139], v[32:35], v[64:67], a[136:139]
  ds_read_b128 v[64:67], v4 offset:20480
  s_waitcnt lgkmcnt(7)
  v_mfma_f32_16x16x32_bf16 a[168:171], v[36:39], v[68:71], a[168:171]
  ds_read_b128 v[68:71], v4 offset:25088
  s_waitcnt lgkmcnt(7)
  v_mfma_f32_16x16x32_bf16 a[200:203], v[40:43], v[72:75], a[200:203]
  ds_read_b128 v[72:75], v4 offset:29696
  s_waitcnt lgkmcnt(7)
  v_mfma_f32_16x16x32_bf16 a[232:235], v[44:47], v[76:79], a[232:235]
  ds_read_b128 v[76:79], v4 offset:34304
  s_waitcnt lgkmcnt(7)
  v_mfma_f32_16x16x32_bf16 a[12:15], v[16:19], v[48:51], a[12:15]
  ds_read_b128 v[48:51], v4 offset:1536
  s_waitcnt lgkmcnt(7)
  v_mfma_f32_16x16x32_bf16 a[44:47], v[20:23], v[52:55], a[44:47]
  ds_read_b128 v[52:55], v4 offset:6144
  s_waitcnt lgkmcnt(7)
  v_mfma_f32_16x16x32_bf16 a[76:79], v[24:27], v[56:59], a[76:79]
  ds_read_b128 v[56:59], v4 offset:10752
  s_waitcnt lgkmcnt(7)
  v_mfma_f32_16x16x32_bf16 a[108:111], v[28:31], v[60:63], a[108:111]
  ds_read_b128 v[60:63], v4 offset:15360
  s_waitcnt lgkmcnt(7)
  v_mfma_f32_16x16x32_bf16 a[140:143], v[32:35], v[64:67], a[140:143]
  ds_read_b128 v[64:67], v4 offset:19968
  s_waitcnt lgkmcnt(7)
  v_mfma_f32_16x16x32_bf16 a[172:175], v[36:39], v[68:71], a[172:175]
  ds_read_b128 v[68:71], v4 offset:24576
  s_waitcnt lgkmcnt(7)
  v_mfma_f32_16x16x32_bf16 a[204:207], v[40:43], v[72:75], a[204:207]
  ds_read_b128 v[72:75], v4 offset:29184
  s_waitcnt lgkmcnt(7)
  v_mfma_f32_16x16x32_bf16 a[236:239], v[44:47], v[76:79], a[236:239]
  ds_read_b128 v[76:79], v4 offset:33792
  s_waitcnt lgkmcnt(7)
  v_mfma_f32_16x16x32_bf16 a[16:19], v[16:19], v[48:51], a[16:19]
  ds_read_b128 v[48:51], v4 offset:1024
  s_waitcnt lgkmcnt(7)
  v_mfma_f32_16x16x32_bf16 a[48:51], v[20:23], v[52:55], a[48:51]
  ds_read_b128 v[52:55], v4 offset:5632
  s_waitcnt lgkmcnt(7)
  v_mfma_f32_16x16x32_bf16 a[80:83], v[24:27], v[56:59], a[80:83]
  ds_read_b128 v[56:59], v4 offset:10240
  s_waitcnt lgkmcnt(7)
  v_mfma_f32_16x16x32_bf16 a[112:115], v[28:31], v[60:63], a[112:115]
  ds_read_b128 v[60:63], v4 offset:14848
  s_waitcnt lgkmcnt(7)
  v_mfma_f32_16x16x32_bf16 a[144:147], v[32:35], v[64:67], a[144:147]
  ds_read_b128 v[64:67], v4 offset:19456
  s_waitcnt lgkmcnt(7)
  v_mfma_f32_16x16x32_bf16 a[176:179], v[36:39], v[68:71], a[176:179]
  ds_read_b128 v[68:71], v4 offset:24064
  s_waitcnt lgkmcnt(7)
  v_mfma_f32_16x16x32_bf16 a[208:211], v[40:43], v[72:75], a[208:211]
  ds_read_b128 v[72:75], v4 offset:28672
  s_waitcnt lgkmcnt(7)
  v_mfma_f32_16x16x32_bf16 a[240:243], v[44:47], v[76:79], a[240:243]
  ds_read_b128 v[76:79], v4 offset:33280
  s_waitcnt lgkmcnt(7)
  v_mfma_f32_16x16x32_bf16 a[20:23], v[16:19], v[48:51], a[20:23]
  ds_read_b128 v[48:51], v4 offset:512
  s_waitcnt lgkmcnt(7)
  v_mfma_f32_16x16x32_bf16 a[52:55], v[20:23], v[52:55], a[52:55]
  ds_read_b128 v[52:55], v4 offset:5120
  s_waitcnt lgkmcnt(7)
  v_mfma_f32_16x16x32_bf16 a[84:87], v[24:27], v[56:59], a[84:87]
  ds_read_b128 v[56:59], v4 offset:9728
  s_waitcnt lgkmcnt(7)
  v_mfma_f32_16x16x32_bf16 a[116:119], v[28:31], v[60:63], a[116:119]
  ds_read_b128 v[60:63], v4 offset:14336
  s_waitcnt lgkmcnt(7)
  v_mfma_f32_16x16x32_bf16 a[148:151], v[32:35], v[64:67], a[148:151]
  ds_read_b128 v[64:67], v4 offset:18944
  s_waitcnt lgkmcnt(7)
  v_mfma_f32_16x16x32_bf16 a[180:183], v[36:39], v[68:71], a[180:183]
  ds_read_b128 v[68:71], v4 offset:23552
  s_waitcnt lgkmcnt(7)
  v_mfma_f32_16x16x32_bf16 a[212:215], v[40:43], v[72:75], a[212:215]
  ds_read_b128 v[72:75], v4 offset:28160
  s_waitcnt lgkmcnt(7)
  v_mfma_f32_16x16x32_bf16 a[244:247], v[44:47], v[76:79], a[244:247]
  ds_read_b128 v[76:79], v4 offset:32768
  s_waitcnt lgkmcnt(7)
  v_mfma_f32_16x16x32_bf16 a[24:27], v[16:19], v[48:51], a[24:27]
  ds_read_b128 v[48:51], v4 offset:0
  s_waitcnt lgkmcnt(7)
  v_mfma_f32_16x16x32_bf16 a[56:59], v[20:23], v[52:55], a[56:59]
  ds_read_b128 v[52:55], v4 offset:4608
  s_waitcnt lgkmcnt(7)
  v_mfma_f32_16x16x32_bf16 a[88:91], v[24:27], v[56:59], a[88:91]
  ds_read_b128 v[56:59], v4 offset:9216
  s_waitcnt lgkmcnt(7)
  v_mfma_f32_16x16x32_bf16 a[120:123], v[28:31], v[60:63], a[120:123]
  ds_read_b128 v[60:63], v4 offset:13824
  s_waitcnt lgkmcnt(7)
  v_mfma_f32_16x16x32_bf16 a[152:155], v[32:35], v[64:67], a[152:155]
  ds_read_b128 v[64:67], v4 offset:18432
  s_waitcnt lgkmcnt(7)
  v_mfma_f32_16x16x32_bf16 a[184:187], v[36:39], v[68:71], a[184:187]
  ds_read_b128 v[68:71], v4 offset:23040
  s_waitcnt lgkmcnt(7)
  v_mfma_f32_16x16x32_bf16 a[216:219], v[40:43], v[72:75], a[216:219]
  ds_read_b128 v[72:75], v4 offset:27648
  s_waitcnt lgkmcnt(7)
  v_mfma_f32_16x16x32_bf16 a[248:251], v[44:47], v[76:79], a[248:251]
  ds_read_b128 v[76:79], v4 offset:32256
  s_waitcnt lgkmcnt(7)
  v_mfma_f32_16x16x32_bf16 a[28:31], v[16:19], v[48:51], a[28:31]
  s_waitcnt lgkmcnt(6)
  v_mfma_f32_16x16x32_bf16 a[60:63], v[20:23], v[52:55], a[60:63]
  s_waitcnt lgkmcnt(5)
  v_mfma_f32_16x16x32_bf16 a[92:95], v[24:27], v[56:59], a[92:95]
  s_waitcnt lgkmcnt(4)
  v_mfma_f32_16x16x32_bf16 a[124:127], v[28:31], v[60:63], a[124:127]
  s_waitcnt lgkmcnt(3)
  v_mfma_f32_16x16x32_bf16 a[156:159], v[32:35], v[64:67], a[156:159]
  s_waitcnt lgkmcnt(2)
  v_mfma_f32_16x16x32_bf16 a[188:191], v[36:39], v[68:71], a[188:191]
  s_waitcnt lgkmcnt(1)
  v_mfma_f32_16x16x32_bf16 a[220:223], v[40:43], v[72:75], a[220:223]
  s_waitcnt lgkmcnt(0)
  v_mfma_f32_16x16x32_bf16 a[252:255], v[44:47], v[76:79], a[252:255]
  v_add_u32 v104, 64, v104
  v_add_u32 v105, 64, v105
  v_add_u32 v106, 64, v106
  v_add_u32 v107, 64, v107
  v_add_u32 v108, 64, v108
  v_add_u32 v109, 64, v109
  v_add_u32 v110, 64, v110
  v_add_u32 v111, 64, v111
  v_add_u32 v4, 64, v4
  v_add_u32 v8, 64, v8
  s_add_u32 s40, s40, 0x8000
  s_waitcnt vmcnt(0)
  s_mov_b64 exec, 1
  buffer_store_dword v13, v1, s[8:11], s39 offen sc1
  s_mov_b64 exec, -1
  ds_write_b32 v14, v13 offset:16
  s_add_u32 s32, s32, 1
  s_and_b32 s6, s32, 7
  s_cbranch_scc1 L_c_conv0
L_c_conv1:
  s_add_u32 s33, s32, 1
  s_and_b32 s6, s32, 7
  s_lshl_b32 s7, s6, 10
  s_add_u32 s7, s7, s35
  v_add_u32 v9, s7, v10
  s_lshl_b32 s6, s6, 1
  s_lshl_b32 s42, 0x30003, s6
  v_mov_b32 v13, s33
  ds_read_b128 v[48:51], v4 offset:3072
  ds_read_b128 v[52:55], v4 offset:7680
  ds_read_b128 v[56:59], v4 offset:12288
  ds_read_b128 v[60:63], v4 offset:16896
  ds_read_b128 v[64:67], v4 offset:21504
  ds_read_b128 v[68:71], v4 offset:26112
  ds_read_b128 v[72:75], v4 offset:30720
  ds_read_b128 v[76:79], v4 offset:35328
  s_mov_b32 s7, 0
L_lw_122:
  ds_read_b32 v88, v2 offset:0
  s_waitcnt lgkmcnt(0)
  v_cmp_gt_i32 vcc, s33, v88
  s_cbranch_vccz L_lwo_123
  s_add_u32 s7, s7, 1
  s_cmp_lt_u32 s7, 131072
  s_cbranch_scc1 L_lw_122
  s_mov_b32 s6, 42
  s_branch L_err
L_lwo_123:
  ds_read2_b32 v[112:113], v104 offset0:0 offset1:1
  ds_read2_b32 v[114:115], v104 offset0:2 offset1:3
  ds_read_b32 v116, v104 offset:16
  ds_read2_b32 v[118:119], v105 offset0:0 offset1:1
  ds_read2_b32 v[120:121], v105 offset0:2 offset1:3
  ds_read_b32 v122, v105 offset:16
  ds_read2_b32 v[124:125], v106 offset0:0 offset1:1
  ds_read2_b32 v[126:127], v106 offset0:2 offset1:3
  ds_read_b32 v128, v106 offset:16
  ds_read2_b32 v[130:131], v107 offset0:0 offset1:1
  ds_read2_b32 v[132:133], v107 offset0:2 offset1:3
  ds_read_b32 v134, v107 offset:16
  s_waitcnt lgkmcnt(9)
  v_alignbyte_b32 v16, v113, v112, v15
  v_alignbyte_b32 v17, v114, v113, v15
  v_alignbyte_b32 v18, v115, v114, v15
  v_alignbyte_b32 v19, v116, v115, v15
  ds_read2_b32 v[112:113], v108 offset0:0 offset1:1
  ds_read2_b32 v[114:115], v108 offset0:2 offset1:3
  ds_read_b32 v116, v108 offset:16
  s_waitcnt lgkmcnt(9)
  v_alignbyte_b32 v20, v119, v118, v15
  v_alignbyte_b32 v21, v120, v119, v15
  v_alignbyte_b32 v22, v121, v120, v15
  v_alignbyte_b32 v23, v122, v121, v15
  ds_read2_b32 v[118:119], v109 offset0:0 offset1:1
  ds_read2_b32 v[120:121], v109 offset0:2 offset1:3
  ds_read_b32 v122, v109 offset:16
  v_mfma_f32_16x16x32_bf16 a[4:7], v[16:19], v[48:51], a[4:7]
  s_waitcnt lgkmcnt(9)
  v_alignbyte_b32 v24, v125, v124, v15
  v_alignbyte_b32 v25, v126, v125, v15
  v_alignbyte_b32 v26, v127, v126, v15
  v_alignbyte_b32 v27, v128, v127, v15
  ds_read2_b32 v[124:125], v110 offset0:0 offset1:1
  ds_read2_b32 v[126:127], v110 offset0:2 offset1:3
  ds_read_b32 v128, v110 offset:16
  v_mfma_f32_16x16x32_bf16 a[36:39], v[20:23], v[52:55], a[36:39]
  s_waitcnt lgkmcnt(9)
  v_alignbyte_b32 v28, v131, v130, v15
  v_alignbyte_b32 v29, v132, v131, v15
  v_alignbyte_b32 v30, v133, v132, v15
  v_alignbyte_b32 v31, v134, v133, v15
  ds_read2_b32 v[130:131], v111 offset0:0 offset1:1
  ds_read2_b32 v[132:133], v111 offset0:2 offset1:3
  ds_read_b32 v134, v111 offset:16
  v_mfma_f32_16x16x32_bf16 a[68:71], v[24:27], v[56:59], a[68:71]
  s_waitcnt lgkmcnt(9)
  v_alignbyte_b32 v32, v113, v112, v15
  v_alignbyte_b32 v33, v114, v113, v15
  v_alignbyte_b32 v34, v115, v114, v15
  v_alignbyte_b32 v35, v116, v115, v15
  ds_read_b64 v[84:85], v8
  ds_read_b64 v[86:87], v9
  v_mfma_f32_16x16x32_bf16 a[100:103], v[28:31], v[60:63], a[100:103]
  s_waitcnt lgkmcnt(8)
  v_alignbyte_b32 v36, v119, v118, v15
  v_alignbyte_b32 v37, v120, v119, v15
  v_alignbyte_b32 v38, v121, v120, v15
  v_alignbyte_b32 v39, v122, v121, v15
  v_mfma_f32_16x16x32_bf16 a[132:135], v[32:35], v[64:67], a[132:135]
  s_waitcnt lgkmcnt(5)
  v_alignbyte_b32 v40, v125, v124, v15
  v_alignbyte_b32 v41, v126, v125, v15
  v_alignbyte_b32 v42, v127, v126, v15
  v_alignbyte_b32 v43, v128, v127, v15
  v_mfma_f32_16x16x32_bf16 a[164:167], v[36:39], v[68:71], a[164:167]
  s_waitcnt lgkmcnt(2)
  v_alignbyte_b32 v44, v131, v130, v15
  v_alignbyte_b32 v45, v132, v131, v15
  v_alignbyte_b32 v46, v133, v132, v15
  v_alignbyte_b32 v47, v134, v133, v15
  v_mfma_f32_16x16x32_bf16 a[196:199], v[40:43], v[72:75], a[196:199]
  s_nop 0
  v_mfma_f32_16x16x32_bf16 a[228:231], v[44:47], v[76:79], a[228:231]
  s_waitcnt lgkmcnt(0)
  ds_read_b128 v[48:51], v4 offset:2560
  ds_read_b128 v[52:55], v4 offset:7168
  ds_read_b128 v[56:59], v4 offset:11776
  ds_read_b128 v[60:63], v4 offset:16384
  ds_read_b128 v[64:67], v4 offset:20992
  ds_read_b128 v[68:71], v4 offset:25600
  ds_read_b128 v[72:75], v4 offset:30208
  ds_read_b128 v[76:79], v4 offset:34816
  s_mov_b32 exec_lo, s42
  s_mov_b32 exec_hi, s42
  ds_write_b128 v6, a[4:7] offset:0
  ds_write_b128 v6, a[36:39] offset:128
  ds_write_b128 v6, a[68:71] offset:256
  ds_write_b128 v6, a[100:103] offset:384
  ds_write_b128 v6, a[132:135] offset:512
  ds_write_b128 v6, a[164:167] offset:640
  ds_write_b128 v6, a[196:199] offset:768
  ds_write_b128 v6, a[228:231] offset:896
  s_mov_b64 exec, -1
  ds_read_b128 v[80:83], v7
  ds_write_b32 v14, v13 offset:8
  v_lshlrev_b32 v88, 16, v84
  v_and_b32 v89, 0xffff0000, v84
  v_lshlrev_b32 v90, 16, v85
  v_and_b32 v91, 0xffff0000, v85
  v_lshlrev_b32 v96, 16, v86
  v_and_b32 v97, 0xffff0000, v86
  v_lshlrev_b32 v98, 16, v87
  v_and_b32 v99, 0xffff0000, v87
  v_mul_f32 v92, v88, v12
  v_mul_f32 v93, v89, v12
  v_mul_f32 v94, v90, v12
  v_mul_f32 v95, v91, v12
  v_cvt_pk_bf16_f32 v84, v92, v93
  v_cvt_pk_bf16_f32 v85, v94, v95
  v_lshlrev_b32 v92, 16, v84
  v_and_b32 v93, 0xffff0000, v84
  v_lshlrev_b32 v94, 16, v85
  v_and_b32 v95, 0xffff0000, v85
  s_waitcnt lgkmcnt(1)
  v_fmac_f32 v80, v88, v11
  v_fmac_f32 v81, v89, v11
  v_fmac_f32 v82, v90, v11
  v_fmac_f32 v83, v91, v11
  v_cvt_pk_bf16_f32 v84, v80, v81
  v_cvt_pk_bf16_f32 v85, v82, v83
  v_lshlrev_b32 v80, 16, v84
  v_and_b32 v81, 0xffff0000, v84
  v_lshlrev_b32 v82, 16, v85
  v_and_b32 v83, 0xffff0000, v85
  v_add_f32 v80, v80, v92
  v_add_f32 v81, v81, v93
  v_add_f32 v82, v82, v94
  v_add_f32 v83, v83, v95
  v_cvt_pk_bf16_f32 v84, v80, v81
  v_cvt_pk_bf16_f32 v85, v82, v83
  v_lshlrev_b32 v80, 16, v84
  v_and_b32 v81, 0xffff0000, v84
  v_lshlrev_b32 v82, 16, v85
  v_and_b32 v83, 0xffff0000, v85
  v_add_f32 v80, v80, v96
  v_add_f32 v81, v81, v97
  v_add_f32 v82, v82, v98
  v_add_f32 v83, v83, v99
  v_cvt_pk_bf16_f32 v84, v80, v81
  v_cvt_pk_bf16_f32 v85, v82, v83
  buffer_store_dwordx2 v[84:85], v10, s[8:11], s40 offen sc1
  v_mfma_f32_16x16x32_bf16 a[8:11], v[16:19], v[48:51], a[8:11]
  ds_read_b128 v[48:51], v4 offset:2048
  v_mfma_f32_16x16x32_bf16 a[40:43], v[20:23], v[52:55], a[40:43]
  ds_read_b128 v[52:55], v4 offset:6656
  v_mfma_f32_16x16x32_bf16 a[72:75], v[24:27], v[56:59], a[72:75]
  ds_read_b128 v[56:59], v4 offset:11264
  v_mfma_f32_16x16x32_bf16 a[104:107], v[28:31], v[60:63], a[104:107]
  ds_read_b128 v[60:63], v4 offset:15872
  v_mfma_f32_16x16x32_bf16 a[136:139], v[32:35], v[64:67], a[136:139]
  ds_read_b128 v[64:67], v4 offset:20480
  v_mfma_f32_16x16x32_bf16 a[168:171], v[36:39], v[68:71], a[168:171]
  ds_read_b128 v[68:71], v4 offset:25088
  v_mfma_f32_16x16x32_bf16 a[200:203], v[40:43], v[72:75], a[200:203]
  ds_read_b128 v[72:75], v4 offset:29696
  v_mfma_f32_16x16x32_bf16 a[232:235], v[44:47], v[76:79], a[232:235]
  ds_read_b128 v[76:79], v4 offset:34304
  s_waitcnt lgkmcnt(7)
  v_mfma_f32_16x16x32_bf16 a[12:15], v[16:19], v[48:51], a[12:15]
  ds_read_b128 v[48:51], v4 offset:1536
  s_waitcnt lgkmcnt(7)
  v_mfma_f32_16x16x32_bf16 a[44:47], v[20:23], v[52:55], a[44:47]
  ds_read_b128 v[52:55], v4 offset:6144
  s_waitcnt lgkmcnt(7)
  v_mfma_f32_16x16x32_bf16 a[76:79], v[24:27], v[56:59], a[76:79]
  ds_read_b128 v[56:59], v4 offset:10752
  s_waitcnt lgkmcnt(7)
  v_mfma_f32_16x16x32_bf16 a[108:111], v[28:31], v[60:63], a[108:111]
  ds_read_b128 v[60:63], v4 offset:15360
  s_waitcnt lgkmcnt(7)
  v_mfma_f32_16x16x32_bf16 a[140:143], v[32:35], v[64:67], a[140:143]
  ds_read_b128 v[64:67], v4 offset:19968
  s_waitcnt lgkmcnt(7)
  v_mfma_f32_16x16x32_bf16 a[172:175], v[36:39], v[68:71], a[172:175]
  ds_read_b128 v[68:71], v4 offset:24576
  s_waitcnt lgkmcnt(7)
  v_mfma_f32_16x16x32_bf16 a[204:207], v[40:43], v[72:75], a[204:207]
  ds_read_b128 v[72:75], v4 offset:29184
  s_waitcnt lgkmcnt(7)
  v_mfma_f32_16x16x32_bf16 a[236:239], v[44:47], v[76:79], a[236:239]
  ds_read_b128 v[76:79], v4 offset:33792
  s_waitcnt lgkmcnt(7)
  v_mfma_f32_16x16x32_bf16 a[16:19], v[16:19], v[48:51], a[16:19]
  ds_read_b128 v[48:51], v4 offset:1024
  s_waitcnt lgkmcnt(7)
  v_mfma_f32_16x16x32_bf16 a[48:51], v[20:23], v[52:55], a[48:51]
  ds_read_b128 v[52:55], v4 offset:5632
  s_waitcnt lgkmcnt(7)
  v_mfma_f32_16x16x32_bf16 a[80:83], v[24:27], v[56:59], a[80:83]
  ds_read_b128 v[56:59], v4 offset:10240
  s_waitcnt lgkmcnt(7)
  v_mfma_f32_16x16x32_bf16 a[112:115], v[28:31], v[60:63], a[112:115]
  ds_read_b128 v[60:63], v4 offset:14848
  s_waitcnt lgkmcnt(7)
  v_mfma_f32_16x16x32_bf16 a[144:147], v[32:35], v[64:67], a[144:147]
  ds_read_b128 v[64:67], v4 offset:19456
  s_waitcnt lgkmcnt(7)
  v_mfma_f32_16x16x32_bf16 a[176:179], v[36:39], v[68:71], a[176:179]
  ds_read_b128 v[68:71], v4 offset:24064
  s_waitcnt lgkmcnt(7)
  v_mfma_f32_16x16x32_bf16 a[208:211], v[40:43], v[72:75], a[208:211]
  ds_read_b128 v[72:75], v4 offset:28672
  s_waitcnt lgkmcnt(7)
  v_mfma_f32_16x16x32_bf16 a[240:243], v[44:47], v[76:79], a[240:243]
  ds_read_b128 v[76:79], v4 offset:33280
  s_waitcnt lgkmcnt(7)
  v_mfma_f32_16x16x32_bf16 a[20:23], v[16:19], v[48:51], a[20:23]
  ds_read_b128 v[48:51], v4 offset:512
  s_waitcnt lgkmcnt(7)
  v_mfma_f32_16x16x32_bf16 a[52:55], v[20:23], v[52:55], a[52:55]
  ds_read_b128 v[52:55], v4 offset:5120
  s_waitcnt lgkmcnt(7)
  v_mfma_f32_16x16x32_bf16 a[84:87], v[24:27], v[56:59], a[84:87]
  ds_read_b128 v[56:59], v4 offset:9728
  s_waitcnt lgkmcnt(7)
  v_mfma_f32_16x16x32_bf16 a[116:119], v[28:31], v[60:63], a[116:119]
  ds_read_b128 v[60:63], v4 offset:14336
  s_waitcnt lgkmcnt(7)
  v_mfma_f32_16x16x32_bf16 a[148:151], v[32:35], v[64:67], a[148:151]
  ds_read_b128 v[64:67], v4 offset:18944
  s_waitcnt lgkmcnt(7)
  v_mfma_f32_16x16x32_bf16 a[180:183], v[36:39], v[68:71], a[180:183]
  ds_read_b128 v[68:71], v4 offset:23552
  s_waitcnt lgkmcnt(7)
  v_mfma_f32_16x16x32_bf16 a[212:215], v[40:43], v[72:75], a[212:215]
  ds_read_b128 v[72:75], v4 offset:28160
  s_waitcnt lgkmcnt(7)
  v_mfma_f32_16x16x32_bf16 a[244:247], v[44:47], v[76:79], a[244:247]
  ds_read_b128 v[76:79], v4 offset:32768
  s_waitcnt lgkmcnt(7)
  v_mfma_f32_16x16x32_bf16 a[24:27], v[16:19], v[48:51], a[24:27]
  ds_read_b128 v[48:51], v4 offset:0
  s_waitcnt lgkmcnt(7)
  v_mfma_f32_16x16x32_bf16 a[56:59], v[20:23], v[52:55], a[56:59]
  ds_read_b128 v[52:55], v4 offset:4608
  s_waitcnt lgkmcnt(7)
  v_mfma_f32_16x16x32_bf16 a[88:91], v[24:27], v[56:59], a[88:91]
  ds_read_b128 v[56:59], v4 offset:9216
  s_waitcnt lgkmcnt(7)
  v_mfma_f32_16x16x32_bf16 a[120:123], v[28:31], v[60:63], a[120:123]
  ds_read_b128 v[60:63], v4 offset:13824
  s_waitcnt lgkmcnt(7)
  v_mfma_f32_16x16x32_bf16 a[152:155], v[32:35], v[64:67], a[152:155]
  ds_read_b128 v[64:67], v4 offset:18432
  s_waitcnt lgkmcnt(7)
  v_mfma_f32_16x16x32_bf16 a[184:187], v[36:39], v[68:71], a[184:187]
  ds_read_b128 v[68:71], v4 offset:23040
  s_waitcnt lgkmcnt(7)
  v_mfma_f32_16x16x32_bf16 a[216:219], v[40:43], v[72:75], a[216:219]
  ds_read_b128 v[72:75], v4 offset:27648
  s_waitcnt lgkmcnt(7)
  v_mfma_f32_16x16x32_bf16 a[248:251], v[44:47], v[76:79], a[248:251]
  ds_read_b128 v[76:79], v4 offset:32256
  s_waitcnt lgkmcnt(7)
  v_mfma_f32_16x16x32_bf16 a[28:31], v[16:19], v[48:51], a[28:31]
  s_waitcnt lgkmcnt(6)
  v_mfma_f32_16x16x32_bf16 a[60:63], v[20:23], v[52:55], a[60:63]
  s_waitcnt lgkmcnt(5)
  v_mfma_f32_16x16x32_bf16 a[92:95], v[24:27], v[56:59], a[92:95]
  s_waitcnt lgkmcnt(4)
  v_mfma_f32_16x16x32_bf16 a[124:127], v[28:31], v[60:63], a[124:127]
  s_waitcnt lgkmcnt(3)
  v_mfma_f32_16x16x32_bf16 a[156:159], v[32:35], v[64:67], a[156:159]
  s_waitcnt lgkmcnt(2)
  v_mfma_f32_16x16x32_bf16 a[188:191], v[36:39], v[68:71], a[188:191]
  s_waitcnt lgkmcnt(1)
  v_mfma_f32_16x16x32_bf16 a[220:223], v[40:43], v[72:75], a[220:223]
  s_waitcnt lgkmcnt(0)
  v_mfma_f32_16x16x32_bf16 a[252:255], v[44:47], v[76:79], a[252:255]
  v_add_u32 v104, 64, v104
  v_add_u32 v105, 64, v105
  v_add_u32 v106, 64, v106
  v_add_u32 v107, 64, v107
  v_add_u32 v108, 64, v108
  v_add_u32 v109, 64, v109
  v_add_u32 v110, 64, v110
  v_add_u32 v111, 64, v111
  v_add_u32 v4, 64, v4
  v_add_u32 v8, 64, v8
  s_add_u32 s40, s40, 0x8000
  s_waitcnt vmcnt(0)
  s_mov_b64 exec, 1
  buffer_store_dword v13, v1, s[8:11], s39 offen sc1
  s_mov_b64 exec, -1
  ds_write_b32 v14, v13 offset:16
  s_add_u32 s32, s32, 1
  s_and_b32 s6, s32, 7
  s_cbranch_scc1 L_c_conv1
L_c_conv2:
  s_add_u32 s33, s32, 1
  s_and_b32 s6, s32, 7
  s_lshl_b32 s7, s6, 10
  s_add_u32 s7, s7, s35
  v_add_u32 v9, s7, v10
  s_lshl_b32 s6, s6, 1
  s_lshl_b32 s42, 0x30003, s6
  v_mov_b32 v13, s33
  ds_read_b128 v[48:51], v4 offset:2560
  ds_read_b128 v[52:55], v4 offset:7168
  ds_read_b128 v[56:59], v4 offset:11776
  ds_read_b128 v[60:63], v4 offset:16384
  ds_read_b128 v[64:67], v4 offset:20992
  ds_read_b128 v[68:71], v4 offset:25600
  ds_read_b128 v[72:75], v4 offset:30208
  ds_read_b128 v[76:79], v4 offset:34816
  s_mov_b32 s7, 0
L_lw_124:
  ds_read_b32 v88, v2 offset:0
  s_waitcnt lgkmcnt(0)
  v_cmp_gt_i32 vcc, s33, v88
  s_cbranch_vccz L_lwo_125
  s_add_u32 s7, s7, 1
  s_cmp_lt_u32 s7, 131072
  s_cbranch_scc1 L_lw_124
  s_mov_b32 s6, 42
  s_branch L_err
L_lwo_125:
  ds_read2_b32 v[112:113], v104 offset0:0 offset1:1
  ds_read2_b32 v[114:115], v104 offset0:2 offset1:3
  ds_read_b32 v116, v104 offset:16
  ds_read2_b32 v[118:119], v105 offset0:0 offset1:1
  ds_read2_b32 v[120:121], v105 offset0:2 offset1:3
  ds_read_b32 v122, v105 offset:16
  ds_read2_b32 v[124:125], v106 offset0:0 offset1:1
  ds_read2_b32 v[126:127], v106 offset0:2 offset1:3
  ds_read_b32 v128, v106 offset:16
  ds_read2_b32 v[130:131], v107 offset0:0 offset1:1
  ds_read2_b32 v[132:133], v107 offset0:2 offset1:3
  ds_read_b32 v134, v107 offset:16
  s_waitcnt lgkmcnt(9)
  v_alignbyte_b32 v16, v113, v112, v15
  v_alignbyte_b32 v17, v114, v113, v15
  v_alignbyte_b32 v18, v115, v114, v15
  v_alignbyte_b32 v19, v116, v115, v15
  ds_read2_b32 v[112:113], v108 offset0:0 offset1:1
  ds_read2_b32 v[114:115], v108 offset0:2 offset1:3
  ds_read_b32 v116, v108 offset:16
  s_waitcnt lgkmcnt(9)
  v_alignbyte_b32 v20, v119, v118, v15
  v_alignbyte_b32 v21, v120, v119, v15
  v_alignbyte_b32 v22, v121, v120, v15
  v_alignbyte_b32 v23, v122, v121, v15
  ds_read2_b32 v[118:119], v109 offset0:0 offset1:1
  ds_read2_b32 v[120:121], v109 offset0:2 offset1:3
  ds_read_b32 v122, v109 offset:16
  v_mfma_f32_16x16x32_bf16 a[8:11], v[16:19], v[48:51], a[8:11]
  s_waitcnt lgkmcnt(9)
  v_alignbyte_b32 v24, v125, v124, v15
  v_alignbyte_b32 v25, v126, v125, v15
  v_alignbyte_b32 v26, v127, v126, v15
  v_alignbyte_b32 v27, v128, v127, v15
  ds_read2_b32 v[124:125], v110 offset0:0 offset1:1
  ds_read2_b32 v[126:127], v110 offset0:2 offset1:3
  ds_read_b32 v128, v110 offset:16
  v_mfma_f32_16x16x32_bf16 a[40:43], v[20:23], v[52:55], a[40:43]
  s_waitcnt lgkmcnt(9)
  v_alignbyte_b32 v28, v131, v130, v15
  v_alignbyte_b32 v29, v132, v131, v15
  v_alignbyte_b32 v30, v133, v132, v15
  v_alignbyte_b32 v31, v134, v133, v15
  ds_read2_b32 v[130:131], v111 offset0:0 offset1:1
  ds_read2_b32 v[132:133], v111 offset0:2 offset1:3
  ds_read_b32 v134, v111 offset:16
  v_mfma_f32_16x16x32_bf16 a[72:75], v[24:27], v[56:59], a[72:75]
  s_waitcnt lgkmcnt(9)
  v_alignbyte_b32 v32, v113, v112, v15
  v_alignbyte_b32 v33, v114, v113, v15
  v_alignbyte_b32 v34, v115, v114, v15
  v_alignbyte_b32 v35, v116, v115, v15
  ds_read_b64 v[84:85], v8
  ds_read_b64 v[86:87], v9
  v_mfma_f32_16x16x32_bf16 a[104:107], v[28:31], v[60:63], a[104:107]
  s_waitcnt lgkmcnt(8)
  v_alignbyte_b32 v36, v119, v118, v15
  v_alignbyte_b32 v37, v120, v119, v15
  v_alignbyte_b32 v38, v121, v120, v15
  v_alignbyte_b32 v39, v122, v121, v15
  v_mfma_f32_16x16x32_bf16 a[136:139], v[32:35], v[64:67], a[136:139]
  s_waitcnt lgkmcnt(5)
  v_alignbyte_b32 v40, v125, v124, v15
  v_alignbyte_b32 v41, v126, v125, v15
  v_alignbyte_b32 v42, v127, v126, v15
  v_alignbyte_b32 v43, v128, v127, v15
  v_mfma_f32_16x16x32_bf16 a[168:171], v[36:39], v[68:71], a[168:171]
  s_waitcnt lgkmcnt(2)
  v_alignbyte_b32 v44, v131, v130, v15
  v_alignbyte_b32 v45, v132, v131, v15
  v_alignbyte_b32 v46, v133, v132, v15
  v_alignbyte_b32 v47, v134, v133, v15
  v_mfma_f32_16x16x32_bf16 a[200:203], v[40:43], v[72:75], a[200:203]
  s_nop 0
  v_mfma_f32_16x16x32_bf16 a[232:235], v[44:47], v[76:79], a[232:235]
  s_waitcnt lgkmcnt(0)
  ds_read_b128 v[48:51], v4 offset:2048
  ds_read_b128 v[52:55], v4 offset:6656
  ds_read_b128 v[56:59], v4 offset:11264
  ds_read_b128 v[60:63], v4 offset:15872
  ds_read_b128 v[64:67], v4 offset:20480
  ds_read_b128 v[68:71], v4 offset:25088
  ds_read_b128 v[72:75], v4 offset:29696
  ds_read_b128 v[76:79], v4 offset:34304
  s_mov_b32 exec_lo, s42
  s_mov_b32 exec_hi, s42
  ds_write_b128 v6, a[8:11] offset:0
  ds_write_b128 v6, a[40:43] offset:128
  ds_write_b128 v6, a[72:75] offset:256
  ds_write_b128 v6, a[104:107] offset:384
  ds_write_b128 v6, a[136:139] offset:512
  ds_write_b128 v6, a[168:171] offset:640
  ds_write_b128 v6, a[200:203] offset:768
  ds_write_b128 v6, a[232:235] offset:896
  s_mov_b64 exec, -1
  ds_read_b128 v[80:83], v7
  ds_write_b32 v14, v13 offset:8
  v_lshlrev_b32 v88, 16, v84
  v_and_b32 v89, 0xffff0000, v84
  v_lshlrev_b32 v90, 16, v85
  v_and_b32 v91, 0xffff0000, v85
  v_lshlrev_b32 v96, 16, v86
  v_and_b32 v97, 0xffff0000, v86
  v_lshlrev_b32 v98, 16, v87
  v_and_b32 v99, 0xffff0000, v87
  v_mul_f32 v92, v88, v12
  v_mul_f32 v93, v89, v12
  v_mul_f32 v94, v90, v12
  v_mul_f32 v95, v91, v12
  v_cvt_pk_bf16_f32 v84, v92, v93
  v_cvt_pk_bf16_f32 v85, v94, v95
  v_lshlrev_b32 v92, 16, v84
  v_and_b32 v93, 0xffff0000, v84
  v_lshlrev_b32 v94, 16, v85
  v_and_b32 v95, 0xffff0000, v85
  s_waitcnt lgkmcnt(1)
  v_fmac_f32 v80, v88, v11
  v_fmac_f32 v81, v89, v11
  v_fmac_f32 v82, v90, v11
  v_fmac_f32 v83, v91, v11
  v_cvt_pk_bf16_f32 v84, v80, v81
  v_cvt_pk_bf16_f32 v85, v82, v83
  v_lshlrev_b32 v80, 16, v84
  v_and_b32 v81, 0xffff0000, v84
  v_lshlrev_b32 v82, 16, v85
  v_and_b32 v83, 0xffff0000, v85
  v_add_f32 v80, v80, v92
  v_add_f32 v81, v81, v93
  v_add_f32 v82, v82, v94
  v_add_f32 v83, v83, v95
  v_cvt_pk_bf16_f32 v84, v80, v81
  v_cvt_pk_bf16_f32 v85, v82, v83
  v_lshlrev_b32 v80, 16, v84
  v_and_b32 v81, 0xffff0000, v84
  v_lshlrev_b32 v82, 16, v85
  v_and_b32 v83, 0xffff0000, v85
  v_add_f32 v80, v80, v96
  v_add_f32 v81, v81, v97
  v_add_f32 v82, v82, v98
  v_add_f32 v83, v83, v99
  v_cvt_pk_bf16_f32 v84, v80, v81
  v_cvt_pk_bf16_f32 v85, v82, v83
  buffer_store_dwordx2 v[84:85], v10, s[8:11], s40 offen sc1
  v_mfma_f32_16x16x32_bf16 a[12:15], v[16:19], v[48:51], a[12:15]
  ds_read_b128 v[48:51], v4 offset:1536
  v_mfma_f32_16x16x32_bf16 a[44:47], v[20:23], v[52:55], a[44:47]
  ds_read_b128 v[52:55], v4 offset:6144
  v_mfma_f32_16x16x32_bf16 a[76:79], v[24:27], v[56:59], a[76:79]
  ds_read_b128 v[56:59], v4 offset:10752
  v_mfma_f32_16x16x32_bf16 a[108:111], v[28:31], v[60:63], a[108:111]
  ds_read_b128 v[60:63], v4 offset:15360
  v_mfma_f32_16x16x32_bf16 a[140:143], v[32:35], v[64:67], a[140:143]
  ds_read_b128 v[64:67], v4 offset:19968
  v_mfma_f32_16x16x32_bf16 a[172:175], v[36:39], v[68:71], a[172:175]
  ds_read_b128 v[68:71], v4 offset:24576
  v_mfma_f32_16x16x32_bf16 a[204:207], v[40:43], v[72:75], a[204:207]
  ds_read_b128 v[72:75], v4 offset:29184
  v_mfma_f32_16x16x32_bf16 a[236:239], v[44:47], v[76:79], a[236:239]
  ds_read_b128 v[76:79], v4 offset:33792
  s_waitcnt lgkmcnt(7)
  v_mfma_f32_16x16x32_bf16 a[16:19], v[16:19], v[48:51], a[16:19]
  ds_read_b128 v[48:51], v4 offset:1024
  s_waitcnt lgkmcnt(7)
  v_mfma_f32_16x16x32_bf16 a[48:51], v[20:23], v[52:55], a[48:51]
  ds_read_b128 v[52:55], v4 offset:5632
  s_waitcnt lgkmcnt(7)
  v_mfma_f32_16x16x32_bf16 a[80:83], v[24:27], v[56:59], a[80:83]
  ds_read_b128 v[56:59], v4 offset:10240
  s_waitcnt lgkmcnt(7)
  v_mfma_f32_16x16x32_bf16 a[112:115], v[28:31], v[60:63], a[112:115]
  ds_read_b128 v[60:63], v4 offset:14848
  s_waitcnt lgkmcnt(7)
  v_mfma_f32_16x16x32_bf16 a[144:147], v[32:35], v[64:67], a[144:147]
  ds_read_b128 v[64:67], v4 offset:19456
  s_waitcnt lgkmcnt(7)
  v_mfma_f32_16x16x32_bf16 a[176:179], v[36:39], v[68:71], a[176:179]
  ds_read_b128 v[68:71], v4 offset:24064
  s_waitcnt lgkmcnt(7)
  v_mfma_f32_16x16x32_bf16 a[208:211], v[40:43], v[72:75], a[208:211]
  ds_read_b128 v[72:75], v4 offset:28672
  s_waitcnt lgkmcnt(7)
  v_mfma_f32_16x16x32_bf16 a[240:243], v[44:47], v[76:79], a[240:243]
  ds_read_b128 v[76:79], v4 offset:33280
  s_waitcnt lgkmcnt(7)
  v_mfma_f32_16x16x32_bf16 a[20:23], v[16:19], v[48:51], a[20:23]
  ds_read_b128 v[48:51], v4 offset:512
  s_waitcnt lgkmcnt(7)
  v_mfma_f32_16x16x32_bf16 a[52:55], v[20:23], v[52:55], a[52:55]
  ds_read_b128 v[52:55], v4 offset:5120
  s_waitcnt lgkmcnt(7)
  v_mfma_f32_16x16x32_bf16 a[84:87], v[24:27], v[56:59], a[84:87]
  ds_read_b128 v[56:59], v4 offset:9728
  s_waitcnt lgkmcnt(7)
  v_mfma_f32_16x16x32_bf16 a[116:119], v[28:31], v[60:63], a[116:119]
  ds_read_b128 v[60:63], v4 offset:14336
  s_waitcnt lgkmcnt(7)
  v_mfma_f32_16x16x32_bf16 a[148:151], v[32:35], v[64:67], a[148:151]
  ds_read_b128 v[64:67], v4 offset:18944
  s_waitcnt lgkmcnt(7)
  v_mfma_f32_16x16x32_bf16 a[180:183], v[36:39], v[68:71], a[180:183]
  ds_read_b128 v[68:71], v4 offset:23552
  s_waitcnt lgkmcnt(7)
  v_mfma_f32_16x16x32_bf16 a[212:215], v[40:43], v[72:75], a[212:215]
  ds_read_b128 v[72:75], v4 offset:28160
  s_waitcnt lgkmcnt(7)
  v_mfma_f32_16x16x32_bf16 a[244:247], v[44:47], v[76:79], a[244:247]
  ds_read_b128 v[76:79], v4 offset:32768
  s_waitcnt lgkmcnt(7)
  v_mfma_f32_16x16x32_bf16 a[24:27], v[16:19], v[48:51], a[24:27]
  ds_read_b128 v[48:51], v4 offset:0
  s_waitcnt lgkmcnt(7)
  v_mfma_f32_16x16x32_bf16 a[56:59], v[20:23], v[52:55], a[56:59]
  ds_read_b128 v[52:55], v4 offset:4608
  s_waitcnt lgkmcnt(7)
  v_mfma_f32_16x16x32_bf16 a[88:91], v[24:27], v[56:59], a[88:91]
  ds_read_b128 v[56:59], v4 offset:9216
  s_waitcnt lgkmcnt(7)
  v_mfma_f32_16x16x32_bf16 a[120:123], v[28:31], v[60:63], a[120:123]
  ds_read_b128 v[60:63], v4 offset:13824
  s_waitcnt lgkmcnt(7)
  v_mfma_f32_16x16x32_bf16 a[152:155], v[32:35], v[64:67], a[152:155]
  ds_read_b128 v[64:67], v4 offset:18432
  s_waitcnt lgkmcnt(7)
  v_mfma_f32_16x16x32_bf16 a[184:187], v[36:39], v[68:71], a[184:187]
  ds_read_b128 v[68:71], v4 offset:23040
  s_waitcnt lgkmcnt(7)
  v_mfma_f32_16x16x32_bf16 a[216:219], v[40:43], v[72:75], a[216:219]
  ds_read_b128 v[72:75], v4 offset:27648
  s_waitcnt lgkmcnt(7)
  v_mfma_f32_16x16x32_bf16 a[248:251], v[44:47], v[76:79], a[248:251]
  ds_read_b128 v[76:79], v4 offset:32256
  s_waitcnt lgkmcnt(7)
  v_mfma_f32_16x16x32_bf16 a[28:31], v[16:19], v[48:51], a[28:31]
  s_waitcnt lgkmcnt(6)
  v_mfma_f32_16x16x32_bf16 a[60:63], v[20:23], v[52:55], a[60:63]
  s_waitcnt lgkmcnt(5)
  v_mfma_f32_16x16x32_bf16 a[92:95], v[24:27], v[56:59], a[92:95]
  s_waitcnt lgkmcnt(4)
  v_mfma_f32_16x16x32_bf16 a[124:127], v[28:31], v[60:63], a[124:127]
  s_waitcnt lgkmcnt(3)
  v_mfma_f32_16x16x32_bf16 a[156:159], v[32:35], v[64:67], a[156:159]
  s_waitcnt lgkmcnt(2)
  v_mfma_f32_16x16x32_bf16 a[188:191], v[36:39], v[68:71], a[188:191]
  s_waitcnt lgkmcnt(1)
  v_mfma_f32_16x16x32_bf16 a[220:223], v[40:43], v[72:75], a[220:223]
  s_waitcnt lgkmcnt(0)
  v_mfma_f32_16x16x32_bf16 a[252:255], v[44:47], v[76:79], a[252:255]
  v_add_u32 v104, 64, v104
  v_add_u32 v105, 64, v105
  v_add_u32 v106, 64, v106
  v_add_u32 v107, 64, v107
  v_add_u32 v108, 64, v108
  v_add_u32 v109, 64, v109
  v_add_u32 v110, 64, v110
  v_add_u32 v111, 64, v111
  v_add_u32 v4, 64, v4
  v_add_u32 v8, 64, v8
  s_add_u32 s40, s40, 0x8000
  s_waitcnt vmcnt(0)
  s_mov_b64 exec, 1
  buffer_store_dword v13, v1, s[8:11], s39 offen sc1
  s_mov_b64 exec, -1
  ds_write_b32 v14, v13 offset:16
  s_add_u32 s32, s32, 1
  s_and_b32 s6, s32, 7
  s_cbranch_scc1 L_c_conv2
L_c_conv3:
  s_add_u32 s33, s32, 1
  s_and_b32 s6, s32, 7
  s_lshl_b32 s7, s6, 10
  s_add_u32 s7, s7, s35
  v_add_u32 v9, s7, v10
  s_lshl_b32 s6, s6, 1
  s_lshl_b32 s42, 0x30003, s6
  v_mov_b32 v13, s33
  ds_read_b128 v[48:51], v4 offset:2048
  ds_read_b128 v[52:55], v4 offset:6656
  ds_read_b128 v[56:59], v4 offset:11264
  ds_read_b128 v[60:63], v4 offset:15872
  ds_read_b128 v[64:67], v4 offset:20480
  ds_read_b128 v[68:71], v4 offset:25088
  ds_read_b128 v[72:75], v4 offset:29696
  ds_read_b128 v[76:79], v4 offset:34304
  s_mov_b32 s7, 0
L_lw_126:
  ds_read_b32 v88, v2 offset:0
  s_waitcnt lgkmcnt(0)
  v_cmp_gt_i32 vcc, s33, v88
  s_cbranch_vccz L_lwo_127
  s_add_u32 s7, s7, 1
  s_cmp_lt_u32 s7, 131072
  s_cbranch_scc1 L_lw_126
  s_mov_b32 s6, 42
  s_branch L_err
L_lwo_127:
  ds_read2_b32 v[112:113], v104 offset0:0 offset1:1
  ds_read2_b32 v[114:115], v104 offset0:2 offset1:3
  ds_read_b32 v116, v104 offset:16
  ds_read2_b32 v[118:119], v105 offset0:0 offset1:1
  ds_read2_b32 v[120:121], v105 offset0:2 offset1:3
  ds_read_b32 v122, v105 offset:16
  ds_read2_b32 v[124:125], v106 offset0:0 offset1:1
  ds_read2_b32 v[126:127], v106 offset0:2 offset1:3
  ds_read_b32 v128, v106 offset:16
  ds_read2_b32 v[130:131], v107 offset0:0 offset1:1
  ds_read2_b32 v[132:133], v107 offset0:2 offset1:3
  ds_read_b32 v134, v107 offset:16
  s_waitcnt lgkmcnt(9)
  v_alignbyte_b32 v16, v113, v112, v15
  v_alignbyte_b32 v17, v114, v113, v15
  v_alignbyte_b32 v18, v115, v114, v15
  v_alignbyte_b32 v19, v116, v115, v15
  ds_read2_b32 v[112:113], v108 offset0:0 offset1:1
  ds_read2_b32 v[114:115], v108 offset0:2 offset1:3
  ds_read_b32 v116, v108 offset:16
  s_waitcnt lgkmcnt(9)
  v_alignbyte_b32 v20, v119, v118, v15
  v_alignbyte_b32 v21, v120, v119, v15
  v_alignbyte_b32 v22, v121, v120, v15
  v_alignbyte_b32 v23, v122, v121, v15
  ds_read2_b32 v[118:119], v109 offset0:0 offset1:1
  ds_read2_b32 v[120:121], v109 offset0:2 offset1:3
  ds_read_b32 v122, v109 offset:16
  v_mfma_f32_16x16x32_bf16 a[12:15], v[16:19], v[48:51], a[12:15]
  s_waitcnt lgkmcnt(9)
  v_alignbyte_b32 v24, v125, v124, v15
  v_alignbyte_b32 v25, v126, v125, v15
  v_alignbyte_b32 v26, v127, v126, v15
  v_alignbyte_b32 v27, v128, v127, v15
  ds_read2_b32 v[124:125], v110 offset0:0 offset1:1
  ds_read2_b32 v[126:127], v110 offset0:2 offset1:3
  ds_read_b32 v128, v110 offset:16
  v_mfma_f32_16x16x32_bf16 a[44:47], v[20:23], v[52:55], a[44:47]
  s_waitcnt lgkmcnt(9)
  v_alignbyte_b32 v28, v131, v130, v15
  v_alignbyte_b32 v29, v132, v131, v15
  v_alignbyte_b32 v30, v133, v132, v15
  v_alignbyte_b32 v31, v134, v133, v15
  ds_read2_b32 v[130:131], v111 offset0:0 offset1:1
  ds_read2_b32 v[132:133], v111 offset0:2 offset1:3
  ds_read_b32 v134, v111 offset:16
  v_mfma_f32_16x16x32_bf16 a[76:79], v[24:27], v[56:59], a[76:79]
  s_waitcnt lgkmcnt(9)
  v_alignbyte_b32 v32, v113, v112, v15
  v_alignbyte_b32 v33, v114, v113, v15
  v_alignbyte_b32 v34, v115, v114, v15
  v_alignbyte_b32 v35, v116, v115, v15
  ds_read_b64 v[84:85], v8
  ds_read_b64 v[86:87], v9
  v_mfma_f32_16x16x32_bf16 a[108:111], v[28:31], v[60:63], a[108:111]
  s_waitcnt lgkmcnt(8)
  v_alignbyte_b32 v36, v119, v118, v15
  v_alignbyte_b32 v37, v120, v119, v15
  v_alignbyte_b32 v38, v121, v120, v15
  v_alignbyte_b32 v39, v122, v121, v15
  v_mfma_f32_16x16x32_bf16 a[140:143], v[32:35], v[64:67], a[140:143]
  s_waitcnt lgkmcnt(5)
  v_alignbyte_b32 v40, v125, v124, v15
  v_alignbyte_b32 v41, v126, v125, v15
  v_alignbyte_b32 v42, v127, v126, v15
  v_alignbyte_b32 v43, v128, v127, v15
  v_mfma_f32_16x16x32_bf16 a[172:175], v[36:39], v[68:71], a[172:175]
  s_waitcnt lgkmcnt(2)
  v_alignbyte_b32 v44, v131, v130, v15
  v_alignbyte_b32 v45, v132, v131, v15
  v_alignbyte_b32 v46, v133, v132, v15
  v_alignbyte_b32 v47, v134, v133, v15
  v_mfma_f32_16x16x32_bf16 a[204:207], v[40:43], v[72:75], a[204:207]
  s_nop 0
  v_mfma_f32_16x16x32_bf16 a[236:239], v[44:47], v[76:79], a[236:239]
  s_waitcnt lgkmcnt(0)
  ds_read_b128 v[48:51], v4 offset:1536
  ds_read_b128 v[52:55], v4 offset:6144
  ds_read_b128 v[56:59], v4 offset:10752
  ds_read_b128 v[60:63], v4 offset:15360
  ds_read_b128 v[64:67], v4 offset:19968
  ds_read_b128 v[68:71], v4 offset:24576
  ds_read_b128 v[72:75], v4 offset:29184
  ds_read_b128 v[76:79], v4 offset:33792
  s_mov_b32 exec_lo, s42
  s_mov_b32 exec_hi, s42
  ds_write_b128 v6, a[12:15] offset:0
  ds_write_b128 v6, a[44:47] offset:128
  ds_write_b128 v6, a[76:79] offset:256
  ds_write_b128 v6, a[108:111] offset:384
  ds_write_b128 v6, a[140:143] offset:512
  ds_write_b128 v6, a[172:175] offset:640
  ds_write_b128 v6, a[204:207] offset:768
  ds_write_b128 v6, a[236:239] offset:896
  s_mov_b64 exec, -1
  ds_read_b128 v[80:83], v7
  ds_write_b32 v14, v13 offset:8
  v_lshlrev_b32 v88, 16, v84
  v_and_b32 v89, 0xffff0000, v84
  v_lshlrev_b32 v90, 16, v85
  v_and_b32 v91, 0xffff0000, v85
  v_lshlrev_b32 v96, 16, v86
  v_and_b32 v97, 0xffff0000, v86
  v_lshlrev_b32 v98, 16, v87
  v_and_b32 v99, 0xffff0000, v87
  v_mul_f32 v92, v88, v12
  v_mul_f32 v93, v89, v12
  v_mul_f32 v94, v90, v12
  v_mul_f32 v95, v91, v12
  v_cvt_pk_bf16_f32 v84, v92, v93
  v_cvt_pk_bf16_f32 v85, v94, v95
  v_lshlrev_b32 v92, 16, v84
  v_and_b32 v93, 0xffff0000, v84
  v_lshlrev_b32 v94, 16, v85
  v_and_b32 v95, 0xffff0000, v85
  s_waitcnt lgkmcnt(1)
  v_fmac_f32 v80, v88, v11
  v_fmac_f32 v81, v89, v11
  v_fmac_f32 v82, v90, v11
  v_fmac_f32 v83, v91, v11
  v_cvt_pk_bf16_f32 v84, v80, v81
  v_cvt_pk_bf16_f32 v85, v82, v83
  v_lshlrev_b32 v80, 16, v84
  v_and_b32 v81, 0xffff0000, v84
  v_lshlrev_b32 v82, 16, v85
  v_and_b32 v83, 0xffff0000, v85
  v_add_f32 v80, v80, v92
  v_add_f32 v81, v81, v93
  v_add_f32 v82, v82, v94
  v_add_f32 v83, v83, v95
  v_cvt_pk_bf16_f32 v84, v80, v81
  v_cvt_pk_bf16_f32 v85, v82, v83
  v_lshlrev_b32 v80, 16, v84
  v_and_b32 v81, 0xffff0000, v84
  v_lshlrev_b32 v82, 16, v85
  v_and_b32 v83, 0xffff0000, v85
  v_add_f32 v80, v80, v96
  v_add_f32 v81, v81, v97
  v_add_f32 v82, v82, v98
  v_add_f32 v83, v83, v99
  v_cvt_pk_bf16_f32 v84, v80, v81
  v_cvt_pk_bf16_f32 v85, v82, v83
  buffer_store_dwordx2 v[84:85], v10, s[8:11], s40 offen sc1
  v_mfma_f32_16x16x32_bf16 a[16:19], v[16:19], v[48:51], a[16:19]
  ds_read_b128 v[48:51], v4 offset:1024
  v_mfma_f32_16x16x32_bf16 a[48:51], v[20:23], v[52:55], a[48:51]
  ds_read_b128 v[52:55], v4 offset:5632
  v_mfma_f32_16x16x32_bf16 a[80:83], v[24:27], v[56:59], a[80:83]
  ds_read_b128 v[56:59], v4 offset:10240
  v_mfma_f32_16x16x32_bf16 a[112:115], v[28:31], v[60:63], a[112:115]
  ds_read_b128 v[60:63], v4 offset:14848
  v_mfma_f32_16x16x32_bf16 a[144:147], v[32:35], v[64:67], a[144:147]
  ds_read_b128 v[64:67], v4 offset:19456
  v_mfma_f32_16x16x32_bf16 a[176:179], v[36:39], v[68:71], a[176:179]
  ds_read_b128 v[68:71], v4 offset:24064
  v_mfma_f32_16x16x32_bf16 a[208:211], v[40:43], v[72:75], a[208:211]
  ds_read_b128 v[72:75], v4 offset:28672
  v_mfma_f32_16x16x32_bf16 a[240:243], v[44:47], v[76:79], a[240:243]
  ds_read_b128 v[76:79], v4 offset:33280
  s_waitcnt lgkmcnt(7)
  v_mfma_f32_16x16x32_bf16 a[20:23], v[16:19], v[48:51], a[20:23]
  ds_read_b128 v[48:51], v4 offset:512
  s_waitcnt lgkmcnt(7)
  v_mfma_f32_16x16x32_bf16 a[52:55], v[20:23], v[52:55], a[52:55]
  ds_read_b128 v[52:55], v4 offset:5120
  s_waitcnt lgkmcnt(7)
  v_mfma_f32_16x16x32_bf16 a[84:87], v[24:27], v[56:59], a[84:87]
  ds_read_b128 v[56:59], v4 offset:9728
  s_waitcnt lgkmcnt(7)
  v_mfma_f32_16x16x32_bf16 a[116:119], v[28:31], v[60:63], a[116:119]
  ds_read_b128 v[60:63], v4 offset:14336
  s_waitcnt lgkmcnt(7)
  v_mfma_f32_16x16x32_bf16 a[148:151], v[32:35], v[64:67], a[148:151]
  ds_read_b128 v[64:67], v4 offset:18944
  s_waitcnt lgkmcnt(7)
  v_mfma_f32_16x16x32_bf16 a[180:183], v[36:39], v[68:71], a[180:183]
  ds_read_b128 v[68:71], v4 offset:23552
  s_waitcnt lgkmcnt(7)
  v_mfma_f32_16x16x32_bf16 a[212:215], v[40:43], v[72:75], a[212:215]
  ds_read_b128 v[72:75], v4 offset:28160
  s_waitcnt lgkmcnt(7)
  v_mfma_f32_16x16x32_bf16 a[244:247], v[44:47], v[76:79], a[244:247]
  ds_read_b128 v[76:79], v4 offset:32768
  s_waitcnt lgkmcnt(7)
  v_mfma_f32_16x16x32_bf16 a[24:27], v[16:19], v[48:51], a[24:27]
  ds_read_b128 v[48:51], v4 offset:0
  s_waitcnt lgkmcnt(7)
  v_mfma_f32_16x16x32_bf16 a[56:59], v[20:23], v[52:55], a[56:59]
  ds_read_b128 v[52:55], v4 offset:4608
  s_waitcnt lgkmcnt(7)
  v_mfma_f32_16x16x32_bf16 a[88:91], v[24:27], v[56:59], a[88:91]
  ds_read_b128 v[56:59], v4 offset:9216
  s_waitcnt lgkmcnt(7)
  v_mfma_f32_16x16x32_bf16 a[120:123], v[28:31], v[60:63], a[120:123]
  ds_read_b128 v[60:63], v4 offset:13824
  s_waitcnt lgkmcnt(7)
  v_mfma_f32_16x16x32_bf16 a[152:155], v[32:35], v[64:67], a[152:155]
  ds_read_b128 v[64:67], v4 offset:18432
  s_waitcnt lgkmcnt(7)
  v_mfma_f32_16x16x32_bf16 a[184:187], v[36:39], v[68:71], a[184:187]
  ds_read_b128 v[68:71], v4 offset:23040
  s_waitcnt lgkmcnt(7)
  v_mfma_f32_16x16x32_bf16 a[216:219], v[40:43], v[72:75], a[216:219]
  ds_read_b128 v[72:75], v4 offset:27648
  s_waitcnt lgkmcnt(7)
  v_mfma_f32_16x16x32_bf16 a[248:251], v[44:47], v[76:79], a[248:251]
  ds_read_b128 v[76:79], v4 offset:32256
  s_waitcnt lgkmcnt(7)
  v_mfma_f32_16x16x32_bf16 a[28:31], v[16:19], v[48:51], a[28:31]
  s_waitcnt lgkmcnt(6)
  v_mfma_f32_16x16x32_bf16 a[60:63], v[20:23], v[52:55], a[60:63]
  s_waitcnt lgkmcnt(5)
  v_mfma_f32_16x16x32_bf16 a[92:95], v[24:27], v[56:59], a[92:95]
  s_waitcnt lgkmcnt(4)
  v_mfma_f32_16x16x32_bf16 a[124:127], v[28:31], v[60:63], a[124:127]
  s_waitcnt lgkmcnt(3)
  v_mfma_f32_16x16x32_bf16 a[156:159], v[32:35], v[64:67], a[156:159]
  s_waitcnt lgkmcnt(2)
  v_mfma_f32_16x16x32_bf16 a[188:191], v[36:39], v[68:71], a[188:191]
  s_waitcnt lgkmcnt(1)
  v_mfma_f32_16x16x32_bf16 a[220:223], v[40:43], v[72:75], a[220:223]
  s_waitcnt lgkmcnt(0)
  v_mfma_f32_16x16x32_bf16 a[252:255], v[44:47], v[76:79], a[252:255]
  v_add_u32 v104, 64, v104
  v_add_u32 v105, 64, v105
  v_add_u32 v106, 64, v106
  v_add_u32 v107, 64, v107
  v_add_u32 v108, 64, v108
  v_add_u32 v109, 64, v109
  v_add_u32 v110, 64, v110
  v_add_u32 v111, 64, v111
  v_add_u32 v4, 64, v4
  v_add_u32 v8, 64, v8
  s_add_u32 s40, s40, 0x8000
  s_waitcnt vmcnt(0)
  s_mov_b64 exec, 1
  buffer_store_dword v13, v1, s[8:11], s39 offen sc1
  s_mov_b64 exec, -1
  ds_write_b32 v14, v13 offset:16
  s_add_u32 s32, s32, 1
  s_and_b32 s6, s32, 7
  s_cbranch_scc1 L_c_conv3
L_c_conv4:
  s_add_u32 s33, s32, 1
  s_and_b32 s6, s32, 7
  s_lshl_b32 s7, s6, 10
  s_add_u32 s7, s7, s35
  v_add_u32 v9, s7, v10
  s_lshl_b32 s6, s6, 1
  s_lshl_b32 s42, 0x30003, s6
  v_mov_b32 v13, s33
  ds_read_b128 v[48:51], v4 offset:1536
  ds_read_b128 v[52:55], v4 offset:6144
  ds_read_b128 v[56:59], v4 offset:10752
  ds_read_b128 v[60:63], v4 offset:15360
  ds_read_b128 v[64:67], v4 offset:19968
  ds_read_b128 v[68:71], v4 offset:24576
  ds_read_b128 v[72:75], v4 offset:29184
  ds_read_b128 v[76:79], v4 offset:33792
  s_mov_b32 s7, 0
L_lw_128:
  ds_read_b32 v88, v2 offset:0
  s_waitcnt lgkmcnt(0)
  v_cmp_gt_i32 vcc, s33, v88
  s_cbranch_vccz L_lwo_129
  s_add_u32 s7, s7, 1
  s_cmp_lt_u32 s7, 131072
  s_cbranch_scc1 L_lw_128
  s_mov_b32 s6, 42
  s_branch L_err
L_lwo_129:
  ds_read2_b32 v[112:113], v104 offset0:0 offset1:1
  ds_read2_b32 v[114:115], v104 offset0:2 offset1:3
  ds_read_b32 v116, v104 offset:16
  ds_read2_b32 v[118:119], v105 offset0:0 offset1:1
  ds_read2_b32 v[120:121], v105 offset0:2 offset1:3
  ds_read_b32 v122, v105 offset:16
  ds_read2_b32 v[124:125], v106 offset0:0 offset1:1
  ds_read2_b32 v[126:127], v106 offset0:2 offset1:3
  ds_read_b32 v128, v106 offset:16
  ds_read2_b32 v[130:131], v107 offset0:0 offset1:1
  ds_read2_b32 v[132:133], v107 offset0:2 offset1:3
  ds_read_b32 v134, v107 offset:16
  s_waitcnt lgkmcnt(9)
  v_alignbyte_b32 v16, v113, v112, v15
  v_alignbyte_b32 v17, v114, v113, v15
  v_alignbyte_b32 v18, v115, v114, v15
  v_alignbyte_b32 v19, v116, v115, v15
  ds_read2_b32 v[112:113], v108 offset0:0 offset1:1
  ds_read2_b32 v[114:115], v108 offset0:2 offset1:3
  ds_read_b32 v116, v108 offset:16
  s_waitcnt lgkmcnt(9)
  v_alignbyte_b32 v20, v119, v118, v15
  v_alignbyte_b32 v21, v120, v119, v15
  v_alignbyte_b32 v22, v121, v120, v15
  v_alignbyte_b32 v23, v122, v121, v15
  ds_read2_b32 v[118:119], v109 offset0:0 offset1:1
  ds_read2_b32 v[120:121], v109 offset0:2 offset1:3
  ds_read_b32 v122, v109 offset:16
  v_mfma_f32_16x16x32_bf16 a[16:19], v[16:19], v[48:51], a[16:19]
  s_waitcnt lgkmcnt(9)
  v_alignbyte_b32 v24, v125, v124, v15
  v_alignbyte_b32 v25, v126, v125, v15
  v_alignbyte_b32 v26, v127, v126, v15
  v_alignbyte_b32 v27, v128, v127, v15
  ds_read2_b32 v[124:125], v110 offset0:0 offset1:1
  ds_read2_b32 v[126:127], v110 offset0:2 offset1:3
  ds_read_b32 v128, v110 offset:16
  v_mfma_f32_16x16x32_bf16 a[48:51], v[20:23], v[52:55], a[48:51]
  s_waitcnt lgkmcnt(9)
  v_alignbyte_b32 v28, v131, v130, v15
  v_alignbyte_b32 v29, v132, v131, v15
  v_alignbyte_b32 v30, v133, v132, v15
  v_alignbyte_b32 v31, v134, v133, v15
  ds_read2_b32 v[130:131], v111 offset0:0 offset1:1
  ds_read2_b32 v[132:133], v111 offset0:2 offset1:3
  ds_read_b32 v134, v111 offset:16
  v_mfma_f32_16x16x32_bf16 a[80:83], v[24:27], v[56:59], a[80:83]
  s_waitcnt lgkmcnt(9)
  v_alignbyte_b32 v32, v113, v112, v15
  v_alignbyte_b32 v33, v114, v113, v15
  v_alignbyte_b32 v34, v115, v114, v15
  v_alignbyte_b32 v35, v116, v115, v15
  ds_read_b64 v[84:85], v8
  ds_read_b64 v[86:87], v9
  v_mfma_f32_16x16x32_bf16 a[112:115], v[28:31], v[60:63], a[112:115]
  s_waitcnt lgkmcnt(8)
  v_alignbyte_b32 v36, v119, v118, v15
  v_alignbyte_b32 v37, v120, v119, v15
  v_alignbyte_b32 v38, v121, v120, v15
  v_alignbyte_b32 v39, v122, v121, v15
  v_mfma_f32_16x16x32_bf16 a[144:147], v[32:35], v[64:67], a[144:147]
  s_waitcnt lgkmcnt(5)
  v_alignbyte_b32 v40, v125, v124, v15
  v_alignbyte_b32 v41, v126, v125, v15
  v_alignbyte_b32 v42, v127, v126, v15
  v_alignbyte_b32 v43, v128, v127, v15
  v_mfma_f32_16x16x32_bf16 a[176:179], v[36:39], v[68:71], a[176:179]
  s_waitcnt lgkmcnt(2)
  v_alignbyte_b32 v44, v131, v130, v15
  v_alignbyte_b32 v45, v132, v131, v15
  v_alignbyte_b32 v46, v133, v132, v15
  v_alignbyte_b32 v47, v134, v133, v15
  v_mfma_f32_16x16x32_bf16 a[208:211], v[40:43], v[72:75], a[208:211]
  s_nop 0
  v_mfma_f32_16x16x32_bf16 a[240:243], v[44:47], v[76:79], a[240:243]
  s_waitcnt lgkmcnt(0)
  ds_read_b128 v[48:51], v4 offset:1024
  ds_read_b128 v[52:55], v4 offset:5632
  ds_read_b128 v[56:59], v4 offset:10240
  ds_read_b128 v[60:63], v4 offset:14848
  ds_read_b128 v[64:67], v4 offset:19456
  ds_read_b128 v[68:71], v4 offset:24064
  ds_read_b128 v[72:75], v4 offset:28672
  ds_read_b128 v[76:79], v4 offset:33280
  s_mov_b32 exec_lo, s42
  s_mov_b32 exec_hi, s42
  ds_write_b128 v6, a[16:19] offset:0
  ds_write_b128 v6, a[48:51] offset:128
  ds_write_b128 v6, a[80:83] offset:256
  ds_write_b128 v6, a[112:115] offset:384
  ds_write_b128 v6, a[144:147] offset:512
  ds_write_b128 v6, a[176:179] offset:640
  ds_write_b128 v6, a[208:211] offset:768
  ds_write_b128 v6, a[240:243] offset:896
  s_mov_b64 exec, -1
  ds_read_b128 v[80:83], v7
  ds_write_b32 v14, v13 offset:8
  v_lshlrev_b32 v88, 16, v84
  v_and_b32 v89, 0xffff0000, v84
  v_lshlrev_b32 v90, 16, v85
  v_and_b32 v91, 0xffff0000, v85
  v_lshlrev_b32 v96, 16, v86
  v_and_b32 v97, 0xffff0000, v86
  v_lshlrev_b32 v98, 16, v87
  v_and_b32 v99, 0xffff0000, v87
  v_mul_f32 v92, v88, v12
  v_mul_f32 v93, v89, v12
  v_mul_f32 v94, v90, v12
  v_mul_f32 v95, v91, v12
  v_cvt_pk_bf16_f32 v84, v92, v93
  v_cvt_pk_bf16_f32 v85, v94, v95
  v_lshlrev_b32 v92, 16, v84
  v_and_b32 v93, 0xffff0000, v84
  v_lshlrev_b32 v94, 16, v85
  v_and_b32 v95, 0xffff0000, v85
  s_waitcnt lgkmcnt(1)
  v_fmac_f32 v80, v88, v11
  v_fmac_f32 v81, v89, v11
  v_fmac_f32 v82, v90, v11
  v_fmac_f32 v83, v91, v11
  v_cvt_pk_bf16_f32 v84, v80, v81
  v_cvt_pk_bf16_f32 v85, v82, v83
  v_lshlrev_b32 v80, 16, v84
  v_and_b32 v81, 0xffff0000, v84
  v_lshlrev_b32 v82, 16, v85
  v_and_b32 v83, 0xffff0000, v85
  v_add_f32 v80, v80, v92
  v_add_f32 v81, v81, v93
  v_add_f32 v82, v82, v94
  v_add_f32 v83, v83, v95
  v_cvt_pk_bf16_f32 v84, v80, v81
  v_cvt_pk_bf16_f32 v85, v82, v83
  v_lshlrev_b32 v80, 16, v84
  v_and_b32 v81, 0xffff0000, v84
  v_lshlrev_b32 v82, 16, v85
  v_and_b32 v83, 0xffff0000, v85
  v_add_f32 v80, v80, v96
  v_add_f32 v81, v81, v97
  v_add_f32 v82, v82, v98
  v_add_f32 v83, v83, v99
  v_cvt_pk_bf16_f32 v84, v80, v81
  v_cvt_pk_bf16_f32 v85, v82, v83
  buffer_store_dwordx2 v[84:85], v10, s[8:11], s40 offen sc1
  v_mfma_f32_16x16x32_bf16 a[20:23], v[16:19], v[48:51], a[20:23]
  ds_read_b128 v[48:51], v4 offset:512
  v_mfma_f32_16x16x32_bf16 a[52:55], v[20:23], v[52:55], a[52:55]
  ds_read_b128 v[52:55], v4 offset:5120
  v_mfma_f32_16x16x32_bf16 a[84:87], v[24:27], v[56:59], a[84:87]
  ds_read_b128 v[56:59], v4 offset:9728
  v_mfma_f32_16x16x32_bf16 a[116:119], v[28:31], v[60:63], a[116:119]
  ds_read_b128 v[60:63], v4 offset:14336
  v_mfma_f32_16x16x32_bf16 a[148:151], v[32:35], v[64:67], a[148:151]
  ds_read_b128 v[64:67], v4 offset:18944
  v_mfma_f32_16x16x32_bf16 a[180:183], v[36:39], v[68:71], a[180:183]
  ds_read_b128 v[68:71], v4 offset:23552
  v_mfma_f32_16x16x32_bf16 a[212:215], v[40:43], v[72:75], a[212:215]
  ds_read_b128 v[72:75], v4 offset:28160
  v_mfma_f32_16x16x32_bf16 a[244:247], v[44:47], v[76:79], a[244:247]
  ds_read_b128 v[76:79], v4 offset:32768
  s_waitcnt lgkmcnt(7)
  v_mfma_f32_16x16x32_bf16 a[24:27], v[16:19], v[48:51], a[24:27]
  ds_read_b128 v[48:51], v4 offset:0
  s_waitcnt lgkmcnt(7)
  v_mfma_f32_16x16x32_bf16 a[56:59], v[20:23], v[52:55], a[56:59]
  ds_read_b128 v[52:55], v4 offset:4608
  s_waitcnt lgkmcnt(7)
  v_mfma_f32_16x16x32_bf16 a[88:91], v[24:27], v[56:59], a[88:91]
  ds_read_b128 v[56:59], v4 offset:9216
  s_waitcnt lgkmcnt(7)
  v_mfma_f32_16x16x32_bf16 a[120:123], v[28:31], v[60:63], a[120:123]
  ds_read_b128 v[60:63], v4 offset:13824
  s_waitcnt lgkmcnt(7)
  v_mfma_f32_16x16x32_bf16 a[152:155], v[32:35], v[64:67], a[152:155]
  ds_read_b128 v[64:67], v4 offset:18432
  s_waitcnt lgkmcnt(7)
  v_mfma_f32_16x16x32_bf16 a[184:187], v[36:39], v[68:71], a[184:187]
  ds_read_b128 v[68:71], v4 offset:23040
  s_waitcnt lgkmcnt(7)
  v_mfma_f32_16x16x32_bf16 a[216:219], v[40:43], v[72:75], a[216:219]
  ds_read_b128 v[72:75], v4 offset:27648
  s_waitcnt lgkmcnt(7)
  v_mfma_f32_16x16x32_bf16 a[248:251], v[44:47], v[76:79], a[248:251]
  ds_read_b128 v[76:79], v4 offset:32256
  s_waitcnt lgkmcnt(7)
  v_mfma_f32_16x16x32_bf16 a[28:31], v[16:19], v[48:51], a[28:31]
  s_waitcnt lgkmcnt(6)
  v_mfma_f32_16x16x32_bf16 a[60:63], v[20:23], v[52:55], a[60:63]
  s_waitcnt lgkmcnt(5)
  v_mfma_f32_16x16x32_bf16 a[92:95], v[24:27], v[56:59], a[92:95]
  s_waitcnt lgkmcnt(4)
  v_mfma_f32_16x16x32_bf16 a[124:127], v[28:31], v[60:63], a[124:127]
  s_waitcnt lgkmcnt(3)
  v_mfma_f32_16x16x32_bf16 a[156:159], v[32:35], v[64:67], a[156:159]
  s_waitcnt lgkmcnt(2)
  v_mfma_f32_16x16x32_bf16 a[188:191], v[36:39], v[68:71], a[188:191]
  s_waitcnt lgkmcnt(1)
  v_mfma_f32_16x16x32_bf16 a[220:223], v[40:43], v[72:75], a[220:223]
  s_waitcnt lgkmcnt(0)
  v_mfma_f32_16x16x32_bf16 a[252:255], v[44:47], v[76:79], a[252:255]
  v_add_u32 v104, 64, v104
  v_add_u32 v105, 64, v105
  v_add_u32 v106, 64, v106
  v_add_u32 v107, 64, v107
  v_add_u32 v108, 64, v108
  v_add_u32 v109, 64, v109
  v_add_u32 v110, 64, v110
  v_add_u32 v111, 64, v111
  v_add_u32 v4, 64, v4
  v_add_u32 v8, 64, v8
  s_add_u32 s40, s40, 0x8000
  s_waitcnt vmcnt(0)
  s_mov_b64 exec, 1
  buffer_store_dword v13, v1, s[8:11], s39 offen sc1
  s_mov_b64 exec, -1
  ds_write_b32 v14, v13 offset:16
  s_add_u32 s32, s32, 1
  s_and_b32 s6, s32, 7
  s_cbranch_scc1 L_c_conv4
L_c_conv5:
  s_add_u32 s33, s32, 1
  s_and_b32 s6, s32, 7
  s_lshl_b32 s7, s6, 10
  s_add_u32 s7, s7, s35
  v_add_u32 v9, s7, v10
  s_lshl_b32 s6, s6, 1
  s_lshl_b32 s42, 0x30003, s6
  v_mov_b32 v13, s33
  ds_read_b128 v[48:51], v4 offset:1024
  ds_read_b128 v[52:55], v4 offset:5632
  ds_read_b128 v[56:59], v4 offset:10240
  ds_read_b128 v[60:63], v4 offset:14848
  ds_read_b128 v[64:67], v4 offset:19456
  ds_read_b128 v[68:71], v4 offset:24064
  ds_read_b128 v[72:75], v4 offset:28672
  ds_read_b128 v[76:79], v4 offset:33280
  s_mov_b32 s7, 0
L_lw_130:
  ds_read_b32 v88, v2 offset:0
  s_waitcnt lgkmcnt(0)
  v_cmp_gt_i32 vcc, s33, v88
  s_cbranch_vccz L_lwo_131
  s_add_u32 s7, s7, 1
  s_cmp_lt_u32 s7, 131072
  s_cbranch_scc1 L_lw_130
  s_mov_b32 s6, 42
  s_branch L_err
L_lwo_131:
  ds_read2_b32 v[112:113], v104 offset0:0 offset1:1
  ds_read2_b32 v[114:115], v104 offset0:2 offset1:3
  ds_read_b32 v116, v104 offset:16
  ds_read2_b32 v[118:119], v105 offset0:0 offset1:1
  ds_read2_b32 v[120:121], v105 offset0:2 offset1:3
  ds_read_b32 v122, v105 offset:16
  ds_read2_b32 v[124:125], v106 offset0:0 offset1:1
  ds_read2_b32 v[126:127], v106 offset0:2 offset1:3
  ds_read_b32 v128, v106 offset:16
  ds_read2_b32 v[130:131], v107 offset0:0 offset1:1
  ds_read2_b32 v[132:133], v107 offset0:2 offset1:3
  ds_read_b32 v134, v107 offset:16
  s_waitcnt lgkmcnt(9)
  v_alignbyte_b32 v16, v113, v112, v15
  v_alignbyte_b32 v17, v114, v113, v15
  v_alignbyte_b32 v18, v115, v114, v15
  v_alignbyte_b32 v19, v116, v115, v15
  ds_read2_b32 v[112:113], v108 offset0:0 offset1:1
  ds_read2_b32 v[114:115], v108 offset0:2 offset1:3
  ds_read_b32 v116, v108 offset:16
  s_waitcnt lgkmcnt(9)
  v_alignbyte_b32 v20, v119, v118, v15
  v_alignbyte_b32 v21, v120, v119, v15
  v_alignbyte_b32 v22, v121, v120, v15
  v_alignbyte_b32 v23, v122, v121, v15
  ds_read2_b32 v[118:119], v109 offset0:0 offset1:1
  ds_read2_b32 v[120:121], v109 offset0:2 offset1:3
  ds_read_b32 v122, v109 offset:16
  v_mfma_f32_16x16x32_bf16 a[20:23], v[16:19], v[48:51], a[20:23]
  s_waitcnt lgkmcnt(9)
  v_alignbyte_b32 v24, v125, v124, v15
  v_alignbyte_b32 v25, v126, v125, v15
  v_alignbyte_b32 v26, v127, v126, v15
  v_alignbyte_b32 v27, v128, v127, v15
  ds_read2_b32 v[124:125], v110 offset0:0 offset1:1
  ds_read2_b32 v[126:127], v110 offset0:2 offset1:3
  ds_read_b32 v128, v110 offset:16
  v_mfma_f32_16x16x32_bf16 a[52:55], v[20:23], v[52:55], a[52:55]
  s_waitcnt lgkmcnt(9)
  v_alignbyte_b32 v28, v131, v130, v15
  v_alignbyte_b32 v29, v132, v131, v15
  v_alignbyte_b32 v30, v133, v132, v15
  v_alignbyte_b32 v31, v134, v133, v15
  ds_read2_b32 v[130:131], v111 offset0:0 offset1:1
  ds_read2_b32 v[132:133], v111 offset0:2 offset1:3
  ds_read_b32 v134, v111 offset:16
  v_mfma_f32_16x16x32_bf16 a[84:87], v[24:27], v[56:59], a[84:87]
  s_waitcnt lgkmcnt(9)
  v_alignbyte_b32 v32, v113, v112, v15
  v_alignbyte_b32 v33, v114, v113, v15
  v_alignbyte_b32 v34, v115, v114, v15
  v_alignbyte_b32 v35, v116, v115, v15
  ds_read_b64 v[84:85], v8
  ds_read_b64 v[86:87], v9
  v_mfma_f32_16x16x32_bf16 a[116:119], v[28:31], v[60:63], a[116:119]
  s_waitcnt lgkmcnt(8)
  v_alignbyte_b32 v36, v119, v118, v15
  v_alignbyte_b32 v37, v120, v119, v15
  v_alignbyte_b32 v38, v121, v120, v15
  v_alignbyte_b32 v39, v122, v121, v15
  v_mfma_f32_16x16x32_bf16 a[148:151], v[32:35], v[64:67], a[148:151]
  s_waitcnt lgkmcnt(5)
  v_alignbyte_b32 v40, v125, v124, v15
  v_alignbyte_b32 v41, v126, v125, v15
  v_alignbyte_b32 v42, v127, v126, v15
  v_alignbyte_b32 v43, v128, v127, v15
  v_mfma_f32_16x16x32_bf16 a[180:183], v[36:39], v[68:71], a[180:183]
  s_waitcnt lgkmcnt(2)
  v_alignbyte_b32 v44, v131, v130, v15
  v_alignbyte_b32 v45, v132, v131, v15
  v_alignbyte_b32 v46, v133, v132, v15
  v_alignbyte_b32 v47, v134, v133, v15
  v_mfma_f32_16x16x32_bf16 a[212:215], v[40:43], v[72:75], a[212:215]
  s_nop 0
  v_mfma_f32_16x16x32_bf16 a[244:247], v[44:47], v[76:79], a[244:247]
  s_waitcnt lgkmcnt(0)
  ds_read_b128 v[48:51], v4 offset:512
  ds_read_b128 v[52:55], v4 offset:5120
  ds_read_b128 v[56:59], v4 offset:9728
  ds_read_b128 v[60:63], v4 offset:14336
  ds_read_b128 v[64:67], v4 offset:18944
  ds_read_b128 v[68:71], v4 offset:23552
  ds_read_b128 v[72:75], v4 offset:28160
  ds_read_b128 v[76:79], v4 offset:32768
  s_mov_b32 exec_lo, s42
  s_mov_b32 exec_hi, s42
  ds_write_b128 v6, a[20:23] offset:0
  ds_write_b128 v6, a[52:55] offset:128
  ds_write_b128 v6, a[84:87] offset:256
  ds_write_b128 v6, a[116:119] offset:384
  ds_write_b128 v6, a[148:151] offset:512
  ds_write_b128 v6, a[180:183] offset:640
  ds_write_b128 v6, a[212:215] offset:768
  ds_write_b128 v6, a[244:247] offset:896
  s_mov_b64 exec, -1
  ds_read_b128 v[80:83], v7
  ds_write_b32 v14, v13 offset:8
  v_lshlrev_b32 v88, 16, v84
  v_and_b32 v89, 0xffff0000, v84
  v_lshlrev_b32 v90, 16, v85
  v_and_b32 v91, 0xffff0000, v85
  v_lshlrev_b32 v96, 16, v86
  v_and_b32 v97, 0xffff0000, v86
  v_lshlrev_b32 v98, 16, v87
  v_and_b32 v99, 0xffff0000, v87
  v_mul_f32 v92, v88, v12
  v_mul_f32 v93, v89, v12
  v_mul_f32 v94, v90, v12
  v_mul_f32 v95, v91, v12
  v_cvt_pk_bf16_f32 v84, v92, v93
  v_cvt_pk_bf16_f32 v85, v94, v95
  v_lshlrev_b32 v92, 16, v84
  v_and_b32 v93, 0xffff0000, v84
  v_lshlrev_b32 v94, 16, v85
  v_and_b32 v95, 0xffff0000, v85
  s_waitcnt lgkmcnt(1)
  v_fmac_f32 v80, v88, v11
  v_fmac_f32 v81, v89, v11
  v_fmac_f32 v82, v90, v11
  v_fmac_f32 v83, v91, v11
  v_cvt_pk_bf16_f32 v84, v80, v81
  v_cvt_pk_bf16_f32 v85, v82, v83
  v_lshlrev_b32 v80, 16, v84
  v_and_b32 v81, 0xffff0000, v84
  v_lshlrev_b32 v82, 16, v85
  v_and_b32 v83, 0xffff0000, v85
  v_add_f32 v80, v80, v92
  v_add_f32 v81, v81, v93
  v_add_f32 v82, v82, v94
  v_add_f32 v83, v83, v95
  v_cvt_pk_bf16_f32 v84, v80, v81
  v_cvt_pk_bf16_f32 v85, v82, v83
  v_lshlrev_b32 v80, 16, v84
  v_and_b32 v81, 0xffff0000, v84
  v_lshlrev_b32 v82, 16, v85
  v_and_b32 v83, 0xffff0000, v85
  v_add_f32 v80, v80, v96
  v_add_f32 v81, v81, v97
  v_add_f32 v82, v82, v98
  v_add_f32 v83, v83, v99
  v_cvt_pk_bf16_f32 v84, v80, v81
  v_cvt_pk_bf16_f32 v85, v82, v83
  buffer_store_dwordx2 v[84:85], v10, s[8:11], s40 offen sc1
  v_mfma_f32_16x16x32_bf16 a[24:27], v[16:19], v[48:51], a[24:27]
  ds_read_b128 v[48:51], v4 offset:0
  v_mfma_f32_16x16x32_bf16 a[56:59], v[20:23], v[52:55], a[56:59]
  ds_read_b128 v[52:55], v4 offset:4608
  v_mfma_f32_16x16x32_bf16 a[88:91], v[24:27], v[56:59], a[88:91]
  ds_read_b128 v[56:59], v4 offset:9216
  v_mfma_f32_16x16x32_bf16 a[120:123], v[28:31], v[60:63], a[120:123]
  ds_read_b128 v[60:63], v4 offset:13824
  v_mfma_f32_16x16x32_bf16 a[152:155], v[32:35], v[64:67], a[152:155]
  ds_read_b128 v[64:67], v4 offset:18432
  v_mfma_f32_16x16x32_bf16 a[184:187], v[36:39], v[68:71], a[184:187]
  ds_read_b128 v[68:71], v4 offset:23040
  v_mfma_f32_16x16x32_bf16 a[216:219], v[40:43], v[72:75], a[216:219]
  ds_read_b128 v[72:75], v4 offset:27648
  v_mfma_f32_16x16x32_bf16 a[248:251], v[44:47], v[76:79], a[248:251]
  ds_read_b128 v[76:79], v4 offset:32256
  s_waitcnt lgkmcnt(7)
  v_mfma_f32_16x16x32_bf16 a[28:31], v[16:19], v[48:51], a[28:31]
  s_waitcnt lgkmcnt(6)
  v_mfma_f32_16x16x32_bf16 a[60:63], v[20:23], v[52:55], a[60:63]
  s_waitcnt lgkmcnt(5)
  v_mfma_f32_16x16x32_bf16 a[92:95], v[24:27], v[56:59], a[92:95]
  s_waitcnt lgkmcnt(4)
  v_mfma_f32_16x16x32_bf16 a[124:127], v[28:31], v[60:63], a[124:127]
  s_waitcnt lgkmcnt(3)
  v_mfma_f32_16x16x32_bf16 a[156:159], v[32:35], v[64:67], a[156:159]
  s_waitcnt lgkmcnt(2)
  v_mfma_f32_16x16x32_bf16 a[188:191], v[36:39], v[68:71], a[188:191]
  s_waitcnt lgkmcnt(1)
  v_mfma_f32_16x16x32_bf16 a[220:223], v[40:43], v[72:75], a[220:223]
  s_waitcnt lgkmcnt(0)
  v_mfma_f32_16x16x32_bf16 a[252:255], v[44:47], v[76:79], a[252:255]
  v_add_u32 v104, 64, v104
  v_add_u32 v105, 64, v105
  v_add_u32 v106, 64, v106
  v_add_u32 v107, 64, v107
  v_add_u32 v108, 64, v108
  v_add_u32 v109, 64, v109
  v_add_u32 v110, 64, v110
  v_add_u32 v111, 64, v111
  v_add_u32 v4, 64, v4
  v_add_u32 v8, 64, v8
  s_add_u32 s40, s40, 0x8000
  s_waitcnt vmcnt(0)
  s_mov_b64 exec, 1
  buffer_store_dword v13, v1, s[8:11], s39 offen sc1
  s_mov_b64 exec, -1
  ds_write_b32 v14, v13 offset:16
  s_add_u32 s32, s32, 1
  s_and_b32 s6, s32, 7
  s_cbranch_scc1 L_c_conv5
L_c_conv6:
  s_add_u32 s33, s32, 1
  s_and_b32 s6, s32, 7
  s_lshl_b32 s7, s6, 10
  s_add_u32 s7, s7, s35
  v_add_u32 v9, s7, v10
  s_lshl_b32 s6, s6, 1
  s_lshl_b32 s42, 0x30003, s6
  v_mov_b32 v13, s33
  ds_read_b128 v[48:51], v4 offset:512
  ds_read_b128 v[52:55], v4 offset:5120
  ds_read_b128 v[56:59], v4 offset:9728
  ds_read_b128 v[60:63], v4 offset:14336
  ds_read_b128 v[64:67], v4 offset:18944
  ds_read_b128 v[68:71], v4 offset:23552
  ds_read_b128 v[72:75], v4 offset:28160
  ds_read_b128 v[76:79], v4 offset:32768
  s_mov_b32 s7, 0
L_lw_132:
  ds_read_b32 v88, v2 offset:0
  s_waitcnt lgkmcnt(0)
  v_cmp_gt_i32 vcc, s33, v88
  s_cbranch_vccz L_lwo_133
  s_add_u32 s7, s7, 1
  s_cmp_lt_u32 s7, 131072
  s_cbranch_scc1 L_lw_132
  s_mov_b32 s6, 42
  s_branch L_err
L_lwo_133:
  ds_read2_b32 v[112:113], v104 offset0:0 offset1:1
  ds_read2_b32 v[114:115], v104 offset0:2 offset1:3
  ds_read_b32 v116, v104 offset:16
  ds_read2_b32 v[118:119], v105 offset0:0 offset1:1
  ds_read2_b32 v[120:121], v105 offset0:2 offset1:3
  ds_read_b32 v122, v105 offset:16
  ds_read2_b32 v[124:125], v106 offset0:0 offset1:1
  ds_read2_b32 v[126:127], v106 offset0:2 offset1:3
  ds_read_b32 v128, v106 offset:16
  ds_read2_b32 v[130:131], v107 offset0:0 offset1:1
  ds_read2_b32 v[132:133], v107 offset0:2 offset1:3
  ds_read_b32 v134, v107 offset:16
  s_waitcnt lgkmcnt(9)
  v_alignbyte_b32 v16, v113, v112, v15
  v_alignbyte_b32 v17, v114, v113, v15
  v_alignbyte_b32 v18, v115, v114, v15
  v_alignbyte_b32 v19, v116, v115, v15
  ds_read2_b32 v[112:113], v108 offset0:0 offset1:1
  ds_read2_b32 v[114:115], v108 offset0:2 offset1:3
  ds_read_b32 v116, v108 offset:16
  s_waitcnt lgkmcnt(9)
  v_alignbyte_b32 v20, v119, v118, v15
  v_alignbyte_b32 v21, v120, v119, v15
  v_alignbyte_b32 v22, v121, v120, v15
  v_alignbyte_b32 v23, v122, v121, v15
  ds_read2_b32 v[118:119], v109 offset0:0 offset1:1
  ds_read2_b32 v[120:121], v109 offset0:2 offset1:3
  ds_read_b32 v122, v109 offset:16
  v_mfma_f32_16x16x32_bf16 a[24:27], v[16:19], v[48:51], a[24:27]
  s_waitcnt lgkmcnt(9)
  v_alignbyte_b32 v24, v125, v124, v15
  v_alignbyte_b32 v25, v126, v125, v15
  v_alignbyte_b32 v26, v127, v126, v15
  v_alignbyte_b32 v27, v128, v127, v15
  ds_read2_b32 v[124:125], v110 offset0:0 offset1:1
  ds_read2_b32 v[126:127], v110 offset0:2 offset1:3
  ds_read_b32 v128, v110 offset:16
  v_mfma_f32_16x16x32_bf16 a[56:59], v[20:23], v[52:55], a[56:59]
  s_waitcnt lgkmcnt(9)
  v_alignbyte_b32 v28, v131, v130, v15
  v_alignbyte_b32 v29, v132, v131, v15
  v_alignbyte_b32 v30, v133, v132, v15
  v_alignbyte_b32 v31, v134, v133, v15
  ds_read2_b32 v[130:131], v111 offset0:0 offset1:1
  ds_read2_b32 v[132:133], v111 offset0:2 offset1:3
  ds_read_b32 v134, v111 offset:16
  v_mfma_f32_16x16x32_bf16 a[88:91], v[24:27], v[56:59], a[88:91]
  s_waitcnt lgkmcnt(9)
  v_alignbyte_b32 v32, v113, v112, v15
  v_alignbyte_b32 v33, v114, v113, v15
  v_alignbyte_b32 v34, v115, v114, v15
  v_alignbyte_b32 v35, v116, v115, v15
  ds_read_b64 v[84:85], v8
  ds_read_b64 v[86:87], v9
  v_mfma_f32_16x16x32_bf16 a[120:123], v[28:31], v[60:63], a[120:123]
  s_waitcnt lgkmcnt(8)
  v_alignbyte_b32 v36, v119, v118, v15
  v_alignbyte_b32 v37, v120, v119, v15
  v_alignbyte_b32 v38, v121, v120, v15
  v_alignbyte_b32 v39, v122, v121, v15
  v_mfma_f32_16x16x32_bf16 a[152:155], v[32:35], v[64:67], a[152:155]
  s_waitcnt lgkmcnt(5)
  v_alignbyte_b32 v40, v125, v124, v15
  v_alignbyte_b32 v41, v126, v125, v15
  v_alignbyte_b32 v42, v127, v126, v15
  v_alignbyte_b32 v43, v128, v127, v15
  v_mfma_f32_16x16x32_bf16 a[184:187], v[36:39], v[68:71], a[184:187]
  s_waitcnt lgkmcnt(2)
  v_alignbyte_b32 v44, v131, v130, v15
  v_alignbyte_b32 v45, v132, v131, v15
  v_alignbyte_b32 v46, v133, v132, v15
  v_alignbyte_b32 v47, v134, v133, v15
  v_mfma_f32_16x16x32_bf16 a[216:219], v[40:43], v[72:75], a[216:219]
  s_nop 0
  v_mfma_f32_16x16x32_bf16 a[248:251], v[44:47], v[76:79], a[248:251]
  s_waitcnt lgkmcnt(0)
  ds_read_b128 v[48:51], v4 offset:0
  ds_read_b128 v[52:55], v4 offset:4608
  ds_read_b128 v[56:59], v4 offset:9216
  ds_read_b128 v[60:63], v4 offset:13824
  ds_read_b128 v[64:67], v4 offset:18432
  ds_read_b128 v[68:71], v4 offset:23040
  ds_read_b128 v[72:75], v4 offset:27648
  ds_read_b128 v[76:79], v4 offset:32256
  s_mov_b32 exec_lo, s42
  s_mov_b32 exec_hi, s42
  ds_write_b128 v6, a[24:27] offset:0
  ds_write_b128 v6, a[56:59] offset:128
  ds_write_b128 v6, a[88:91] offset:256
  ds_write_b128 v6, a[120:123] offset:384
  ds_write_b128 v6, a[152:155] offset:512
  ds_write_b128 v6, a[184:187] offset:640
  ds_write_b128 v6, a[216:219] offset:768
  ds_write_b128 v6, a[248:251] offset:896
  s_mov_b64 exec, -1
  ds_read_b128 v[80:83], v7
  ds_write_b32 v14, v13 offset:8
  v_lshlrev_b32 v88, 16, v84
  v_and_b32 v89, 0xffff0000, v84
  v_lshlrev_b32 v90, 16, v85
  v_and_b32 v91, 0xffff0000, v85
  v_lshlrev_b32 v96, 16, v86
  v_and_b32 v97, 0xffff0000, v86
  v_lshlrev_b32 v98, 16, v87
  v_and_b32 v99, 0xffff0000, v87
  v_mul_f32 v92, v88, v12
  v_mul_f32 v93, v89, v12
  v_mul_f32 v94, v90, v12
  v_mul_f32 v95, v91, v12
  v_cvt_pk_bf16_f32 v84, v92, v93
  v_cvt_pk_bf16_f32 v85, v94, v95
  v_lshlrev_b32 v92, 16, v84
  v_and_b32 v93, 0xffff0000, v84
  v_lshlrev_b32 v94, 16, v85
  v_and_b32 v95, 0xffff0000, v85
  s_waitcnt lgkmcnt(1)
  v_fmac_f32 v80, v88, v11
  v_fmac_f32 v81, v89, v11
  v_fmac_f32 v82, v90, v11
  v_fmac_f32 v83, v91, v11
  v_cvt_pk_bf16_f32 v84, v80, v81
  v_cvt_pk_bf16_f32 v85, v82, v83
  v_lshlrev_b32 v80, 16, v84
  v_and_b32 v81, 0xffff0000, v84
  v_lshlrev_b32 v82, 16, v85
  v_and_b32 v83, 0xffff0000, v85
  v_add_f32 v80, v80, v92
  v_add_f32 v81, v81, v93
  v_add_f32 v82, v82, v94
  v_add_f32 v83, v83, v95
  v_cvt_pk_bf16_f32 v84, v80, v81
  v_cvt_pk_bf16_f32 v85, v82, v83
  v_lshlrev_b32 v80, 16, v84
  v_and_b32 v81, 0xffff0000, v84
  v_lshlrev_b32 v82, 16, v85
  v_and_b32 v83, 0xffff0000, v85
  v_add_f32 v80, v80, v96
  v_add_f32 v81, v81, v97
  v_add_f32 v82, v82, v98
  v_add_f32 v83, v83, v99
  v_cvt_pk_bf16_f32 v84, v80, v81
  v_cvt_pk_bf16_f32 v85, v82, v83
  buffer_store_dwordx2 v[84:85], v10, s[8:11], s40 offen sc1
  v_mfma_f32_16x16x32_bf16 a[28:31], v[16:19], v[48:51], a[28:31]
  v_mfma_f32_16x16x32_bf16 a[60:63], v[20:23], v[52:55], a[60:63]
  v_mfma_f32_16x16x32_bf16 a[92:95], v[24:27], v[56:59], a[92:95]
  v_mfma_f32_16x16x32_bf16 a[124:127], v[28:31], v[60:63], a[124:127]
  v_mfma_f32_16x16x32_bf16 a[156:159], v[32:35], v[64:67], a[156:159]
  v_mfma_f32_16x16x32_bf16 a[188:191], v[36:39], v[68:71], a[188:191]
  v_mfma_f32_16x16x32_bf16 a[220:223], v[40:43], v[72:75], a[220:223]
  v_mfma_f32_16x16x32_bf16 a[252:255], v[44:47], v[76:79], a[252:255]
  v_add_u32 v104, 64, v104
  v_add_u32 v105, 64, v105
  v_add_u32 v106, 64, v106
  v_add_u32 v107, 64, v107
  v_add_u32 v108, 64, v108
  v_add_u32 v109, 64, v109
  v_add_u32 v110, 64, v110
  v_add_u32 v111, 64, v111
  v_add_u32 v4, 64, v4
  v_add_u32 v8, 64, v8
  s_add_u32 s40, s40, 0x8000
  s_waitcnt vmcnt(0)
  s_mov_b64 exec, 1
  buffer_store_dword v13, v1, s[8:11], s39 offen sc1
  s_mov_b64 exec, -1
  ds_write_b32 v14, v13 offset:16
  s_add_u32 s32, s32, 1
  s_and_b32 s6, s32, 7
  s_cbranch_scc1 L_c_conv6
L_c_conv7:
  s_add_u32 s33, s32, 1
  s_and_b32 s6, s32, 7
  s_lshl_b32 s7, s6, 10
  s_add_u32 s7, s7, s35
  v_add_u32 v9, s7, v10
  s_lshl_b32 s6, s6, 1
  s_lshl_b32 s42, 0x30003, s6
  v_mov_b32 v13, s33
  ds_read_b128 v[48:51], v4 offset:0
  ds_read_b128 v[52:55], v4 offset:4608
  ds_read_b128 v[56:59], v4 offset:9216
  ds_read_b128 v[60:63], v4 offset:13824
  ds_read_b128 v[64:67], v4 offset:18432
  ds_read_b128 v[68:71], v4 offset:23040
  ds_read_b128 v[72:75], v4 offset:27648
  ds_read_b128 v[76:79], v4 offset:32256
  s_mov_b32 s7, 0
L_lw_134:
  ds_read_b32 v88, v2 offset:0
  s_waitcnt lgkmcnt(0)
  v_cmp_gt_i32 vcc, s33, v88
  s_cbranch_vccz L_lwo_135
  s_add_u32 s7, s7, 1
  s_cmp_lt_u32 s7, 131072
  s_cbranch_scc1 L_lw_134
  s_mov_b32 s6, 42
  s_branch L_err
L_lwo_135:
  ds_read2_b32 v[112:113], v104 offset0:0 offset1:1
  ds_read2_b32 v[114:115], v104 offset0:2 offset1:3
  ds_read_b32 v116, v104 offset:16
  ds_read2_b32 v[118:119], v105 offset0:0 offset1:1
  ds_read2_b32 v[120:121], v105 offset0:2 offset1:3
  ds_read_b32 v122, v105 offset:16
  ds_read2_b32 v[124:125], v106 offset0:0 offset1:1
  ds_read2_b32 v[126:127], v106 offset0:2 offset1:3
  ds_read_b32 v128, v106 offset:16
  ds_read2_b32 v[130:131], v107 offset0:0 offset1:1
  ds_read2_b32 v[132:133], v107 offset0:2 offset1:3
  ds_read_b32 v134, v107 offset:16
  s_waitcnt lgkmcnt(9)
  v_alignbyte_b32 v16, v113, v112, v15
  v_alignbyte_b32 v17, v114, v113, v15
  v_alignbyte_b32 v18, v115, v114, v15
  v_alignbyte_b32 v19, v116, v115, v15
  ds_read2_b32 v[112:113], v108 offset0:0 offset1:1
  ds_read2_b32 v[114:115], v108 offset0:2 offset1:3
  ds_read_b32 v116, v108 offset:16
  s_waitcnt lgkmcnt(9)
  v_alignbyte_b32 v20, v119, v118, v15
  v_alignbyte_b32 v21, v120, v119, v15
  v_alignbyte_b32 v22, v121, v120, v15
  v_alignbyte_b32 v23, v122, v121, v15
  ds_read2_b32 v[118:119], v109 offset0:0 offset1:1
  ds_read2_b32 v[120:121], v109 offset0:2 offset1:3
  ds_read_b32 v122, v109 offset:16
  v_mfma_f32_16x16x32_bf16 a[28:31], v[16:19], v[48:51], a[28:31]
  s_waitcnt lgkmcnt(9)
  v_alignbyte_b32 v24, v125, v124, v15
  v_alignbyte_b32 v25, v126, v125, v15
  v_alignbyte_b32 v26, v127, v126, v15
  v_alignbyte_b32 v27, v128, v127, v15
  ds_read2_b32 v[124:125], v110 offset0:0 offset1:1
  ds_read2_b32 v[126:127], v110 offset0:2 offset1:3
  ds_read_b32 v128, v110 offset:16
  v_mfma_f32_16x16x32_bf16 a[60:63], v[20:23], v[52:55], a[60:63]
  s_waitcnt lgkmcnt(9)
  v_alignbyte_b32 v28, v131, v130, v15
  v_alignbyte_b32 v29, v132, v131, v15
  v_alignbyte_b32 v30, v133, v132, v15
  v_alignbyte_b32 v31, v134, v133, v15
  ds_read2_b32 v[130:131], v111 offset0:0 offset1:1
  ds_read2_b32 v[132:133], v111 offset0:2 offset1:3
  ds_read_b32 v134, v111 offset:16
  v_mfma_f32_16x16x32_bf16 a[92:95], v[24:27], v[56:59], a[92:95]
  s_waitcnt lgkmcnt(9)
  v_alignbyte_b32 v32, v113, v112, v15
  v_alignbyte_b32 v33, v114, v113, v15
  v_alignbyte_b32 v34, v115, v114, v15
  v_alignbyte_b32 v35, v116, v115, v15
  ds_read_b64 v[84:85], v8
  ds_read_b64 v[86:87], v9
  v_mfma_f32_16x16x32_bf16 a[124:127], v[28:31], v[60:63], a[124:127]
  s_waitcnt lgkmcnt(8)
  v_alignbyte_b32 v36, v119, v118, v15
  v_alignbyte_b32 v37, v120, v119, v15
  v_alignbyte_b32 v38, v121, v120, v15
  v_alignbyte_b32 v39, v122, v121, v15
  v_mfma_f32_16x16x32_bf16 a[156:159], v[32:35], v[64:67], a[156:159]
  s_waitcnt lgkmcnt(5)
  v_alignbyte_b32 v40, v125, v124, v15
  v_alignbyte_b32 v41, v126, v125, v15
  v_alignbyte_b32 v42, v127, v126, v15
  v_alignbyte_b32 v43, v128, v127, v15
  v_mfma_f32_16x16x32_bf16 a[188:191], v[36:39], v[68:71], a[188:191]
  s_waitcnt lgkmcnt(2)
  v_alignbyte_b32 v44, v131, v130, v15
  v_alignbyte_b32 v45, v132, v131, v15
  v_alignbyte_b32 v46, v133, v132, v15
  v_alignbyte_b32 v47, v134, v133, v15
  v_mfma_f32_16x16x32_bf16 a[220:223], v[40:43], v[72:75], a[220:223]
  s_nop 0
  v_mfma_f32_16x16x32_bf16 a[252:255], v[44:47], v[76:79], a[252:255]
  s_waitcnt lgkmcnt(0)
  s_mov_b32 exec_lo, s42
  s_mov_b32 exec_hi, s42
  ds_write_b128 v6, a[28:31] offset:0
  ds_write_b128 v6, a[60:63] offset:128
  ds_write_b128 v6, a[92:95] offset:256
  ds_write_b128 v6, a[124:127] offset:384
  ds_write_b128 v6, a[156:159] offset:512
  ds_write_b128 v6, a[188:191] offset:640
  ds_write_b128 v6, a[220:223] offset:768
  ds_write_b128 v6, a[252:255] offset:896
  s_mov_b64 exec, -1
  ds_read_b128 v[80:83], v7
  ds_write_b32 v14, v13 offset:8
  v_lshlrev_b32 v88, 16, v84
  v_and_b32 v89, 0xffff0000, v84
  v_lshlrev_b32 v90, 16, v85
  v_and_b32 v91, 0xffff0000, v85
  v_lshlrev_b32 v96, 16, v86
  v_and_b32 v97, 0xffff0000, v86
  v_lshlrev_b32 v98, 16, v87
  v_and_b32 v99, 0xffff0000, v87
  v_mul_f32 v92, v88, v12
  v_mul_f32 v93, v89, v12
  v_mul_f32 v94, v90, v12
  v_mul_f32 v95, v91, v12
  v_cvt_pk_bf16_f32 v84, v92, v93
  v_cvt_pk_bf16_f32 v85, v94, v95
  v_lshlrev_b32 v92, 16, v84
  v_and_b32 v93, 0xffff0000, v84
  v_lshlrev_b32 v94, 16, v85
  v_and_b32 v95, 0xffff0000, v85
  s_waitcnt lgkmcnt(1)
  v_fmac_f32 v80, v88, v11
  v_fmac_f32 v81, v89, v11
  v_fmac_f32 v82, v90, v11
  v_fmac_f32 v83, v91, v11
  v_cvt_pk_bf16_f32 v84, v80, v81
  v_cvt_pk_bf16_f32 v85, v82, v83
  v_lshlrev_b32 v80, 16, v84
  v_and_b32 v81, 0xffff0000, v84
  v_lshlrev_b32 v82, 16, v85
  v_and_b32 v83, 0xffff0000, v85
  v_add_f32 v80, v80, v92
  v_add_f32 v81, v81, v93
  v_add_f32 v82, v82, v94
  v_add_f32 v83, v83, v95
  v_cvt_pk_bf16_f32 v84, v80, v81
  v_cvt_pk_bf16_f32 v85, v82, v83
  v_lshlrev_b32 v80, 16, v84
  v_and_b32 v81, 0xffff0000, v84
  v_lshlrev_b32 v82, 16, v85
  v_and_b32 v83, 0xffff0000, v85
  v_add_f32 v80, v80, v96
  v_add_f32 v81, v81, v97
  v_add_f32 v82, v82, v98
  v_add_f32 v83, v83, v99
  v_cvt_pk_bf16_f32 v84, v80, v81
  v_cvt_pk_bf16_f32 v85, v82, v83
  buffer_store_dwordx2 v[84:85], v10, s[8:11], s40 offen sc1
  v_add_u32 v104, 64, v104
  v_add_u32 v105, 64, v105
  v_add_u32 v106, 64, v106
  v_add_u32 v107, 64, v107
  v_add_u32 v108, 64, v108
  v_add_u32 v109, 64, v109
  v_add_u32 v110, 64, v110
  v_add_u32 v111, 64, v111
  v_add_u32 v4, 64, v4
  v_add_u32 v8, 64, v8
  s_add_u32 s40, s40, 0x8000
  s_waitcnt vmcnt(0)
  s_mov_b64 exec, 1
  buffer_store_dword v13, v1, s[8:11], s39 offen sc1
  s_mov_b64 exec, -1
  ds_write_b32 v14, v13 offset:16
  s_add_u32 s32, s32, 1
  s_and_b32 s6, s32, 7
  s_cbranch_scc1 L_c_conv7
  s_waitcnt vmcnt(0)
  s_endpgm
L_c_res:
  s_mov_b32 s16, s92
  s_mov_b32 s17, s93
  s_mov_b32 s18, 0x200000
  s_mov_b32 s19, 0x20000
  s_and_b32 s6, s3, 1
  s_mul_i32 s37, s6, 0x200000
  s_mul_i32 s38, s6, 0x800000
  s_lshl_b32 s7, s5, 10
  s_add_u32 s37, s37, s7
  s_add_u32 s37, s37, 0x0
  s_add_u32 s38, s38, s7
  s_add_u32 s38, s38, 0x8800000
  s_lshl_b32 s6, s5, 3
  s_add_u32 s39, s6, 0x710900
  s_lshl_b32 s41, s5, 5
  v_bfe_u32 v16, v0, 4, 5
  v_lshrrev_b32 v17, 9, v0
  v_lshlrev_b32 v18, 1, v16
  v_lshl_or_b32 v4, v17, 8, v18
  v_add_u32 v8, 139776, v4
  v_mul_u32_u24 v19, 16512, v17
  v_add_u32 v19, v19, v18
  v_add_u32 v7, 73760, v19
  v_bfe_u32 v5, v0, 2, 3
  v_bfe_u32 v6, v0, 8, 1
  v_lshlrev_b32 v6, 3, v6
  v_and_b32 v19, 0xf0, v0
  v_or_b32 v6, v19, v6
  v_lshlrev_b32 v19, 10, v16
  v_lshl_or_b32 v9, v17, 3, v19
  s_mov_b32 s43, 0
  s_mov_b32 s46, 0
  s_mov_b32 s23, 0
  s_mov_b32 s20, 0x3f80
  s_mov_b32 s21, 0x3f800000
  s_mov_b32 s22, 0x3f803f80
  v_bfe_u32 v10, v0, 4, 2
  v_lshlrev_b32 v10, 15, v10
  v_mov_b32 v32, 0
  v_mov_b32 v33, 0
  v_mov_b32 v34, 0
  v_mov_b32 v35, 0
  v_mov_b32 v36, 0
  v_mov_b32 v37, 0
  v_mov_b32 v38, 0
  v_mov_b32 v39, 0
  s_cmp_eq_u32 s3, 2
  s_cbranch_scc0 L_c_r5
L_c_rf:
  s_cmp_eq_u32 s3, 2
  s_cbranch_scc1 L_ga_136
  s_mov_b32 s47, 0
L_gl_138:
  ds_read_b32 v52, v2 offset:24
  s_waitcnt lgkmcnt(0)
  v_readfirstlane_b32 s6, v52
  s_cmp_gt_i32 s6, s46
  s_cbranch_scc1 L_gb_137
  s_add_u32 s47, s47, 1
  s_cmp_lt_u32 s47, 131072
  s_cbranch_scc1 L_gl_138
  s_mov_b32 s6, 47
  s_branch L_err
L_ga_136:
  s_add_u32 s6, s46, 1
  v_mov_b32 v52, s6
  ds_write_b32 v2, v52 offset:24
L_gb_137:
  s_min_i32 s46, s6, 0x7ffffffe
  buffer_load_short_d16_hi v32, v4, s[8:11], s37 offen offset:0
  buffer_load_short_d16_hi v33, v4, s[8:11], s37 offen offset:64
  buffer_load_short_d16_hi v34, v4, s[8:11], s37 offen offset:128
  buffer_load_short_d16_hi v35, v4, s[8:11], s37 offen offset:192
  buffer_load_short_d16_hi v36, v4, s[8:11], s37 offen offset:512
  buffer_load_short_d16_hi v37, v4, s[8:11], s37 offen offset:576
  buffer_load_short_d16_hi v38, v4, s[8:11], s37 offen offset:640
  buffer_load_short_d16_hi v39, v4, s[8:11], s37 offen offset:704
  s_and_b32 s6, s43, 3
  s_lshl_b32 s6, s6, 17
  s_add_u32 s44, s38, s6
  s_lshr_b32 s6, s43, 2
  s_andn2_b32 s45, 1, s6
  s_add_u32 s6, s44, 0
  buffer_load_dwordx4 v[16:19], v0, s[8:11], s6 offen sc1
  s_add_u32 s6, s44, 32768
  buffer_load_dwordx4 v[20:23], v0, s[8:11], s6 offen sc1
  s_add_u32 s6, s44, 65536
  buffer_load_dwordx4 v[24:27], v0, s[8:11], s6 offen sc1
  s_add_u32 s6, s44, 98304
  buffer_load_dwordx4 v[28:31], v0, s[8:11], s6 offen sc1
  s_add_u32 s37, s37, 0x8000
  s_add_u32 s43, s43, 1
L_c_rloop:
  s_mov_b32 s7, 0
L_c_rp:
  s_waitcnt vmcnt(0)
  v_bitop3_b32 v52, v16, v20, s45 bitop3:0x7e
  v_bitop3_b32 v53, v24, v28, s45 bitop3:0x7e
  v_bitop3_b32 v52, v52, v53, 1 bitop3:0xa8
  v_cmp_ne_u32 vcc, 0, v52
  s_cbranch_vccz L_c_rok
  s_cmp_eq_u32 s3, 2
  s_cbranch_scc1 L_ga_139
  s_mov_b32 s47, 0
L_gl_141:
  ds_read_b32 v52, v2 offset:24
  s_waitcnt lgkmcnt(0)
  v_readfirstlane_b32 s6, v52
  s_cmp_gt_i32 s6, s46
  s_cbranch_scc1 L_gb_140
  s_add_u32 s47, s47, 1
  s_cmp_lt_u32 s47, 131072
  s_cbranch_scc1 L_gl_141
  s_mov_b32 s6, 47
  s_branch L_err
L_gb_140:
  s_min_i32 s46, s6, 0x7ffffffe
L_ga_139:
  s_add_u32 s6, s44, 0
  s_nop 0
  buffer_load_dwordx4 v[16:19], v0, s[8:11], s6 offen sc1
  s_add_u32 s6, s44, 32768
  buffer_load_dwordx4 v[20:23], v0, s[8:11], s6 offen sc1
  s_add_u32 s6, s44, 65536
  buffer_load_dwordx4 v[24:27], v0, s[8:11], s6 offen sc1
  s_add_u32 s6, s44, 98304
  buffer_load_dwordx4 v[28:31], v0, s[8:11], s6 offen sc1
  s_add_u32 s7, s7, 1
  s_cmp_lt_u32 s7, 131072
  s_cbranch_scc1 L_c_rp
  s_mov_b32 s6, 43
  s_branch L_err
L_c_rok:
  v_dot2_f32_bf16 v40, v16, s20, 0
  v_dot2_f32_bf16 v41, v16, s21, 0
  v_dot2_f32_bf16 v42, v17, s20, 0
  v_dot2_f32_bf16 v43, v17, s21, 0
  v_dot2_f32_bf16 v44, v18, s20, 0
  v_dot2_f32_bf16 v45, v18, s21, 0
  v_dot2_f32_bf16 v46, v19, s20, 0
  v_dot2_f32_bf16 v47, v19, s21, 0
  v_dot2_f32_bf16 v40, v20, s20, v40
  v_dot2_f32_bf16 v41, v20, s21, v41
  v_dot2_f32_bf16 v42, v21, s20, v42
  v_dot2_f32_bf16 v43, v21, s21, v43
  v_dot2_f32_bf16 v44, v22, s20, v44
  v_dot2_f32_bf16 v45, v22, s21, v45
  v_dot2_f32_bf16 v46, v23, s20, v46
  v_dot2_f32_bf16 v47, v23, s21, v47
  v_dot2_f32_bf16 v40, v24, s20, v40
  v_dot2_f32_bf16 v41, v24, s21, v41
  v_dot2_f32_bf16 v42, v25, s20, v42
  v_dot2_f32_bf16 v43, v25, s21, v43
  v_dot2_f32_bf16 v44, v26, s20, v44
  v_dot2_f32_bf16 v45, v26, s21, v45
  v_dot2_f32_bf16 v46, v27, s20, v46
  v_dot2_f32_bf16 v47, v27, s21, v47
  v_dot2_f32_bf16 v40, v28, s20, v40
  v_dot2_f32_bf16 v41, v28, s21, v41
  v_dot2_f32_bf16 v42, v29, s20, v42
  v_dot2_f32_bf16 v43, v29, s21, v43
  v_dot2_f32_bf16 v44, v30, s20, v44
  v_dot2_f32_bf16 v45, v30, s21, v45
  v_dot2_f32_bf16 v46, v31, s20, v46
  v_dot2_f32_bf16 v47, v31, s21, v47
  v_cvt_pk_bf16_f32 v48, v40, v41
  v_cvt_pk_bf16_f32 v49, v42, v43
  v_cvt_pk_bf16_f32 v50, v44, v45
  v_cvt_pk_bf16_f32 v51, v46, v47
  v_dot2_f32_bf16 v40, v48, s20, v32
  v_dot2_f32_bf16 v41, v48, s21, v33
  v_dot2_f32_bf16 v42, v49, s20, v34
  v_dot2_f32_bf16 v43, v49, s21, v35
  v_dot2_f32_bf16 v44, v50, s20, v36
  v_dot2_f32_bf16 v45, v50, s21, v37
  v_dot2_f32_bf16 v46, v51, s20, v38
  v_dot2_f32_bf16 v47, v51, s21, v39
  v_cvt_pk_bf16_f32 v48, v40, v41
  v_cvt_pk_bf16_f32 v49, v42, v43
  v_cvt_pk_bf16_f32 v50, v44, v45
  v_cvt_pk_bf16_f32 v51, v46, v47
  s_cmp_eq_u32 s3, 2
  s_cbranch_scc1 L_c_ln
  buffer_store_dwordx2 v[48:49], v9, s[16:19], s41 offen
  buffer_store_dwordx2 v[50:51], v9, s[16:19], s41 offen offset:16
  s_add_u32 s41, s41, 0x8000
  v_mov_b32 v52, s43
  s_mov_b64 exec, 3
  buffer_store_dword v52, v5, s[8:11], s39 offen sc1
  s_mov_b64 exec, -1
  s_add_u32 s32, s32, 1
  s_cmp_eq_u32 s32, 64
  s_cbranch_scc1 L_c_rend
L_c_r5:
  s_add_u32 s33, s32, 1
  s_mov_b32 s7, 0
L_lw_142:
  ds_read_b64 v[52:53], v2 offset:16
  s_waitcnt lgkmcnt(0)
  v_min_i32 v52, v52, v53
  v_cmp_gt_i32 vcc, s33, v52
  s_cbranch_vccz L_lwo_143
  s_add_u32 s7, s7, 1
  s_cmp_lt_u32 s7, 131072
  s_cbranch_scc1 L_lw_142
  s_mov_b32 s6, 46
  s_branch L_err
L_lwo_143:
  s_branch L_c_rf
L_c_ln:
  s_cmp_eq_u32 s32, 63
  s_cbranch_scc0 L_cf_144
  v_mov_b32 v52, 0x7fffffff
  ds_write_b32 v2, v52 offset:24
  s_branch L_cnf_145
L_cf_144:
L_ga_146:
  s_add_u32 s6, s46, 1
  v_mov_b32 v52, s6
  ds_write_b32 v2, v52 offset:24
L_gb_147:
  s_min_i32 s46, s6, 0x7ffffffe
  buffer_load_short_d16_hi v32, v4, s[8:11], s37 offen offset:0
  buffer_load_short_d16_hi v33, v4, s[8:11], s37 offen offset:64
  buffer_load_short_d16_hi v34, v4, s[8:11], s37 offen offset:128
  buffer_load_short_d16_hi v35, v4, s[8:11], s37 offen offset:192
  buffer_load_short_d16_hi v36, v4, s[8:11], s37 offen offset:512
  buffer_load_short_d16_hi v37, v4, s[8:11], s37 offen offset:576
  buffer_load_short_d16_hi v38, v4, s[8:11], s37 offen offset:640
  buffer_load_short_d16_hi v39, v4, s[8:11], s37 offen offset:704
  s_and_b32 s6, s43, 3
  s_lshl_b32 s6, s6, 17
  s_add_u32 s44, s38, s6
  s_lshr_b32 s6, s43, 2
  s_andn2_b32 s45, 1, s6
  s_add_u32 s6, s44, 0
  buffer_load_dwordx4 v[16:19], v0, s[8:11], s6 offen sc1
  s_add_u32 s6, s44, 32768
  buffer_load_dwordx4 v[20:23], v0, s[8:11], s6 offen sc1
  s_add_u32 s6, s44, 65536
  buffer_load_dwordx4 v[24:27], v0, s[8:11], s6 offen sc1
  s_add_u32 s6, s44, 98304
  buffer_load_dwordx4 v[28:31], v0, s[8:11], s6 offen sc1
  s_add_u32 s37, s37, 0x8000
  s_add_u32 s43, s43, 1
L_cnf_145:
  v_dot2_f32_bf16 v52, v48, s22, 0
  v_dot2_f32_bf16 v53, v48, v48, 0
  v_dot2_f32_bf16 v52, v49, s22, v52
  v_dot2_f32_bf16 v53, v49, v49, v53
  v_dot2_f32_bf16 v52, v50, s22, v52
  v_dot2_f32_bf16 v53, v50, v50, v53
  v_dot2_f32_bf16 v52, v51, s22, v52
  v_dot2_f32_bf16 v53, v51, v51, v53
  s_lshr_b32 s6, s32, 2
  s_andn2_b32 s36, 1, s6
  s_and_b32 s6, s32, 3
  s_lshl_b32 s6, s6, 13
  s_add_u32 s34, s6, 0x738000
  s_lshl_b32 s6, s5, 8
  s_add_u32 s6, s6, s34
  v_mov_b32 v54, v52
  v_mov_b32 v55, v53
  s_nop 0
  v_permlane32_swap_b32 v52, v54
  v_permlane32_swap_b32 v53, v55
  v_add_f32 v52, v52, v54
  v_add_f32 v53, v53, v55
  v_bfi_b32 v53, 1, s36, v53
  s_mov_b32 exec_hi, 0
  buffer_store_dwordx2 v[52:53], v6, s[8:11], s6 offen
  s_cmp_lt_u32 s32, 62
  s_cbranch_scc1 L_cnl_149
  buffer_store_dwordx2 v[52:53], v6, s[8:11], s6 offen sc1
L_cnl_149:
  s_mov_b32 exec_hi, -1
  s_add_u32 s35, s34, 4096
  s_sub_u32 s33, s32, 7
  s_mov_b32 s7, 0
L_lw_150:
  ds_read_b64 v[52:53], v2 offset:8
  s_waitcnt lgkmcnt(0)
  v_min_i32 v52, v52, v53
  v_cmp_gt_i32 vcc, s33, v52
  s_cbranch_vccz L_lwo_151
  s_add_u32 s7, s7, 1
  s_cmp_lt_u32 s7, 131072
  s_cbranch_scc1 L_lw_150
  s_mov_b32 s6, 44
  s_branch L_err
L_lwo_151:
  s_and_b32 s6, s32, 7
  s_lshl_b32 s6, s6, 10
  v_add_u32 v52, s6, v8
  ds_write_b16 v52, v48 offset:0
  ds_write_b16_d16_hi v52, v48 offset:64
  ds_write_b16 v52, v49 offset:128
  ds_write_b16_d16_hi v52, v49 offset:192
  ds_write_b16 v52, v50 offset:512
  ds_write_b16_d16_hi v52, v50 offset:576
  ds_write_b16 v52, v51 offset:640
  ds_write_b16_d16_hi v52, v51 offset:704
  buffer_load_dwordx4 v[64:67], v0, s[8:11], s34 offen offset:0 sc1
  buffer_load_dwordx4 v[68:71], v0, s[8:11], s34 offen offset:1024 sc1
  buffer_load_dwordx4 v[72:75], v0, s[8:11], s34 offen offset:2048 sc1
  buffer_load_dwordx4 v[76:79], v0, s[8:11], s34 offen offset:3072 sc1
  buffer_load_dwordx4 v[80:83], v0, s[8:11], s35 offen offset:0 sc1
  buffer_load_dwordx4 v[84:87], v0, s[8:11], s35 offen offset:1024 sc1
  buffer_load_dwordx4 v[88:91], v0, s[8:11], s35 offen offset:2048 sc1
  buffer_load_dwordx4 v[92:95], v0, s[8:11], s35 offen offset:3072 sc1
  s_mov_b32 s7, 0
L_c_g:
  s_waitcnt vmcnt(0)
L_c_g1:
  v_bitop3_b32 v56, v65, v67, s36 bitop3:0x7e
  v_bitop3_b32 v57, v69, v71, s36 bitop3:0x7e
  v_bitop3_b32 v58, v73, v75, s36 bitop3:0x7e
  v_bitop3_b32 v59, v77, v79, s36 bitop3:0x7e
  v_bitop3_b32 v60, v81, v83, s36 bitop3:0x7e
  v_bitop3_b32 v61, v85, v87, s36 bitop3:0x7e
  v_bitop3_b32 v62, v89, v91, s36 bitop3:0x7e
  v_bitop3_b32 v63, v93, v95, s36 bitop3:0x7e
  v_or3_b32 v52, v56, v57, v58
  v_or3_b32 v53, v59, v60, v61
  v_or3_b32 v52, v52, v62, v63
  v_bitop3_b32 v52, v52, v53, 1 bitop3:0xa8
  v_cmp_ne_u32 vcc, 0, v52
  s_cbranch_vccz L_c_gok0
  v_and_b32 v56, 1, v56
  v_and_b32 v57, 1, v57
  v_and_b32 v58, 1, v58
  v_and_b32 v59, 1, v59
  v_and_b32 v60, 1, v60
  v_and_b32 v61, 1, v61
  v_and_b32 v62, 1, v62
  v_and_b32 v63, 1, v63
  v_cmp_ne_u32 s[48:49], 0, v56
  v_cmp_ne_u32 s[50:51], 0, v57
  v_cmp_ne_u32 s[52:53], 0, v58
  v_cmp_ne_u32 s[54:55], 0, v59
  v_cmp_ne_u32 s[56:57], 0, v60
  v_cmp_ne_u32 s[58:59], 0, v61
  v_cmp_ne_u32 s[60:61], 0, v62
  v_cmp_ne_u32 s[62:63], 0, v63
  s_or_b64 exec, s[48:49], 1
  buffer_load_dwordx4 v[64:67], v0, s[8:11], s34 offen offset:0 sc1
  s_or_b64 exec, s[50:51], 1
  buffer_load_dwordx4 v[68:71], v0, s[8:11], s34 offen offset:1024 sc1
  s_or_b64 exec, s[52:53], 1
  buffer_load_dwordx4 v[72:75], v0, s[8:11], s34 offen offset:2048 sc1
  s_or_b64 exec, s[54:55], 1
  buffer_load_dwordx4 v[76:79], v0, s[8:11], s34 offen offset:3072 sc1
  s_or_b64 exec, s[56:57], 1
  buffer_load_dwordx4 v[80:83], v0, s[8:11], s35 offen offset:0 sc1
  s_or_b64 exec, s[58:59], 1
  buffer_load_dwordx4 v[84:87], v0, s[8:11], s35 offen offset:1024 sc1
  s_or_b64 exec, s[60:61], 1
  buffer_load_dwordx4 v[88:91], v0, s[8:11], s35 offen offset:2048 sc1
  s_or_b64 exec, s[62:63], 1
  buffer_load_dwordx4 v[92:95], v0, s[8:11], s35 offen offset:3072 sc1
  s_mov_b64 exec, -1
  s_cmp_lg_u32 s23, 0
  s_cbranch_scc1 L_c_na
  s_cmp_eq_u32 s32, 63
  s_cbranch_scc1 L_c_na
  s_waitcnt vmcnt(8)
  v_bitop3_b32 v52, v16, v20, s45 bitop3:0x7e
  v_bitop3_b32 v53, v24, v28, s45 bitop3:0x7e
  v_bitop3_b32 v52, v52, v53, 1 bitop3:0xa8
  v_cmp_ne_u32 vcc, 0, v52
  s_cbranch_vccz L_c_pa
  s_cmp_lg_u32 s7, 0
  s_cbranch_scc1 L_c_na
  s_add_u32 s6, s44, 0
  buffer_load_dwordx4 v[16:19], v0, s[8:11], s6 offen sc1
  s_add_u32 s6, s44, 32768
  buffer_load_dwordx4 v[20:23], v0, s[8:11], s6 offen sc1
  s_add_u32 s6, s44, 65536
  buffer_load_dwordx4 v[24:27], v0, s[8:11], s6 offen sc1
  s_add_u32 s6, s44, 98304
  buffer_load_dwordx4 v[28:31], v0, s[8:11], s6 offen sc1
  s_mov_b32 s7, 1
  s_waitcnt vmcnt(4)
  s_branch L_c_g1
L_c_pa:
  s_cbranch_vccnz L_c_na
  s_add_u32 s26, s32, 1
  s_mov_b32 s23, 1
  v_dot2_f32_bf16 v40, v16, s20, 0
  v_dot2_f32_bf16 v41, v16, s21, 0
  v_dot2_f32_bf16 v42, v17, s20, 0
  v_dot2_f32_bf16 v43, v17, s21, 0
  v_dot2_f32_bf16 v44, v18, s20, 0
  v_dot2_f32_bf16 v45, v18, s21, 0
  v_dot2_f32_bf16 v46, v19, s20, 0
  v_dot2_f32_bf16 v47, v19, s21, 0
  v_dot2_f32_bf16 v40, v20, s20, v40
  v_dot2_f32_bf16 v41, v20, s21, v41
  v_dot2_f32_bf16 v42, v21, s20, v42
  v_dot2_f32_bf16 v43, v21, s21, v43
  v_dot2_f32_bf16 v44, v22, s20, v44
  v_dot2_f32_bf16 v45, v22, s21, v45
  v_dot2_f32_bf16 v46, v23, s20, v46
  v_dot2_f32_bf16 v47, v23, s21, v47
  v_dot2_f32_bf16 v40, v24, s20, v40
  v_dot2_f32_bf16 v41, v24, s21, v41
  v_dot2_f32_bf16 v42, v25, s20, v42
  v_dot2_f32_bf16 v43, v25, s21, v43
  v_dot2_f32_bf16 v44, v26, s20, v44
  v_dot2_f32_bf16 v45, v26, s21, v45
  v_dot2_f32_bf16 v46, v27, s20, v46
  v_dot2_f32_bf16 v47, v27, s21, v47
  v_dot2_f32_bf16 v40, v28, s20, v40
  v_dot2_f32_bf16 v41, v28, s21, v41
  v_dot2_f32_bf16 v42, v29, s20, v42
  v_dot2_f32_bf16 v43, v29, s21, v43
  v_dot2_f32_bf16 v44, v30, s20, v44
  v_dot2_f32_bf16 v45, v30, s21, v45
  v_dot2_f32_bf16 v46, v31, s20, v46
  v_dot2_f32_bf16 v47, v31, s21, v47
  v_cvt_pk_bf16_f32 v96, v40, v41
  v_cvt_pk_bf16_f32 v97, v42, v43
  v_cvt_pk_bf16_f32 v98, v44, v45
  v_cvt_pk_bf16_f32 v99, v46, v47
  v_dot2_f32_bf16 v40, v96, s20, v32
  v_dot2_f32_bf16 v41, v96, s21, v33
  v_dot2_f32_bf16 v42, v97, s20, v34
  v_dot2_f32_bf16 v43, v97, s21, v35
  v_dot2_f32_bf16 v44, v98, s20, v36
  v_dot2_f32_bf16 v45, v98, s21, v37
  v_dot2_f32_bf16 v46, v99, s20, v38
  v_dot2_f32_bf16 v47, v99, s21, v39
  v_cvt_pk_bf16_f32 v96, v40, v41
  v_cvt_pk_bf16_f32 v97, v42, v43
  v_cvt_pk_bf16_f32 v98, v44, v45
  v_cvt_pk_bf16_f32 v99, v46, v47
  v_dot2_f32_bf16 v52, v96, s22, 0
  v_dot2_f32_bf16 v53, v96, v96, 0
  v_dot2_f32_bf16 v52, v97, s22, v52
  v_dot2_f32_bf16 v53, v97, v97, v53
  v_dot2_f32_bf16 v52, v98, s22, v52
  v_dot2_f32_bf16 v53, v98, v98, v53
  v_dot2_f32_bf16 v52, v99, s22, v52
  v_dot2_f32_bf16 v53, v99, v99, v53
  s_lshr_b32 s6, s26, 2
  s_andn2_b32 s24, 1, s6
  s_and_b32 s6, s26, 3
  s_lshl_b32 s6, s6, 13
  s_add_u32 s25, s6, 0x738000
  s_lshl_b32 s6, s5, 8
  s_add_u32 s6, s6, s25
  v_mov_b32 v54, v52
  v_mov_b32 v55, v53
  s_nop 0
  v_permlane32_swap_b32 v52, v54
  v_permlane32_swap_b32 v53, v55
  v_add_f32 v52, v52, v54
  v_add_f32 v53, v53, v55
  v_bfi_b32 v53, 1, s24, v53
  s_mov_b32 exec_hi, 0
  buffer_store_dwordx2 v[52:53], v6, s[8:11], s6 offen
  s_cmp_lt_u32 s26, 62
  s_cbranch_scc1 L_cnl_152
  buffer_store_dwordx2 v[52:53], v6, s[8:11], s6 offen sc1
  s_waitcnt vmcnt(1)
L_cnl_152:
  s_mov_b32 exec_hi, -1
  s_sub_u32 s33, s26, 7
  s_mov_b32 s7, 0
L_lw_153:
  ds_read_b64 v[52:53], v2 offset:8
  s_waitcnt lgkmcnt(0)
  v_min_i32 v52, v52, v53
  v_cmp_gt_i32 vcc, s33, v52
  s_cbranch_vccz L_lwo_154
  s_add_u32 s7, s7, 1
  s_cmp_lt_u32 s7, 131072
  s_cbranch_scc1 L_lw_153
  s_mov_b32 s6, 44
  s_branch L_err
L_lwo_154:
  s_and_b32 s6, s26, 7
  s_lshl_b32 s6, s6, 10
  v_add_u32 v52, s6, v8
  ds_write_b16 v52, v96 offset:0
  ds_write_b16_d16_hi v52, v96 offset:64
  ds_write_b16 v52, v97 offset:128
  ds_write_b16_d16_hi v52, v97 offset:192
  ds_write_b16 v52, v98 offset:512
  ds_write_b16_d16_hi v52, v98 offset:576
  ds_write_b16 v52, v99 offset:640
  ds_write_b16_d16_hi v52, v99 offset:704
  s_waitcnt vmcnt(1)
  s_branch L_c_g1
L_c_pre:
  s_mov_b32 s23, 0
  s_mov_b32 s36, s24
  s_mov_b32 s34, s25
  s_add_u32 s35, s25, 4096
  s_mov_b32 s7, 0
  buffer_load_dwordx4 v[64:67], v0, s[8:11], s34 offen offset:0 sc1
  buffer_load_dwordx4 v[68:71], v0, s[8:11], s34 offen offset:1024 sc1
  buffer_load_dwordx4 v[72:75], v0, s[8:11], s34 offen offset:2048 sc1
  buffer_load_dwordx4 v[76:79], v0, s[8:11], s34 offen offset:3072 sc1
  buffer_load_dwordx4 v[80:83], v0, s[8:11], s35 offen offset:0 sc1
  buffer_load_dwordx4 v[84:87], v0, s[8:11], s35 offen offset:1024 sc1
  buffer_load_dwordx4 v[88:91], v0, s[8:11], s35 offen offset:2048 sc1
  buffer_load_dwordx4 v[92:95], v0, s[8:11], s35 offen offset:3072 sc1
  v_mov_b32 v48, v96
  v_mov_b32 v49, v97
  v_mov_b32 v50, v98
  v_mov_b32 v51, v99
  s_cmp_eq_u32 s32, 63
  s_cbranch_scc0 L_cf_155
  v_mov_b32 v52, 0x7fffffff
  ds_write_b32 v2, v52 offset:24
  s_waitcnt vmcnt(0)
  s_branch L_cnf_156
L_cf_155:
L_ga_157:
  s_add_u32 s6, s46, 1
  v_mov_b32 v52, s6
  ds_write_b32 v2, v52 offset:24
L_gb_158:
  s_min_i32 s46, s6, 0x7ffffffe
  buffer_load_short_d16_hi v32, v4, s[8:11], s37 offen offset:0
  buffer_load_short_d16_hi v33, v4, s[8:11], s37 offen offset:64
  buffer_load_short_d16_hi v34, v4, s[8:11], s37 offen offset:128
  buffer_load_short_d16_hi v35, v4, s[8:11], s37 offen offset:192
  buffer_load_short_d16_hi v36, v4, s[8:11], s37 offen offset:512
  buffer_load_short_d16_hi v37, v4, s[8:11], s37 offen offset:576
  buffer_load_short_d16_hi v38, v4, s[8:11], s37 offen offset:640
  buffer_load_short_d16_hi v39, v4, s[8:11], s37 offen offset:704
  s_and_b32 s6, s43, 3
  s_lshl_b32 s6, s6, 17
  s_add_u32 s44, s38, s6
  s_lshr_b32 s6, s43, 2
  s_andn2_b32 s45, 1, s6
  s_add_u32 s6, s44, 0
  buffer_load_dwordx4 v[16:19], v0, s[8:11], s6 offen sc1
  s_add_u32 s6, s44, 32768
  buffer_load_dwordx4 v[20:23], v0, s[8:11], s6 offen sc1
  s_add_u32 s6, s44, 65536
  buffer_load_dwordx4 v[24:27], v0, s[8:11], s6 offen sc1
  s_add_u32 s6, s44, 98304
  buffer_load_dwordx4 v[28:31], v0, s[8:11], s6 offen sc1
  s_add_u32 s37, s37, 0x8000
  s_add_u32 s43, s43, 1
L_cnf_156:
  s_waitcnt vmcnt(12)
  s_branch L_c_g1
L_c_na:
  s_and_b32 s6, s7, 31
  s_cmp_lg_u32 s6, 31
  s_cbranch_scc1 L_tf_160
  buffer_wbl2 sc1
  s_waitcnt vmcnt(0)
  buffer_inv sc1
  s_waitcnt vmcnt(0)
L_tf_160:
  s_add_u32 s7, s7, 1
  s_cmp_lt_u32 s7, 131072
  s_cbranch_scc1 L_c_g
  s_mov_b32 s6, 45
  s_branch L_err
L_c_gok0:
  v_pk_add_f32 v[64:65], v[64:65], v[80:81]
  v_pk_add_f32 v[66:67], v[66:67], v[82:83]
  v_pk_add_f32 v[68:69], v[68:69], v[84:85]
  v_pk_add_f32 v[70:71], v[70:71], v[86:87]
  v_pk_add_f32 v[72:73], v[72:73], v[88:89]
  v_pk_add_f32 v[74:75], v[74:75], v[90:91]
  v_pk_add_f32 v[76:77], v[76:77], v[92:93]
  v_pk_add_f32 v[78:79], v[78:79], v[94:95]
L_c_gok:
  v_pk_add_f32 v[64:65], v[64:65], v[72:73]
  v_pk_add_f32 v[66:67], v[66:67], v[74:75]
  v_pk_add_f32 v[68:69], v[68:69], v[76:77]
  v_pk_add_f32 v[70:71], v[70:71], v[78:79]
  v_pk_add_f32 v[64:65], v[64:65], v[68:69]
  v_pk_add_f32 v[66:67], v[66:67], v[70:71]
  s_nop 1
  v_permlane16_swap_b32 v64, v66
  v_permlane16_swap_b32 v65, v67
  v_pk_add_f32 v[52:53], v[64:65], v[66:67]
  v_mov_b32 v54, v52
  v_mov_b32 v55, v53
  s_nop 0
  v_permlane32_swap_b32 v52, v54
  v_permlane32_swap_b32 v53, v55
  v_add_f32 v52, v52, v54
  v_add_f32 v53, v53, v55
  v_mul_f32 v52, 0x3b000000, v52
  v_mul_f32 v54, v52, v52
  v_mul_f32 v53, 0x3b000000, v53
  v_sub_f32 v53, v53, v54
  v_max_f32 v53, 0, v53
  v_cvt_pk_bf16_f32 v53, v53, v53
  v_and_b32 v53, 0xffff0000, v53
  v_add_f32 v53, 0x3727c5ac, v53
  v_cvt_pk_bf16_f32 v53, v53, v53
  v_and_b32 v53, 0xffff0000, v53
  v_sqrt_f32 v53, v53
  v_cvt_pk_bf16_f32 v52, v52, v52
  v_and_b32 v52, 0xffff0000, v52
  v_cvt_pk_bf16_f32 v53, v53, v53
  v_and_b32 v53, 0xffff0000, v53
  v_rcp_f32 v53, v53
  v_dot2_f32_bf16 v40, v48, s20, v52 neg_lo:[0,0,1]
  v_dot2_f32_bf16 v41, v48, s21, v52 neg_lo:[0,0,1]
  v_dot2_f32_bf16 v42, v49, s20, v52 neg_lo:[0,0,1]
  v_dot2_f32_bf16 v43, v49, s21, v52 neg_lo:[0,0,1]
  v_dot2_f32_bf16 v44, v50, s20, v52 neg_lo:[0,0,1]
  v_dot2_f32_bf16 v45, v50, s21, v52 neg_lo:[0,0,1]
  v_dot2_f32_bf16 v46, v51, s20, v52 neg_lo:[0,0,1]
  v_dot2_f32_bf16 v47, v51, s21, v52 neg_lo:[0,0,1]
  v_cvt_pk_bf16_f32 v48, v40, v41
  v_cvt_pk_bf16_f32 v49, v42, v43
  v_cvt_pk_bf16_f32 v50, v44, v45
  v_cvt_pk_bf16_f32 v51, v46, v47
  v_lshlrev_b32 v40, 16, v48
  v_and_b32 v41, 0xffff0000, v48
  v_lshlrev_b32 v42, 16, v49
  v_and_b32 v43, 0xffff0000, v49
  v_lshlrev_b32 v44, 16, v50
  v_and_b32 v45, 0xffff0000, v50
  v_lshlrev_b32 v46, 16, v51
  v_and_b32 v47, 0xffff0000, v51
  v_mul_f32 v40, v40, v53
  v_mul_f32 v41, v41, v53
  v_mul_f32 v42, v42, v53
  v_mul_f32 v43, v43, v53
  v_mul_f32 v44, v44, v53
  v_mul_f32 v45, v45, v53
  v_mul_f32 v46, v46, v53
  v_mul_f32 v47, v47, v53
  v_cvt_pk_bf16_f32 v48, v40, v41
  v_cvt_pk_bf16_f32 v49, v42, v43
  v_cvt_pk_bf16_f32 v50, v44, v45
  v_cvt_pk_bf16_f32 v51, v46, v47
  s_add_u32 s6, s32, 1
  v_mov_b32 v52, s6
  ds_write_b16 v7, v48 offset:0
  ds_write_b16_d16_hi v7, v48 offset:4128
  ds_write_b16 v7, v49 offset:8256
  ds_write_b16_d16_hi v7, v49 offset:12384
  ds_write_b16 v7, v50 offset:33024
  ds_write_b16_d16_hi v7, v50 offset:37152
  ds_write_b16 v7, v51 offset:41280
  ds_write_b16_d16_hi v7, v51 offset:45408
  ds_write_b32 v2, v52
  v_add_u32 v7, 64, v7
  s_add_u32 s32, s32, 1
  s_cmp_lg_u32 s23, 0
  s_cbranch_scc1 L_c_pre
  s_cmp_lt_u32 s32, 64
  s_cbranch_scc1 L_c_rloop
L_c_rend:
  s_waitcnt vmcnt(0)
  s_endpgm
.section .rodata,"a"
.p2align 6
.amdhsa_kernel interleave_layers__ssm_conv_s4d__memory_aug_recurrent_mem_tr__prompt_kernel
  .amdhsa_next_free_vgpr 512
  .amdhsa_next_free_sgpr 102
  .amdhsa_accum_offset 256
  .amdhsa_group_segment_fixed_size 0
  .amdhsa_kernarg_size 136
  .amdhsa_user_sgpr_count 2
  .amdhsa_user_sgpr_kernarg_segment_ptr 1
  .amdhsa_system_sgpr_workgroup_id_x 1
.end_amdhsa_kernel
```

```asm
; @launch grid=(256,1,1) block=(256,1,1) lds=163840
.amdgcn_target "amdgcn-amd-amdhsa--gfx950"
.text
.globl interleave_layers__ssm_conv_s4d__memory_aug_recurrent_mem_tr__prompt_kernel
.p2align 8
.type interleave_layers__ssm_conv_s4d__memory_aug_recurrent_mem_tr__prompt_kernel,@function
interleave_layers__ssm_conv_s4d__memory_aug_recurrent_mem_tr__prompt_kernel:
  s_cmp_ge_u32 s2, 256
  s_cbranch_scc1 L_end
  s_load_dwordx16 s[64:79], s[0:1], 0
  s_load_dwordx16 s[80:95], s[0:1], 64
  s_load_dwordx2 s[96:97], s[0:1], 128
  s_getreg_b32 s4, hwreg(HW_REG_XCC_ID,0,4)
  v_lshrrev_b32 v1, 6, v0
  v_and_b32 v0, 63, v0
  s_and_b32 s4, s4, 7
  v_readfirstlane_b32 s3, v1
  s_lshl_b32 s4, s4, 2
  s_lshr_b32 s4, 0x10673254, s4
  s_and_b32 s4, s4, 7
  s_waitcnt lgkmcnt(0)
  s_mov_b32 s12, s94
  s_mov_b32 s13, s95
  s_mov_b32 s14, 0x100
  s_mov_b32 s15, 0x20000
  s_mov_b32 s8, s96
  s_mov_b32 s9, s97
  s_mov_b32 s10, 0x10000000
  s_mov_b32 s11, 0x20000
  s_mov_b32 s16, s64
  s_mov_b32 s17, s65
  s_mov_b32 s18, 0x200000
  s_mov_b32 s19, 0x20000
  s_lshl_b32 s6, s2, 3
  s_lshl_b32 s7, s3, 1
  s_add_u32 s32, s6, s7
  s_lshl_b32 s6, s32, 10
  v_lshlrev_b32 v4, 5, v0
  buffer_load_dwordx4 v[40:43], v4, s[16:19], s6 offen
  buffer_load_dwordx4 v[44:47], v4, s[16:19], s6 offen offset:16
  s_cmp_lg_u32 s3, 0
  s_cbranch_scc1 L_tk_1
  s_and_b32 s6, s4, 3
  s_lshl_b32 s6, s6, 6
  s_and_b32 s7, s4, 4
  s_add_u32 s6, s6, s7
  s_mov_b64 exec, 1
  v_mov_b32 v2, s6
  v_mov_b32 v3, 1
  buffer_atomic_add v3, v2, s[12:15], 0 offen sc0 sc1
  s_mov_b64 exec, -1
L_tk_1:
  s_cmp_lg_u32 s3, 0
  s_waitcnt vmcnt(1)
  s_cbranch_scc0 L_xw_2
  s_waitcnt vmcnt(0)
L_xw_2:
  v_mov_b32 v5, 0
  v_mov_b32 v6, 0
  v_mov_b32 v7, 0x3f803f80
  v_dot2c_f32_bf16 v5, v40, v7
  v_dot2c_f32_bf16 v6, v40, v40
  v_dot2c_f32_bf16 v5, v41, v7
  v_dot2c_f32_bf16 v6, v41, v41
  v_dot2c_f32_bf16 v5, v42, v7
  v_dot2c_f32_bf16 v6, v42, v42
  v_dot2c_f32_bf16 v5, v43, v7
  v_dot2c_f32_bf16 v6, v43, v43
  v_dot2c_f32_bf16 v5, v44, v7
  v_dot2c_f32_bf16 v6, v44, v44
  v_dot2c_f32_bf16 v5, v45, v7
  v_dot2c_f32_bf16 v6, v45, v45
  v_dot2c_f32_bf16 v5, v46, v7
  v_dot2c_f32_bf16 v6, v46, v46
  v_dot2c_f32_bf16 v5, v47, v7
  v_dot2c_f32_bf16 v6, v47, v47
  s_nop 1
  v_add_f32_dpp v5, v5, v5 quad_perm:[1,0,3,2] row_mask:0xf bank_mask:0xf
  v_add_f32_dpp v6, v6, v6 quad_perm:[1,0,3,2] row_mask:0xf bank_mask:0xf
  s_nop 0
  v_add_f32_dpp v5, v5, v5 quad_perm:[2,3,0,1] row_mask:0xf bank_mask:0xf
  v_add_f32_dpp v6, v6, v6 quad_perm:[2,3,0,1] row_mask:0xf bank_mask:0xf
  s_nop 0
  v_add_f32_dpp v5, v5, v5 row_half_mirror row_mask:0xf bank_mask:0xf
  v_add_f32_dpp v6, v6, v6 row_half_mirror row_mask:0xf bank_mask:0xf
  s_nop 0
  v_add_f32_dpp v5, v5, v5 row_mirror row_mask:0xf bank_mask:0xf
  v_add_f32_dpp v6, v6, v6 row_mirror row_mask:0xf bank_mask:0xf
  v_mov_b32 v8, v5
  v_mov_b32 v9, v6
  s_nop 0
  v_permlane16_swap_b32 v5, v8
  v_permlane16_swap_b32 v6, v9
  v_add_f32 v8, v5, v8
  v_add_f32 v9, v6, v9
  v_mul_f32 v8, 0x3b000000, v8
  v_mul_f32 v10, v8, v8
  v_mul_f32 v9, 0x3b000000, v9
  v_sub_f32 v9, v9, v10
  v_max_f32 v9, 0, v9
  v_cvt_pk_bf16_f32 v9, v9, v9
  v_and_b32 v9, 0xffff0000, v9
  v_add_f32 v9, 0x3727c5ac, v9
  v_cvt_pk_bf16_f32 v9, v9, v9
  v_and_b32 v9, 0xffff0000, v9
  v_sqrt_f32 v9, v9
  v_cvt_pk_bf16_f32 v8, v8, v8
  v_and_b32 v8, 0xffff0000, v8
  v_cvt_pk_bf16_f32 v9, v9, v9
  v_and_b32 v9, 0xffff0000, v9
  v_rcp_f32 v9, v9
  v_lshlrev_b32 v16, 16, v40
  v_and_b32 v17, 0xffff0000, v40
  v_lshlrev_b32 v18, 16, v41
  v_and_b32 v19, 0xffff0000, v41
  v_lshlrev_b32 v20, 16, v42
  v_and_b32 v21, 0xffff0000, v42
  v_lshlrev_b32 v22, 16, v43
  v_and_b32 v23, 0xffff0000, v43
  v_lshlrev_b32 v24, 16, v44
  v_and_b32 v25, 0xffff0000, v44
  v_lshlrev_b32 v26, 16, v45
  v_and_b32 v27, 0xffff0000, v45
  v_lshlrev_b32 v28, 16, v46
  v_and_b32 v29, 0xffff0000, v46
  v_lshlrev_b32 v30, 16, v47
  v_and_b32 v31, 0xffff0000, v47
  v_sub_f32 v16, v16, v8
  v_sub_f32 v17, v17, v8
  v_sub_f32 v18, v18, v8
  v_sub_f32 v19, v19, v8
  v_sub_f32 v20, v20, v8
  v_sub_f32 v21, v21, v8
  v_sub_f32 v22, v22, v8
  v_sub_f32 v23, v23, v8
  v_sub_f32 v24, v24, v8
  v_sub_f32 v25, v25, v8
  v_sub_f32 v26, v26, v8
  v_sub_f32 v27, v27, v8
  v_sub_f32 v28, v28, v8
  v_sub_f32 v29, v29, v8
  v_sub_f32 v30, v30, v8
  v_sub_f32 v31, v31, v8
  v_cvt_pk_bf16_f32 v32, v16, v17
  v_cvt_pk_bf16_f32 v33, v18, v19
  v_cvt_pk_bf16_f32 v34, v20, v21
  v_cvt_pk_bf16_f32 v35, v22, v23
  v_cvt_pk_bf16_f32 v36, v24, v25
  v_cvt_pk_bf16_f32 v37, v26, v27
  v_cvt_pk_bf16_f32 v38, v28, v29
  v_cvt_pk_bf16_f32 v39, v30, v31
  v_lshlrev_b32 v16, 16, v32
  v_and_b32 v17, 0xffff0000, v32
  v_lshlrev_b32 v18, 16, v33
  v_and_b32 v19, 0xffff0000, v33
  v_lshlrev_b32 v20, 16, v34
  v_and_b32 v21, 0xffff0000, v34
  v_lshlrev_b32 v22, 16, v35
  v_and_b32 v23, 0xffff0000, v35
  v_lshlrev_b32 v24, 16, v36
  v_and_b32 v25, 0xffff0000, v36
  v_lshlrev_b32 v26, 16, v37
  v_and_b32 v27, 0xffff0000, v37
  v_lshlrev_b32 v28, 16, v38
  v_and_b32 v29, 0xffff0000, v38
  v_lshlrev_b32 v30, 16, v39
  v_and_b32 v31, 0xffff0000, v39
  v_mul_f32 v16, v16, v9
  v_mul_f32 v17, v17, v9
  v_mul_f32 v18, v18, v9
  v_mul_f32 v19, v19, v9
  v_mul_f32 v20, v20, v9
  v_mul_f32 v21, v21, v9
  v_mul_f32 v22, v22, v9
  v_mul_f32 v23, v23, v9
  v_mul_f32 v24, v24, v9
  v_mul_f32 v25, v25, v9
  v_mul_f32 v26, v26, v9
  v_mul_f32 v27, v27, v9
  v_mul_f32 v28, v28, v9
  v_mul_f32 v29, v29, v9
  v_mul_f32 v30, v30, v9
  v_mul_f32 v31, v31, v9
  v_cvt_pk_bf16_f32 v32, v16, v17
  v_cvt_pk_bf16_f32 v33, v18, v19
  v_cvt_pk_bf16_f32 v34, v20, v21
  v_cvt_pk_bf16_f32 v35, v22, v23
  v_cvt_pk_bf16_f32 v36, v24, v25
  v_cvt_pk_bf16_f32 v37, v26, v27
  v_cvt_pk_bf16_f32 v38, v28, v29
  v_cvt_pk_bf16_f32 v39, v30, v31
  s_mov_b32 s6, 0x05040100
  s_mov_b32 s7, 0x07060302
  v_and_b32 v4, 31, v0
  v_mul_u32_u24 v4, 528, v4
  v_lshrrev_b32 v5, 5, v0
  v_lshl_add_u32 v4, v5, 8, v4
  s_lshl_b32 s34, s3, 2
  s_add_u32 s34, s34, 64
  v_add_u32 v4, s34, v4
  v_permlane32_swap_b32 v32, v36
  v_permlane32_swap_b32 v33, v37
  v_permlane32_swap_b32 v34, v38
  v_permlane32_swap_b32 v35, v39
  v_perm_b32 v16, v36, v32, s6
  ds_write_b32 v4, v16 offset:0
  v_perm_b32 v17, v36, v32, s7
  ds_write_b32 v4, v17 offset:16
  v_perm_b32 v18, v37, v33, s6
  ds_write_b32 v4, v18 offset:32
  v_perm_b32 v19, v37, v33, s7
  ds_write_b32 v4, v19 offset:48
  v_perm_b32 v20, v38, v34, s6
  ds_write_b32 v4, v20 offset:128
  v_perm_b32 v21, v38, v34, s7
  ds_write_b32 v4, v21 offset:144
  v_perm_b32 v22, v39, v35, s6
  ds_write_b32 v4, v22 offset:160
  v_perm_b32 v23, v39, v35, s7
  ds_write_b32 v4, v23 offset:176
  v_permlane32_swap_b32 v40, v44
  v_permlane32_swap_b32 v41, v45
  v_permlane32_swap_b32 v42, v46
  v_permlane32_swap_b32 v43, v47
  v_perm_b32 v24, v44, v40, s6
  ds_write_b32 v4, v24 offset:64
  v_perm_b32 v25, v44, v40, s7
  ds_write_b32 v4, v25 offset:80
  v_perm_b32 v26, v45, v41, s6
  ds_write_b32 v4, v26 offset:96
  v_perm_b32 v27, v45, v41, s7
  ds_write_b32 v4, v27 offset:112
  v_perm_b32 v28, v46, v42, s6
  ds_write_b32 v4, v28 offset:192
  v_perm_b32 v29, v46, v42, s7
  ds_write_b32 v4, v29 offset:208
  v_perm_b32 v30, v47, v43, s6
  ds_write_b32 v4, v30 offset:224
  v_perm_b32 v31, v47, v43, s7
  ds_write_b32 v4, v31 offset:240
  s_cmp_lg_u32 s3, 0
  s_cbranch_scc1 L_rl_3
  s_waitcnt vmcnt(0)
  v_readfirstlane_b32 s5, v3
  s_cmp_lt_u32 s5, 32
  s_cbranch_scc1 L_rok_4
  s_mov_b64 exec, 1
  v_mov_b32 v2, 32
  v_mov_b32 v3, 1
  buffer_atomic_add v3, v2, s[12:15], 0 offen sc0 sc1
  s_waitcnt vmcnt(0)
  v_readfirstlane_b32 s33, v3
  s_mov_b64 exec, -1
  s_mov_b32 s7, 0
  v_lshlrev_b32 v2, 2, v0
L_row_5:
  buffer_load_dword v3, v2, s[12:15], 0 offen sc1
  s_waitcnt vmcnt(0)
  s_mov_b32 s34, 0
  v_readlane_b32 s40, v3, 0
  v_readlane_b32 s41, v3, 16
  v_readlane_b32 s42, v3, 32
  v_readlane_b32 s43, v3, 48
  v_readlane_b32 s44, v3, 1
  v_readlane_b32 s45, v3, 17
  v_readlane_b32 s46, v3, 33
  v_readlane_b32 s47, v3, 49
  s_add_u32 s34, s34, s40
  s_add_u32 s34, s34, s41
  s_add_u32 s34, s34, s42
  s_add_u32 s34, s34, s43
  s_add_u32 s34, s34, s44
  s_add_u32 s34, s34, s45
  s_add_u32 s34, s34, s46
  s_add_u32 s34, s34, s47
  s_cmp_eq_u32 s34, 256
  s_cbranch_scc1 L_row2_6
  s_add_u32 s7, s7, 1
  s_cmp_lt_u32 s7, 131072
  s_cbranch_scc1 L_row_5
  s_mov_b32 s6, 1
  s_branch L_err
L_row2_6:
  s_min_u32 s5, s40, 32
  s_sub_u32 s35, 32, s5
  s_cmp_ge_u32 s33, s35
  s_cbranch_scc1 L_ovn_7
  s_add_u32 s5, s5, s33
  s_mov_b32 s4, 0
  s_branch L_rok_4
L_ovn_7:
  s_sub_u32 s33, s33, s35
  s_min_u32 s5, s41, 32
  s_sub_u32 s35, 32, s5
  s_cmp_ge_u32 s33, s35
  s_cbranch_scc1 L_ovn_8
  s_add_u32 s5, s5, s33
  s_mov_b32 s4, 1
  s_branch L_rok_4
L_ovn_8:
  s_sub_u32 s33, s33, s35
  s_min_u32 s5, s42, 32
  s_sub_u32 s35, 32, s5
  s_cmp_ge_u32 s33, s35
  s_cbranch_scc1 L_ovn_9
  s_add_u32 s5, s5, s33
  s_mov_b32 s4, 2
  s_branch L_rok_4
L_ovn_9:
  s_sub_u32 s33, s33, s35
  s_min_u32 s5, s43, 32
  s_sub_u32 s35, 32, s5
  s_cmp_ge_u32 s33, s35
  s_cbranch_scc1 L_ovn_10
  s_add_u32 s5, s5, s33
  s_mov_b32 s4, 3
  s_branch L_rok_4
L_ovn_10:
  s_sub_u32 s33, s33, s35
  s_min_u32 s5, s44, 32
  s_sub_u32 s35, 32, s5
  s_cmp_ge_u32 s33, s35
  s_cbranch_scc1 L_ovn_11
  s_add_u32 s5, s5, s33
  s_mov_b32 s4, 4
  s_branch L_rok_4
L_ovn_11:
  s_sub_u32 s33, s33, s35
  s_min_u32 s5, s45, 32
  s_sub_u32 s35, 32, s5
  s_cmp_ge_u32 s33, s35
  s_cbranch_scc1 L_ovn_12
  s_add_u32 s5, s5, s33
  s_mov_b32 s4, 5
  s_branch L_rok_4
L_ovn_12:
  s_sub_u32 s33, s33, s35
  s_min_u32 s5, s46, 32
  s_sub_u32 s35, 32, s5
  s_cmp_ge_u32 s33, s35
  s_cbranch_scc1 L_ovn_13
  s_add_u32 s5, s5, s33
  s_mov_b32 s4, 6
  s_branch L_rok_4
L_ovn_13:
  s_sub_u32 s33, s33, s35
  s_min_u32 s5, s47, 32
  s_sub_u32 s35, 32, s5
  s_cmp_ge_u32 s33, s35
  s_cbranch_scc1 L_ovn_14
  s_add_u32 s5, s5, s33
  s_mov_b32 s4, 7
  s_branch L_rok_4
L_ovn_14:
  s_sub_u32 s33, s33, s35
  s_mov_b32 s6, 2
  s_branch L_err
L_rok_4:
  s_lshl_b32 s6, s4, 5
  s_add_u32 s6, s6, s5
  v_mov_b32 v2, 0
  v_mov_b32 v3, s6
  ds_write_b32 v2, v3
L_rl_3:
  v_lshrrev_b32 v4, 5, v0
  s_lshl_b32 s6, s3, 1
  v_add_u32 v4, s6, v4
  v_mul_u32_u24 v4, 528, v4
  v_and_b32 v5, 31, v0
  v_lshl_add_u32 v4, v5, 4, v4
  v_lshrrev_b32 v5, 3, v0
  v_lshlrev_b32 v5, 15, v5
  v_and_b32 v6, 7, v0
  v_lshl_or_b32 v5, v6, 4, v5
  s_lshl_b32 s6, s3, 18
  s_lshl_b32 s7, s2, 7
  s_add_u32 s6, s6, s7
  s_add_u32 s6, s6, 0xb000000
  s_waitcnt lgkmcnt(0)
  s_barrier
  ds_read_b128 v[16:19], v4 offset:64
  ds_read_b128 v[20:23], v4 offset:4288
  ds_read_b128 v[24:27], v4 offset:8512
  ds_read_b128 v[28:31], v4 offset:12736
  s_waitcnt lgkmcnt(3)
  buffer_store_dwordx4 v[16:19], v5, s[8:11], s6 offen sc1
  s_add_u32 s6, s6, 1048576
  s_waitcnt lgkmcnt(2)
  buffer_store_dwordx4 v[20:23], v5, s[8:11], s6 offen sc1
  s_add_u32 s6, s6, 1048576
  s_waitcnt lgkmcnt(1)
  buffer_store_dwordx4 v[24:27], v5, s[8:11], s6 offen sc1
  s_add_u32 s6, s6, 1048576
  s_waitcnt lgkmcnt(0)
  buffer_store_dwordx4 v[28:31], v5, s[8:11], s6 offen sc1
  s_add_u32 s6, s6, 1048576
  v_mov_b32 v2, 0
  ds_read_b32 v3, v2
  s_waitcnt lgkmcnt(0)
  v_readfirstlane_b32 s6, v3
  s_barrier
  s_lshr_b32 s4, s6, 5
  s_and_b32 s4, s4, 7
  s_and_b32 s5, s6, 31
  s_cmp_eq_u32 s4, 0
  s_cbranch_scc1 L_rec
  s_cmp_eq_u32 s4, 1
  s_cbranch_scc1 L_rec
  s_cmp_eq_u32 s4, 2
  s_cbranch_scc1 L_p
  s_cmp_eq_u32 s4, 3
  s_cbranch_scc1 L_p
  s_cmp_eq_u32 s4, 4
  s_cbranch_scc1 L_p
  s_cmp_eq_u32 s4, 5
  s_cbranch_scc1 L_p
  s_cmp_eq_u32 s4, 6
  s_cbranch_scc1 L_o
  s_cmp_eq_u32 s4, 7
  s_cbranch_scc1 L_c
  s_waitcnt vmcnt(0)
  s_barrier
  s_cmp_lg_u32 s3, 0
  s_cbranch_scc1 L_sd_15
  s_mov_b64 exec, 1
  s_and_b32 s6, s4, 3
  s_lshl_b32 s6, s6, 6
  v_mov_b32 v2, 16
  v_mov_b32 v3, 1
  buffer_atomic_add v3, v2, s[12:15], s6 offen sc1
  s_mov_b64 exec, -1
L_sd_15:
  s_waitcnt vmcnt(0)
  s_endpgm
L_err:
  s_mov_b64 exec, 1
  s_lshl_b32 s7, s4, 2
  s_add_u32 s7, s7, 160
  v_mov_b32 v2, s7
  v_mov_b32 v3, s6
  buffer_store_dword v3, v2, s[12:15], 0 offen sc1
  s_waitcnt vmcnt(0)
L_end:
  s_endpgm
L_rec:
  s_and_b32 s58, s4, 1
  s_mul_i32 s35, s58, 0x2000000
  s_add_u32 s35, s35, 0x800000
  s_mul_i32 s36, s58, 0x1000000
  s_add_u32 s36, s36, 0x4800000
  s_mul_i32 s39, s58, 0x40000
  s_add_u32 s39, s39, 0x740000
  s_mul_i32 s44, s58, 0x2000
  s_add_u32 s44, s44, 0x708000
  s_lshl_b32 s6, s5, 14
  s_lshl_b32 s7, s3, 11
  s_add_u32 s35, s35, s6
  s_add_u32 s35, s35, s7
  s_mov_b32 s48, s7
  s_lshl_b32 s6, s5, 8
  s_add_u32 s43, s44, s6
  s_add_u32 s44, s44, s7
  s_lshl_b32 s7, s5, 13
  s_add_u32 s41, s39, s7
  s_add_u32 s42, s41, 4096
  s_add_u32 s39, s39, s6
  s_add_u32 s40, s39, 32768
  s_lshl_b32 s7, s5, 12
  s_add_u32 s36, s36, s7
  s_lshl_b32 s7, s3, 10
  s_add_u32 s36, s36, s7
  s_add_u32 s53, s48, 8192
  s_add_u32 s37, s48, 16384
  s_lshl_b32 s6, s58, 13
  s_lshl_b32 s7, s5, 7
  s_add_u32 s38, s6, s7
  s_add_u32 s38, s38, 0x714000
  s_mov_b32 s54, 0x00ff00ff
  s_mov_b32 s55, 0x00ff00ff
  s_mov_b32 s56, 0x33333333
  s_mov_b32 s57, 0x33333333
  s_mov_b32 s34, 0x3e0293ee
  s_add_u32 s6, s3, 1
  s_and_b32 s6, s6, 3
  s_lshl_b32 s45, s6, 11
  s_add_u32 s6, s3, 2
  s_and_b32 s6, s6, 3
  s_lshl_b32 s46, s6, 11
  s_add_u32 s6, s3, 3
  s_and_b32 s6, s6, 3
  s_lshl_b32 s47, s6, 11
  v_and_b32 v16, 15, v0
  v_lshrrev_b32 v17, 4, v0
  v_lshlrev_b32 v1, 4, v0
  s_lshl_b32 s6, s3, 8
  s_add_u32 s6, s6, 24576
  v_mul_u32_u24 v18, 1088, v17
  v_lshl_add_u32 v18, v16, 3, v18
  v_add_u32 v2, s6, v18
  v_and_b32 v18, 3, v0
  v_mul_u32_u24 v18, 1088, v18
  v_bfe_u32 v19, v0, 2, 3
  v_lshl_add_u32 v18, v19, 3, v18
  v_lshrrev_b32 v19, 5, v0
  v_lshl_add_u32 v18, v19, 7, v18
  v_add_u32 v3, 24576, v18
  v_and_b32 v18, 7, v0
  v_bfe_u32 v19, v0, 3, 1
  v_lshl_or_b32 v18, v19, 4, v18
  v_lshlrev_b32 v18, 4, v18
  v_lshl_add_u32 v18, v17, 9, v18
  v_add_u32 v4, 8192, v18
  v_lshrrev_b32 v18, 2, v16
  v_and_b32 v19, 1, v0
  v_lshl_or_b32 v18, v18, 1, v19
  v_mul_u32_u24 v18, 288, v18
  v_lshl_add_u32 v18, v17, 2, v18
  s_lshl_b32 s6, s3, 6
  s_add_u32 s6, s6, 28928
  v_add_u32 v5, s6, v18
  v_lshrrev_b32 v18, 1, v16
  v_mul_u32_u24 v18, 288, v18
  v_lshl_add_u32 v18, v17, 5, v18
  v_lshl_add_u32 v18, v19, 4, v18
  v_add_u32 v6, 28928, v18
  s_lshl_b32 s6, s3, 15
  s_add_u32 s6, s6, 32768
  v_add_u32 v7, s6, v1
  v_lshrrev_b32 v18, 2, v16
  v_lshlrev_b32 v18, 13, v18
  v_and_b32 v19, 3, v0
  v_lshl_or_b32 v19, v17, 2, v19
  v_lshl_or_b32 v18, v19, 4, v18
  s_lshl_b32 s6, s3, 16
  v_add_u32 v8, s6, v18
  v_lshlrev_b32 v18, 4, v16
  v_lshl_or_b32 v18, v17, 9, v18
  v_add_u32 v9, s37, v18
  v_mov_b32 v10, 0x3f803f80
  v_mov_b32 v11, 0x3f803f80
  v_mov_b32 v12, 0
  v_mov_b32 v13, 0
  v_mov_b32 v14, 0
  v_mov_b32 v15, 0
  buffer_store_dwordx4 v[12:15], v8, s[8:11], s39 offen sc1
  buffer_store_dwordx4 v[12:15], v8, s[8:11], s40 offen sc1
  s_add_u32 s6, s36, 0
  buffer_store_dwordx4 v[12:15], v1, s[8:11], s6 offen sc1
  s_add_u32 s6, s36, 131072
  buffer_store_dwordx4 v[12:15], v1, s[8:11], s6 offen sc1
  s_add_u32 s6, s36, 262144
  buffer_store_dwordx4 v[12:15], v1, s[8:11], s6 offen sc1
  s_add_u32 s6, s36, 393216
  buffer_store_dwordx4 v[12:15], v1, s[8:11], s6 offen sc1
  s_mov_b64 exec, 0xffff
  buffer_store_dwordx4 v[12:15], v1, s[8:11], s43 offen sc1
  s_mov_b64 exec, -1
  s_cmp_eq_u32 s4, 1
  s_cbranch_scc1 L_pro
  s_branch L_rec3
L_rec2:
  v_and_b32 v16, 15, v0
  v_lshrrev_b32 v17, 4, v0
  v_lshlrev_b32 v1, 4, v0
  s_lshl_b32 s6, s3, 8
  s_add_u32 s6, s6, 24576
  v_mul_u32_u24 v18, 1088, v17
  v_lshl_add_u32 v18, v16, 3, v18
  v_add_u32 v2, s6, v18
  v_and_b32 v18, 3, v0
  v_mul_u32_u24 v18, 1088, v18
  v_bfe_u32 v19, v0, 2, 3
  v_lshl_add_u32 v18, v19, 3, v18
  v_lshrrev_b32 v19, 5, v0
  v_lshl_add_u32 v18, v19, 7, v18
  v_add_u32 v3, 24576, v18
  v_and_b32 v18, 7, v0
  v_bfe_u32 v19, v0, 3, 1
  v_lshl_or_b32 v18, v19, 4, v18
  v_lshlrev_b32 v18, 4, v18
  v_lshl_add_u32 v18, v17, 9, v18
  v_add_u32 v4, 8192, v18
  v_lshrrev_b32 v18, 2, v16
  v_and_b32 v19, 1, v0
  v_lshl_or_b32 v18, v18, 1, v19
  v_mul_u32_u24 v18, 288, v18
  v_lshl_add_u32 v18, v17, 2, v18
  s_lshl_b32 s6, s3, 6
  s_add_u32 s6, s6, 28928
  v_add_u32 v5, s6, v18
  v_lshrrev_b32 v18, 1, v16
  v_mul_u32_u24 v18, 288, v18
  v_lshl_add_u32 v18, v17, 5, v18
  v_lshl_add_u32 v18, v19, 4, v18
  v_add_u32 v6, 28928, v18
  s_lshl_b32 s6, s3, 15
  s_add_u32 s6, s6, 32768
  v_add_u32 v7, s6, v1
  v_lshrrev_b32 v18, 2, v16
  v_lshlrev_b32 v18, 13, v18
  v_and_b32 v19, 3, v0
  v_lshl_or_b32 v19, v17, 2, v19
  v_lshl_or_b32 v18, v19, 4, v18
  s_lshl_b32 s6, s3, 16
  v_add_u32 v8, s6, v18
  v_lshlrev_b32 v18, 4, v16
  v_lshl_or_b32 v18, v17, 9, v18
  v_add_u32 v9, s37, v18
  v_mov_b32 v10, 0x3f803f80
  v_mov_b32 v11, 0x3f803f80
  v_mov_b32 v12, 0
  v_mov_b32 v13, 0
  v_mov_b32 v14, 0
  v_mov_b32 v15, 0
L_rec3:
  s_mov_b32 s16, s82
  s_mov_b32 s17, s83
  s_mov_b32 s18, 0x400000
  s_mov_b32 s19, 0x20000
  s_mov_b32 s20, s84
  s_mov_b32 s21, s85
  s_mov_b32 s22, 0x400000
  s_mov_b32 s23, 0x20000
  s_mov_b32 s24, s86
  s_mov_b32 s25, s87
  s_mov_b32 s26, 0x400000
  s_mov_b32 s27, 0x20000
  s_mov_b32 s28, s88
  s_mov_b32 s29, s89
  s_mov_b32 s30, 0x400000
  s_mov_b32 s31, 0x20000
  v_bfe_u32 v16, v0, 4, 1
  v_lshrrev_b32 v17, 5, v0
  v_lshl_or_b32 v18, v17, 5, v16
  s_and_b32 s6, s3, 1
  s_lshr_b32 s7, s3, 1
  s_lshl_b32 s60, s6, 4
  s_lshl_b32 s7, s7, 6
  s_add_u32 s7, s7, s60
  v_add_u32 v18, s7, v18
  v_lshlrev_b32 v18, 13, v18
  v_lshrrev_b32 v19, 4, v0
  s_lshl_b32 s6, s6, 2
  v_or_b32 v19, s6, v19
  v_lshlrev_b32 v19, 1, v19
  v_and_b32 v116, 15, v0
  v_xor_b32 v19, v19, v116
  v_lshl_or_b32 v116, v19, 4, v18
  v_bfe_u32 v18, v0, 2, 2
  v_lshl_or_b32 v19, v16, 2, v18
  v_lshl_or_b32 v18, v17, 3, v18
  v_lshl_or_b32 v18, v16, 5, v18
  v_lshlrev_b32 v18, 8, v18
  s_lshl_b32 s6, s3, 1
  v_xor_b32 v19, s6, v19
  v_lshl_or_b32 v18, v19, 5, v18
  v_and_b32 v19, 3, v0
  v_lshl_or_b32 v18, v19, 3, v18
  v_add_u32 v120, 32768, v18
  v_xor_b32 v121, 32, v120
  v_add_u32 v122, 0x10000, v120
  v_add_u32 v123, 0x10000, v121
  v_lshrrev_b32 v16, 4, v0
  v_and_b32 v17, 15, v0
  v_lshlrev_b32 v18, 1, v16
  v_xor_b32 v17, v17, v18
  v_lshlrev_b32 v17, 4, v17
  v_lshl_or_b32 v118, v16, 10, v17
  v_xor_b32 v119, 0x80, v118
  s_lshl_b32 s60, s3, 13
  s_add_u32 s60, s60, 32768
  v_bfe_u32 v17, v0, 2, 2
  v_bfe_u32 v18, v0, 4, 1
  v_lshl_or_b32 v18, v18, 2, v17
  v_lshl_or_b32 v17, v16, 3, v17
  v_lshlrev_b32 v17, 8, v17
  v_lshl_or_b32 v17, v18, 5, v17
  v_lshl_or_b32 v17, v19, 3, v17
  v_add_u32 v124, s60, v17
  v_add_u32 v127, s60, v1
  s_lshl_b32 s63, s5, 8
  s_add_u32 s61, s63, 0
  s_add_u32 m0, s60, 0
  s_add_u32 s62, s61, 0
  buffer_load_dwordx4 v116, s[16:19], s62 offen lds
  s_add_u32 m0, s60, 1024
  s_add_u32 s62, s61, 16384
  buffer_load_dwordx4 v116, s[16:19], s62 offen lds
  s_add_u32 m0, s60, 2048
  s_add_u32 s62, s61, 32768
  buffer_load_dwordx4 v116, s[16:19], s62 offen lds
  s_add_u32 m0, s60, 3072
  s_add_u32 s62, s61, 49152
  buffer_load_dwordx4 v116, s[16:19], s62 offen lds
  s_add_u32 m0, s60, 4096
  s_add_u32 s62, s61, 65536
  buffer_load_dwordx4 v116, s[16:19], s62 offen lds
  s_add_u32 m0, s60, 5120
  s_add_u32 s62, s61, 81920
  buffer_load_dwordx4 v116, s[16:19], s62 offen lds
  s_add_u32 m0, s60, 6144
  s_add_u32 s62, s61, 98304
  buffer_load_dwordx4 v116, s[16:19], s62 offen lds
  s_add_u32 m0, s60, 7168
  s_add_u32 s62, s61, 114688
  buffer_load_dwordx4 v116, s[16:19], s62 offen lds
  s_add_u32 s61, s63, 1048576
  s_add_u32 m0, s60, 32768
  s_add_u32 s62, s61, 0
  buffer_load_dwordx4 v116, s[16:19], s62 offen lds
  s_add_u32 m0, s60, 33792
  s_add_u32 s62, s61, 16384
  buffer_load_dwordx4 v116, s[16:19], s62 offen lds
  s_add_u32 m0, s60, 34816
  s_add_u32 s62, s61, 32768
  buffer_load_dwordx4 v116, s[16:19], s62 offen lds
  s_add_u32 m0, s60, 35840
  s_add_u32 s62, s61, 49152
  buffer_load_dwordx4 v116, s[16:19], s62 offen lds
  s_add_u32 m0, s60, 36864
  s_add_u32 s62, s61, 65536
  buffer_load_dwordx4 v116, s[16:19], s62 offen lds
  s_add_u32 m0, s60, 37888
  s_add_u32 s62, s61, 81920
  buffer_load_dwordx4 v116, s[16:19], s62 offen lds
  s_add_u32 m0, s60, 38912
  s_add_u32 s62, s61, 98304
  buffer_load_dwordx4 v116, s[16:19], s62 offen lds
  s_add_u32 m0, s60, 39936
  s_add_u32 s62, s61, 114688
  buffer_load_dwordx4 v116, s[16:19], s62 offen lds
  s_add_u32 s61, s63, 2097152
  s_add_u32 m0, s60, 65536
  s_add_u32 s62, s61, 0
  buffer_load_dwordx4 v116, s[16:19], s62 offen lds
  s_add_u32 m0, s60, 66560
  s_add_u32 s62, s61, 16384
  buffer_load_dwordx4 v116, s[16:19], s62 offen lds
  s_add_u32 m0, s60, 67584
  s_add_u32 s62, s61, 32768
  buffer_load_dwordx4 v116, s[16:19], s62 offen lds
  s_add_u32 m0, s60, 68608
  s_add_u32 s62, s61, 49152
  buffer_load_dwordx4 v116, s[16:19], s62 offen lds
  s_add_u32 m0, s60, 69632
  s_add_u32 s62, s61, 65536
  buffer_load_dwordx4 v116, s[16:19], s62 offen lds
  s_add_u32 m0, s60, 70656
  s_add_u32 s62, s61, 81920
  buffer_load_dwordx4 v116, s[16:19], s62 offen lds
  s_add_u32 m0, s60, 71680
  s_add_u32 s62, s61, 98304
  buffer_load_dwordx4 v116, s[16:19], s62 offen lds
  s_add_u32 m0, s60, 72704
  s_add_u32 s62, s61, 114688
  buffer_load_dwordx4 v116, s[16:19], s62 offen lds
  s_lshr_b32 s6, 0x72, s4
  s_bitcmp1_b32 s6, 0
  s_cbranch_scc1 L_rdn_16
  s_waitcnt vmcnt(24)
  s_barrier
  s_cmp_lg_u32 s3, 0
  s_cbranch_scc1 L_sd_17
  s_mov_b64 exec, 1
  s_and_b32 s6, s4, 3
  s_lshl_b32 s6, s6, 6
  v_mov_b32 v18, 16
  v_mov_b32 v19, 1
  buffer_atomic_add v19, v18, s[12:15], s6 offen sc1
  s_mov_b64 exec, -1
L_sd_17:
L_rdn_16:
  s_waitcnt vmcnt(16)
  s_barrier
  s_add_u32 s61, s63, 3145728
  s_add_u32 m0, s60, 98304
  s_add_u32 s62, s61, 0
  buffer_load_dwordx4 v116, s[16:19], s62 offen lds
  s_add_u32 m0, s60, 99328
  s_add_u32 s62, s61, 16384
  buffer_load_dwordx4 v116, s[16:19], s62 offen lds
  s_add_u32 m0, s60, 100352
  s_add_u32 s62, s61, 32768
  buffer_load_dwordx4 v116, s[16:19], s62 offen lds
  s_add_u32 m0, s60, 101376
  s_add_u32 s62, s61, 49152
  buffer_load_dwordx4 v116, s[16:19], s62 offen lds
  s_add_u32 m0, s60, 102400
  s_add_u32 s62, s61, 65536
  buffer_load_dwordx4 v116, s[16:19], s62 offen lds
  s_add_u32 m0, s60, 103424
  s_add_u32 s62, s61, 81920
  buffer_load_dwordx4 v116, s[16:19], s62 offen lds
  s_add_u32 m0, s60, 104448
  s_add_u32 s62, s61, 98304
  buffer_load_dwordx4 v116, s[16:19], s62 offen lds
  s_add_u32 m0, s60, 105472
  s_add_u32 s62, s61, 114688
  buffer_load_dwordx4 v116, s[16:19], s62 offen lds
  s_cmp_eq_u32 s3, 1
  s_cbranch_scc1 L_lv_20
  s_cmp_eq_u32 s3, 2
  s_cbranch_scc1 L_lv_21
  s_cmp_eq_u32 s3, 3
  s_cbranch_scc1 L_lv_22
L_lv_19:
  ds_read_b64_tr_b16 a[0:1], v120 offset:0
  ds_read_b64_tr_b16 a[2:3], v120 offset:1024
  ds_read_b64_tr_b16 a[4:5], v120 offset:4096
  ds_read_b64_tr_b16 a[6:7], v120 offset:5120
  ds_read_b64_tr_b16 a[8:9], v121 offset:0
  ds_read_b64_tr_b16 a[10:11], v121 offset:1024
  ds_read_b64_tr_b16 a[12:13], v121 offset:4096
  ds_read_b64_tr_b16 a[14:15], v121 offset:5120
  ds_read_b64_tr_b16 a[16:17], v120 offset:16384
  ds_read_b64_tr_b16 a[18:19], v120 offset:17408
  ds_read_b64_tr_b16 a[20:21], v120 offset:20480
  ds_read_b64_tr_b16 a[22:23], v120 offset:21504
  ds_read_b64_tr_b16 a[24:25], v121 offset:16384
  ds_read_b64_tr_b16 a[26:27], v121 offset:17408
  ds_read_b64_tr_b16 a[28:29], v121 offset:20480
  ds_read_b64_tr_b16 a[30:31], v121 offset:21504
  s_branch L_lw_18
L_lv_20:
  ds_read_b64_tr_b16 a[96:97], v120 offset:0
  ds_read_b64_tr_b16 a[98:99], v120 offset:1024
  ds_read_b64_tr_b16 a[100:101], v120 offset:4096
  ds_read_b64_tr_b16 a[102:103], v120 offset:5120
  ds_read_b64_tr_b16 a[104:105], v121 offset:0
  ds_read_b64_tr_b16 a[106:107], v121 offset:1024
  ds_read_b64_tr_b16 a[108:109], v121 offset:4096
  ds_read_b64_tr_b16 a[110:111], v121 offset:5120
  ds_read_b64_tr_b16 a[112:113], v120 offset:16384
  ds_read_b64_tr_b16 a[114:115], v120 offset:17408
  ds_read_b64_tr_b16 a[116:117], v120 offset:20480
  ds_read_b64_tr_b16 a[118:119], v120 offset:21504
  ds_read_b64_tr_b16 a[120:121], v121 offset:16384
  ds_read_b64_tr_b16 a[122:123], v121 offset:17408
  ds_read_b64_tr_b16 a[124:125], v121 offset:20480
  ds_read_b64_tr_b16 a[126:127], v121 offset:21504
  s_branch L_lw_18
L_lv_21:
  ds_read_b64_tr_b16 a[64:65], v120 offset:0
  ds_read_b64_tr_b16 a[66:67], v120 offset:1024
  ds_read_b64_tr_b16 a[68:69], v120 offset:4096
  ds_read_b64_tr_b16 a[70:71], v120 offset:5120
  ds_read_b64_tr_b16 a[72:73], v121 offset:0
  ds_read_b64_tr_b16 a[74:75], v121 offset:1024
  ds_read_b64_tr_b16 a[76:77], v121 offset:4096
  ds_read_b64_tr_b16 a[78:79], v121 offset:5120
  ds_read_b64_tr_b16 a[80:81], v120 offset:16384
  ds_read_b64_tr_b16 a[82:83], v120 offset:17408
  ds_read_b64_tr_b16 a[84:85], v120 offset:20480
  ds_read_b64_tr_b16 a[86:87], v120 offset:21504
  ds_read_b64_tr_b16 a[88:89], v121 offset:16384
  ds_read_b64_tr_b16 a[90:91], v121 offset:17408
  ds_read_b64_tr_b16 a[92:93], v121 offset:20480
  ds_read_b64_tr_b16 a[94:95], v121 offset:21504
  s_branch L_lw_18
L_lv_22:
  ds_read_b64_tr_b16 a[32:33], v120 offset:0
  ds_read_b64_tr_b16 a[34:35], v120 offset:1024
  ds_read_b64_tr_b16 a[36:37], v120 offset:4096
  ds_read_b64_tr_b16 a[38:39], v120 offset:5120
  ds_read_b64_tr_b16 a[40:41], v121 offset:0
  ds_read_b64_tr_b16 a[42:43], v121 offset:1024
  ds_read_b64_tr_b16 a[44:45], v121 offset:4096
  ds_read_b64_tr_b16 a[46:47], v121 offset:5120
  ds_read_b64_tr_b16 a[48:49], v120 offset:16384
  ds_read_b64_tr_b16 a[50:51], v120 offset:17408
  ds_read_b64_tr_b16 a[52:53], v120 offset:20480
  ds_read_b64_tr_b16 a[54:55], v120 offset:21504
  ds_read_b64_tr_b16 a[56:57], v121 offset:16384
  ds_read_b64_tr_b16 a[58:59], v121 offset:17408
  ds_read_b64_tr_b16 a[60:61], v121 offset:20480
  ds_read_b64_tr_b16 a[62:63], v121 offset:21504
L_lw_18:
  s_waitcnt lgkmcnt(0)
  s_waitcnt vmcnt(16)
  s_barrier
  s_add_u32 s61, s63, 0
  s_add_u32 m0, s60, 0
  s_add_u32 s62, s61, 0
  buffer_load_dwordx4 v116, s[20:23], s62 offen lds
  s_add_u32 m0, s60, 1024
  s_add_u32 s62, s61, 16384
  buffer_load_dwordx4 v116, s[20:23], s62 offen lds
  s_add_u32 m0, s60, 2048
  s_add_u32 s62, s61, 32768
  buffer_load_dwordx4 v116, s[20:23], s62 offen lds
  s_add_u32 m0, s60, 3072
  s_add_u32 s62, s61, 49152
  buffer_load_dwordx4 v116, s[20:23], s62 offen lds
  s_add_u32 m0, s60, 4096
  s_add_u32 s62, s61, 65536
  buffer_load_dwordx4 v116, s[20:23], s62 offen lds
  s_add_u32 m0, s60, 5120
  s_add_u32 s62, s61, 81920
  buffer_load_dwordx4 v116, s[20:23], s62 offen lds
  s_add_u32 m0, s60, 6144
  s_add_u32 s62, s61, 98304
  buffer_load_dwordx4 v116, s[20:23], s62 offen lds
  s_add_u32 m0, s60, 7168
  s_add_u32 s62, s61, 114688
  buffer_load_dwordx4 v116, s[20:23], s62 offen lds
  s_cmp_eq_u32 s3, 1
  s_cbranch_scc1 L_lv_25
  s_cmp_eq_u32 s3, 2
  s_cbranch_scc1 L_lv_26
  s_cmp_eq_u32 s3, 3
  s_cbranch_scc1 L_lv_27
L_lv_24:
  ds_read_b64_tr_b16 a[32:33], v120 offset:32768
  ds_read_b64_tr_b16 a[34:35], v120 offset:33792
  ds_read_b64_tr_b16 a[36:37], v120 offset:36864
  ds_read_b64_tr_b16 a[38:39], v120 offset:37888
  ds_read_b64_tr_b16 a[40:41], v121 offset:32768
  ds_read_b64_tr_b16 a[42:43], v121 offset:33792
  ds_read_b64_tr_b16 a[44:45], v121 offset:36864
  ds_read_b64_tr_b16 a[46:47], v121 offset:37888
  ds_read_b64_tr_b16 a[48:49], v120 offset:49152
  ds_read_b64_tr_b16 a[50:51], v120 offset:50176
  ds_read_b64_tr_b16 a[52:53], v120 offset:53248
  ds_read_b64_tr_b16 a[54:55], v120 offset:54272
  ds_read_b64_tr_b16 a[56:57], v121 offset:49152
  ds_read_b64_tr_b16 a[58:59], v121 offset:50176
  ds_read_b64_tr_b16 a[60:61], v121 offset:53248
  ds_read_b64_tr_b16 a[62:63], v121 offset:54272
  s_branch L_lw_23
L_lv_25:
  ds_read_b64_tr_b16 a[0:1], v120 offset:32768
  ds_read_b64_tr_b16 a[2:3], v120 offset:33792
  ds_read_b64_tr_b16 a[4:5], v120 offset:36864
  ds_read_b64_tr_b16 a[6:7], v120 offset:37888
  ds_read_b64_tr_b16 a[8:9], v121 offset:32768
  ds_read_b64_tr_b16 a[10:11], v121 offset:33792
  ds_read_b64_tr_b16 a[12:13], v121 offset:36864
  ds_read_b64_tr_b16 a[14:15], v121 offset:37888
  ds_read_b64_tr_b16 a[16:17], v120 offset:49152
  ds_read_b64_tr_b16 a[18:19], v120 offset:50176
  ds_read_b64_tr_b16 a[20:21], v120 offset:53248
  ds_read_b64_tr_b16 a[22:23], v120 offset:54272
  ds_read_b64_tr_b16 a[24:25], v121 offset:49152
  ds_read_b64_tr_b16 a[26:27], v121 offset:50176
  ds_read_b64_tr_b16 a[28:29], v121 offset:53248
  ds_read_b64_tr_b16 a[30:31], v121 offset:54272
  s_branch L_lw_23
L_lv_26:
  ds_read_b64_tr_b16 a[96:97], v120 offset:32768
  ds_read_b64_tr_b16 a[98:99], v120 offset:33792
  ds_read_b64_tr_b16 a[100:101], v120 offset:36864
  ds_read_b64_tr_b16 a[102:103], v120 offset:37888
  ds_read_b64_tr_b16 a[104:105], v121 offset:32768
  ds_read_b64_tr_b16 a[106:107], v121 offset:33792
  ds_read_b64_tr_b16 a[108:109], v121 offset:36864
  ds_read_b64_tr_b16 a[110:111], v121 offset:37888
  ds_read_b64_tr_b16 a[112:113], v120 offset:49152
  ds_read_b64_tr_b16 a[114:115], v120 offset:50176
  ds_read_b64_tr_b16 a[116:117], v120 offset:53248
  ds_read_b64_tr_b16 a[118:119], v120 offset:54272
  ds_read_b64_tr_b16 a[120:121], v121 offset:49152
  ds_read_b64_tr_b16 a[122:123], v121 offset:50176
  ds_read_b64_tr_b16 a[124:125], v121 offset:53248
  ds_read_b64_tr_b16 a[126:127], v121 offset:54272
  s_branch L_lw_23
L_lv_27:
  ds_read_b64_tr_b16 a[64:65], v120 offset:32768
  ds_read_b64_tr_b16 a[66:67], v120 offset:33792
  ds_read_b64_tr_b16 a[68:69], v120 offset:36864
  ds_read_b64_tr_b16 a[70:71], v120 offset:37888
  ds_read_b64_tr_b16 a[72:73], v121 offset:32768
  ds_read_b64_tr_b16 a[74:75], v121 offset:33792
  ds_read_b64_tr_b16 a[76:77], v121 offset:36864
  ds_read_b64_tr_b16 a[78:79], v121 offset:37888
  ds_read_b64_tr_b16 a[80:81], v120 offset:49152
  ds_read_b64_tr_b16 a[82:83], v120 offset:50176
  ds_read_b64_tr_b16 a[84:85], v120 offset:53248
  ds_read_b64_tr_b16 a[86:87], v120 offset:54272
  ds_read_b64_tr_b16 a[88:89], v121 offset:49152
  ds_read_b64_tr_b16 a[90:91], v121 offset:50176
  ds_read_b64_tr_b16 a[92:93], v121 offset:53248
  ds_read_b64_tr_b16 a[94:95], v121 offset:54272
L_lw_23:
  s_waitcnt lgkmcnt(0)
  s_waitcnt vmcnt(16)
  s_barrier
  s_add_u32 s61, s63, 1048576
  s_add_u32 m0, s60, 32768
  s_add_u32 s62, s61, 0
  buffer_load_dwordx4 v116, s[20:23], s62 offen lds
  s_add_u32 m0, s60, 33792
  s_add_u32 s62, s61, 16384
  buffer_load_dwordx4 v116, s[20:23], s62 offen lds
  s_add_u32 m0, s60, 34816
  s_add_u32 s62, s61, 32768
  buffer_load_dwordx4 v116, s[20:23], s62 offen lds
  s_add_u32 m0, s60, 35840
  s_add_u32 s62, s61, 49152
  buffer_load_dwordx4 v116, s[20:23], s62 offen lds
  s_add_u32 m0, s60, 36864
  s_add_u32 s62, s61, 65536
  buffer_load_dwordx4 v116, s[20:23], s62 offen lds
  s_add_u32 m0, s60, 37888
  s_add_u32 s62, s61, 81920
  buffer_load_dwordx4 v116, s[20:23], s62 offen lds
  s_add_u32 m0, s60, 38912
  s_add_u32 s62, s61, 98304
  buffer_load_dwordx4 v116, s[20:23], s62 offen lds
  s_add_u32 m0, s60, 39936
  s_add_u32 s62, s61, 114688
  buffer_load_dwordx4 v116, s[20:23], s62 offen lds
  s_cmp_eq_u32 s3, 1
  s_cbranch_scc1 L_lv_30
  s_cmp_eq_u32 s3, 2
  s_cbranch_scc1 L_lv_31
  s_cmp_eq_u32 s3, 3
  s_cbranch_scc1 L_lv_32
L_lv_29:
  ds_read_b64_tr_b16 a[64:65], v122 offset:0
  ds_read_b64_tr_b16 a[66:67], v122 offset:1024
  ds_read_b64_tr_b16 a[68:69], v122 offset:4096
  ds_read_b64_tr_b16 a[70:71], v122 offset:5120
  ds_read_b64_tr_b16 a[72:73], v123 offset:0
  ds_read_b64_tr_b16 a[74:75], v123 offset:1024
  ds_read_b64_tr_b16 a[76:77], v123 offset:4096
  ds_read_b64_tr_b16 a[78:79], v123 offset:5120
  ds_read_b64_tr_b16 a[80:81], v122 offset:16384
  ds_read_b64_tr_b16 a[82:83], v122 offset:17408
  ds_read_b64_tr_b16 a[84:85], v122 offset:20480
  ds_read_b64_tr_b16 a[86:87], v122 offset:21504
  ds_read_b64_tr_b16 a[88:89], v123 offset:16384
  ds_read_b64_tr_b16 a[90:91], v123 offset:17408
  ds_read_b64_tr_b16 a[92:93], v123 offset:20480
  ds_read_b64_tr_b16 a[94:95], v123 offset:21504
  s_branch L_lw_28
L_lv_30:
  ds_read_b64_tr_b16 a[32:33], v122 offset:0
  ds_read_b64_tr_b16 a[34:35], v122 offset:1024
  ds_read_b64_tr_b16 a[36:37], v122 offset:4096
  ds_read_b64_tr_b16 a[38:39], v122 offset:5120
  ds_read_b64_tr_b16 a[40:41], v123 offset:0
  ds_read_b64_tr_b16 a[42:43], v123 offset:1024
  ds_read_b64_tr_b16 a[44:45], v123 offset:4096
  ds_read_b64_tr_b16 a[46:47], v123 offset:5120
  ds_read_b64_tr_b16 a[48:49], v122 offset:16384
  ds_read_b64_tr_b16 a[50:51], v122 offset:17408
  ds_read_b64_tr_b16 a[52:53], v122 offset:20480
  ds_read_b64_tr_b16 a[54:55], v122 offset:21504
  ds_read_b64_tr_b16 a[56:57], v123 offset:16384
  ds_read_b64_tr_b16 a[58:59], v123 offset:17408
  ds_read_b64_tr_b16 a[60:61], v123 offset:20480
  ds_read_b64_tr_b16 a[62:63], v123 offset:21504
  s_branch L_lw_28
L_lv_31:
  ds_read_b64_tr_b16 a[0:1], v122 offset:0
  ds_read_b64_tr_b16 a[2:3], v122 offset:1024
  ds_read_b64_tr_b16 a[4:5], v122 offset:4096
  ds_read_b64_tr_b16 a[6:7], v122 offset:5120
  ds_read_b64_tr_b16 a[8:9], v123 offset:0
  ds_read_b64_tr_b16 a[10:11], v123 offset:1024
  ds_read_b64_tr_b16 a[12:13], v123 offset:4096
  ds_read_b64_tr_b16 a[14:15], v123 offset:5120
  ds_read_b64_tr_b16 a[16:17], v122 offset:16384
  ds_read_b64_tr_b16 a[18:19], v122 offset:17408
  ds_read_b64_tr_b16 a[20:21], v122 offset:20480
  ds_read_b64_tr_b16 a[22:23], v122 offset:21504
  ds_read_b64_tr_b16 a[24:25], v123 offset:16384
  ds_read_b64_tr_b16 a[26:27], v123 offset:17408
  ds_read_b64_tr_b16 a[28:29], v123 offset:20480
  ds_read_b64_tr_b16 a[30:31], v123 offset:21504
  s_branch L_lw_28
L_lv_32:
  ds_read_b64_tr_b16 a[96:97], v122 offset:0
  ds_read_b64_tr_b16 a[98:99], v122 offset:1024
  ds_read_b64_tr_b16 a[100:101], v122 offset:4096
  ds_read_b64_tr_b16 a[102:103], v122 offset:5120
  ds_read_b64_tr_b16 a[104:105], v123 offset:0
  ds_read_b64_tr_b16 a[106:107], v123 offset:1024
  ds_read_b64_tr_b16 a[108:109], v123 offset:4096
  ds_read_b64_tr_b16 a[110:111], v123 offset:5120
  ds_read_b64_tr_b16 a[112:113], v122 offset:16384
  ds_read_b64_tr_b16 a[114:115], v122 offset:17408
  ds_read_b64_tr_b16 a[116:117], v122 offset:20480
  ds_read_b64_tr_b16 a[118:119], v122 offset:21504
  ds_read_b64_tr_b16 a[120:121], v123 offset:16384
  ds_read_b64_tr_b16 a[122:123], v123 offset:17408
  ds_read_b64_tr_b16 a[124:125], v123 offset:20480
  ds_read_b64_tr_b16 a[126:127], v123 offset:21504
L_lw_28:
  s_waitcnt lgkmcnt(0)
  s_waitcnt vmcnt(16)
  s_barrier
  s_add_u32 s61, s63, 2097152
  s_add_u32 m0, s60, 65536
  s_add_u32 s62, s61, 0
  buffer_load_dwordx4 v116, s[20:23], s62 offen lds
  s_add_u32 m0, s60, 66560
  s_add_u32 s62, s61, 16384
  buffer_load_dwordx4 v116, s[20:23], s62 offen lds
  s_add_u32 m0, s60, 67584
  s_add_u32 s62, s61, 32768
  buffer_load_dwordx4 v116, s[20:23], s62 offen lds
  s_add_u32 m0, s60, 68608
  s_add_u32 s62, s61, 49152
  buffer_load_dwordx4 v116, s[20:23], s62 offen lds
  s_add_u32 m0, s60, 69632
  s_add_u32 s62, s61, 65536
  buffer_load_dwordx4 v116, s[20:23], s62 offen lds
  s_add_u32 m0, s60, 70656
  s_add_u32 s62, s61, 81920
  buffer_load_dwordx4 v116, s[20:23], s62 offen lds
  s_add_u32 m0, s60, 71680
  s_add_u32 s62, s61, 98304
  buffer_load_dwordx4 v116, s[20:23], s62 offen lds
  s_add_u32 m0, s60, 72704
  s_add_u32 s62, s61, 114688
  buffer_load_dwordx4 v116, s[20:23], s62 offen lds
  s_cmp_eq_u32 s3, 1
  s_cbranch_scc1 L_lv_35
  s_cmp_eq_u32 s3, 2
  s_cbranch_scc1 L_lv_36
  s_cmp_eq_u32 s3, 3
  s_cbranch_scc1 L_lv_37
L_lv_34:
  ds_read_b64_tr_b16 a[96:97], v122 offset:32768
  ds_read_b64_tr_b16 a[98:99], v122 offset:33792
  ds_read_b64_tr_b16 a[100:101], v122 offset:36864
  ds_read_b64_tr_b16 a[102:103], v122 offset:37888
  ds_read_b64_tr_b16 a[104:105], v123 offset:32768
  ds_read_b64_tr_b16 a[106:107], v123 offset:33792
  ds_read_b64_tr_b16 a[108:109], v123 offset:36864
  ds_read_b64_tr_b16 a[110:111], v123 offset:37888
  ds_read_b64_tr_b16 a[112:113], v122 offset:49152
  ds_read_b64_tr_b16 a[114:115], v122 offset:50176
  ds_read_b64_tr_b16 a[116:117], v122 offset:53248
  ds_read_b64_tr_b16 a[118:119], v122 offset:54272
  ds_read_b64_tr_b16 a[120:121], v123 offset:49152
  ds_read_b64_tr_b16 a[122:123], v123 offset:50176
  ds_read_b64_tr_b16 a[124:125], v123 offset:53248
  ds_read_b64_tr_b16 a[126:127], v123 offset:54272
  s_branch L_lw_33
L_lv_35:
  ds_read_b64_tr_b16 a[64:65], v122 offset:32768
  ds_read_b64_tr_b16 a[66:67], v122 offset:33792
  ds_read_b64_tr_b16 a[68:69], v122 offset:36864
  ds_read_b64_tr_b16 a[70:71], v122 offset:37888
  ds_read_b64_tr_b16 a[72:73], v123 offset:32768
  ds_read_b64_tr_b16 a[74:75], v123 offset:33792
  ds_read_b64_tr_b16 a[76:77], v123 offset:36864
  ds_read_b64_tr_b16 a[78:79], v123 offset:37888
  ds_read_b64_tr_b16 a[80:81], v122 offset:49152
  ds_read_b64_tr_b16 a[82:83], v122 offset:50176
  ds_read_b64_tr_b16 a[84:85], v122 offset:53248
  ds_read_b64_tr_b16 a[86:87], v122 offset:54272
  ds_read_b64_tr_b16 a[88:89], v123 offset:49152
  ds_read_b64_tr_b16 a[90:91], v123 offset:50176
  ds_read_b64_tr_b16 a[92:93], v123 offset:53248
  ds_read_b64_tr_b16 a[94:95], v123 offset:54272
  s_branch L_lw_33
L_lv_36:
  ds_read_b64_tr_b16 a[32:33], v122 offset:32768
  ds_read_b64_tr_b16 a[34:35], v122 offset:33792
  ds_read_b64_tr_b16 a[36:37], v122 offset:36864
  ds_read_b64_tr_b16 a[38:39], v122 offset:37888
  ds_read_b64_tr_b16 a[40:41], v123 offset:32768
  ds_read_b64_tr_b16 a[42:43], v123 offset:33792
  ds_read_b64_tr_b16 a[44:45], v123 offset:36864
  ds_read_b64_tr_b16 a[46:47], v123 offset:37888
  ds_read_b64_tr_b16 a[48:49], v122 offset:49152
  ds_read_b64_tr_b16 a[50:51], v122 offset:50176
  ds_read_b64_tr_b16 a[52:53], v122 offset:53248
  ds_read_b64_tr_b16 a[54:55], v122 offset:54272
  ds_read_b64_tr_b16 a[56:57], v123 offset:49152
  ds_read_b64_tr_b16 a[58:59], v123 offset:50176
  ds_read_b64_tr_b16 a[60:61], v123 offset:53248
  ds_read_b64_tr_b16 a[62:63], v123 offset:54272
  s_branch L_lw_33
L_lv_37:
  ds_read_b64_tr_b16 a[0:1], v122 offset:32768
  ds_read_b64_tr_b16 a[2:3], v122 offset:33792
  ds_read_b64_tr_b16 a[4:5], v122 offset:36864
  ds_read_b64_tr_b16 a[6:7], v122 offset:37888
  ds_read_b64_tr_b16 a[8:9], v123 offset:32768
  ds_read_b64_tr_b16 a[10:11], v123 offset:33792
  ds_read_b64_tr_b16 a[12:13], v123 offset:36864
  ds_read_b64_tr_b16 a[14:15], v123 offset:37888
  ds_read_b64_tr_b16 a[16:17], v122 offset:49152
  ds_read_b64_tr_b16 a[18:19], v122 offset:50176
  ds_read_b64_tr_b16 a[20:21], v122 offset:53248
  ds_read_b64_tr_b16 a[22:23], v122 offset:54272
  ds_read_b64_tr_b16 a[24:25], v123 offset:49152
  ds_read_b64_tr_b16 a[26:27], v123 offset:50176
  ds_read_b64_tr_b16 a[28:29], v123 offset:53248
  ds_read_b64_tr_b16 a[30:31], v123 offset:54272
L_lw_33:
  s_waitcnt lgkmcnt(0)
  s_waitcnt vmcnt(16)
  s_barrier
  s_add_u32 s61, s63, 3145728
  s_add_u32 m0, s60, 98304
  s_add_u32 s62, s61, 0
  buffer_load_dwordx4 v116, s[20:23], s62 offen lds
  s_add_u32 m0, s60, 99328
  s_add_u32 s62, s61, 16384
  buffer_load_dwordx4 v116, s[20:23], s62 offen lds
  s_add_u32 m0, s60, 100352
  s_add_u32 s62, s61, 32768
  buffer_load_dwordx4 v116, s[20:23], s62 offen lds
  s_add_u32 m0, s60, 101376
  s_add_u32 s62, s61, 49152
  buffer_load_dwordx4 v116, s[20:23], s62 offen lds
  s_add_u32 m0, s60, 102400
  s_add_u32 s62, s61, 65536
  buffer_load_dwordx4 v116, s[20:23], s62 offen lds
  s_add_u32 m0, s60, 103424
  s_add_u32 s62, s61, 81920
  buffer_load_dwordx4 v116, s[20:23], s62 offen lds
  s_add_u32 m0, s60, 104448
  s_add_u32 s62, s61, 98304
  buffer_load_dwordx4 v116, s[20:23], s62 offen lds
  s_add_u32 m0, s60, 105472
  s_add_u32 s62, s61, 114688
  buffer_load_dwordx4 v116, s[20:23], s62 offen lds
  s_cmp_eq_u32 s3, 1
  s_cbranch_scc1 L_lv_40
  s_cmp_eq_u32 s3, 2
  s_cbranch_scc1 L_lv_41
  s_cmp_eq_u32 s3, 3
  s_cbranch_scc1 L_lv_42
L_lv_39:
  ds_read_b64_tr_b16 a[128:129], v120 offset:0
  ds_read_b64_tr_b16 a[130:131], v120 offset:1024
  ds_read_b64_tr_b16 a[132:133], v120 offset:4096
  ds_read_b64_tr_b16 a[134:135], v120 offset:5120
  ds_read_b64_tr_b16 a[136:137], v121 offset:0
  ds_read_b64_tr_b16 a[138:139], v121 offset:1024
  ds_read_b64_tr_b16 a[140:141], v121 offset:4096
  ds_read_b64_tr_b16 a[142:143], v121 offset:5120
  ds_read_b64_tr_b16 a[144:145], v120 offset:16384
  ds_read_b64_tr_b16 a[146:147], v120 offset:17408
  ds_read_b64_tr_b16 a[148:149], v120 offset:20480
  ds_read_b64_tr_b16 a[150:151], v120 offset:21504
  ds_read_b64_tr_b16 a[152:153], v121 offset:16384
  ds_read_b64_tr_b16 a[154:155], v121 offset:17408
  ds_read_b64_tr_b16 a[156:157], v121 offset:20480
  ds_read_b64_tr_b16 a[158:159], v121 offset:21504
  s_branch L_lw_38
L_lv_40:
  ds_read_b64_tr_b16 a[224:225], v120 offset:0
  ds_read_b64_tr_b16 a[226:227], v120 offset:1024
  ds_read_b64_tr_b16 a[228:229], v120 offset:4096
  ds_read_b64_tr_b16 a[230:231], v120 offset:5120
  ds_read_b64_tr_b16 a[232:233], v121 offset:0
  ds_read_b64_tr_b16 a[234:235], v121 offset:1024
  ds_read_b64_tr_b16 a[236:237], v121 offset:4096
  ds_read_b64_tr_b16 a[238:239], v121 offset:5120
  ds_read_b64_tr_b16 a[240:241], v120 offset:16384
  ds_read_b64_tr_b16 a[242:243], v120 offset:17408
  ds_read_b64_tr_b16 a[244:245], v120 offset:20480
  ds_read_b64_tr_b16 a[246:247], v120 offset:21504
  ds_read_b64_tr_b16 a[248:249], v121 offset:16384
  ds_read_b64_tr_b16 a[250:251], v121 offset:17408
  ds_read_b64_tr_b16 a[252:253], v121 offset:20480
  ds_read_b64_tr_b16 a[254:255], v121 offset:21504
  s_branch L_lw_38
L_lv_41:
  ds_read_b64_tr_b16 a[192:193], v120 offset:0
  ds_read_b64_tr_b16 a[194:195], v120 offset:1024
  ds_read_b64_tr_b16 a[196:197], v120 offset:4096
  ds_read_b64_tr_b16 a[198:199], v120 offset:5120
  ds_read_b64_tr_b16 a[200:201], v121 offset:0
  ds_read_b64_tr_b16 a[202:203], v121 offset:1024
  ds_read_b64_tr_b16 a[204:205], v121 offset:4096
  ds_read_b64_tr_b16 a[206:207], v121 offset:5120
  ds_read_b64_tr_b16 a[208:209], v120 offset:16384
  ds_read_b64_tr_b16 a[210:211], v120 offset:17408
  ds_read_b64_tr_b16 a[212:213], v120 offset:20480
  ds_read_b64_tr_b16 a[214:215], v120 offset:21504
  ds_read_b64_tr_b16 a[216:217], v121 offset:16384
  ds_read_b64_tr_b16 a[218:219], v121 offset:17408
  ds_read_b64_tr_b16 a[220:221], v121 offset:20480
  ds_read_b64_tr_b16 a[222:223], v121 offset:21504
  s_branch L_lw_38
L_lv_42:
  ds_read_b64_tr_b16 a[160:161], v120 offset:0
  ds_read_b64_tr_b16 a[162:163], v120 offset:1024
  ds_read_b64_tr_b16 a[164:165], v120 offset:4096
  ds_read_b64_tr_b16 a[166:167], v120 offset:5120
  ds_read_b64_tr_b16 a[168:169], v121 offset:0
  ds_read_b64_tr_b16 a[170:171], v121 offset:1024
  ds_read_b64_tr_b16 a[172:173], v121 offset:4096
  ds_read_b64_tr_b16 a[174:175], v121 offset:5120
  ds_read_b64_tr_b16 a[176:177], v120 offset:16384
  ds_read_b64_tr_b16 a[178:179], v120 offset:17408
  ds_read_b64_tr_b16 a[180:181], v120 offset:20480
  ds_read_b64_tr_b16 a[182:183], v120 offset:21504
  ds_read_b64_tr_b16 a[184:185], v121 offset:16384
  ds_read_b64_tr_b16 a[186:187], v121 offset:17408
  ds_read_b64_tr_b16 a[188:189], v121 offset:20480
  ds_read_b64_tr_b16 a[190:191], v121 offset:21504
L_lw_38:
  s_waitcnt lgkmcnt(0)
  s_waitcnt vmcnt(16)
  s_barrier
  s_add_u32 s61, s63, 0
  s_add_u32 m0, s60, 0
  s_add_u32 s62, s61, 0
  buffer_load_dwordx4 v116, s[24:27], s62 offen lds
  s_add_u32 m0, s60, 1024
  s_add_u32 s62, s61, 16384
  buffer_load_dwordx4 v116, s[24:27], s62 offen lds
  s_add_u32 m0, s60, 2048
  s_add_u32 s62, s61, 32768
  buffer_load_dwordx4 v116, s[24:27], s62 offen lds
  s_add_u32 m0, s60, 3072
  s_add_u32 s62, s61, 49152
  buffer_load_dwordx4 v116, s[24:27], s62 offen lds
  s_add_u32 m0, s60, 4096
  s_add_u32 s62, s61, 65536
  buffer_load_dwordx4 v116, s[24:27], s62 offen lds
  s_add_u32 m0, s60, 5120
  s_add_u32 s62, s61, 81920
  buffer_load_dwordx4 v116, s[24:27], s62 offen lds
  s_add_u32 m0, s60, 6144
  s_add_u32 s62, s61, 98304
  buffer_load_dwordx4 v116, s[24:27], s62 offen lds
  s_add_u32 m0, s60, 7168
  s_add_u32 s62, s61, 114688
  buffer_load_dwordx4 v116, s[24:27], s62 offen lds
  s_cmp_eq_u32 s3, 1
  s_cbranch_scc1 L_lv_45
  s_cmp_eq_u32 s3, 2
  s_cbranch_scc1 L_lv_46
  s_cmp_eq_u32 s3, 3
  s_cbranch_scc1 L_lv_47
L_lv_44:
  ds_read_b64_tr_b16 a[160:161], v120 offset:32768
  ds_read_b64_tr_b16 a[162:163], v120 offset:33792
  ds_read_b64_tr_b16 a[164:165], v120 offset:36864
  ds_read_b64_tr_b16 a[166:167], v120 offset:37888
  ds_read_b64_tr_b16 a[168:169], v121 offset:32768
  ds_read_b64_tr_b16 a[170:171], v121 offset:33792
  ds_read_b64_tr_b16 a[172:173], v121 offset:36864
  ds_read_b64_tr_b16 a[174:175], v121 offset:37888
  ds_read_b64_tr_b16 a[176:177], v120 offset:49152
  ds_read_b64_tr_b16 a[178:179], v120 offset:50176
  ds_read_b64_tr_b16 a[180:181], v120 offset:53248
  ds_read_b64_tr_b16 a[182:183], v120 offset:54272
  ds_read_b64_tr_b16 a[184:185], v121 offset:49152
  ds_read_b64_tr_b16 a[186:187], v121 offset:50176
  ds_read_b64_tr_b16 a[188:189], v121 offset:53248
  ds_read_b64_tr_b16 a[190:191], v121 offset:54272
  s_branch L_lw_43
L_lv_45:
  ds_read_b64_tr_b16 a[128:129], v120 offset:32768
  ds_read_b64_tr_b16 a[130:131], v120 offset:33792
  ds_read_b64_tr_b16 a[132:133], v120 offset:36864
  ds_read_b64_tr_b16 a[134:135], v120 offset:37888
  ds_read_b64_tr_b16 a[136:137], v121 offset:32768
  ds_read_b64_tr_b16 a[138:139], v121 offset:33792
  ds_read_b64_tr_b16 a[140:141], v121 offset:36864
  ds_read_b64_tr_b16 a[142:143], v121 offset:37888
  ds_read_b64_tr_b16 a[144:145], v120 offset:49152
  ds_read_b64_tr_b16 a[146:147], v120 offset:50176
  ds_read_b64_tr_b16 a[148:149], v120 offset:53248
  ds_read_b64_tr_b16 a[150:151], v120 offset:54272
  ds_read_b64_tr_b16 a[152:153], v121 offset:49152
  ds_read_b64_tr_b16 a[154:155], v121 offset:50176
  ds_read_b64_tr_b16 a[156:157], v121 offset:53248
  ds_read_b64_tr_b16 a[158:159], v121 offset:54272
  s_branch L_lw_43
L_lv_46:
  ds_read_b64_tr_b16 a[224:225], v120 offset:32768
  ds_read_b64_tr_b16 a[226:227], v120 offset:33792
  ds_read_b64_tr_b16 a[228:229], v120 offset:36864
  ds_read_b64_tr_b16 a[230:231], v120 offset:37888
  ds_read_b64_tr_b16 a[232:233], v121 offset:32768
  ds_read_b64_tr_b16 a[234:235], v121 offset:33792
  ds_read_b64_tr_b16 a[236:237], v121 offset:36864
  ds_read_b64_tr_b16 a[238:239], v121 offset:37888
  ds_read_b64_tr_b16 a[240:241], v120 offset:49152
  ds_read_b64_tr_b16 a[242:243], v120 offset:50176
  ds_read_b64_tr_b16 a[244:245], v120 offset:53248
  ds_read_b64_tr_b16 a[246:247], v120 offset:54272
  ds_read_b64_tr_b16 a[248:249], v121 offset:49152
  ds_read_b64_tr_b16 a[250:251], v121 offset:50176
  ds_read_b64_tr_b16 a[252:253], v121 offset:53248
  ds_read_b64_tr_b16 a[254:255], v121 offset:54272
  s_branch L_lw_43
L_lv_47:
  ds_read_b64_tr_b16 a[192:193], v120 offset:32768
  ds_read_b64_tr_b16 a[194:195], v120 offset:33792
  ds_read_b64_tr_b16 a[196:197], v120 offset:36864
  ds_read_b64_tr_b16 a[198:199], v120 offset:37888
  ds_read_b64_tr_b16 a[200:201], v121 offset:32768
  ds_read_b64_tr_b16 a[202:203], v121 offset:33792
  ds_read_b64_tr_b16 a[204:205], v121 offset:36864
  ds_read_b64_tr_b16 a[206:207], v121 offset:37888
  ds_read_b64_tr_b16 a[208:209], v120 offset:49152
  ds_read_b64_tr_b16 a[210:211], v120 offset:50176
  ds_read_b64_tr_b16 a[212:213], v120 offset:53248
  ds_read_b64_tr_b16 a[214:215], v120 offset:54272
  ds_read_b64_tr_b16 a[216:217], v121 offset:49152
  ds_read_b64_tr_b16 a[218:219], v121 offset:50176
  ds_read_b64_tr_b16 a[220:221], v121 offset:53248
  ds_read_b64_tr_b16 a[222:223], v121 offset:54272
L_lw_43:
  s_waitcnt lgkmcnt(0)
  s_waitcnt vmcnt(16)
  s_barrier
  s_add_u32 s61, s63, 1048576
  s_add_u32 m0, s60, 32768
  s_add_u32 s62, s61, 0
  buffer_load_dwordx4 v116, s[24:27], s62 offen lds
  s_add_u32 m0, s60, 33792
  s_add_u32 s62, s61, 16384
  buffer_load_dwordx4 v116, s[24:27], s62 offen lds
  s_add_u32 m0, s60, 34816
  s_add_u32 s62, s61, 32768
  buffer_load_dwordx4 v116, s[24:27], s62 offen lds
  s_add_u32 m0, s60, 35840
  s_add_u32 s62, s61, 49152
  buffer_load_dwordx4 v116, s[24:27], s62 offen lds
  s_add_u32 m0, s60, 36864
  s_add_u32 s62, s61, 65536
  buffer_load_dwordx4 v116, s[24:27], s62 offen lds
  s_add_u32 m0, s60, 37888
  s_add_u32 s62, s61, 81920
  buffer_load_dwordx4 v116, s[24:27], s62 offen lds
  s_add_u32 m0, s60, 38912
  s_add_u32 s62, s61, 98304
  buffer_load_dwordx4 v116, s[24:27], s62 offen lds
  s_add_u32 m0, s60, 39936
  s_add_u32 s62, s61, 114688
  buffer_load_dwordx4 v116, s[24:27], s62 offen lds
  s_cmp_eq_u32 s3, 1
  s_cbranch_scc1 L_lv_50
  s_cmp_eq_u32 s3, 2
  s_cbranch_scc1 L_lv_51
  s_cmp_eq_u32 s3, 3
  s_cbranch_scc1 L_lv_52
L_lv_49:
  ds_read_b64_tr_b16 a[192:193], v122 offset:0
  ds_read_b64_tr_b16 a[194:195], v122 offset:1024
  ds_read_b64_tr_b16 a[196:197], v122 offset:4096
  ds_read_b64_tr_b16 a[198:199], v122 offset:5120
  ds_read_b64_tr_b16 a[200:201], v123 offset:0
  ds_read_b64_tr_b16 a[202:203], v123 offset:1024
  ds_read_b64_tr_b16 a[204:205], v123 offset:4096
  ds_read_b64_tr_b16 a[206:207], v123 offset:5120
  ds_read_b64_tr_b16 a[208:209], v122 offset:16384
  ds_read_b64_tr_b16 a[210:211], v122 offset:17408
  ds_read_b64_tr_b16 a[212:213], v122 offset:20480
  ds_read_b64_tr_b16 a[214:215], v122 offset:21504
  ds_read_b64_tr_b16 a[216:217], v123 offset:16384
  ds_read_b64_tr_b16 a[218:219], v123 offset:17408
  ds_read_b64_tr_b16 a[220:221], v123 offset:20480
  ds_read_b64_tr_b16 a[222:223], v123 offset:21504
  s_branch L_lw_48
L_lv_50:
  ds_read_b64_tr_b16 a[160:161], v122 offset:0
  ds_read_b64_tr_b16 a[162:163], v122 offset:1024
  ds_read_b64_tr_b16 a[164:165], v122 offset:4096
  ds_read_b64_tr_b16 a[166:167], v122 offset:5120
  ds_read_b64_tr_b16 a[168:169], v123 offset:0
  ds_read_b64_tr_b16 a[170:171], v123 offset:1024
  ds_read_b64_tr_b16 a[172:173], v123 offset:4096
  ds_read_b64_tr_b16 a[174:175], v123 offset:5120
  ds_read_b64_tr_b16 a[176:177], v122 offset:16384
  ds_read_b64_tr_b16 a[178:179], v122 offset:17408
  ds_read_b64_tr_b16 a[180:181], v122 offset:20480
  ds_read_b64_tr_b16 a[182:183], v122 offset:21504
  ds_read_b64_tr_b16 a[184:185], v123 offset:16384
  ds_read_b64_tr_b16 a[186:187], v123 offset:17408
  ds_read_b64_tr_b16 a[188:189], v123 offset:20480
  ds_read_b64_tr_b16 a[190:191], v123 offset:21504
  s_branch L_lw_48
L_lv_51:
  ds_read_b64_tr_b16 a[128:129], v122 offset:0
  ds_read_b64_tr_b16 a[130:131], v122 offset:1024
  ds_read_b64_tr_b16 a[132:133], v122 offset:4096
  ds_read_b64_tr_b16 a[134:135], v122 offset:5120
  ds_read_b64_tr_b16 a[136:137], v123 offset:0
  ds_read_b64_tr_b16 a[138:139], v123 offset:1024
  ds_read_b64_tr_b16 a[140:141], v123 offset:4096
  ds_read_b64_tr_b16 a[142:143], v123 offset:5120
  ds_read_b64_tr_b16 a[144:145], v122 offset:16384
  ds_read_b64_tr_b16 a[146:147], v122 offset:17408
  ds_read_b64_tr_b16 a[148:149], v122 offset:20480
  ds_read_b64_tr_b16 a[150:151], v122 offset:21504
  ds_read_b64_tr_b16 a[152:153], v123 offset:16384
  ds_read_b64_tr_b16 a[154:155], v123 offset:17408
  ds_read_b64_tr_b16 a[156:157], v123 offset:20480
  ds_read_b64_tr_b16 a[158:159], v123 offset:21504
  s_branch L_lw_48
L_lv_52:
  ds_read_b64_tr_b16 a[224:225], v122 offset:0
  ds_read_b64_tr_b16 a[226:227], v122 offset:1024
  ds_read_b64_tr_b16 a[228:229], v122 offset:4096
  ds_read_b64_tr_b16 a[230:231], v122 offset:5120
  ds_read_b64_tr_b16 a[232:233], v123 offset:0
  ds_read_b64_tr_b16 a[234:235], v123 offset:1024
  ds_read_b64_tr_b16 a[236:237], v123 offset:4096
  ds_read_b64_tr_b16 a[238:239], v123 offset:5120
  ds_read_b64_tr_b16 a[240:241], v122 offset:16384
  ds_read_b64_tr_b16 a[242:243], v122 offset:17408
  ds_read_b64_tr_b16 a[244:245], v122 offset:20480
  ds_read_b64_tr_b16 a[246:247], v122 offset:21504
  ds_read_b64_tr_b16 a[248:249], v123 offset:16384
  ds_read_b64_tr_b16 a[250:251], v123 offset:17408
  ds_read_b64_tr_b16 a[252:253], v123 offset:20480
  ds_read_b64_tr_b16 a[254:255], v123 offset:21504
L_lw_48:
  s_waitcnt lgkmcnt(0)
  s_waitcnt vmcnt(16)
  s_barrier
  s_add_u32 s61, s63, 2097152
  s_add_u32 m0, s60, 65536
  s_add_u32 s62, s61, 0
  buffer_load_dwordx4 v116, s[24:27], s62 offen lds
  s_add_u32 m0, s60, 66560
  s_add_u32 s62, s61, 16384
  buffer_load_dwordx4 v116, s[24:27], s62 offen lds
  s_add_u32 m0, s60, 67584
  s_add_u32 s62, s61, 32768
  buffer_load_dwordx4 v116, s[24:27], s62 offen lds
  s_add_u32 m0, s60, 68608
  s_add_u32 s62, s61, 49152
  buffer_load_dwordx4 v116, s[24:27], s62 offen lds
  s_add_u32 m0, s60, 69632
  s_add_u32 s62, s61, 65536
  buffer_load_dwordx4 v116, s[24:27], s62 offen lds
  s_add_u32 m0, s60, 70656
  s_add_u32 s62, s61, 81920
  buffer_load_dwordx4 v116, s[24:27], s62 offen lds
  s_add_u32 m0, s60, 71680
  s_add_u32 s62, s61, 98304
  buffer_load_dwordx4 v116, s[24:27], s62 offen lds
  s_add_u32 m0, s60, 72704
  s_add_u32 s62, s61, 114688
  buffer_load_dwordx4 v116, s[24:27], s62 offen lds
  s_cmp_eq_u32 s3, 1
  s_cbranch_scc1 L_lv_55
  s_cmp_eq_u32 s3, 2
  s_cbranch_scc1 L_lv_56
  s_cmp_eq_u32 s3, 3
  s_cbranch_scc1 L_lv_57
L_lv_54:
  ds_read_b64_tr_b16 a[224:225], v122 offset:32768
  ds_read_b64_tr_b16 a[226:227], v122 offset:33792
  ds_read_b64_tr_b16 a[228:229], v122 offset:36864
  ds_read_b64_tr_b16 a[230:231], v122 offset:37888
  ds_read_b64_tr_b16 a[232:233], v123 offset:32768
  ds_read_b64_tr_b16 a[234:235], v123 offset:33792
  ds_read_b64_tr_b16 a[236:237], v123 offset:36864
  ds_read_b64_tr_b16 a[238:239], v123 offset:37888
  ds_read_b64_tr_b16 a[240:241], v122 offset:49152
  ds_read_b64_tr_b16 a[242:243], v122 offset:50176
  ds_read_b64_tr_b16 a[244:245], v122 offset:53248
  ds_read_b64_tr_b16 a[246:247], v122 offset:54272
  ds_read_b64_tr_b16 a[248:249], v123 offset:49152
  ds_read_b64_tr_b16 a[250:251], v123 offset:50176
  ds_read_b64_tr_b16 a[252:253], v123 offset:53248
  ds_read_b64_tr_b16 a[254:255], v123 offset:54272
  s_branch L_lw_53
L_lv_55:
  ds_read_b64_tr_b16 a[192:193], v122 offset:32768
  ds_read_b64_tr_b16 a[194:195], v122 offset:33792
  ds_read_b64_tr_b16 a[196:197], v122 offset:36864
  ds_read_b64_tr_b16 a[198:199], v122 offset:37888
  ds_read_b64_tr_b16 a[200:201], v123 offset:32768
  ds_read_b64_tr_b16 a[202:203], v123 offset:33792
  ds_read_b64_tr_b16 a[204:205], v123 offset:36864
  ds_read_b64_tr_b16 a[206:207], v123 offset:37888
  ds_read_b64_tr_b16 a[208:209], v122 offset:49152
  ds_read_b64_tr_b16 a[210:211], v122 offset:50176
  ds_read_b64_tr_b16 a[212:213], v122 offset:53248
  ds_read_b64_tr_b16 a[214:215], v122 offset:54272
  ds_read_b64_tr_b16 a[216:217], v123 offset:49152
  ds_read_b64_tr_b16 a[218:219], v123 offset:50176
  ds_read_b64_tr_b16 a[220:221], v123 offset:53248
  ds_read_b64_tr_b16 a[222:223], v123 offset:54272
  s_branch L_lw_53
L_lv_56:
  ds_read_b64_tr_b16 a[160:161], v122 offset:32768
  ds_read_b64_tr_b16 a[162:163], v122 offset:33792
  ds_read_b64_tr_b16 a[164:165], v122 offset:36864
  ds_read_b64_tr_b16 a[166:167], v122 offset:37888
  ds_read_b64_tr_b16 a[168:169], v123 offset:32768
  ds_read_b64_tr_b16 a[170:171], v123 offset:33792
  ds_read_b64_tr_b16 a[172:173], v123 offset:36864
  ds_read_b64_tr_b16 a[174:175], v123 offset:37888
  ds_read_b64_tr_b16 a[176:177], v122 offset:49152
  ds_read_b64_tr_b16 a[178:179], v122 offset:50176
  ds_read_b64_tr_b16 a[180:181], v122 offset:53248
  ds_read_b64_tr_b16 a[182:183], v122 offset:54272
  ds_read_b64_tr_b16 a[184:185], v123 offset:49152
  ds_read_b64_tr_b16 a[186:187], v123 offset:50176
  ds_read_b64_tr_b16 a[188:189], v123 offset:53248
  ds_read_b64_tr_b16 a[190:191], v123 offset:54272
  s_branch L_lw_53
L_lv_57:
  ds_read_b64_tr_b16 a[128:129], v122 offset:32768
  ds_read_b64_tr_b16 a[130:131], v122 offset:33792
  ds_read_b64_tr_b16 a[132:133], v122 offset:36864
  ds_read_b64_tr_b16 a[134:135], v122 offset:37888
  ds_read_b64_tr_b16 a[136:137], v123 offset:32768
  ds_read_b64_tr_b16 a[138:139], v123 offset:33792
  ds_read_b64_tr_b16 a[140:141], v123 offset:36864
  ds_read_b64_tr_b16 a[142:143], v123 offset:37888
  ds_read_b64_tr_b16 a[144:145], v122 offset:49152
  ds_read_b64_tr_b16 a[146:147], v122 offset:50176
  ds_read_b64_tr_b16 a[148:149], v122 offset:53248
  ds_read_b64_tr_b16 a[150:151], v122 offset:54272
  ds_read_b64_tr_b16 a[152:153], v123 offset:49152
  ds_read_b64_tr_b16 a[154:155], v123 offset:50176
  ds_read_b64_tr_b16 a[156:157], v123 offset:53248
  ds_read_b64_tr_b16 a[158:159], v123 offset:54272
L_lw_53:
  s_waitcnt lgkmcnt(0)
  s_waitcnt vmcnt(16)
  s_barrier
  s_add_u32 s61, s63, 3145728
  s_add_u32 m0, s60, 98304
  s_add_u32 s62, s61, 0
  buffer_load_dwordx4 v116, s[24:27], s62 offen lds
  s_add_u32 m0, s60, 99328
  s_add_u32 s62, s61, 16384
  buffer_load_dwordx4 v116, s[24:27], s62 offen lds
  s_add_u32 m0, s60, 100352
  s_add_u32 s62, s61, 32768
  buffer_load_dwordx4 v116, s[24:27], s62 offen lds
  s_add_u32 m0, s60, 101376
  s_add_u32 s62, s61, 49152
  buffer_load_dwordx4 v116, s[24:27], s62 offen lds
  s_add_u32 m0, s60, 102400
  s_add_u32 s62, s61, 65536
  buffer_load_dwordx4 v116, s[24:27], s62 offen lds
  s_add_u32 m0, s60, 103424
  s_add_u32 s62, s61, 81920
  buffer_load_dwordx4 v116, s[24:27], s62 offen lds
  s_add_u32 m0, s60, 104448
  s_add_u32 s62, s61, 98304
  buffer_load_dwordx4 v116, s[24:27], s62 offen lds
  s_add_u32 m0, s60, 105472
  s_add_u32 s62, s61, 114688
  buffer_load_dwordx4 v116, s[24:27], s62 offen lds
  s_mov_b32 s16, s80
  s_mov_b32 s17, s81
  s_mov_b32 s18, 0x2000
  s_mov_b32 s19, 0x20000
  v_and_b32 v16, 15, v0
  v_lshrrev_b32 v17, 1, v16
  v_lshlrev_b32 v17, 10, v17
  v_and_b32 v18, 1, v0
  v_lshl_or_b32 v17, v18, 6, v17
  v_lshrrev_b32 v19, 4, v0
  v_lshl_or_b32 v17, v19, 3, v17
  s_lshl_b32 s6, s3, 8
  buffer_load_dwordx2 v[84:85], v17, s[16:19], s6 offen offset:0
  buffer_load_dwordx2 v[86:87], v17, s[16:19], s6 offen offset:32
  buffer_load_dwordx2 v[88:89], v17, s[16:19], s6 offen offset:128
  buffer_load_dwordx2 v[90:91], v17, s[16:19], s6 offen offset:160
  v_mov_b32 v19, 0x4444
  v_mov_b32 v16, 0xeeee
  v_cmp_eq_u32 vcc, 0, v18
  s_nop 1
  v_cndmask_b32 v0, v16, v19, vcc
  v_mbcnt_lo_u32_b32 v16, -1, 0
  v_and_b32 v16, 3, v16
  v_lshlrev_b32 v16, 6, v16
  buffer_load_dword v17, v16, s[12:15], 0 offen offset:16 sc1
  s_cmp_eq_u32 s3, 1
  s_cbranch_scc1 L_lv_60
  s_cmp_eq_u32 s3, 2
  s_cbranch_scc1 L_lv_61
  s_cmp_eq_u32 s3, 3
  s_cbranch_scc1 L_lv_62
L_lv_59:
  ds_read_b64_tr_b16 v[128:129], v120 offset:0
  ds_read_b64_tr_b16 v[130:131], v120 offset:1024
  ds_read_b64_tr_b16 v[132:133], v120 offset:4096
  ds_read_b64_tr_b16 v[134:135], v120 offset:5120
  ds_read_b64_tr_b16 v[136:137], v121 offset:0
  ds_read_b64_tr_b16 v[138:139], v121 offset:1024
  ds_read_b64_tr_b16 v[140:141], v121 offset:4096
  ds_read_b64_tr_b16 v[142:143], v121 offset:5120
  ds_read_b64_tr_b16 v[144:145], v120 offset:16384
  ds_read_b64_tr_b16 v[146:147], v120 offset:17408
  ds_read_b64_tr_b16 v[148:149], v120 offset:20480
  ds_read_b64_tr_b16 v[150:151], v120 offset:21504
  ds_read_b64_tr_b16 v[152:153], v121 offset:16384
  ds_read_b64_tr_b16 v[154:155], v121 offset:17408
  ds_read_b64_tr_b16 v[156:157], v121 offset:20480
  ds_read_b64_tr_b16 v[158:159], v121 offset:21504
  s_branch L_lw_58
L_lv_60:
  ds_read_b64_tr_b16 v[224:225], v120 offset:0
  ds_read_b64_tr_b16 v[226:227], v120 offset:1024
  ds_read_b64_tr_b16 v[228:229], v120 offset:4096
  ds_read_b64_tr_b16 v[230:231], v120 offset:5120
  ds_read_b64_tr_b16 v[232:233], v121 offset:0
  ds_read_b64_tr_b16 v[234:235], v121 offset:1024
  ds_read_b64_tr_b16 v[236:237], v121 offset:4096
  ds_read_b64_tr_b16 v[238:239], v121 offset:5120
  ds_read_b64_tr_b16 v[240:241], v120 offset:16384
  ds_read_b64_tr_b16 v[242:243], v120 offset:17408
  ds_read_b64_tr_b16 v[244:245], v120 offset:20480
  ds_read_b64_tr_b16 v[246:247], v120 offset:21504
  ds_read_b64_tr_b16 v[248:249], v121 offset:16384
  ds_read_b64_tr_b16 v[250:251], v121 offset:17408
  ds_read_b64_tr_b16 v[252:253], v121 offset:20480
  ds_read_b64_tr_b16 v[254:255], v121 offset:21504
  s_branch L_lw_58
L_lv_61:
  ds_read_b64_tr_b16 v[192:193], v120 offset:0
  ds_read_b64_tr_b16 v[194:195], v120 offset:1024
  ds_read_b64_tr_b16 v[196:197], v120 offset:4096
  ds_read_b64_tr_b16 v[198:199], v120 offset:5120
  ds_read_b64_tr_b16 v[200:201], v121 offset:0
  ds_read_b64_tr_b16 v[202:203], v121 offset:1024
  ds_read_b64_tr_b16 v[204:205], v121 offset:4096
  ds_read_b64_tr_b16 v[206:207], v121 offset:5120
  ds_read_b64_tr_b16 v[208:209], v120 offset:16384
  ds_read_b64_tr_b16 v[210:211], v120 offset:17408
  ds_read_b64_tr_b16 v[212:213], v120 offset:20480
  ds_read_b64_tr_b16 v[214:215], v120 offset:21504
  ds_read_b64_tr_b16 v[216:217], v121 offset:16384
  ds_read_b64_tr_b16 v[218:219], v121 offset:17408
  ds_read_b64_tr_b16 v[220:221], v121 offset:20480
  ds_read_b64_tr_b16 v[222:223], v121 offset:21504
  s_branch L_lw_58
L_lv_62:
  ds_read_b64_tr_b16 v[160:161], v120 offset:0
  ds_read_b64_tr_b16 v[162:163], v120 offset:1024
  ds_read_b64_tr_b16 v[164:165], v120 offset:4096
  ds_read_b64_tr_b16 v[166:167], v120 offset:5120
  ds_read_b64_tr_b16 v[168:169], v121 offset:0
  ds_read_b64_tr_b16 v[170:171], v121 offset:1024
  ds_read_b64_tr_b16 v[172:173], v121 offset:4096
  ds_read_b64_tr_b16 v[174:175], v121 offset:5120
  ds_read_b64_tr_b16 v[176:177], v120 offset:16384
  ds_read_b64_tr_b16 v[178:179], v120 offset:17408
  ds_read_b64_tr_b16 v[180:181], v120 offset:20480
  ds_read_b64_tr_b16 v[182:183], v120 offset:21504
  ds_read_b64_tr_b16 v[184:185], v121 offset:16384
  ds_read_b64_tr_b16 v[186:187], v121 offset:17408
  ds_read_b64_tr_b16 v[188:189], v121 offset:20480
  ds_read_b64_tr_b16 v[190:191], v121 offset:21504
L_lw_58:
  s_waitcnt lgkmcnt(0)
  s_waitcnt vmcnt(16)
  s_barrier
  s_lshl_b32 s61, s5, 17
  s_lshl_b32 s62, s3, 15
  s_add_u32 s61, s61, s62
  s_add_u32 s61, s61, 0
  s_add_u32 m0, s60, 0
  s_add_u32 s62, s61, 0
  buffer_load_dwordx4 v118, s[28:31], s62 offen lds
  s_add_u32 m0, s60, 1024
  s_add_u32 s62, s61, 4096
  buffer_load_dwordx4 v118, s[28:31], s62 offen lds
  s_add_u32 m0, s60, 2048
  s_add_u32 s62, s61, 8192
  buffer_load_dwordx4 v119, s[28:31], s62 offen lds
  s_add_u32 m0, s60, 3072
  s_add_u32 s62, s61, 12288
  buffer_load_dwordx4 v119, s[28:31], s62 offen lds
  s_add_u32 m0, s60, 4096
  s_add_u32 s62, s61, 16384
  buffer_load_dwordx4 v118, s[28:31], s62 offen lds
  s_add_u32 m0, s60, 5120
  s_add_u32 s62, s61, 20480
  buffer_load_dwordx4 v118, s[28:31], s62 offen lds
  s_add_u32 m0, s60, 6144
  s_add_u32 s62, s61, 24576
  buffer_load_dwordx4 v119, s[28:31], s62 offen lds
  s_add_u32 m0, s60, 7168
  s_add_u32 s62, s61, 28672
  buffer_load_dwordx4 v119, s[28:31], s62 offen lds
  s_cmp_eq_u32 s3, 1
  s_cbranch_scc1 L_lv_65
  s_cmp_eq_u32 s3, 2
  s_cbranch_scc1 L_lv_66
  s_cmp_eq_u32 s3, 3
  s_cbranch_scc1 L_lv_67
L_lv_64:
  ds_read_b64_tr_b16 v[160:161], v120 offset:32768
  ds_read_b64_tr_b16 v[162:163], v120 offset:33792
  ds_read_b64_tr_b16 v[164:165], v120 offset:36864
  ds_read_b64_tr_b16 v[166:167], v120 offset:37888
  ds_read_b64_tr_b16 v[168:169], v121 offset:32768
  ds_read_b64_tr_b16 v[170:171], v121 offset:33792
  ds_read_b64_tr_b16 v[172:173], v121 offset:36864
  ds_read_b64_tr_b16 v[174:175], v121 offset:37888
  ds_read_b64_tr_b16 v[176:177], v120 offset:49152
  ds_read_b64_tr_b16 v[178:179], v120 offset:50176
  ds_read_b64_tr_b16 v[180:181], v120 offset:53248
  ds_read_b64_tr_b16 v[182:183], v120 offset:54272
  ds_read_b64_tr_b16 v[184:185], v121 offset:49152
  ds_read_b64_tr_b16 v[186:187], v121 offset:50176
  ds_read_b64_tr_b16 v[188:189], v121 offset:53248
  ds_read_b64_tr_b16 v[190:191], v121 offset:54272
  s_branch L_lw_63
L_lv_65:
  ds_read_b64_tr_b16 v[128:129], v120 offset:32768
  ds_read_b64_tr_b16 v[130:131], v120 offset:33792
  ds_read_b64_tr_b16 v[132:133], v120 offset:36864
  ds_read_b64_tr_b16 v[134:135], v120 offset:37888
  ds_read_b64_tr_b16 v[136:137], v121 offset:32768
  ds_read_b64_tr_b16 v[138:139], v121 offset:33792
  ds_read_b64_tr_b16 v[140:141], v121 offset:36864
  ds_read_b64_tr_b16 v[142:143], v121 offset:37888
  ds_read_b64_tr_b16 v[144:145], v120 offset:49152
  ds_read_b64_tr_b16 v[146:147], v120 offset:50176
  ds_read_b64_tr_b16 v[148:149], v120 offset:53248
  ds_read_b64_tr_b16 v[150:151], v120 offset:54272
  ds_read_b64_tr_b16 v[152:153], v121 offset:49152
  ds_read_b64_tr_b16 v[154:155], v121 offset:50176
  ds_read_b64_tr_b16 v[156:157], v121 offset:53248
  ds_read_b64_tr_b16 v[158:159], v121 offset:54272
  s_branch L_lw_63
L_lv_66:
  ds_read_b64_tr_b16 v[224:225], v120 offset:32768
  ds_read_b64_tr_b16 v[226:227], v120 offset:33792
  ds_read_b64_tr_b16 v[228:229], v120 offset:36864
  ds_read_b64_tr_b16 v[230:231], v120 offset:37888
  ds_read_b64_tr_b16 v[232:233], v121 offset:32768
  ds_read_b64_tr_b16 v[234:235], v121 offset:33792
  ds_read_b64_tr_b16 v[236:237], v121 offset:36864
  ds_read_b64_tr_b16 v[238:239], v121 offset:37888
  ds_read_b64_tr_b16 v[240:241], v120 offset:49152
  ds_read_b64_tr_b16 v[242:243], v120 offset:50176
  ds_read_b64_tr_b16 v[244:245], v120 offset:53248
  ds_read_b64_tr_b16 v[246:247], v120 offset:54272
  ds_read_b64_tr_b16 v[248:249], v121 offset:49152
  ds_read_b64_tr_b16 v[250:251], v121 offset:50176
  ds_read_b64_tr_b16 v[252:253], v121 offset:53248
  ds_read_b64_tr_b16 v[254:255], v121 offset:54272
  s_branch L_lw_63
L_lv_67:
  ds_read_b64_tr_b16 v[192:193], v120 offset:32768
  ds_read_b64_tr_b16 v[194:195], v120 offset:33792
  ds_read_b64_tr_b16 v[196:197], v120 offset:36864
  ds_read_b64_tr_b16 v[198:199], v120 offset:37888
  ds_read_b64_tr_b16 v[200:201], v121 offset:32768
  ds_read_b64_tr_b16 v[202:203], v121 offset:33792
  ds_read_b64_tr_b16 v[204:205], v121 offset:36864
  ds_read_b64_tr_b16 v[206:207], v121 offset:37888
  ds_read_b64_tr_b16 v[208:209], v120 offset:49152
  ds_read_b64_tr_b16 v[210:211], v120 offset:50176
  ds_read_b64_tr_b16 v[212:213], v120 offset:53248
  ds_read_b64_tr_b16 v[214:215], v120 offset:54272
  ds_read_b64_tr_b16 v[216:217], v121 offset:49152
  ds_read_b64_tr_b16 v[218:219], v121 offset:50176
  ds_read_b64_tr_b16 v[220:221], v121 offset:53248
  ds_read_b64_tr_b16 v[222:223], v121 offset:54272
L_lw_63:
  s_waitcnt lgkmcnt(0)
  s_waitcnt vmcnt(16)
  s_barrier
  s_lshl_b32 s61, s5, 17
  s_lshl_b32 s62, s3, 15
  s_add_u32 s61, s61, s62
  s_add_u32 s61, s61, 256
  s_add_u32 m0, s60, 32768
  s_add_u32 s62, s61, 0
  buffer_load_dwordx4 v118, s[28:31], s62 offen lds
  s_add_u32 m0, s60, 33792
  s_add_u32 s62, s61, 4096
  buffer_load_dwordx4 v118, s[28:31], s62 offen lds
  s_add_u32 m0, s60, 34816
  s_add_u32 s62, s61, 8192
  buffer_load_dwordx4 v119, s[28:31], s62 offen lds
  s_add_u32 m0, s60, 35840
  s_add_u32 s62, s61, 12288
  buffer_load_dwordx4 v119, s[28:31], s62 offen lds
  s_add_u32 m0, s60, 36864
  s_add_u32 s62, s61, 16384
  buffer_load_dwordx4 v118, s[28:31], s62 offen lds
  s_add_u32 m0, s60, 37888
  s_add_u32 s62, s61, 20480
  buffer_load_dwordx4 v118, s[28:31], s62 offen lds
  s_add_u32 m0, s60, 38912
  s_add_u32 s62, s61, 24576
  buffer_load_dwordx4 v119, s[28:31], s62 offen lds
  s_add_u32 m0, s60, 39936
  s_add_u32 s62, s61, 28672
  buffer_load_dwordx4 v119, s[28:31], s62 offen lds
  s_cmp_eq_u32 s3, 1
  s_cbranch_scc1 L_lv_70
  s_cmp_eq_u32 s3, 2
  s_cbranch_scc1 L_lv_71
  s_cmp_eq_u32 s3, 3
  s_cbranch_scc1 L_lv_72
L_lv_69:
  ds_read_b64_tr_b16 v[192:193], v122 offset:0
  ds_read_b64_tr_b16 v[194:195], v122 offset:1024
  ds_read_b64_tr_b16 v[196:197], v122 offset:4096
  ds_read_b64_tr_b16 v[198:199], v122 offset:5120
  ds_read_b64_tr_b16 v[200:201], v123 offset:0
  ds_read_b64_tr_b16 v[202:203], v123 offset:1024
  ds_read_b64_tr_b16 v[204:205], v123 offset:4096
  ds_read_b64_tr_b16 v[206:207], v123 offset:5120
  ds_read_b64_tr_b16 v[208:209], v122 offset:16384
  ds_read_b64_tr_b16 v[210:211], v122 offset:17408
  ds_read_b64_tr_b16 v[212:213], v122 offset:20480
  ds_read_b64_tr_b16 v[214:215], v122 offset:21504
  ds_read_b64_tr_b16 v[216:217], v123 offset:16384
  ds_read_b64_tr_b16 v[218:219], v123 offset:17408
  ds_read_b64_tr_b16 v[220:221], v123 offset:20480
  ds_read_b64_tr_b16 v[222:223], v123 offset:21504
  s_branch L_lw_68
L_lv_70:
  ds_read_b64_tr_b16 v[160:161], v122 offset:0
  ds_read_b64_tr_b16 v[162:163], v122 offset:1024
  ds_read_b64_tr_b16 v[164:165], v122 offset:4096
  ds_read_b64_tr_b16 v[166:167], v122 offset:5120
  ds_read_b64_tr_b16 v[168:169], v123 offset:0
  ds_read_b64_tr_b16 v[170:171], v123 offset:1024
  ds_read_b64_tr_b16 v[172:173], v123 offset:4096
  ds_read_b64_tr_b16 v[174:175], v123 offset:5120
  ds_read_b64_tr_b16 v[176:177], v122 offset:16384
  ds_read_b64_tr_b16 v[178:179], v122 offset:17408
  ds_read_b64_tr_b16 v[180:181], v122 offset:20480
  ds_read_b64_tr_b16 v[182:183], v122 offset:21504
  ds_read_b64_tr_b16 v[184:185], v123 offset:16384
  ds_read_b64_tr_b16 v[186:187], v123 offset:17408
  ds_read_b64_tr_b16 v[188:189], v123 offset:20480
  ds_read_b64_tr_b16 v[190:191], v123 offset:21504
  s_branch L_lw_68
L_lv_71:
  ds_read_b64_tr_b16 v[128:129], v122 offset:0
  ds_read_b64_tr_b16 v[130:131], v122 offset:1024
  ds_read_b64_tr_b16 v[132:133], v122 offset:4096
  ds_read_b64_tr_b16 v[134:135], v122 offset:5120
  ds_read_b64_tr_b16 v[136:137], v123 offset:0
  ds_read_b64_tr_b16 v[138:139], v123 offset:1024
  ds_read_b64_tr_b16 v[140:141], v123 offset:4096
  ds_read_b64_tr_b16 v[142:143], v123 offset:5120
  ds_read_b64_tr_b16 v[144:145], v122 offset:16384
  ds_read_b64_tr_b16 v[146:147], v122 offset:17408
  ds_read_b64_tr_b16 v[148:149], v122 offset:20480
  ds_read_b64_tr_b16 v[150:151], v122 offset:21504
  ds_read_b64_tr_b16 v[152:153], v123 offset:16384
  ds_read_b64_tr_b16 v[154:155], v123 offset:17408
  ds_read_b64_tr_b16 v[156:157], v123 offset:20480
  ds_read_b64_tr_b16 v[158:159], v123 offset:21504
  s_branch L_lw_68
L_lv_72:
  ds_read_b64_tr_b16 v[224:225], v122 offset:0
  ds_read_b64_tr_b16 v[226:227], v122 offset:1024
  ds_read_b64_tr_b16 v[228:229], v122 offset:4096
  ds_read_b64_tr_b16 v[230:231], v122 offset:5120
  ds_read_b64_tr_b16 v[232:233], v123 offset:0
  ds_read_b64_tr_b16 v[234:235], v123 offset:1024
  ds_read_b64_tr_b16 v[236:237], v123 offset:4096
  ds_read_b64_tr_b16 v[238:239], v123 offset:5120
  ds_read_b64_tr_b16 v[240:241], v122 offset:16384
  ds_read_b64_tr_b16 v[242:243], v122 offset:17408
  ds_read_b64_tr_b16 v[244:245], v122 offset:20480
  ds_read_b64_tr_b16 v[246:247], v122 offset:21504
  ds_read_b64_tr_b16 v[248:249], v123 offset:16384
  ds_read_b64_tr_b16 v[250:251], v123 offset:17408
  ds_read_b64_tr_b16 v[252:253], v123 offset:20480
  ds_read_b64_tr_b16 v[254:255], v123 offset:21504
L_lw_68:
  s_waitcnt lgkmcnt(0)
  s_waitcnt vmcnt(16)
  s_barrier
  s_lshl_b32 s61, s5, 17
  s_lshl_b32 s62, s3, 15
  s_add_u32 s61, s61, s62
  s_add_u32 s61, s61, 512
  s_add_u32 m0, s60, 65536
  s_add_u32 s62, s61, 0
  buffer_load_dwordx4 v118, s[28:31], s62 offen lds
  s_add_u32 m0, s60, 66560
  s_add_u32 s62, s61, 4096
  buffer_load_dwordx4 v118, s[28:31], s62 offen lds
  s_add_u32 m0, s60, 67584
  s_add_u32 s62, s61, 8192
  buffer_load_dwordx4 v119, s[28:31], s62 offen lds
  s_add_u32 m0, s60, 68608
  s_add_u32 s62, s61, 12288
  buffer_load_dwordx4 v119, s[28:31], s62 offen lds
  s_add_u32 m0, s60, 69632
  s_add_u32 s62, s61, 16384
  buffer_load_dwordx4 v118, s[28:31], s62 offen lds
  s_add_u32 m0, s60, 70656
  s_add_u32 s62, s61, 20480
  buffer_load_dwordx4 v118, s[28:31], s62 offen lds
  s_add_u32 m0, s60, 71680
  s_add_u32 s62, s61, 24576
  buffer_load_dwordx4 v119, s[28:31], s62 offen lds
  s_add_u32 m0, s60, 72704
  s_add_u32 s62, s61, 28672
  buffer_load_dwordx4 v119, s[28:31], s62 offen lds
  s_cmp_eq_u32 s3, 1
  s_cbranch_scc1 L_lv_75
  s_cmp_eq_u32 s3, 2
  s_cbranch_scc1 L_lv_76
  s_cmp_eq_u32 s3, 3
  s_cbranch_scc1 L_lv_77
L_lv_74:
  ds_read_b64_tr_b16 v[224:225], v122 offset:32768
  ds_read_b64_tr_b16 v[226:227], v122 offset:33792
  ds_read_b64_tr_b16 v[228:229], v122 offset:36864
  ds_read_b64_tr_b16 v[230:231], v122 offset:37888
  ds_read_b64_tr_b16 v[232:233], v123 offset:32768
  ds_read_b64_tr_b16 v[234:235], v123 offset:33792
  ds_read_b64_tr_b16 v[236:237], v123 offset:36864
  ds_read_b64_tr_b16 v[238:239], v123 offset:37888
  ds_read_b64_tr_b16 v[240:241], v122 offset:49152
  ds_read_b64_tr_b16 v[242:243], v122 offset:50176
  ds_read_b64_tr_b16 v[244:245], v122 offset:53248
  ds_read_b64_tr_b16 v[246:247], v122 offset:54272
  ds_read_b64_tr_b16 v[248:249], v123 offset:49152
  ds_read_b64_tr_b16 v[250:251], v123 offset:50176
  ds_read_b64_tr_b16 v[252:253], v123 offset:53248
  ds_read_b64_tr_b16 v[254:255], v123 offset:54272
  s_branch L_lw_73
L_lv_75:
  ds_read_b64_tr_b16 v[192:193], v122 offset:32768
  ds_read_b64_tr_b16 v[194:195], v122 offset:33792
  ds_read_b64_tr_b16 v[196:197], v122 offset:36864
  ds_read_b64_tr_b16 v[198:199], v122 offset:37888
  ds_read_b64_tr_b16 v[200:201], v123 offset:32768
  ds_read_b64_tr_b16 v[202:203], v123 offset:33792
  ds_read_b64_tr_b16 v[204:205], v123 offset:36864
  ds_read_b64_tr_b16 v[206:207], v123 offset:37888
  ds_read_b64_tr_b16 v[208:209], v122 offset:49152
  ds_read_b64_tr_b16 v[210:211], v122 offset:50176
  ds_read_b64_tr_b16 v[212:213], v122 offset:53248
  ds_read_b64_tr_b16 v[214:215], v122 offset:54272
  ds_read_b64_tr_b16 v[216:217], v123 offset:49152
  ds_read_b64_tr_b16 v[218:219], v123 offset:50176
  ds_read_b64_tr_b16 v[220:221], v123 offset:53248
  ds_read_b64_tr_b16 v[222:223], v123 offset:54272
  s_branch L_lw_73
L_lv_76:
  ds_read_b64_tr_b16 v[160:161], v122 offset:32768
  ds_read_b64_tr_b16 v[162:163], v122 offset:33792
  ds_read_b64_tr_b16 v[164:165], v122 offset:36864
  ds_read_b64_tr_b16 v[166:167], v122 offset:37888
  ds_read_b64_tr_b16 v[168:169], v123 offset:32768
  ds_read_b64_tr_b16 v[170:171], v123 offset:33792
  ds_read_b64_tr_b16 v[172:173], v123 offset:36864
  ds_read_b64_tr_b16 v[174:175], v123 offset:37888
  ds_read_b64_tr_b16 v[176:177], v122 offset:49152
  ds_read_b64_tr_b16 v[178:179], v122 offset:50176
  ds_read_b64_tr_b16 v[180:181], v122 offset:53248
  ds_read_b64_tr_b16 v[182:183], v122 offset:54272
  ds_read_b64_tr_b16 v[184:185], v123 offset:49152
  ds_read_b64_tr_b16 v[186:187], v123 offset:50176
  ds_read_b64_tr_b16 v[188:189], v123 offset:53248
  ds_read_b64_tr_b16 v[190:191], v123 offset:54272
  s_branch L_lw_73
L_lv_77:
  ds_read_b64_tr_b16 v[128:129], v122 offset:32768
  ds_read_b64_tr_b16 v[130:131], v122 offset:33792
  ds_read_b64_tr_b16 v[132:133], v122 offset:36864
  ds_read_b64_tr_b16 v[134:135], v122 offset:37888
  ds_read_b64_tr_b16 v[136:137], v123 offset:32768
  ds_read_b64_tr_b16 v[138:139], v123 offset:33792
  ds_read_b64_tr_b16 v[140:141], v123 offset:36864
  ds_read_b64_tr_b16 v[142:143], v123 offset:37888
  ds_read_b64_tr_b16 v[144:145], v122 offset:49152
  ds_read_b64_tr_b16 v[146:147], v122 offset:50176
  ds_read_b64_tr_b16 v[148:149], v122 offset:53248
  ds_read_b64_tr_b16 v[150:151], v122 offset:54272
  ds_read_b64_tr_b16 v[152:153], v123 offset:49152
  ds_read_b64_tr_b16 v[154:155], v123 offset:50176
  ds_read_b64_tr_b16 v[156:157], v123 offset:53248
  ds_read_b64_tr_b16 v[158:159], v123 offset:54272
L_lw_73:
  s_waitcnt lgkmcnt(0)
  s_waitcnt vmcnt(16)
  s_barrier
  s_lshl_b32 s61, s5, 17
  s_lshl_b32 s62, s3, 15
  s_add_u32 s61, s61, s62
  s_add_u32 s61, s61, 768
  s_add_u32 m0, s60, 98304
  s_add_u32 s62, s61, 0
  buffer_load_dwordx4 v118, s[28:31], s62 offen lds
  s_add_u32 m0, s60, 99328
  s_add_u32 s62, s61, 4096
  buffer_load_dwordx4 v118, s[28:31], s62 offen lds
  s_add_u32 m0, s60, 100352
  s_add_u32 s62, s61, 8192
  buffer_load_dwordx4 v119, s[28:31], s62 offen lds
  s_add_u32 m0, s60, 101376
  s_add_u32 s62, s61, 12288
  buffer_load_dwordx4 v119, s[28:31], s62 offen lds
  s_add_u32 m0, s60, 102400
  s_add_u32 s62, s61, 16384
  buffer_load_dwordx4 v118, s[28:31], s62 offen lds
  s_add_u32 m0, s60, 103424
  s_add_u32 s62, s61, 20480
  buffer_load_dwordx4 v118, s[28:31], s62 offen lds
  s_add_u32 m0, s60, 104448
  s_add_u32 s62, s61, 24576
  buffer_load_dwordx4 v119, s[28:31], s62 offen lds
  s_add_u32 m0, s60, 105472
  s_add_u32 s62, s61, 28672
  buffer_load_dwordx4 v119, s[28:31], s62 offen lds
  v_xor_b32 v126, 0, v124
  ds_read_b64_tr_b16 v[20:21], v126 offset:0
  ds_read_b64_tr_b16 v[22:23], v126 offset:1024
  v_xor_b32 v126, 32, v124
  ds_read_b64_tr_b16 v[24:25], v126 offset:0
  ds_read_b64_tr_b16 v[26:27], v126 offset:1024
  v_xor_b32 v126, 64, v124
  ds_read_b64_tr_b16 v[28:29], v126 offset:0
  ds_read_b64_tr_b16 v[30:31], v126 offset:1024
  v_xor_b32 v126, 96, v124
  ds_read_b64_tr_b16 v[32:33], v126 offset:0
  ds_read_b64_tr_b16 v[34:35], v126 offset:1024
  v_xor_b32 v126, 128, v124
  ds_read_b64_tr_b16 v[36:37], v126 offset:0
  ds_read_b64_tr_b16 v[38:39], v126 offset:1024
  v_xor_b32 v126, 160, v124
  ds_read_b64_tr_b16 v[40:41], v126 offset:0
  ds_read_b64_tr_b16 v[42:43], v126 offset:1024
  v_xor_b32 v126, 192, v124
  ds_read_b64_tr_b16 v[44:45], v126 offset:0
  ds_read_b64_tr_b16 v[46:47], v126 offset:1024
  v_xor_b32 v126, 224, v124
  ds_read_b64_tr_b16 v[48:49], v126 offset:0
  ds_read_b64_tr_b16 v[50:51], v126 offset:1024
  s_waitcnt lgkmcnt(0)
  ds_write_b128 v127, v[20:23] offset:0
  ds_write_b128 v127, v[24:27] offset:1024
  ds_write_b128 v127, v[28:31] offset:2048
  ds_write_b128 v127, v[32:35] offset:3072
  ds_write_b128 v127, v[36:39] offset:4096
  ds_write_b128 v127, v[40:43] offset:5120
  ds_write_b128 v127, v[44:47] offset:6144
  ds_write_b128 v127, v[48:51] offset:7168
  s_waitcnt lgkmcnt(0)
  v_add_u32 v124, 0x8000, v124
  v_add_u32 v127, 0x8000, v127
  s_waitcnt vmcnt(16)
  v_xor_b32 v126, 0, v124
  ds_read_b64_tr_b16 v[20:21], v126 offset:0
  ds_read_b64_tr_b16 v[22:23], v126 offset:1024
  v_xor_b32 v126, 32, v124
  ds_read_b64_tr_b16 v[24:25], v126 offset:0
  ds_read_b64_tr_b16 v[26:27], v126 offset:1024
  v_xor_b32 v126, 64, v124
  ds_read_b64_tr_b16 v[28:29], v126 offset:0
  ds_read_b64_tr_b16 v[30:31], v126 offset:1024
  v_xor_b32 v126, 96, v124
  ds_read_b64_tr_b16 v[32:33], v126 offset:0
  ds_read_b64_tr_b16 v[34:35], v126 offset:1024
  v_xor_b32 v126, 128, v124
  ds_read_b64_tr_b16 v[36:37], v126 offset:0
  ds_read_b64_tr_b16 v[38:39], v126 offset:1024
  v_xor_b32 v126, 160, v124
  ds_read_b64_tr_b16 v[40:41], v126 offset:0
  ds_read_b64_tr_b16 v[42:43], v126 offset:1024
  v_xor_b32 v126, 192, v124
  ds_read_b64_tr_b16 v[44:45], v126 offset:0
  ds_read_b64_tr_b16 v[46:47], v126 offset:1024
  v_xor_b32 v126, 224, v124
  ds_read_b64_tr_b16 v[48:49], v126 offset:0
  ds_read_b64_tr_b16 v[50:51], v126 offset:1024
  s_waitcnt lgkmcnt(0)
  ds_write_b128 v127, v[20:23] offset:0
  ds_write_b128 v127, v[24:27] offset:1024
  ds_write_b128 v127, v[28:31] offset:2048
  ds_write_b128 v127, v[32:35] offset:3072
  ds_write_b128 v127, v[36:39] offset:4096
  ds_write_b128 v127, v[40:43] offset:5120
  ds_write_b128 v127, v[44:47] offset:6144
  ds_write_b128 v127, v[48:51] offset:7168
  s_waitcnt lgkmcnt(0)
  v_add_u32 v124, 0x8000, v124
  v_add_u32 v127, 0x8000, v127
  s_waitcnt vmcnt(8)
  v_xor_b32 v126, 0, v124
  ds_read_b64_tr_b16 v[20:21], v126 offset:0
  ds_read_b64_tr_b16 v[22:23], v126 offset:1024
  v_xor_b32 v126, 32, v124
  ds_read_b64_tr_b16 v[24:25], v126 offset:0
  ds_read_b64_tr_b16 v[26:27], v126 offset:1024
  v_xor_b32 v126, 64, v124
  ds_read_b64_tr_b16 v[28:29], v126 offset:0
  ds_read_b64_tr_b16 v[30:31], v126 offset:1024
  v_xor_b32 v126, 96, v124
  ds_read_b64_tr_b16 v[32:33], v126 offset:0
  ds_read_b64_tr_b16 v[34:35], v126 offset:1024
  v_xor_b32 v126, 128, v124
  ds_read_b64_tr_b16 v[36:37], v126 offset:0
  ds_read_b64_tr_b16 v[38:39], v126 offset:1024
  v_xor_b32 v126, 160, v124
  ds_read_b64_tr_b16 v[40:41], v126 offset:0
  ds_read_b64_tr_b16 v[42:43], v126 offset:1024
  v_xor_b32 v126, 192, v124
  ds_read_b64_tr_b16 v[44:45], v126 offset:0
  ds_read_b64_tr_b16 v[46:47], v126 offset:1024
  v_xor_b32 v126, 224, v124
  ds_read_b64_tr_b16 v[48:49], v126 offset:0
  ds_read_b64_tr_b16 v[50:51], v126 offset:1024
  s_waitcnt lgkmcnt(0)
  ds_write_b128 v127, v[20:23] offset:0
  ds_write_b128 v127, v[24:27] offset:1024
  ds_write_b128 v127, v[28:31] offset:2048
  ds_write_b128 v127, v[32:35] offset:3072
  ds_write_b128 v127, v[36:39] offset:4096
  ds_write_b128 v127, v[40:43] offset:5120
  ds_write_b128 v127, v[44:47] offset:6144
  ds_write_b128 v127, v[48:51] offset:7168
  s_waitcnt lgkmcnt(0)
  v_add_u32 v124, 0x8000, v124
  v_add_u32 v127, 0x8000, v127
  s_waitcnt vmcnt(0)
  v_cmp_ne_u32 vcc, 64, v17
  s_cbranch_vccz L_rec_dn
  s_mov_b32 s7, 0
  v_mbcnt_lo_u32_b32 v16, -1, 0
  v_and_b32 v16, 3, v16
  v_lshlrev_b32 v16, 6, v16
L_wd_78:
  buffer_load_dword v17, v16, s[12:15], 0 offen offset:16 sc1
  s_waitcnt vmcnt(0)
  v_cmp_ne_u32 vcc, 64, v17
  s_cbranch_vccz L_wdo_79
  s_add_u32 s7, s7, 1
  s_cmp_lt_u32 s7, 131072
  s_cbranch_scc1 L_wd_78
  s_mov_b32 s6, 10
  s_branch L_err
L_wdo_79:
L_rec_dn:
  s_sub_u32 s60, s35, s53
  s_add_u32 s61, s60, 4096
  buffer_load_dwordx4 v[52:55], v4, s[8:11], s60 offen offset:0 sc1
  buffer_load_dwordx4 v[68:71], v4, s[8:11], s60 offen offset:128 sc1
  buffer_load_dwordx4 v[56:59], v4, s[8:11], s60 offen offset:2048 sc1
  buffer_load_dwordx4 v[72:75], v4, s[8:11], s60 offen offset:2176 sc1
  buffer_load_dwordx4 v[60:63], v4, s[8:11], s61 offen offset:0 sc1
  buffer_load_dwordx4 v[76:79], v4, s[8:11], s61 offen offset:128 sc1
  buffer_load_dwordx4 v[64:67], v4, s[8:11], s61 offen offset:2048 sc1
  buffer_load_dwordx4 v[80:83], v4, s[8:11], s61 offen offset:2176 sc1
  buffer_load_dwordx4 v[108:111], v9, s[8:11], s60 offen offset:0 sc1
  buffer_load_dwordx4 v[112:115], v9, s[8:11], s60 offen offset:256 sc1
  v_xor_b32 v126, 0, v124
  ds_read_b64_tr_b16 v[20:21], v126 offset:0
  ds_read_b64_tr_b16 v[22:23], v126 offset:1024
  v_xor_b32 v126, 32, v124
  ds_read_b64_tr_b16 v[24:25], v126 offset:0
  ds_read_b64_tr_b16 v[26:27], v126 offset:1024
  v_xor_b32 v126, 64, v124
  ds_read_b64_tr_b16 v[28:29], v126 offset:0
  ds_read_b64_tr_b16 v[30:31], v126 offset:1024
  v_xor_b32 v126, 96, v124
  ds_read_b64_tr_b16 v[32:33], v126 offset:0
  ds_read_b64_tr_b16 v[34:35], v126 offset:1024
  v_xor_b32 v126, 128, v124
  ds_read_b64_tr_b16 v[36:37], v126 offset:0
  ds_read_b64_tr_b16 v[38:39], v126 offset:1024
  v_xor_b32 v126, 160, v124
  ds_read_b64_tr_b16 v[40:41], v126 offset:0
  ds_read_b64_tr_b16 v[42:43], v126 offset:1024
  v_xor_b32 v126, 192, v124
  ds_read_b64_tr_b16 v[44:45], v126 offset:0
  ds_read_b64_tr_b16 v[46:47], v126 offset:1024
  v_xor_b32 v126, 224, v124
  ds_read_b64_tr_b16 v[48:49], v126 offset:0
  ds_read_b64_tr_b16 v[50:51], v126 offset:1024
  s_waitcnt lgkmcnt(0)
  ds_write_b128 v127, v[20:23] offset:0
  ds_write_b128 v127, v[24:27] offset:1024
  ds_write_b128 v127, v[28:31] offset:2048
  ds_write_b128 v127, v[32:35] offset:3072
  ds_write_b128 v127, v[36:39] offset:4096
  ds_write_b128 v127, v[40:43] offset:5120
  ds_write_b128 v127, v[44:47] offset:6144
  ds_write_b128 v127, v[48:51] offset:7168
  s_waitcnt lgkmcnt(0)
  v_add_u32 v124, 0x8000, v124
  v_add_u32 v127, 0x8000, v127
  v_mov_b64 v[20:21], v[84:85]
  v_mov_b64 v[22:23], v[86:87]
  v_mov_b64 v[24:25], v[88:89]
  v_mov_b64 v[26:27], v[90:91]
  s_mov_b32 s32, 0
  s_mov_b32 s49, 1
  s_mov_b32 s33, 1
  s_mov_b32 s59, 1
  s_and_b32 s6, s32, 3
  s_lshl_b32 s6, s6, 19
  s_add_u32 s6, s6, s35
  s_sub_u32 s60, s6, s53
  s_add_u32 s61, s60, 4096
  s_mov_b32 s7, 0
  s_branch L_kvt_81
L_kvs_80:
  buffer_load_dwordx4 v[52:55], v4, s[8:11], s60 offen offset:0 sc1
  buffer_load_dwordx4 v[68:71], v4, s[8:11], s60 offen offset:128 sc1
  buffer_load_dwordx4 v[56:59], v4, s[8:11], s60 offen offset:2048 sc1
  buffer_load_dwordx4 v[72:75], v4, s[8:11], s60 offen offset:2176 sc1
  buffer_load_dwordx4 v[60:63], v4, s[8:11], s61 offen offset:0 sc1
  buffer_load_dwordx4 v[76:79], v4, s[8:11], s61 offen offset:128 sc1
  buffer_load_dwordx4 v[64:67], v4, s[8:11], s61 offen offset:2048 sc1
  buffer_load_dwordx4 v[80:83], v4, s[8:11], s61 offen offset:2176 sc1
  buffer_load_dwordx4 v[108:111], v9, s[8:11], s60 offen offset:0 sc1
  buffer_load_dwordx4 v[112:115], v9, s[8:11], s60 offen offset:256 sc1
L_kvt_81:
  s_waitcnt vmcnt(0)
  v_bitop3_b32 v16, v52, v56, s59 bitop3:0x7e
  v_bitop3_b32 v17, v60, v64, s59 bitop3:0x7e
  v_bitop3_b32 v18, v68, v72, s59 bitop3:0x7e
  v_bitop3_b32 v19, v76, v80, s59 bitop3:0x7e
  v_or3_b32 v16, v16, v17, v18
  v_bitop3_b32 v17, v108, v112, s59 bitop3:0x7e
  v_or3_b32 v16, v16, v17, v19
  v_and_b32 v16, 1, v16
  v_cmp_ne_u32 vcc, 0, v16
  s_cbranch_vccz L_rec_go
  s_add_u32 s7, s7, 1
  s_cmp_lt_u32 s7, 131072
  s_cbranch_scc1 L_kvs_80
  s_mov_b32 s6, 13
  s_branch L_err
L_rec_go:
  s_add_u32 s6, s32, 1
  s_and_b32 s6, s6, 3
  s_lshl_b32 s6, s6, 19
  s_add_u32 s50, s35, s6
  s_add_u32 s51, s50, 0x2000
  v_add_u32 v116, s48, v1
  v_add_u32 v117, s45, v1
  v_add_u32 v118, s46, v1
  v_add_u32 v119, s47, v1
  v_mov_b64 v[84:85], 0
  v_mov_b64 v[86:87], 0
  v_mov_b64 v[88:89], 0
  v_mov_b64 v[90:91], 0
  v_mov_b64 v[92:93], 0
  v_mov_b64 v[94:95], 0
  v_mov_b64 v[96:97], 0
  v_mov_b64 v[98:99], 0
  v_mov_b64 v[100:101], 0
  v_mov_b64 v[102:103], 0
  v_mov_b64 v[104:105], 0
  v_mov_b64 v[106:107], 0
  s_mov_b64 s[60:61], 0
  s_branch L_rec_step
L_rec_loop:
  buffer_load_dwordx4 v[20:23], v1, s[8:11], s44 offen sc1
  buffer_load_dwordx4 v[24:27], v1, s[8:11], s44 offen offset:1024 sc1
  s_mov_b32 s7, 0
  v_add_u32 v116, s48, v1
  v_add_u32 v117, s45, v1
  v_add_u32 v118, s46, v1
  v_add_u32 v119, s47, v1
  v_mov_b64 v[84:85], 0
  v_mov_b64 v[86:87], 0
  v_mov_b64 v[88:89], 0
  v_mov_b64 v[90:91], 0
  v_mov_b64 v[92:93], 0
  v_mov_b64 v[94:95], 0
  v_mov_b64 v[96:97], 0
  v_mov_b64 v[98:99], 0
  v_mov_b64 v[100:101], 0
  v_mov_b64 v[102:103], 0
  v_mov_b64 v[104:105], 0
  v_mov_b64 v[106:107], 0
  buffer_load_dwordx4 v[120:123], v1, s[8:11], s44 offen sc1
  buffer_load_dwordx4 v[124:127], v1, s[8:11], s44 offen offset:1024 sc1
  s_branch L_rec_gather1
L_rec_gather:
  buffer_load_dwordx4 v[120:123], v1, s[8:11], s44 offen sc1
  buffer_load_dwordx4 v[124:127], v1, s[8:11], s44 offen offset:1024 sc1
L_rec_gather1:
  s_waitcnt vmcnt(2)
  v_bitop3_b32 v16, v20, v22, s33 bitop3:0x7e
  v_bitop3_b32 v17, v24, v26, s33 bitop3:0x7e
  v_bitop3_b32 v16, v16, v17, 1 bitop3:0xa8
  v_cmp_ne_u32 vcc, 0, v16
  s_cbranch_vccz L_rec_got
  buffer_load_dwordx4 v[20:23], v1, s[8:11], s44 offen sc1
  buffer_load_dwordx4 v[24:27], v1, s[8:11], s44 offen offset:1024 sc1
  s_waitcnt vmcnt(2)
  v_bitop3_b32 v16, v120, v122, s33 bitop3:0x7e
  v_bitop3_b32 v17, v124, v126, s33 bitop3:0x7e
  v_bitop3_b32 v16, v16, v17, 1 bitop3:0xa8
  v_cmp_ne_u32 vcc, 0, v16
  s_cbranch_vccz L_rec_got1
  s_and_b32 s6, s7, 31
  s_cmp_lg_u32 s6, 31
  s_cbranch_scc1 L_tf_82
  buffer_wbl2 sc1
  s_waitcnt vmcnt(0)
  buffer_inv sc1
  s_waitcnt vmcnt(0)
L_tf_82:
  s_add_u32 s7, s7, 1
  s_cmp_lt_u32 s7, 131072
  s_cbranch_scc1 L_rec_gather
  s_mov_b32 s6, 12
  s_branch L_err
L_rec_got1:
  v_mov_b64 v[20:21], v[120:121]
  v_mov_b64 v[22:23], v[122:123]
  v_mov_b64 v[24:25], v[124:125]
  v_mov_b64 v[26:27], v[126:127]
L_rec_got:
  s_mov_b32 s63, s7
  s_xor_b32 s33, s33, 1
L_rec_step:
  ds_write_b128 v116, v[20:23]
  ds_write_b128 v116, v[24:27] offset:1024
  v_smfmac_f32_16x16x64_bf16 v[84:87], v[20:23], a[0:7], v0
  s_and_b32 s6, s32, 3
  v_smfmac_f32_16x16x64_bf16 v[88:91], v[20:23], a[8:15], v0
  s_lshl_b32 s6, s6, 17
  v_smfmac_f32_16x16x64_bf16 v[84:87], v[24:27], a[16:23], v0
  s_add_u32 s52, s36, s6
  v_smfmac_f32_16x16x64_bf16 v[88:91], v[24:27], a[24:31], v0
  s_cmp_lg_u64 s[60:61], 0
  s_waitcnt lgkmcnt(0)
  s_barrier
  ds_read_b128 v[28:31], v117 offset:0
  ds_read_b128 v[32:35], v117 offset:1024
  v_smfmac_f32_16x16x64_bf16 v[92:95], v[20:23], a[128:135], v0
  ds_read_b128 v[36:39], v118 offset:0
  ds_read_b128 v[40:43], v118 offset:1024
  v_smfmac_f32_16x16x64_bf16 v[96:99], v[20:23], a[136:143], v0
  ds_read_b128 v[44:47], v119 offset:0
  ds_read_b128 v[48:51], v119 offset:1024
  v_smfmac_f32_16x16x64_bf16 v[92:95], v[24:27], a[144:151], v0
  v_smfmac_f32_16x16x64_bf16 v[96:99], v[24:27], a[152:159], v0
  v_smfmac_f32_16x16x64_bf16 v[100:103], v[20:23], v[128:135], v0
  v_smfmac_f32_16x16x64_bf16 v[104:107], v[20:23], v[136:143], v0
  v_smfmac_f32_16x16x64_bf16 v[100:103], v[24:27], v[144:151], v0
  v_smfmac_f32_16x16x64_bf16 v[104:107], v[24:27], v[152:159], v0
  s_cbranch_scc1 L_rec_kvwait
L_rec_kvok:
  s_waitcnt lgkmcnt(5)
  v_smfmac_f32_16x16x64_bf16 v[84:87], v[28:31], a[32:39], v0
  v_smfmac_f32_16x16x64_bf16 v[88:91], v[28:31], a[40:47], v0
  s_mov_b32 m0, s53
  s_waitcnt lgkmcnt(4)
  v_smfmac_f32_16x16x64_bf16 v[84:87], v[32:35], a[48:55], v0
  v_smfmac_f32_16x16x64_bf16 v[88:91], v[32:35], a[56:63], v0
  buffer_load_dwordx4 v1, s[8:11], s50 offen sc1 lds
  s_waitcnt lgkmcnt(3)
  v_smfmac_f32_16x16x64_bf16 v[84:87], v[36:39], a[64:71], v0
  v_smfmac_f32_16x16x64_bf16 v[88:91], v[36:39], a[72:79], v0
  buffer_load_dwordx4 v1, s[8:11], s50 offen offset:1024 sc1 lds
  s_waitcnt lgkmcnt(2)
  v_smfmac_f32_16x16x64_bf16 v[84:87], v[40:43], a[80:87], v0
  v_smfmac_f32_16x16x64_bf16 v[88:91], v[40:43], a[88:95], v0
  s_mov_b32 m0, s37
  s_waitcnt lgkmcnt(1)
  v_smfmac_f32_16x16x64_bf16 v[84:87], v[44:47], a[96:103], v0
  v_smfmac_f32_16x16x64_bf16 v[88:91], v[44:47], a[104:111], v0
  buffer_load_dwordx4 v1, s[8:11], s51 offen sc1 lds
  s_waitcnt lgkmcnt(0)
  v_smfmac_f32_16x16x64_bf16 v[84:87], v[48:51], a[112:119], v0
  v_smfmac_f32_16x16x64_bf16 v[88:91], v[48:51], a[120:127], v0
  buffer_load_dwordx4 v1, s[8:11], s51 offen offset:1024 sc1 lds
  v_smfmac_f32_16x16x64_bf16 v[92:95], v[28:31], a[160:167], v0
  v_smfmac_f32_16x16x64_bf16 v[92:95], v[32:35], a[176:183], v0
  v_smfmac_f32_16x16x64_bf16 v[92:95], v[36:39], a[192:199], v0
  v_smfmac_f32_16x16x64_bf16 v[92:95], v[40:43], a[208:215], v0
  v_smfmac_f32_16x16x64_bf16 v[92:95], v[44:47], a[224:231], v0
  s_nop 0
  v_add_f32 v84, v84, v85
  v_add_f32 v86, v86, v87
  v_smfmac_f32_16x16x64_bf16 v[92:95], v[48:51], a[240:247], v0
  v_cvt_pk_bf16_f32 v16, v84, v86
  v_add_f32 v88, v88, v89
  v_smfmac_f32_16x16x64_bf16 v[96:99], v[28:31], a[168:175], v0
  v_add_f32 v90, v90, v91
  v_cvt_pk_bf16_f32 v18, v88, v90
  v_smfmac_f32_16x16x64_bf16 v[96:99], v[32:35], a[184:191], v0
  v_smfmac_f32_16x16x64_bf16 v[96:99], v[36:39], a[200:207], v0
  s_nop 0
  v_add_f32 v92, v92, v93
  v_smfmac_f32_16x16x64_bf16 v[96:99], v[40:43], a[216:223], v0
  v_add_f32 v94, v94, v95
  v_smfmac_f32_16x16x64_bf16 v[96:99], v[44:47], a[232:239], v0
  v_cvt_pk_bf16_f32 v17, v92, v94
  v_smfmac_f32_16x16x64_bf16 v[96:99], v[48:51], a[248:255], v0
  ds_write_b64 v2, v[16:17]
  v_smfmac_f32_16x16x64_bf16 v[100:103], v[28:31], v[160:167], v0
  v_smfmac_f32_16x16x64_bf16 v[104:107], v[28:31], v[168:175], v0
  s_nop 4
  v_add_f32 v96, v96, v97
  v_add_f32 v98, v98, v99
  v_cvt_pk_bf16_f32 v19, v96, v98
  ds_write_b64 v2, v[18:19] offset:128
  v_smfmac_f32_16x16x64_bf16 v[100:103], v[32:35], v[176:183], v0
  v_smfmac_f32_16x16x64_bf16 v[104:107], v[32:35], v[184:191], v0
  s_waitcnt lgkmcnt(0)
  s_barrier
  ds_read_b64_tr_b16 v[84:85], v3 offset:0
  ds_read_b64_tr_b16 v[86:87], v3 offset:64
  v_smfmac_f32_16x16x64_bf16 v[100:103], v[36:39], v[192:199], v0
  ds_read_b64_tr_b16 v[88:89], v3 offset:256
  ds_read_b64_tr_b16 v[90:91], v3 offset:320
  v_smfmac_f32_16x16x64_bf16 v[104:107], v[36:39], v[200:207], v0
  ds_read_b64_tr_b16 v[92:93], v3 offset:512
  ds_read_b64_tr_b16 v[94:95], v3 offset:576
  v_smfmac_f32_16x16x64_bf16 v[100:103], v[40:43], v[208:215], v0
  ds_read_b64_tr_b16 v[96:97], v3 offset:768
  ds_read_b64_tr_b16 v[98:99], v3 offset:832
  v_smfmac_f32_16x16x64_bf16 v[104:107], v[40:43], v[216:223], v0
  s_waitcnt vmcnt(4)
  s_waitcnt lgkmcnt(6)
  v_mfma_f32_16x16x32_bf16 v[116:119], v[52:55], v[84:87], 0
  v_mfma_f32_16x16x32_bf16 v[120:123], v[68:71], v[84:87], 0
  v_mfma_f32_16x16x32_bf16 v[124:127], v[84:87], v[84:87], 0
  s_waitcnt lgkmcnt(4)
  v_mfma_f32_16x16x32_bf16 v[116:119], v[56:59], v[88:91], v[116:119]
  v_mfma_f32_16x16x32_bf16 v[120:123], v[72:75], v[88:91], v[120:123]
  v_mfma_f32_16x16x32_bf16 v[124:127], v[88:91], v[88:91], v[124:127]
  s_waitcnt lgkmcnt(2)
  v_mfma_f32_16x16x32_bf16 v[116:119], v[60:63], v[92:95], v[116:119]
  v_mfma_f32_16x16x32_bf16 v[120:123], v[76:79], v[92:95], v[120:123]
  v_mfma_f32_16x16x32_bf16 v[124:127], v[92:95], v[92:95], v[124:127]
  s_waitcnt lgkmcnt(0)
  v_mfma_f32_16x16x32_bf16 v[116:119], v[64:67], v[96:99], v[116:119]
  v_mfma_f32_16x16x32_bf16 v[120:123], v[80:83], v[96:99], v[120:123]
  v_mfma_f32_16x16x32_bf16 v[124:127], v[96:99], v[96:99], v[124:127]
  v_smfmac_f32_16x16x64_bf16 v[100:103], v[44:47], v[224:231], v0
  ds_read_b128 v[52:55], v7 offset:0
  ds_read_b128 v[56:59], v7 offset:8192
  s_nop 2
  v_max3_f32 v88, v116, v117, v118
  v_max3_f32 v89, v120, v121, v122
  v_max3_f32 v88, v88, v119, v123
  v_max3_f32 v89, v89, v126, v127
  v_max_f32 v88, v88, v89
  v_max_f32 v89, v88, v89
  v_smfmac_f32_16x16x64_bf16 v[104:107], v[44:47], v[232:239], v0
  ds_read_b128 v[60:63], v7 offset:1024
  v_permlane32_swap_b32 v88, v89
  v_max_f32 v88, v88, v89
  v_max_f32 v89, v88, v89
  v_smfmac_f32_16x16x64_bf16 v[100:103], v[48:51], v[240:247], v0
  ds_read_b128 v[64:67], v7 offset:9216
  v_permlane16_swap_b32 v88, v89
  v_max_f32 v88, v88, v89
  v_mul_f32 v88, s34, v88
  v_smfmac_f32_16x16x64_bf16 v[104:107], v[48:51], v[248:255], v0
  v_fma_f32 v126, v126, s34, -v88
  v_fma_f32 v127, v127, s34, -v88
  v_exp_f32 v126, v126
  ds_read_b128 v[68:71], v7 offset:16384
  v_exp_f32 v127, v127
  ds_read_b128 v[72:75], v7 offset:24576
  v_fma_f32 v116, v116, s34, -v88
  v_fma_f32 v117, v117, s34, -v88
  v_fma_f32 v118, v118, s34, -v88
  v_fma_f32 v119, v119, s34, -v88
  v_cvt_pk_bf16_f32 v12, v126, v127
  v_exp_f32 v116, v116
  ds_read_b128 v[76:79], v7 offset:17408
  v_exp_f32 v117, v117
  ds_read_b128 v[80:83], v7 offset:25600
  v_mfma_f32_16x16x16_bf16 v[124:127], v[10:11], v[12:13], 0
  v_exp_f32 v118, v118
  ds_read_b128 v[20:23], v7 offset:2048
  v_exp_f32 v119, v119
  ds_read_b128 v[24:27], v7 offset:10240
  v_add_f32 v100, v100, v101
  v_add_f32 v102, v102, v103
  v_cvt_pk_bf16_f32 v16, v100, v102
  v_cvt_pk_bf16_f32 v92, v116, v117
  v_cvt_pk_bf16_f32 v93, v118, v119
  v_add_f32 v104, v104, v105
  v_add_f32 v106, v106, v107
  v_cvt_pk_bf16_f32 v18, v104, v106
  v_mfma_f32_16x16x16_bf16 v[124:127], v[10:11], v[92:93], v[124:127]
  v_bfi_b32 v16, 1, s59, v16
  v_fma_f32 v120, v120, s34, -v88
  v_fma_f32 v121, v121, s34, -v88
  buffer_store_dwordx4 v[16:19], v1, s[8:11], s52 offen sc1
  v_mfma_f32_16x16x16_bf16 v[100:103], v[16:17], v[12:13], 0
  v_fma_f32 v122, v122, s34, -v88
  v_fma_f32 v123, v123, s34, -v88
  v_mfma_f32_16x16x16_bf16 v[104:107], v[18:19], v[12:13], 0
  v_exp_f32 v120, v120
  ds_read_b128 v[28:31], v7 offset:3072
  v_exp_f32 v121, v121
  ds_read_b128 v[32:35], v7 offset:11264
  v_exp_f32 v122, v122
  ds_read_b128 v[36:39], v7 offset:18432
  v_exp_f32 v123, v123
  ds_read_b128 v[40:43], v7 offset:26624
  s_cmp_eq_u32 s32, 63
  v_cvt_pk_bf16_f32 v94, v120, v121
  v_cvt_pk_bf16_f32 v95, v122, v123
  s_cbranch_scc1 L_rec_last
  s_nop 0
  v_mfma_f32_16x16x16_bf16 v[124:127], v[10:11], v[94:95], v[124:127]
  v_mfma_f32_16x16x32_bf16 v[100:103], v[108:111], v[92:95], v[100:103]
  v_mfma_f32_16x16x32_bf16 v[104:107], v[112:115], v[92:95], v[104:107]
  ds_read_b128 v[44:47], v7 offset:19456
  ds_read_b128 v[48:51], v7 offset:27648
  s_nop 3
  v_rcp_f32 v124, v124
  s_nop 0
  v_pk_mul_f32 v[100:101], v[100:101], v[124:125] op_sel_hi:[1,0]
  v_pk_mul_f32 v[102:103], v[102:103], v[124:125] op_sel_hi:[1,0]
  v_cvt_pk_bf16_f32 v116, v100, v101
  v_cvt_pk_bf16_f32 v117, v102, v103
  v_pk_mul_f32 v[104:105], v[104:105], v[124:125] op_sel_hi:[1,0]
  v_pk_mul_f32 v[106:107], v[106:107], v[124:125] op_sel_hi:[1,0]
  v_cvt_pk_bf16_f32 v118, v104, v105
  v_cvt_pk_bf16_f32 v119, v106, v107
  s_mov_b64 exec, s[56:57]
  ds_write2_b32 v5, v116, v117 offset0:0 offset1:4
  ds_write2_b32 v5, v118, v119 offset0:8 offset1:12
  s_mov_b64 exec, -1
  v_mfma_f32_32x32x8_bf16 v[84:99], v[12:13], v[14:15], 0
  v_mfma_f32_32x32x8_bf16 v[100:115], v[12:13], v[14:15], 0
  s_waitcnt vmcnt(1) lgkmcnt(0)
  s_barrier
  ds_read_b128 v[116:119], v6
  ds_read_b128 v[120:123], v6 offset:128
  s_waitcnt lgkmcnt(1)
  s_nop 3
  v_smfmac_f32_16x16x64_bf16 v[84:87], v[116:119], v[52:59], v0
  ds_read_b128 v[52:55], v7 offset:4096
  ds_read_b128 v[56:59], v7 offset:12288
  v_smfmac_f32_16x16x64_bf16 v[88:91], v[116:119], v[60:67], v0
  ds_read_b128 v[60:63], v7 offset:5120
  ds_read_b128 v[64:67], v7 offset:13312
  s_waitcnt lgkmcnt(4)
  v_smfmac_f32_16x16x64_bf16 v[84:87], v[120:123], v[68:75], v0
  ds_read_b128 v[68:71], v7 offset:20480
  ds_read_b128 v[72:75], v7 offset:28672
  v_smfmac_f32_16x16x64_bf16 v[88:91], v[120:123], v[76:83], v0
  ds_read_b128 v[76:79], v7 offset:21504
  ds_read_b128 v[80:83], v7 offset:29696
  v_smfmac_f32_16x16x64_bf16 v[92:95], v[116:119], v[20:27], v0
  ds_read_b128 v[20:23], v7 offset:6144
  ds_read_b128 v[24:27], v7 offset:14336
  v_smfmac_f32_16x16x64_bf16 v[96:99], v[116:119], v[28:35], v0
  ds_read_b128 v[28:31], v7 offset:7168
  ds_read_b128 v[32:35], v7 offset:15360
  v_add_f32 v84, v84, v85
  v_smfmac_f32_16x16x64_bf16 v[92:95], v[120:123], v[36:43], v0
  ds_read_b128 v[36:39], v7 offset:22528
  ds_read_b128 v[40:43], v7 offset:30720
  v_add_f32 v86, v86, v87
  v_smfmac_f32_16x16x64_bf16 v[96:99], v[120:123], v[44:51], v0
  ds_read_b128 v[44:47], v7 offset:23552
  ds_read_b128 v[48:51], v7 offset:31744
  v_cvt_pk_bf16_f32 v124, v84, v86
  s_waitcnt lgkmcnt(14)
  v_smfmac_f32_16x16x64_bf16 v[100:103], v[116:119], v[52:59], v0
  v_add_f32 v88, v88, v89
  v_add_f32 v90, v90, v91
  s_waitcnt lgkmcnt(12)
  v_smfmac_f32_16x16x64_bf16 v[104:107], v[116:119], v[60:67], v0
  v_cvt_pk_bf16_f32 v125, v88, v90
  v_add_f32 v92, v92, v93
  s_waitcnt lgkmcnt(10)
  v_smfmac_f32_16x16x64_bf16 v[100:103], v[120:123], v[68:75], v0
  v_add_f32 v94, v94, v95
  v_cvt_pk_bf16_f32 v126, v92, v94
  s_waitcnt lgkmcnt(8)
  v_smfmac_f32_16x16x64_bf16 v[104:107], v[120:123], v[76:83], v0
  v_add_f32 v96, v96, v97
  v_add_f32 v98, v98, v99
  s_waitcnt lgkmcnt(6)
  v_smfmac_f32_16x16x64_bf16 v[108:111], v[116:119], v[20:27], v0
  v_cvt_pk_bf16_f32 v127, v96, v98
  v_bfi_b32 v124, 1, s33, v124
  s_waitcnt lgkmcnt(4)
  v_smfmac_f32_16x16x64_bf16 v[112:115], v[116:119], v[28:35], v0
  buffer_store_dwordx4 v[124:127], v8, s[8:11], s39 offen
  v_add_f32 v100, v100, v101
  s_waitcnt lgkmcnt(2)
  v_smfmac_f32_16x16x64_bf16 v[108:111], v[120:123], v[36:43], v0
  v_add_f32 v102, v102, v103
  v_cvt_pk_bf16_f32 v16, v100, v102
  s_waitcnt lgkmcnt(0)
  v_smfmac_f32_16x16x64_bf16 v[112:115], v[120:123], v[44:51], v0
  v_add_f32 v104, v104, v105
  v_add_f32 v106, v106, v107
  v_cvt_pk_bf16_f32 v17, v104, v106
  s_nop 0
  v_add_f32 v108, v108, v109
  v_add_f32 v110, v110, v111
  v_cvt_pk_bf16_f32 v18, v108, v110
  s_nop 0
  v_add_f32 v112, v112, v113
  v_add_f32 v114, v114, v115
  v_cvt_pk_bf16_f32 v19, v112, v114
  v_bfi_b32 v16, 1, s33, v16
  buffer_store_dwordx4 v[16:19], v8, s[8:11], s40 offen
  s_add_u32 s32, s32, 1
  ds_read_b128 v[52:55], v4 offset:0
  ds_read_b128 v[68:71], v4 offset:128
  ds_read_b128 v[56:59], v4 offset:2048
  ds_read_b128 v[72:75], v4 offset:2176
  ds_read_b128 v[60:63], v4 offset:4096
  ds_read_b128 v[76:79], v4 offset:4224
  ds_read_b128 v[64:67], v4 offset:6144
  ds_read_b128 v[80:83], v4 offset:6272
  ds_read_b128 v[108:111], v9
  ds_read_b128 v[112:115], v9 offset:256
  s_lshr_b32 s6, s32, 2
  s_andn2_b32 s59, 1, s6
  s_add_u32 s6, s32, 1
  s_and_b32 s6, s6, 3
  s_lshl_b32 s6, s6, 19
  s_add_u32 s50, s35, s6
  s_add_u32 s51, s50, 0x2000
  v_bfe_u32 v19, v1, 4, 4
  v_and_b32 v16, 1, v19
  v_lshlrev_b32 v17, 4, v16
  v_mov_b32 v18, 0x3f80
  v_lshlrev_b32 v17, v17, v18
  v_lshrrev_b32 v18, 1, v19
  v_cmp_eq_u32 vcc, 0, v18
  s_nop 1
  v_cndmask_b32 v120, 0, v17, vcc
  v_cmp_eq_u32 vcc, 1, v18
  s_nop 1
  v_cndmask_b32 v121, 0, v17, vcc
  v_cmp_eq_u32 vcc, 2, v18
  s_nop 1
  v_cndmask_b32 v122, 0, v17, vcc
  v_cmp_eq_u32 vcc, 3, v18
  s_nop 1
  v_cndmask_b32 v123, 0, v17, vcc
  v_lshlrev_b32 v16, 5, v16
  v_bfe_u32 v17, v19, 2, 1
  v_lshl_or_b32 v16, v17, 4, v16
  v_bfe_u32 v17, v19, 1, 1
  v_lshl_or_b32 v16, v17, 3, v16
  v_lshrrev_b32 v17, 8, v1
  v_lshl_or_b32 v124, v17, 6, v16
  s_waitcnt lgkmcnt(0)
  v_bitop3_b32 v16, v52, v56, s59 bitop3:0x7e
  v_bitop3_b32 v17, v60, v64, s59 bitop3:0x7e
  v_bitop3_b32 v18, v68, v72, s59 bitop3:0x7e
  v_bitop3_b32 v19, v76, v80, s59 bitop3:0x7e
  v_or3_b32 v16, v16, v17, v18
  v_bitop3_b32 v17, v108, v112, s59 bitop3:0x7e
  v_or3_b32 v16, v16, v17, v19
  v_and_b32 v16, 1, v16
  v_cmp_ne_u32 s[60:61], 0, v16
  v_mov_b32 v19, v124
  s_cmp_lg_u32 s3, 0
  s_cbranch_scc1 L_rec_nored
  s_mov_b32 s7, 0
L_rec_rr:
  buffer_load_dwordx4 v[20:23], v1, s[8:11], s41 offen offset:0 sc1
  buffer_load_dwordx4 v[24:27], v1, s[8:11], s41 offen offset:1024 sc1
  buffer_load_dwordx4 v[28:31], v1, s[8:11], s41 offen offset:2048 sc1
  buffer_load_dwordx4 v[32:35], v1, s[8:11], s41 offen offset:3072 sc1
  buffer_load_dwordx4 v[36:39], v1, s[8:11], s42 offen offset:0 sc1
  buffer_load_dwordx4 v[40:43], v1, s[8:11], s42 offen offset:1024 sc1
  buffer_load_dwordx4 v[44:47], v1, s[8:11], s42 offen offset:2048 sc1
  buffer_load_dwordx4 v[48:51], v1, s[8:11], s42 offen offset:3072 sc1
  s_waitcnt vmcnt(7)
  v_mfma_f32_16x16x32_bf16 v[124:127], v[20:23], v[120:123], 0
  s_waitcnt vmcnt(6)
  v_mfma_f32_16x16x32_bf16 v[124:127], v[24:27], v[120:123], v[124:127]
  v_bitop3_b32 v16, v20, v24, s33 bitop3:0x7e
  s_waitcnt vmcnt(5)
  v_mfma_f32_16x16x32_bf16 v[124:127], v[28:31], v[120:123], v[124:127]
  s_waitcnt vmcnt(4)
  v_mfma_f32_16x16x32_bf16 v[124:127], v[32:35], v[120:123], v[124:127]
  v_bitop3_b32 v17, v28, v32, s33 bitop3:0x7e
  s_waitcnt vmcnt(3)
  v_mfma_f32_16x16x32_bf16 v[124:127], v[36:39], v[120:123], v[124:127]
  s_waitcnt vmcnt(2)
  v_mfma_f32_16x16x32_bf16 v[124:127], v[40:43], v[120:123], v[124:127]
  v_bitop3_b32 v18, v36, v40, s33 bitop3:0x7e
  s_waitcnt vmcnt(1)
  v_mfma_f32_16x16x32_bf16 v[124:127], v[44:47], v[120:123], v[124:127]
  v_or3_b32 v16, v16, v17, v18
  s_waitcnt vmcnt(0)
  v_mfma_f32_16x16x32_bf16 v[124:127], v[48:51], v[120:123], v[124:127]
  v_bitop3_b32 v17, v44, v48, s33 bitop3:0x7e
  v_bitop3_b32 v16, v16, v17, 1 bitop3:0xa8
  v_cmp_ne_u32 vcc, 0, v16
  s_cbranch_vccz L_rec_red
  s_and_b32 s6, s7, 31
  s_cmp_lg_u32 s6, 31
  s_cbranch_scc1 L_tf_83
  buffer_wbl2 sc1
  s_waitcnt vmcnt(0)
  buffer_inv sc1
  s_waitcnt vmcnt(0)
L_tf_83:
  s_add_u32 s7, s7, 1
  s_cmp_lt_u32 s7, 131072
  s_cbranch_scc1 L_rec_rr
  s_mov_b32 s6, 14
  s_branch L_err
L_rec_red:
  s_nop 3
  v_cvt_pk_bf16_f32 v124, v124, v125
  v_cvt_pk_bf16_f32 v125, v126, v127
  v_bfi_b32 v124, 1, s33, v124
  s_mov_b64 exec, s[54:55]
  buffer_store_dwordx2 v[124:125], v19, s[8:11], s43 offen
  s_cmp_lg_u32 s32, 63
  s_cbranch_scc1 L_rec_nl
  buffer_store_dwordx2 v[124:125], v19, s[8:11], s43 offen sc1
L_rec_nl:
  s_mov_b64 exec, -1
  s_barrier
  s_cmp_lg_u64 s[60:61], 0
  s_cbranch_scc0 L_ke_84
  s_and_b32 s6, s32, 3
  s_lshl_b32 s6, s6, 19
  s_add_u32 s6, s6, s35
  s_sub_u32 s60, s6, s53
  s_add_u32 s61, s60, 4096
  buffer_load_dwordx4 v[52:55], v4, s[8:11], s60 offen offset:0 sc1
  buffer_load_dwordx4 v[68:71], v4, s[8:11], s60 offen offset:128 sc1
  buffer_load_dwordx4 v[56:59], v4, s[8:11], s60 offen offset:2048 sc1
  buffer_load_dwordx4 v[72:75], v4, s[8:11], s60 offen offset:2176 sc1
  buffer_load_dwordx4 v[60:63], v4, s[8:11], s61 offen offset:0 sc1
  buffer_load_dwordx4 v[76:79], v4, s[8:11], s61 offen offset:128 sc1
  buffer_load_dwordx4 v[64:67], v4, s[8:11], s61 offen offset:2048 sc1
  buffer_load_dwordx4 v[80:83], v4, s[8:11], s61 offen offset:2176 sc1
  buffer_load_dwordx4 v[108:111], v9, s[8:11], s60 offen offset:0 sc1
  buffer_load_dwordx4 v[112:115], v9, s[8:11], s60 offen offset:256 sc1
L_ke_84:
  s_branch L_rec_loop
L_rec_nored:
  s_cmp_lg_u64 s[60:61], 0
  s_cbranch_scc0 L_ke_85
  s_and_b32 s6, s32, 3
  s_lshl_b32 s6, s6, 19
  s_add_u32 s6, s6, s35
  s_sub_u32 s60, s6, s53
  s_add_u32 s61, s60, 4096
  buffer_load_dwordx4 v[52:55], v4, s[8:11], s60 offen offset:0 sc1
  buffer_load_dwordx4 v[68:71], v4, s[8:11], s60 offen offset:128 sc1
  buffer_load_dwordx4 v[56:59], v4, s[8:11], s60 offen offset:2048 sc1
  buffer_load_dwordx4 v[72:75], v4, s[8:11], s60 offen offset:2176 sc1
  buffer_load_dwordx4 v[60:63], v4, s[8:11], s61 offen offset:0 sc1
  buffer_load_dwordx4 v[76:79], v4, s[8:11], s61 offen offset:128 sc1
  buffer_load_dwordx4 v[64:67], v4, s[8:11], s61 offen offset:2048 sc1
  buffer_load_dwordx4 v[80:83], v4, s[8:11], s61 offen offset:2176 sc1
  buffer_load_dwordx4 v[108:111], v9, s[8:11], s60 offen offset:0 sc1
  buffer_load_dwordx4 v[112:115], v9, s[8:11], s60 offen offset:256 sc1
L_ke_85:
  s_barrier
  s_branch L_rec_loop
L_rec_kvwait:
  s_and_b32 s6, s32, 3
  s_lshl_b32 s6, s6, 19
  s_add_u32 s6, s6, s35
  s_sub_u32 s60, s6, s53
  s_add_u32 s61, s60, 4096
  s_mov_b32 s7, 0
  s_branch L_kvt_87
L_kvs_86:
  buffer_load_dwordx4 v[52:55], v4, s[8:11], s60 offen offset:0 sc1
  buffer_load_dwordx4 v[68:71], v4, s[8:11], s60 offen offset:128 sc1
  buffer_load_dwordx4 v[56:59], v4, s[8:11], s60 offen offset:2048 sc1
  buffer_load_dwordx4 v[72:75], v4, s[8:11], s60 offen offset:2176 sc1
  buffer_load_dwordx4 v[60:63], v4, s[8:11], s61 offen offset:0 sc1
  buffer_load_dwordx4 v[76:79], v4, s[8:11], s61 offen offset:128 sc1
  buffer_load_dwordx4 v[64:67], v4, s[8:11], s61 offen offset:2048 sc1
  buffer_load_dwordx4 v[80:83], v4, s[8:11], s61 offen offset:2176 sc1
  buffer_load_dwordx4 v[108:111], v9, s[8:11], s60 offen offset:0 sc1
  buffer_load_dwordx4 v[112:115], v9, s[8:11], s60 offen offset:256 sc1
L_kvt_87:
  s_waitcnt vmcnt(0)
  v_bitop3_b32 v16, v52, v56, s59 bitop3:0x7e
  v_bitop3_b32 v17, v60, v64, s59 bitop3:0x7e
  v_bitop3_b32 v18, v68, v72, s59 bitop3:0x7e
  v_bitop3_b32 v19, v76, v80, s59 bitop3:0x7e
  v_or3_b32 v16, v16, v17, v18
  v_bitop3_b32 v17, v108, v112, s59 bitop3:0x7e
  v_or3_b32 v16, v16, v17, v19
  v_and_b32 v16, 1, v16
  v_cmp_ne_u32 vcc, 0, v16
  s_cbranch_vccz L_rec_kvok
  s_add_u32 s7, s7, 1
  s_cmp_lt_u32 s7, 131072
  s_cbranch_scc1 L_kvs_86
  s_mov_b32 s6, 13
  s_branch L_err
L_rec_last:
  s_waitcnt vmcnt(0)
  s_endpgm
L_p:
  s_sub_u32 s35, s4, 2
  s_lshr_b32 s35, s35, 1
  s_and_b32 s6, s4, 1
  s_lshl_b32 s6, s6, 4
  s_and_b32 s36, s5, 15
  s_add_u32 s36, s36, s6
  s_lshr_b32 s37, s5, 4
  s_mul_i32 s38, s35, 0x200000
  s_add_u32 s38, s38, 0x0
  s_mul_i32 s39, s35, 0x2000000
  s_add_u32 s39, s39, 0x800000
  s_mul_i32 s40, s35, 0x1000000
  s_add_u32 s40, s40, 0x4800000
  s_mul_i32 s41, s35, 0x1000000
  s_add_u32 s41, s41, 0x6800000
  s_mul_i32 s44, s35, 0x800
  s_add_u32 s44, s44, 0x710000
  s_lshl_b32 s6, s3, 13
  s_add_u32 s38, s38, s6
  s_add_u32 s53, s6, 0
  s_lshl_b32 s6, s36, 14
  s_lshl_b32 s7, s3, 11
  s_add_u32 s39, s39, s6
  s_add_u32 s39, s39, s7
  s_lshl_b32 s6, s36, 12
  s_lshl_b32 s7, s3, 10
  s_add_u32 s40, s40, s6
  s_add_u32 s40, s40, s7
  s_lshl_b32 s6, s36, 13
  s_lshr_b32 s7, s3, 1
  s_lshl_b32 s7, s7, 12
  s_add_u32 s41, s41, s6
  s_add_u32 s41, s41, s7
  s_lshl_b32 s6, s35, 13
  s_lshl_b32 s7, s37, 12
  s_add_u32 s6, s6, s7
  s_lshl_b32 s7, s36, 7
  s_add_u32 s6, s6, s7
  s_lshl_b32 s7, s3, 2
  s_add_u32 s6, s6, s7
  s_add_u32 s43, s6, 0x718000
  s_mov_b32 s34, 0x3e0293ee
  v_mov_b32 v12, 0
  v_mov_b32 v13, 0
  v_mov_b32 v14, 0
  v_mov_b32 v15, 0
  v_lshlrev_b32 v16, 4, v0
  s_lshl_b32 s6, s37, 19
  s_add_u32 s6, s6, s39
  s_mov_b64 exec, 1
  buffer_store_dword v12, v12, s[8:11], s43 offen sc1
  s_mov_b64 exec, -1
  buffer_store_dwordx4 v[12:15], v16, s[8:11], s6 offen offset:0 sc1
  buffer_store_dwordx4 v[12:15], v16, s[8:11], s6 offen offset:1024 sc1
  s_add_u32 s6, s6, 8192
  buffer_store_dwordx4 v[12:15], v16, s[8:11], s6 offen offset:0 sc1
  buffer_store_dwordx4 v[12:15], v16, s[8:11], s6 offen offset:1024 sc1
  s_add_u32 s6, s6, 1040384
  buffer_store_dwordx4 v[12:15], v16, s[8:11], s6 offen offset:0 sc1
  buffer_store_dwordx4 v[12:15], v16, s[8:11], s6 offen offset:1024 sc1
  s_add_u32 s6, s6, 8192
  buffer_store_dwordx4 v[12:15], v16, s[8:11], s6 offen offset:0 sc1
  buffer_store_dwordx4 v[12:15], v16, s[8:11], s6 offen offset:1024 sc1
  s_cmp_ge_u32 s4, 4
  s_cbranch_scc1 L_pro
L_p2:
  v_mov_b32 v12, 0
  v_mov_b32 v13, 0
  v_lshlrev_b32 v0, 4, v0
  s_mov_b32 s16, s82
  s_mov_b32 s17, s83
  s_mov_b32 s18, 0x400000
  s_mov_b32 s19, 0x20000
  s_mov_b32 s20, s84
  s_mov_b32 s21, s85
  s_mov_b32 s22, 0x400000
  s_mov_b32 s23, 0x20000
  s_mov_b32 s24, s86
  s_mov_b32 s25, s87
  s_mov_b32 s26, 0x400000
  s_mov_b32 s27, 0x20000
  v_mov_b32 v80, 0x3f803f80
  v_mov_b32 v81, 0x3f803f80
  v_mov_b32 v82, 0x3f803f80
  v_mov_b32 v83, 0x3f803f80
  v_lshrrev_b32 v104, 4, v0
  v_lshrrev_b32 v100, 8, v0
  v_lshlrev_b32 v105, 2, v100
  v_and_b32 v104, 15, v104
  v_xor_b32 v104, v104, v105
  v_mul_u32_u24 v100, 8192, v100
  v_lshl_add_u32 v100, v104, 4, v100
  v_bfe_u32 v104, v0, 6, 2
  v_lshlrev_b32 v105, 2, v104
  v_bfe_u32 v106, v0, 8, 1
  v_lshlrev_b32 v106, 1, v106
  v_bfe_u32 v107, v0, 5, 1
  v_or_b32 v106, v106, v107
  s_lshl_b32 s6, s3, 2
  v_or_b32 v106, s6, v106
  v_xor_b32 v106, v106, v105
  v_lshlrev_b32 v106, 4, v106
  v_bfe_u32 v107, v0, 4, 1
  v_lshl_or_b32 v106, v107, 3, v106
  v_bfe_u32 v107, v0, 9, 1
  v_lshl_or_b32 v104, v107, 3, v104
  v_lshl_or_b32 v104, v104, 8, v106
  v_add_u32 v105, 0x10000, v104
  s_lshl_b32 s60, s3, 13
  s_mul_i32 s63, s3, 262144
  s_lshr_b32 s6, 0x72, s4
  s_bitcmp1_b32 s6, 0
  s_cbranch_scc1 L_rdn_88
  s_waitcnt vmcnt(0)
  s_barrier
  s_cmp_lg_u32 s3, 0
  s_cbranch_scc1 L_sd_89
  s_mov_b64 exec, 1
  s_and_b32 s6, s4, 3
  s_lshl_b32 s6, s6, 6
  v_mov_b32 v18, 16
  v_mov_b32 v19, 1
  buffer_atomic_add v19, v18, s[12:15], s6 offen sc1
  s_mov_b64 exec, -1
L_sd_89:
L_rdn_88:
  s_lshl_b32 s61, s36, 8
  s_add_u32 s61, s61, 0
  s_add_u32 s61, s61, s63
  s_add_u32 m0, s60, 0
  s_add_u32 s62, s61, 0
  buffer_load_dwordx4 v100, s[16:19], s62 offen lds
  s_add_u32 m0, s60, 1024
  s_add_u32 s62, s61, 32768
  buffer_load_dwordx4 v100, s[16:19], s62 offen lds
  s_add_u32 m0, s60, 2048
  s_add_u32 s62, s61, 65536
  buffer_load_dwordx4 v100, s[16:19], s62 offen lds
  s_add_u32 m0, s60, 3072
  s_add_u32 s62, s61, 98304
  buffer_load_dwordx4 v100, s[16:19], s62 offen lds
  s_add_u32 m0, s60, 4096
  s_add_u32 s62, s61, 131072
  buffer_load_dwordx4 v100, s[16:19], s62 offen lds
  s_add_u32 m0, s60, 5120
  s_add_u32 s62, s61, 163840
  buffer_load_dwordx4 v100, s[16:19], s62 offen lds
  s_add_u32 m0, s60, 6144
  s_add_u32 s62, s61, 196608
  buffer_load_dwordx4 v100, s[16:19], s62 offen lds
  s_add_u32 m0, s60, 7168
  s_add_u32 s62, s61, 229376
  buffer_load_dwordx4 v100, s[16:19], s62 offen lds
  s_lshl_b32 s61, s36, 8
  s_add_u32 s61, s61, 1048576
  s_add_u32 s61, s61, s63
  s_add_u32 m0, s60, 32768
  s_add_u32 s62, s61, 0
  buffer_load_dwordx4 v100, s[16:19], s62 offen lds
  s_add_u32 m0, s60, 33792
  s_add_u32 s62, s61, 32768
  buffer_load_dwordx4 v100, s[16:19], s62 offen lds
  s_add_u32 m0, s60, 34816
  s_add_u32 s62, s61, 65536
  buffer_load_dwordx4 v100, s[16:19], s62 offen lds
  s_add_u32 m0, s60, 35840
  s_add_u32 s62, s61, 98304
  buffer_load_dwordx4 v100, s[16:19], s62 offen lds
  s_add_u32 m0, s60, 36864
  s_add_u32 s62, s61, 131072
  buffer_load_dwordx4 v100, s[16:19], s62 offen lds
  s_add_u32 m0, s60, 37888
  s_add_u32 s62, s61, 163840
  buffer_load_dwordx4 v100, s[16:19], s62 offen lds
  s_add_u32 m0, s60, 38912
  s_add_u32 s62, s61, 196608
  buffer_load_dwordx4 v100, s[16:19], s62 offen lds
  s_add_u32 m0, s60, 39936
  s_add_u32 s62, s61, 229376
  buffer_load_dwordx4 v100, s[16:19], s62 offen lds
  s_lshl_b32 s61, s36, 8
  s_add_u32 s61, s61, 2097152
  s_add_u32 s61, s61, s63
  s_add_u32 m0, s60, 65536
  s_add_u32 s62, s61, 0
  buffer_load_dwordx4 v100, s[16:19], s62 offen lds
  s_add_u32 m0, s60, 66560
  s_add_u32 s62, s61, 32768
  buffer_load_dwordx4 v100, s[16:19], s62 offen lds
  s_add_u32 m0, s60, 67584
  s_add_u32 s62, s61, 65536
  buffer_load_dwordx4 v100, s[16:19], s62 offen lds
  s_add_u32 m0, s60, 68608
  s_add_u32 s62, s61, 98304
  buffer_load_dwordx4 v100, s[16:19], s62 offen lds
  s_add_u32 m0, s60, 69632
  s_add_u32 s62, s61, 131072
  buffer_load_dwordx4 v100, s[16:19], s62 offen lds
  s_add_u32 m0, s60, 70656
  s_add_u32 s62, s61, 163840
  buffer_load_dwordx4 v100, s[16:19], s62 offen lds
  s_add_u32 m0, s60, 71680
  s_add_u32 s62, s61, 196608
  buffer_load_dwordx4 v100, s[16:19], s62 offen lds
  s_add_u32 m0, s60, 72704
  s_add_u32 s62, s61, 229376
  buffer_load_dwordx4 v100, s[16:19], s62 offen lds
  s_waitcnt vmcnt(16)
  s_barrier
  s_lshl_b32 s61, s36, 8
  s_add_u32 s61, s61, 3145728
  s_add_u32 s61, s61, s63
  s_add_u32 m0, s60, 98304
  s_add_u32 s62, s61, 0
  buffer_load_dwordx4 v100, s[16:19], s62 offen lds
  s_add_u32 m0, s60, 99328
  s_add_u32 s62, s61, 32768
  buffer_load_dwordx4 v100, s[16:19], s62 offen lds
  s_add_u32 m0, s60, 100352
  s_add_u32 s62, s61, 65536
  buffer_load_dwordx4 v100, s[16:19], s62 offen lds
  s_add_u32 m0, s60, 101376
  s_add_u32 s62, s61, 98304
  buffer_load_dwordx4 v100, s[16:19], s62 offen lds
  s_add_u32 m0, s60, 102400
  s_add_u32 s62, s61, 131072
  buffer_load_dwordx4 v100, s[16:19], s62 offen lds
  s_add_u32 m0, s60, 103424
  s_add_u32 s62, s61, 163840
  buffer_load_dwordx4 v100, s[16:19], s62 offen lds
  s_add_u32 m0, s60, 104448
  s_add_u32 s62, s61, 196608
  buffer_load_dwordx4 v100, s[16:19], s62 offen lds
  s_add_u32 m0, s60, 105472
  s_add_u32 s62, s61, 229376
  buffer_load_dwordx4 v100, s[16:19], s62 offen lds
  ds_read_b64_tr_b16 a[0:1], v104 offset:0
  ds_read_b64_tr_b16 a[2:3], v104 offset:1024
  ds_read_b64_tr_b16 a[4:5], v104 offset:4096
  ds_read_b64_tr_b16 a[6:7], v104 offset:5120
  ds_read_b64_tr_b16 a[8:9], v104 offset:8192
  ds_read_b64_tr_b16 a[10:11], v104 offset:9216
  ds_read_b64_tr_b16 a[12:13], v104 offset:12288
  ds_read_b64_tr_b16 a[14:15], v104 offset:13312
  ds_read_b64_tr_b16 a[16:17], v104 offset:16384
  ds_read_b64_tr_b16 a[18:19], v104 offset:17408
  ds_read_b64_tr_b16 a[20:21], v104 offset:20480
  ds_read_b64_tr_b16 a[22:23], v104 offset:21504
  ds_read_b64_tr_b16 a[24:25], v104 offset:24576
  ds_read_b64_tr_b16 a[26:27], v104 offset:25600
  ds_read_b64_tr_b16 a[28:29], v104 offset:28672
  ds_read_b64_tr_b16 a[30:31], v104 offset:29696
  s_waitcnt lgkmcnt(0)
  v_mfma_f32_32x32x16_bf16 v[32:47], v[80:83], a[0:3], 0
  v_mfma_f32_32x32x16_bf16 v[32:47], v[80:83], a[4:7], v[32:47]
  v_mfma_f32_32x32x16_bf16 v[32:47], v[80:83], a[8:11], v[32:47]
  v_mfma_f32_32x32x16_bf16 v[32:47], v[80:83], a[12:15], v[32:47]
  v_mfma_f32_32x32x16_bf16 v[32:47], v[80:83], a[16:19], v[32:47]
  v_mfma_f32_32x32x16_bf16 v[32:47], v[80:83], a[20:23], v[32:47]
  v_mfma_f32_32x32x16_bf16 v[32:47], v[80:83], a[24:27], v[32:47]
  v_mfma_f32_32x32x16_bf16 v[32:47], v[80:83], a[28:31], v[32:47]
  s_waitcnt vmcnt(16)
  s_barrier
  s_lshl_b32 s61, s36, 8
  s_add_u32 s61, s61, 0
  s_add_u32 s61, s61, s63
  s_add_u32 m0, s60, 0
  s_add_u32 s62, s61, 0
  buffer_load_dwordx4 v100, s[20:23], s62 offen lds
  s_add_u32 m0, s60, 1024
  s_add_u32 s62, s61, 32768
  buffer_load_dwordx4 v100, s[20:23], s62 offen lds
  s_add_u32 m0, s60, 2048
  s_add_u32 s62, s61, 65536
  buffer_load_dwordx4 v100, s[20:23], s62 offen lds
  s_add_u32 m0, s60, 3072
  s_add_u32 s62, s61, 98304
  buffer_load_dwordx4 v100, s[20:23], s62 offen lds
  s_add_u32 m0, s60, 4096
  s_add_u32 s62, s61, 131072
  buffer_load_dwordx4 v100, s[20:23], s62 offen lds
  s_add_u32 m0, s60, 5120
  s_add_u32 s62, s61, 163840
  buffer_load_dwordx4 v100, s[20:23], s62 offen lds
  s_add_u32 m0, s60, 6144
  s_add_u32 s62, s61, 196608
  buffer_load_dwordx4 v100, s[20:23], s62 offen lds
  s_add_u32 m0, s60, 7168
  s_add_u32 s62, s61, 229376
  buffer_load_dwordx4 v100, s[20:23], s62 offen lds
  ds_read_b64_tr_b16 a[32:33], v104 offset:32768
  ds_read_b64_tr_b16 a[34:35], v104 offset:33792
  ds_read_b64_tr_b16 a[36:37], v104 offset:36864
  ds_read_b64_tr_b16 a[38:39], v104 offset:37888
  ds_read_b64_tr_b16 a[40:41], v104 offset:40960
  ds_read_b64_tr_b16 a[42:43], v104 offset:41984
  ds_read_b64_tr_b16 a[44:45], v104 offset:45056
  ds_read_b64_tr_b16 a[46:47], v104 offset:46080
  ds_read_b64_tr_b16 a[48:49], v104 offset:49152
  ds_read_b64_tr_b16 a[50:51], v104 offset:50176
  ds_read_b64_tr_b16 a[52:53], v104 offset:53248
  ds_read_b64_tr_b16 a[54:55], v104 offset:54272
  ds_read_b64_tr_b16 a[56:57], v104 offset:57344
  ds_read_b64_tr_b16 a[58:59], v104 offset:58368
  ds_read_b64_tr_b16 a[60:61], v104 offset:61440
  ds_read_b64_tr_b16 a[62:63], v104 offset:62464
  s_waitcnt lgkmcnt(0)
  v_mfma_f32_32x32x16_bf16 v[32:47], v[80:83], a[32:35], v[32:47]
  v_mfma_f32_32x32x16_bf16 v[32:47], v[80:83], a[36:39], v[32:47]
  v_mfma_f32_32x32x16_bf16 v[32:47], v[80:83], a[40:43], v[32:47]
  v_mfma_f32_32x32x16_bf16 v[32:47], v[80:83], a[44:47], v[32:47]
  v_mfma_f32_32x32x16_bf16 v[32:47], v[80:83], a[48:51], v[32:47]
  v_mfma_f32_32x32x16_bf16 v[32:47], v[80:83], a[52:55], v[32:47]
  v_mfma_f32_32x32x16_bf16 v[32:47], v[80:83], a[56:59], v[32:47]
  v_mfma_f32_32x32x16_bf16 v[32:47], v[80:83], a[60:63], v[32:47]
  s_waitcnt vmcnt(16)
  s_barrier
  s_lshl_b32 s61, s36, 8
  s_add_u32 s61, s61, 1048576
  s_add_u32 s61, s61, s63
  s_add_u32 m0, s60, 32768
  s_add_u32 s62, s61, 0
  buffer_load_dwordx4 v100, s[20:23], s62 offen lds
  s_add_u32 m0, s60, 33792
  s_add_u32 s62, s61, 32768
  buffer_load_dwordx4 v100, s[20:23], s62 offen lds
  s_add_u32 m0, s60, 34816
  s_add_u32 s62, s61, 65536
  buffer_load_dwordx4 v100, s[20:23], s62 offen lds
  s_add_u32 m0, s60, 35840
  s_add_u32 s62, s61, 98304
  buffer_load_dwordx4 v100, s[20:23], s62 offen lds
  s_add_u32 m0, s60, 36864
  s_add_u32 s62, s61, 131072
  buffer_load_dwordx4 v100, s[20:23], s62 offen lds
  s_add_u32 m0, s60, 37888
  s_add_u32 s62, s61, 163840
  buffer_load_dwordx4 v100, s[20:23], s62 offen lds
  s_add_u32 m0, s60, 38912
  s_add_u32 s62, s61, 196608
  buffer_load_dwordx4 v100, s[20:23], s62 offen lds
  s_add_u32 m0, s60, 39936
  s_add_u32 s62, s61, 229376
  buffer_load_dwordx4 v100, s[20:23], s62 offen lds
  ds_read_b64_tr_b16 a[64:65], v105 offset:0
  ds_read_b64_tr_b16 a[66:67], v105 offset:1024
  ds_read_b64_tr_b16 a[68:69], v105 offset:4096
  ds_read_b64_tr_b16 a[70:71], v105 offset:5120
  ds_read_b64_tr_b16 a[72:73], v105 offset:8192
  ds_read_b64_tr_b16 a[74:75], v105 offset:9216
  ds_read_b64_tr_b16 a[76:77], v105 offset:12288
  ds_read_b64_tr_b16 a[78:79], v105 offset:13312
  ds_read_b64_tr_b16 a[80:81], v105 offset:16384
  ds_read_b64_tr_b16 a[82:83], v105 offset:17408
  ds_read_b64_tr_b16 a[84:85], v105 offset:20480
  ds_read_b64_tr_b16 a[86:87], v105 offset:21504
  ds_read_b64_tr_b16 a[88:89], v105 offset:24576
  ds_read_b64_tr_b16 a[90:91], v105 offset:25600
  ds_read_b64_tr_b16 a[92:93], v105 offset:28672
  ds_read_b64_tr_b16 a[94:95], v105 offset:29696
  s_waitcnt lgkmcnt(0)
  v_mfma_f32_32x32x16_bf16 v[32:47], v[80:83], a[64:67], v[32:47]
  v_mfma_f32_32x32x16_bf16 v[32:47], v[80:83], a[68:71], v[32:47]
  v_mfma_f32_32x32x16_bf16 v[32:47], v[80:83], a[72:75], v[32:47]
  v_mfma_f32_32x32x16_bf16 v[32:47], v[80:83], a[76:79], v[32:47]
  v_mfma_f32_32x32x16_bf16 v[32:47], v[80:83], a[80:83], v[32:47]
  v_mfma_f32_32x32x16_bf16 v[32:47], v[80:83], a[84:87], v[32:47]
  v_mfma_f32_32x32x16_bf16 v[32:47], v[80:83], a[88:91], v[32:47]
  v_mfma_f32_32x32x16_bf16 v[32:47], v[80:83], a[92:95], v[32:47]
  s_waitcnt vmcnt(16)
  s_barrier
  s_lshl_b32 s61, s36, 8
  s_add_u32 s61, s61, 2097152
  s_add_u32 s61, s61, s63
  s_add_u32 m0, s60, 65536
  s_add_u32 s62, s61, 0
  buffer_load_dwordx4 v100, s[20:23], s62 offen lds
  s_add_u32 m0, s60, 66560
  s_add_u32 s62, s61, 32768
  buffer_load_dwordx4 v100, s[20:23], s62 offen lds
  s_add_u32 m0, s60, 67584
  s_add_u32 s62, s61, 65536
  buffer_load_dwordx4 v100, s[20:23], s62 offen lds
  s_add_u32 m0, s60, 68608
  s_add_u32 s62, s61, 98304
  buffer_load_dwordx4 v100, s[20:23], s62 offen lds
  s_add_u32 m0, s60, 69632
  s_add_u32 s62, s61, 131072
  buffer_load_dwordx4 v100, s[20:23], s62 offen lds
  s_add_u32 m0, s60, 70656
  s_add_u32 s62, s61, 163840
  buffer_load_dwordx4 v100, s[20:23], s62 offen lds
  s_add_u32 m0, s60, 71680
  s_add_u32 s62, s61, 196608
  buffer_load_dwordx4 v100, s[20:23], s62 offen lds
  s_add_u32 m0, s60, 72704
  s_add_u32 s62, s61, 229376
  buffer_load_dwordx4 v100, s[20:23], s62 offen lds
  ds_read_b64_tr_b16 a[96:97], v105 offset:32768
  ds_read_b64_tr_b16 a[98:99], v105 offset:33792
  ds_read_b64_tr_b16 a[100:101], v105 offset:36864
  ds_read_b64_tr_b16 a[102:103], v105 offset:37888
  ds_read_b64_tr_b16 a[104:105], v105 offset:40960
  ds_read_b64_tr_b16 a[106:107], v105 offset:41984
  ds_read_b64_tr_b16 a[108:109], v105 offset:45056
  ds_read_b64_tr_b16 a[110:111], v105 offset:46080
  ds_read_b64_tr_b16 a[112:113], v105 offset:49152
  ds_read_b64_tr_b16 a[114:115], v105 offset:50176
  ds_read_b64_tr_b16 a[116:117], v105 offset:53248
  ds_read_b64_tr_b16 a[118:119], v105 offset:54272
  ds_read_b64_tr_b16 a[120:121], v105 offset:57344
  ds_read_b64_tr_b16 a[122:123], v105 offset:58368
  ds_read_b64_tr_b16 a[124:125], v105 offset:61440
  ds_read_b64_tr_b16 a[126:127], v105 offset:62464
  s_waitcnt lgkmcnt(0)
  v_mfma_f32_32x32x16_bf16 v[32:47], v[80:83], a[96:99], v[32:47]
  v_mfma_f32_32x32x16_bf16 v[32:47], v[80:83], a[100:103], v[32:47]
  v_mfma_f32_32x32x16_bf16 v[32:47], v[80:83], a[104:107], v[32:47]
  v_mfma_f32_32x32x16_bf16 v[32:47], v[80:83], a[108:111], v[32:47]
  v_mfma_f32_32x32x16_bf16 v[32:47], v[80:83], a[112:115], v[32:47]
  v_mfma_f32_32x32x16_bf16 v[32:47], v[80:83], a[116:119], v[32:47]
  v_mfma_f32_32x32x16_bf16 v[32:47], v[80:83], a[120:123], v[32:47]
  v_mfma_f32_32x32x16_bf16 v[32:47], v[80:83], a[124:127], v[32:47]
  s_waitcnt vmcnt(16)
  s_barrier
  s_lshl_b32 s61, s36, 8
  s_add_u32 s61, s61, 3145728
  s_add_u32 s61, s61, s63
  s_add_u32 m0, s60, 98304
  s_add_u32 s62, s61, 0
  buffer_load_dwordx4 v100, s[20:23], s62 offen lds
  s_add_u32 m0, s60, 99328
  s_add_u32 s62, s61, 32768
  buffer_load_dwordx4 v100, s[20:23], s62 offen lds
  s_add_u32 m0, s60, 100352
  s_add_u32 s62, s61, 65536
  buffer_load_dwordx4 v100, s[20:23], s62 offen lds
  s_add_u32 m0, s60, 101376
  s_add_u32 s62, s61, 98304
  buffer_load_dwordx4 v100, s[20:23], s62 offen lds
  s_add_u32 m0, s60, 102400
  s_add_u32 s62, s61, 131072
  buffer_load_dwordx4 v100, s[20:23], s62 offen lds
  s_add_u32 m0, s60, 103424
  s_add_u32 s62, s61, 163840
  buffer_load_dwordx4 v100, s[20:23], s62 offen lds
  s_add_u32 m0, s60, 104448
  s_add_u32 s62, s61, 196608
  buffer_load_dwordx4 v100, s[20:23], s62 offen lds
  s_add_u32 m0, s60, 105472
  s_add_u32 s62, s61, 229376
  buffer_load_dwordx4 v100, s[20:23], s62 offen lds
  ds_read_b64_tr_b16 a[128:129], v104 offset:0
  ds_read_b64_tr_b16 a[130:131], v104 offset:1024
  ds_read_b64_tr_b16 a[132:133], v104 offset:4096
  ds_read_b64_tr_b16 a[134:135], v104 offset:5120
  ds_read_b64_tr_b16 a[136:137], v104 offset:8192
  ds_read_b64_tr_b16 a[138:139], v104 offset:9216
  ds_read_b64_tr_b16 a[140:141], v104 offset:12288
  ds_read_b64_tr_b16 a[142:143], v104 offset:13312
  ds_read_b64_tr_b16 a[144:145], v104 offset:16384
  ds_read_b64_tr_b16 a[146:147], v104 offset:17408
  ds_read_b64_tr_b16 a[148:149], v104 offset:20480
  ds_read_b64_tr_b16 a[150:151], v104 offset:21504
  ds_read_b64_tr_b16 a[152:153], v104 offset:24576
  ds_read_b64_tr_b16 a[154:155], v104 offset:25600
  ds_read_b64_tr_b16 a[156:157], v104 offset:28672
  ds_read_b64_tr_b16 a[158:159], v104 offset:29696
  s_waitcnt lgkmcnt(0)
  v_mfma_f32_32x32x16_bf16 v[48:63], v[80:83], a[128:131], 0
  v_mfma_f32_32x32x16_bf16 v[48:63], v[80:83], a[132:135], v[48:63]
  v_mfma_f32_32x32x16_bf16 v[48:63], v[80:83], a[136:139], v[48:63]
  v_mfma_f32_32x32x16_bf16 v[48:63], v[80:83], a[140:143], v[48:63]
  v_mfma_f32_32x32x16_bf16 v[48:63], v[80:83], a[144:147], v[48:63]
  v_mfma_f32_32x32x16_bf16 v[48:63], v[80:83], a[148:151], v[48:63]
  v_mfma_f32_32x32x16_bf16 v[48:63], v[80:83], a[152:155], v[48:63]
  v_mfma_f32_32x32x16_bf16 v[48:63], v[80:83], a[156:159], v[48:63]
  s_waitcnt vmcnt(16)
  s_barrier
  s_lshl_b32 s61, s36, 8
  s_add_u32 s61, s61, 0
  s_add_u32 s61, s61, s63
  s_add_u32 m0, s60, 0
  s_add_u32 s62, s61, 0
  buffer_load_dwordx4 v100, s[24:27], s62 offen lds
  s_add_u32 m0, s60, 1024
  s_add_u32 s62, s61, 32768
  buffer_load_dwordx4 v100, s[24:27], s62 offen lds
  s_add_u32 m0, s60, 2048
  s_add_u32 s62, s61, 65536
  buffer_load_dwordx4 v100, s[24:27], s62 offen lds
  s_add_u32 m0, s60, 3072
  s_add_u32 s62, s61, 98304
  buffer_load_dwordx4 v100, s[24:27], s62 offen lds
  s_add_u32 m0, s60, 4096
  s_add_u32 s62, s61, 131072
  buffer_load_dwordx4 v100, s[24:27], s62 offen lds
  s_add_u32 m0, s60, 5120
  s_add_u32 s62, s61, 163840
  buffer_load_dwordx4 v100, s[24:27], s62 offen lds
  s_add_u32 m0, s60, 6144
  s_add_u32 s62, s61, 196608
  buffer_load_dwordx4 v100, s[24:27], s62 offen lds
  s_add_u32 m0, s60, 7168
  s_add_u32 s62, s61, 229376
  buffer_load_dwordx4 v100, s[24:27], s62 offen lds
  ds_read_b64_tr_b16 a[160:161], v104 offset:32768
  ds_read_b64_tr_b16 a[162:163], v104 offset:33792
  ds_read_b64_tr_b16 a[164:165], v104 offset:36864
  ds_read_b64_tr_b16 a[166:167], v104 offset:37888
  ds_read_b64_tr_b16 a[168:169], v104 offset:40960
  ds_read_b64_tr_b16 a[170:171], v104 offset:41984
  ds_read_b64_tr_b16 a[172:173], v104 offset:45056
  ds_read_b64_tr_b16 a[174:175], v104 offset:46080
  ds_read_b64_tr_b16 a[176:177], v104 offset:49152
  ds_read_b64_tr_b16 a[178:179], v104 offset:50176
  ds_read_b64_tr_b16 a[180:181], v104 offset:53248
  ds_read_b64_tr_b16 a[182:183], v104 offset:54272
  ds_read_b64_tr_b16 a[184:185], v104 offset:57344
  ds_read_b64_tr_b16 a[186:187], v104 offset:58368
  ds_read_b64_tr_b16 a[188:189], v104 offset:61440
  ds_read_b64_tr_b16 a[190:191], v104 offset:62464
  s_waitcnt lgkmcnt(0)
  v_mfma_f32_32x32x16_bf16 v[48:63], v[80:83], a[160:163], v[48:63]
  v_mfma_f32_32x32x16_bf16 v[48:63], v[80:83], a[164:167], v[48:63]
  v_mfma_f32_32x32x16_bf16 v[48:63], v[80:83], a[168:171], v[48:63]
  v_mfma_f32_32x32x16_bf16 v[48:63], v[80:83], a[172:175], v[48:63]
  v_mfma_f32_32x32x16_bf16 v[48:63], v[80:83], a[176:179], v[48:63]
  v_mfma_f32_32x32x16_bf16 v[48:63], v[80:83], a[180:183], v[48:63]
  v_mfma_f32_32x32x16_bf16 v[48:63], v[80:83], a[184:187], v[48:63]
  v_mfma_f32_32x32x16_bf16 v[48:63], v[80:83], a[188:191], v[48:63]
  s_waitcnt vmcnt(16)
  s_barrier
  s_lshl_b32 s61, s36, 8
  s_add_u32 s61, s61, 1048576
  s_add_u32 s61, s61, s63
  s_add_u32 m0, s60, 32768
  s_add_u32 s62, s61, 0
  buffer_load_dwordx4 v100, s[24:27], s62 offen lds
  s_add_u32 m0, s60, 33792
  s_add_u32 s62, s61, 32768
  buffer_load_dwordx4 v100, s[24:27], s62 offen lds
  s_add_u32 m0, s60, 34816
  s_add_u32 s62, s61, 65536
  buffer_load_dwordx4 v100, s[24:27], s62 offen lds
  s_add_u32 m0, s60, 35840
  s_add_u32 s62, s61, 98304
  buffer_load_dwordx4 v100, s[24:27], s62 offen lds
  s_add_u32 m0, s60, 36864
  s_add_u32 s62, s61, 131072
  buffer_load_dwordx4 v100, s[24:27], s62 offen lds
  s_add_u32 m0, s60, 37888
  s_add_u32 s62, s61, 163840
  buffer_load_dwordx4 v100, s[24:27], s62 offen lds
  s_add_u32 m0, s60, 38912
  s_add_u32 s62, s61, 196608
  buffer_load_dwordx4 v100, s[24:27], s62 offen lds
  s_add_u32 m0, s60, 39936
  s_add_u32 s62, s61, 229376
  buffer_load_dwordx4 v100, s[24:27], s62 offen lds
  ds_read_b64_tr_b16 a[192:193], v105 offset:0
  ds_read_b64_tr_b16 a[194:195], v105 offset:1024
  ds_read_b64_tr_b16 a[196:197], v105 offset:4096
  ds_read_b64_tr_b16 a[198:199], v105 offset:5120
  ds_read_b64_tr_b16 a[200:201], v105 offset:8192
  ds_read_b64_tr_b16 a[202:203], v105 offset:9216
  ds_read_b64_tr_b16 a[204:205], v105 offset:12288
  ds_read_b64_tr_b16 a[206:207], v105 offset:13312
  ds_read_b64_tr_b16 a[208:209], v105 offset:16384
  ds_read_b64_tr_b16 a[210:211], v105 offset:17408
  ds_read_b64_tr_b16 a[212:213], v105 offset:20480
  ds_read_b64_tr_b16 a[214:215], v105 offset:21504
  ds_read_b64_tr_b16 a[216:217], v105 offset:24576
  ds_read_b64_tr_b16 a[218:219], v105 offset:25600
  ds_read_b64_tr_b16 a[220:221], v105 offset:28672
  ds_read_b64_tr_b16 a[222:223], v105 offset:29696
  s_waitcnt lgkmcnt(0)
  v_mfma_f32_32x32x16_bf16 v[48:63], v[80:83], a[192:195], v[48:63]
  v_mfma_f32_32x32x16_bf16 v[48:63], v[80:83], a[196:199], v[48:63]
  v_mfma_f32_32x32x16_bf16 v[48:63], v[80:83], a[200:203], v[48:63]
  v_mfma_f32_32x32x16_bf16 v[48:63], v[80:83], a[204:207], v[48:63]
  v_mfma_f32_32x32x16_bf16 v[48:63], v[80:83], a[208:211], v[48:63]
  v_mfma_f32_32x32x16_bf16 v[48:63], v[80:83], a[212:215], v[48:63]
  v_mfma_f32_32x32x16_bf16 v[48:63], v[80:83], a[216:219], v[48:63]
  v_mfma_f32_32x32x16_bf16 v[48:63], v[80:83], a[220:223], v[48:63]
  s_waitcnt vmcnt(16)
  s_barrier
  s_lshl_b32 s61, s36, 8
  s_add_u32 s61, s61, 2097152
  s_add_u32 s61, s61, s63
  s_add_u32 m0, s60, 65536
  s_add_u32 s62, s61, 0
  buffer_load_dwordx4 v100, s[24:27], s62 offen lds
  s_add_u32 m0, s60, 66560
  s_add_u32 s62, s61, 32768
  buffer_load_dwordx4 v100, s[24:27], s62 offen lds
  s_add_u32 m0, s60, 67584
  s_add_u32 s62, s61, 65536
  buffer_load_dwordx4 v100, s[24:27], s62 offen lds
  s_add_u32 m0, s60, 68608
  s_add_u32 s62, s61, 98304
  buffer_load_dwordx4 v100, s[24:27], s62 offen lds
  s_add_u32 m0, s60, 69632
  s_add_u32 s62, s61, 131072
  buffer_load_dwordx4 v100, s[24:27], s62 offen lds
  s_add_u32 m0, s60, 70656
  s_add_u32 s62, s61, 163840
  buffer_load_dwordx4 v100, s[24:27], s62 offen lds
  s_add_u32 m0, s60, 71680
  s_add_u32 s62, s61, 196608
  buffer_load_dwordx4 v100, s[24:27], s62 offen lds
  s_add_u32 m0, s60, 72704
  s_add_u32 s62, s61, 229376
  buffer_load_dwordx4 v100, s[24:27], s62 offen lds
  ds_read_b64_tr_b16 a[224:225], v105 offset:32768
  ds_read_b64_tr_b16 a[226:227], v105 offset:33792
  ds_read_b64_tr_b16 a[228:229], v105 offset:36864
  ds_read_b64_tr_b16 a[230:231], v105 offset:37888
  ds_read_b64_tr_b16 a[232:233], v105 offset:40960
  ds_read_b64_tr_b16 a[234:235], v105 offset:41984
  ds_read_b64_tr_b16 a[236:237], v105 offset:45056
  ds_read_b64_tr_b16 a[238:239], v105 offset:46080
  ds_read_b64_tr_b16 a[240:241], v105 offset:49152
  ds_read_b64_tr_b16 a[242:243], v105 offset:50176
  ds_read_b64_tr_b16 a[244:245], v105 offset:53248
  ds_read_b64_tr_b16 a[246:247], v105 offset:54272
  ds_read_b64_tr_b16 a[248:249], v105 offset:57344
  ds_read_b64_tr_b16 a[250:251], v105 offset:58368
  ds_read_b64_tr_b16 a[252:253], v105 offset:61440
  ds_read_b64_tr_b16 a[254:255], v105 offset:62464
  s_waitcnt lgkmcnt(0)
  v_mfma_f32_32x32x16_bf16 v[48:63], v[80:83], a[224:227], v[48:63]
  v_mfma_f32_32x32x16_bf16 v[48:63], v[80:83], a[228:231], v[48:63]
  v_mfma_f32_32x32x16_bf16 v[48:63], v[80:83], a[232:235], v[48:63]
  v_mfma_f32_32x32x16_bf16 v[48:63], v[80:83], a[236:239], v[48:63]
  v_mfma_f32_32x32x16_bf16 v[48:63], v[80:83], a[240:243], v[48:63]
  v_mfma_f32_32x32x16_bf16 v[48:63], v[80:83], a[244:247], v[48:63]
  v_mfma_f32_32x32x16_bf16 v[48:63], v[80:83], a[248:251], v[48:63]
  v_mfma_f32_32x32x16_bf16 v[48:63], v[80:83], a[252:255], v[48:63]
  s_waitcnt vmcnt(16)
  s_barrier
  s_lshl_b32 s61, s36, 8
  s_add_u32 s61, s61, 3145728
  s_add_u32 s61, s61, s63
  s_add_u32 m0, s60, 98304
  s_add_u32 s62, s61, 0
  buffer_load_dwordx4 v100, s[24:27], s62 offen lds
  s_add_u32 m0, s60, 99328
  s_add_u32 s62, s61, 32768
  buffer_load_dwordx4 v100, s[24:27], s62 offen lds
  s_add_u32 m0, s60, 100352
  s_add_u32 s62, s61, 65536
  buffer_load_dwordx4 v100, s[24:27], s62 offen lds
  s_add_u32 m0, s60, 101376
  s_add_u32 s62, s61, 98304
  buffer_load_dwordx4 v100, s[24:27], s62 offen lds
  s_add_u32 m0, s60, 102400
  s_add_u32 s62, s61, 131072
  buffer_load_dwordx4 v100, s[24:27], s62 offen lds
  s_add_u32 m0, s60, 103424
  s_add_u32 s62, s61, 163840
  buffer_load_dwordx4 v100, s[24:27], s62 offen lds
  s_add_u32 m0, s60, 104448
  s_add_u32 s62, s61, 196608
  buffer_load_dwordx4 v100, s[24:27], s62 offen lds
  s_add_u32 m0, s60, 105472
  s_add_u32 s62, s61, 229376
  buffer_load_dwordx4 v100, s[24:27], s62 offen lds
  ds_read_b64_tr_b16 v[128:129], v104 offset:0
  ds_read_b64_tr_b16 v[130:131], v104 offset:1024
  ds_read_b64_tr_b16 v[132:133], v104 offset:4096
  ds_read_b64_tr_b16 v[134:135], v104 offset:5120
  ds_read_b64_tr_b16 v[136:137], v104 offset:8192
  ds_read_b64_tr_b16 v[138:139], v104 offset:9216
  ds_read_b64_tr_b16 v[140:141], v104 offset:12288
  ds_read_b64_tr_b16 v[142:143], v104 offset:13312
  ds_read_b64_tr_b16 v[144:145], v104 offset:16384
  ds_read_b64_tr_b16 v[146:147], v104 offset:17408
  ds_read_b64_tr_b16 v[148:149], v104 offset:20480
  ds_read_b64_tr_b16 v[150:151], v104 offset:21504
  ds_read_b64_tr_b16 v[152:153], v104 offset:24576
  ds_read_b64_tr_b16 v[154:155], v104 offset:25600
  ds_read_b64_tr_b16 v[156:157], v104 offset:28672
  ds_read_b64_tr_b16 v[158:159], v104 offset:29696
  s_waitcnt lgkmcnt(0)
  v_mfma_f32_32x32x16_bf16 v[64:79], v[80:83], v[128:131], 0
  v_mfma_f32_32x32x16_bf16 v[64:79], v[80:83], v[132:135], v[64:79]
  v_mfma_f32_32x32x16_bf16 v[64:79], v[80:83], v[136:139], v[64:79]
  v_mfma_f32_32x32x16_bf16 v[64:79], v[80:83], v[140:143], v[64:79]
  v_mfma_f32_32x32x16_bf16 v[64:79], v[80:83], v[144:147], v[64:79]
  v_mfma_f32_32x32x16_bf16 v[64:79], v[80:83], v[148:151], v[64:79]
  v_mfma_f32_32x32x16_bf16 v[64:79], v[80:83], v[152:155], v[64:79]
  v_mfma_f32_32x32x16_bf16 v[64:79], v[80:83], v[156:159], v[64:79]
  s_waitcnt vmcnt(16)
  s_barrier
  ds_read_b64_tr_b16 v[160:161], v104 offset:32768
  ds_read_b64_tr_b16 v[162:163], v104 offset:33792
  ds_read_b64_tr_b16 v[164:165], v104 offset:36864
  ds_read_b64_tr_b16 v[166:167], v104 offset:37888
  ds_read_b64_tr_b16 v[168:169], v104 offset:40960
  ds_read_b64_tr_b16 v[170:171], v104 offset:41984
  ds_read_b64_tr_b16 v[172:173], v104 offset:45056
  ds_read_b64_tr_b16 v[174:175], v104 offset:46080
  ds_read_b64_tr_b16 v[176:177], v104 offset:49152
  ds_read_b64_tr_b16 v[178:179], v104 offset:50176
  ds_read_b64_tr_b16 v[180:181], v104 offset:53248
  ds_read_b64_tr_b16 v[182:183], v104 offset:54272
  ds_read_b64_tr_b16 v[184:185], v104 offset:57344
  ds_read_b64_tr_b16 v[186:187], v104 offset:58368
  ds_read_b64_tr_b16 v[188:189], v104 offset:61440
  ds_read_b64_tr_b16 v[190:191], v104 offset:62464
  s_waitcnt lgkmcnt(0)
  v_mfma_f32_32x32x16_bf16 v[64:79], v[80:83], v[160:163], v[64:79]
  v_mfma_f32_32x32x16_bf16 v[64:79], v[80:83], v[164:167], v[64:79]
  v_mfma_f32_32x32x16_bf16 v[64:79], v[80:83], v[168:171], v[64:79]
  v_mfma_f32_32x32x16_bf16 v[64:79], v[80:83], v[172:175], v[64:79]
  v_mfma_f32_32x32x16_bf16 v[64:79], v[80:83], v[176:179], v[64:79]
  v_mfma_f32_32x32x16_bf16 v[64:79], v[80:83], v[180:183], v[64:79]
  v_mfma_f32_32x32x16_bf16 v[64:79], v[80:83], v[184:187], v[64:79]
  v_mfma_f32_32x32x16_bf16 v[64:79], v[80:83], v[188:191], v[64:79]
  s_waitcnt vmcnt(8)
  s_barrier
  ds_read_b64_tr_b16 v[192:193], v105 offset:0
  ds_read_b64_tr_b16 v[194:195], v105 offset:1024
  ds_read_b64_tr_b16 v[196:197], v105 offset:4096
  ds_read_b64_tr_b16 v[198:199], v105 offset:5120
  ds_read_b64_tr_b16 v[200:201], v105 offset:8192
  ds_read_b64_tr_b16 v[202:203], v105 offset:9216
  ds_read_b64_tr_b16 v[204:205], v105 offset:12288
  ds_read_b64_tr_b16 v[206:207], v105 offset:13312
  ds_read_b64_tr_b16 v[208:209], v105 offset:16384
  ds_read_b64_tr_b16 v[210:211], v105 offset:17408
  ds_read_b64_tr_b16 v[212:213], v105 offset:20480
  ds_read_b64_tr_b16 v[214:215], v105 offset:21504
  ds_read_b64_tr_b16 v[216:217], v105 offset:24576
  ds_read_b64_tr_b16 v[218:219], v105 offset:25600
  ds_read_b64_tr_b16 v[220:221], v105 offset:28672
  ds_read_b64_tr_b16 v[222:223], v105 offset:29696
  s_waitcnt lgkmcnt(0)
  v_mfma_f32_32x32x16_bf16 v[64:79], v[80:83], v[192:195], v[64:79]
  v_mfma_f32_32x32x16_bf16 v[64:79], v[80:83], v[196:199], v[64:79]
  v_mfma_f32_32x32x16_bf16 v[64:79], v[80:83], v[200:203], v[64:79]
  v_mfma_f32_32x32x16_bf16 v[64:79], v[80:83], v[204:207], v[64:79]
  v_mfma_f32_32x32x16_bf16 v[64:79], v[80:83], v[208:211], v[64:79]
  v_mfma_f32_32x32x16_bf16 v[64:79], v[80:83], v[212:215], v[64:79]
  v_mfma_f32_32x32x16_bf16 v[64:79], v[80:83], v[216:219], v[64:79]
  v_mfma_f32_32x32x16_bf16 v[64:79], v[80:83], v[220:223], v[64:79]
  s_waitcnt vmcnt(0)
  s_barrier
  ds_read_b64_tr_b16 v[224:225], v105 offset:32768
  ds_read_b64_tr_b16 v[226:227], v105 offset:33792
  ds_read_b64_tr_b16 v[228:229], v105 offset:36864
  ds_read_b64_tr_b16 v[230:231], v105 offset:37888
  ds_read_b64_tr_b16 v[232:233], v105 offset:40960
  ds_read_b64_tr_b16 v[234:235], v105 offset:41984
  ds_read_b64_tr_b16 v[236:237], v105 offset:45056
  ds_read_b64_tr_b16 v[238:239], v105 offset:46080
  ds_read_b64_tr_b16 v[240:241], v105 offset:49152
  ds_read_b64_tr_b16 v[242:243], v105 offset:50176
  ds_read_b64_tr_b16 v[244:245], v105 offset:53248
  ds_read_b64_tr_b16 v[246:247], v105 offset:54272
  ds_read_b64_tr_b16 v[248:249], v105 offset:57344
  ds_read_b64_tr_b16 v[250:251], v105 offset:58368
  ds_read_b64_tr_b16 v[252:253], v105 offset:61440
  ds_read_b64_tr_b16 v[254:255], v105 offset:62464
  s_waitcnt lgkmcnt(0)
  v_mfma_f32_32x32x16_bf16 v[64:79], v[80:83], v[224:227], v[64:79]
  v_mfma_f32_32x32x16_bf16 v[64:79], v[80:83], v[228:231], v[64:79]
  v_mfma_f32_32x32x16_bf16 v[64:79], v[80:83], v[232:235], v[64:79]
  v_mfma_f32_32x32x16_bf16 v[64:79], v[80:83], v[236:239], v[64:79]
  v_mfma_f32_32x32x16_bf16 v[64:79], v[80:83], v[240:243], v[64:79]
  v_mfma_f32_32x32x16_bf16 v[64:79], v[80:83], v[244:247], v[64:79]
  v_mfma_f32_32x32x16_bf16 v[64:79], v[80:83], v[248:251], v[64:79]
  v_mfma_f32_32x32x16_bf16 v[64:79], v[80:83], v[252:255], v[64:79]
  s_barrier
  v_bfe_u32 v16, v0, 4, 4
  v_lshrrev_b32 v17, 8, v0
  v_lshrrev_b32 v114, 2, v0
  v_bfe_u32 v18, v0, 6, 2
  v_lshrrev_b32 v19, 9, v0
  v_lshl_or_b32 v18, v19, 3, v18
  v_lshlrev_b32 v18, 6, v18
  v_and_b32 v20, 1, v17
  v_lshl_or_b32 v18, v20, 5, v18
  v_and_b32 v20, 3, v16
  v_lshl_or_b32 v1, v20, 3, v18
  v_and_b32 v18, 7, v16
  v_lshrrev_b32 v20, 3, v16
  v_lshl_or_b32 v18, v20, 4, v18
  v_lshlrev_b32 v18, 4, v18
  v_lshl_add_u32 v18, v17, 9, v18
  v_add_u32 v2, 73728, v18
  s_and_b32 s6, s3, 1
  s_lshl_b32 s6, s6, 8
  v_lshlrev_b32 v18, 4, v16
  v_lshl_or_b32 v18, v17, 9, v18
  v_add_u32 v113, s6, v18
  v_add_u32 v3, 65536, v113
  s_lshr_b32 s7, s3, 1
  s_lshl_b32 s6, s7, 12
  s_add_u32 s6, s6, 81920
  v_add_u32 v4, s6, v18
  s_lshl_b32 s6, s3, 11
  s_add_u32 s6, s6, 32768
  v_add_u32 v112, s6, v0
  v_mul_u32_u24 v18, 1088, v17
  v_lshl_add_u32 v18, v16, 3, v18
  s_lshl_b32 s6, s3, 8
  s_add_u32 s6, s6, 57344
  v_add_u32 v5, s6, v18
  s_lshl_b32 s6, s7, 9
  s_add_u32 s6, s6, 57344
  v_add_u32 v7, s6, v18
  v_and_b32 v18, 3, v16
  v_mul_u32_u24 v18, 1088, v18
  v_bfe_u32 v20, v0, 6, 3
  v_lshl_add_u32 v18, v20, 3, v18
  v_lshl_add_u32 v18, v19, 7, v18
  v_add_u32 v6, 57344, v18
  s_lshl_b32 s6, s3, 7
  s_add_u32 s6, s6, 61952
  v_lshlrev_b32 v18, 4, v19
  v_add_u32 v8, s6, v18
  v_and_b32 v18, 0x7c, v114
  v_add_u32 v9, s6, v18
  v_lshlrev_b32 v18, 1, v18
  v_add_u32 v15, 62464, v18
  s_lshl_b32 s6, s3, 13
  v_add_u32 v14, s6, v1
  v_mov_b32 v10, 0x3f803f80
  v_mov_b32 v11, 0x3f803f80
  s_and_b32 s6, s3, 1
  s_lshl_b32 s6, s6, 4
  v_add_u32 v16, s6, v16
  v_lshlrev_b32 v18, 4, v19
  v_and_b32 v20, 1, v17
  v_lshl_or_b32 v18, v20, 2, v18
  v_sub_u32 v16, v16, v18
  v_mov_b32 v17, 0xf149f2ca
  v_cmp_gt_i32 vcc, 0, v16
  s_nop 1
  v_cndmask_b32 v24, 0, v17, vcc
  v_cmp_gt_i32 vcc, 1, v16
  s_nop 1
  v_cndmask_b32 v25, 0, v17, vcc
  v_cmp_gt_i32 vcc, 2, v16
  s_nop 1
  v_cndmask_b32 v26, 0, v17, vcc
  v_cmp_gt_i32 vcc, 3, v16
  s_nop 1
  v_cndmask_b32 v27, 0, v17, vcc
  v_cmp_gt_i32 vcc, 8, v16
  s_nop 1
  v_cndmask_b32 v28, 0, v17, vcc
  v_cmp_gt_i32 vcc, 9, v16
  s_nop 1
  v_cndmask_b32 v29, 0, v17, vcc
  v_cmp_gt_i32 vcc, 10, v16
  s_nop 1
  v_cndmask_b32 v30, 0, v17, vcc
  v_cmp_gt_i32 vcc, 11, v16
  s_nop 1
  v_cndmask_b32 v31, 0, v17, vcc
  v_cmp_gt_u32 vcc, 512, v0
  v_cvt_pk_bf16_f32 v33, v32, v32
  v_and_b32 v33, 0xffff0000, v33
  v_sub_f32 v32, v32, v33
  v_cvt_pk_bf16_f32 v32, v32, v33
  v_cndmask_b32 v16, 0, v32, vcc
  v_cvt_pk_bf16_f32 v49, v48, v48
  v_and_b32 v49, 0xffff0000, v49
  v_sub_f32 v48, v48, v49
  v_cvt_pk_bf16_f32 v48, v48, v49
  v_cndmask_b32 v17, 0, v48, vcc
  v_cvt_pk_bf16_f32 v65, v64, v64
  v_and_b32 v65, 0xffff0000, v65
  v_sub_f32 v64, v64, v65
  v_cvt_pk_bf16_f32 v64, v64, v65
  v_cndmask_b32 v18, 0, v64, vcc
  v_mov_b32 v19, 0
  v_mov_b32 v21, 0
  v_mov_b32 v22, 0
  s_mov_b32 s7, 0
  v_mbcnt_lo_u32_b32 v92, -1, 0
  v_and_b32 v92, 3, v92
  v_lshlrev_b32 v92, 6, v92
L_wd_90:
  buffer_load_dword v93, v92, s[12:15], 0 offen offset:16 sc1
  s_waitcnt vmcnt(0)
  v_cmp_ne_u32 vcc, 64, v93
  s_cbranch_vccz L_wdo_91
  s_add_u32 s7, s7, 1
  s_cmp_lt_u32 s7, 131072
  s_cbranch_scc1 L_wd_90
  s_mov_b32 s6, 20
  s_branch L_err
L_wdo_91:
  s_mov_b32 s32, 0
  s_mov_b32 s52, 0
  s_mov_b32 s33, s37
  s_add_u32 s49, s33, 1
  s_cmp_lg_u32 s35, 0
  s_cbranch_scc1 L_p1_92
  s_mov_b32 s7, 0
L_pl_93:
  buffer_load_dwordx4 v[32:35], v0, s[8:11], s44 offen offset:0 sc1
  buffer_load_dwordx4 v[36:39], v0, s[8:11], s44 offen offset:1024 sc1
  s_waitcnt vmcnt(0)
  v_min3_u32 v32, v32, v33, v34
  v_min3_u32 v35, v35, v36, v37
  v_min3_u32 v32, v32, v38, v39
  v_min_u32 v32, v32, v35
  v_cmp_gt_u32 vcc, s49, v32
  s_cbranch_vccz L_plo_94
  s_add_u32 s7, s7, 1
  s_cmp_lt_u32 s7, 131072
  s_cbranch_scc1 L_pl_93
  s_mov_b32 s6, 21
  s_branch L_err
L_plo_94:
L_p1_92:
L_p_xwait:
  s_mov_b32 s7, 0
L_pl_95:
  buffer_load_dword v92, v114, s[8:11], s44 offen offset:0 sc1
  s_waitcnt vmcnt(0)
  v_cmp_gt_u32 vcc, s49, v92
  s_cbranch_vccz L_plo_96
  s_add_u32 s7, s7, 1
  s_cmp_lt_u32 s7, 131072
  s_cbranch_scc1 L_pl_95
  s_mov_b32 s6, 22
  s_branch L_err
L_plo_96:
  s_sub_u32 s6, s49, 1
  s_lshl_b32 s6, s6, 15
  s_add_u32 s45, s38, s6
  s_mov_b32 m0, s53
  s_add_u32 s6, s45, 4096
  buffer_load_dwordx4 v0, s[8:11], s45 offen offset:0 lds
  buffer_load_dwordx4 v0, s[8:11], s45 offen offset:1024 lds
  buffer_load_dwordx4 v0, s[8:11], s45 offen offset:2048 lds
  buffer_load_dwordx4 v0, s[8:11], s45 offen offset:3072 lds
  s_add_u32 m0, s53, 4096
  s_nop 0
  buffer_load_dwordx4 v0, s[8:11], s6 offen offset:0 lds
  buffer_load_dwordx4 v0, s[8:11], s6 offen offset:1024 lds
  buffer_load_dwordx4 v0, s[8:11], s6 offen offset:2048 lds
  buffer_load_dwordx4 v0, s[8:11], s6 offen offset:3072 lds
  s_waitcnt vmcnt(0)
L_p_loop:
  s_barrier
  s_and_b32 s6, s33, 3
  s_lshl_b32 s6, s6, 19
  s_add_u32 s46, s39, s6
  s_lshr_b32 s6, s33, 2
  s_andn2_b32 s42, 1, s6
  s_add_u32 s49, s33, 3
  s_lshl_b32 s7, s3, 8
  ds_read_b64_tr_b16 v[80:81], v1 offset:0
  ds_read_b64_tr_b16 v[82:83], v1 offset:256
  ds_read_b64_tr_b16 v[84:85], v1 offset:1024
  ds_read_b64_tr_b16 v[86:87], v1 offset:1280
  ds_read_b64_tr_b16 v[96:97], v14 offset:0
  ds_read_b64_tr_b16 v[98:99], v14 offset:256
  v_mov_b32 v92, 0
  v_mov_b32 v93, 0
  v_add_u32 v108, s7, v15
  s_waitcnt lgkmcnt(4)
  v_mfma_f32_32x32x16_bf16 v[48:63], a[128:131], v[80:83], 0
  ds_read_b64_tr_b16 v[88:89], v1 offset:2048
  ds_read_b64_tr_b16 v[90:91], v1 offset:2304
  s_waitcnt lgkmcnt(2)
  ds_read_b64_tr_b16 v[100:101], v14 offset:1024
  ds_read_b64_tr_b16 v[102:103], v14 offset:1280
  v_lshlrev_b32 v104, 16, v96
  v_and_b32 v105, 0xffff0000, v96
  v_add_f32 v92, v92, v104
  v_mfma_f32_32x32x16_bf16 v[64:79], v[80:83], v[128:131], 0
  v_fmac_f32 v93, v104, v104
  v_add_f32 v92, v92, v105
  v_fmac_f32 v93, v105, v105
  v_lshlrev_b32 v106, 16, v97
  v_and_b32 v107, 0xffff0000, v97
  v_mfma_f32_32x32x16_bf16 v[48:63], a[132:135], v[84:87], v[48:63]
  ds_read_b64_tr_b16 v[80:81], v1 offset:3072
  ds_read_b64_tr_b16 v[82:83], v1 offset:3328
  v_add_f32 v92, v92, v106
  v_fmac_f32 v93, v106, v106
  v_add_f32 v92, v92, v107
  v_fmac_f32 v93, v107, v107
  v_mfma_f32_32x32x16_bf16 v[64:79], v[84:87], v[132:135], v[64:79]
  v_lshlrev_b32 v104, 16, v98
  v_and_b32 v105, 0xffff0000, v98
  v_add_f32 v92, v92, v104
  v_fmac_f32 v93, v104, v104
  s_waitcnt lgkmcnt(4)
  v_mfma_f32_32x32x16_bf16 v[48:63], a[136:139], v[88:91], v[48:63]
  ds_read_b64_tr_b16 v[84:85], v1 offset:4096
  ds_read_b64_tr_b16 v[86:87], v1 offset:4352
  v_add_f32 v92, v92, v105
  v_fmac_f32 v93, v105, v105
  v_lshlrev_b32 v106, 16, v99
  v_and_b32 v107, 0xffff0000, v99
  v_mfma_f32_32x32x16_bf16 v[64:79], v[88:91], v[136:139], v[64:79]
  v_add_f32 v92, v92, v106
  v_fmac_f32 v93, v106, v106
  v_add_f32 v92, v92, v107
  v_fmac_f32 v93, v107, v107
  s_waitcnt lgkmcnt(2)
  v_mfma_f32_32x32x16_bf16 v[48:63], a[140:143], v[80:83], v[48:63]
  ds_read_b64_tr_b16 v[88:89], v1 offset:5120
  ds_read_b64_tr_b16 v[90:91], v1 offset:5376
  ds_read_b64_tr_b16 v[96:97], v14 offset:2048
  ds_read_b64_tr_b16 v[98:99], v14 offset:2304
  v_lshlrev_b32 v104, 16, v100
  v_and_b32 v105, 0xffff0000, v100
  v_add_f32 v92, v92, v104
  v_mfma_f32_32x32x16_bf16 v[64:79], v[80:83], v[140:143], v[64:79]
  v_fmac_f32 v93, v104, v104
  v_add_f32 v92, v92, v105
  v_fmac_f32 v93, v105, v105
  v_lshlrev_b32 v106, 16, v101
  v_and_b32 v107, 0xffff0000, v101
  s_waitcnt lgkmcnt(4)
  v_mfma_f32_32x32x16_bf16 v[48:63], a[144:147], v[84:87], v[48:63]
  ds_read_b64_tr_b16 v[80:81], v1 offset:6144
  ds_read_b64_tr_b16 v[82:83], v1 offset:6400
  v_add_f32 v92, v92, v106
  v_fmac_f32 v93, v106, v106
  v_add_f32 v92, v92, v107
  v_fmac_f32 v93, v107, v107
  v_mfma_f32_32x32x16_bf16 v[64:79], v[84:87], v[144:147], v[64:79]
  v_lshlrev_b32 v104, 16, v102
  v_and_b32 v105, 0xffff0000, v102
  v_add_f32 v92, v92, v104
  v_fmac_f32 v93, v104, v104
  s_cmp_eq_u32 s52, 2
  s_cbranch_scc0 L_p_nof
  s_waitcnt vmcnt(0)
  s_mov_b64 exec, 1
  buffer_store_dword v126, v13, s[8:11], s43 offen sc1
  s_mov_b64 exec, -1
L_p_nof:
  s_waitcnt lgkmcnt(4)
  v_mfma_f32_32x32x16_bf16 v[48:63], a[148:151], v[88:91], v[48:63]
  ds_read_b64_tr_b16 v[84:85], v1 offset:7168
  ds_read_b64_tr_b16 v[86:87], v1 offset:7424
  v_add_f32 v92, v92, v105
  v_fmac_f32 v93, v105, v105
  v_lshlrev_b32 v106, 16, v103
  v_and_b32 v107, 0xffff0000, v103
  v_mfma_f32_32x32x16_bf16 v[64:79], v[88:91], v[148:151], v[64:79]
  v_add_f32 v92, v92, v106
  v_fmac_f32 v93, v106, v106
  v_add_f32 v92, v92, v107
  v_fmac_f32 v93, v107, v107
  s_waitcnt lgkmcnt(2)
  v_mfma_f32_32x32x16_bf16 v[48:63], a[152:155], v[80:83], v[48:63]
  ds_read_b64_tr_b16 v[88:89], v1 offset:8192
  ds_read_b64_tr_b16 v[90:91], v1 offset:8448
  ds_read_b64_tr_b16 v[100:101], v14 offset:3072
  ds_read_b64_tr_b16 v[102:103], v14 offset:3328
  v_lshlrev_b32 v104, 16, v96
  v_and_b32 v105, 0xffff0000, v96
  v_add_f32 v92, v92, v104
  v_mfma_f32_32x32x16_bf16 v[64:79], v[80:83], v[152:155], v[64:79]
  v_fmac_f32 v93, v104, v104
  v_add_f32 v92, v92, v105
  v_fmac_f32 v93, v105, v105
  v_lshlrev_b32 v106, 16, v97
  v_and_b32 v107, 0xffff0000, v97
  s_waitcnt lgkmcnt(4)
  v_mfma_f32_32x32x16_bf16 v[48:63], a[156:159], v[84:87], v[48:63]
  ds_read_b64_tr_b16 v[80:81], v1 offset:9216
  ds_read_b64_tr_b16 v[82:83], v1 offset:9472
  v_add_f32 v92, v92, v106
  v_fmac_f32 v93, v106, v106
  v_add_f32 v92, v92, v107
  v_fmac_f32 v93, v107, v107
  v_mfma_f32_32x32x16_bf16 v[64:79], v[84:87], v[156:159], v[64:79]
  v_lshlrev_b32 v104, 16, v98
  v_and_b32 v105, 0xffff0000, v98
  v_add_f32 v92, v92, v104
  v_fmac_f32 v93, v104, v104
  s_waitcnt lgkmcnt(4)
  v_mfma_f32_32x32x16_bf16 v[48:63], a[160:163], v[88:91], v[48:63]
  ds_read_b64_tr_b16 v[84:85], v1 offset:10240
  ds_read_b64_tr_b16 v[86:87], v1 offset:10496
  v_add_f32 v92, v92, v105
  v_fmac_f32 v93, v105, v105
  v_lshlrev_b32 v106, 16, v99
  v_and_b32 v107, 0xffff0000, v99
  v_mfma_f32_32x32x16_bf16 v[64:79], v[88:91], v[160:163], v[64:79]
  v_add_f32 v92, v92, v106
  v_fmac_f32 v93, v106, v106
  v_add_f32 v92, v92, v107
  v_fmac_f32 v93, v107, v107
  s_waitcnt lgkmcnt(2)
  v_mfma_f32_32x32x16_bf16 v[48:63], a[164:167], v[80:83], v[48:63]
  ds_read_b64_tr_b16 v[88:89], v1 offset:11264
  ds_read_b64_tr_b16 v[90:91], v1 offset:11520
  ds_read_b64_tr_b16 v[96:97], v14 offset:4096
  ds_read_b64_tr_b16 v[98:99], v14 offset:4352
  v_lshlrev_b32 v104, 16, v100
  v_and_b32 v105, 0xffff0000, v100
  v_add_f32 v92, v92, v104
  v_mfma_f32_32x32x16_bf16 v[64:79], v[80:83], v[164:167], v[64:79]
  v_fmac_f32 v93, v104, v104
  v_add_f32 v92, v92, v105
  v_fmac_f32 v93, v105, v105
  v_lshlrev_b32 v106, 16, v101
  v_and_b32 v107, 0xffff0000, v101
  s_waitcnt lgkmcnt(4)
  v_mfma_f32_32x32x16_bf16 v[48:63], a[168:171], v[84:87], v[48:63]
  ds_read_b64_tr_b16 v[80:81], v1 offset:12288
  ds_read_b64_tr_b16 v[82:83], v1 offset:12544
  v_add_f32 v92, v92, v106
  v_fmac_f32 v93, v106, v106
  v_add_f32 v92, v92, v107
  v_fmac_f32 v93, v107, v107
  v_mfma_f32_32x32x16_bf16 v[64:79], v[84:87], v[168:171], v[64:79]
  v_lshlrev_b32 v104, 16, v102
  v_and_b32 v105, 0xffff0000, v102
  v_add_f32 v92, v92, v104
  v_fmac_f32 v93, v104, v104
  s_waitcnt lgkmcnt(4)
  v_mfma_f32_32x32x16_bf16 v[48:63], a[172:175], v[88:91], v[48:63]
  ds_read_b64_tr_b16 v[84:85], v1 offset:13312
  ds_read_b64_tr_b16 v[86:87], v1 offset:13568
  v_add_f32 v92, v92, v105
  v_fmac_f32 v93, v105, v105
  v_lshlrev_b32 v106, 16, v103
  v_and_b32 v107, 0xffff0000, v103
  v_mfma_f32_32x32x16_bf16 v[64:79], v[88:91], v[172:175], v[64:79]
  v_add_f32 v92, v92, v106
  v_fmac_f32 v93, v106, v106
  v_add_f32 v92, v92, v107
  v_fmac_f32 v93, v107, v107
  s_waitcnt lgkmcnt(2)
  v_mfma_f32_32x32x16_bf16 v[48:63], a[176:179], v[80:83], v[48:63]
  ds_read_b64_tr_b16 v[88:89], v1 offset:14336
  ds_read_b64_tr_b16 v[90:91], v1 offset:14592
  ds_read_b64_tr_b16 v[100:101], v14 offset:5120
  ds_read_b64_tr_b16 v[102:103], v14 offset:5376
  v_lshlrev_b32 v104, 16, v96
  v_and_b32 v105, 0xffff0000, v96
  v_add_f32 v92, v92, v104
  v_mfma_f32_32x32x16_bf16 v[64:79], v[80:83], v[176:179], v[64:79]
  v_fmac_f32 v93, v104, v104
  v_add_f32 v92, v92, v105
  v_fmac_f32 v93, v105, v105
  v_lshlrev_b32 v106, 16, v97
  v_and_b32 v107, 0xffff0000, v97
  s_waitcnt lgkmcnt(4)
  v_mfma_f32_32x32x16_bf16 v[48:63], a[180:183], v[84:87], v[48:63]
  ds_read_b64_tr_b16 v[80:81], v1 offset:15360
  ds_read_b64_tr_b16 v[82:83], v1 offset:15616
  v_add_f32 v92, v92, v106
  v_fmac_f32 v93, v106, v106
  v_add_f32 v92, v92, v107
  v_fmac_f32 v93, v107, v107
  v_mfma_f32_32x32x16_bf16 v[64:79], v[84:87], v[180:183], v[64:79]
  v_lshlrev_b32 v104, 16, v98
  v_and_b32 v105, 0xffff0000, v98
  v_add_f32 v92, v92, v104
  v_fmac_f32 v93, v104, v104
  s_waitcnt lgkmcnt(4)
  v_mfma_f32_32x32x16_bf16 v[48:63], a[184:187], v[88:91], v[48:63]
  ds_read_b64_tr_b16 v[84:85], v1 offset:16384
  ds_read_b64_tr_b16 v[86:87], v1 offset:16640
  v_add_f32 v92, v92, v105
  v_fmac_f32 v93, v105, v105
  v_lshlrev_b32 v106, 16, v99
  v_and_b32 v107, 0xffff0000, v99
  v_mfma_f32_32x32x16_bf16 v[64:79], v[88:91], v[184:187], v[64:79]
  v_add_f32 v92, v92, v106
  v_fmac_f32 v93, v106, v106
  v_add_f32 v92, v92, v107
  v_fmac_f32 v93, v107, v107
  s_waitcnt lgkmcnt(2)
  v_mfma_f32_32x32x16_bf16 v[48:63], a[188:191], v[80:83], v[48:63]
  ds_read_b64_tr_b16 v[88:89], v1 offset:17408
  ds_read_b64_tr_b16 v[90:91], v1 offset:17664
  ds_read_b64_tr_b16 v[96:97], v14 offset:6144
  ds_read_b64_tr_b16 v[98:99], v14 offset:6400
  v_lshlrev_b32 v104, 16, v100
  v_and_b32 v105, 0xffff0000, v100
  v_add_f32 v92, v92, v104
  v_mfma_f32_32x32x16_bf16 v[64:79], v[80:83], v[188:191], v[64:79]
  v_fmac_f32 v93, v104, v104
  v_add_f32 v92, v92, v105
  v_fmac_f32 v93, v105, v105
  v_lshlrev_b32 v106, 16, v101
  v_and_b32 v107, 0xffff0000, v101
  s_waitcnt lgkmcnt(4)
  v_mfma_f32_32x32x16_bf16 v[48:63], a[192:195], v[84:87], v[48:63]
  ds_read_b64_tr_b16 v[80:81], v1 offset:18432
  ds_read_b64_tr_b16 v[82:83], v1 offset:18688
  v_add_f32 v92, v92, v106
  v_fmac_f32 v93, v106, v106
  v_add_f32 v92, v92, v107
  v_fmac_f32 v93, v107, v107
  v_mfma_f32_32x32x16_bf16 v[64:79], v[84:87], v[192:195], v[64:79]
  v_lshlrev_b32 v104, 16, v102
  v_and_b32 v105, 0xffff0000, v102
  v_add_f32 v92, v92, v104
  v_fmac_f32 v93, v104, v104
  s_waitcnt lgkmcnt(4)
  v_mfma_f32_32x32x16_bf16 v[48:63], a[196:199], v[88:91], v[48:63]
  ds_read_b64_tr_b16 v[84:85], v1 offset:19456
  ds_read_b64_tr_b16 v[86:87], v1 offset:19712
  v_add_f32 v92, v92, v105
  v_fmac_f32 v93, v105, v105
  v_lshlrev_b32 v106, 16, v103
  v_and_b32 v107, 0xffff0000, v103
  v_mfma_f32_32x32x16_bf16 v[64:79], v[88:91], v[196:199], v[64:79]
  v_add_f32 v92, v92, v106
  v_fmac_f32 v93, v106, v106
  v_add_f32 v92, v92, v107
  v_fmac_f32 v93, v107, v107
  s_waitcnt lgkmcnt(2)
  v_mfma_f32_32x32x16_bf16 v[48:63], a[200:203], v[80:83], v[48:63]
  ds_read_b64_tr_b16 v[88:89], v1 offset:20480
  ds_read_b64_tr_b16 v[90:91], v1 offset:20736
  ds_read_b64_tr_b16 v[100:101], v14 offset:7168
  ds_read_b64_tr_b16 v[102:103], v14 offset:7424
  v_lshlrev_b32 v104, 16, v96
  v_and_b32 v105, 0xffff0000, v96
  v_add_f32 v92, v92, v104
  v_mfma_f32_32x32x16_bf16 v[64:79], v[80:83], v[200:203], v[64:79]
  v_fmac_f32 v93, v104, v104
  v_add_f32 v92, v92, v105
  v_fmac_f32 v93, v105, v105
  v_lshlrev_b32 v106, 16, v97
  v_and_b32 v107, 0xffff0000, v97
  s_waitcnt lgkmcnt(4)
  v_mfma_f32_32x32x16_bf16 v[48:63], a[204:207], v[84:87], v[48:63]
  ds_read_b64_tr_b16 v[80:81], v1 offset:21504
  ds_read_b64_tr_b16 v[82:83], v1 offset:21760
  v_add_f32 v92, v92, v106
  v_fmac_f32 v93, v106, v106
  v_add_f32 v92, v92, v107
  v_fmac_f32 v93, v107, v107
  v_mfma_f32_32x32x16_bf16 v[64:79], v[84:87], v[204:207], v[64:79]
  v_lshlrev_b32 v104, 16, v98
  v_and_b32 v105, 0xffff0000, v98
  v_add_f32 v92, v92, v104
  v_fmac_f32 v93, v104, v104
  s_waitcnt lgkmcnt(4)
  v_mfma_f32_32x32x16_bf16 v[48:63], a[208:211], v[88:91], v[48:63]
  ds_read_b64_tr_b16 v[84:85], v1 offset:22528
  ds_read_b64_tr_b16 v[86:87], v1 offset:22784
  v_add_f32 v92, v92, v105
  v_fmac_f32 v93, v105, v105
  v_lshlrev_b32 v106, 16, v99
  v_and_b32 v107, 0xffff0000, v99
  v_mfma_f32_32x32x16_bf16 v[64:79], v[88:91], v[208:211], v[64:79]
  v_add_f32 v92, v92, v106
  v_fmac_f32 v93, v106, v106
  v_add_f32 v92, v92, v107
  v_fmac_f32 v93, v107, v107
  s_waitcnt lgkmcnt(2)
  v_mfma_f32_32x32x16_bf16 v[48:63], a[212:215], v[80:83], v[48:63]
  ds_read_b64_tr_b16 v[88:89], v1 offset:23552
  ds_read_b64_tr_b16 v[90:91], v1 offset:23808
  v_lshlrev_b32 v104, 16, v100
  v_and_b32 v105, 0xffff0000, v100
  v_add_f32 v92, v92, v104
  v_fmac_f32 v93, v104, v104
  v_mfma_f32_32x32x16_bf16 v[64:79], v[80:83], v[212:215], v[64:79]
  v_add_f32 v92, v92, v105
  v_fmac_f32 v93, v105, v105
  v_lshlrev_b32 v106, 16, v101
  v_and_b32 v107, 0xffff0000, v101
  s_waitcnt lgkmcnt(2)
  v_mfma_f32_32x32x16_bf16 v[48:63], a[216:219], v[84:87], v[48:63]
  ds_read_b64_tr_b16 v[80:81], v1 offset:24576
  ds_read_b64_tr_b16 v[82:83], v1 offset:24832
  v_add_f32 v92, v92, v106
  v_fmac_f32 v93, v106, v106
  v_add_f32 v92, v92, v107
  v_fmac_f32 v93, v107, v107
  v_mfma_f32_32x32x16_bf16 v[64:79], v[84:87], v[216:219], v[64:79]
  v_lshlrev_b32 v104, 16, v102
  v_and_b32 v105, 0xffff0000, v102
  v_add_f32 v92, v92, v104
  v_fmac_f32 v93, v104, v104
  s_waitcnt lgkmcnt(2)
  v_mfma_f32_32x32x16_bf16 v[48:63], a[220:223], v[88:91], v[48:63]
  ds_read_b64_tr_b16 v[84:85], v1 offset:25600
  ds_read_b64_tr_b16 v[86:87], v1 offset:25856
  v_add_f32 v92, v92, v105
  v_fmac_f32 v93, v105, v105
  v_lshlrev_b32 v106, 16, v103
  v_and_b32 v107, 0xffff0000, v103
  v_mfma_f32_32x32x16_bf16 v[64:79], v[88:91], v[220:223], v[64:79]
  v_add_f32 v92, v92, v106
  v_fmac_f32 v93, v106, v106
  v_add_f32 v92, v92, v107
  v_fmac_f32 v93, v107, v107
  s_waitcnt lgkmcnt(2)
  v_mfma_f32_32x32x16_bf16 v[48:63], a[224:227], v[80:83], v[48:63]
  ds_read_b64_tr_b16 v[88:89], v1 offset:26624
  ds_read_b64_tr_b16 v[90:91], v1 offset:26880
  v_mov_b32 v94, v92
  v_mov_b32 v95, v93
  s_nop 0
  v_permlane32_swap_b32 v92, v94
  v_permlane32_swap_b32 v93, v95
  v_mfma_f32_32x32x16_bf16 v[64:79], v[80:83], v[224:227], v[64:79]
  v_add_f32 v92, v92, v94
  v_add_f32 v93, v93, v95
  ds_write_b64 v108, v[92:93]
  s_waitcnt lgkmcnt(3)
  v_mfma_f32_32x32x16_bf16 v[48:63], a[228:231], v[84:87], v[48:63]
  ds_read_b64_tr_b16 v[80:81], v1 offset:27648
  ds_read_b64_tr_b16 v[82:83], v1 offset:27904
  s_waitcnt lgkmcnt(2)
  s_barrier
  ds_read_b64 v[96:97], v15 offset:0
  v_mfma_f32_32x32x16_bf16 v[64:79], v[84:87], v[228:231], v[64:79]
  ds_read_b64 v[98:99], v15 offset:256
  ds_read_b64 v[100:101], v15 offset:512
  ds_read_b64 v[102:103], v15 offset:768
  v_mfma_f32_32x32x16_bf16 v[48:63], a[232:235], v[88:91], v[48:63]
  ds_read_b64_tr_b16 v[84:85], v1 offset:28672
  ds_read_b64_tr_b16 v[86:87], v1 offset:28928
  v_mfma_f32_32x32x16_bf16 v[64:79], v[88:91], v[232:235], v[64:79]
  s_waitcnt lgkmcnt(6)
  v_mfma_f32_32x32x16_bf16 v[48:63], a[236:239], v[80:83], v[48:63]
  ds_read_b64_tr_b16 v[88:89], v1 offset:29696
  ds_read_b64_tr_b16 v[90:91], v1 offset:29952
  s_waitcnt lgkmcnt(4)
  v_add_f32 v92, v96, v98
  v_add_f32 v93, v97, v99
  v_add_f32 v94, v100, v102
  v_mfma_f32_32x32x16_bf16 v[64:79], v[80:83], v[236:239], v[64:79]
  v_add_f32 v95, v101, v103
  v_add_f32 v92, v92, v94
  v_add_f32 v93, v93, v95
  v_mul_f32 v92, 0x3b000000, v92
  s_waitcnt lgkmcnt(2)
  v_mfma_f32_32x32x16_bf16 v[48:63], a[240:243], v[84:87], v[48:63]
  ds_read_b64_tr_b16 v[80:81], v1 offset:30720
  ds_read_b64_tr_b16 v[82:83], v1 offset:30976
  v_mul_f32 v94, v92, v92
  v_mul_f32 v93, 0x3b000000, v93
  v_sub_f32 v93, v93, v94
  v_max_f32 v93, 0, v93
  v_mfma_f32_32x32x16_bf16 v[64:79], v[84:87], v[240:243], v[64:79]
  v_cvt_pk_bf16_f32 v93, v93, v93
  v_and_b32 v93, 0xffff0000, v93
  v_add_f32 v93, 0x3727c5ac, v93
  v_cvt_pk_bf16_f32 v93, v93, v93
  s_waitcnt lgkmcnt(2)
  v_mfma_f32_32x32x16_bf16 v[48:63], a[244:247], v[88:91], v[48:63]
  ds_read_b64_tr_b16 v[84:85], v1 offset:31744
  ds_read_b64_tr_b16 v[86:87], v1 offset:32000
  v_and_b32 v93, 0xffff0000, v93
  v_sqrt_f32 v93, v93
  v_cvt_pk_bf16_f32 v92, v92, v92
  v_and_b32 v92, 0xffff0000, v92
  v_mfma_f32_32x32x16_bf16 v[64:79], v[88:91], v[244:247], v[64:79]
  v_cvt_pk_bf16_f32 v93, v93, v93
  v_and_b32 v93, 0xffff0000, v93
  v_rcp_f32 v93, v93
  v_xor_b32 v92, 0x80000000, v92
  s_waitcnt lgkmcnt(2)
  v_mfma_f32_32x32x16_bf16 v[48:63], a[248:251], v[80:83], v[48:63]
  ds_read_b64_tr_b16 v[88:89], v1 offset:0
  ds_read_b64_tr_b16 v[90:91], v1 offset:256
  v_lshrrev_b32 v94, 16, v92
  v_or_b32 v20, v92, v94
  v_or_b32 v23, v92, v94
  v_mfma_f32_32x32x16_bf16 v[64:79], v[80:83], v[248:251], v[64:79]
  v_mov_b32 v92, v93
  ds_write_b32 v9, v93
  s_waitcnt lgkmcnt(3)
  v_mfma_f32_32x32x16_bf16 v[48:63], a[252:255], v[84:87], v[48:63]
  ds_read_b64_tr_b16 v[80:81], v1 offset:1024
  ds_read_b64_tr_b16 v[82:83], v1 offset:1280
  ds_read_b128 v[96:99], v8 offset:0
  ds_read_b128 v[100:103], v8 offset:32
  v_mfma_f32_32x32x16_bf16 v[64:79], v[84:87], v[252:255], v[64:79]
  ds_read_b128 v[104:107], v8 offset:64
  ds_read_b128 v[108:111], v8 offset:96
  s_add_u32 s7, s46, 0x2000
  v_mfma_f32_32x32x8_bf16 v[48:63], v[16:17], v[22:23], v[48:63]
  v_mfma_f32_32x32x8_bf16 v[64:79], v[20:21], v[18:19], v[64:79]
  s_waitcnt lgkmcnt(7)
  v_mfma_f32_32x32x16_bf16 v[32:47], a[0:3], v[88:91], 0
  ds_read_b64_tr_b16 v[84:85], v1 offset:2048
  ds_read_b64_tr_b16 v[86:87], v1 offset:2304
  s_waitcnt lgkmcnt(6)
  v_mfma_f32_32x32x16_bf16 v[32:47], a[4:7], v[80:83], v[32:47]
  ds_read_b64_tr_b16 v[88:89], v1 offset:3072
  ds_read_b64_tr_b16 v[90:91], v1 offset:3328
  s_nop 2
  v_pk_mul_f32 v[48:49], v[48:49], v[92:93]
  v_pk_mul_f32 v[50:51], v[50:51], v[92:93]
  v_pk_mul_f32 v[52:53], v[52:53], v[92:93]
  v_pk_mul_f32 v[54:55], v[54:55], v[92:93]
  s_waitcnt lgkmcnt(2)
  v_mfma_f32_32x32x16_bf16 v[32:47], a[8:11], v[84:87], v[32:47]
  ds_read_b64_tr_b16 v[80:81], v1 offset:4096
  ds_read_b64_tr_b16 v[82:83], v1 offset:4352
  v_pk_mul_f32 v[56:57], v[56:57], v[92:93]
  v_pk_mul_f32 v[58:59], v[58:59], v[92:93]
  v_pk_mul_f32 v[60:61], v[60:61], v[92:93]
  v_pk_mul_f32 v[62:63], v[62:63], v[92:93]
  s_waitcnt lgkmcnt(2)
  v_mfma_f32_32x32x16_bf16 v[32:47], a[12:15], v[88:91], v[32:47]
  ds_read_b64_tr_b16 v[84:85], v1 offset:5120
  ds_read_b64_tr_b16 v[86:87], v1 offset:5376
  v_cvt_pk_bf16_f32 v48, v48, v49
  v_cvt_pk_bf16_f32 v49, v50, v51
  v_cvt_pk_bf16_f32 v50, v52, v53
  v_cvt_pk_bf16_f32 v51, v54, v55
  s_waitcnt lgkmcnt(2)
  v_mfma_f32_32x32x16_bf16 v[32:47], a[16:19], v[80:83], v[32:47]
  ds_read_b64_tr_b16 v[88:89], v1 offset:6144
  ds_read_b64_tr_b16 v[90:91], v1 offset:6400
  v_cvt_pk_bf16_f32 v52, v56, v57
  v_cvt_pk_bf16_f32 v53, v58, v59
  v_cvt_pk_bf16_f32 v54, v60, v61
  v_cvt_pk_bf16_f32 v55, v62, v63
  s_waitcnt lgkmcnt(2)
  v_mfma_f32_32x32x16_bf16 v[32:47], a[20:23], v[84:87], v[32:47]
  ds_read_b64_tr_b16 v[80:81], v1 offset:7168
  ds_read_b64_tr_b16 v[82:83], v1 offset:7424
  v_bfi_b32 v48, 1, s42, v48
  v_bfi_b32 v52, 1, s42, v52
  buffer_store_dwordx4 v[48:51], v0, s[8:11], s46 offen offset:0 sc1
  ds_write_b128 v112, v[48:51] offset:8192
  s_waitcnt lgkmcnt(3)
  v_mfma_f32_32x32x16_bf16 v[32:47], a[24:27], v[88:91], v[32:47]
  ds_read_b64_tr_b16 v[84:85], v1 offset:8192
  ds_read_b64_tr_b16 v[86:87], v1 offset:8448
  buffer_store_dwordx4 v[52:55], v0, s[8:11], s46 offen offset:1024 sc1
  ds_write_b128 v112, v[52:55] offset:9216
  v_pk_mul_f32 v[64:65], v[64:65], v[96:97]
  s_waitcnt lgkmcnt(4)
  v_mfma_f32_32x32x16_bf16 v[32:47], a[28:31], v[80:83], v[32:47]
  ds_read_b64_tr_b16 v[88:89], v1 offset:9216
  ds_read_b64_tr_b16 v[90:91], v1 offset:9472
  v_pk_mul_f32 v[66:67], v[66:67], v[98:99]
  v_pk_mul_f32 v[68:69], v[68:69], v[100:101]
  v_pk_mul_f32 v[70:71], v[70:71], v[102:103]
  v_pk_mul_f32 v[72:73], v[72:73], v[104:105]
  s_waitcnt lgkmcnt(3)
  v_mfma_f32_32x32x16_bf16 v[32:47], a[32:35], v[84:87], v[32:47]
  ds_read_b64_tr_b16 v[80:81], v1 offset:10240
  ds_read_b64_tr_b16 v[82:83], v1 offset:10496
  v_pk_mul_f32 v[74:75], v[74:75], v[106:107]
  v_pk_mul_f32 v[76:77], v[76:77], v[108:109]
  v_pk_mul_f32 v[78:79], v[78:79], v[110:111]
  v_cvt_pk_bf16_f32 v64, v64, v65
  s_waitcnt lgkmcnt(2)
  v_mfma_f32_32x32x16_bf16 v[32:47], a[36:39], v[88:91], v[32:47]
  ds_read_b64_tr_b16 v[84:85], v1 offset:11264
  ds_read_b64_tr_b16 v[86:87], v1 offset:11520
  v_cvt_pk_bf16_f32 v65, v66, v67
  v_cvt_pk_bf16_f32 v66, v68, v69
  v_cvt_pk_bf16_f32 v67, v70, v71
  v_cvt_pk_bf16_f32 v68, v72, v73
  s_waitcnt lgkmcnt(2)
  v_mfma_f32_32x32x16_bf16 v[32:47], a[40:43], v[80:83], v[32:47]
  ds_read_b64_tr_b16 v[88:89], v1 offset:12288
  ds_read_b64_tr_b16 v[90:91], v1 offset:12544
  v_cvt_pk_bf16_f32 v69, v74, v75
  v_cvt_pk_bf16_f32 v70, v76, v77
  v_cvt_pk_bf16_f32 v71, v78, v79
  v_bfi_b32 v64, 1, s42, v64
  s_waitcnt lgkmcnt(2)
  v_mfma_f32_32x32x16_bf16 v[32:47], a[44:47], v[84:87], v[32:47]
  ds_read_b64_tr_b16 v[80:81], v1 offset:13312
  ds_read_b64_tr_b16 v[82:83], v1 offset:13568
  v_bfi_b32 v68, 1, s42, v68
  buffer_store_dwordx4 v[64:67], v0, s[8:11], s7 offen offset:0 sc1
  ds_write_b128 v112, v[64:67] offset:16384
  buffer_store_dwordx4 v[68:71], v0, s[8:11], s7 offen offset:1024 sc1
  s_waitcnt lgkmcnt(3)
  v_mfma_f32_32x32x16_bf16 v[32:47], a[48:51], v[88:91], v[32:47]
  ds_read_b64_tr_b16 v[84:85], v1 offset:14336
  ds_read_b64_tr_b16 v[86:87], v1 offset:14592
  ds_write_b128 v112, v[68:71] offset:17408
  s_waitcnt lgkmcnt(4)
  v_mfma_f32_32x32x16_bf16 v[32:47], a[52:55], v[80:83], v[32:47]
  ds_read_b64_tr_b16 v[88:89], v1 offset:15360
  ds_read_b64_tr_b16 v[90:91], v1 offset:15616
  s_waitcnt lgkmcnt(3)
  v_mfma_f32_32x32x16_bf16 v[32:47], a[56:59], v[84:87], v[32:47]
  ds_read_b64_tr_b16 v[80:81], v1 offset:16384
  ds_read_b64_tr_b16 v[82:83], v1 offset:16640
  s_waitcnt lgkmcnt(2)
  v_mfma_f32_32x32x16_bf16 v[32:47], a[60:63], v[88:91], v[32:47]
  ds_read_b64_tr_b16 v[84:85], v1 offset:17408
  ds_read_b64_tr_b16 v[86:87], v1 offset:17664
  s_waitcnt lgkmcnt(2)
  v_mfma_f32_32x32x16_bf16 v[32:47], a[64:67], v[80:83], v[32:47]
  ds_read_b64_tr_b16 v[88:89], v1 offset:18432
  ds_read_b64_tr_b16 v[90:91], v1 offset:18688
  s_waitcnt lgkmcnt(2)
  v_mfma_f32_32x32x16_bf16 v[32:47], a[68:71], v[84:87], v[32:47]
  ds_read_b64_tr_b16 v[80:81], v1 offset:19456
  ds_read_b64_tr_b16 v[82:83], v1 offset:19712
  s_waitcnt lgkmcnt(2)
  v_mfma_f32_32x32x16_bf16 v[32:47], a[72:75], v[88:91], v[32:47]
  ds_read_b64_tr_b16 v[84:85], v1 offset:20480
  ds_read_b64_tr_b16 v[86:87], v1 offset:20736
  s_waitcnt lgkmcnt(2)
  v_mfma_f32_32x32x16_bf16 v[32:47], a[76:79], v[80:83], v[32:47]
  ds_read_b64_tr_b16 v[88:89], v1 offset:21504
  ds_read_b64_tr_b16 v[90:91], v1 offset:21760
  s_waitcnt lgkmcnt(2)
  v_mfma_f32_32x32x16_bf16 v[32:47], a[80:83], v[84:87], v[32:47]
  ds_read_b64_tr_b16 v[80:81], v1 offset:22528
  ds_read_b64_tr_b16 v[82:83], v1 offset:22784
  s_waitcnt lgkmcnt(2)
  v_mfma_f32_32x32x16_bf16 v[32:47], a[84:87], v[88:91], v[32:47]
  ds_read_b64_tr_b16 v[84:85], v1 offset:23552
  ds_read_b64_tr_b16 v[86:87], v1 offset:23808
  s_waitcnt lgkmcnt(2)
  v_mfma_f32_32x32x16_bf16 v[32:47], a[88:91], v[80:83], v[32:47]
  ds_read_b64_tr_b16 v[88:89], v1 offset:24576
  ds_read_b64_tr_b16 v[90:91], v1 offset:24832
  s_waitcnt lgkmcnt(2)
  v_mfma_f32_32x32x16_bf16 v[32:47], a[92:95], v[84:87], v[32:47]
  ds_read_b64_tr_b16 v[80:81], v1 offset:25600
  ds_read_b64_tr_b16 v[82:83], v1 offset:25856
  s_waitcnt lgkmcnt(2)
  v_mfma_f32_32x32x16_bf16 v[32:47], a[96:99], v[88:91], v[32:47]
  ds_read_b64_tr_b16 v[84:85], v1 offset:26624
  ds_read_b64_tr_b16 v[86:87], v1 offset:26880
  s_waitcnt lgkmcnt(2)
  v_mfma_f32_32x32x16_bf16 v[32:47], a[100:103], v[80:83], v[32:47]
  ds_read_b64_tr_b16 v[88:89], v1 offset:27648
  ds_read_b64_tr_b16 v[90:91], v1 offset:27904
  s_waitcnt lgkmcnt(2)
  v_mfma_f32_32x32x16_bf16 v[32:47], a[104:107], v[84:87], v[32:47]
  ds_read_b64_tr_b16 v[80:81], v1 offset:28672
  ds_read_b64_tr_b16 v[82:83], v1 offset:28928
  s_waitcnt lgkmcnt(2)
  v_mfma_f32_32x32x16_bf16 v[32:47], a[108:111], v[88:91], v[32:47]
  ds_read_b64_tr_b16 v[84:85], v1 offset:29696
  ds_read_b64_tr_b16 v[86:87], v1 offset:29952
  s_waitcnt lgkmcnt(2)
  v_mfma_f32_32x32x16_bf16 v[32:47], a[112:115], v[80:83], v[32:47]
  ds_read_b64_tr_b16 v[88:89], v1 offset:30720
  ds_read_b64_tr_b16 v[90:91], v1 offset:30976
  s_waitcnt lgkmcnt(2)
  v_mfma_f32_32x32x16_bf16 v[32:47], a[116:119], v[84:87], v[32:47]
  ds_read_b64_tr_b16 v[80:81], v1 offset:31744
  ds_read_b64_tr_b16 v[82:83], v1 offset:32000
  s_waitcnt lgkmcnt(2)
  v_mfma_f32_32x32x16_bf16 v[32:47], a[120:123], v[88:91], v[32:47]
  s_waitcnt lgkmcnt(0)
  v_mfma_f32_32x32x16_bf16 v[32:47], a[124:127], v[80:83], v[32:47]
  s_sub_u32 s51, s33, 2
  s_and_b32 s6, s51, 3
  s_lshl_b32 s6, s6, 17
  s_add_u32 s47, s40, s6
  s_lshr_b32 s6, s51, 2
  s_andn2_b32 s50, 1, s6
  s_lshl_b32 s6, s51, 18
  s_add_u32 s48, s41, s6
  s_add_u32 s51, s51, 1
  buffer_load_dwordx4 v[116:119], v0, s[8:11], s47 offen sc1
  buffer_load_dword v115, v114, s[8:11], s44 offen sc1
  v_mfma_f32_32x32x8_bf16 v[32:47], v[16:17], v[20:21], v[32:47]
  s_nop 11
  v_pk_mul_f32 v[32:33], v[32:33], v[92:93]
  v_pk_mul_f32 v[34:35], v[34:35], v[92:93]
  v_pk_mul_f32 v[36:37], v[36:37], v[92:93]
  v_pk_mul_f32 v[38:39], v[38:39], v[92:93]
  v_pk_mul_f32 v[40:41], v[40:41], v[92:93]
  v_pk_mul_f32 v[42:43], v[42:43], v[92:93]
  v_pk_mul_f32 v[44:45], v[44:45], v[92:93]
  v_pk_mul_f32 v[46:47], v[46:47], v[92:93]
  v_cvt_pk_bf16_f32 v32, v32, v33
  v_cvt_pk_bf16_f32 v33, v34, v35
  v_cvt_pk_bf16_f32 v34, v36, v37
  v_cvt_pk_bf16_f32 v35, v38, v39
  v_cvt_pk_bf16_f32 v36, v40, v41
  v_cvt_pk_bf16_f32 v37, v42, v43
  v_cvt_pk_bf16_f32 v38, v44, v45
  v_cvt_pk_bf16_f32 v39, v46, v47
  ds_write_b128 v112, v[32:35] offset:0
  ds_write_b128 v112, v[36:39] offset:1024
  s_cmp_eq_u32 s32, 0
  s_cbranch_scc1 L_p_first
L_p_att:
  ds_read_b128 v[64:67], v3 offset:0
  ds_read_b128 v[32:35], v2 offset:0
  ds_read_b128 v[48:51], v2 offset:128
  ds_read_b128 v[68:71], v3 offset:2048
  ds_read_b128 v[36:39], v2 offset:2048
  ds_read_b128 v[52:55], v2 offset:2176
  ds_read_b128 v[72:75], v3 offset:4096
  ds_read_b128 v[40:43], v2 offset:4096
  ds_read_b128 v[56:59], v2 offset:4224
  ds_read_b128 v[76:79], v3 offset:6144
  ds_read_b128 v[44:47], v2 offset:6144
  ds_read_b128 v[60:63], v2 offset:6272
  s_waitcnt lgkmcnt(9)
  v_mfma_f32_16x16x32_bf16 v[96:99], v[32:35], v[64:67], v[24:27]
  v_mfma_f32_16x16x32_bf16 v[100:103], v[48:51], v[64:67], v[28:31]
  s_waitcnt lgkmcnt(6)
  v_mfma_f32_16x16x32_bf16 v[96:99], v[36:39], v[68:71], v[96:99]
  v_mfma_f32_16x16x32_bf16 v[100:103], v[52:55], v[68:71], v[100:103]
  s_waitcnt lgkmcnt(3)
  v_mfma_f32_16x16x32_bf16 v[96:99], v[40:43], v[72:75], v[96:99]
  v_mfma_f32_16x16x32_bf16 v[100:103], v[56:59], v[72:75], v[100:103]
  s_waitcnt lgkmcnt(0)
  v_mfma_f32_16x16x32_bf16 v[96:99], v[44:47], v[76:79], v[96:99]
  v_mfma_f32_16x16x32_bf16 v[100:103], v[60:63], v[76:79], v[100:103]
  ds_read_b128 v[80:83], v4 offset:0
  ds_read_b128 v[84:87], v4 offset:256
  ds_read_b128 v[88:91], v4 offset:2048
  ds_read_b128 v[92:95], v4 offset:2304
  s_mov_b32 s52, 0
  s_barrier
  s_mov_b32 s7, 0
  s_waitcnt vmcnt(0)
L_p_km:
  v_bitop3_b32 v126, v116, s50, 1 bitop3:0x28
  v_cmp_ne_u32 vcc, 0, v126
  s_cbranch_vccz L_p_kmok
  buffer_load_dwordx4 v[116:119], v0, s[8:11], s47 offen sc1
  s_cmp_lg_u32 s52, 0
  s_cbranch_scc1 L_p_k0
  s_cmp_ge_u32 s32, 31
  s_cbranch_scc1 L_p_k0
  v_cmp_gt_u32 vcc, s49, v115
  s_cbranch_vccnz L_p_k1
  s_mov_b32 s52, 1
  s_sub_u32 s6, s49, 1
  s_lshl_b32 s6, s6, 15
  s_add_u32 s45, s38, s6
  s_mov_b32 m0, s53
  s_add_u32 s6, s45, 4096
  buffer_load_dwordx4 v0, s[8:11], s45 offen offset:0 lds
  buffer_load_dwordx4 v0, s[8:11], s45 offen offset:1024 lds
  buffer_load_dwordx4 v0, s[8:11], s45 offen offset:2048 lds
  buffer_load_dwordx4 v0, s[8:11], s45 offen offset:3072 lds
  s_add_u32 m0, s53, 4096
  s_nop 0
  buffer_load_dwordx4 v0, s[8:11], s6 offen offset:0 lds
  buffer_load_dwordx4 v0, s[8:11], s6 offen offset:1024 lds
  buffer_load_dwordx4 v0, s[8:11], s6 offen offset:2048 lds
  buffer_load_dwordx4 v0, s[8:11], s6 offen offset:3072 lds
  s_waitcnt vmcnt(8)
  s_branch L_p_k2
L_p_k1:
  buffer_load_dword v115, v114, s[8:11], s44 offen sc1
L_p_k0:
  s_waitcnt vmcnt(0)
L_p_k2:
  s_add_u32 s7, s7, 1
  s_cmp_lt_u32 s7, 131072
  s_cbranch_scc1 L_p_km
  s_mov_b32 s6, 23
  s_branch L_err
L_p_kmok:
  s_cmp_lg_u32 s52, 0
  s_cbranch_scc1 L_nx_97
  s_cmp_ge_u32 s32, 31
  s_cbranch_scc1 L_nx_97
  v_cmp_gt_u32 vcc, s49, v115
  s_cbranch_vccnz L_nx_98
  s_mov_b32 s52, 1
  s_sub_u32 s6, s49, 1
  s_lshl_b32 s6, s6, 15
  s_add_u32 s45, s38, s6
  s_mov_b32 m0, s53
  s_add_u32 s6, s45, 4096
  buffer_load_dwordx4 v0, s[8:11], s45 offen offset:0 lds
  buffer_load_dwordx4 v0, s[8:11], s45 offen offset:1024 lds
  buffer_load_dwordx4 v0, s[8:11], s45 offen offset:2048 lds
  buffer_load_dwordx4 v0, s[8:11], s45 offen offset:3072 lds
  s_add_u32 m0, s53, 4096
  s_nop 0
  buffer_load_dwordx4 v0, s[8:11], s6 offen offset:0 lds
  buffer_load_dwordx4 v0, s[8:11], s6 offen offset:1024 lds
  buffer_load_dwordx4 v0, s[8:11], s6 offen offset:2048 lds
  buffer_load_dwordx4 v0, s[8:11], s6 offen offset:3072 lds
  s_branch L_nx_97
L_nx_98:
  buffer_load_dword v115, v114, s[8:11], s44 offen sc1
L_nx_97:
  ds_write_b64 v5, v[116:117]
  ds_write_b64 v5, v[118:119] offset:128
  v_max3_f32 v124, v96, v97, v98
  v_max3_f32 v125, v100, v101, v102
  v_max3_f32 v124, v124, v99, v103
  s_waitcnt lgkmcnt(0)
  s_barrier
  ds_read_b64_tr_b16 v[32:33], v6 offset:0
  ds_read_b64_tr_b16 v[34:35], v6 offset:64
  ds_read_b64_tr_b16 v[36:37], v6 offset:256
  ds_read_b64_tr_b16 v[38:39], v6 offset:320
  ds_read_b64_tr_b16 v[40:41], v6 offset:512
  ds_read_b64_tr_b16 v[42:43], v6 offset:576
  ds_read_b64_tr_b16 v[44:45], v6 offset:768
  ds_read_b64_tr_b16 v[46:47], v6 offset:832
  ds_read_b64 v[48:49], v7 offset:0
  ds_read_b64 v[50:51], v7 offset:128
  ds_read_b64 v[52:53], v7 offset:256
  ds_read_b64 v[54:55], v7 offset:384
  s_waitcnt lgkmcnt(10)
  v_mfma_f32_16x16x32_bf16 v[104:107], v[32:35], v[64:67], 0
  s_waitcnt lgkmcnt(8)
  v_mfma_f32_16x16x32_bf16 v[104:107], v[36:39], v[68:71], v[104:107]
  s_waitcnt lgkmcnt(6)
  v_mfma_f32_16x16x32_bf16 v[104:107], v[40:43], v[72:75], v[104:107]
  s_waitcnt lgkmcnt(4)
  v_mfma_f32_16x16x32_bf16 v[104:107], v[44:47], v[76:79], v[104:107]
  v_max_f32 v124, v124, v125
  s_nop 6
  v_max3_f32 v124, v124, v106, v107
  v_mov_b32 v125, v124
  s_nop 1
  v_permlane32_swap_b32 v124, v125
  v_max_f32 v124, v124, v125
  v_max_f32 v125, v124, v125
  s_nop 1
  v_permlane16_swap_b32 v124, v125
  v_max_f32 v124, v124, v125
  v_mul_f32 v124, s34, v124
  v_fma_f32 v106, v106, s34, -v124
  v_fma_f32 v107, v107, s34, -v124
  v_fma_f32 v96, v96, s34, -v124
  v_fma_f32 v97, v97, s34, -v124
  v_fma_f32 v98, v98, s34, -v124
  v_fma_f32 v99, v99, s34, -v124
  v_fma_f32 v100, v100, s34, -v124
  v_fma_f32 v101, v101, s34, -v124
  v_fma_f32 v102, v102, s34, -v124
  v_fma_f32 v103, v103, s34, -v124
  v_exp_f32 v106, v106
  v_exp_f32 v107, v107
  v_exp_f32 v96, v96
  v_cvt_pk_bf16_f32 v12, v106, v107
  v_exp_f32 v97, v97
  s_waitcnt lgkmcnt(0)
  v_mfma_f32_16x16x16_bf16 v[108:111], v[10:11], v[12:13], 0
  v_mfma_f32_16x16x16_bf16 v[56:59], v[48:49], v[12:13], 0
  v_exp_f32 v98, v98
  v_exp_f32 v99, v99
  v_mfma_f32_16x16x16_bf16 v[60:63], v[50:51], v[12:13], 0
  v_exp_f32 v100, v100
  v_exp_f32 v101, v101
  v_mfma_f32_16x16x16_bf16 v[64:67], v[52:53], v[12:13], 0
  v_exp_f32 v102, v102
  v_exp_f32 v103, v103
  v_mfma_f32_16x16x16_bf16 v[68:71], v[54:55], v[12:13], 0
  v_cvt_pk_bf16_f32 v120, v96, v97
  v_cvt_pk_bf16_f32 v121, v98, v99
  v_cvt_pk_bf16_f32 v122, v100, v101
  v_cvt_pk_bf16_f32 v123, v102, v103
  v_mfma_f32_16x16x16_bf16 v[108:111], v[10:11], v[120:121], v[108:111]
  s_nop 0
  v_mfma_f32_16x16x16_bf16 v[108:111], v[10:11], v[122:123], v[108:111]
  v_mfma_f32_16x16x32_bf16 v[56:59], v[80:83], v[120:123], v[56:59]
  v_mfma_f32_16x16x32_bf16 v[60:63], v[84:87], v[120:123], v[60:63]
  v_mfma_f32_16x16x32_bf16 v[64:67], v[88:91], v[120:123], v[64:67]
  v_mfma_f32_16x16x32_bf16 v[68:71], v[92:95], v[120:123], v[68:71]
  s_nop 3
  v_rcp_f32 v108, v108
  v_mov_b32 v126, s51
  v_pk_mul_f32 v[56:57], v[56:57], v[108:109] op_sel_hi:[1,0]
  v_pk_mul_f32 v[58:59], v[58:59], v[108:109] op_sel_hi:[1,0]
  v_pk_mul_f32 v[60:61], v[60:61], v[108:109] op_sel_hi:[1,0]
  v_pk_mul_f32 v[62:63], v[62:63], v[108:109] op_sel_hi:[1,0]
  v_cvt_pk_bf16_f32 v56, v56, v57
  v_cvt_pk_bf16_f32 v57, v58, v59
  v_cvt_pk_bf16_f32 v58, v60, v61
  v_cvt_pk_bf16_f32 v59, v62, v63
  buffer_store_dwordx4 v[56:59], v113, s[8:11], s48 offen offset:0 sc1
  v_pk_mul_f32 v[64:65], v[64:65], v[108:109] op_sel_hi:[1,0]
  v_pk_mul_f32 v[66:67], v[66:67], v[108:109] op_sel_hi:[1,0]
  v_pk_mul_f32 v[68:69], v[68:69], v[108:109] op_sel_hi:[1,0]
  v_pk_mul_f32 v[70:71], v[70:71], v[108:109] op_sel_hi:[1,0]
  v_cvt_pk_bf16_f32 v64, v64, v65
  v_cvt_pk_bf16_f32 v65, v66, v67
  v_cvt_pk_bf16_f32 v66, v68, v69
  v_cvt_pk_bf16_f32 v67, v70, v71
  buffer_store_dwordx4 v[64:67], v113, s[8:11], s48 offen offset:2048 sc1
  s_cmp_ge_u32 s32, 31
  s_cbranch_scc1 L_p_of
  s_cmp_lg_u32 s52, 0
  s_cbranch_scc1 L_p_of3
  s_waitcnt vmcnt(2)
  v_cmp_gt_u32 vcc, s49, v115
  s_cbranch_vccnz L_p_of
  s_mov_b32 s52, 1
  s_sub_u32 s6, s49, 1
  s_lshl_b32 s6, s6, 15
  s_add_u32 s45, s38, s6
  s_mov_b32 m0, s53
  s_add_u32 s6, s45, 4096
  buffer_load_dwordx4 v0, s[8:11], s45 offen offset:0 lds
  buffer_load_dwordx4 v0, s[8:11], s45 offen offset:1024 lds
  buffer_load_dwordx4 v0, s[8:11], s45 offen offset:2048 lds
  buffer_load_dwordx4 v0, s[8:11], s45 offen offset:3072 lds
  s_add_u32 m0, s53, 4096
  s_nop 0
  buffer_load_dwordx4 v0, s[8:11], s6 offen offset:0 lds
  buffer_load_dwordx4 v0, s[8:11], s6 offen offset:1024 lds
  buffer_load_dwordx4 v0, s[8:11], s6 offen offset:2048 lds
  buffer_load_dwordx4 v0, s[8:11], s6 offen offset:3072 lds
  s_waitcnt vmcnt(8)
  s_mov_b64 exec, 1
  buffer_store_dword v126, v13, s[8:11], s43 offen sc1
  s_mov_b64 exec, -1
  s_waitcnt vmcnt(1)
  s_branch L_p_of2
L_p_of3:
  s_mov_b32 s52, 2
  s_waitcnt vmcnt(2)
  s_branch L_p_of2
L_p_of:
  s_waitcnt vmcnt(0)
  s_mov_b64 exec, 1
  buffer_store_dword v126, v13, s[8:11], s43 offen sc1
  s_mov_b64 exec, -1
L_p_of2:
L_p_next:
  v_xor_b32 v2, 0x18000, v2
  v_xor_b32 v3, 0x18000, v3
  v_xor_b32 v4, 0x18000, v4
  v_xor_b32 v112, 0x18000, v112
  s_add_u32 s32, s32, 1
  s_add_u32 s33, s33, 2
  s_cmp_gt_u32 s32, 32
  s_cbranch_scc1 L_p_end
  s_cmp_eq_u32 s32, 32
  s_cbranch_scc1 L_p_tail
  s_cmp_eq_u32 s52, 0
  s_cbranch_scc1 L_p_xwait
  s_branch L_p_loop
L_p_tail:
  s_sub_u32 s51, s33, 2
  s_and_b32 s6, s51, 3
  s_lshl_b32 s6, s6, 17
  s_add_u32 s47, s40, s6
  s_lshr_b32 s6, s51, 2
  s_andn2_b32 s50, 1, s6
  s_lshl_b32 s6, s51, 18
  s_add_u32 s48, s41, s6
  s_add_u32 s51, s51, 1
  buffer_load_dwordx4 v[116:119], v0, s[8:11], s47 offen sc1
  s_waitcnt vmcnt(0) lgkmcnt(0)
  s_barrier
  s_branch L_p_att
L_p_first:
  s_waitcnt vmcnt(0) lgkmcnt(0)
  s_barrier
  s_mov_b32 s52, 0
  s_cmp_ge_u32 s32, 31
  s_cbranch_scc1 L_nx_99
  v_cmp_gt_u32 vcc, s49, v115
  s_cbranch_vccnz L_nx_99
  s_mov_b32 s52, 1
  s_sub_u32 s6, s49, 1
  s_lshl_b32 s6, s6, 15
  s_add_u32 s45, s38, s6
  s_mov_b32 m0, s53
  s_add_u32 s6, s45, 4096
  buffer_load_dwordx4 v0, s[8:11], s45 offen offset:0 lds
  buffer_load_dwordx4 v0, s[8:11], s45 offen offset:1024 lds
  buffer_load_dwordx4 v0, s[8:11], s45 offen offset:2048 lds
  buffer_load_dwordx4 v0, s[8:11], s45 offen offset:3072 lds
  s_add_u32 m0, s53, 4096
  s_nop 0
  buffer_load_dwordx4 v0, s[8:11], s6 offen offset:0 lds
  buffer_load_dwordx4 v0, s[8:11], s6 offen offset:1024 lds
  buffer_load_dwordx4 v0, s[8:11], s6 offen offset:2048 lds
  buffer_load_dwordx4 v0, s[8:11], s6 offen offset:3072 lds
L_nx_99:
  s_cmp_lg_u32 s35, 0
  s_cbranch_scc1 L_p_f2
  s_mov_b32 s51, 127
  s_mov_b32 s7, 0
L_pl_101:
  buffer_load_dwordx4 v[32:35], v0, s[8:11], s44 offen offset:0 sc1
  buffer_load_dwordx4 v[36:39], v0, s[8:11], s44 offen offset:1024 sc1
  s_waitcnt vmcnt(0)
  v_min3_u32 v32, v32, v33, v34
  v_min3_u32 v35, v35, v36, v37
  v_min3_u32 v32, v32, v38, v39
  v_min_u32 v32, v32, v35
  v_cmp_gt_u32 vcc, s51, v32
  s_cbranch_vccz L_plo_102
  s_add_u32 s7, s7, 1
  s_cmp_lt_u32 s7, 131072
  s_cbranch_scc1 L_pl_101
  s_mov_b32 s6, 24
  s_branch L_err
L_plo_102:
L_p_f2:
  s_waitcnt vmcnt(0)
  s_branch L_p_next
L_p_end:
  s_waitcnt vmcnt(0)
  s_endpgm
L_o:
  s_lshr_b32 s33, s5, 4
  s_bfe_u32 s34, s5, 0x20002
  s_and_b32 s35, s5, 3
  s_mul_i32 s36, s33, 0x1000000
  s_add_u32 s36, s36, 0x6800000
  s_lshl_b32 s6, s34, 3
  s_lshl_b32 s7, s3, 1
  s_add_u32 s6, s6, s7
  s_lshl_b32 s7, s6, 13
  s_add_u32 s36, s36, s7
  s_lshl_b32 s6, s6, 7
  s_lshl_b32 s7, s33, 13
  s_add_u32 s6, s6, s7
  s_add_u32 s38, s6, 0x718000
  s_mul_i32 s37, s33, 0x800000
  s_add_u32 s37, s37, 0x8800000
  s_lshl_b32 s6, s34, 15
  s_add_u32 s37, s37, s6
  s_lshl_b32 s6, s35, 13
  s_add_u32 s37, s37, s6
  s_lshl_b32 s6, s3, 11
  s_add_u32 s37, s37, s6
  s_lshl_b32 s6, s35, 6
  s_lshl_b32 s7, s3, 4
  s_add_u32 s6, s6, s7
  s_lshl_b32 s7, s33, 8
  s_add_u32 s6, s6, s7
  s_add_u32 s39, s6, 0x710800
  s_lshl_b32 s42, s3, 14
  s_branch L_pro
L_o2:
  v_lshlrev_b32 v0, 4, v0
  s_mov_b32 s16, s88
  s_mov_b32 s17, s89
  s_mov_b32 s18, 0x400000
  s_mov_b32 s19, 0x20000
  v_lshrrev_b32 v104, 4, v0
  v_lshrrev_b32 v100, 8, v0
  v_lshlrev_b32 v105, 2, v100
  v_and_b32 v104, 15, v104
  v_xor_b32 v104, v104, v105
  v_mul_u32_u24 v100, 1024, v100
  v_lshl_add_u32 v100, v104, 4, v100
  v_bfe_u32 v104, v0, 6, 2
  v_lshlrev_b32 v105, 2, v104
  v_bfe_u32 v106, v0, 8, 1
  v_lshlrev_b32 v106, 1, v106
  v_bfe_u32 v107, v0, 5, 1
  v_or_b32 v106, v106, v107
  s_lshl_b32 s6, s3, 2
  v_or_b32 v106, s6, v106
  v_xor_b32 v106, v106, v105
  v_lshlrev_b32 v106, 4, v106
  v_bfe_u32 v107, v0, 4, 1
  v_lshl_or_b32 v106, v107, 3, v106
  v_bfe_u32 v107, v0, 9, 1
  v_lshl_or_b32 v104, v107, 2, v104
  v_lshl_or_b32 v104, v104, 8, v106
  v_add_u32 v105, 0x10000, v104
  s_lshl_b32 s60, s3, 13
  s_mul_i32 s63, s3, 32768
  s_lshl_b32 s61, s34, 20
  s_lshl_b32 s62, s35, 8
  s_add_u32 s61, s61, s62
  s_add_u32 s61, s61, 0
  s_add_u32 s61, s61, s63
  s_add_u32 m0, s60, 0
  s_add_u32 s62, s61, 0
  buffer_load_dwordx4 v100, s[16:19], s62 offen lds
  s_add_u32 m0, s60, 1024
  s_add_u32 s62, s61, 4096
  buffer_load_dwordx4 v100, s[16:19], s62 offen lds
  s_add_u32 m0, s60, 2048
  s_add_u32 s62, s61, 8192
  buffer_load_dwordx4 v100, s[16:19], s62 offen lds
  s_add_u32 m0, s60, 3072
  s_add_u32 s62, s61, 12288
  buffer_load_dwordx4 v100, s[16:19], s62 offen lds
  s_add_u32 m0, s60, 4096
  s_add_u32 s62, s61, 16384
  buffer_load_dwordx4 v100, s[16:19], s62 offen lds
  s_add_u32 m0, s60, 5120
  s_add_u32 s62, s61, 20480
  buffer_load_dwordx4 v100, s[16:19], s62 offen lds
  s_add_u32 m0, s60, 6144
  s_add_u32 s62, s61, 24576
  buffer_load_dwordx4 v100, s[16:19], s62 offen lds
  s_add_u32 m0, s60, 7168
  s_add_u32 s62, s61, 28672
  buffer_load_dwordx4 v100, s[16:19], s62 offen lds
  s_lshl_b32 s61, s34, 20
  s_lshl_b32 s62, s35, 8
  s_add_u32 s61, s61, s62
  s_add_u32 s61, s61, 131072
  s_add_u32 s61, s61, s63
  s_add_u32 m0, s60, 32768
  s_add_u32 s62, s61, 0
  buffer_load_dwordx4 v100, s[16:19], s62 offen lds
  s_add_u32 m0, s60, 33792
  s_add_u32 s62, s61, 4096
  buffer_load_dwordx4 v100, s[16:19], s62 offen lds
  s_add_u32 m0, s60, 34816
  s_add_u32 s62, s61, 8192
  buffer_load_dwordx4 v100, s[16:19], s62 offen lds
  s_add_u32 m0, s60, 35840
  s_add_u32 s62, s61, 12288
  buffer_load_dwordx4 v100, s[16:19], s62 offen lds
  s_add_u32 m0, s60, 36864
  s_add_u32 s62, s61, 16384
  buffer_load_dwordx4 v100, s[16:19], s62 offen lds
  s_add_u32 m0, s60, 37888
  s_add_u32 s62, s61, 20480
  buffer_load_dwordx4 v100, s[16:19], s62 offen lds
  s_add_u32 m0, s60, 38912
  s_add_u32 s62, s61, 24576
  buffer_load_dwordx4 v100, s[16:19], s62 offen lds
  s_add_u32 m0, s60, 39936
  s_add_u32 s62, s61, 28672
  buffer_load_dwordx4 v100, s[16:19], s62 offen lds
  s_lshl_b32 s61, s34, 20
  s_lshl_b32 s62, s35, 8
  s_add_u32 s61, s61, s62
  s_add_u32 s61, s61, 262144
  s_add_u32 s61, s61, s63
  s_add_u32 m0, s60, 65536
  s_add_u32 s62, s61, 0
  buffer_load_dwordx4 v100, s[16:19], s62 offen lds
  s_add_u32 m0, s60, 66560
  s_add_u32 s62, s61, 4096
  buffer_load_dwordx4 v100, s[16:19], s62 offen lds
  s_add_u32 m0, s60, 67584
  s_add_u32 s62, s61, 8192
  buffer_load_dwordx4 v100, s[16:19], s62 offen lds
  s_add_u32 m0, s60, 68608
  s_add_u32 s62, s61, 12288
  buffer_load_dwordx4 v100, s[16:19], s62 offen lds
  s_add_u32 m0, s60, 69632
  s_add_u32 s62, s61, 16384
  buffer_load_dwordx4 v100, s[16:19], s62 offen lds
  s_add_u32 m0, s60, 70656
  s_add_u32 s62, s61, 20480
  buffer_load_dwordx4 v100, s[16:19], s62 offen lds
  s_add_u32 m0, s60, 71680
  s_add_u32 s62, s61, 24576
  buffer_load_dwordx4 v100, s[16:19], s62 offen lds
  s_add_u32 m0, s60, 72704
  s_add_u32 s62, s61, 28672
  buffer_load_dwordx4 v100, s[16:19], s62 offen lds
  s_waitcnt vmcnt(16)
  s_barrier
  s_lshl_b32 s61, s34, 20
  s_lshl_b32 s62, s35, 8
  s_add_u32 s61, s61, s62
  s_add_u32 s61, s61, 393216
  s_add_u32 s61, s61, s63
  s_add_u32 m0, s60, 98304
  s_add_u32 s62, s61, 0
  buffer_load_dwordx4 v100, s[16:19], s62 offen lds
  s_add_u32 m0, s60, 99328
  s_add_u32 s62, s61, 4096
  buffer_load_dwordx4 v100, s[16:19], s62 offen lds
  s_add_u32 m0, s60, 100352
  s_add_u32 s62, s61, 8192
  buffer_load_dwordx4 v100, s[16:19], s62 offen lds
  s_add_u32 m0, s60, 101376
  s_add_u32 s62, s61, 12288
  buffer_load_dwordx4 v100, s[16:19], s62 offen lds
  s_add_u32 m0, s60, 102400
  s_add_u32 s62, s61, 16384
  buffer_load_dwordx4 v100, s[16:19], s62 offen lds
  s_add_u32 m0, s60, 103424
  s_add_u32 s62, s61, 20480
  buffer_load_dwordx4 v100, s[16:19], s62 offen lds
  s_add_u32 m0, s60, 104448
  s_add_u32 s62, s61, 24576
  buffer_load_dwordx4 v100, s[16:19], s62 offen lds
  s_add_u32 m0, s60, 105472
  s_add_u32 s62, s61, 28672
  buffer_load_dwordx4 v100, s[16:19], s62 offen lds
  ds_read_b64_tr_b16 a[0:1], v104 offset:0
  ds_read_b64_tr_b16 a[2:3], v104 offset:4096
  ds_read_b64_tr_b16 a[4:5], v104 offset:2048
  ds_read_b64_tr_b16 a[6:7], v104 offset:6144
  ds_read_b64_tr_b16 a[8:9], v104 offset:8192
  ds_read_b64_tr_b16 a[10:11], v104 offset:12288
  ds_read_b64_tr_b16 a[12:13], v104 offset:10240
  ds_read_b64_tr_b16 a[14:15], v104 offset:14336
  ds_read_b64_tr_b16 a[16:17], v104 offset:16384
  ds_read_b64_tr_b16 a[18:19], v104 offset:20480
  ds_read_b64_tr_b16 a[20:21], v104 offset:18432
  ds_read_b64_tr_b16 a[22:23], v104 offset:22528
  ds_read_b64_tr_b16 a[24:25], v104 offset:24576
  ds_read_b64_tr_b16 a[26:27], v104 offset:28672
  ds_read_b64_tr_b16 a[28:29], v104 offset:26624
  ds_read_b64_tr_b16 a[30:31], v104 offset:30720
  s_waitcnt lgkmcnt(0)
  s_waitcnt vmcnt(16)
  s_barrier
  s_lshl_b32 s61, s34, 20
  s_lshl_b32 s62, s35, 8
  s_add_u32 s61, s61, s62
  s_add_u32 s61, s61, 524288
  s_add_u32 s61, s61, s63
  s_add_u32 m0, s60, 0
  s_add_u32 s62, s61, 0
  buffer_load_dwordx4 v100, s[16:19], s62 offen lds
  s_add_u32 m0, s60, 1024
  s_add_u32 s62, s61, 4096
  buffer_load_dwordx4 v100, s[16:19], s62 offen lds
  s_add_u32 m0, s60, 2048
  s_add_u32 s62, s61, 8192
  buffer_load_dwordx4 v100, s[16:19], s62 offen lds
  s_add_u32 m0, s60, 3072
  s_add_u32 s62, s61, 12288
  buffer_load_dwordx4 v100, s[16:19], s62 offen lds
  s_add_u32 m0, s60, 4096
  s_add_u32 s62, s61, 16384
  buffer_load_dwordx4 v100, s[16:19], s62 offen lds
  s_add_u32 m0, s60, 5120
  s_add_u32 s62, s61, 20480
  buffer_load_dwordx4 v100, s[16:19], s62 offen lds
  s_add_u32 m0, s60, 6144
  s_add_u32 s62, s61, 24576
  buffer_load_dwordx4 v100, s[16:19], s62 offen lds
  s_add_u32 m0, s60, 7168
  s_add_u32 s62, s61, 28672
  buffer_load_dwordx4 v100, s[16:19], s62 offen lds
  ds_read_b64_tr_b16 a[32:33], v104 offset:32768
  ds_read_b64_tr_b16 a[34:35], v104 offset:36864
  ds_read_b64_tr_b16 a[36:37], v104 offset:34816
  ds_read_b64_tr_b16 a[38:39], v104 offset:38912
  ds_read_b64_tr_b16 a[40:41], v104 offset:40960
  ds_read_b64_tr_b16 a[42:43], v104 offset:45056
  ds_read_b64_tr_b16 a[44:45], v104 offset:43008
  ds_read_b64_tr_b16 a[46:47], v104 offset:47104
  ds_read_b64_tr_b16 a[48:49], v104 offset:49152
  ds_read_b64_tr_b16 a[50:51], v104 offset:53248
  ds_read_b64_tr_b16 a[52:53], v104 offset:51200
  ds_read_b64_tr_b16 a[54:55], v104 offset:55296
  ds_read_b64_tr_b16 a[56:57], v104 offset:57344
  ds_read_b64_tr_b16 a[58:59], v104 offset:61440
  ds_read_b64_tr_b16 a[60:61], v104 offset:59392
  ds_read_b64_tr_b16 a[62:63], v104 offset:63488
  s_waitcnt lgkmcnt(0)
  s_waitcnt vmcnt(16)
  s_barrier
  s_lshl_b32 s61, s34, 20
  s_lshl_b32 s62, s35, 8
  s_add_u32 s61, s61, s62
  s_add_u32 s61, s61, 655360
  s_add_u32 s61, s61, s63
  s_add_u32 m0, s60, 32768
  s_add_u32 s62, s61, 0
  buffer_load_dwordx4 v100, s[16:19], s62 offen lds
  s_add_u32 m0, s60, 33792
  s_add_u32 s62, s61, 4096
  buffer_load_dwordx4 v100, s[16:19], s62 offen lds
  s_add_u32 m0, s60, 34816
  s_add_u32 s62, s61, 8192
  buffer_load_dwordx4 v100, s[16:19], s62 offen lds
  s_add_u32 m0, s60, 35840
  s_add_u32 s62, s61, 12288
  buffer_load_dwordx4 v100, s[16:19], s62 offen lds
  s_add_u32 m0, s60, 36864
  s_add_u32 s62, s61, 16384
  buffer_load_dwordx4 v100, s[16:19], s62 offen lds
  s_add_u32 m0, s60, 37888
  s_add_u32 s62, s61, 20480
  buffer_load_dwordx4 v100, s[16:19], s62 offen lds
  s_add_u32 m0, s60, 38912
  s_add_u32 s62, s61, 24576
  buffer_load_dwordx4 v100, s[16:19], s62 offen lds
  s_add_u32 m0, s60, 39936
  s_add_u32 s62, s61, 28672
  buffer_load_dwordx4 v100, s[16:19], s62 offen lds
  ds_read_b64_tr_b16 a[64:65], v105 offset:0
  ds_read_b64_tr_b16 a[66:67], v105 offset:4096
  ds_read_b64_tr_b16 a[68:69], v105 offset:2048
  ds_read_b64_tr_b16 a[70:71], v105 offset:6144
  ds_read_b64_tr_b16 a[72:73], v105 offset:8192
  ds_read_b64_tr_b16 a[74:75], v105 offset:12288
  ds_read_b64_tr_b16 a[76:77], v105 offset:10240
  ds_read_b64_tr_b16 a[78:79], v105 offset:14336
  ds_read_b64_tr_b16 a[80:81], v105 offset:16384
  ds_read_b64_tr_b16 a[82:83], v105 offset:20480
  ds_read_b64_tr_b16 a[84:85], v105 offset:18432
  ds_read_b64_tr_b16 a[86:87], v105 offset:22528
  ds_read_b64_tr_b16 a[88:89], v105 offset:24576
  ds_read_b64_tr_b16 a[90:91], v105 offset:28672
  ds_read_b64_tr_b16 a[92:93], v105 offset:26624
  ds_read_b64_tr_b16 a[94:95], v105 offset:30720
  s_waitcnt lgkmcnt(0)
  s_waitcnt vmcnt(16)
  s_barrier
  s_lshl_b32 s61, s34, 20
  s_lshl_b32 s62, s35, 8
  s_add_u32 s61, s61, s62
  s_add_u32 s61, s61, 786432
  s_add_u32 s61, s61, s63
  s_add_u32 m0, s60, 65536
  s_add_u32 s62, s61, 0
  buffer_load_dwordx4 v100, s[16:19], s62 offen lds
  s_add_u32 m0, s60, 66560
  s_add_u32 s62, s61, 4096
  buffer_load_dwordx4 v100, s[16:19], s62 offen lds
  s_add_u32 m0, s60, 67584
  s_add_u32 s62, s61, 8192
  buffer_load_dwordx4 v100, s[16:19], s62 offen lds
  s_add_u32 m0, s60, 68608
  s_add_u32 s62, s61, 12288
  buffer_load_dwordx4 v100, s[16:19], s62 offen lds
  s_add_u32 m0, s60, 69632
  s_add_u32 s62, s61, 16384
  buffer_load_dwordx4 v100, s[16:19], s62 offen lds
  s_add_u32 m0, s60, 70656
  s_add_u32 s62, s61, 20480
  buffer_load_dwordx4 v100, s[16:19], s62 offen lds
  s_add_u32 m0, s60, 71680
  s_add_u32 s62, s61, 24576
  buffer_load_dwordx4 v100, s[16:19], s62 offen lds
  s_add_u32 m0, s60, 72704
  s_add_u32 s62, s61, 28672
  buffer_load_dwordx4 v100, s[16:19], s62 offen lds
  ds_read_b64_tr_b16 a[96:97], v105 offset:32768
  ds_read_b64_tr_b16 a[98:99], v105 offset:36864
  ds_read_b64_tr_b16 a[100:101], v105 offset:34816
  ds_read_b64_tr_b16 a[102:103], v105 offset:38912
  ds_read_b64_tr_b16 a[104:105], v105 offset:40960
  ds_read_b64_tr_b16 a[106:107], v105 offset:45056
  ds_read_b64_tr_b16 a[108:109], v105 offset:43008
  ds_read_b64_tr_b16 a[110:111], v105 offset:47104
  ds_read_b64_tr_b16 a[112:113], v105 offset:49152
  ds_read_b64_tr_b16 a[114:115], v105 offset:53248
  ds_read_b64_tr_b16 a[116:117], v105 offset:51200
  ds_read_b64_tr_b16 a[118:119], v105 offset:55296
  ds_read_b64_tr_b16 a[120:121], v105 offset:57344
  ds_read_b64_tr_b16 a[122:123], v105 offset:61440
  ds_read_b64_tr_b16 a[124:125], v105 offset:59392
  ds_read_b64_tr_b16 a[126:127], v105 offset:63488
  s_waitcnt lgkmcnt(0)
  s_waitcnt vmcnt(16)
  s_barrier
  s_lshl_b32 s61, s34, 20
  s_lshl_b32 s62, s35, 8
  s_add_u32 s61, s61, s62
  s_add_u32 s61, s61, 917504
  s_add_u32 s61, s61, s63
  s_add_u32 m0, s60, 98304
  s_add_u32 s62, s61, 0
  buffer_load_dwordx4 v100, s[16:19], s62 offen lds
  s_add_u32 m0, s60, 99328
  s_add_u32 s62, s61, 4096
  buffer_load_dwordx4 v100, s[16:19], s62 offen lds
  s_add_u32 m0, s60, 100352
  s_add_u32 s62, s61, 8192
  buffer_load_dwordx4 v100, s[16:19], s62 offen lds
  s_add_u32 m0, s60, 101376
  s_add_u32 s62, s61, 12288
  buffer_load_dwordx4 v100, s[16:19], s62 offen lds
  s_add_u32 m0, s60, 102400
  s_add_u32 s62, s61, 16384
  buffer_load_dwordx4 v100, s[16:19], s62 offen lds
  s_add_u32 m0, s60, 103424
  s_add_u32 s62, s61, 20480
  buffer_load_dwordx4 v100, s[16:19], s62 offen lds
  s_add_u32 m0, s60, 104448
  s_add_u32 s62, s61, 24576
  buffer_load_dwordx4 v100, s[16:19], s62 offen lds
  s_add_u32 m0, s60, 105472
  s_add_u32 s62, s61, 28672
  buffer_load_dwordx4 v100, s[16:19], s62 offen lds
  ds_read_b64_tr_b16 a[128:129], v104 offset:0
  ds_read_b64_tr_b16 a[130:131], v104 offset:4096
  ds_read_b64_tr_b16 a[132:133], v104 offset:2048
  ds_read_b64_tr_b16 a[134:135], v104 offset:6144
  ds_read_b64_tr_b16 a[136:137], v104 offset:8192
  ds_read_b64_tr_b16 a[138:139], v104 offset:12288
  ds_read_b64_tr_b16 a[140:141], v104 offset:10240
  ds_read_b64_tr_b16 a[142:143], v104 offset:14336
  ds_read_b64_tr_b16 a[144:145], v104 offset:16384
  ds_read_b64_tr_b16 a[146:147], v104 offset:20480
  ds_read_b64_tr_b16 a[148:149], v104 offset:18432
  ds_read_b64_tr_b16 a[150:151], v104 offset:22528
  ds_read_b64_tr_b16 a[152:153], v104 offset:24576
  ds_read_b64_tr_b16 a[154:155], v104 offset:28672
  ds_read_b64_tr_b16 a[156:157], v104 offset:26624
  ds_read_b64_tr_b16 a[158:159], v104 offset:30720
  s_waitcnt lgkmcnt(0)
  s_waitcnt vmcnt(16)
  s_barrier
  ds_read_b64_tr_b16 a[160:161], v104 offset:32768
  ds_read_b64_tr_b16 a[162:163], v104 offset:36864
  ds_read_b64_tr_b16 a[164:165], v104 offset:34816
  ds_read_b64_tr_b16 a[166:167], v104 offset:38912
  ds_read_b64_tr_b16 a[168:169], v104 offset:40960
  ds_read_b64_tr_b16 a[170:171], v104 offset:45056
  ds_read_b64_tr_b16 a[172:173], v104 offset:43008
  ds_read_b64_tr_b16 a[174:175], v104 offset:47104
  ds_read_b64_tr_b16 a[176:177], v104 offset:49152
  ds_read_b64_tr_b16 a[178:179], v104 offset:53248
  ds_read_b64_tr_b16 a[180:181], v104 offset:51200
  ds_read_b64_tr_b16 a[182:183], v104 offset:55296
  ds_read_b64_tr_b16 a[184:185], v104 offset:57344
  ds_read_b64_tr_b16 a[186:187], v104 offset:61440
  ds_read_b64_tr_b16 a[188:189], v104 offset:59392
  ds_read_b64_tr_b16 a[190:191], v104 offset:63488
  s_waitcnt lgkmcnt(0)
  s_waitcnt vmcnt(8)
  s_barrier
  ds_read_b64_tr_b16 a[192:193], v105 offset:0
  ds_read_b64_tr_b16 a[194:195], v105 offset:4096
  ds_read_b64_tr_b16 a[196:197], v105 offset:2048
  ds_read_b64_tr_b16 a[198:199], v105 offset:6144
  ds_read_b64_tr_b16 a[200:201], v105 offset:8192
  ds_read_b64_tr_b16 a[202:203], v105 offset:12288
  ds_read_b64_tr_b16 a[204:205], v105 offset:10240
  ds_read_b64_tr_b16 a[206:207], v105 offset:14336
  ds_read_b64_tr_b16 a[208:209], v105 offset:16384
  ds_read_b64_tr_b16 a[210:211], v105 offset:20480
  ds_read_b64_tr_b16 a[212:213], v105 offset:18432
  ds_read_b64_tr_b16 a[214:215], v105 offset:22528
  ds_read_b64_tr_b16 a[216:217], v105 offset:24576
  ds_read_b64_tr_b16 a[218:219], v105 offset:28672
  ds_read_b64_tr_b16 a[220:221], v105 offset:26624
  ds_read_b64_tr_b16 a[222:223], v105 offset:30720
  s_waitcnt lgkmcnt(0)
  s_waitcnt vmcnt(0)
  s_barrier
  ds_read_b64_tr_b16 a[224:225], v105 offset:32768
  ds_read_b64_tr_b16 a[226:227], v105 offset:36864
  ds_read_b64_tr_b16 a[228:229], v105 offset:34816
  ds_read_b64_tr_b16 a[230:231], v105 offset:38912
  ds_read_b64_tr_b16 a[232:233], v105 offset:40960
  ds_read_b64_tr_b16 a[234:235], v105 offset:45056
  ds_read_b64_tr_b16 a[236:237], v105 offset:43008
  ds_read_b64_tr_b16 a[238:239], v105 offset:47104
  ds_read_b64_tr_b16 a[240:241], v105 offset:49152
  ds_read_b64_tr_b16 a[242:243], v105 offset:53248
  ds_read_b64_tr_b16 a[244:245], v105 offset:51200
  ds_read_b64_tr_b16 a[246:247], v105 offset:55296
  ds_read_b64_tr_b16 a[248:249], v105 offset:57344
  ds_read_b64_tr_b16 a[250:251], v105 offset:61440
  ds_read_b64_tr_b16 a[252:253], v105 offset:59392
  ds_read_b64_tr_b16 a[254:255], v105 offset:63488
  s_waitcnt lgkmcnt(0)
  s_barrier
  v_mov_b32 v3, 0
  v_mov_b32 v1, v0
  v_bfe_u32 v2, v0, 6, 1
  v_lshlrev_b32 v2, 7, v2
  v_bfe_u32 v4, v0, 2, 4
  v_or_b32 v2, v2, v4
  v_bfe_u32 v6, v0, 2, 4
  v_and_b32 v6, 12, v6
  s_mov_b32 s7, 0
  v_mbcnt_lo_u32_b32 v16, -1, 0
  v_and_b32 v16, 3, v16
  v_lshlrev_b32 v16, 6, v16
L_wd_103:
  buffer_load_dword v17, v16, s[12:15], 0 offen offset:16 sc1
  s_waitcnt vmcnt(0)
  v_cmp_ne_u32 vcc, 64, v17
  s_cbranch_vccz L_wdo_104
  s_add_u32 s7, s7, 1
  s_cmp_lt_u32 s7, 131072
  s_cbranch_scc1 L_wd_103
  s_mov_b32 s6, 30
  s_branch L_err
L_wdo_104:
  s_mov_b32 s32, 0
  s_mov_b32 s41, 1
  s_mov_b32 s40, s38
L_o_wait:
  s_mov_b32 s7, 0
L_pl_105:
  buffer_load_dword v4, v2, s[8:11], s40 offen offset:0 sc1
  s_waitcnt vmcnt(0)
  v_cmp_gt_u32 vcc, s41, v4
  s_cbranch_vccz L_plo_106
  s_add_u32 s7, s7, 1
  s_cmp_lt_u32 s7, 131072
  s_cbranch_scc1 L_pl_105
  s_mov_b32 s6, 31
  s_branch L_err
L_plo_106:
L_o_go:
  s_sub_u32 s6, s41, 1
  s_lshl_b32 s6, s6, 18
  s_add_u32 s44, s36, s6
  s_add_u32 m0, s42, 0
  s_add_u32 s45, s44, 0
  buffer_load_dwordx4 v0, s[8:11], s45 offen offset:0 lds
  buffer_load_dwordx4 v0, s[8:11], s45 offen offset:1024 lds
  buffer_load_dwordx4 v0, s[8:11], s45 offen offset:2048 lds
  buffer_load_dwordx4 v0, s[8:11], s45 offen offset:3072 lds
  s_add_u32 m0, s42, 4096
  s_add_u32 s45, s44, 4096
  buffer_load_dwordx4 v0, s[8:11], s45 offen offset:0 lds
  buffer_load_dwordx4 v0, s[8:11], s45 offen offset:1024 lds
  buffer_load_dwordx4 v0, s[8:11], s45 offen offset:2048 lds
  buffer_load_dwordx4 v0, s[8:11], s45 offen offset:3072 lds
  s_add_u32 m0, s42, 8192
  s_add_u32 s45, s44, 8192
  buffer_load_dwordx4 v0, s[8:11], s45 offen offset:0 lds
  buffer_load_dwordx4 v0, s[8:11], s45 offen offset:1024 lds
  buffer_load_dwordx4 v0, s[8:11], s45 offen offset:2048 lds
  buffer_load_dwordx4 v0, s[8:11], s45 offen offset:3072 lds
  s_add_u32 m0, s42, 12288
  s_add_u32 s45, s44, 12288
  buffer_load_dwordx4 v0, s[8:11], s45 offen offset:0 lds
  buffer_load_dwordx4 v0, s[8:11], s45 offen offset:1024 lds
  buffer_load_dwordx4 v0, s[8:11], s45 offen offset:2048 lds
  buffer_load_dwordx4 v0, s[8:11], s45 offen offset:3072 lds
  s_xor_b32 s42, s42, 0x10000
  s_mov_b32 s43, 0
  s_waitcnt vmcnt(8)
L_o_loop:
  s_barrier
  ds_read_b128 v[32:35], v1 offset:0
  ds_read_b128 v[36:39], v1 offset:1024
  ds_read_b128 v[40:43], v1 offset:2048
  s_add_u32 s41, s32, 2
  s_xor_b32 s40, s40, 0x1000
  buffer_load_dword v4, v2, s[8:11], s40 offen sc1
  buffer_load_dword v5, v6, s[8:11], s39 offen sc1
  s_waitcnt lgkmcnt(2)
  v_mfma_f32_32x32x16_bf16 v[16:31], a[0:3], v[32:35], 0
  ds_read_b128 v[44:47], v1 offset:3072
  s_waitcnt lgkmcnt(2)
  v_mfma_f32_32x32x16_bf16 v[16:31], a[4:7], v[36:39], v[16:31]
  ds_read_b128 v[32:35], v1 offset:4096
  s_waitcnt lgkmcnt(2)
  v_mfma_f32_32x32x16_bf16 v[16:31], a[8:11], v[40:43], v[16:31]
  ds_read_b128 v[36:39], v1 offset:5120
  s_waitcnt lgkmcnt(2)
  v_mfma_f32_32x32x16_bf16 v[16:31], a[12:15], v[44:47], v[16:31]
  ds_read_b128 v[40:43], v1 offset:6144
  s_waitcnt lgkmcnt(2)
  v_mfma_f32_32x32x16_bf16 v[16:31], a[16:19], v[32:35], v[16:31]
  ds_read_b128 v[44:47], v1 offset:7168
  s_waitcnt lgkmcnt(2)
  v_mfma_f32_32x32x16_bf16 v[16:31], a[20:23], v[36:39], v[16:31]
  ds_read_b128 v[32:35], v1 offset:16384
  s_waitcnt lgkmcnt(2)
  v_mfma_f32_32x32x16_bf16 v[16:31], a[24:27], v[40:43], v[16:31]
  ds_read_b128 v[36:39], v1 offset:17408
  s_waitcnt lgkmcnt(2)
  v_mfma_f32_32x32x16_bf16 v[16:31], a[28:31], v[44:47], v[16:31]
  ds_read_b128 v[40:43], v1 offset:18432
  s_waitcnt lgkmcnt(2)
  v_mfma_f32_32x32x16_bf16 v[16:31], a[64:67], v[32:35], v[16:31]
  ds_read_b128 v[44:47], v1 offset:19456
  s_waitcnt lgkmcnt(2)
  v_mfma_f32_32x32x16_bf16 v[16:31], a[68:71], v[36:39], v[16:31]
  ds_read_b128 v[32:35], v1 offset:20480
  s_waitcnt lgkmcnt(2)
  v_mfma_f32_32x32x16_bf16 v[16:31], a[72:75], v[40:43], v[16:31]
  ds_read_b128 v[36:39], v1 offset:21504
  s_waitcnt lgkmcnt(2)
  v_mfma_f32_32x32x16_bf16 v[16:31], a[76:79], v[44:47], v[16:31]
  ds_read_b128 v[40:43], v1 offset:22528
  s_waitcnt lgkmcnt(2)
  v_mfma_f32_32x32x16_bf16 v[16:31], a[80:83], v[32:35], v[16:31]
  ds_read_b128 v[44:47], v1 offset:23552
  s_waitcnt lgkmcnt(2)
  v_mfma_f32_32x32x16_bf16 v[16:31], a[84:87], v[36:39], v[16:31]
  ds_read_b128 v[32:35], v1 offset:32768
  s_waitcnt lgkmcnt(2)
  v_mfma_f32_32x32x16_bf16 v[16:31], a[88:91], v[40:43], v[16:31]
  ds_read_b128 v[36:39], v1 offset:33792
  s_waitcnt lgkmcnt(2)
  v_mfma_f32_32x32x16_bf16 v[16:31], a[92:95], v[44:47], v[16:31]
  ds_read_b128 v[40:43], v1 offset:34816
  s_waitcnt lgkmcnt(2)
  v_mfma_f32_32x32x16_bf16 v[16:31], a[128:131], v[32:35], v[16:31]
  ds_read_b128 v[44:47], v1 offset:35840
  s_waitcnt lgkmcnt(2)
  v_mfma_f32_32x32x16_bf16 v[16:31], a[132:135], v[36:39], v[16:31]
  ds_read_b128 v[32:35], v1 offset:36864
  s_waitcnt lgkmcnt(2)
  v_mfma_f32_32x32x16_bf16 v[16:31], a[136:139], v[40:43], v[16:31]
  ds_read_b128 v[36:39], v1 offset:37888
  s_waitcnt lgkmcnt(2)
  v_mfma_f32_32x32x16_bf16 v[16:31], a[140:143], v[44:47], v[16:31]
  ds_read_b128 v[40:43], v1 offset:38912
  s_waitcnt lgkmcnt(2)
  v_mfma_f32_32x32x16_bf16 v[16:31], a[144:147], v[32:35], v[16:31]
  ds_read_b128 v[44:47], v1 offset:39936
  s_waitcnt lgkmcnt(2)
  v_mfma_f32_32x32x16_bf16 v[16:31], a[148:151], v[36:39], v[16:31]
  ds_read_b128 v[32:35], v1 offset:49152
  s_waitcnt lgkmcnt(2)
  v_mfma_f32_32x32x16_bf16 v[16:31], a[152:155], v[40:43], v[16:31]
  ds_read_b128 v[36:39], v1 offset:50176
  s_waitcnt lgkmcnt(2)
  v_mfma_f32_32x32x16_bf16 v[16:31], a[156:159], v[44:47], v[16:31]
  ds_read_b128 v[40:43], v1 offset:51200
  s_waitcnt lgkmcnt(2)
  v_mfma_f32_32x32x16_bf16 v[16:31], a[192:195], v[32:35], v[16:31]
  ds_read_b128 v[44:47], v1 offset:52224
  s_waitcnt lgkmcnt(2)
  v_mfma_f32_32x32x16_bf16 v[16:31], a[196:199], v[36:39], v[16:31]
  ds_read_b128 v[32:35], v1 offset:53248
  s_waitcnt lgkmcnt(2)
  v_mfma_f32_32x32x16_bf16 v[16:31], a[200:203], v[40:43], v[16:31]
  ds_read_b128 v[36:39], v1 offset:54272
  s_waitcnt lgkmcnt(2)
  v_mfma_f32_32x32x16_bf16 v[16:31], a[204:207], v[44:47], v[16:31]
  ds_read_b128 v[40:43], v1 offset:55296
  s_waitcnt lgkmcnt(2)
  v_mfma_f32_32x32x16_bf16 v[16:31], a[208:211], v[32:35], v[16:31]
  ds_read_b128 v[44:47], v1 offset:56320
  s_waitcnt lgkmcnt(2)
  v_mfma_f32_32x32x16_bf16 v[16:31], a[212:215], v[36:39], v[16:31]
  s_waitcnt lgkmcnt(1)
  v_mfma_f32_32x32x16_bf16 v[16:31], a[216:219], v[40:43], v[16:31]
  s_waitcnt lgkmcnt(0)
  v_mfma_f32_32x32x16_bf16 v[16:31], a[220:223], v[44:47], v[16:31]
  s_waitcnt vmcnt(0)
  s_barrier
  ds_read_b128 v[32:35], v1 offset:8192
  ds_read_b128 v[36:39], v1 offset:9216
  ds_read_b128 v[40:43], v1 offset:10240
  s_mov_b32 s43, 0
  s_cmp_eq_u32 s32, 63
  s_cbranch_scc1 L_on_107
  v_cmp_gt_u32 vcc, s41, v4
  s_cbranch_vccnz L_on_107
  s_mov_b32 s43, 1
  s_waitcnt lgkmcnt(2)
  v_mfma_f32_32x32x16_bf16 v[16:31], a[32:35], v[32:35], v[16:31]
  ds_read_b128 v[44:47], v1 offset:11264
  s_sub_u32 s6, s41, 1
  s_lshl_b32 s6, s6, 18
  s_add_u32 s44, s36, s6
  s_waitcnt lgkmcnt(2)
  v_mfma_f32_32x32x16_bf16 v[16:31], a[36:39], v[36:39], v[16:31]
  ds_read_b128 v[32:35], v1 offset:12288
  s_add_u32 m0, s42, 0
  s_add_u32 s45, s44, 0
  buffer_load_dwordx4 v0, s[8:11], s45 offen offset:0 lds
  s_waitcnt lgkmcnt(2)
  v_mfma_f32_32x32x16_bf16 v[16:31], a[40:43], v[40:43], v[16:31]
  ds_read_b128 v[36:39], v1 offset:13312
  buffer_load_dwordx4 v0, s[8:11], s45 offen offset:1024 lds
  s_waitcnt lgkmcnt(2)
  v_mfma_f32_32x32x16_bf16 v[16:31], a[44:47], v[44:47], v[16:31]
  ds_read_b128 v[40:43], v1 offset:14336
  buffer_load_dwordx4 v0, s[8:11], s45 offen offset:2048 lds
  s_waitcnt lgkmcnt(2)
  v_mfma_f32_32x32x16_bf16 v[16:31], a[48:51], v[32:35], v[16:31]
  ds_read_b128 v[44:47], v1 offset:15360
  buffer_load_dwordx4 v0, s[8:11], s45 offen offset:3072 lds
  s_waitcnt lgkmcnt(2)
  v_mfma_f32_32x32x16_bf16 v[16:31], a[52:55], v[36:39], v[16:31]
  ds_read_b128 v[32:35], v1 offset:24576
  s_waitcnt lgkmcnt(2)
  v_mfma_f32_32x32x16_bf16 v[16:31], a[56:59], v[40:43], v[16:31]
  ds_read_b128 v[36:39], v1 offset:25600
  s_add_u32 m0, s42, 4096
  s_add_u32 s45, s44, 4096
  buffer_load_dwordx4 v0, s[8:11], s45 offen offset:0 lds
  s_waitcnt lgkmcnt(2)
  v_mfma_f32_32x32x16_bf16 v[16:31], a[60:63], v[44:47], v[16:31]
  ds_read_b128 v[40:43], v1 offset:26624
  s_waitcnt lgkmcnt(2)
  v_mfma_f32_32x32x16_bf16 v[16:31], a[96:99], v[32:35], v[16:31]
  ds_read_b128 v[44:47], v1 offset:27648
  buffer_load_dwordx4 v0, s[8:11], s45 offen offset:1024 lds
  s_waitcnt lgkmcnt(2)
  v_mfma_f32_32x32x16_bf16 v[16:31], a[100:103], v[36:39], v[16:31]
  ds_read_b128 v[32:35], v1 offset:28672
  s_waitcnt lgkmcnt(2)
  v_mfma_f32_32x32x16_bf16 v[16:31], a[104:107], v[40:43], v[16:31]
  ds_read_b128 v[36:39], v1 offset:29696
  buffer_load_dwordx4 v0, s[8:11], s45 offen offset:2048 lds
  s_waitcnt lgkmcnt(2)
  v_mfma_f32_32x32x16_bf16 v[16:31], a[108:111], v[44:47], v[16:31]
  ds_read_b128 v[40:43], v1 offset:30720
  s_waitcnt lgkmcnt(2)
  v_mfma_f32_32x32x16_bf16 v[16:31], a[112:115], v[32:35], v[16:31]
  ds_read_b128 v[44:47], v1 offset:31744
  buffer_load_dwordx4 v0, s[8:11], s45 offen offset:3072 lds
  s_waitcnt lgkmcnt(2)
  v_mfma_f32_32x32x16_bf16 v[16:31], a[116:119], v[36:39], v[16:31]
  ds_read_b128 v[32:35], v1 offset:40960
  s_waitcnt lgkmcnt(2)
  v_mfma_f32_32x32x16_bf16 v[16:31], a[120:123], v[40:43], v[16:31]
  ds_read_b128 v[36:39], v1 offset:41984
  s_add_u32 m0, s42, 8192
  s_add_u32 s45, s44, 8192
  buffer_load_dwordx4 v0, s[8:11], s45 offen offset:0 lds
  s_waitcnt lgkmcnt(2)
  v_mfma_f32_32x32x16_bf16 v[16:31], a[124:127], v[44:47], v[16:31]
  ds_read_b128 v[40:43], v1 offset:43008
  s_waitcnt lgkmcnt(2)
  v_mfma_f32_32x32x16_bf16 v[16:31], a[160:163], v[32:35], v[16:31]
  ds_read_b128 v[44:47], v1 offset:44032
  buffer_load_dwordx4 v0, s[8:11], s45 offen offset:1024 lds
  s_waitcnt lgkmcnt(2)
  v_mfma_f32_32x32x16_bf16 v[16:31], a[164:167], v[36:39], v[16:31]
  ds_read_b128 v[32:35], v1 offset:45056
  s_waitcnt lgkmcnt(2)
  v_mfma_f32_32x32x16_bf16 v[16:31], a[168:171], v[40:43], v[16:31]
  ds_read_b128 v[36:39], v1 offset:46080
  buffer_load_dwordx4 v0, s[8:11], s45 offen offset:2048 lds
  s_waitcnt lgkmcnt(2)
  v_mfma_f32_32x32x16_bf16 v[16:31], a[172:175], v[44:47], v[16:31]
  ds_read_b128 v[40:43], v1 offset:47104
  s_waitcnt lgkmcnt(2)
  v_mfma_f32_32x32x16_bf16 v[16:31], a[176:179], v[32:35], v[16:31]
  ds_read_b128 v[44:47], v1 offset:48128
  buffer_load_dwordx4 v0, s[8:11], s45 offen offset:3072 lds
  s_waitcnt lgkmcnt(2)
  v_mfma_f32_32x32x16_bf16 v[16:31], a[180:183], v[36:39], v[16:31]
  ds_read_b128 v[32:35], v1 offset:57344
  s_waitcnt lgkmcnt(2)
  v_mfma_f32_32x32x16_bf16 v[16:31], a[184:187], v[40:43], v[16:31]
  ds_read_b128 v[36:39], v1 offset:58368
  s_add_u32 m0, s42, 12288
  s_add_u32 s45, s44, 12288
  buffer_load_dwordx4 v0, s[8:11], s45 offen offset:0 lds
  s_waitcnt lgkmcnt(2)
  v_mfma_f32_32x32x16_bf16 v[16:31], a[188:191], v[44:47], v[16:31]
  ds_read_b128 v[40:43], v1 offset:59392
  s_waitcnt lgkmcnt(2)
  v_mfma_f32_32x32x16_bf16 v[16:31], a[224:227], v[32:35], v[16:31]
  ds_read_b128 v[44:47], v1 offset:60416
  buffer_load_dwordx4 v0, s[8:11], s45 offen offset:1024 lds
  s_waitcnt lgkmcnt(2)
  v_mfma_f32_32x32x16_bf16 v[16:31], a[228:231], v[36:39], v[16:31]
  ds_read_b128 v[32:35], v1 offset:61440
  s_waitcnt lgkmcnt(2)
  v_mfma_f32_32x32x16_bf16 v[16:31], a[232:235], v[40:43], v[16:31]
  ds_read_b128 v[36:39], v1 offset:62464
  buffer_load_dwordx4 v0, s[8:11], s45 offen offset:2048 lds
  s_waitcnt lgkmcnt(2)
  v_mfma_f32_32x32x16_bf16 v[16:31], a[236:239], v[44:47], v[16:31]
  ds_read_b128 v[40:43], v1 offset:63488
  s_waitcnt lgkmcnt(2)
  v_mfma_f32_32x32x16_bf16 v[16:31], a[240:243], v[32:35], v[16:31]
  ds_read_b128 v[44:47], v1 offset:64512
  buffer_load_dwordx4 v0, s[8:11], s45 offen offset:3072 lds
  s_waitcnt lgkmcnt(2)
  v_mfma_f32_32x32x16_bf16 v[16:31], a[244:247], v[36:39], v[16:31]
  s_waitcnt lgkmcnt(1)
  v_mfma_f32_32x32x16_bf16 v[16:31], a[248:251], v[40:43], v[16:31]
  s_xor_b32 s42, s42, 0x10000
  s_waitcnt lgkmcnt(0)
  v_mfma_f32_32x32x16_bf16 v[16:31], a[252:255], v[44:47], v[16:31]
  s_branch L_o_h2
L_on_107:
  s_waitcnt lgkmcnt(2)
  v_mfma_f32_32x32x16_bf16 v[16:31], a[32:35], v[32:35], v[16:31]
  ds_read_b128 v[44:47], v1 offset:11264
  s_waitcnt lgkmcnt(2)
  v_mfma_f32_32x32x16_bf16 v[16:31], a[36:39], v[36:39], v[16:31]
  ds_read_b128 v[32:35], v1 offset:12288
  s_waitcnt lgkmcnt(2)
  v_mfma_f32_32x32x16_bf16 v[16:31], a[40:43], v[40:43], v[16:31]
  ds_read_b128 v[36:39], v1 offset:13312
  s_waitcnt lgkmcnt(2)
  v_mfma_f32_32x32x16_bf16 v[16:31], a[44:47], v[44:47], v[16:31]
  ds_read_b128 v[40:43], v1 offset:14336
  s_waitcnt lgkmcnt(2)
  v_mfma_f32_32x32x16_bf16 v[16:31], a[48:51], v[32:35], v[16:31]
  ds_read_b128 v[44:47], v1 offset:15360
  buffer_load_dword v4, v2, s[8:11], s40 offen sc1
  s_waitcnt lgkmcnt(2)
  v_mfma_f32_32x32x16_bf16 v[16:31], a[52:55], v[36:39], v[16:31]
  ds_read_b128 v[32:35], v1 offset:24576
  s_waitcnt lgkmcnt(2)
  v_mfma_f32_32x32x16_bf16 v[16:31], a[56:59], v[40:43], v[16:31]
  ds_read_b128 v[36:39], v1 offset:25600
  s_waitcnt lgkmcnt(2)
  v_mfma_f32_32x32x16_bf16 v[16:31], a[60:63], v[44:47], v[16:31]
  ds_read_b128 v[40:43], v1 offset:26624
  s_waitcnt lgkmcnt(2)
  v_mfma_f32_32x32x16_bf16 v[16:31], a[96:99], v[32:35], v[16:31]
  ds_read_b128 v[44:47], v1 offset:27648
  s_waitcnt lgkmcnt(2)
  v_mfma_f32_32x32x16_bf16 v[16:31], a[100:103], v[36:39], v[16:31]
  ds_read_b128 v[32:35], v1 offset:28672
  s_waitcnt lgkmcnt(2)
  v_mfma_f32_32x32x16_bf16 v[16:31], a[104:107], v[40:43], v[16:31]
  ds_read_b128 v[36:39], v1 offset:29696
  s_waitcnt lgkmcnt(2)
  v_mfma_f32_32x32x16_bf16 v[16:31], a[108:111], v[44:47], v[16:31]
  ds_read_b128 v[40:43], v1 offset:30720
  s_waitcnt lgkmcnt(2)
  v_mfma_f32_32x32x16_bf16 v[16:31], a[112:115], v[32:35], v[16:31]
  ds_read_b128 v[44:47], v1 offset:31744
  s_waitcnt lgkmcnt(2)
  v_mfma_f32_32x32x16_bf16 v[16:31], a[116:119], v[36:39], v[16:31]
  ds_read_b128 v[32:35], v1 offset:40960
  s_waitcnt lgkmcnt(2)
  v_mfma_f32_32x32x16_bf16 v[16:31], a[120:123], v[40:43], v[16:31]
  ds_read_b128 v[36:39], v1 offset:41984
  s_waitcnt lgkmcnt(2)
  v_mfma_f32_32x32x16_bf16 v[16:31], a[124:127], v[44:47], v[16:31]
  ds_read_b128 v[40:43], v1 offset:43008
  s_waitcnt lgkmcnt(2)
  v_mfma_f32_32x32x16_bf16 v[16:31], a[160:163], v[32:35], v[16:31]
  ds_read_b128 v[44:47], v1 offset:44032
  s_waitcnt lgkmcnt(2)
  v_mfma_f32_32x32x16_bf16 v[16:31], a[164:167], v[36:39], v[16:31]
  ds_read_b128 v[32:35], v1 offset:45056
  s_waitcnt lgkmcnt(2)
  v_mfma_f32_32x32x16_bf16 v[16:31], a[168:171], v[40:43], v[16:31]
  ds_read_b128 v[36:39], v1 offset:46080
  s_waitcnt lgkmcnt(2)
  v_mfma_f32_32x32x16_bf16 v[16:31], a[172:175], v[44:47], v[16:31]
  ds_read_b128 v[40:43], v1 offset:47104
  s_waitcnt lgkmcnt(2)
  v_mfma_f32_32x32x16_bf16 v[16:31], a[176:179], v[32:35], v[16:31]
  ds_read_b128 v[44:47], v1 offset:48128
  s_waitcnt lgkmcnt(2)
  v_mfma_f32_32x32x16_bf16 v[16:31], a[180:183], v[36:39], v[16:31]
  ds_read_b128 v[32:35], v1 offset:57344
  s_waitcnt lgkmcnt(2)
  v_mfma_f32_32x32x16_bf16 v[16:31], a[184:187], v[40:43], v[16:31]
  ds_read_b128 v[36:39], v1 offset:58368
  s_waitcnt lgkmcnt(2)
  v_mfma_f32_32x32x16_bf16 v[16:31], a[188:191], v[44:47], v[16:31]
  ds_read_b128 v[40:43], v1 offset:59392
  s_waitcnt lgkmcnt(2)
  v_mfma_f32_32x32x16_bf16 v[16:31], a[224:227], v[32:35], v[16:31]
  ds_read_b128 v[44:47], v1 offset:60416
  s_waitcnt lgkmcnt(2)
  v_mfma_f32_32x32x16_bf16 v[16:31], a[228:231], v[36:39], v[16:31]
  ds_read_b128 v[32:35], v1 offset:61440
  s_waitcnt lgkmcnt(2)
  v_mfma_f32_32x32x16_bf16 v[16:31], a[232:235], v[40:43], v[16:31]
  ds_read_b128 v[36:39], v1 offset:62464
  s_waitcnt lgkmcnt(2)
  v_mfma_f32_32x32x16_bf16 v[16:31], a[236:239], v[44:47], v[16:31]
  ds_read_b128 v[40:43], v1 offset:63488
  s_waitcnt lgkmcnt(2)
  v_mfma_f32_32x32x16_bf16 v[16:31], a[240:243], v[32:35], v[16:31]
  ds_read_b128 v[44:47], v1 offset:64512
  s_waitcnt lgkmcnt(2)
  v_mfma_f32_32x32x16_bf16 v[16:31], a[244:247], v[36:39], v[16:31]
  s_waitcnt lgkmcnt(1)
  v_mfma_f32_32x32x16_bf16 v[16:31], a[248:251], v[40:43], v[16:31]
  s_waitcnt lgkmcnt(0)
  v_mfma_f32_32x32x16_bf16 v[16:31], a[252:255], v[44:47], v[16:31]
L_o_h2:
  s_sub_u32 s45, s32, 3
  v_cmp_gt_i32 vcc, s45, v5
  s_cbranch_vccz L_o_free
  s_mov_b32 s7, 0
L_o_bp:
  buffer_load_dword v5, v6, s[8:11], s39 offen sc1
  s_waitcnt vmcnt(0)
  v_cmp_gt_i32 vcc, s45, v5
  s_cbranch_vccz L_o_free
  s_add_u32 s7, s7, 1
  s_cmp_lt_u32 s7, 131072
  s_cbranch_scc1 L_o_bp
  s_mov_b32 s6, 32
  s_branch L_err
L_o_free:
  s_and_b32 s6, s32, 3
  s_lshl_b32 s6, s6, 17
  s_add_u32 s44, s37, s6
  s_lshr_b32 s6, s32, 2
  s_andn2_b32 s45, 1, s6
  s_add_u32 s32, s32, 1
  v_xor_b32 v1, 0x10000, v1
  s_nop 1
  v_cvt_pk_bf16_f32 v48, v16, v17
  v_cvt_pk_bf16_f32 v49, v18, v19
  v_cvt_pk_bf16_f32 v50, v20, v21
  v_cvt_pk_bf16_f32 v51, v22, v23
  v_bfi_b32 v48, 1, s45, v48
  buffer_store_dwordx4 v[48:51], v0, s[8:11], s44 offen offset:0 sc1
  v_cvt_pk_bf16_f32 v52, v24, v25
  v_cvt_pk_bf16_f32 v53, v26, v27
  v_cvt_pk_bf16_f32 v54, v28, v29
  v_cvt_pk_bf16_f32 v55, v30, v31
  v_bfi_b32 v52, 1, s45, v52
  buffer_store_dwordx4 v[52:55], v0, s[8:11], s44 offen offset:1024 sc1
  s_cmp_eq_u32 s43, 0
  s_waitcnt vmcnt(10)
  s_cbranch_scc0 L_o_loop
  s_cmp_eq_u32 s32, 64
  s_cbranch_scc1 L_o_end
  s_waitcnt vmcnt(2)
  v_cmp_gt_u32 vcc, s41, v4
  s_cbranch_vccz L_o_go
  s_branch L_o_wait
L_o_end:
  s_waitcnt vmcnt(0)
  s_endpgm
L_pro:
  s_max_u32 s6, s4, 3
  s_sub_u32 s6, s6, 3
  s_lshl_b32 s6, s6, 5
  s_add_u32 s6, s6, s5
  s_lshl_b32 s62, s6, 15
  s_lshl_b32 s6, s6, 2
  s_add_u32 s60, s6, s3
  s_lshl_b32 s6, s60, 2
  s_add_u32 s6, s6, 0x710000
  v_mov_b32 v1, 0
  v_lshlrev_b32 v2, 4, v0
  s_mov_b64 exec, 1
  buffer_store_dword v1, v1, s[8:11], s6 offen sc1
  s_mov_b64 exec, -1
  v_lshlrev_b32 v16, 2, v0
  s_lshl_b32 s6, s60, 8
  s_lshl_b32 s7, s60, 1
  s_mov_b32 s16, s66
  s_mov_b32 s17, s67
  s_mov_b32 s18, 0x20000
  s_mov_b32 s19, 0x20000
  buffer_load_dword v20, v16, s[16:19], s6 offen
  s_mov_b32 s20, s68
  s_mov_b32 s21, s69
  s_mov_b32 s22, 0x20000
  s_mov_b32 s23, 0x20000
  buffer_load_dword v21, v16, s[20:23], s6 offen
  s_mov_b32 s24, s70
  s_mov_b32 s25, s71
  s_mov_b32 s26, 0x20000
  s_mov_b32 s27, 0x20000
  buffer_load_dword v22, v16, s[24:27], s6 offen
  s_mov_b32 s28, s72
  s_mov_b32 s29, s73
  s_mov_b32 s30, 0x20000
  s_mov_b32 s31, 0x20000
  buffer_load_dword v23, v16, s[28:31], s6 offen
  s_mov_b32 s16, s74
  s_mov_b32 s17, s75
  s_mov_b32 s18, 0x400
  s_mov_b32 s19, 0x20000
  buffer_load_ushort v24, v1, s[16:19], s7 offen
  s_mov_b32 s20, s76
  s_mov_b32 s21, s77
  s_mov_b32 s22, 0x400
  s_mov_b32 s23, 0x20000
  buffer_load_ushort v232, v1, s[20:23], s7 offen
  s_waitcnt vmcnt(6)
  s_barrier
  s_cmp_lg_u32 s3, 0
  s_cbranch_scc1 L_sd_108
  s_mov_b64 exec, 1
  s_and_b32 s6, s4, 3
  s_lshl_b32 s6, s6, 6
  v_mov_b32 v18, 16
  v_mov_b32 v19, 1
  buffer_atomic_add v19, v18, s[12:15], s6 offen sc1
  s_mov_b64 exec, -1
L_sd_108:
  v_and_b32 v16, 15, v0
  v_and_b32 v17, 7, v16
  v_lshrrev_b32 v18, 3, v16
  v_lshl_add_u32 v19, v18, 7, v17
  v_add_u32 v19, 1, v19
  v_cvt_f32_u32 v4, v19
  v_and_b32 v19, 3, v16
  v_lshrrev_b32 v25, 2, v16
  v_lshlrev_b32 v25, 6, v25
  v_add_u32 v19, v19, v25
  v_lshlrev_b32 v19, 1, v19
  v_add_u32 v19, 258, v19
  v_cmp_gt_u32 vcc, 8, v16
  s_nop 1
  v_cndmask_b32 v19, 0, v19, vcc
  v_cvt_f32_u32 v5, v19
  v_and_b32 v19, 1, v16
  v_lshrrev_b32 v25, 1, v17
  v_lshlrev_b32 v25, 7, v25
  v_lshl_add_u32 v19, v19, 2, v25
  v_add_u32 v19, 516, v19
  v_lshlrev_b32 v25, 7, v17
  v_add_u32 v25, 1032, v25
  v_cndmask_b32 v19, v25, v19, vcc
  v_cvt_f32_u32 v6, v19
  v_lshlrev_b32 v19, 3, v16
  v_cvt_f32_u32 v7, v19
  v_lshrrev_b32 v19, 4, v0
  s_lshl_b32 s6, s3, 11
  v_lshl_add_u32 v3, v19, 6, s6
  v_lshlrev_b32 v16, 4, v0
  v_cvt_f32_u32 v16, v16
  s_mul_i32 s63, s3, 4352
  s_add_u32 s63, s63, 8192
  v_sub_f32 v17, 0x45800000, v16
  v_sub_f32 v18, 0x457fe000, v16
  v_cvt_pk_bf16_f32 v17, v17, v18
  v_lshlrev_b32 v160, 16, v17
  v_and_b32 v161, 0xffff0000, v17
  v_cvt_u32_f32 v160, v160
  v_cvt_u32_f32 v161, v161
  v_add_u32 v160, s63, v160
  v_add_u32 v161, s63, v161
  v_sub_f32 v17, 0x457fc000, v16
  v_sub_f32 v18, 0x457fa000, v16
  v_cvt_pk_bf16_f32 v17, v17, v18
  v_lshlrev_b32 v162, 16, v17
  v_and_b32 v163, 0xffff0000, v17
  v_cvt_u32_f32 v162, v162
  v_cvt_u32_f32 v163, v163
  v_add_u32 v162, s63, v162
  v_add_u32 v163, s63, v163
  v_sub_f32 v17, 0x457f8000, v16
  v_sub_f32 v18, 0x457f6000, v16
  v_cvt_pk_bf16_f32 v17, v17, v18
  v_lshlrev_b32 v164, 16, v17
  v_and_b32 v165, 0xffff0000, v17
  v_cvt_u32_f32 v164, v164
  v_cvt_u32_f32 v165, v165
  v_add_u32 v164, s63, v164
  v_add_u32 v165, s63, v165
  v_sub_f32 v17, 0x457f4000, v16
  v_sub_f32 v18, 0x457f2000, v16
  v_cvt_pk_bf16_f32 v17, v17, v18
  v_lshlrev_b32 v166, 16, v17
  v_and_b32 v167, 0xffff0000, v17
  v_cvt_u32_f32 v166, v166
  v_cvt_u32_f32 v167, v167
  v_add_u32 v166, s63, v166
  v_add_u32 v167, s63, v167
  v_sub_f32 v17, 0x45400000, v16
  v_sub_f32 v18, 0x453fe000, v16
  v_cvt_pk_bf16_f32 v17, v17, v18
  v_lshlrev_b32 v168, 16, v17
  v_and_b32 v169, 0xffff0000, v17
  v_cvt_u32_f32 v168, v168
  v_cvt_u32_f32 v169, v169
  v_add_u32 v168, s63, v168
  v_add_u32 v169, s63, v169
  v_sub_f32 v17, 0x453fc000, v16
  v_sub_f32 v18, 0x453fa000, v16
  v_cvt_pk_bf16_f32 v17, v17, v18
  v_lshlrev_b32 v170, 16, v17
  v_and_b32 v171, 0xffff0000, v17
  v_cvt_u32_f32 v170, v170
  v_cvt_u32_f32 v171, v171
  v_add_u32 v170, s63, v170
  v_add_u32 v171, s63, v171
  v_sub_f32 v17, 0x453f8000, v16
  v_sub_f32 v18, 0x453f6000, v16
  v_cvt_pk_bf16_f32 v17, v17, v18
  v_lshlrev_b32 v172, 16, v17
  v_and_b32 v173, 0xffff0000, v17
  v_cvt_u32_f32 v172, v172
  v_cvt_u32_f32 v173, v173
  v_add_u32 v172, s63, v172
  v_add_u32 v173, s63, v173
  v_sub_f32 v17, 0x453f4000, v16
  v_sub_f32 v18, 0x453f2000, v16
  v_cvt_pk_bf16_f32 v17, v17, v18
  v_lshlrev_b32 v174, 16, v17
  v_and_b32 v175, 0xffff0000, v17
  v_cvt_u32_f32 v174, v174
  v_cvt_u32_f32 v175, v175
  v_add_u32 v174, s63, v174
  v_add_u32 v175, s63, v175
  v_sub_f32 v17, 0x45000000, v16
  v_sub_f32 v18, 0x44ffc000, v16
  v_cvt_pk_bf16_f32 v17, v17, v18
  v_lshlrev_b32 v176, 16, v17
  v_and_b32 v177, 0xffff0000, v17
  v_cvt_u32_f32 v176, v176
  v_cvt_u32_f32 v177, v177
  v_add_u32 v176, s63, v176
  v_add_u32 v177, s63, v177
  v_sub_f32 v17, 0x44ff8000, v16
  v_sub_f32 v18, 0x44ff4000, v16
  v_cvt_pk_bf16_f32 v17, v17, v18
  v_lshlrev_b32 v178, 16, v17
  v_and_b32 v179, 0xffff0000, v17
  v_cvt_u32_f32 v178, v178
  v_cvt_u32_f32 v179, v179
  v_add_u32 v178, s63, v178
  v_add_u32 v179, s63, v179
  v_sub_f32 v17, 0x44ff0000, v16
  v_sub_f32 v18, 0x44fec000, v16
  v_cvt_pk_bf16_f32 v17, v17, v18
  v_lshlrev_b32 v180, 16, v17
  v_and_b32 v181, 0xffff0000, v17
  v_cvt_u32_f32 v180, v180
  v_cvt_u32_f32 v181, v181
  v_add_u32 v180, s63, v180
  v_add_u32 v181, s63, v181
  v_sub_f32 v17, 0x44fe8000, v16
  v_sub_f32 v18, 0x44fe4000, v16
  v_cvt_pk_bf16_f32 v17, v17, v18
  v_lshlrev_b32 v182, 16, v17
  v_and_b32 v183, 0xffff0000, v17
  v_cvt_u32_f32 v182, v182
  v_cvt_u32_f32 v183, v183
  v_add_u32 v182, s63, v182
  v_add_u32 v183, s63, v183
  v_sub_f32 v17, 0x44800000, v16
  v_sub_f32 v18, 0x447f8000, v16
  v_cvt_pk_bf16_f32 v17, v17, v18
  v_lshlrev_b32 v184, 16, v17
  v_and_b32 v185, 0xffff0000, v17
  v_cvt_u32_f32 v184, v184
  v_cvt_u32_f32 v185, v185
  v_add_u32 v184, s63, v184
  v_add_u32 v185, s63, v185
  v_sub_f32 v17, 0x447f0000, v16
  v_sub_f32 v18, 0x447e8000, v16
  v_cvt_pk_bf16_f32 v17, v17, v18
  v_lshlrev_b32 v186, 16, v17
  v_and_b32 v187, 0xffff0000, v17
  v_cvt_u32_f32 v186, v186
  v_cvt_u32_f32 v187, v187
  v_add_u32 v186, s63, v186
  v_add_u32 v187, s63, v187
  v_sub_f32 v17, 0x447e0000, v16
  v_sub_f32 v18, 0x447d8000, v16
  v_cvt_pk_bf16_f32 v17, v17, v18
  v_lshlrev_b32 v188, 16, v17
  v_and_b32 v189, 0xffff0000, v17
  v_cvt_u32_f32 v188, v188
  v_cvt_u32_f32 v189, v189
  v_add_u32 v188, s63, v188
  v_add_u32 v189, s63, v189
  v_sub_f32 v17, 0x447d0000, v16
  v_sub_f32 v18, 0x447c8000, v16
  v_cvt_pk_bf16_f32 v17, v17, v18
  v_lshlrev_b32 v190, 16, v17
  v_and_b32 v191, 0xffff0000, v17
  v_cvt_u32_f32 v190, v190
  v_cvt_u32_f32 v191, v191
  v_add_u32 v190, s63, v190
  v_add_u32 v191, s63, v191
  s_waitcnt vmcnt(1)
  v_lshlrev_b32 v24, 16, v24
  v_mul_f32 v26, 0x3fb8aa3b, v24
  v_mov_b32 v27, 0x3fb8aa3b
  v_fma_f32 v27, v24, v27, -v26
  v_fmac_f32 v27, 0x32a57060, v24
  v_exp_f32 v26, v26
  v_mul_f32 v27, 0x3f317218, v27
  v_fma_f32 v24, v26, v27, v26
  v_cvt_pk_bf16_f32 v24, v24, v24
  v_and_b32 v24, 0xffff0000, v24
  v_lshlrev_b32 v32, 16, v20
  v_and_b32 v36, 0xffff0000, v20
  v_lshlrev_b32 v33, 16, v21
  v_and_b32 v37, 0xffff0000, v21
  v_lshlrev_b32 v34, 16, v22
  v_and_b32 v38, 0xffff0000, v22
  v_lshlrev_b32 v35, 16, v23
  v_and_b32 v39, 0xffff0000, v23
  v_max3_f32 v28, |v34|, |v35|, |v38|
  v_max_f32 v28, |v39|, v28
  s_nop 1
  v_max_f32_dpp v28, v28, v28 quad_perm:[1,0,3,2] row_mask:0xf bank_mask:0xf
  s_nop 1
  v_max_f32_dpp v28, v28, v28 quad_perm:[2,3,0,1] row_mask:0xf bank_mask:0xf
  s_nop 1
  v_max_f32_dpp v28, v28, v28 row_half_mirror row_mask:0xf bank_mask:0xf
  s_nop 1
  v_max_f32_dpp v28, v28, v28 row_mirror row_mask:0xf bank_mask:0xf
  v_mov_b32 v29, v28
  s_nop 1
  v_permlane16_swap_b32 v28, v29
  v_max_f32 v28, v28, v29
  v_mov_b32 v29, v28
  s_nop 1
  v_permlane32_swap_b32 v28, v29
  v_max_f32 v28, v28, v29
  v_frexp_exp_i32_f32 v28, v28
  v_sub_u32 v29, 0, v28
  v_mul_f32 v26, 0x3fb8aa3b, v32
  v_mov_b32 v27, 0x3fb8aa3b
  v_fma_f32 v27, v32, v27, -v26
  v_fmac_f32 v27, 0x32a57060, v32
  v_exp_f32 v26, v26
  v_mul_f32 v27, 0x3f317218, v27
  v_fma_f32 v32, v26, v27, v26
  v_cvt_pk_bf16_f32 v32, v32, v32
  v_and_b32 v32, 0xffff0000, v32
  v_mul_f32 v32, v32, v24
  v_mul_f32 v33, v33, v24
  v_ldexp_f32 v34, v34, v29
  v_ldexp_f32 v35, v35, v29
  v_mul_f32 v32, 0xbfb8aa3b, v32
  v_mul_f32 v33, 0x3e22f983, v33
  v_mul_f32 v26, 0x3fb8aa3b, v36
  v_mov_b32 v27, 0x3fb8aa3b
  v_fma_f32 v27, v36, v27, -v26
  v_fmac_f32 v27, 0x32a57060, v36
  v_exp_f32 v26, v26
  v_mul_f32 v27, 0x3f317218, v27
  v_fma_f32 v36, v26, v27, v26
  v_cvt_pk_bf16_f32 v36, v36, v36
  v_and_b32 v36, 0xffff0000, v36
  v_mul_f32 v36, v36, v24
  v_mul_f32 v37, v37, v24
  v_ldexp_f32 v38, v38, v29
  v_ldexp_f32 v39, v39, v29
  v_mul_f32 v36, 0xbfb8aa3b, v36
  v_mul_f32 v37, 0x3e22f983, v37
  v_add_f32 v24, v24, v24
  v_ldexp_f32 v233, v24, v28
  s_lshl_b32 s6, s3, 11
  v_lshl_add_u32 v16, v0, 5, s6
  ds_write_b128 v16, v[32:35] offset:0
  ds_write_b128 v16, v[36:39] offset:16
  ds_read_b128 v[8:11], v3 offset:0
  v_mov_b32 v48, 0
  v_mov_b32 v49, 0
  v_mov_b32 v50, 0
  v_mov_b32 v51, 0
  v_mov_b32 v52, 0
  v_mov_b32 v53, 0
  v_mov_b32 v54, 0
  v_mov_b32 v55, 0
  v_mov_b32 v56, 0
  v_mov_b32 v57, 0
  v_mov_b32 v58, 0
  v_mov_b32 v59, 0
  v_mov_b32 v16, 0
  v_mov_b32 v17, 0
  v_mov_b32 v18, 0
  v_mov_b32 v19, 0
  v_mov_b32 v20, 0
  v_mov_b32 v21, 0
  v_mov_b32 v22, 0
  v_mov_b32 v23, 0
  v_mov_b32 v24, 0
  v_mov_b32 v25, 0
  v_mov_b32 v26, 0
  v_mov_b32 v27, 0
  v_mov_b32 v28, 0
  v_mov_b32 v29, 0
  v_mov_b32 v30, 0
  v_mov_b32 v31, 0
  s_mov_b32 s6, 2
L_kg_109:
  s_waitcnt lgkmcnt(0)
  ds_read_b128 v[12:15], v3 offset:16
  v_mfma_f32_16x16x32_f16 v[48:51], v[16:19], v[28:31], v[48:51]
  v_pk_mul_f32 v[38:39], v[8:9], v[6:7] op_sel:[0,1] op_sel_hi:[1,1]
  v_mfma_f32_16x16x32_f16 v[52:55], v[20:23], v[28:31], v[52:55]
  v_pk_mul_f32 v[32:33], v[8:9], v[4:5] op_sel:[0,0] op_sel_hi:[1,0]
  v_mfma_f32_16x16x32_f16 v[56:59], v[24:27], v[28:31], v[56:59]
  v_pk_mul_f32 v[34:35], v[8:9], v[4:5] op_sel:[0,1] op_sel_hi:[1,1]
  v_pk_mul_f32 v[36:37], v[8:9], v[6:7] op_sel:[0,0] op_sel_hi:[1,0]
  v_fract_f32 v39, v39
  v_fract_f32 v33, v33
  v_fract_f32 v35, v35
  v_fract_f32 v37, v37
  v_exp_f32 v38, v38
  v_cos_f32 v46, v39
  v_sin_f32 v47, v39
  v_exp_f32 v32, v32
  v_cos_f32 v40, v33
  v_sin_f32 v41, v33
  v_exp_f32 v34, v34
  v_cos_f32 v42, v35
  v_sin_f32 v43, v35
  v_exp_f32 v36, v36
  v_cos_f32 v44, v37
  v_sin_f32 v45, v37
  v_pk_mul_f32 v[46:47], v[46:47], v[38:39] op_sel_hi:[1,0]
  v_pk_mul_f32 v[40:41], v[40:41], v[32:33] op_sel_hi:[1,0]
  v_pk_mul_f32 v[42:43], v[42:43], v[34:35] op_sel_hi:[1,0]
  v_pk_mul_f32 v[44:45], v[44:45], v[36:37] op_sel_hi:[1,0]
  v_pk_mul_f32 v[32:33], v[46:47], v[10:11] op_sel_hi:[1,0] neg_hi:[1,0]
  v_cvt_pk_f16_f32 v16, v40, v41
  v_pk_fma_f32 v[32:33], v[46:47], v[10:11], v[32:33] op_sel:[1,1,0] op_sel_hi:[0,1,1] neg_lo:[1,0,0] neg_hi:[1,0,0]
  v_cvt_pk_f16_f32 v20, v42, v43
  v_cvt_pk_f16_f32 v24, v44, v45
  v_cvt_pk_f16_f32 v28, v32, v33
  s_waitcnt lgkmcnt(0)
  ds_read_b128 v[8:11], v3 offset:32
  v_pk_mul_f32 v[38:39], v[12:13], v[6:7] op_sel:[0,1] op_sel_hi:[1,1]
  v_pk_mul_f32 v[32:33], v[12:13], v[4:5] op_sel:[0,0] op_sel_hi:[1,0]
  v_pk_mul_f32 v[34:35], v[12:13], v[4:5] op_sel:[0,1] op_sel_hi:[1,1]
  v_pk_mul_f32 v[36:37], v[12:13], v[6:7] op_sel:[0,0] op_sel_hi:[1,0]
  v_fract_f32 v39, v39
  v_fract_f32 v33, v33
  v_fract_f32 v35, v35
  v_fract_f32 v37, v37
  v_exp_f32 v38, v38
  v_cos_f32 v46, v39
  v_sin_f32 v47, v39
  v_exp_f32 v32, v32
  v_cos_f32 v40, v33
  v_sin_f32 v41, v33
  v_exp_f32 v34, v34
  v_cos_f32 v42, v35
  v_sin_f32 v43, v35
  v_exp_f32 v36, v36
  v_cos_f32 v44, v37
  v_sin_f32 v45, v37
  v_pk_mul_f32 v[46:47], v[46:47], v[38:39] op_sel_hi:[1,0]
  v_pk_mul_f32 v[40:41], v[40:41], v[32:33] op_sel_hi:[1,0]
  v_pk_mul_f32 v[42:43], v[42:43], v[34:35] op_sel_hi:[1,0]
  v_pk_mul_f32 v[44:45], v[44:45], v[36:37] op_sel_hi:[1,0]
  v_pk_mul_f32 v[32:33], v[46:47], v[14:15] op_sel_hi:[1,0] neg_hi:[1,0]
  v_cvt_pk_f16_f32 v17, v40, v41
  v_pk_fma_f32 v[32:33], v[46:47], v[14:15], v[32:33] op_sel:[1,1,0] op_sel_hi:[0,1,1] neg_lo:[1,0,0] neg_hi:[1,0,0]
  v_cvt_pk_f16_f32 v21, v42, v43
  v_cvt_pk_f16_f32 v25, v44, v45
  v_cvt_pk_f16_f32 v29, v32, v33
  s_waitcnt lgkmcnt(0)
  ds_read_b128 v[12:15], v3 offset:48
  v_pk_mul_f32 v[38:39], v[8:9], v[6:7] op_sel:[0,1] op_sel_hi:[1,1]
  v_pk_mul_f32 v[32:33], v[8:9], v[4:5] op_sel:[0,0] op_sel_hi:[1,0]
  v_pk_mul_f32 v[34:35], v[8:9], v[4:5] op_sel:[0,1] op_sel_hi:[1,1]
  v_pk_mul_f32 v[36:37], v[8:9], v[6:7] op_sel:[0,0] op_sel_hi:[1,0]
  v_fract_f32 v39, v39
  v_fract_f32 v33, v33
  v_fract_f32 v35, v35
  v_fract_f32 v37, v37
  v_exp_f32 v38, v38
  v_cos_f32 v46, v39
  v_sin_f32 v47, v39
  v_exp_f32 v32, v32
  v_cos_f32 v40, v33
  v_sin_f32 v41, v33
  v_exp_f32 v34, v34
  v_cos_f32 v42, v35
  v_sin_f32 v43, v35
  v_exp_f32 v36, v36
  v_cos_f32 v44, v37
  v_sin_f32 v45, v37
  v_pk_mul_f32 v[46:47], v[46:47], v[38:39] op_sel_hi:[1,0]
  v_pk_mul_f32 v[40:41], v[40:41], v[32:33] op_sel_hi:[1,0]
  v_pk_mul_f32 v[42:43], v[42:43], v[34:35] op_sel_hi:[1,0]
  v_pk_mul_f32 v[44:45], v[44:45], v[36:37] op_sel_hi:[1,0]
  v_pk_mul_f32 v[32:33], v[46:47], v[10:11] op_sel_hi:[1,0] neg_hi:[1,0]
  v_cvt_pk_f16_f32 v18, v40, v41
  v_pk_fma_f32 v[32:33], v[46:47], v[10:11], v[32:33] op_sel:[1,1,0] op_sel_hi:[0,1,1] neg_lo:[1,0,0] neg_hi:[1,0,0]
  v_cvt_pk_f16_f32 v22, v42, v43
  v_cvt_pk_f16_f32 v26, v44, v45
  v_cvt_pk_f16_f32 v30, v32, v33
  s_waitcnt lgkmcnt(0)
  ds_read_b128 v[8:11], v3 offset:256
  v_pk_mul_f32 v[38:39], v[12:13], v[6:7] op_sel:[0,1] op_sel_hi:[1,1]
  v_pk_mul_f32 v[32:33], v[12:13], v[4:5] op_sel:[0,0] op_sel_hi:[1,0]
  v_pk_mul_f32 v[34:35], v[12:13], v[4:5] op_sel:[0,1] op_sel_hi:[1,1]
  v_pk_mul_f32 v[36:37], v[12:13], v[6:7] op_sel:[0,0] op_sel_hi:[1,0]
  v_fract_f32 v39, v39
  v_fract_f32 v33, v33
  v_fract_f32 v35, v35
  v_fract_f32 v37, v37
  v_exp_f32 v38, v38
  v_cos_f32 v46, v39
  v_sin_f32 v47, v39
  v_exp_f32 v32, v32
  v_cos_f32 v40, v33
  v_sin_f32 v41, v33
  v_exp_f32 v34, v34
  v_cos_f32 v42, v35
  v_sin_f32 v43, v35
  v_exp_f32 v36, v36
  v_cos_f32 v44, v37
  v_sin_f32 v45, v37
  v_pk_mul_f32 v[46:47], v[46:47], v[38:39] op_sel_hi:[1,0]
  v_pk_mul_f32 v[40:41], v[40:41], v[32:33] op_sel_hi:[1,0]
  v_pk_mul_f32 v[42:43], v[42:43], v[34:35] op_sel_hi:[1,0]
  v_pk_mul_f32 v[44:45], v[44:45], v[36:37] op_sel_hi:[1,0]
  v_pk_mul_f32 v[32:33], v[46:47], v[14:15] op_sel_hi:[1,0] neg_hi:[1,0]
  v_cvt_pk_f16_f32 v19, v40, v41
  v_pk_fma_f32 v[32:33], v[46:47], v[14:15], v[32:33] op_sel:[1,1,0] op_sel_hi:[0,1,1] neg_lo:[1,0,0] neg_hi:[1,0,0]
  v_cvt_pk_f16_f32 v23, v42, v43
  v_cvt_pk_f16_f32 v27, v44, v45
  v_cvt_pk_f16_f32 v31, v32, v33
  v_add_u32 v3, 256, v3
  s_sub_u32 s6, s6, 1
  s_cmp_lg_u32 s6, 0
  s_cbranch_scc1 L_kg_109
  s_mov_b32 s6, 2
L_kg_110:
  s_waitcnt lgkmcnt(0)
  ds_read_b128 v[12:15], v3 offset:16
  v_mfma_f32_16x16x32_f16 v[48:51], v[16:19], v[28:31], v[48:51]
  v_pk_mul_f32 v[38:39], v[8:9], v[6:7] op_sel:[0,1] op_sel_hi:[1,1]
  v_mfma_f32_16x16x32_f16 v[52:55], v[20:23], v[28:31], v[52:55]
  v_pk_mul_f32 v[32:33], v[8:9], v[4:5] op_sel:[0,0] op_sel_hi:[1,0]
  v_mfma_f32_16x16x32_f16 v[56:59], v[24:27], v[28:31], v[56:59]
  v_pk_mul_f32 v[34:35], v[8:9], v[4:5] op_sel:[0,1] op_sel_hi:[1,1]
  v_pk_mul_f32 v[36:37], v[8:9], v[6:7] op_sel:[0,0] op_sel_hi:[1,0]
  v_fract_f32 v39, v39
  v_fract_f32 v33, v33
  v_fract_f32 v35, v35
  v_fract_f32 v37, v37
  v_exp_f32 v38, v38
  v_cos_f32 v46, v39
  v_sin_f32 v47, v39
  v_exp_f32 v32, v32
  v_cos_f32 v40, v33
  v_sin_f32 v41, v33
  v_exp_f32 v34, v34
  v_cos_f32 v42, v35
  v_sin_f32 v43, v35
  v_exp_f32 v36, v36
  v_cos_f32 v44, v37
  v_sin_f32 v45, v37
  v_pk_mul_f32 v[46:47], v[46:47], v[38:39] op_sel_hi:[1,0]
  v_pk_mul_f32 v[40:41], v[40:41], v[32:33] op_sel_hi:[1,0]
  v_pk_mul_f32 v[42:43], v[42:43], v[34:35] op_sel_hi:[1,0]
  v_pk_mul_f32 v[44:45], v[44:45], v[36:37] op_sel_hi:[1,0]
  v_pk_mul_f32 v[32:33], v[46:47], v[10:11] op_sel_hi:[1,0] neg_hi:[1,0]
  v_cvt_pk_f16_f32 v16, v40, v41
  v_pk_fma_f32 v[32:33], v[46:47], v[10:11], v[32:33] op_sel:[1,1,0] op_sel_hi:[0,1,1] neg_lo:[1,0,0] neg_hi:[1,0,0]
  v_cvt_pk_f16_f32 v20, v42, v43
  v_cvt_pk_f16_f32 v24, v44, v45
  v_cvt_pk_f16_f32 v28, v32, v33
  s_waitcnt lgkmcnt(0)
  ds_read_b128 v[8:11], v3 offset:32
  v_pk_mul_f32 v[38:39], v[12:13], v[6:7] op_sel:[0,1] op_sel_hi:[1,1]
  v_pk_mul_f32 v[32:33], v[12:13], v[4:5] op_sel:[0,0] op_sel_hi:[1,0]
  v_pk_mul_f32 v[34:35], v[12:13], v[4:5] op_sel:[0,1] op_sel_hi:[1,1]
  v_pk_mul_f32 v[36:37], v[12:13], v[6:7] op_sel:[0,0] op_sel_hi:[1,0]
  v_fract_f32 v39, v39
  v_fract_f32 v33, v33
  v_fract_f32 v35, v35
  v_fract_f32 v37, v37
  v_exp_f32 v38, v38
  v_cos_f32 v46, v39
  v_sin_f32 v47, v39
  v_exp_f32 v32, v32
  v_cos_f32 v40, v33
  v_sin_f32 v41, v33
  v_exp_f32 v34, v34
  v_cos_f32 v42, v35
  v_sin_f32 v43, v35
  v_exp_f32 v36, v36
  v_cos_f32 v44, v37
  v_sin_f32 v45, v37
  v_pk_mul_f32 v[46:47], v[46:47], v[38:39] op_sel_hi:[1,0]
  v_pk_mul_f32 v[40:41], v[40:41], v[32:33] op_sel_hi:[1,0]
  v_pk_mul_f32 v[42:43], v[42:43], v[34:35] op_sel_hi:[1,0]
  v_pk_mul_f32 v[44:45], v[44:45], v[36:37] op_sel_hi:[1,0]
  v_pk_mul_f32 v[32:33], v[46:47], v[14:15] op_sel_hi:[1,0] neg_hi:[1,0]
  v_cvt_pk_f16_f32 v17, v40, v41
  v_pk_fma_f32 v[32:33], v[46:47], v[14:15], v[32:33] op_sel:[1,1,0] op_sel_hi:[0,1,1] neg_lo:[1,0,0] neg_hi:[1,0,0]
  v_cvt_pk_f16_f32 v21, v42, v43
  v_cvt_pk_f16_f32 v25, v44, v45
  v_cvt_pk_f16_f32 v29, v32, v33
  s_waitcnt lgkmcnt(0)
  ds_read_b128 v[12:15], v3 offset:48
  v_pk_mul_f32 v[38:39], v[8:9], v[6:7] op_sel:[0,1] op_sel_hi:[1,1]
  v_pk_mul_f32 v[32:33], v[8:9], v[4:5] op_sel:[0,0] op_sel_hi:[1,0]
  v_pk_mul_f32 v[34:35], v[8:9], v[4:5] op_sel:[0,1] op_sel_hi:[1,1]
  v_pk_mul_f32 v[36:37], v[8:9], v[6:7] op_sel:[0,0] op_sel_hi:[1,0]
  v_fract_f32 v39, v39
  v_fract_f32 v33, v33
  v_fract_f32 v35, v35
  v_fract_f32 v37, v37
  v_exp_f32 v38, v38
  v_cos_f32 v46, v39
  v_sin_f32 v47, v39
  v_exp_f32 v32, v32
  v_cos_f32 v40, v33
  v_sin_f32 v41, v33
  v_exp_f32 v34, v34
  v_cos_f32 v42, v35
  v_sin_f32 v43, v35
  v_exp_f32 v36, v36
  v_cos_f32 v44, v37
  v_sin_f32 v45, v37
  v_pk_mul_f32 v[46:47], v[46:47], v[38:39] op_sel_hi:[1,0]
  v_pk_mul_f32 v[40:41], v[40:41], v[32:33] op_sel_hi:[1,0]
  v_pk_mul_f32 v[42:43], v[42:43], v[34:35] op_sel_hi:[1,0]
  v_pk_mul_f32 v[44:45], v[44:45], v[36:37] op_sel_hi:[1,0]
  v_pk_mul_f32 v[32:33], v[46:47], v[10:11] op_sel_hi:[1,0] neg_hi:[1,0]
  v_cvt_pk_f16_f32 v18, v40, v41
  v_pk_fma_f32 v[32:33], v[46:47], v[10:11], v[32:33] op_sel:[1,1,0] op_sel_hi:[0,1,1] neg_lo:[1,0,0] neg_hi:[1,0,0]
  v_cvt_pk_f16_f32 v22, v42, v43
  v_cvt_pk_f16_f32 v26, v44, v45
  v_cvt_pk_f16_f32 v30, v32, v33
  s_waitcnt lgkmcnt(0)
  ds_read_b128 v[8:11], v3 offset:256
  v_pk_mul_f32 v[38:39], v[12:13], v[6:7] op_sel:[0,1] op_sel_hi:[1,1]
  v_pk_mul_f32 v[32:33], v[12:13], v[4:5] op_sel:[0,0] op_sel_hi:[1,0]
  v_pk_mul_f32 v[34:35], v[12:13], v[4:5] op_sel:[0,1] op_sel_hi:[1,1]
  v_pk_mul_f32 v[36:37], v[12:13], v[6:7] op_sel:[0,0] op_sel_hi:[1,0]
  v_fract_f32 v39, v39
  v_fract_f32 v33, v33
  v_fract_f32 v35, v35
  v_fract_f32 v37, v37
  v_exp_f32 v38, v38
  v_cos_f32 v46, v39
  v_sin_f32 v47, v39
  v_exp_f32 v32, v32
  v_cos_f32 v40, v33
  v_sin_f32 v41, v33
  v_exp_f32 v34, v34
  v_cos_f32 v42, v35
  v_sin_f32 v43, v35
  v_exp_f32 v36, v36
  v_cos_f32 v44, v37
  v_sin_f32 v45, v37
  v_pk_mul_f32 v[46:47], v[46:47], v[38:39] op_sel_hi:[1,0]
  v_pk_mul_f32 v[40:41], v[40:41], v[32:33] op_sel_hi:[1,0]
  v_pk_mul_f32 v[42:43], v[42:43], v[34:35] op_sel_hi:[1,0]
  v_pk_mul_f32 v[44:45], v[44:45], v[36:37] op_sel_hi:[1,0]
  v_pk_mul_f32 v[32:33], v[46:47], v[14:15] op_sel_hi:[1,0] neg_hi:[1,0]
  v_cvt_pk_f16_f32 v19, v40, v41
  v_pk_fma_f32 v[32:33], v[46:47], v[14:15], v[32:33] op_sel:[1,1,0] op_sel_hi:[0,1,1] neg_lo:[1,0,0] neg_hi:[1,0,0]
  v_cvt_pk_f16_f32 v23, v42, v43
  v_cvt_pk_f16_f32 v27, v44, v45
  v_cvt_pk_f16_f32 v31, v32, v33
  v_add_u32 v3, 256, v3
  s_sub_u32 s6, s6, 1
  s_cmp_lg_u32 s6, 0
  s_cbranch_scc1 L_kg_110
  s_mov_b32 s6, 2
L_kg_111:
  s_waitcnt lgkmcnt(0)
  ds_read_b128 v[12:15], v3 offset:16
  v_mfma_f32_16x16x32_f16 v[48:51], v[16:19], v[28:31], v[48:51]
  v_pk_mul_f32 v[38:39], v[8:9], v[6:7] op_sel:[0,1] op_sel_hi:[1,1]
  v_mfma_f32_16x16x32_f16 v[52:55], v[20:23], v[28:31], v[52:55]
  v_pk_mul_f32 v[32:33], v[8:9], v[4:5] op_sel:[0,0] op_sel_hi:[1,0]
  v_mfma_f32_16x16x32_f16 v[56:59], v[24:27], v[28:31], v[56:59]
  v_pk_mul_f32 v[34:35], v[8:9], v[4:5] op_sel:[0,1] op_sel_hi:[1,1]
  v_pk_mul_f32 v[36:37], v[8:9], v[6:7] op_sel:[0,0] op_sel_hi:[1,0]
  v_fract_f32 v39, v39
  v_fract_f32 v33, v33
  v_fract_f32 v35, v35
  v_fract_f32 v37, v37
  v_exp_f32 v38, v38
  v_cos_f32 v46, v39
  v_sin_f32 v47, v39
  v_exp_f32 v32, v32
  v_cos_f32 v40, v33
  v_sin_f32 v41, v33
  v_exp_f32 v34, v34
  v_cos_f32 v42, v35
  v_sin_f32 v43, v35
  v_exp_f32 v36, v36
  v_cos_f32 v44, v37
  v_sin_f32 v45, v37
  v_pk_mul_f32 v[46:47], v[46:47], v[38:39] op_sel_hi:[1,0]
  v_pk_mul_f32 v[40:41], v[40:41], v[32:33] op_sel_hi:[1,0]
  v_pk_mul_f32 v[42:43], v[42:43], v[34:35] op_sel_hi:[1,0]
  v_pk_mul_f32 v[44:45], v[44:45], v[36:37] op_sel_hi:[1,0]
  v_pk_mul_f32 v[32:33], v[46:47], v[10:11] op_sel_hi:[1,0] neg_hi:[1,0]
  v_cvt_pk_f16_f32 v16, v40, v41
  v_pk_fma_f32 v[32:33], v[46:47], v[10:11], v[32:33] op_sel:[1,1,0] op_sel_hi:[0,1,1] neg_lo:[1,0,0] neg_hi:[1,0,0]
  v_cvt_pk_f16_f32 v20, v42, v43
  v_cvt_pk_f16_f32 v24, v44, v45
  v_cvt_pk_f16_f32 v28, v32, v33
  s_waitcnt lgkmcnt(0)
  ds_read_b128 v[8:11], v3 offset:32
  v_pk_mul_f32 v[38:39], v[12:13], v[6:7] op_sel:[0,1] op_sel_hi:[1,1]
  v_pk_mul_f32 v[32:33], v[12:13], v[4:5] op_sel:[0,0] op_sel_hi:[1,0]
  v_pk_mul_f32 v[34:35], v[12:13], v[4:5] op_sel:[0,1] op_sel_hi:[1,1]
  v_pk_mul_f32 v[36:37], v[12:13], v[6:7] op_sel:[0,0] op_sel_hi:[1,0]
  v_fract_f32 v39, v39
  v_fract_f32 v33, v33
  v_fract_f32 v35, v35
  v_fract_f32 v37, v37
  v_exp_f32 v38, v38
  v_cos_f32 v46, v39
  v_sin_f32 v47, v39
  v_exp_f32 v32, v32
  v_cos_f32 v40, v33
  v_sin_f32 v41, v33
  v_exp_f32 v34, v34
  v_cos_f32 v42, v35
  v_sin_f32 v43, v35
  v_exp_f32 v36, v36
  v_cos_f32 v44, v37
  v_sin_f32 v45, v37
  v_pk_mul_f32 v[46:47], v[46:47], v[38:39] op_sel_hi:[1,0]
  v_pk_mul_f32 v[40:41], v[40:41], v[32:33] op_sel_hi:[1,0]
  v_pk_mul_f32 v[42:43], v[42:43], v[34:35] op_sel_hi:[1,0]
  v_pk_mul_f32 v[44:45], v[44:45], v[36:37] op_sel_hi:[1,0]
  v_pk_mul_f32 v[32:33], v[46:47], v[14:15] op_sel_hi:[1,0] neg_hi:[1,0]
  v_cvt_pk_f16_f32 v17, v40, v41
  v_pk_fma_f32 v[32:33], v[46:47], v[14:15], v[32:33] op_sel:[1,1,0] op_sel_hi:[0,1,1] neg_lo:[1,0,0] neg_hi:[1,0,0]
  v_cvt_pk_f16_f32 v21, v42, v43
  v_cvt_pk_f16_f32 v25, v44, v45
  v_cvt_pk_f16_f32 v29, v32, v33
  s_waitcnt lgkmcnt(0)
  ds_read_b128 v[12:15], v3 offset:48
  v_pk_mul_f32 v[38:39], v[8:9], v[6:7] op_sel:[0,1] op_sel_hi:[1,1]
  v_pk_mul_f32 v[32:33], v[8:9], v[4:5] op_sel:[0,0] op_sel_hi:[1,0]
  v_pk_mul_f32 v[34:35], v[8:9], v[4:5] op_sel:[0,1] op_sel_hi:[1,1]
  v_pk_mul_f32 v[36:37], v[8:9], v[6:7] op_sel:[0,0] op_sel_hi:[1,0]
  v_fract_f32 v39, v39
  v_fract_f32 v33, v33
  v_fract_f32 v35, v35
  v_fract_f32 v37, v37
  v_exp_f32 v38, v38
  v_cos_f32 v46, v39
  v_sin_f32 v47, v39
  v_exp_f32 v32, v32
  v_cos_f32 v40, v33
  v_sin_f32 v41, v33
  v_exp_f32 v34, v34
  v_cos_f32 v42, v35
  v_sin_f32 v43, v35
  v_exp_f32 v36, v36
  v_cos_f32 v44, v37
  v_sin_f32 v45, v37
  v_pk_mul_f32 v[46:47], v[46:47], v[38:39] op_sel_hi:[1,0]
  v_pk_mul_f32 v[40:41], v[40:41], v[32:33] op_sel_hi:[1,0]
  v_pk_mul_f32 v[42:43], v[42:43], v[34:35] op_sel_hi:[1,0]
  v_pk_mul_f32 v[44:45], v[44:45], v[36:37] op_sel_hi:[1,0]
  v_pk_mul_f32 v[32:33], v[46:47], v[10:11] op_sel_hi:[1,0] neg_hi:[1,0]
  v_cvt_pk_f16_f32 v18, v40, v41
  v_pk_fma_f32 v[32:33], v[46:47], v[10:11], v[32:33] op_sel:[1,1,0] op_sel_hi:[0,1,1] neg_lo:[1,0,0] neg_hi:[1,0,0]
  v_cvt_pk_f16_f32 v22, v42, v43
  v_cvt_pk_f16_f32 v26, v44, v45
  v_cvt_pk_f16_f32 v30, v32, v33
  s_waitcnt lgkmcnt(0)
  ds_read_b128 v[8:11], v3 offset:256
  v_pk_mul_f32 v[38:39], v[12:13], v[6:7] op_sel:[0,1] op_sel_hi:[1,1]
  v_pk_mul_f32 v[32:33], v[12:13], v[4:5] op_sel:[0,0] op_sel_hi:[1,0]
  v_pk_mul_f32 v[34:35], v[12:13], v[4:5] op_sel:[0,1] op_sel_hi:[1,1]
  v_pk_mul_f32 v[36:37], v[12:13], v[6:7] op_sel:[0,0] op_sel_hi:[1,0]
  v_fract_f32 v39, v39
  v_fract_f32 v33, v33
  v_fract_f32 v35, v35
  v_fract_f32 v37, v37
  v_exp_f32 v38, v38
  v_cos_f32 v46, v39
  v_sin_f32 v47, v39
  v_exp_f32 v32, v32
  v_cos_f32 v40, v33
  v_sin_f32 v41, v33
  v_exp_f32 v34, v34
  v_cos_f32 v42, v35
  v_sin_f32 v43, v35
  v_exp_f32 v36, v36
  v_cos_f32 v44, v37
  v_sin_f32 v45, v37
  v_pk_mul_f32 v[46:47], v[46:47], v[38:39] op_sel_hi:[1,0]
  v_pk_mul_f32 v[40:41], v[40:41], v[32:33] op_sel_hi:[1,0]
  v_pk_mul_f32 v[42:43], v[42:43], v[34:35] op_sel_hi:[1,0]
  v_pk_mul_f32 v[44:45], v[44:45], v[36:37] op_sel_hi:[1,0]
  v_pk_mul_f32 v[32:33], v[46:47], v[14:15] op_sel_hi:[1,0] neg_hi:[1,0]
  v_cvt_pk_f16_f32 v19, v40, v41
  v_pk_fma_f32 v[32:33], v[46:47], v[14:15], v[32:33] op_sel:[1,1,0] op_sel_hi:[0,1,1] neg_lo:[1,0,0] neg_hi:[1,0,0]
  v_cvt_pk_f16_f32 v23, v42, v43
  v_cvt_pk_f16_f32 v27, v44, v45
  v_cvt_pk_f16_f32 v31, v32, v33
  v_add_u32 v3, 256, v3
  s_sub_u32 s6, s6, 1
  s_cmp_lg_u32 s6, 0
  s_cbranch_scc1 L_kg_111
  s_cmp_lg_u32 s3, 0
  s_cbranch_scc1 L_wdo_113
  s_mov_b32 s7, 0
  v_mbcnt_lo_u32_b32 v216, -1, 0
  v_and_b32 v216, 3, v216
  v_lshlrev_b32 v216, 6, v216
L_wd_112:
  buffer_load_dword v217, v216, s[12:15], 0 offen offset:16 sc1
  s_waitcnt vmcnt(0)
  v_cmp_ne_u32 vcc, 64, v217
  s_cbranch_vccz L_wdo_113
  s_add_u32 s7, s7, 1
  s_cmp_lt_u32 s7, 131072
  s_cbranch_scc1 L_wd_112
  s_mov_b32 s6, 50
  s_branch L_err
L_wdo_113:
  s_barrier
  s_lshl_b32 s6, s3, 13
  s_add_u32 s6, s6, s62
  s_add_u32 s6, s6, 0xb000000
  s_lshl_b32 s7, s3, 10
  v_lshlrev_b32 v216, 7, v0
  s_add_u32 m0, s7, 44064
  s_nop 0
  buffer_load_dwordx4 v216, s[8:11], s6 offen lds
  s_add_u32 s6, s6, 16
  s_add_u32 m0, s7, 48192
  s_nop 0
  buffer_load_dwordx4 v216, s[8:11], s6 offen lds
  s_add_u32 s6, s6, 16
  s_add_u32 m0, s7, 52320
  s_nop 0
  buffer_load_dwordx4 v216, s[8:11], s6 offen lds
  s_add_u32 s6, s6, 16
  s_add_u32 m0, s7, 56448
  s_nop 0
  buffer_load_dwordx4 v216, s[8:11], s6 offen lds
  s_add_u32 s6, s6, 16
  s_add_u32 m0, s7, 60544
  s_nop 0
  buffer_load_dwordx4 v216, s[8:11], s6 offen lds
  s_add_u32 s6, s6, 16
  s_add_u32 m0, s7, 64640
  s_nop 0
  buffer_load_dwordx4 v216, s[8:11], s6 offen lds
  s_add_u32 s6, s6, 16
  s_add_u32 m0, s7, 68736
  s_nop 0
  buffer_load_dwordx4 v216, s[8:11], s6 offen lds
  s_add_u32 s6, s6, 16
  s_add_u32 m0, s7, 72832
  s_nop 0
  buffer_load_dwordx4 v216, s[8:11], s6 offen lds
  s_add_u32 s6, s6, 16
  s_mov_b32 s6, 2
L_kg_114:
  s_waitcnt lgkmcnt(0)
  ds_read_b128 v[12:15], v3 offset:16
  v_mfma_f32_16x16x32_f16 v[48:51], v[16:19], v[28:31], v[48:51]
  v_pk_mul_f32 v[38:39], v[8:9], v[6:7] op_sel:[0,1] op_sel_hi:[1,1]
  v_mfma_f32_16x16x32_f16 v[52:55], v[20:23], v[28:31], v[52:55]
  v_pk_mul_f32 v[32:33], v[8:9], v[4:5] op_sel:[0,0] op_sel_hi:[1,0]
  v_mfma_f32_16x16x32_f16 v[56:59], v[24:27], v[28:31], v[56:59]
  v_pk_mul_f32 v[34:35], v[8:9], v[4:5] op_sel:[0,1] op_sel_hi:[1,1]
  v_pk_mul_f32 v[36:37], v[8:9], v[6:7] op_sel:[0,0] op_sel_hi:[1,0]
  v_fract_f32 v39, v39
  v_fract_f32 v33, v33
  v_fract_f32 v35, v35
  v_fract_f32 v37, v37
  v_exp_f32 v38, v38
  v_cos_f32 v46, v39
  v_sin_f32 v47, v39
  v_exp_f32 v32, v32
  v_cos_f32 v40, v33
  v_sin_f32 v41, v33
  v_exp_f32 v34, v34
  v_cos_f32 v42, v35
  v_sin_f32 v43, v35
  v_exp_f32 v36, v36
  v_cos_f32 v44, v37
  v_sin_f32 v45, v37
  v_pk_mul_f32 v[46:47], v[46:47], v[38:39] op_sel_hi:[1,0]
  v_pk_mul_f32 v[40:41], v[40:41], v[32:33] op_sel_hi:[1,0]
  v_pk_mul_f32 v[42:43], v[42:43], v[34:35] op_sel_hi:[1,0]
  v_pk_mul_f32 v[44:45], v[44:45], v[36:37] op_sel_hi:[1,0]
  v_pk_mul_f32 v[32:33], v[46:47], v[10:11] op_sel_hi:[1,0] neg_hi:[1,0]
  v_cvt_pk_f16_f32 v16, v40, v41
  v_pk_fma_f32 v[32:33], v[46:47], v[10:11], v[32:33] op_sel:[1,1,0] op_sel_hi:[0,1,1] neg_lo:[1,0,0] neg_hi:[1,0,0]
  v_cvt_pk_f16_f32 v20, v42, v43
  v_cvt_pk_f16_f32 v24, v44, v45
  v_cvt_pk_f16_f32 v28, v32, v33
  s_waitcnt lgkmcnt(0)
  ds_read_b128 v[8:11], v3 offset:32
  v_pk_mul_f32 v[38:39], v[12:13], v[6:7] op_sel:[0,1] op_sel_hi:[1,1]
  v_pk_mul_f32 v[32:33], v[12:13], v[4:5] op_sel:[0,0] op_sel_hi:[1,0]
  v_pk_mul_f32 v[34:35], v[12:13], v[4:5] op_sel:[0,1] op_sel_hi:[1,1]
  v_pk_mul_f32 v[36:37], v[12:13], v[6:7] op_sel:[0,0] op_sel_hi:[1,0]
  v_fract_f32 v39, v39
  v_fract_f32 v33, v33
  v_fract_f32 v35, v35
  v_fract_f32 v37, v37
  v_exp_f32 v38, v38
  v_cos_f32 v46, v39
  v_sin_f32 v47, v39
  v_exp_f32 v32, v32
  v_cos_f32 v40, v33
  v_sin_f32 v41, v33
  v_exp_f32 v34, v34
  v_cos_f32 v42, v35
  v_sin_f32 v43, v35
  v_exp_f32 v36, v36
  v_cos_f32 v44, v37
  v_sin_f32 v45, v37
  v_pk_mul_f32 v[46:47], v[46:47], v[38:39] op_sel_hi:[1,0]
  v_pk_mul_f32 v[40:41], v[40:41], v[32:33] op_sel_hi:[1,0]
  v_pk_mul_f32 v[42:43], v[42:43], v[34:35] op_sel_hi:[1,0]
  v_pk_mul_f32 v[44:45], v[44:45], v[36:37] op_sel_hi:[1,0]
  v_pk_mul_f32 v[32:33], v[46:47], v[14:15] op_sel_hi:[1,0] neg_hi:[1,0]
  v_cvt_pk_f16_f32 v17, v40, v41
  v_pk_fma_f32 v[32:33], v[46:47], v[14:15], v[32:33] op_sel:[1,1,0] op_sel_hi:[0,1,1] neg_lo:[1,0,0] neg_hi:[1,0,0]
  v_cvt_pk_f16_f32 v21, v42, v43
  v_cvt_pk_f16_f32 v25, v44, v45
  v_cvt_pk_f16_f32 v29, v32, v33
  s_waitcnt lgkmcnt(0)
  ds_read_b128 v[12:15], v3 offset:48
  v_pk_mul_f32 v[38:39], v[8:9], v[6:7] op_sel:[0,1] op_sel_hi:[1,1]
  v_pk_mul_f32 v[32:33], v[8:9], v[4:5] op_sel:[0,0] op_sel_hi:[1,0]
  v_pk_mul_f32 v[34:35], v[8:9], v[4:5] op_sel:[0,1] op_sel_hi:[1,1]
  v_pk_mul_f32 v[36:37], v[8:9], v[6:7] op_sel:[0,0] op_sel_hi:[1,0]
  v_fract_f32 v39, v39
  v_fract_f32 v33, v33
  v_fract_f32 v35, v35
  v_fract_f32 v37, v37
  v_exp_f32 v38, v38
  v_cos_f32 v46, v39
  v_sin_f32 v47, v39
  v_exp_f32 v32, v32
  v_cos_f32 v40, v33
  v_sin_f32 v41, v33
  v_exp_f32 v34, v34
  v_cos_f32 v42, v35
  v_sin_f32 v43, v35
  v_exp_f32 v36, v36
  v_cos_f32 v44, v37
  v_sin_f32 v45, v37
  v_pk_mul_f32 v[46:47], v[46:47], v[38:39] op_sel_hi:[1,0]
  v_pk_mul_f32 v[40:41], v[40:41], v[32:33] op_sel_hi:[1,0]
  v_pk_mul_f32 v[42:43], v[42:43], v[34:35] op_sel_hi:[1,0]
  v_pk_mul_f32 v[44:45], v[44:45], v[36:37] op_sel_hi:[1,0]
  v_pk_mul_f32 v[32:33], v[46:47], v[10:11] op_sel_hi:[1,0] neg_hi:[1,0]
  v_cvt_pk_f16_f32 v18, v40, v41
  v_pk_fma_f32 v[32:33], v[46:47], v[10:11], v[32:33] op_sel:[1,1,0] op_sel_hi:[0,1,1] neg_lo:[1,0,0] neg_hi:[1,0,0]
  v_cvt_pk_f16_f32 v22, v42, v43
  v_cvt_pk_f16_f32 v26, v44, v45
  v_cvt_pk_f16_f32 v30, v32, v33
  s_waitcnt lgkmcnt(0)
  ds_read_b128 v[8:11], v3 offset:256
  v_pk_mul_f32 v[38:39], v[12:13], v[6:7] op_sel:[0,1] op_sel_hi:[1,1]
  v_pk_mul_f32 v[32:33], v[12:13], v[4:5] op_sel:[0,0] op_sel_hi:[1,0]
  v_pk_mul_f32 v[34:35], v[12:13], v[4:5] op_sel:[0,1] op_sel_hi:[1,1]
  v_pk_mul_f32 v[36:37], v[12:13], v[6:7] op_sel:[0,0] op_sel_hi:[1,0]
  v_fract_f32 v39, v39
  v_fract_f32 v33, v33
  v_fract_f32 v35, v35
  v_fract_f32 v37, v37
  v_exp_f32 v38, v38
  v_cos_f32 v46, v39
  v_sin_f32 v47, v39
  v_exp_f32 v32, v32
  v_cos_f32 v40, v33
  v_sin_f32 v41, v33
  v_exp_f32 v34, v34
  v_cos_f32 v42, v35
  v_sin_f32 v43, v35
  v_exp_f32 v36, v36
  v_cos_f32 v44, v37
  v_sin_f32 v45, v37
  v_pk_mul_f32 v[46:47], v[46:47], v[38:39] op_sel_hi:[1,0]
  v_pk_mul_f32 v[40:41], v[40:41], v[32:33] op_sel_hi:[1,0]
  v_pk_mul_f32 v[42:43], v[42:43], v[34:35] op_sel_hi:[1,0]
  v_pk_mul_f32 v[44:45], v[44:45], v[36:37] op_sel_hi:[1,0]
  v_pk_mul_f32 v[32:33], v[46:47], v[14:15] op_sel_hi:[1,0] neg_hi:[1,0]
  v_cvt_pk_f16_f32 v19, v40, v41
  v_pk_fma_f32 v[32:33], v[46:47], v[14:15], v[32:33] op_sel:[1,1,0] op_sel_hi:[0,1,1] neg_lo:[1,0,0] neg_hi:[1,0,0]
  v_cvt_pk_f16_f32 v23, v42, v43
  v_cvt_pk_f16_f32 v27, v44, v45
  v_cvt_pk_f16_f32 v31, v32, v33
  v_add_u32 v3, 256, v3
  s_sub_u32 s6, s6, 1
  s_cmp_lg_u32 s6, 0
  s_cbranch_scc1 L_kg_114
  v_mfma_f32_16x16x32_f16 v[48:51], v[16:19], v[28:31], v[48:51]
  v_mfma_f32_16x16x32_f16 v[52:55], v[20:23], v[28:31], v[52:55]
  v_mfma_f32_16x16x32_f16 v[56:59], v[24:27], v[28:31], v[56:59]
  s_waitcnt lgkmcnt(0)
  s_nop 4
  v_mul_f32 v48, v48, v233
  v_mul_f32 v49, v49, v233
  v_mul_f32 v50, v50, v233
  v_mul_f32 v51, v51, v233
  v_mul_f32 v52, v52, v233
  v_mul_f32 v53, v53, v233
  v_mul_f32 v54, v54, v233
  v_mul_f32 v55, v55, v233
  v_mul_f32 v56, v56, v233
  v_mul_f32 v57, v57, v233
  v_mul_f32 v58, v58, v233
  v_mul_f32 v59, v59, v233
  v_readlane_b32 s61, v52, 32
  v_lshrrev_b32 v16, 4, v0
  v_and_b32 v17, 15, v0
  v_lshlrev_b32 v17, 4, v17
  v_add_u32 v17, s63, v17
  v_lshrrev_b32 v18, 1, v16
  v_and_b32 v19, 1, v16
  v_lshlrev_b32 v20, 8, v18
  v_lshl_add_u32 v20, v19, 3, v20
  v_add3_u32 v20, v20, v17, 2
  v_lshlrev_b32 v21, 8, v19
  v_add_u32 v21, 516, v21
  v_cmp_eq_u32 vcc, 0, v18
  s_nop 1
  v_cndmask_b32 v21, 0, v21, vcc
  v_cndmask_b32 v22, 0, 4, vcc
  v_add_u32 v21, v21, v17
  v_lshlrev_b32 v23, 9, v19
  v_add_u32 v23, 1032, v23
  v_lshlrev_b32 v24, 10, v19
  v_add_u32 v24, 2064, v24
  v_cndmask_b32 v23, v24, v23, vcc
  v_add_u32 v23, v23, v17
  v_mov_b32 v24, 0x100
  v_cndmask_b32 v24, v24, 8, vcc
  v_mov_b32 v25, 0x200
  v_cndmask_b32 v25, v25, v24, vcc
  v_mov_b32 v26, 0x100
  v_cndmask_b32 v25, v25, v26, vcc
  v_cvt_pk_bf16_f32 v32, v48, v49
  v_cvt_pk_bf16_f32 v33, v50, v51
  v_cvt_pk_bf16_f32 v34, v52, v53
  v_cvt_pk_bf16_f32 v35, v54, v55
  v_cvt_pk_bf16_f32 v36, v56, v57
  v_cvt_pk_bf16_f32 v37, v58, v59
  ds_write_b16 v21, v34
  v_add_u32 v21, v21, v22
  ds_write_b16_d16_hi v21, v34
  v_add_u32 v21, v21, v22
  ds_write_b16 v21, v35
  v_add_u32 v21, v21, v22
  ds_write_b16_d16_hi v21, v35
  ds_write_b16 v20, v32 offset:0
  ds_write_b16_d16_hi v20, v32 offset:2
  ds_write_b16 v20, v33 offset:4
  ds_write_b16_d16_hi v20, v33 offset:6
  ds_write_b16 v23, v36
  v_add_u32 v26, v23, v24
  v_add_u32 v23, v23, v25
  ds_write_b16_d16_hi v26, v36
  ds_write_b16 v23, v37
  v_add_u32 v23, v23, v24
  ds_write_b16_d16_hi v23, v37
  ds_read_u16 v160, v160
  ds_read_u16 v161, v161
  ds_read_u16 v162, v162
  ds_read_u16 v163, v163
  ds_read_u16 v164, v164
  ds_read_u16 v165, v165
  ds_read_u16 v166, v166
  ds_read_u16 v167, v167
  ds_read_u16 v168, v168
  ds_read_u16 v169, v169
  ds_read_u16 v170, v170
  ds_read_u16 v171, v171
  ds_read_u16 v172, v172
  ds_read_u16 v173, v173
  ds_read_u16 v174, v174
  ds_read_u16 v175, v175
  ds_read_u16 v176, v176
  ds_read_u16 v177, v177
  ds_read_u16 v178, v178
  ds_read_u16 v179, v179
  ds_read_u16 v180, v180
  ds_read_u16 v181, v181
  ds_read_u16 v182, v182
  ds_read_u16 v183, v183
  ds_read_u16 v184, v184
  ds_read_u16 v185, v185
  ds_read_u16 v186, v186
  ds_read_u16 v187, v187
  ds_read_u16 v188, v188
  ds_read_u16 v189, v189
  ds_read_u16 v190, v190
  ds_read_u16 v191, v191
  s_mul_i32 s6, s3, 4608
  s_add_u32 s6, s6, 25600
  v_add_u32 v16, s6, v2
  s_mul_i32 s7, s60, 4608
  s_add_u32 s7, s7, 0x400000
  v_mov_b32 v21, 0
  v_mov_b32 v22, 0
  v_mov_b32 v23, 0
  v_mov_b32 v20, s61
  v_cmp_eq_u32 vcc, 30, v0
  s_nop 1
  v_cndmask_b32 v20, 0, v20, vcc
  s_mul_i32 s62, s3, 4128
  s_add_u32 s62, s62, 44032
  v_and_b32 v24, 16, v2
  v_add_u32 v24, s62, v24
  v_mov_b32 v28, 0
  v_mov_b32 v29, 0
  v_mov_b32 v30, 0
  v_mov_b32 v31, 0
  s_waitcnt lgkmcnt(15)
  v_lshl_or_b32 v160, v161, 16, v160
  v_lshl_or_b32 v161, v163, 16, v162
  v_lshl_or_b32 v162, v165, 16, v164
  v_lshl_or_b32 v163, v167, 16, v166
  ds_write_b128 v16, v[160:163] offset:0
  buffer_store_dwordx4 v[160:163], v2, s[8:11], s7 offen offset:0 sc1
  s_waitcnt lgkmcnt(15)
  s_waitcnt lgkmcnt(15)
  v_lshl_or_b32 v168, v169, 16, v168
  v_lshl_or_b32 v169, v171, 16, v170
  v_lshl_or_b32 v170, v173, 16, v172
  v_lshl_or_b32 v171, v175, 16, v174
  ds_write_b128 v16, v[168:171] offset:1024
  buffer_store_dwordx4 v[168:171], v2, s[8:11], s7 offen offset:1024 sc1
  s_waitcnt lgkmcnt(10)
  v_lshl_or_b32 v176, v177, 16, v176
  v_lshl_or_b32 v177, v179, 16, v178
  v_lshl_or_b32 v178, v181, 16, v180
  v_lshl_or_b32 v179, v183, 16, v182
  ds_write_b128 v16, v[176:179] offset:2048
  buffer_store_dwordx4 v[176:179], v2, s[8:11], s7 offen offset:2048 sc1
  s_waitcnt lgkmcnt(3)
  v_lshl_or_b32 v184, v185, 16, v184
  v_lshl_or_b32 v185, v187, 16, v186
  v_lshl_or_b32 v186, v189, 16, v188
  v_lshl_or_b32 v187, v191, 16, v190
  ds_write_b128 v16, v[184:187] offset:3072
  buffer_store_dwordx4 v[184:187], v2, s[8:11], s7 offen offset:3072 sc1
  s_add_u32 s7, s7, 4096
  ds_write_b128 v24, v[28:31]
  s_mov_b32 exec_hi, 0
  ds_write_b128 v16, v[20:23] offset:4096
  buffer_store_dwordx4 v[20:23], v2, s[8:11], s7 offen sc1
  s_mov_b32 exec_hi, -1
  v_and_b32 v16, 15, v0
  v_lshrrev_b32 v17, 4, v0
  v_lshlrev_b32 v18, 5, v16
  s_add_u32 s6, s6, 480
  v_sub_u32 v18, s6, v18
  v_lshl_add_u32 v4, v17, 4, v18
  v_lshlrev_b32 v18, 1, v16
  v_lshl_add_u32 v18, v17, 4, v18
  v_and_b32 v6, 2, v18
  v_and_b32 v18, -4, v18
  v_add_u32 v5, s62, v18
  v_lshlrev_b32 v18, 5, v16
  v_lshl_add_u32 v18, v17, 3, v18
  v_add3_u32 v7, v18, s62, 32
  s_lshl_b32 s7, s3, 12
  s_add_u32 s7, s7, 60544
  v_add_u32 v8, s7, v18
  v_lshrrev_b32 v18, 1, v16
  v_lshlrev_b32 v18, 15, v18
  v_and_b32 v19, 1, v16
  v_lshl_or_b32 v18, v19, 5, v18
  v_lshl_or_b32 v9, v17, 3, v18
  v_lshlrev_b32 v31, 16, v232
  v_add_u32 v60, 1024, v5
  v_add_u32 v61, 2048, v5
  v_add_u32 v62, 3072, v5
  s_lshl_b32 s62, s60, 6
  s_add_u32 s62, s62, 0x0
  s_waitcnt vmcnt(5) lgkmcnt(0)
  s_barrier
  ds_read_b128 a[32:35], v4 offset:4032
  ds_read_b128 a[36:39], v4 offset:3968
  ds_read_b128 a[40:43], v4 offset:3904
  ds_read2_b32 v[10:11], v5 offset0:112 offset1:113
  ds_read2_b32 v[12:13], v5 offset0:114 offset1:115
  ds_read_b32 v14, v5 offset:464
  ds_read2_b32 v[16:17], v5 offset0:96 offset1:97
  ds_read2_b32 v[18:19], v5 offset0:98 offset1:99
  ds_read_b32 v20, v5 offset:400
  ds_read2_b32 v[32:33], v5 offset0:80 offset1:81
  ds_read2_b32 v[34:35], v5 offset0:82 offset1:83
  ds_read_b32 v36, v5 offset:336
  ds_read2_b32 v[38:39], v5 offset0:64 offset1:65
  ds_read2_b32 v[40:41], v5 offset0:66 offset1:67
  ds_read_b32 v42, v5 offset:272
  ds_read2_b32 v[44:45], v5 offset0:48 offset1:49
  ds_read2_b32 v[46:47], v5 offset0:50 offset1:51
  ds_read_b32 v48, v5 offset:208
  s_waitcnt lgkmcnt(12)
  v_alignbyte_b32 v92, v11, v10, v6
  v_alignbyte_b32 v93, v12, v11, v6
  v_alignbyte_b32 v94, v13, v12, v6
  v_alignbyte_b32 v95, v14, v13, v6
  s_waitcnt lgkmcnt(9)
  v_alignbyte_b32 v88, v17, v16, v6
  v_alignbyte_b32 v89, v18, v17, v6
  v_alignbyte_b32 v90, v19, v18, v6
  v_alignbyte_b32 v91, v20, v19, v6
  v_mfma_f32_16x16x32_bf16 a[0:3], v[92:95], a[32:35], 0
  ds_read2_b32 v[10:11], v5 offset0:32 offset1:33
  ds_read2_b32 v[12:13], v5 offset0:34 offset1:35
  ds_read_b32 v14, v5 offset:144
  ds_read_b128 a[44:47], v4 offset:3840
  s_waitcnt lgkmcnt(10)
  v_alignbyte_b32 v84, v33, v32, v6
  v_alignbyte_b32 v85, v34, v33, v6
  v_alignbyte_b32 v86, v35, v34, v6
  v_alignbyte_b32 v87, v36, v35, v6
  v_mfma_f32_16x16x32_bf16 a[0:3], v[88:91], a[36:39], a[0:3]
  ds_read2_b32 v[16:17], v5 offset0:16 offset1:17
  ds_read2_b32 v[18:19], v5 offset0:18 offset1:19
  ds_read_b32 v20, v5 offset:80
  ds_read_b128 a[32:35], v4 offset:3776
  s_waitcnt lgkmcnt(11)
  v_alignbyte_b32 v80, v39, v38, v6
  v_alignbyte_b32 v81, v40, v39, v6
  v_alignbyte_b32 v82, v41, v40, v6
  v_alignbyte_b32 v83, v42, v41, v6
  v_mfma_f32_16x16x32_bf16 a[0:3], v[84:87], a[40:43], a[0:3]
  ds_read2_b32 v[32:33], v5 offset0:0 offset1:1
  ds_read2_b32 v[34:35], v5 offset0:2 offset1:3
  ds_read_b32 v36, v5 offset:16
  ds_read_b128 a[36:39], v4 offset:3712
  s_waitcnt lgkmcnt(12)
  v_alignbyte_b32 v76, v45, v44, v6
  v_alignbyte_b32 v77, v46, v45, v6
  v_alignbyte_b32 v78, v47, v46, v6
  v_alignbyte_b32 v79, v48, v47, v6
  s_waitcnt lgkmcnt(8)
  v_mfma_f32_16x16x32_bf16 a[0:3], v[80:83], a[44:47], a[0:3]
  ds_read2_b32 v[38:39], v62 offset0:240 offset1:241
  ds_read2_b32 v[40:41], v62 offset0:242 offset1:243
  ds_read_b32 v42, v62 offset:976
  ds_read_b128 a[40:43], v4 offset:3648
  v_alignbyte_b32 v72, v11, v10, v6
  v_alignbyte_b32 v73, v12, v11, v6
  v_alignbyte_b32 v74, v13, v12, v6
  v_alignbyte_b32 v75, v14, v13, v6
  s_waitcnt lgkmcnt(8)
  v_mfma_f32_16x16x32_bf16 a[0:3], v[76:79], a[32:35], a[0:3]
  ds_read2_b32 v[44:45], v62 offset0:112 offset1:113
  ds_read2_b32 v[46:47], v62 offset0:114 offset1:115
  ds_read_b32 v48, v62 offset:464
  ds_read_b128 a[44:47], v4 offset:3584
  v_alignbyte_b32 v68, v17, v16, v6
  v_alignbyte_b32 v69, v18, v17, v6
  v_alignbyte_b32 v70, v19, v18, v6
  v_alignbyte_b32 v71, v20, v19, v6
  s_waitcnt lgkmcnt(8)
  v_mfma_f32_16x16x32_bf16 a[0:3], v[72:75], a[36:39], a[0:3]
  ds_read2_b32 v[10:11], v61 offset0:240 offset1:241
  ds_read2_b32 v[12:13], v61 offset0:242 offset1:243
  ds_read_b32 v14, v61 offset:976
  ds_read_b128 a[32:35], v4 offset:4032
  v_alignbyte_b32 v64, v33, v32, v6
  v_alignbyte_b32 v65, v34, v33, v6
  v_alignbyte_b32 v66, v35, v34, v6
  v_alignbyte_b32 v67, v36, v35, v6
  s_waitcnt lgkmcnt(8)
  v_mfma_f32_16x16x32_bf16 a[0:3], v[68:71], a[40:43], a[0:3]
  ds_read2_b32 v[16:17], v61 offset0:112 offset1:113
  ds_read2_b32 v[18:19], v61 offset0:114 offset1:115
  ds_read_b32 v20, v61 offset:464
  ds_read_b128 a[36:39], v4 offset:3968
  v_alignbyte_b32 v26, v39, v38, v6
  v_alignbyte_b32 v27, v40, v39, v6
  v_alignbyte_b32 v28, v41, v40, v6
  v_alignbyte_b32 v29, v42, v41, v6
  s_waitcnt lgkmcnt(8)
  v_mfma_f32_16x16x32_bf16 a[0:3], v[64:67], a[44:47], a[0:3]
  ds_read2_b32 v[32:33], v60 offset0:240 offset1:241
  ds_read2_b32 v[34:35], v60 offset0:242 offset1:243
  ds_read_b32 v36, v60 offset:976
  ds_read_b128 a[40:43], v4 offset:3904
  v_alignbyte_b32 v56, v45, v44, v6
  v_alignbyte_b32 v57, v46, v45, v6
  v_alignbyte_b32 v58, v47, v46, v6
  v_alignbyte_b32 v59, v48, v47, v6
  v_accvgpr_write_b32 a92, v56
  v_accvgpr_write_b32 a93, v57
  v_accvgpr_write_b32 a94, v58
  v_accvgpr_write_b32 a95, v59
  s_waitcnt lgkmcnt(8)
  v_mfma_f32_16x16x32_bf16 a[28:31], v[26:29], a[32:35], 0
  ds_read2_b32 v[38:39], v60 offset0:112 offset1:113
  ds_read2_b32 v[40:41], v60 offset0:114 offset1:115
  ds_read_b32 v42, v60 offset:464
  ds_read_b128 a[44:47], v4 offset:3840
  ds_read_b64 v[224:225], v7 offset:0
  ds_read_b64 v[226:227], v8 offset:0
  v_accvgpr_read_b32 v96, a0
  v_accvgpr_read_b32 v97, a1
  v_accvgpr_read_b32 v98, a2
  v_accvgpr_read_b32 v99, a3
  s_waitcnt lgkmcnt(0)
  v_lshlrev_b32 v128, 16, v224
  v_and_b32 v129, 0xffff0000, v224
  v_lshlrev_b32 v130, 16, v225
  v_and_b32 v131, 0xffff0000, v225
  v_lshlrev_b32 v192, 16, v226
  v_and_b32 v193, 0xffff0000, v226
  v_lshlrev_b32 v194, 16, v227
  v_and_b32 v195, 0xffff0000, v227
  v_mul_f32 v160, v128, v31
  v_mul_f32 v161, v129, v31
  v_mul_f32 v162, v130, v31
  v_mul_f32 v163, v131, v31
  v_fmac_f32 v96, s61, v128
  v_fmac_f32 v97, s61, v129
  v_fmac_f32 v98, s61, v130
  v_fmac_f32 v99, s61, v131
  v_cvt_pk_bf16_f32 v224, v160, v161
  v_cvt_pk_bf16_f32 v225, v162, v163
  v_lshlrev_b32 v160, 16, v224
  v_and_b32 v161, 0xffff0000, v224
  v_lshlrev_b32 v162, 16, v225
  v_and_b32 v163, 0xffff0000, v225
  v_cvt_pk_bf16_f32 v224, v96, v97
  v_cvt_pk_bf16_f32 v225, v98, v99
  v_lshlrev_b32 v96, 16, v224
  v_and_b32 v97, 0xffff0000, v224
  v_lshlrev_b32 v98, 16, v225
  v_and_b32 v99, 0xffff0000, v225
  v_add_f32 v96, v96, v160
  v_add_f32 v97, v97, v161
  v_add_f32 v98, v98, v162
  v_add_f32 v99, v99, v163
  v_cvt_pk_bf16_f32 v224, v96, v97
  v_cvt_pk_bf16_f32 v225, v98, v99
  v_lshlrev_b32 v96, 16, v224
  v_and_b32 v97, 0xffff0000, v224
  v_lshlrev_b32 v98, 16, v225
  v_and_b32 v99, 0xffff0000, v225
  v_add_f32 v96, v96, v192
  v_add_f32 v97, v97, v193
  v_add_f32 v98, v98, v194
  v_add_f32 v99, v99, v195
  v_cvt_pk_bf16_f32 v224, v96, v97
  v_cvt_pk_bf16_f32 v225, v98, v99
  s_add_u32 s6, s62, 0
  buffer_store_dwordx2 v[224:225], v9, s[8:11], s6 offen sc1
  v_alignbyte_b32 v252, v11, v10, v6
  v_alignbyte_b32 v253, v12, v11, v6
  v_alignbyte_b32 v254, v13, v12, v6
  v_alignbyte_b32 v255, v14, v13, v6
  v_mfma_f32_16x16x32_bf16 a[24:27], a[92:95], a[32:35], 0
  ds_read2_b32 v[44:45], v5 offset0:240 offset1:241
  ds_read2_b32 v[46:47], v5 offset0:242 offset1:243
  ds_read_b32 v48, v5 offset:976
  v_alignbyte_b32 v220, v17, v16, v6
  v_alignbyte_b32 v221, v18, v17, v6
  v_alignbyte_b32 v222, v19, v18, v6
  v_alignbyte_b32 v223, v20, v19, v6
  v_mfma_f32_16x16x32_bf16 a[20:23], v[252:255], a[32:35], 0
  ds_read2_b32 v[10:11], v62 offset0:224 offset1:225
  ds_read2_b32 v[12:13], v62 offset0:226 offset1:227
  ds_read_b32 v14, v62 offset:912
  v_alignbyte_b32 v188, v33, v32, v6
  v_alignbyte_b32 v189, v34, v33, v6
  v_alignbyte_b32 v190, v35, v34, v6
  v_alignbyte_b32 v191, v36, v35, v6
  v_mfma_f32_16x16x32_bf16 a[16:19], v[220:223], a[32:35], 0
  ds_read2_b32 v[16:17], v62 offset0:96 offset1:97
  ds_read2_b32 v[18:19], v62 offset0:98 offset1:99
  ds_read_b32 v20, v62 offset:400
  v_alignbyte_b32 v156, v39, v38, v6
  v_alignbyte_b32 v157, v40, v39, v6
  v_alignbyte_b32 v158, v41, v40, v6
  v_alignbyte_b32 v159, v42, v41, v6
  v_mfma_f32_16x16x32_bf16 a[12:15], v[188:191], a[32:35], 0
  ds_read2_b32 v[32:33], v61 offset0:224 offset1:225
  ds_read2_b32 v[34:35], v61 offset0:226 offset1:227
  ds_read_b32 v36, v61 offset:912
  s_waitcnt lgkmcnt(9)
  v_alignbyte_b32 v124, v45, v44, v6
  v_alignbyte_b32 v125, v46, v45, v6
  v_alignbyte_b32 v126, v47, v46, v6
  v_alignbyte_b32 v127, v48, v47, v6
  v_mfma_f32_16x16x32_bf16 a[8:11], v[156:159], a[32:35], 0
  ds_read2_b32 v[38:39], v61 offset0:96 offset1:97
  ds_read2_b32 v[40:41], v61 offset0:98 offset1:99
  ds_read_b32 v42, v61 offset:400
  s_waitcnt lgkmcnt(9)
  v_alignbyte_b32 v22, v11, v10, v6
  v_alignbyte_b32 v23, v12, v11, v6
  v_alignbyte_b32 v24, v13, v12, v6
  v_alignbyte_b32 v25, v14, v13, v6
  v_mfma_f32_16x16x32_bf16 a[4:7], v[124:127], a[32:35], 0
  ds_read2_b32 v[44:45], v60 offset0:224 offset1:225
  ds_read2_b32 v[46:47], v60 offset0:226 offset1:227
  ds_read_b32 v48, v60 offset:912
  s_waitcnt lgkmcnt(9)
  v_alignbyte_b32 v56, v17, v16, v6
  v_alignbyte_b32 v57, v18, v17, v6
  v_alignbyte_b32 v58, v19, v18, v6
  v_alignbyte_b32 v59, v20, v19, v6
  v_accvgpr_write_b32 a88, v56
  v_accvgpr_write_b32 a89, v57
  v_accvgpr_write_b32 a90, v58
  v_accvgpr_write_b32 a91, v59
  v_mfma_f32_16x16x32_bf16 a[28:31], v[22:25], a[36:39], a[28:31]
  ds_read2_b32 v[10:11], v60 offset0:96 offset1:97
  ds_read2_b32 v[12:13], v60 offset0:98 offset1:99
  ds_read_b32 v14, v60 offset:400
  ds_read_b128 a[32:35], v4 offset:3776
  s_waitcnt lgkmcnt(10)
  v_alignbyte_b32 v248, v33, v32, v6
  v_alignbyte_b32 v249, v34, v33, v6
  v_alignbyte_b32 v250, v35, v34, v6
  v_alignbyte_b32 v251, v36, v35, v6
  v_mfma_f32_16x16x32_bf16 a[24:27], a[88:91], a[36:39], a[24:27]
  ds_read2_b32 v[16:17], v5 offset0:224 offset1:225
  ds_read2_b32 v[18:19], v5 offset0:226 offset1:227
  ds_read_b32 v20, v5 offset:912
  s_waitcnt lgkmcnt(10)
  v_alignbyte_b32 v216, v39, v38, v6
  v_alignbyte_b32 v217, v40, v39, v6
  v_alignbyte_b32 v218, v41, v40, v6
  v_alignbyte_b32 v219, v42, v41, v6
  v_mfma_f32_16x16x32_bf16 a[20:23], v[248:251], a[36:39], a[20:23]
  ds_read2_b32 v[32:33], v62 offset0:208 offset1:209
  ds_read2_b32 v[34:35], v62 offset0:210 offset1:211
  ds_read_b32 v36, v62 offset:848
  s_waitcnt lgkmcnt(10)
  v_alignbyte_b32 v184, v45, v44, v6
  v_alignbyte_b32 v185, v46, v45, v6
  v_alignbyte_b32 v186, v47, v46, v6
  v_alignbyte_b32 v187, v48, v47, v6
  v_mfma_f32_16x16x32_bf16 a[16:19], v[216:219], a[36:39], a[16:19]
  ds_read2_b32 v[38:39], v62 offset0:80 offset1:81
  ds_read2_b32 v[40:41], v62 offset0:82 offset1:83
  ds_read_b32 v42, v62 offset:336
  s_waitcnt lgkmcnt(10)
  v_alignbyte_b32 v152, v11, v10, v6
  v_alignbyte_b32 v153, v12, v11, v6
  v_alignbyte_b32 v154, v13, v12, v6
  v_alignbyte_b32 v155, v14, v13, v6
  v_mfma_f32_16x16x32_bf16 a[12:15], v[184:187], a[36:39], a[12:15]
  ds_read2_b32 v[44:45], v61 offset0:208 offset1:209
  ds_read2_b32 v[46:47], v61 offset0:210 offset1:211
  ds_read_b32 v48, v61 offset:848
  s_waitcnt lgkmcnt(9)
  v_alignbyte_b32 v120, v17, v16, v6
  v_alignbyte_b32 v121, v18, v17, v6
  v_alignbyte_b32 v122, v19, v18, v6
  v_alignbyte_b32 v123, v20, v19, v6
  v_mfma_f32_16x16x32_bf16 a[8:11], v[152:155], a[36:39], a[8:11]
  ds_read2_b32 v[10:11], v61 offset0:80 offset1:81
  ds_read2_b32 v[12:13], v61 offset0:82 offset1:83
  ds_read_b32 v14, v61 offset:336
  s_waitcnt lgkmcnt(9)
  v_alignbyte_b32 v26, v33, v32, v6
  v_alignbyte_b32 v27, v34, v33, v6
  v_alignbyte_b32 v28, v35, v34, v6
  v_alignbyte_b32 v29, v36, v35, v6
  v_mfma_f32_16x16x32_bf16 a[4:7], v[120:123], a[36:39], a[4:7]
  ds_read2_b32 v[16:17], v60 offset0:208 offset1:209
  ds_read2_b32 v[18:19], v60 offset0:210 offset1:211
  ds_read_b32 v20, v60 offset:848
  s_waitcnt lgkmcnt(9)
  v_alignbyte_b32 v56, v39, v38, v6
  v_alignbyte_b32 v57, v40, v39, v6
  v_alignbyte_b32 v58, v41, v40, v6
  v_alignbyte_b32 v59, v42, v41, v6
  v_accvgpr_write_b32 a84, v56
  v_accvgpr_write_b32 a85, v57
  v_accvgpr_write_b32 a86, v58
  v_accvgpr_write_b32 a87, v59
  v_mfma_f32_16x16x32_bf16 a[28:31], v[26:29], a[40:43], a[28:31]
  ds_read2_b32 v[32:33], v60 offset0:80 offset1:81
  ds_read2_b32 v[34:35], v60 offset0:82 offset1:83
  ds_read_b32 v36, v60 offset:336
  ds_read_b128 a[36:39], v4 offset:3712
  s_lshl_b32 s6, s60, 2
  s_add_u32 s6, s6, 0x710000
  v_mov_b32 v226, 8
  s_waitcnt vmcnt(0)
  s_mov_b64 exec, 1
  buffer_store_dword v226, v1, s[8:11], s6 offen sc1
  s_mov_b64 exec, -1
  s_waitcnt lgkmcnt(10)
  v_alignbyte_b32 v244, v45, v44, v6
  v_alignbyte_b32 v245, v46, v45, v6
  v_alignbyte_b32 v246, v47, v46, v6
  v_alignbyte_b32 v247, v48, v47, v6
  v_mfma_f32_16x16x32_bf16 a[24:27], a[84:87], a[40:43], a[24:27]
  ds_read2_b32 v[38:39], v5 offset0:208 offset1:209
  ds_read2_b32 v[40:41], v5 offset0:210 offset1:211
  ds_read_b32 v42, v5 offset:848
  s_waitcnt lgkmcnt(10)
  v_alignbyte_b32 v212, v11, v10, v6
  v_alignbyte_b32 v213, v12, v11, v6
  v_alignbyte_b32 v214, v13, v12, v6
  v_alignbyte_b32 v215, v14, v13, v6
  v_mfma_f32_16x16x32_bf16 a[20:23], v[244:247], a[40:43], a[20:23]
  ds_read2_b32 v[44:45], v62 offset0:192 offset1:193
  ds_read2_b32 v[46:47], v62 offset0:194 offset1:195
  ds_read_b32 v48, v62 offset:784
  s_waitcnt lgkmcnt(10)
  v_alignbyte_b32 v180, v17, v16, v6
  v_alignbyte_b32 v181, v18, v17, v6
  v_alignbyte_b32 v182, v19, v18, v6
  v_alignbyte_b32 v183, v20, v19, v6
  v_mfma_f32_16x16x32_bf16 a[16:19], v[212:215], a[40:43], a[16:19]
  ds_read2_b32 v[10:11], v62 offset0:64 offset1:65
  ds_read2_b32 v[12:13], v62 offset0:66 offset1:67
  ds_read_b32 v14, v62 offset:272
  s_waitcnt lgkmcnt(10)
  v_alignbyte_b32 v148, v33, v32, v6
  v_alignbyte_b32 v149, v34, v33, v6
  v_alignbyte_b32 v150, v35, v34, v6
  v_alignbyte_b32 v151, v36, v35, v6
  v_mfma_f32_16x16x32_bf16 a[12:15], v[180:183], a[40:43], a[12:15]
  ds_read2_b32 v[16:17], v61 offset0:192 offset1:193
  ds_read2_b32 v[18:19], v61 offset0:194 offset1:195
  ds_read_b32 v20, v61 offset:784
  s_waitcnt lgkmcnt(9)
  v_alignbyte_b32 v116, v39, v38, v6
  v_alignbyte_b32 v117, v40, v39, v6
  v_alignbyte_b32 v118, v41, v40, v6
  v_alignbyte_b32 v119, v42, v41, v6
  v_mfma_f32_16x16x32_bf16 a[8:11], v[148:151], a[40:43], a[8:11]
  ds_read2_b32 v[32:33], v61 offset0:64 offset1:65
  ds_read2_b32 v[34:35], v61 offset0:66 offset1:67
  ds_read_b32 v36, v61 offset:272
  s_waitcnt lgkmcnt(9)
  v_alignbyte_b32 v22, v45, v44, v6
  v_alignbyte_b32 v23, v46, v45, v6
  v_alignbyte_b32 v24, v47, v46, v6
  v_alignbyte_b32 v25, v48, v47, v6
  v_mfma_f32_16x16x32_bf16 a[4:7], v[116:119], a[40:43], a[4:7]
  ds_read2_b32 v[38:39], v60 offset0:192 offset1:193
  ds_read2_b32 v[40:41], v60 offset0:194 offset1:195
  ds_read_b32 v42, v60 offset:784
  s_waitcnt lgkmcnt(9)
  v_alignbyte_b32 v56, v11, v10, v6
  v_alignbyte_b32 v57, v12, v11, v6
  v_alignbyte_b32 v58, v13, v12, v6
  v_alignbyte_b32 v59, v14, v13, v6
  v_accvgpr_write_b32 a80, v56
  v_accvgpr_write_b32 a81, v57
  v_accvgpr_write_b32 a82, v58
  v_accvgpr_write_b32 a83, v59
  v_mfma_f32_16x16x32_bf16 a[28:31], v[22:25], a[44:47], a[28:31]
  ds_read2_b32 v[44:45], v60 offset0:64 offset1:65
  ds_read2_b32 v[46:47], v60 offset0:66 offset1:67
  ds_read_b32 v48, v60 offset:272
  ds_read_b128 a[40:43], v4 offset:3648
  s_waitcnt lgkmcnt(10)
  v_alignbyte_b32 v240, v17, v16, v6
  v_alignbyte_b32 v241, v18, v17, v6
  v_alignbyte_b32 v242, v19, v18, v6
  v_alignbyte_b32 v243, v20, v19, v6
  v_mfma_f32_16x16x32_bf16 a[24:27], a[80:83], a[44:47], a[24:27]
  ds_read2_b32 v[10:11], v5 offset0:192 offset1:193
  ds_read2_b32 v[12:13], v5 offset0:194 offset1:195
  ds_read_b32 v14, v5 offset:784
  s_waitcnt lgkmcnt(10)
  v_alignbyte_b32 v208, v33, v32, v6
  v_alignbyte_b32 v209, v34, v33, v6
  v_alignbyte_b32 v210, v35, v34, v6
  v_alignbyte_b32 v211, v36, v35, v6
  v_mfma_f32_16x16x32_bf16 a[20:23], v[240:243], a[44:47], a[20:23]
  ds_read2_b32 v[16:17], v62 offset0:176 offset1:177
  ds_read2_b32 v[18:19], v62 offset0:178 offset1:179
  ds_read_b32 v20, v62 offset:720
  s_waitcnt lgkmcnt(10)
  v_alignbyte_b32 v176, v39, v38, v6
  v_alignbyte_b32 v177, v40, v39, v6
  v_alignbyte_b32 v178, v41, v40, v6
  v_alignbyte_b32 v179, v42, v41, v6
  v_mfma_f32_16x16x32_bf16 a[16:19], v[208:211], a[44:47], a[16:19]
  ds_read2_b32 v[32:33], v62 offset0:48 offset1:49
  ds_read2_b32 v[34:35], v62 offset0:50 offset1:51
  ds_read_b32 v36, v62 offset:208
  s_waitcnt lgkmcnt(10)
  v_alignbyte_b32 v144, v45, v44, v6
  v_alignbyte_b32 v145, v46, v45, v6
  v_alignbyte_b32 v146, v47, v46, v6
  v_alignbyte_b32 v147, v48, v47, v6
  v_mfma_f32_16x16x32_bf16 a[12:15], v[176:179], a[44:47], a[12:15]
  ds_read2_b32 v[38:39], v61 offset0:176 offset1:177
  ds_read2_b32 v[40:41], v61 offset0:178 offset1:179
  ds_read_b32 v42, v61 offset:720
  s_waitcnt lgkmcnt(9)
  v_alignbyte_b32 v112, v11, v10, v6
  v_alignbyte_b32 v113, v12, v11, v6
  v_alignbyte_b32 v114, v13, v12, v6
  v_alignbyte_b32 v115, v14, v13, v6
  v_mfma_f32_16x16x32_bf16 a[8:11], v[144:147], a[44:47], a[8:11]
  ds_read2_b32 v[44:45], v61 offset0:48 offset1:49
  ds_read2_b32 v[46:47], v61 offset0:50 offset1:51
  ds_read_b32 v48, v61 offset:208
  s_waitcnt lgkmcnt(9)
  v_alignbyte_b32 v26, v17, v16, v6
  v_alignbyte_b32 v27, v18, v17, v6
  v_alignbyte_b32 v28, v19, v18, v6
  v_alignbyte_b32 v29, v20, v19, v6
  v_mfma_f32_16x16x32_bf16 a[4:7], v[112:115], a[44:47], a[4:7]
  ds_read2_b32 v[10:11], v60 offset0:176 offset1:177
  ds_read2_b32 v[12:13], v60 offset0:178 offset1:179
  ds_read_b32 v14, v60 offset:720
  s_waitcnt lgkmcnt(9)
  v_alignbyte_b32 v56, v33, v32, v6
  v_alignbyte_b32 v57, v34, v33, v6
  v_alignbyte_b32 v58, v35, v34, v6
  v_alignbyte_b32 v59, v36, v35, v6
  v_accvgpr_write_b32 a76, v56
  v_accvgpr_write_b32 a77, v57
  v_accvgpr_write_b32 a78, v58
  v_accvgpr_write_b32 a79, v59
  v_mfma_f32_16x16x32_bf16 a[28:31], v[26:29], a[32:35], a[28:31]
  ds_read2_b32 v[16:17], v60 offset0:48 offset1:49
  ds_read2_b32 v[18:19], v60 offset0:50 offset1:51
  ds_read_b32 v20, v60 offset:208
  ds_read_b128 a[44:47], v4 offset:3584
  s_waitcnt lgkmcnt(10)
  v_alignbyte_b32 v236, v39, v38, v6
  v_alignbyte_b32 v237, v40, v39, v6
  v_alignbyte_b32 v238, v41, v40, v6
  v_alignbyte_b32 v239, v42, v41, v6
  v_mfma_f32_16x16x32_bf16 a[24:27], a[76:79], a[32:35], a[24:27]
  ds_read2_b32 v[32:33], v5 offset0:176 offset1:177
  ds_read2_b32 v[34:35], v5 offset0:178 offset1:179
  ds_read_b32 v36, v5 offset:720
  s_waitcnt lgkmcnt(10)
  v_alignbyte_b32 v204, v45, v44, v6
  v_alignbyte_b32 v205, v46, v45, v6
  v_alignbyte_b32 v206, v47, v46, v6
  v_alignbyte_b32 v207, v48, v47, v6
  v_mfma_f32_16x16x32_bf16 a[20:23], v[236:239], a[32:35], a[20:23]
  ds_read2_b32 v[38:39], v62 offset0:160 offset1:161
  ds_read2_b32 v[40:41], v62 offset0:162 offset1:163
  ds_read_b32 v42, v62 offset:656
  s_waitcnt lgkmcnt(10)
  v_alignbyte_b32 v172, v11, v10, v6
  v_alignbyte_b32 v173, v12, v11, v6
  v_alignbyte_b32 v174, v13, v12, v6
  v_alignbyte_b32 v175, v14, v13, v6
  v_mfma_f32_16x16x32_bf16 a[16:19], v[204:207], a[32:35], a[16:19]
  ds_read2_b32 v[44:45], v62 offset0:32 offset1:33
  ds_read2_b32 v[46:47], v62 offset0:34 offset1:35
  ds_read_b32 v48, v62 offset:144
  s_waitcnt lgkmcnt(10)
  v_alignbyte_b32 v140, v17, v16, v6
  v_alignbyte_b32 v141, v18, v17, v6
  v_alignbyte_b32 v142, v19, v18, v6
  v_alignbyte_b32 v143, v20, v19, v6
  v_mfma_f32_16x16x32_bf16 a[12:15], v[172:175], a[32:35], a[12:15]
  ds_read2_b32 v[10:11], v61 offset0:160 offset1:161
  ds_read2_b32 v[12:13], v61 offset0:162 offset1:163
  ds_read_b32 v14, v61 offset:656
  s_waitcnt lgkmcnt(9)
  v_alignbyte_b32 v108, v33, v32, v6
  v_alignbyte_b32 v109, v34, v33, v6
  v_alignbyte_b32 v110, v35, v34, v6
  v_alignbyte_b32 v111, v36, v35, v6
  v_mfma_f32_16x16x32_bf16 a[8:11], v[140:143], a[32:35], a[8:11]
  ds_read2_b32 v[16:17], v61 offset0:32 offset1:33
  ds_read2_b32 v[18:19], v61 offset0:34 offset1:35
  ds_read_b32 v20, v61 offset:144
  s_waitcnt lgkmcnt(9)
  v_alignbyte_b32 v22, v39, v38, v6
  v_alignbyte_b32 v23, v40, v39, v6
  v_alignbyte_b32 v24, v41, v40, v6
  v_alignbyte_b32 v25, v42, v41, v6
  v_mfma_f32_16x16x32_bf16 a[4:7], v[108:111], a[32:35], a[4:7]
  ds_read2_b32 v[32:33], v60 offset0:160 offset1:161
  ds_read2_b32 v[34:35], v60 offset0:162 offset1:163
  ds_read_b32 v36, v60 offset:656
  s_waitcnt lgkmcnt(9)
  v_alignbyte_b32 v56, v45, v44, v6
  v_alignbyte_b32 v57, v46, v45, v6
  v_alignbyte_b32 v58, v47, v46, v6
  v_alignbyte_b32 v59, v48, v47, v6
  v_accvgpr_write_b32 a72, v56
  v_accvgpr_write_b32 a73, v57
  v_accvgpr_write_b32 a74, v58
  v_accvgpr_write_b32 a75, v59
  v_mfma_f32_16x16x32_bf16 a[28:31], v[22:25], a[36:39], a[28:31]
  ds_read2_b32 v[38:39], v60 offset0:32 offset1:33
  ds_read2_b32 v[40:41], v60 offset0:34 offset1:35
  ds_read_b32 v42, v60 offset:144
  ds_read_b128 a[32:35], v4 offset:3520
  s_waitcnt lgkmcnt(10)
  v_alignbyte_b32 v232, v11, v10, v6
  v_alignbyte_b32 v233, v12, v11, v6
  v_alignbyte_b32 v234, v13, v12, v6
  v_alignbyte_b32 v235, v14, v13, v6
  v_mfma_f32_16x16x32_bf16 a[24:27], a[72:75], a[36:39], a[24:27]
  ds_read2_b32 v[44:45], v5 offset0:160 offset1:161
  ds_read2_b32 v[46:47], v5 offset0:162 offset1:163
  ds_read_b32 v48, v5 offset:656
  s_waitcnt lgkmcnt(10)
  v_alignbyte_b32 v200, v17, v16, v6
  v_alignbyte_b32 v201, v18, v17, v6
  v_alignbyte_b32 v202, v19, v18, v6
  v_alignbyte_b32 v203, v20, v19, v6
  v_mfma_f32_16x16x32_bf16 a[20:23], v[232:235], a[36:39], a[20:23]
  ds_read2_b32 v[10:11], v62 offset0:144 offset1:145
  ds_read2_b32 v[12:13], v62 offset0:146 offset1:147
  ds_read_b32 v14, v62 offset:592
  s_waitcnt lgkmcnt(10)
  v_alignbyte_b32 v168, v33, v32, v6
  v_alignbyte_b32 v169, v34, v33, v6
  v_alignbyte_b32 v170, v35, v34, v6
  v_alignbyte_b32 v171, v36, v35, v6
  v_mfma_f32_16x16x32_bf16 a[16:19], v[200:203], a[36:39], a[16:19]
  ds_read2_b32 v[16:17], v62 offset0:16 offset1:17
  ds_read2_b32 v[18:19], v62 offset0:18 offset1:19
  ds_read_b32 v20, v62 offset:80
  s_waitcnt lgkmcnt(10)
  v_alignbyte_b32 v136, v39, v38, v6
  v_alignbyte_b32 v137, v40, v39, v6
  v_alignbyte_b32 v138, v41, v40, v6
  v_alignbyte_b32 v139, v42, v41, v6
  v_mfma_f32_16x16x32_bf16 a[12:15], v[168:171], a[36:39], a[12:15]
  ds_read2_b32 v[32:33], v61 offset0:144 offset1:145
  ds_read2_b32 v[34:35], v61 offset0:146 offset1:147
  ds_read_b32 v36, v61 offset:592
  s_waitcnt lgkmcnt(9)
  v_alignbyte_b32 v104, v45, v44, v6
  v_alignbyte_b32 v105, v46, v45, v6
  v_alignbyte_b32 v106, v47, v46, v6
  v_alignbyte_b32 v107, v48, v47, v6
  v_mfma_f32_16x16x32_bf16 a[8:11], v[136:139], a[36:39], a[8:11]
  ds_read2_b32 v[38:39], v61 offset0:16 offset1:17
  ds_read2_b32 v[40:41], v61 offset0:18 offset1:19
  ds_read_b32 v42, v61 offset:80
  s_waitcnt lgkmcnt(9)
  v_alignbyte_b32 v26, v11, v10, v6
  v_alignbyte_b32 v27, v12, v11, v6
  v_alignbyte_b32 v28, v13, v12, v6
  v_alignbyte_b32 v29, v14, v13, v6
  v_mfma_f32_16x16x32_bf16 a[4:7], v[104:107], a[36:39], a[4:7]
  ds_read2_b32 v[44:45], v60 offset0:144 offset1:145
  ds_read2_b32 v[46:47], v60 offset0:146 offset1:147
  ds_read_b32 v48, v60 offset:592
  s_waitcnt lgkmcnt(9)
  v_alignbyte_b32 v56, v17, v16, v6
  v_alignbyte_b32 v57, v18, v17, v6
  v_alignbyte_b32 v58, v19, v18, v6
  v_alignbyte_b32 v59, v20, v19, v6
  v_accvgpr_write_b32 a68, v56
  v_accvgpr_write_b32 a69, v57
  v_accvgpr_write_b32 a70, v58
  v_accvgpr_write_b32 a71, v59
  v_mfma_f32_16x16x32_bf16 a[28:31], v[26:29], a[40:43], a[28:31]
  ds_read2_b32 v[10:11], v60 offset0:16 offset1:17
  ds_read2_b32 v[12:13], v60 offset0:18 offset1:19
  ds_read_b32 v14, v60 offset:80
  ds_read_b128 a[36:39], v4 offset:3456
  s_waitcnt lgkmcnt(10)
  v_alignbyte_b32 v228, v33, v32, v6
  v_alignbyte_b32 v229, v34, v33, v6
  v_alignbyte_b32 v230, v35, v34, v6
  v_alignbyte_b32 v231, v36, v35, v6
  v_mfma_f32_16x16x32_bf16 a[24:27], a[68:71], a[40:43], a[24:27]
  ds_read2_b32 v[16:17], v5 offset0:144 offset1:145
  ds_read2_b32 v[18:19], v5 offset0:146 offset1:147
  ds_read_b32 v20, v5 offset:592
  s_waitcnt lgkmcnt(10)
  v_alignbyte_b32 v196, v39, v38, v6
  v_alignbyte_b32 v197, v40, v39, v6
  v_alignbyte_b32 v198, v41, v40, v6
  v_alignbyte_b32 v199, v42, v41, v6
  v_mfma_f32_16x16x32_bf16 a[20:23], v[228:231], a[40:43], a[20:23]
  ds_read2_b32 v[32:33], v62 offset0:128 offset1:129
  ds_read2_b32 v[34:35], v62 offset0:130 offset1:131
  ds_read_b32 v36, v62 offset:528
  s_waitcnt lgkmcnt(10)
  v_alignbyte_b32 v164, v45, v44, v6
  v_alignbyte_b32 v165, v46, v45, v6
  v_alignbyte_b32 v166, v47, v46, v6
  v_alignbyte_b32 v167, v48, v47, v6
  v_mfma_f32_16x16x32_bf16 a[16:19], v[196:199], a[40:43], a[16:19]
  ds_read2_b32 v[38:39], v62 offset0:0 offset1:1
  ds_read2_b32 v[40:41], v62 offset0:2 offset1:3
  ds_read_b32 v42, v62 offset:16
  s_waitcnt lgkmcnt(10)
  v_alignbyte_b32 v132, v11, v10, v6
  v_alignbyte_b32 v133, v12, v11, v6
  v_alignbyte_b32 v134, v13, v12, v6
  v_alignbyte_b32 v135, v14, v13, v6
  v_mfma_f32_16x16x32_bf16 a[12:15], v[164:167], a[40:43], a[12:15]
  ds_read2_b32 v[44:45], v61 offset0:128 offset1:129
  ds_read2_b32 v[46:47], v61 offset0:130 offset1:131
  ds_read_b32 v48, v61 offset:528
  s_waitcnt lgkmcnt(9)
  v_alignbyte_b32 v100, v17, v16, v6
  v_alignbyte_b32 v101, v18, v17, v6
  v_alignbyte_b32 v102, v19, v18, v6
  v_alignbyte_b32 v103, v20, v19, v6
  v_mfma_f32_16x16x32_bf16 a[8:11], v[132:135], a[40:43], a[8:11]
  ds_read2_b32 v[10:11], v61 offset0:0 offset1:1
  ds_read2_b32 v[12:13], v61 offset0:2 offset1:3
  ds_read_b32 v14, v61 offset:16
  s_waitcnt lgkmcnt(9)
  v_alignbyte_b32 v22, v33, v32, v6
  v_alignbyte_b32 v23, v34, v33, v6
  v_alignbyte_b32 v24, v35, v34, v6
  v_alignbyte_b32 v25, v36, v35, v6
  v_mfma_f32_16x16x32_bf16 a[4:7], v[100:103], a[40:43], a[4:7]
  ds_read2_b32 v[16:17], v60 offset0:128 offset1:129
  ds_read2_b32 v[18:19], v60 offset0:130 offset1:131
  ds_read_b32 v20, v60 offset:528
  s_waitcnt lgkmcnt(9)
  v_alignbyte_b32 v56, v39, v38, v6
  v_alignbyte_b32 v57, v40, v39, v6
  v_alignbyte_b32 v58, v41, v40, v6
  v_alignbyte_b32 v59, v42, v41, v6
  v_accvgpr_write_b32 a64, v56
  v_accvgpr_write_b32 a65, v57
  v_accvgpr_write_b32 a66, v58
  v_accvgpr_write_b32 a67, v59
  v_mfma_f32_16x16x32_bf16 a[28:31], v[22:25], a[44:47], a[28:31]
  ds_read2_b32 v[32:33], v60 offset0:0 offset1:1
  ds_read2_b32 v[34:35], v60 offset0:2 offset1:3
  ds_read_b32 v36, v60 offset:16
  ds_read_b128 a[40:43], v4 offset:3392
  s_waitcnt lgkmcnt(10)
  v_alignbyte_b32 v224, v45, v44, v6
  v_alignbyte_b32 v225, v46, v45, v6
  v_alignbyte_b32 v226, v47, v46, v6
  v_alignbyte_b32 v227, v48, v47, v6
  v_mfma_f32_16x16x32_bf16 a[24:27], a[64:67], a[44:47], a[24:27]
  ds_read2_b32 v[38:39], v5 offset0:128 offset1:129
  ds_read2_b32 v[40:41], v5 offset0:130 offset1:131
  ds_read_b32 v42, v5 offset:528
  s_waitcnt lgkmcnt(10)
  v_alignbyte_b32 v192, v11, v10, v6
  v_alignbyte_b32 v193, v12, v11, v6
  v_alignbyte_b32 v194, v13, v12, v6
  v_alignbyte_b32 v195, v14, v13, v6
  v_mfma_f32_16x16x32_bf16 a[20:23], v[224:227], a[44:47], a[20:23]
  s_waitcnt lgkmcnt(7)
  v_alignbyte_b32 v160, v17, v16, v6
  v_alignbyte_b32 v161, v18, v17, v6
  v_alignbyte_b32 v162, v19, v18, v6
  v_alignbyte_b32 v163, v20, v19, v6
  v_mfma_f32_16x16x32_bf16 a[16:19], v[192:195], a[44:47], a[16:19]
  s_waitcnt lgkmcnt(4)
  v_alignbyte_b32 v128, v33, v32, v6
  v_alignbyte_b32 v129, v34, v33, v6
  v_alignbyte_b32 v130, v35, v34, v6
  v_alignbyte_b32 v131, v36, v35, v6
  v_mfma_f32_16x16x32_bf16 a[12:15], v[160:163], a[44:47], a[12:15]
  s_waitcnt lgkmcnt(0)
  v_alignbyte_b32 v96, v39, v38, v6
  v_alignbyte_b32 v97, v40, v39, v6
  v_alignbyte_b32 v98, v41, v40, v6
  v_alignbyte_b32 v99, v42, v41, v6
  v_mfma_f32_16x16x32_bf16 a[8:11], v[128:131], a[44:47], a[8:11]
  s_nop 0
  v_mfma_f32_16x16x32_bf16 a[4:7], v[96:99], a[44:47], a[4:7]
  v_mfma_f32_16x16x32_bf16 a[28:31], a[92:95], a[32:35], a[28:31]
  ds_read_b128 a[44:47], v4 offset:3328
  v_mfma_f32_16x16x32_bf16 a[24:27], v[252:255], a[32:35], a[24:27]
  v_mfma_f32_16x16x32_bf16 a[20:23], v[220:223], a[32:35], a[20:23]
  v_mfma_f32_16x16x32_bf16 a[16:19], v[188:191], a[32:35], a[16:19]
  v_mfma_f32_16x16x32_bf16 a[12:15], v[156:159], a[32:35], a[12:15]
  v_mfma_f32_16x16x32_bf16 a[8:11], v[124:127], a[32:35], a[8:11]
  v_mfma_f32_16x16x32_bf16 a[4:7], v[92:95], a[32:35], a[4:7]
  v_mfma_f32_16x16x32_bf16 a[28:31], a[88:91], a[36:39], a[28:31]
  ds_read_b128 a[32:35], v4 offset:3264
  v_mfma_f32_16x16x32_bf16 a[24:27], v[248:251], a[36:39], a[24:27]
  v_mfma_f32_16x16x32_bf16 a[20:23], v[216:219], a[36:39], a[20:23]
  v_mfma_f32_16x16x32_bf16 a[16:19], v[184:187], a[36:39], a[16:19]
  v_mfma_f32_16x16x32_bf16 a[12:15], v[152:155], a[36:39], a[12:15]
  v_mfma_f32_16x16x32_bf16 a[8:11], v[120:123], a[36:39], a[8:11]
  v_mfma_f32_16x16x32_bf16 a[4:7], v[88:91], a[36:39], a[4:7]
  v_mfma_f32_16x16x32_bf16 a[28:31], a[84:87], a[40:43], a[28:31]
  ds_read_b128 a[36:39], v4 offset:3200
  v_mfma_f32_16x16x32_bf16 a[24:27], v[244:247], a[40:43], a[24:27]
  v_mfma_f32_16x16x32_bf16 a[20:23], v[212:215], a[40:43], a[20:23]
  v_mfma_f32_16x16x32_bf16 a[16:19], v[180:183], a[40:43], a[16:19]
  v_mfma_f32_16x16x32_bf16 a[12:15], v[148:151], a[40:43], a[12:15]
  v_mfma_f32_16x16x32_bf16 a[8:11], v[116:119], a[40:43], a[8:11]
  v_mfma_f32_16x16x32_bf16 a[4:7], v[84:87], a[40:43], a[4:7]
  s_waitcnt lgkmcnt(2)
  v_mfma_f32_16x16x32_bf16 a[28:31], a[80:83], a[44:47], a[28:31]
  ds_read_b128 a[40:43], v4 offset:3136
  v_mfma_f32_16x16x32_bf16 a[24:27], v[240:243], a[44:47], a[24:27]
  v_mfma_f32_16x16x32_bf16 a[20:23], v[208:211], a[44:47], a[20:23]
  v_mfma_f32_16x16x32_bf16 a[16:19], v[176:179], a[44:47], a[16:19]
  v_mfma_f32_16x16x32_bf16 a[12:15], v[144:147], a[44:47], a[12:15]
  v_mfma_f32_16x16x32_bf16 a[8:11], v[112:115], a[44:47], a[8:11]
  v_mfma_f32_16x16x32_bf16 a[4:7], v[80:83], a[44:47], a[4:7]
  s_waitcnt lgkmcnt(2)
  v_mfma_f32_16x16x32_bf16 a[28:31], a[76:79], a[32:35], a[28:31]
  ds_read_b128 a[44:47], v4 offset:3072
  v_mfma_f32_16x16x32_bf16 a[24:27], v[236:239], a[32:35], a[24:27]
  v_mfma_f32_16x16x32_bf16 a[20:23], v[204:207], a[32:35], a[20:23]
  v_mfma_f32_16x16x32_bf16 a[16:19], v[172:175], a[32:35], a[16:19]
  v_mfma_f32_16x16x32_bf16 a[12:15], v[140:143], a[32:35], a[12:15]
  v_mfma_f32_16x16x32_bf16 a[8:11], v[108:111], a[32:35], a[8:11]
  v_mfma_f32_16x16x32_bf16 a[4:7], v[76:79], a[32:35], a[4:7]
  s_waitcnt lgkmcnt(2)
  v_mfma_f32_16x16x32_bf16 a[28:31], a[72:75], a[36:39], a[28:31]
  ds_read_b128 a[32:35], v4 offset:3008
  v_mfma_f32_16x16x32_bf16 a[24:27], v[232:235], a[36:39], a[24:27]
  v_mfma_f32_16x16x32_bf16 a[20:23], v[200:203], a[36:39], a[20:23]
  v_mfma_f32_16x16x32_bf16 a[16:19], v[168:171], a[36:39], a[16:19]
  v_mfma_f32_16x16x32_bf16 a[12:15], v[136:139], a[36:39], a[12:15]
  v_mfma_f32_16x16x32_bf16 a[8:11], v[104:107], a[36:39], a[8:11]
  v_mfma_f32_16x16x32_bf16 a[4:7], v[72:75], a[36:39], a[4:7]
  s_waitcnt lgkmcnt(2)
  v_mfma_f32_16x16x32_bf16 a[28:31], a[68:71], a[40:43], a[28:31]
  ds_read_b128 a[36:39], v4 offset:2944
  v_mfma_f32_16x16x32_bf16 a[24:27], v[228:231], a[40:43], a[24:27]
  v_mfma_f32_16x16x32_bf16 a[20:23], v[196:199], a[40:43], a[20:23]
  v_mfma_f32_16x16x32_bf16 a[16:19], v[164:167], a[40:43], a[16:19]
  v_mfma_f32_16x16x32_bf16 a[12:15], v[132:135], a[40:43], a[12:15]
  v_mfma_f32_16x16x32_bf16 a[8:11], v[100:103], a[40:43], a[8:11]
  v_mfma_f32_16x16x32_bf16 a[4:7], v[68:71], a[40:43], a[4:7]
  s_waitcnt lgkmcnt(2)
  v_mfma_f32_16x16x32_bf16 a[28:31], a[64:67], a[44:47], a[28:31]
  ds_read_b128 a[40:43], v4 offset:2880
  v_mfma_f32_16x16x32_bf16 a[24:27], v[224:227], a[44:47], a[24:27]
  v_mfma_f32_16x16x32_bf16 a[20:23], v[192:195], a[44:47], a[20:23]
  v_mfma_f32_16x16x32_bf16 a[16:19], v[160:163], a[44:47], a[16:19]
  v_mfma_f32_16x16x32_bf16 a[12:15], v[128:131], a[44:47], a[12:15]
  v_mfma_f32_16x16x32_bf16 a[8:11], v[96:99], a[44:47], a[8:11]
  v_mfma_f32_16x16x32_bf16 a[4:7], v[64:67], a[44:47], a[4:7]
  s_waitcnt lgkmcnt(2)
  v_mfma_f32_16x16x32_bf16 a[28:31], v[252:255], a[32:35], a[28:31]
  ds_read_b128 a[44:47], v4 offset:2816
  ds_read_b64 v[36:37], v7 offset:512
  ds_read_b64 v[38:39], v8 offset:512
  s_nop 2
  v_accvgpr_read_b32 v44, a4
  v_accvgpr_read_b32 v45, a5
  v_mfma_f32_16x16x32_bf16 a[24:27], v[220:223], a[32:35], a[24:27]
  v_accvgpr_read_b32 v46, a6
  v_accvgpr_read_b32 v47, a7
  v_mfma_f32_16x16x32_bf16 a[20:23], v[188:191], a[32:35], a[20:23]
  s_waitcnt lgkmcnt(0)
  v_lshlrev_b32 v48, 16, v36
  v_and_b32 v49, 0xffff0000, v36
  v_mfma_f32_16x16x32_bf16 a[16:19], v[156:159], a[32:35], a[16:19]
  v_lshlrev_b32 v50, 16, v37
  v_and_b32 v51, 0xffff0000, v37
  v_mfma_f32_16x16x32_bf16 a[12:15], v[124:127], a[32:35], a[12:15]
  v_lshlrev_b32 v32, 16, v38
  v_and_b32 v33, 0xffff0000, v38
  v_mfma_f32_16x16x32_bf16 a[8:11], v[92:95], a[32:35], a[8:11]
  v_lshlrev_b32 v34, 16, v39
  v_and_b32 v35, 0xffff0000, v39
  v_mfma_f32_16x16x32_bf16 a[28:31], v[248:251], a[36:39], a[28:31]
  ds_read_b128 a[32:35], v4 offset:2752
  v_mul_f32 v52, v48, v31
  v_mul_f32 v53, v49, v31
  v_mfma_f32_16x16x32_bf16 a[24:27], v[216:219], a[36:39], a[24:27]
  v_mul_f32 v54, v50, v31
  v_mul_f32 v55, v51, v31
  v_mfma_f32_16x16x32_bf16 a[20:23], v[184:187], a[36:39], a[20:23]
  v_fmac_f32 v44, s61, v48
  v_fmac_f32 v45, s61, v49
  v_mfma_f32_16x16x32_bf16 a[16:19], v[152:155], a[36:39], a[16:19]
  v_fmac_f32 v46, s61, v50
  v_fmac_f32 v47, s61, v51
  v_mfma_f32_16x16x32_bf16 a[12:15], v[120:123], a[36:39], a[12:15]
  v_cvt_pk_bf16_f32 v36, v52, v53
  v_cvt_pk_bf16_f32 v37, v54, v55
  v_mfma_f32_16x16x32_bf16 a[8:11], v[88:91], a[36:39], a[8:11]
  v_lshlrev_b32 v52, 16, v36
  v_and_b32 v53, 0xffff0000, v36
  v_mfma_f32_16x16x32_bf16 a[28:31], v[244:247], a[40:43], a[28:31]
  ds_read_b128 a[36:39], v4 offset:2688
  v_lshlrev_b32 v54, 16, v37
  v_and_b32 v55, 0xffff0000, v37
  v_mfma_f32_16x16x32_bf16 a[24:27], v[212:215], a[40:43], a[24:27]
  v_cvt_pk_bf16_f32 v36, v44, v45
  v_cvt_pk_bf16_f32 v37, v46, v47
  v_mfma_f32_16x16x32_bf16 a[20:23], v[180:183], a[40:43], a[20:23]
  v_lshlrev_b32 v44, 16, v36
  v_and_b32 v45, 0xffff0000, v36
  v_mfma_f32_16x16x32_bf16 a[16:19], v[148:151], a[40:43], a[16:19]
  v_lshlrev_b32 v46, 16, v37
  v_and_b32 v47, 0xffff0000, v37
  v_mfma_f32_16x16x32_bf16 a[12:15], v[116:119], a[40:43], a[12:15]
  v_add_f32 v44, v44, v52
  v_add_f32 v45, v45, v53
  v_mfma_f32_16x16x32_bf16 a[8:11], v[84:87], a[40:43], a[8:11]
  v_add_f32 v46, v46, v54
  v_add_f32 v47, v47, v55
  v_mfma_f32_16x16x32_bf16 a[28:31], v[240:243], a[44:47], a[28:31]
  ds_read_b128 a[40:43], v4 offset:2624
  v_cvt_pk_bf16_f32 v36, v44, v45
  v_cvt_pk_bf16_f32 v37, v46, v47
  v_mfma_f32_16x16x32_bf16 a[24:27], v[208:211], a[44:47], a[24:27]
  v_lshlrev_b32 v44, 16, v36
  v_and_b32 v45, 0xffff0000, v36
  v_mfma_f32_16x16x32_bf16 a[20:23], v[176:179], a[44:47], a[20:23]
  v_lshlrev_b32 v46, 16, v37
  v_and_b32 v47, 0xffff0000, v37
  v_mfma_f32_16x16x32_bf16 a[16:19], v[144:147], a[44:47], a[16:19]
  v_add_f32 v44, v44, v32
  v_add_f32 v45, v45, v33
  v_mfma_f32_16x16x32_bf16 a[12:15], v[112:115], a[44:47], a[12:15]
  v_add_f32 v46, v46, v34
  v_add_f32 v47, v47, v35
  v_mfma_f32_16x16x32_bf16 a[8:11], v[80:83], a[44:47], a[8:11]
  v_cvt_pk_bf16_f32 v36, v44, v45
  v_cvt_pk_bf16_f32 v37, v46, v47
  s_waitcnt lgkmcnt(2)
  v_mfma_f32_16x16x32_bf16 a[28:31], v[236:239], a[32:35], a[28:31]
  ds_read_b128 a[44:47], v4 offset:2560
  s_add_u32 s6, s62, 262144
  buffer_store_dwordx2 v[36:37], v9, s[8:11], s6 offen sc1
  v_mfma_f32_16x16x32_bf16 a[24:27], v[204:207], a[32:35], a[24:27]
  v_mfma_f32_16x16x32_bf16 a[20:23], v[172:175], a[32:35], a[20:23]
  v_mfma_f32_16x16x32_bf16 a[16:19], v[140:143], a[32:35], a[16:19]
  v_mfma_f32_16x16x32_bf16 a[12:15], v[108:111], a[32:35], a[12:15]
  v_mfma_f32_16x16x32_bf16 a[8:11], v[76:79], a[32:35], a[8:11]
  s_waitcnt lgkmcnt(2)
  v_mfma_f32_16x16x32_bf16 a[28:31], v[232:235], a[36:39], a[28:31]
  ds_read_b128 a[32:35], v4 offset:2496
  v_mfma_f32_16x16x32_bf16 a[24:27], v[200:203], a[36:39], a[24:27]
  v_mfma_f32_16x16x32_bf16 a[20:23], v[168:171], a[36:39], a[20:23]
  v_mfma_f32_16x16x32_bf16 a[16:19], v[136:139], a[36:39], a[16:19]
  v_mfma_f32_16x16x32_bf16 a[12:15], v[104:107], a[36:39], a[12:15]
  v_mfma_f32_16x16x32_bf16 a[8:11], v[72:75], a[36:39], a[8:11]
  s_waitcnt lgkmcnt(2)
  v_mfma_f32_16x16x32_bf16 a[28:31], v[228:231], a[40:43], a[28:31]
  ds_read_b128 a[36:39], v4 offset:2432
  v_mfma_f32_16x16x32_bf16 a[24:27], v[196:199], a[40:43], a[24:27]
  v_mfma_f32_16x16x32_bf16 a[20:23], v[164:167], a[40:43], a[20:23]
  v_mfma_f32_16x16x32_bf16 a[16:19], v[132:135], a[40:43], a[16:19]
  v_mfma_f32_16x16x32_bf16 a[12:15], v[100:103], a[40:43], a[12:15]
  v_mfma_f32_16x16x32_bf16 a[8:11], v[68:71], a[40:43], a[8:11]
  s_waitcnt lgkmcnt(2)
  v_mfma_f32_16x16x32_bf16 a[28:31], v[224:227], a[44:47], a[28:31]
  ds_read_b128 a[40:43], v4 offset:2368
  v_mfma_f32_16x16x32_bf16 a[24:27], v[192:195], a[44:47], a[24:27]
  v_mfma_f32_16x16x32_bf16 a[20:23], v[160:163], a[44:47], a[20:23]
  v_mfma_f32_16x16x32_bf16 a[16:19], v[128:131], a[44:47], a[16:19]
  v_mfma_f32_16x16x32_bf16 a[12:15], v[96:99], a[44:47], a[12:15]
  v_mfma_f32_16x16x32_bf16 a[8:11], v[64:67], a[44:47], a[8:11]
  s_waitcnt lgkmcnt(2)
  v_mfma_f32_16x16x32_bf16 a[28:31], v[220:223], a[32:35], a[28:31]
  ds_read_b128 a[44:47], v4 offset:2304
  ds_read_b64 v[36:37], v7 offset:1024
  ds_read_b64 v[38:39], v8 offset:1024
  s_nop 2
  v_accvgpr_read_b32 v44, a8
  v_accvgpr_read_b32 v45, a9
  v_mfma_f32_16x16x32_bf16 a[24:27], v[188:191], a[32:35], a[24:27]
  v_accvgpr_read_b32 v46, a10
  v_accvgpr_read_b32 v47, a11
  v_mfma_f32_16x16x32_bf16 a[20:23], v[156:159], a[32:35], a[20:23]
  s_waitcnt lgkmcnt(0)
  v_lshlrev_b32 v48, 16, v36
  v_and_b32 v49, 0xffff0000, v36
  v_mfma_f32_16x16x32_bf16 a[16:19], v[124:127], a[32:35], a[16:19]
  v_lshlrev_b32 v50, 16, v37
  v_and_b32 v51, 0xffff0000, v37
  v_mfma_f32_16x16x32_bf16 a[12:15], v[92:95], a[32:35], a[12:15]
  v_lshlrev_b32 v32, 16, v38
  v_and_b32 v33, 0xffff0000, v38
  v_mfma_f32_16x16x32_bf16 a[28:31], v[216:219], a[36:39], a[28:31]
  ds_read_b128 a[32:35], v4 offset:2240
  v_lshlrev_b32 v34, 16, v39
  v_and_b32 v35, 0xffff0000, v39
  v_mfma_f32_16x16x32_bf16 a[24:27], v[184:187], a[36:39], a[24:27]
  v_mul_f32 v52, v48, v31
  v_mul_f32 v53, v49, v31
  v_mfma_f32_16x16x32_bf16 a[20:23], v[152:155], a[36:39], a[20:23]
  v_mul_f32 v54, v50, v31
  v_mul_f32 v55, v51, v31
  v_mfma_f32_16x16x32_bf16 a[16:19], v[120:123], a[36:39], a[16:19]
  v_fmac_f32 v44, s61, v48
  v_fmac_f32 v45, s61, v49
  v_mfma_f32_16x16x32_bf16 a[12:15], v[88:91], a[36:39], a[12:15]
  v_fmac_f32 v46, s61, v50
  v_fmac_f32 v47, s61, v51
  v_mfma_f32_16x16x32_bf16 a[28:31], v[212:215], a[40:43], a[28:31]
  ds_read_b128 a[36:39], v4 offset:2176
  v_cvt_pk_bf16_f32 v36, v52, v53
  v_cvt_pk_bf16_f32 v37, v54, v55
  v_mfma_f32_16x16x32_bf16 a[24:27], v[180:183], a[40:43], a[24:27]
  v_lshlrev_b32 v52, 16, v36
  v_and_b32 v53, 0xffff0000, v36
  v_mfma_f32_16x16x32_bf16 a[20:23], v[148:151], a[40:43], a[20:23]
  v_lshlrev_b32 v54, 16, v37
  v_and_b32 v55, 0xffff0000, v37
  v_mfma_f32_16x16x32_bf16 a[16:19], v[116:119], a[40:43], a[16:19]
  v_cvt_pk_bf16_f32 v36, v44, v45
  v_cvt_pk_bf16_f32 v37, v46, v47
  v_mfma_f32_16x16x32_bf16 a[12:15], v[84:87], a[40:43], a[12:15]
  v_lshlrev_b32 v44, 16, v36
  v_and_b32 v45, 0xffff0000, v36
  v_mfma_f32_16x16x32_bf16 a[28:31], v[208:211], a[44:47], a[28:31]
  ds_read_b128 a[40:43], v4 offset:2112
  v_lshlrev_b32 v46, 16, v37
  v_and_b32 v47, 0xffff0000, v37
  v_mfma_f32_16x16x32_bf16 a[24:27], v[176:179], a[44:47], a[24:27]
  v_add_f32 v44, v44, v52
  v_add_f32 v45, v45, v53
  v_mfma_f32_16x16x32_bf16 a[20:23], v[144:147], a[44:47], a[20:23]
  v_add_f32 v46, v46, v54
  v_add_f32 v47, v47, v55
  v_mfma_f32_16x16x32_bf16 a[16:19], v[112:115], a[44:47], a[16:19]
  v_cvt_pk_bf16_f32 v36, v44, v45
  v_cvt_pk_bf16_f32 v37, v46, v47
  v_mfma_f32_16x16x32_bf16 a[12:15], v[80:83], a[44:47], a[12:15]
  v_lshlrev_b32 v44, 16, v36
  v_and_b32 v45, 0xffff0000, v36
  s_waitcnt lgkmcnt(2)
  v_mfma_f32_16x16x32_bf16 a[28:31], v[204:207], a[32:35], a[28:31]
  ds_read_b128 a[44:47], v4 offset:2048
  v_lshlrev_b32 v46, 16, v37
  v_and_b32 v47, 0xffff0000, v37
  v_mfma_f32_16x16x32_bf16 a[24:27], v[172:175], a[32:35], a[24:27]
  v_add_f32 v44, v44, v32
  v_add_f32 v45, v45, v33
  v_mfma_f32_16x16x32_bf16 a[20:23], v[140:143], a[32:35], a[20:23]
  v_add_f32 v46, v46, v34
  v_add_f32 v47, v47, v35
  v_mfma_f32_16x16x32_bf16 a[16:19], v[108:111], a[32:35], a[16:19]
  v_cvt_pk_bf16_f32 v36, v44, v45
  v_cvt_pk_bf16_f32 v37, v46, v47
  v_mfma_f32_16x16x32_bf16 a[12:15], v[76:79], a[32:35], a[12:15]
  s_add_u32 s6, s62, 524288
  buffer_store_dwordx2 v[36:37], v9, s[8:11], s6 offen sc1
  s_waitcnt lgkmcnt(2)
  v_mfma_f32_16x16x32_bf16 a[28:31], v[200:203], a[36:39], a[28:31]
  ds_read_b128 a[32:35], v4 offset:1984
  v_mfma_f32_16x16x32_bf16 a[24:27], v[168:171], a[36:39], a[24:27]
  v_mfma_f32_16x16x32_bf16 a[20:23], v[136:139], a[36:39], a[20:23]
  v_mfma_f32_16x16x32_bf16 a[16:19], v[104:107], a[36:39], a[16:19]
  v_mfma_f32_16x16x32_bf16 a[12:15], v[72:75], a[36:39], a[12:15]
  s_waitcnt lgkmcnt(2)
  v_mfma_f32_16x16x32_bf16 a[28:31], v[196:199], a[40:43], a[28:31]
  ds_read_b128 a[36:39], v4 offset:1920
  v_mfma_f32_16x16x32_bf16 a[24:27], v[164:167], a[40:43], a[24:27]
  v_mfma_f32_16x16x32_bf16 a[20:23], v[132:135], a[40:43], a[20:23]
  v_mfma_f32_16x16x32_bf16 a[16:19], v[100:103], a[40:43], a[16:19]
  v_mfma_f32_16x16x32_bf16 a[12:15], v[68:71], a[40:43], a[12:15]
  s_waitcnt lgkmcnt(2)
  v_mfma_f32_16x16x32_bf16 a[28:31], v[192:195], a[44:47], a[28:31]
  ds_read_b128 a[40:43], v4 offset:1856
  v_mfma_f32_16x16x32_bf16 a[24:27], v[160:163], a[44:47], a[24:27]
  v_mfma_f32_16x16x32_bf16 a[20:23], v[128:131], a[44:47], a[20:23]
  v_mfma_f32_16x16x32_bf16 a[16:19], v[96:99], a[44:47], a[16:19]
  v_mfma_f32_16x16x32_bf16 a[12:15], v[64:67], a[44:47], a[12:15]
  s_waitcnt lgkmcnt(2)
  v_mfma_f32_16x16x32_bf16 a[28:31], v[188:191], a[32:35], a[28:31]
  ds_read_b128 a[44:47], v4 offset:1792
  ds_read_b64 v[36:37], v7 offset:1536
  ds_read_b64 v[38:39], v8 offset:1536
  s_nop 2
  v_accvgpr_read_b32 v44, a12
  v_accvgpr_read_b32 v45, a13
  v_mfma_f32_16x16x32_bf16 a[24:27], v[156:159], a[32:35], a[24:27]
  v_accvgpr_read_b32 v46, a14
  v_accvgpr_read_b32 v47, a15
  v_mfma_f32_16x16x32_bf16 a[20:23], v[124:127], a[32:35], a[20:23]
  s_waitcnt lgkmcnt(0)
  v_lshlrev_b32 v48, 16, v36
  v_and_b32 v49, 0xffff0000, v36
  v_mfma_f32_16x16x32_bf16 a[16:19], v[92:95], a[32:35], a[16:19]
  v_lshlrev_b32 v50, 16, v37
  v_and_b32 v51, 0xffff0000, v37
  v_mfma_f32_16x16x32_bf16 a[28:31], v[184:187], a[36:39], a[28:31]
  ds_read_b128 a[32:35], v4 offset:1728
  v_lshlrev_b32 v32, 16, v38
  v_and_b32 v33, 0xffff0000, v38
  v_mfma_f32_16x16x32_bf16 a[24:27], v[152:155], a[36:39], a[24:27]
  v_lshlrev_b32 v34, 16, v39
  v_and_b32 v35, 0xffff0000, v39
  v_mfma_f32_16x16x32_bf16 a[20:23], v[120:123], a[36:39], a[20:23]
  v_mul_f32 v52, v48, v31
  v_mul_f32 v53, v49, v31
  v_mfma_f32_16x16x32_bf16 a[16:19], v[88:91], a[36:39], a[16:19]
  v_mul_f32 v54, v50, v31
  v_mul_f32 v55, v51, v31
  v_mfma_f32_16x16x32_bf16 a[28:31], v[180:183], a[40:43], a[28:31]
  ds_read_b128 a[36:39], v4 offset:1664
  v_fmac_f32 v44, s61, v48
  v_fmac_f32 v45, s61, v49
  v_mfma_f32_16x16x32_bf16 a[24:27], v[148:151], a[40:43], a[24:27]
  v_fmac_f32 v46, s61, v50
  v_fmac_f32 v47, s61, v51
  v_mfma_f32_16x16x32_bf16 a[20:23], v[116:119], a[40:43], a[20:23]
  v_cvt_pk_bf16_f32 v36, v52, v53
  v_cvt_pk_bf16_f32 v37, v54, v55
  v_mfma_f32_16x16x32_bf16 a[16:19], v[84:87], a[40:43], a[16:19]
  v_lshlrev_b32 v52, 16, v36
  v_and_b32 v53, 0xffff0000, v36
  v_mfma_f32_16x16x32_bf16 a[28:31], v[176:179], a[44:47], a[28:31]
  ds_read_b128 a[40:43], v4 offset:1600
  v_lshlrev_b32 v54, 16, v37
  v_and_b32 v55, 0xffff0000, v37
  v_mfma_f32_16x16x32_bf16 a[24:27], v[144:147], a[44:47], a[24:27]
  v_cvt_pk_bf16_f32 v36, v44, v45
  v_cvt_pk_bf16_f32 v37, v46, v47
  v_mfma_f32_16x16x32_bf16 a[20:23], v[112:115], a[44:47], a[20:23]
  v_lshlrev_b32 v44, 16, v36
  v_and_b32 v45, 0xffff0000, v36
  v_mfma_f32_16x16x32_bf16 a[16:19], v[80:83], a[44:47], a[16:19]
  v_lshlrev_b32 v46, 16, v37
  v_and_b32 v47, 0xffff0000, v37
  s_waitcnt lgkmcnt(2)
  v_mfma_f32_16x16x32_bf16 a[28:31], v[172:175], a[32:35], a[28:31]
  ds_read_b128 a[44:47], v4 offset:1536
  v_add_f32 v44, v44, v52
  v_add_f32 v45, v45, v53
  v_mfma_f32_16x16x32_bf16 a[24:27], v[140:143], a[32:35], a[24:27]
  v_add_f32 v46, v46, v54
  v_add_f32 v47, v47, v55
  v_mfma_f32_16x16x32_bf16 a[20:23], v[108:111], a[32:35], a[20:23]
  v_cvt_pk_bf16_f32 v36, v44, v45
  v_cvt_pk_bf16_f32 v37, v46, v47
  v_mfma_f32_16x16x32_bf16 a[16:19], v[76:79], a[32:35], a[16:19]
  v_lshlrev_b32 v44, 16, v36
  v_and_b32 v45, 0xffff0000, v36
  s_waitcnt lgkmcnt(2)
  v_mfma_f32_16x16x32_bf16 a[28:31], v[168:171], a[36:39], a[28:31]
  ds_read_b128 a[32:35], v4 offset:1472
  v_lshlrev_b32 v46, 16, v37
  v_and_b32 v47, 0xffff0000, v37
  v_mfma_f32_16x16x32_bf16 a[24:27], v[136:139], a[36:39], a[24:27]
  v_add_f32 v44, v44, v32
  v_add_f32 v45, v45, v33
  v_mfma_f32_16x16x32_bf16 a[20:23], v[104:107], a[36:39], a[20:23]
  v_add_f32 v46, v46, v34
  v_add_f32 v47, v47, v35
  v_mfma_f32_16x16x32_bf16 a[16:19], v[72:75], a[36:39], a[16:19]
  v_cvt_pk_bf16_f32 v36, v44, v45
  v_cvt_pk_bf16_f32 v37, v46, v47
  s_waitcnt lgkmcnt(2)
  v_mfma_f32_16x16x32_bf16 a[28:31], v[164:167], a[40:43], a[28:31]
  ds_read_b128 a[36:39], v4 offset:1408
  s_add_u32 s6, s62, 786432
  buffer_store_dwordx2 v[36:37], v9, s[8:11], s6 offen sc1
  v_mfma_f32_16x16x32_bf16 a[24:27], v[132:135], a[40:43], a[24:27]
  v_mfma_f32_16x16x32_bf16 a[20:23], v[100:103], a[40:43], a[20:23]
  v_mfma_f32_16x16x32_bf16 a[16:19], v[68:71], a[40:43], a[16:19]
  s_waitcnt lgkmcnt(2)
  v_mfma_f32_16x16x32_bf16 a[28:31], v[160:163], a[44:47], a[28:31]
  ds_read_b128 a[40:43], v4 offset:1344
  v_mfma_f32_16x16x32_bf16 a[24:27], v[128:131], a[44:47], a[24:27]
  v_mfma_f32_16x16x32_bf16 a[20:23], v[96:99], a[44:47], a[20:23]
  v_mfma_f32_16x16x32_bf16 a[16:19], v[64:67], a[44:47], a[16:19]
  s_waitcnt lgkmcnt(2)
  v_mfma_f32_16x16x32_bf16 a[28:31], v[156:159], a[32:35], a[28:31]
  ds_read_b128 a[44:47], v4 offset:1280
  ds_read_b64 v[36:37], v7 offset:2048
  ds_read_b64 v[38:39], v8 offset:2048
  s_nop 2
  v_accvgpr_read_b32 v44, a16
  v_accvgpr_read_b32 v45, a17
  v_mfma_f32_16x16x32_bf16 a[24:27], v[124:127], a[32:35], a[24:27]
  v_accvgpr_read_b32 v46, a18
  v_accvgpr_read_b32 v47, a19
  v_mfma_f32_16x16x32_bf16 a[20:23], v[92:95], a[32:35], a[20:23]
  s_waitcnt lgkmcnt(0)
  v_lshlrev_b32 v48, 16, v36
  v_and_b32 v49, 0xffff0000, v36
  v_mfma_f32_16x16x32_bf16 a[28:31], v[152:155], a[36:39], a[28:31]
  ds_read_b128 a[32:35], v4 offset:1216
  v_lshlrev_b32 v50, 16, v37
  v_and_b32 v51, 0xffff0000, v37
  v_mfma_f32_16x16x32_bf16 a[24:27], v[120:123], a[36:39], a[24:27]
  v_lshlrev_b32 v32, 16, v38
  v_and_b32 v33, 0xffff0000, v38
  v_mfma_f32_16x16x32_bf16 a[20:23], v[88:91], a[36:39], a[20:23]
  v_lshlrev_b32 v34, 16, v39
  v_and_b32 v35, 0xffff0000, v39
  v_mfma_f32_16x16x32_bf16 a[28:31], v[148:151], a[40:43], a[28:31]
  ds_read_b128 a[36:39], v4 offset:1152
  v_mul_f32 v52, v48, v31
  v_mul_f32 v53, v49, v31
  v_mfma_f32_16x16x32_bf16 a[24:27], v[116:119], a[40:43], a[24:27]
  v_mul_f32 v54, v50, v31
  v_mul_f32 v55, v51, v31
  v_mfma_f32_16x16x32_bf16 a[20:23], v[84:87], a[40:43], a[20:23]
  v_fmac_f32 v44, s61, v48
  v_fmac_f32 v45, s61, v49
  v_mfma_f32_16x16x32_bf16 a[28:31], v[144:147], a[44:47], a[28:31]
  ds_read_b128 a[40:43], v4 offset:1088
  v_fmac_f32 v46, s61, v50
  v_fmac_f32 v47, s61, v51
  v_mfma_f32_16x16x32_bf16 a[24:27], v[112:115], a[44:47], a[24:27]
  v_cvt_pk_bf16_f32 v36, v52, v53
  v_cvt_pk_bf16_f32 v37, v54, v55
  v_mfma_f32_16x16x32_bf16 a[20:23], v[80:83], a[44:47], a[20:23]
  v_lshlrev_b32 v52, 16, v36
  v_and_b32 v53, 0xffff0000, v36
  s_waitcnt lgkmcnt(2)
  v_mfma_f32_16x16x32_bf16 a[28:31], v[140:143], a[32:35], a[28:31]
  ds_read_b128 a[44:47], v4 offset:1024
  v_lshlrev_b32 v54, 16, v37
  v_and_b32 v55, 0xffff0000, v37
  v_mfma_f32_16x16x32_bf16 a[24:27], v[108:111], a[32:35], a[24:27]
  v_cvt_pk_bf16_f32 v36, v44, v45
  v_cvt_pk_bf16_f32 v37, v46, v47
  v_mfma_f32_16x16x32_bf16 a[20:23], v[76:79], a[32:35], a[20:23]
  v_lshlrev_b32 v44, 16, v36
  v_and_b32 v45, 0xffff0000, v36
  s_waitcnt lgkmcnt(2)
  v_mfma_f32_16x16x32_bf16 a[28:31], v[136:139], a[36:39], a[28:31]
  ds_read_b128 a[32:35], v4 offset:960
  v_lshlrev_b32 v46, 16, v37
  v_and_b32 v47, 0xffff0000, v37
  v_mfma_f32_16x16x32_bf16 a[24:27], v[104:107], a[36:39], a[24:27]
  v_add_f32 v44, v44, v52
  v_add_f32 v45, v45, v53
  v_mfma_f32_16x16x32_bf16 a[20:23], v[72:75], a[36:39], a[20:23]
  v_add_f32 v46, v46, v54
  v_add_f32 v47, v47, v55
  s_waitcnt lgkmcnt(2)
  v_mfma_f32_16x16x32_bf16 a[28:31], v[132:135], a[40:43], a[28:31]
  ds_read_b128 a[36:39], v4 offset:896
  v_cvt_pk_bf16_f32 v36, v44, v45
  v_cvt_pk_bf16_f32 v37, v46, v47
  v_mfma_f32_16x16x32_bf16 a[24:27], v[100:103], a[40:43], a[24:27]
  v_lshlrev_b32 v44, 16, v36
  v_and_b32 v45, 0xffff0000, v36
  v_mfma_f32_16x16x32_bf16 a[20:23], v[68:71], a[40:43], a[20:23]
  v_lshlrev_b32 v46, 16, v37
  v_and_b32 v47, 0xffff0000, v37
  s_waitcnt lgkmcnt(2)
  v_mfma_f32_16x16x32_bf16 a[28:31], v[128:131], a[44:47], a[28:31]
  ds_read_b128 a[40:43], v4 offset:832
  v_add_f32 v44, v44, v32
  v_add_f32 v45, v45, v33
  v_mfma_f32_16x16x32_bf16 a[24:27], v[96:99], a[44:47], a[24:27]
  v_add_f32 v46, v46, v34
  v_add_f32 v47, v47, v35
  v_mfma_f32_16x16x32_bf16 a[20:23], v[64:67], a[44:47], a[20:23]
  v_cvt_pk_bf16_f32 v36, v44, v45
  v_cvt_pk_bf16_f32 v37, v46, v47
  s_waitcnt lgkmcnt(2)
  v_mfma_f32_16x16x32_bf16 a[28:31], v[124:127], a[32:35], a[28:31]
  ds_read_b128 a[44:47], v4 offset:768
  s_add_u32 s6, s62, 1048576
  buffer_store_dwordx2 v[36:37], v9, s[8:11], s6 offen sc1
  v_mfma_f32_16x16x32_bf16 a[24:27], v[92:95], a[32:35], a[24:27]
  ds_read_b64 v[36:37], v7 offset:2560
  ds_read_b64 v[38:39], v8 offset:2560
  v_accvgpr_read_b32 v44, a20
  v_accvgpr_read_b32 v45, a21
  s_waitcnt lgkmcnt(4)
  v_mfma_f32_16x16x32_bf16 a[28:31], v[120:123], a[36:39], a[28:31]
  ds_read_b128 a[32:35], v4 offset:704
  v_accvgpr_read_b32 v46, a22
  v_accvgpr_read_b32 v47, a23
  v_mfma_f32_16x16x32_bf16 a[24:27], v[88:91], a[36:39], a[24:27]
  s_waitcnt lgkmcnt(1)
  v_lshlrev_b32 v48, 16, v36
  v_and_b32 v49, 0xffff0000, v36
  v_mfma_f32_16x16x32_bf16 a[28:31], v[116:119], a[40:43], a[28:31]
  ds_read_b128 a[36:39], v4 offset:640
  v_lshlrev_b32 v50, 16, v37
  v_and_b32 v51, 0xffff0000, v37
  v_mfma_f32_16x16x32_bf16 a[24:27], v[84:87], a[40:43], a[24:27]
  v_lshlrev_b32 v32, 16, v38
  v_and_b32 v33, 0xffff0000, v38
  v_mfma_f32_16x16x32_bf16 a[28:31], v[112:115], a[44:47], a[28:31]
  ds_read_b128 a[40:43], v4 offset:576
  v_lshlrev_b32 v34, 16, v39
  v_and_b32 v35, 0xffff0000, v39
  v_mfma_f32_16x16x32_bf16 a[24:27], v[80:83], a[44:47], a[24:27]
  v_mul_f32 v52, v48, v31
  v_mul_f32 v53, v49, v31
  s_waitcnt lgkmcnt(2)
  v_mfma_f32_16x16x32_bf16 a[28:31], v[108:111], a[32:35], a[28:31]
  ds_read_b128 a[44:47], v4 offset:512
  v_mul_f32 v54, v50, v31
  v_mul_f32 v55, v51, v31
  v_mfma_f32_16x16x32_bf16 a[24:27], v[76:79], a[32:35], a[24:27]
  v_fmac_f32 v44, s61, v48
  v_fmac_f32 v45, s61, v49
  s_waitcnt lgkmcnt(2)
  v_mfma_f32_16x16x32_bf16 a[28:31], v[104:107], a[36:39], a[28:31]
  ds_read_b128 a[32:35], v4 offset:448
  v_fmac_f32 v46, s61, v50
  v_fmac_f32 v47, s61, v51
  v_mfma_f32_16x16x32_bf16 a[24:27], v[72:75], a[36:39], a[24:27]
  v_cvt_pk_bf16_f32 v36, v52, v53
  v_cvt_pk_bf16_f32 v37, v54, v55
  s_waitcnt lgkmcnt(2)
  v_mfma_f32_16x16x32_bf16 a[28:31], v[100:103], a[40:43], a[28:31]
  ds_read_b128 a[36:39], v4 offset:384
  v_lshlrev_b32 v52, 16, v36
  v_and_b32 v53, 0xffff0000, v36
  v_mfma_f32_16x16x32_bf16 a[24:27], v[68:71], a[40:43], a[24:27]
  v_lshlrev_b32 v54, 16, v37
  v_and_b32 v55, 0xffff0000, v37
  s_waitcnt lgkmcnt(2)
  v_mfma_f32_16x16x32_bf16 a[28:31], v[96:99], a[44:47], a[28:31]
  ds_read_b128 a[40:43], v4 offset:320
  v_cvt_pk_bf16_f32 v36, v44, v45
  v_cvt_pk_bf16_f32 v37, v46, v47
  v_mfma_f32_16x16x32_bf16 a[24:27], v[64:67], a[44:47], a[24:27]
  v_lshlrev_b32 v44, 16, v36
  v_and_b32 v45, 0xffff0000, v36
  s_waitcnt lgkmcnt(2)
  v_mfma_f32_16x16x32_bf16 a[28:31], v[92:95], a[32:35], a[28:31]
  ds_read_b128 a[44:47], v4 offset:256
  v_lshlrev_b32 v46, 16, v37
  v_and_b32 v47, 0xffff0000, v37
  s_waitcnt lgkmcnt(2)
  v_mfma_f32_16x16x32_bf16 a[28:31], v[88:91], a[36:39], a[28:31]
  ds_read_b128 a[32:35], v4 offset:192
  v_add_f32 v44, v44, v52
  v_add_f32 v45, v45, v53
  s_waitcnt lgkmcnt(2)
  v_mfma_f32_16x16x32_bf16 a[28:31], v[84:87], a[40:43], a[28:31]
  ds_read_b128 a[36:39], v4 offset:128
  v_add_f32 v46, v46, v54
  v_add_f32 v47, v47, v55
  s_waitcnt lgkmcnt(2)
  v_mfma_f32_16x16x32_bf16 a[28:31], v[80:83], a[44:47], a[28:31]
  ds_read_b128 a[40:43], v4 offset:64
  v_cvt_pk_bf16_f32 v36, v44, v45
  v_cvt_pk_bf16_f32 v37, v46, v47
  s_waitcnt lgkmcnt(2)
  v_mfma_f32_16x16x32_bf16 a[28:31], v[76:79], a[32:35], a[28:31]
  ds_read_b128 a[44:47], v4 offset:0
  v_lshlrev_b32 v44, 16, v36
  v_and_b32 v45, 0xffff0000, v36
  s_waitcnt lgkmcnt(2)
  v_mfma_f32_16x16x32_bf16 a[28:31], v[72:75], a[36:39], a[28:31]
  v_lshlrev_b32 v46, 16, v37
  v_and_b32 v47, 0xffff0000, v37
  s_waitcnt lgkmcnt(1)
  v_mfma_f32_16x16x32_bf16 a[28:31], v[68:71], a[40:43], a[28:31]
  v_add_f32 v44, v44, v32
  v_add_f32 v45, v45, v33
  s_waitcnt lgkmcnt(0)
  v_mfma_f32_16x16x32_bf16 a[28:31], v[64:67], a[44:47], a[28:31]
  v_add_f32 v46, v46, v34
  v_add_f32 v47, v47, v35
  v_cvt_pk_bf16_f32 v36, v44, v45
  v_cvt_pk_bf16_f32 v37, v46, v47
  s_add_u32 s6, s62, 1310720
  buffer_store_dwordx2 v[36:37], v9, s[8:11], s6 offen sc1
  ds_read_b64 v[36:37], v7 offset:3072
  ds_read_b64 v[38:39], v8 offset:3072
  v_accvgpr_read_b32 v44, a24
  v_accvgpr_read_b32 v45, a25
  v_accvgpr_read_b32 v46, a26
  v_accvgpr_read_b32 v47, a27
  s_waitcnt lgkmcnt(0)
  v_lshlrev_b32 v48, 16, v36
  v_and_b32 v49, 0xffff0000, v36
  v_lshlrev_b32 v50, 16, v37
  v_and_b32 v51, 0xffff0000, v37
  v_lshlrev_b32 v32, 16, v38
  v_and_b32 v33, 0xffff0000, v38
  v_lshlrev_b32 v34, 16, v39
  v_and_b32 v35, 0xffff0000, v39
  v_mul_f32 v52, v48, v31
  v_mul_f32 v53, v49, v31
  v_mul_f32 v54, v50, v31
  v_mul_f32 v55, v51, v31
  v_fmac_f32 v44, s61, v48
  v_fmac_f32 v45, s61, v49
  v_fmac_f32 v46, s61, v50
  v_fmac_f32 v47, s61, v51
  v_cvt_pk_bf16_f32 v36, v52, v53
  v_cvt_pk_bf16_f32 v37, v54, v55
  v_lshlrev_b32 v52, 16, v36
  v_and_b32 v53, 0xffff0000, v36
  v_lshlrev_b32 v54, 16, v37
  v_and_b32 v55, 0xffff0000, v37
  v_cvt_pk_bf16_f32 v36, v44, v45
  v_cvt_pk_bf16_f32 v37, v46, v47
  v_lshlrev_b32 v44, 16, v36
  v_and_b32 v45, 0xffff0000, v36
  v_lshlrev_b32 v46, 16, v37
  v_and_b32 v47, 0xffff0000, v37
  v_add_f32 v44, v44, v52
  v_add_f32 v45, v45, v53
  v_add_f32 v46, v46, v54
  v_add_f32 v47, v47, v55
  v_cvt_pk_bf16_f32 v36, v44, v45
  v_cvt_pk_bf16_f32 v37, v46, v47
  v_lshlrev_b32 v44, 16, v36
  v_and_b32 v45, 0xffff0000, v36
  v_lshlrev_b32 v46, 16, v37
  v_and_b32 v47, 0xffff0000, v37
  v_add_f32 v44, v44, v32
  v_add_f32 v45, v45, v33
  v_add_f32 v46, v46, v34
  v_add_f32 v47, v47, v35
  v_cvt_pk_bf16_f32 v36, v44, v45
  v_cvt_pk_bf16_f32 v37, v46, v47
  s_add_u32 s6, s62, 1572864
  buffer_store_dwordx2 v[36:37], v9, s[8:11], s6 offen sc1
  ds_read_b64 v[36:37], v7 offset:3584
  ds_read_b64 v[38:39], v8 offset:3584
  v_accvgpr_read_b32 v44, a28
  v_accvgpr_read_b32 v45, a29
  v_accvgpr_read_b32 v46, a30
  v_accvgpr_read_b32 v47, a31
  s_waitcnt lgkmcnt(0)
  v_lshlrev_b32 v48, 16, v36
  v_and_b32 v49, 0xffff0000, v36
  v_lshlrev_b32 v50, 16, v37
  v_and_b32 v51, 0xffff0000, v37
  v_lshlrev_b32 v32, 16, v38
  v_and_b32 v33, 0xffff0000, v38
  v_lshlrev_b32 v34, 16, v39
  v_and_b32 v35, 0xffff0000, v39
  v_mul_f32 v52, v48, v31
  v_mul_f32 v53, v49, v31
  v_mul_f32 v54, v50, v31
  v_mul_f32 v55, v51, v31
  v_fmac_f32 v44, s61, v48
  v_fmac_f32 v45, s61, v49
  v_fmac_f32 v46, s61, v50
  v_fmac_f32 v47, s61, v51
  v_cvt_pk_bf16_f32 v36, v52, v53
  v_cvt_pk_bf16_f32 v37, v54, v55
  v_lshlrev_b32 v52, 16, v36
  v_and_b32 v53, 0xffff0000, v36
  v_lshlrev_b32 v54, 16, v37
  v_and_b32 v55, 0xffff0000, v37
  v_cvt_pk_bf16_f32 v36, v44, v45
  v_cvt_pk_bf16_f32 v37, v46, v47
  v_lshlrev_b32 v44, 16, v36
  v_and_b32 v45, 0xffff0000, v36
  v_lshlrev_b32 v46, 16, v37
  v_and_b32 v47, 0xffff0000, v37
  v_add_f32 v44, v44, v52
  v_add_f32 v45, v45, v53
  v_add_f32 v46, v46, v54
  v_add_f32 v47, v47, v55
  v_cvt_pk_bf16_f32 v36, v44, v45
  v_cvt_pk_bf16_f32 v37, v46, v47
  v_lshlrev_b32 v44, 16, v36
  v_and_b32 v45, 0xffff0000, v36
  v_lshlrev_b32 v46, 16, v37
  v_and_b32 v47, 0xffff0000, v37
  v_add_f32 v44, v44, v32
  v_add_f32 v45, v45, v33
  v_add_f32 v46, v46, v34
  v_add_f32 v47, v47, v35
  v_cvt_pk_bf16_f32 v36, v44, v45
  v_cvt_pk_bf16_f32 v37, v46, v47
  s_add_u32 s6, s62, 1835008
  buffer_store_dwordx2 v[36:37], v9, s[8:11], s6 offen sc1
  s_lshl_b32 s6, s60, 2
  s_add_u32 s6, s6, 0x710000
  v_mov_b32 v16, 127
  s_waitcnt vmcnt(0)
  s_mov_b64 exec, 1
  buffer_store_dword v16, v1, s[8:11], s6 offen sc1
  s_mov_b64 exec, -1
  s_barrier
  s_cmp_eq_u32 s4, 1
  s_cbranch_scc1 L_rec2
  s_cmp_eq_u32 s4, 6
  s_cbranch_scc1 L_o2
  s_branch L_p2
L_c:
  v_lshlrev_b32 v4, 2, v0
  v_lshlrev_b32 v0, 4, v0
  v_mov_b32 v1, 0
  v_mov_b32 v2, 150016
  s_lshl_b32 s6, s5, 8
  s_lshl_b32 s7, s3, 13
  s_add_u32 s6, s6, s7
  s_add_u32 s6, s6, 0x738000
  buffer_store_dword v1, v4, s[8:11], s6 offen sc1
  s_lshl_b32 s6, s5, 3
  s_add_u32 s6, s6, 0x710800
  s_mov_b64 exec, 3
  buffer_store_dword v1, v4, s[8:11], s6 offen sc1
  buffer_store_dword v1, v4, s[8:11], s6 offen offset:256 sc1
  s_mov_b64 exec, -1
  s_lshl_b32 s6, s5, 10
  s_lshl_b32 s7, s3, 15
  s_add_u32 s6, s6, s7
  s_add_u32 s6, s6, 0x8800000
  v_mov_b32 v8, 0
  v_mov_b32 v9, 0
  v_mov_b32 v10, 0
  v_mov_b32 v11, 0
  buffer_store_dwordx4 v[8:11], v0, s[8:11], s6 offen sc1
  s_add_u32 s6, s6, 0x20000
  buffer_store_dwordx4 v[8:11], v0, s[8:11], s6 offen sc1
  s_add_u32 s6, s6, 0x20000
  buffer_store_dwordx4 v[8:11], v0, s[8:11], s6 offen sc1
  s_add_u32 s6, s6, 0x20000
  buffer_store_dwordx4 v[8:11], v0, s[8:11], s6 offen sc1
  s_add_u32 s6, s6, 0x7a0000
  buffer_store_dwordx4 v[8:11], v0, s[8:11], s6 offen sc1
  s_add_u32 s6, s6, 0x20000
  buffer_store_dwordx4 v[8:11], v0, s[8:11], s6 offen sc1
  s_add_u32 s6, s6, 0x20000
  buffer_store_dwordx4 v[8:11], v0, s[8:11], s6 offen sc1
  s_add_u32 s6, s6, 0x20000
  buffer_store_dwordx4 v[8:11], v0, s[8:11], s6 offen sc1
  s_waitcnt vmcnt(0)
  s_barrier
  s_cmp_lg_u32 s3, 0
  s_cbranch_scc1 L_sd_115
  s_mov_b64 exec, 1
  s_and_b32 s6, s4, 3
  s_lshl_b32 s6, s6, 6
  v_mov_b32 v6, 16
  v_mov_b32 v7, 1
  buffer_atomic_add v7, v6, s[12:15], s6 offen sc1
  s_mov_b64 exec, -1
L_sd_115:
  v_bfe_u32 v5, v0, 5, 4
  v_mul_u32_u24 v5, 4128, v5
  v_and_b32 v6, 16, v0
  v_add3_u32 v5, v5, v6, v1
  v_add_u32 v5, 73728, v5
  ds_write_b128 v5, v[8:11]
  ds_write_b128 v2, v[8:11]
  ds_write_b128 v2, v[8:11] offset:16
  v_accvgpr_write_b32 a0, 0
  v_accvgpr_write_b32 a1, 0
  v_accvgpr_write_b32 a2, 0
  v_accvgpr_write_b32 a3, 0
  v_accvgpr_write_b32 a4, 0
  v_accvgpr_write_b32 a5, 0
  v_accvgpr_write_b32 a6, 0
  v_accvgpr_write_b32 a7, 0
  v_accvgpr_write_b32 a8, 0
  v_accvgpr_write_b32 a9, 0
  v_accvgpr_write_b32 a10, 0
  v_accvgpr_write_b32 a11, 0
  v_accvgpr_write_b32 a12, 0
  v_accvgpr_write_b32 a13, 0
  v_accvgpr_write_b32 a14, 0
  v_accvgpr_write_b32 a15, 0
  v_accvgpr_write_b32 a16, 0
  v_accvgpr_write_b32 a17, 0
  v_accvgpr_write_b32 a18, 0
  v_accvgpr_write_b32 a19, 0
  v_accvgpr_write_b32 a20, 0
  v_accvgpr_write_b32 a21, 0
  v_accvgpr_write_b32 a22, 0
  v_accvgpr_write_b32 a23, 0
  v_accvgpr_write_b32 a24, 0
  v_accvgpr_write_b32 a25, 0
  v_accvgpr_write_b32 a26, 0
  v_accvgpr_write_b32 a27, 0
  v_accvgpr_write_b32 a28, 0
  v_accvgpr_write_b32 a29, 0
  v_accvgpr_write_b32 a30, 0
  v_accvgpr_write_b32 a31, 0
  v_accvgpr_write_b32 a32, 0
  v_accvgpr_write_b32 a33, 0
  v_accvgpr_write_b32 a34, 0
  v_accvgpr_write_b32 a35, 0
  v_accvgpr_write_b32 a36, 0
  v_accvgpr_write_b32 a37, 0
  v_accvgpr_write_b32 a38, 0
  v_accvgpr_write_b32 a39, 0
  v_accvgpr_write_b32 a40, 0
  v_accvgpr_write_b32 a41, 0
  v_accvgpr_write_b32 a42, 0
  v_accvgpr_write_b32 a43, 0
  v_accvgpr_write_b32 a44, 0
  v_accvgpr_write_b32 a45, 0
  v_accvgpr_write_b32 a46, 0
  v_accvgpr_write_b32 a47, 0
  v_accvgpr_write_b32 a48, 0
  v_accvgpr_write_b32 a49, 0
  v_accvgpr_write_b32 a50, 0
  v_accvgpr_write_b32 a51, 0
  v_accvgpr_write_b32 a52, 0
  v_accvgpr_write_b32 a53, 0
  v_accvgpr_write_b32 a54, 0
  v_accvgpr_write_b32 a55, 0
  v_accvgpr_write_b32 a56, 0
  v_accvgpr_write_b32 a57, 0
  v_accvgpr_write_b32 a58, 0
  v_accvgpr_write_b32 a59, 0
  v_accvgpr_write_b32 a60, 0
  v_accvgpr_write_b32 a61, 0
  v_accvgpr_write_b32 a62, 0
  v_accvgpr_write_b32 a63, 0
  v_accvgpr_write_b32 a64, 0
  v_accvgpr_write_b32 a65, 0
  v_accvgpr_write_b32 a66, 0
  v_accvgpr_write_b32 a67, 0
  v_accvgpr_write_b32 a68, 0
  v_accvgpr_write_b32 a69, 0
  v_accvgpr_write_b32 a70, 0
  v_accvgpr_write_b32 a71, 0
  v_accvgpr_write_b32 a72, 0
  v_accvgpr_write_b32 a73, 0
  v_accvgpr_write_b32 a74, 0
  v_accvgpr_write_b32 a75, 0
  v_accvgpr_write_b32 a76, 0
  v_accvgpr_write_b32 a77, 0
  v_accvgpr_write_b32 a78, 0
  v_accvgpr_write_b32 a79, 0
  v_accvgpr_write_b32 a80, 0
  v_accvgpr_write_b32 a81, 0
  v_accvgpr_write_b32 a82, 0
  v_accvgpr_write_b32 a83, 0
  v_accvgpr_write_b32 a84, 0
  v_accvgpr_write_b32 a85, 0
  v_accvgpr_write_b32 a86, 0
  v_accvgpr_write_b32 a87, 0
  v_accvgpr_write_b32 a88, 0
  v_accvgpr_write_b32 a89, 0
  v_accvgpr_write_b32 a90, 0
  v_accvgpr_write_b32 a91, 0
  v_accvgpr_write_b32 a92, 0
  v_accvgpr_write_b32 a93, 0
  v_accvgpr_write_b32 a94, 0
  v_accvgpr_write_b32 a95, 0
  v_accvgpr_write_b32 a96, 0
  v_accvgpr_write_b32 a97, 0
  v_accvgpr_write_b32 a98, 0
  v_accvgpr_write_b32 a99, 0
  v_accvgpr_write_b32 a100, 0
  v_accvgpr_write_b32 a101, 0
  v_accvgpr_write_b32 a102, 0
  v_accvgpr_write_b32 a103, 0
  v_accvgpr_write_b32 a104, 0
  v_accvgpr_write_b32 a105, 0
  v_accvgpr_write_b32 a106, 0
  v_accvgpr_write_b32 a107, 0
  v_accvgpr_write_b32 a108, 0
  v_accvgpr_write_b32 a109, 0
  v_accvgpr_write_b32 a110, 0
  v_accvgpr_write_b32 a111, 0
  v_accvgpr_write_b32 a112, 0
  v_accvgpr_write_b32 a113, 0
  v_accvgpr_write_b32 a114, 0
  v_accvgpr_write_b32 a115, 0
  v_accvgpr_write_b32 a116, 0
  v_accvgpr_write_b32 a117, 0
  v_accvgpr_write_b32 a118, 0
  v_accvgpr_write_b32 a119, 0
  v_accvgpr_write_b32 a120, 0
  v_accvgpr_write_b32 a121, 0
  v_accvgpr_write_b32 a122, 0
  v_accvgpr_write_b32 a123, 0
  v_accvgpr_write_b32 a124, 0
  v_accvgpr_write_b32 a125, 0
  v_accvgpr_write_b32 a126, 0
  v_accvgpr_write_b32 a127, 0
  v_accvgpr_write_b32 a128, 0
  v_accvgpr_write_b32 a129, 0
  v_accvgpr_write_b32 a130, 0
  v_accvgpr_write_b32 a131, 0
  v_accvgpr_write_b32 a132, 0
  v_accvgpr_write_b32 a133, 0
  v_accvgpr_write_b32 a134, 0
  v_accvgpr_write_b32 a135, 0
  v_accvgpr_write_b32 a136, 0
  v_accvgpr_write_b32 a137, 0
  v_accvgpr_write_b32 a138, 0
  v_accvgpr_write_b32 a139, 0
  v_accvgpr_write_b32 a140, 0
  v_accvgpr_write_b32 a141, 0
  v_accvgpr_write_b32 a142, 0
  v_accvgpr_write_b32 a143, 0
  v_accvgpr_write_b32 a144, 0
  v_accvgpr_write_b32 a145, 0
  v_accvgpr_write_b32 a146, 0
  v_accvgpr_write_b32 a147, 0
  v_accvgpr_write_b32 a148, 0
  v_accvgpr_write_b32 a149, 0
  v_accvgpr_write_b32 a150, 0
  v_accvgpr_write_b32 a151, 0
  v_accvgpr_write_b32 a152, 0
  v_accvgpr_write_b32 a153, 0
  v_accvgpr_write_b32 a154, 0
  v_accvgpr_write_b32 a155, 0
  v_accvgpr_write_b32 a156, 0
  v_accvgpr_write_b32 a157, 0
  v_accvgpr_write_b32 a158, 0
  v_accvgpr_write_b32 a159, 0
  v_accvgpr_write_b32 a160, 0
  v_accvgpr_write_b32 a161, 0
  v_accvgpr_write_b32 a162, 0
  v_accvgpr_write_b32 a163, 0
  v_accvgpr_write_b32 a164, 0
  v_accvgpr_write_b32 a165, 0
  v_accvgpr_write_b32 a166, 0
  v_accvgpr_write_b32 a167, 0
  v_accvgpr_write_b32 a168, 0
  v_accvgpr_write_b32 a169, 0
  v_accvgpr_write_b32 a170, 0
  v_accvgpr_write_b32 a171, 0
  v_accvgpr_write_b32 a172, 0
  v_accvgpr_write_b32 a173, 0
  v_accvgpr_write_b32 a174, 0
  v_accvgpr_write_b32 a175, 0
  v_accvgpr_write_b32 a176, 0
  v_accvgpr_write_b32 a177, 0
  v_accvgpr_write_b32 a178, 0
  v_accvgpr_write_b32 a179, 0
  v_accvgpr_write_b32 a180, 0
  v_accvgpr_write_b32 a181, 0
  v_accvgpr_write_b32 a182, 0
  v_accvgpr_write_b32 a183, 0
  v_accvgpr_write_b32 a184, 0
  v_accvgpr_write_b32 a185, 0
  v_accvgpr_write_b32 a186, 0
  v_accvgpr_write_b32 a187, 0
  v_accvgpr_write_b32 a188, 0
  v_accvgpr_write_b32 a189, 0
  v_accvgpr_write_b32 a190, 0
  v_accvgpr_write_b32 a191, 0
  v_accvgpr_write_b32 a192, 0
  v_accvgpr_write_b32 a193, 0
  v_accvgpr_write_b32 a194, 0
  v_accvgpr_write_b32 a195, 0
  v_accvgpr_write_b32 a196, 0
  v_accvgpr_write_b32 a197, 0
  v_accvgpr_write_b32 a198, 0
  v_accvgpr_write_b32 a199, 0
  v_accvgpr_write_b32 a200, 0
  v_accvgpr_write_b32 a201, 0
  v_accvgpr_write_b32 a202, 0
  v_accvgpr_write_b32 a203, 0
  v_accvgpr_write_b32 a204, 0
  v_accvgpr_write_b32 a205, 0
  v_accvgpr_write_b32 a206, 0
  v_accvgpr_write_b32 a207, 0
  v_accvgpr_write_b32 a208, 0
  v_accvgpr_write_b32 a209, 0
  v_accvgpr_write_b32 a210, 0
  v_accvgpr_write_b32 a211, 0
  v_accvgpr_write_b32 a212, 0
  v_accvgpr_write_b32 a213, 0
  v_accvgpr_write_b32 a214, 0
  v_accvgpr_write_b32 a215, 0
  v_accvgpr_write_b32 a216, 0
  v_accvgpr_write_b32 a217, 0
  v_accvgpr_write_b32 a218, 0
  v_accvgpr_write_b32 a219, 0
  v_accvgpr_write_b32 a220, 0
  v_accvgpr_write_b32 a221, 0
  v_accvgpr_write_b32 a222, 0
  v_accvgpr_write_b32 a223, 0
  v_accvgpr_write_b32 a224, 0
  v_accvgpr_write_b32 a225, 0
  v_accvgpr_write_b32 a226, 0
  v_accvgpr_write_b32 a227, 0
  v_accvgpr_write_b32 a228, 0
  v_accvgpr_write_b32 a229, 0
  v_accvgpr_write_b32 a230, 0
  v_accvgpr_write_b32 a231, 0
  v_accvgpr_write_b32 a232, 0
  v_accvgpr_write_b32 a233, 0
  v_accvgpr_write_b32 a234, 0
  v_accvgpr_write_b32 a235, 0
  v_accvgpr_write_b32 a236, 0
  v_accvgpr_write_b32 a237, 0
  v_accvgpr_write_b32 a238, 0
  v_accvgpr_write_b32 a239, 0
  v_accvgpr_write_b32 a240, 0
  v_accvgpr_write_b32 a241, 0
  v_accvgpr_write_b32 a242, 0
  v_accvgpr_write_b32 a243, 0
  v_accvgpr_write_b32 a244, 0
  v_accvgpr_write_b32 a245, 0
  v_accvgpr_write_b32 a246, 0
  v_accvgpr_write_b32 a247, 0
  v_accvgpr_write_b32 a248, 0
  v_accvgpr_write_b32 a249, 0
  v_accvgpr_write_b32 a250, 0
  v_accvgpr_write_b32 a251, 0
  v_accvgpr_write_b32 a252, 0
  v_accvgpr_write_b32 a253, 0
  v_accvgpr_write_b32 a254, 0
  v_accvgpr_write_b32 a255, 0
  s_cmp_lg_u32 s3, 0
  s_cbranch_scc1 L_wdo_117
  s_mov_b32 s7, 0
  v_mbcnt_lo_u32_b32 v8, -1, 0
  v_and_b32 v8, 3, v8
  v_lshlrev_b32 v8, 6, v8
L_wd_116:
  buffer_load_dword v9, v8, s[12:15], 0 offen offset:16 sc1
  s_waitcnt vmcnt(0)
  v_cmp_ne_u32 vcc, 64, v9
  s_cbranch_vccz L_wdo_117
  s_add_u32 s7, s7, 1
  s_cmp_lt_u32 s7, 131072
  s_cbranch_scc1 L_wd_116
  s_mov_b32 s6, 40
  s_branch L_err
L_wdo_117:
  s_barrier
  v_and_b32 v4, 60, v4
  s_lshl_b32 s6, s5, 6
  s_add_u32 s34, s6, 0x710000
  s_mov_b32 s33, 127
  s_mov_b32 s7, 0
L_pl_118:
  buffer_load_dword v8, v4, s[8:11], s34 offen offset:0 sc1
  s_waitcnt vmcnt(0)
  v_cmp_gt_u32 vcc, s33, v8
  s_cbranch_vccz L_plo_119
  s_add_u32 s7, s7, 1
  s_cmp_lt_u32 s7, 131072
  s_cbranch_scc1 L_pl_118
  s_mov_b32 s6, 41
  s_branch L_err
L_plo_119:
  s_mul_i32 s34, s5, 73728
  s_mul_i32 s35, s3, 18432
  s_add_u32 s34, s34, s35
  s_add_u32 s34, s34, 0x400000
  s_add_u32 m0, s35, 0
  s_add_u32 s6, s34, 0
  buffer_load_dwordx4 v0, s[8:11], s6 offen offset:0 lds
  buffer_load_dwordx4 v0, s[8:11], s6 offen offset:1024 lds
  buffer_load_dwordx4 v0, s[8:11], s6 offen offset:2048 lds
  buffer_load_dwordx4 v0, s[8:11], s6 offen offset:3072 lds
  s_add_u32 m0, s35, 4096
  s_add_u32 s6, s34, 4096
  buffer_load_dwordx4 v0, s[8:11], s6 offen offset:0 lds
  buffer_load_dwordx4 v0, s[8:11], s6 offen offset:1024 lds
  buffer_load_dwordx4 v0, s[8:11], s6 offen offset:2048 lds
  buffer_load_dwordx4 v0, s[8:11], s6 offen offset:3072 lds
  s_add_u32 m0, s35, 8192
  s_add_u32 s6, s34, 8192
  buffer_load_dwordx4 v0, s[8:11], s6 offen offset:0 lds
  buffer_load_dwordx4 v0, s[8:11], s6 offen offset:1024 lds
  buffer_load_dwordx4 v0, s[8:11], s6 offen offset:2048 lds
  buffer_load_dwordx4 v0, s[8:11], s6 offen offset:3072 lds
  s_add_u32 m0, s35, 12288
  s_add_u32 s6, s34, 12288
  buffer_load_dwordx4 v0, s[8:11], s6 offen offset:0 lds
  buffer_load_dwordx4 v0, s[8:11], s6 offen offset:1024 lds
  buffer_load_dwordx4 v0, s[8:11], s6 offen offset:2048 lds
  buffer_load_dwordx4 v0, s[8:11], s6 offen offset:3072 lds
  s_add_u32 m0, s35, 16384
  s_add_u32 s6, s34, 16384
  buffer_load_dwordx4 v0, s[8:11], s6 offen offset:0 lds
  buffer_load_dwordx4 v0, s[8:11], s6 offen offset:1024 lds
  s_mov_b32 s32, 0
  s_waitcnt vmcnt(0) lgkmcnt(0)
  s_barrier
  s_cmp_ge_u32 s3, 2
  s_cbranch_scc1 L_c_res
  s_mov_b32 s16, s76
  s_mov_b32 s17, s77
  s_mov_b32 s18, 0x400
  s_mov_b32 s19, 0x20000
  v_bfe_u32 v16, v0, 4, 4
  v_lshrrev_b32 v17, 8, v0
  v_lshrrev_b32 v18, 7, v0
  s_lshl_b32 s6, s5, 5
  s_lshl_b32 s7, s3, 4
  s_add_u32 s6, s6, s7
  v_lshlrev_b32 v19, 1, v18
  buffer_load_ushort v12, v19, s[16:19], s6 offen
  s_mul_i32 s6, s3, 36864
  v_mul_u32_u24 v19, 4608, v18
  v_add_u32 v19, s6, v19
  ds_read_b32 v11, v19 offset:4576
  s_add_u32 s6, s6, 480
  v_lshlrev_b32 v19, 5, v16
  v_sub_u32 v19, s6, v19
  v_lshl_add_u32 v4, v17, 4, v19
  s_mul_i32 s6, s3, 33024
  s_add_u32 s6, s6, 73728
  v_lshlrev_b32 v19, 1, v16
  v_lshl_add_u32 v19, v17, 4, v19
  v_add_u32 v5, s6, v19
  v_mul_u32_u24 v19, 4128, v18
  v_bfe_u32 v20, v0, 1, 6
  v_add3_u32 v19, v19, v20, s6
  v_add_u32 v8, 32, v19
  s_lshl_b32 s6, s3, 10
  s_add_u32 s6, s6, 147968
  v_add_u32 v7, s6, v0
  v_and_b32 v19, 1, v16
  v_lshlrev_b32 v19, 6, v19
  v_lshl_add_u32 v19, v17, 4, v19
  v_add_u32 v6, s6, v19
  v_lshrrev_b32 v10, 1, v0
  s_lshl_b32 s6, s3, 9
  s_add_u32 s35, s6, 139776
  s_lshl_b32 s7, s5, 10
  s_add_u32 s6, s6, s7
  s_add_u32 s40, s6, 0x200000
  s_lshl_b32 s6, s5, 3
  s_lshl_b32 s7, s3, 2
  s_add_u32 s6, s6, s7
  s_add_u32 s39, s6, 0x710800
  v_add_u32 v14, s7, v2
  s_waitcnt vmcnt(0) lgkmcnt(0)
  v_lshlrev_b32 v12, 16, v12
  v_and_b32 v15, 2, v5
  v_and_b32 v5, -4, v5
  v_add_u32 v104, 0, v5
  v_add_u32 v105, 4128, v5
  v_add_u32 v106, 8256, v5
  v_add_u32 v107, 12384, v5
  v_add_u32 v108, 16512, v5
  v_add_u32 v109, 20640, v5
  v_add_u32 v110, 24768, v5
  v_add_u32 v111, 28896, v5
L_c_conv0:
  s_add_u32 s33, s32, 1
  s_and_b32 s6, s32, 7
  s_lshl_b32 s7, s6, 10
  s_add_u32 s7, s7, s35
  v_add_u32 v9, s7, v10
  s_lshl_b32 s6, s6, 1
  s_lshl_b32 s42, 0x30003, s6
  v_mov_b32 v13, s33
  ds_read_b128 v[48:51], v4 offset:3584
  ds_read_b128 v[52:55], v4 offset:8192
  ds_read_b128 v[56:59], v4 offset:12800
  ds_read_b128 v[60:63], v4 offset:17408
  ds_read_b128 v[64:67], v4 offset:22016
  ds_read_b128 v[68:71], v4 offset:26624
  ds_read_b128 v[72:75], v4 offset:31232
  ds_read_b128 v[76:79], v4 offset:35840
  s_mov_b32 s7, 0
L_lw_120:
  ds_read_b32 v88, v2 offset:0
  s_waitcnt lgkmcnt(0)
  v_cmp_gt_i32 vcc, s33, v88
  s_cbranch_vccz L_lwo_121
  s_add_u32 s7, s7, 1
  s_cmp_lt_u32 s7, 131072
  s_cbranch_scc1 L_lw_120
  s_mov_b32 s6, 42
  s_branch L_err
L_lwo_121:
  ds_read2_b32 v[112:113], v104 offset0:0 offset1:1
  ds_read2_b32 v[114:115], v104 offset0:2 offset1:3
  ds_read_b32 v116, v104 offset:16
  ds_read2_b32 v[118:119], v105 offset0:0 offset1:1
  ds_read2_b32 v[120:121], v105 offset0:2 offset1:3
  ds_read_b32 v122, v105 offset:16
  ds_read2_b32 v[124:125], v106 offset0:0 offset1:1
  ds_read2_b32 v[126:127], v106 offset0:2 offset1:3
  ds_read_b32 v128, v106 offset:16
  ds_read2_b32 v[130:131], v107 offset0:0 offset1:1
  ds_read2_b32 v[132:133], v107 offset0:2 offset1:3
  ds_read_b32 v134, v107 offset:16
  s_waitcnt lgkmcnt(9)
  v_alignbyte_b32 v16, v113, v112, v15
  v_alignbyte_b32 v17, v114, v113, v15
  v_alignbyte_b32 v18, v115, v114, v15
  v_alignbyte_b32 v19, v116, v115, v15
  ds_read2_b32 v[112:113], v108 offset0:0 offset1:1
  ds_read2_b32 v[114:115], v108 offset0:2 offset1:3
  ds_read_b32 v116, v108 offset:16
  s_waitcnt lgkmcnt(9)
  v_alignbyte_b32 v20, v119, v118, v15
  v_alignbyte_b32 v21, v120, v119, v15
  v_alignbyte_b32 v22, v121, v120, v15
  v_alignbyte_b32 v23, v122, v121, v15
  ds_read2_b32 v[118:119], v109 offset0:0 offset1:1
  ds_read2_b32 v[120:121], v109 offset0:2 offset1:3
  ds_read_b32 v122, v109 offset:16
  v_mfma_f32_16x16x32_bf16 a[0:3], v[16:19], v[48:51], a[0:3]
  s_waitcnt lgkmcnt(9)
  v_alignbyte_b32 v24, v125, v124, v15
  v_alignbyte_b32 v25, v126, v125, v15
  v_alignbyte_b32 v26, v127, v126, v15
  v_alignbyte_b32 v27, v128, v127, v15
  ds_read2_b32 v[124:125], v110 offset0:0 offset1:1
  ds_read2_b32 v[126:127], v110 offset0:2 offset1:3
  ds_read_b32 v128, v110 offset:16
  v_mfma_f32_16x16x32_bf16 a[32:35], v[20:23], v[52:55], a[32:35]
  s_waitcnt lgkmcnt(9)
  v_alignbyte_b32 v28, v131, v130, v15
  v_alignbyte_b32 v29, v132, v131, v15
  v_alignbyte_b32 v30, v133, v132, v15
  v_alignbyte_b32 v31, v134, v133, v15
  ds_read2_b32 v[130:131], v111 offset0:0 offset1:1
  ds_read2_b32 v[132:133], v111 offset0:2 offset1:3
  ds_read_b32 v134, v111 offset:16
  v_mfma_f32_16x16x32_bf16 a[64:67], v[24:27], v[56:59], a[64:67]
  s_waitcnt lgkmcnt(9)
  v_alignbyte_b32 v32, v113, v112, v15
  v_alignbyte_b32 v33, v114, v113, v15
  v_alignbyte_b32 v34, v115, v114, v15
  v_alignbyte_b32 v35, v116, v115, v15
  ds_read_b64 v[84:85], v8
  ds_read_b64 v[86:87], v9
  v_mfma_f32_16x16x32_bf16 a[96:99], v[28:31], v[60:63], a[96:99]
  s_waitcnt lgkmcnt(8)
  v_alignbyte_b32 v36, v119, v118, v15
  v_alignbyte_b32 v37, v120, v119, v15
  v_alignbyte_b32 v38, v121, v120, v15
  v_alignbyte_b32 v39, v122, v121, v15
  v_mfma_f32_16x16x32_bf16 a[128:131], v[32:35], v[64:67], a[128:131]
  s_waitcnt lgkmcnt(5)
  v_alignbyte_b32 v40, v125, v124, v15
  v_alignbyte_b32 v41, v126, v125, v15
  v_alignbyte_b32 v42, v127, v126, v15
  v_alignbyte_b32 v43, v128, v127, v15
  v_mfma_f32_16x16x32_bf16 a[160:163], v[36:39], v[68:71], a[160:163]
  s_waitcnt lgkmcnt(2)
  v_alignbyte_b32 v44, v131, v130, v15
  v_alignbyte_b32 v45, v132, v131, v15
  v_alignbyte_b32 v46, v133, v132, v15
  v_alignbyte_b32 v47, v134, v133, v15
  v_mfma_f32_16x16x32_bf16 a[192:195], v[40:43], v[72:75], a[192:195]
  s_nop 0
  v_mfma_f32_16x16x32_bf16 a[224:227], v[44:47], v[76:79], a[224:227]
  s_waitcnt lgkmcnt(0)
  ds_read_b128 v[48:51], v4 offset:3072
  ds_read_b128 v[52:55], v4 offset:7680
  ds_read_b128 v[56:59], v4 offset:12288
  ds_read_b128 v[60:63], v4 offset:16896
  ds_read_b128 v[64:67], v4 offset:21504
  ds_read_b128 v[68:71], v4 offset:26112
  ds_read_b128 v[72:75], v4 offset:30720
  ds_read_b128 v[76:79], v4 offset:35328
  s_mov_b32 exec_lo, s42
  s_mov_b32 exec_hi, s42
  ds_write_b128 v6, a[0:3] offset:0
  ds_write_b128 v6, a[32:35] offset:128
  ds_write_b128 v6, a[64:67] offset:256
  ds_write_b128 v6, a[96:99] offset:384
  ds_write_b128 v6, a[128:131] offset:512
  ds_write_b128 v6, a[160:163] offset:640
  ds_write_b128 v6, a[192:195] offset:768
  ds_write_b128 v6, a[224:227] offset:896
  s_mov_b64 exec, -1
  ds_read_b128 v[80:83], v7
  ds_write_b32 v14, v13 offset:8
  v_lshlrev_b32 v88, 16, v84
  v_and_b32 v89, 0xffff0000, v84
  v_lshlrev_b32 v90, 16, v85
  v_and_b32 v91, 0xffff0000, v85
  v_lshlrev_b32 v96, 16, v86
  v_and_b32 v97, 0xffff0000, v86
  v_lshlrev_b32 v98, 16, v87
  v_and_b32 v99, 0xffff0000, v87
  v_mul_f32 v92, v88, v12
  v_mul_f32 v93, v89, v12
  v_mul_f32 v94, v90, v12
  v_mul_f32 v95, v91, v12
  v_cvt_pk_bf16_f32 v84, v92, v93
  v_cvt_pk_bf16_f32 v85, v94, v95
  v_lshlrev_b32 v92, 16, v84
  v_and_b32 v93, 0xffff0000, v84
  v_lshlrev_b32 v94, 16, v85
  v_and_b32 v95, 0xffff0000, v85
  s_waitcnt lgkmcnt(1)
  v_fmac_f32 v80, v88, v11
  v_fmac_f32 v81, v89, v11
  v_fmac_f32 v82, v90, v11
  v_fmac_f32 v83, v91, v11
  v_cvt_pk_bf16_f32 v84, v80, v81
  v_cvt_pk_bf16_f32 v85, v82, v83
  v_lshlrev_b32 v80, 16, v84
  v_and_b32 v81, 0xffff0000, v84
  v_lshlrev_b32 v82, 16, v85
  v_and_b32 v83, 0xffff0000, v85
  v_add_f32 v80, v80, v92
  v_add_f32 v81, v81, v93
  v_add_f32 v82, v82, v94
  v_add_f32 v83, v83, v95
  v_cvt_pk_bf16_f32 v84, v80, v81
  v_cvt_pk_bf16_f32 v85, v82, v83
  v_lshlrev_b32 v80, 16, v84
  v_and_b32 v81, 0xffff0000, v84
  v_lshlrev_b32 v82, 16, v85
  v_and_b32 v83, 0xffff0000, v85
  v_add_f32 v80, v80, v96
  v_add_f32 v81, v81, v97
  v_add_f32 v82, v82, v98
  v_add_f32 v83, v83, v99
  v_cvt_pk_bf16_f32 v84, v80, v81
  v_cvt_pk_bf16_f32 v85, v82, v83
  buffer_store_dwordx2 v[84:85], v10, s[8:11], s40 offen sc1
  v_mfma_f32_16x16x32_bf16 a[4:7], v[16:19], v[48:51], a[4:7]
  ds_read_b128 v[48:51], v4 offset:2560
  v_mfma_f32_16x16x32_bf16 a[36:39], v[20:23], v[52:55], a[36:39]
  ds_read_b128 v[52:55], v4 offset:7168
  v_mfma_f32_16x16x32_bf16 a[68:71], v[24:27], v[56:59], a[68:71]
  ds_read_b128 v[56:59], v4 offset:11776
  v_mfma_f32_16x16x32_bf16 a[100:103], v[28:31], v[60:63], a[100:103]
  ds_read_b128 v[60:63], v4 offset:16384
  v_mfma_f32_16x16x32_bf16 a[132:135], v[32:35], v[64:67], a[132:135]
  ds_read_b128 v[64:67], v4 offset:20992
  v_mfma_f32_16x16x32_bf16 a[164:167], v[36:39], v[68:71], a[164:167]
  ds_read_b128 v[68:71], v4 offset:25600
  v_mfma_f32_16x16x32_bf16 a[196:199], v[40:43], v[72:75], a[196:199]
  ds_read_b128 v[72:75], v4 offset:30208
  v_mfma_f32_16x16x32_bf16 a[228:231], v[44:47], v[76:79], a[228:231]
  ds_read_b128 v[76:79], v4 offset:34816
  s_waitcnt lgkmcnt(7)
  v_mfma_f32_16x16x32_bf16 a[8:11], v[16:19], v[48:51], a[8:11]
  ds_read_b128 v[48:51], v4 offset:2048
  s_waitcnt lgkmcnt(7)
  v_mfma_f32_16x16x32_bf16 a[40:43], v[20:23], v[52:55], a[40:43]
  ds_read_b128 v[52:55], v4 offset:6656
  s_waitcnt lgkmcnt(7)
  v_mfma_f32_16x16x32_bf16 a[72:75], v[24:27], v[56:59], a[72:75]
  ds_read_b128 v[56:59], v4 offset:11264
  s_waitcnt lgkmcnt(7)
  v_mfma_f32_16x16x32_bf16 a[104:107], v[28:31], v[60:63], a[104:107]
  ds_read_b128 v[60:63], v4 offset:15872
  s_waitcnt lgkmcnt(7)
  v_mfma_f32_16x16x32_bf16 a[136:139], v[32:35], v[64:67], a[136:139]
  ds_read_b128 v[64:67], v4 offset:20480
  s_waitcnt lgkmcnt(7)
  v_mfma_f32_16x16x32_bf16 a[168:171], v[36:39], v[68:71], a[168:171]
  ds_read_b128 v[68:71], v4 offset:25088
  s_waitcnt lgkmcnt(7)
  v_mfma_f32_16x16x32_bf16 a[200:203], v[40:43], v[72:75], a[200:203]
  ds_read_b128 v[72:75], v4 offset:29696
  s_waitcnt lgkmcnt(7)
  v_mfma_f32_16x16x32_bf16 a[232:235], v[44:47], v[76:79], a[232:235]
  ds_read_b128 v[76:79], v4 offset:34304
  s_waitcnt lgkmcnt(7)
  v_mfma_f32_16x16x32_bf16 a[12:15], v[16:19], v[48:51], a[12:15]
  ds_read_b128 v[48:51], v4 offset:1536
  s_waitcnt lgkmcnt(7)
  v_mfma_f32_16x16x32_bf16 a[44:47], v[20:23], v[52:55], a[44:47]
  ds_read_b128 v[52:55], v4 offset:6144
  s_waitcnt lgkmcnt(7)
  v_mfma_f32_16x16x32_bf16 a[76:79], v[24:27], v[56:59], a[76:79]
  ds_read_b128 v[56:59], v4 offset:10752
  s_waitcnt lgkmcnt(7)
  v_mfma_f32_16x16x32_bf16 a[108:111], v[28:31], v[60:63], a[108:111]
  ds_read_b128 v[60:63], v4 offset:15360
  s_waitcnt lgkmcnt(7)
  v_mfma_f32_16x16x32_bf16 a[140:143], v[32:35], v[64:67], a[140:143]
  ds_read_b128 v[64:67], v4 offset:19968
  s_waitcnt lgkmcnt(7)
  v_mfma_f32_16x16x32_bf16 a[172:175], v[36:39], v[68:71], a[172:175]
  ds_read_b128 v[68:71], v4 offset:24576
  s_waitcnt lgkmcnt(7)
  v_mfma_f32_16x16x32_bf16 a[204:207], v[40:43], v[72:75], a[204:207]
  ds_read_b128 v[72:75], v4 offset:29184
  s_waitcnt lgkmcnt(7)
  v_mfma_f32_16x16x32_bf16 a[236:239], v[44:47], v[76:79], a[236:239]
  ds_read_b128 v[76:79], v4 offset:33792
  s_waitcnt lgkmcnt(7)
  v_mfma_f32_16x16x32_bf16 a[16:19], v[16:19], v[48:51], a[16:19]
  ds_read_b128 v[48:51], v4 offset:1024
  s_waitcnt lgkmcnt(7)
  v_mfma_f32_16x16x32_bf16 a[48:51], v[20:23], v[52:55], a[48:51]
  ds_read_b128 v[52:55], v4 offset:5632
  s_waitcnt lgkmcnt(7)
  v_mfma_f32_16x16x32_bf16 a[80:83], v[24:27], v[56:59], a[80:83]
  ds_read_b128 v[56:59], v4 offset:10240
  s_waitcnt lgkmcnt(7)
  v_mfma_f32_16x16x32_bf16 a[112:115], v[28:31], v[60:63], a[112:115]
  ds_read_b128 v[60:63], v4 offset:14848
  s_waitcnt lgkmcnt(7)
  v_mfma_f32_16x16x32_bf16 a[144:147], v[32:35], v[64:67], a[144:147]
  ds_read_b128 v[64:67], v4 offset:19456
  s_waitcnt lgkmcnt(7)
  v_mfma_f32_16x16x32_bf16 a[176:179], v[36:39], v[68:71], a[176:179]
  ds_read_b128 v[68:71], v4 offset:24064
  s_waitcnt lgkmcnt(7)
  v_mfma_f32_16x16x32_bf16 a[208:211], v[40:43], v[72:75], a[208:211]
  ds_read_b128 v[72:75], v4 offset:28672
  s_waitcnt lgkmcnt(7)
  v_mfma_f32_16x16x32_bf16 a[240:243], v[44:47], v[76:79], a[240:243]
  ds_read_b128 v[76:79], v4 offset:33280
  s_waitcnt lgkmcnt(7)
  v_mfma_f32_16x16x32_bf16 a[20:23], v[16:19], v[48:51], a[20:23]
  ds_read_b128 v[48:51], v4 offset:512
  s_waitcnt lgkmcnt(7)
  v_mfma_f32_16x16x32_bf16 a[52:55], v[20:23], v[52:55], a[52:55]
  ds_read_b128 v[52:55], v4 offset:5120
  s_waitcnt lgkmcnt(7)
  v_mfma_f32_16x16x32_bf16 a[84:87], v[24:27], v[56:59], a[84:87]
  ds_read_b128 v[56:59], v4 offset:9728
  s_waitcnt lgkmcnt(7)
  v_mfma_f32_16x16x32_bf16 a[116:119], v[28:31], v[60:63], a[116:119]
  ds_read_b128 v[60:63], v4 offset:14336
  s_waitcnt lgkmcnt(7)
  v_mfma_f32_16x16x32_bf16 a[148:151], v[32:35], v[64:67], a[148:151]
  ds_read_b128 v[64:67], v4 offset:18944
  s_waitcnt lgkmcnt(7)
  v_mfma_f32_16x16x32_bf16 a[180:183], v[36:39], v[68:71], a[180:183]
  ds_read_b128 v[68:71], v4 offset:23552
  s_waitcnt lgkmcnt(7)
  v_mfma_f32_16x16x32_bf16 a[212:215], v[40:43], v[72:75], a[212:215]
  ds_read_b128 v[72:75], v4 offset:28160
  s_waitcnt lgkmcnt(7)
  v_mfma_f32_16x16x32_bf16 a[244:247], v[44:47], v[76:79], a[244:247]
  ds_read_b128 v[76:79], v4 offset:32768
  s_waitcnt lgkmcnt(7)
  v_mfma_f32_16x16x32_bf16 a[24:27], v[16:19], v[48:51], a[24:27]
  ds_read_b128 v[48:51], v4 offset:0
  s_waitcnt lgkmcnt(7)
  v_mfma_f32_16x16x32_bf16 a[56:59], v[20:23], v[52:55], a[56:59]
  ds_read_b128 v[52:55], v4 offset:4608
  s_waitcnt lgkmcnt(7)
  v_mfma_f32_16x16x32_bf16 a[88:91], v[24:27], v[56:59], a[88:91]
  ds_read_b128 v[56:59], v4 offset:9216
  s_waitcnt lgkmcnt(7)
  v_mfma_f32_16x16x32_bf16 a[120:123], v[28:31], v[60:63], a[120:123]
  ds_read_b128 v[60:63], v4 offset:13824
  s_waitcnt lgkmcnt(7)
  v_mfma_f32_16x16x32_bf16 a[152:155], v[32:35], v[64:67], a[152:155]
  ds_read_b128 v[64:67], v4 offset:18432
  s_waitcnt lgkmcnt(7)
  v_mfma_f32_16x16x32_bf16 a[184:187], v[36:39], v[68:71], a[184:187]
  ds_read_b128 v[68:71], v4 offset:23040
  s_waitcnt lgkmcnt(7)
  v_mfma_f32_16x16x32_bf16 a[216:219], v[40:43], v[72:75], a[216:219]
  ds_read_b128 v[72:75], v4 offset:27648
  s_waitcnt lgkmcnt(7)
  v_mfma_f32_16x16x32_bf16 a[248:251], v[44:47], v[76:79], a[248:251]
  ds_read_b128 v[76:79], v4 offset:32256
  s_waitcnt lgkmcnt(7)
  v_mfma_f32_16x16x32_bf16 a[28:31], v[16:19], v[48:51], a[28:31]
  s_waitcnt lgkmcnt(6)
  v_mfma_f32_16x16x32_bf16 a[60:63], v[20:23], v[52:55], a[60:63]
  s_waitcnt lgkmcnt(5)
  v_mfma_f32_16x16x32_bf16 a[92:95], v[24:27], v[56:59], a[92:95]
  s_waitcnt lgkmcnt(4)
  v_mfma_f32_16x16x32_bf16 a[124:127], v[28:31], v[60:63], a[124:127]
  s_waitcnt lgkmcnt(3)
  v_mfma_f32_16x16x32_bf16 a[156:159], v[32:35], v[64:67], a[156:159]
  s_waitcnt lgkmcnt(2)
  v_mfma_f32_16x16x32_bf16 a[188:191], v[36:39], v[68:71], a[188:191]
  s_waitcnt lgkmcnt(1)
  v_mfma_f32_16x16x32_bf16 a[220:223], v[40:43], v[72:75], a[220:223]
  s_waitcnt lgkmcnt(0)
  v_mfma_f32_16x16x32_bf16 a[252:255], v[44:47], v[76:79], a[252:255]
  v_add_u32 v104, 64, v104
  v_add_u32 v105, 64, v105
  v_add_u32 v106, 64, v106
  v_add_u32 v107, 64, v107
  v_add_u32 v108, 64, v108
  v_add_u32 v109, 64, v109
  v_add_u32 v110, 64, v110
  v_add_u32 v111, 64, v111
  v_add_u32 v4, 64, v4
  v_add_u32 v8, 64, v8
  s_add_u32 s40, s40, 0x8000
  s_waitcnt vmcnt(0)
  s_mov_b64 exec, 1
  buffer_store_dword v13, v1, s[8:11], s39 offen sc1
  s_mov_b64 exec, -1
  ds_write_b32 v14, v13 offset:16
  s_add_u32 s32, s32, 1
  s_and_b32 s6, s32, 7
  s_cbranch_scc1 L_c_conv0
L_c_conv1:
  s_add_u32 s33, s32, 1
  s_and_b32 s6, s32, 7
  s_lshl_b32 s7, s6, 10
  s_add_u32 s7, s7, s35
  v_add_u32 v9, s7, v10
  s_lshl_b32 s6, s6, 1
  s_lshl_b32 s42, 0x30003, s6
  v_mov_b32 v13, s33
  ds_read_b128 v[48:51], v4 offset:3072
  ds_read_b128 v[52:55], v4 offset:7680
  ds_read_b128 v[56:59], v4 offset:12288
  ds_read_b128 v[60:63], v4 offset:16896
  ds_read_b128 v[64:67], v4 offset:21504
  ds_read_b128 v[68:71], v4 offset:26112
  ds_read_b128 v[72:75], v4 offset:30720
  ds_read_b128 v[76:79], v4 offset:35328
  s_mov_b32 s7, 0
L_lw_122:
  ds_read_b32 v88, v2 offset:0
  s_waitcnt lgkmcnt(0)
  v_cmp_gt_i32 vcc, s33, v88
  s_cbranch_vccz L_lwo_123
  s_add_u32 s7, s7, 1
  s_cmp_lt_u32 s7, 131072
  s_cbranch_scc1 L_lw_122
  s_mov_b32 s6, 42
  s_branch L_err
L_lwo_123:
  ds_read2_b32 v[112:113], v104 offset0:0 offset1:1
  ds_read2_b32 v[114:115], v104 offset0:2 offset1:3
  ds_read_b32 v116, v104 offset:16
  ds_read2_b32 v[118:119], v105 offset0:0 offset1:1
  ds_read2_b32 v[120:121], v105 offset0:2 offset1:3
  ds_read_b32 v122, v105 offset:16
  ds_read2_b32 v[124:125], v106 offset0:0 offset1:1
  ds_read2_b32 v[126:127], v106 offset0:2 offset1:3
  ds_read_b32 v128, v106 offset:16
  ds_read2_b32 v[130:131], v107 offset0:0 offset1:1
  ds_read2_b32 v[132:133], v107 offset0:2 offset1:3
  ds_read_b32 v134, v107 offset:16
  s_waitcnt lgkmcnt(9)
  v_alignbyte_b32 v16, v113, v112, v15
  v_alignbyte_b32 v17, v114, v113, v15
  v_alignbyte_b32 v18, v115, v114, v15
  v_alignbyte_b32 v19, v116, v115, v15
  ds_read2_b32 v[112:113], v108 offset0:0 offset1:1
  ds_read2_b32 v[114:115], v108 offset0:2 offset1:3
  ds_read_b32 v116, v108 offset:16
  s_waitcnt lgkmcnt(9)
  v_alignbyte_b32 v20, v119, v118, v15
  v_alignbyte_b32 v21, v120, v119, v15
  v_alignbyte_b32 v22, v121, v120, v15
  v_alignbyte_b32 v23, v122, v121, v15
  ds_read2_b32 v[118:119], v109 offset0:0 offset1:1
  ds_read2_b32 v[120:121], v109 offset0:2 offset1:3
  ds_read_b32 v122, v109 offset:16
  v_mfma_f32_16x16x32_bf16 a[4:7], v[16:19], v[48:51], a[4:7]
  s_waitcnt lgkmcnt(9)
  v_alignbyte_b32 v24, v125, v124, v15
  v_alignbyte_b32 v25, v126, v125, v15
  v_alignbyte_b32 v26, v127, v126, v15
  v_alignbyte_b32 v27, v128, v127, v15
  ds_read2_b32 v[124:125], v110 offset0:0 offset1:1
  ds_read2_b32 v[126:127], v110 offset0:2 offset1:3
  ds_read_b32 v128, v110 offset:16
  v_mfma_f32_16x16x32_bf16 a[36:39], v[20:23], v[52:55], a[36:39]
  s_waitcnt lgkmcnt(9)
  v_alignbyte_b32 v28, v131, v130, v15
  v_alignbyte_b32 v29, v132, v131, v15
  v_alignbyte_b32 v30, v133, v132, v15
  v_alignbyte_b32 v31, v134, v133, v15
  ds_read2_b32 v[130:131], v111 offset0:0 offset1:1
  ds_read2_b32 v[132:133], v111 offset0:2 offset1:3
  ds_read_b32 v134, v111 offset:16
  v_mfma_f32_16x16x32_bf16 a[68:71], v[24:27], v[56:59], a[68:71]
  s_waitcnt lgkmcnt(9)
  v_alignbyte_b32 v32, v113, v112, v15
  v_alignbyte_b32 v33, v114, v113, v15
  v_alignbyte_b32 v34, v115, v114, v15
  v_alignbyte_b32 v35, v116, v115, v15
  ds_read_b64 v[84:85], v8
  ds_read_b64 v[86:87], v9
  v_mfma_f32_16x16x32_bf16 a[100:103], v[28:31], v[60:63], a[100:103]
  s_waitcnt lgkmcnt(8)
  v_alignbyte_b32 v36, v119, v118, v15
  v_alignbyte_b32 v37, v120, v119, v15
  v_alignbyte_b32 v38, v121, v120, v15
  v_alignbyte_b32 v39, v122, v121, v15
  v_mfma_f32_16x16x32_bf16 a[132:135], v[32:35], v[64:67], a[132:135]
  s_waitcnt lgkmcnt(5)
  v_alignbyte_b32 v40, v125, v124, v15
  v_alignbyte_b32 v41, v126, v125, v15
  v_alignbyte_b32 v42, v127, v126, v15
  v_alignbyte_b32 v43, v128, v127, v15
  v_mfma_f32_16x16x32_bf16 a[164:167], v[36:39], v[68:71], a[164:167]
  s_waitcnt lgkmcnt(2)
  v_alignbyte_b32 v44, v131, v130, v15
  v_alignbyte_b32 v45, v132, v131, v15
  v_alignbyte_b32 v46, v133, v132, v15
  v_alignbyte_b32 v47, v134, v133, v15
  v_mfma_f32_16x16x32_bf16 a[196:199], v[40:43], v[72:75], a[196:199]
  s_nop 0
  v_mfma_f32_16x16x32_bf16 a[228:231], v[44:47], v[76:79], a[228:231]
  s_waitcnt lgkmcnt(0)
  ds_read_b128 v[48:51], v4 offset:2560
  ds_read_b128 v[52:55], v4 offset:7168
  ds_read_b128 v[56:59], v4 offset:11776
  ds_read_b128 v[60:63], v4 offset:16384
  ds_read_b128 v[64:67], v4 offset:20992
  ds_read_b128 v[68:71], v4 offset:25600
  ds_read_b128 v[72:75], v4 offset:30208
  ds_read_b128 v[76:79], v4 offset:34816
  s_mov_b32 exec_lo, s42
  s_mov_b32 exec_hi, s42
  ds_write_b128 v6, a[4:7] offset:0
  ds_write_b128 v6, a[36:39] offset:128
  ds_write_b128 v6, a[68:71] offset:256
  ds_write_b128 v6, a[100:103] offset:384
  ds_write_b128 v6, a[132:135] offset:512
  ds_write_b128 v6, a[164:167] offset:640
  ds_write_b128 v6, a[196:199] offset:768
  ds_write_b128 v6, a[228:231] offset:896
  s_mov_b64 exec, -1
  ds_read_b128 v[80:83], v7
  ds_write_b32 v14, v13 offset:8
  v_lshlrev_b32 v88, 16, v84
  v_and_b32 v89, 0xffff0000, v84
  v_lshlrev_b32 v90, 16, v85
  v_and_b32 v91, 0xffff0000, v85
  v_lshlrev_b32 v96, 16, v86
  v_and_b32 v97, 0xffff0000, v86
  v_lshlrev_b32 v98, 16, v87
  v_and_b32 v99, 0xffff0000, v87
  v_mul_f32 v92, v88, v12
  v_mul_f32 v93, v89, v12
  v_mul_f32 v94, v90, v12
  v_mul_f32 v95, v91, v12
  v_cvt_pk_bf16_f32 v84, v92, v93
  v_cvt_pk_bf16_f32 v85, v94, v95
  v_lshlrev_b32 v92, 16, v84
  v_and_b32 v93, 0xffff0000, v84
  v_lshlrev_b32 v94, 16, v85
  v_and_b32 v95, 0xffff0000, v85
  s_waitcnt lgkmcnt(1)
  v_fmac_f32 v80, v88, v11
  v_fmac_f32 v81, v89, v11
  v_fmac_f32 v82, v90, v11
  v_fmac_f32 v83, v91, v11
  v_cvt_pk_bf16_f32 v84, v80, v81
  v_cvt_pk_bf16_f32 v85, v82, v83
  v_lshlrev_b32 v80, 16, v84
  v_and_b32 v81, 0xffff0000, v84
  v_lshlrev_b32 v82, 16, v85
  v_and_b32 v83, 0xffff0000, v85
  v_add_f32 v80, v80, v92
  v_add_f32 v81, v81, v93
  v_add_f32 v82, v82, v94
  v_add_f32 v83, v83, v95
  v_cvt_pk_bf16_f32 v84, v80, v81
  v_cvt_pk_bf16_f32 v85, v82, v83
  v_lshlrev_b32 v80, 16, v84
  v_and_b32 v81, 0xffff0000, v84
  v_lshlrev_b32 v82, 16, v85
  v_and_b32 v83, 0xffff0000, v85
  v_add_f32 v80, v80, v96
  v_add_f32 v81, v81, v97
  v_add_f32 v82, v82, v98
  v_add_f32 v83, v83, v99
  v_cvt_pk_bf16_f32 v84, v80, v81
  v_cvt_pk_bf16_f32 v85, v82, v83
  buffer_store_dwordx2 v[84:85], v10, s[8:11], s40 offen sc1
  v_mfma_f32_16x16x32_bf16 a[8:11], v[16:19], v[48:51], a[8:11]
  ds_read_b128 v[48:51], v4 offset:2048
  v_mfma_f32_16x16x32_bf16 a[40:43], v[20:23], v[52:55], a[40:43]
  ds_read_b128 v[52:55], v4 offset:6656
  v_mfma_f32_16x16x32_bf16 a[72:75], v[24:27], v[56:59], a[72:75]
  ds_read_b128 v[56:59], v4 offset:11264
  v_mfma_f32_16x16x32_bf16 a[104:107], v[28:31], v[60:63], a[104:107]
  ds_read_b128 v[60:63], v4 offset:15872
  v_mfma_f32_16x16x32_bf16 a[136:139], v[32:35], v[64:67], a[136:139]
  ds_read_b128 v[64:67], v4 offset:20480
  v_mfma_f32_16x16x32_bf16 a[168:171], v[36:39], v[68:71], a[168:171]
  ds_read_b128 v[68:71], v4 offset:25088
  v_mfma_f32_16x16x32_bf16 a[200:203], v[40:43], v[72:75], a[200:203]
  ds_read_b128 v[72:75], v4 offset:29696
  v_mfma_f32_16x16x32_bf16 a[232:235], v[44:47], v[76:79], a[232:235]
  ds_read_b128 v[76:79], v4 offset:34304
  s_waitcnt lgkmcnt(7)
  v_mfma_f32_16x16x32_bf16 a[12:15], v[16:19], v[48:51], a[12:15]
  ds_read_b128 v[48:51], v4 offset:1536
  s_waitcnt lgkmcnt(7)
  v_mfma_f32_16x16x32_bf16 a[44:47], v[20:23], v[52:55], a[44:47]
  ds_read_b128 v[52:55], v4 offset:6144
  s_waitcnt lgkmcnt(7)
  v_mfma_f32_16x16x32_bf16 a[76:79], v[24:27], v[56:59], a[76:79]
  ds_read_b128 v[56:59], v4 offset:10752
  s_waitcnt lgkmcnt(7)
  v_mfma_f32_16x16x32_bf16 a[108:111], v[28:31], v[60:63], a[108:111]
  ds_read_b128 v[60:63], v4 offset:15360
  s_waitcnt lgkmcnt(7)
  v_mfma_f32_16x16x32_bf16 a[140:143], v[32:35], v[64:67], a[140:143]
  ds_read_b128 v[64:67], v4 offset:19968
  s_waitcnt lgkmcnt(7)
  v_mfma_f32_16x16x32_bf16 a[172:175], v[36:39], v[68:71], a[172:175]
  ds_read_b128 v[68:71], v4 offset:24576
  s_waitcnt lgkmcnt(7)
  v_mfma_f32_16x16x32_bf16 a[204:207], v[40:43], v[72:75], a[204:207]
  ds_read_b128 v[72:75], v4 offset:29184
  s_waitcnt lgkmcnt(7)
  v_mfma_f32_16x16x32_bf16 a[236:239], v[44:47], v[76:79], a[236:239]
  ds_read_b128 v[76:79], v4 offset:33792
  s_waitcnt lgkmcnt(7)
  v_mfma_f32_16x16x32_bf16 a[16:19], v[16:19], v[48:51], a[16:19]
  ds_read_b128 v[48:51], v4 offset:1024
  s_waitcnt lgkmcnt(7)
  v_mfma_f32_16x16x32_bf16 a[48:51], v[20:23], v[52:55], a[48:51]
  ds_read_b128 v[52:55], v4 offset:5632
  s_waitcnt lgkmcnt(7)
  v_mfma_f32_16x16x32_bf16 a[80:83], v[24:27], v[56:59], a[80:83]
  ds_read_b128 v[56:59], v4 offset:10240
  s_waitcnt lgkmcnt(7)
  v_mfma_f32_16x16x32_bf16 a[112:115], v[28:31], v[60:63], a[112:115]
  ds_read_b128 v[60:63], v4 offset:14848
  s_waitcnt lgkmcnt(7)
  v_mfma_f32_16x16x32_bf16 a[144:147], v[32:35], v[64:67], a[144:147]
  ds_read_b128 v[64:67], v4 offset:19456
  s_waitcnt lgkmcnt(7)
  v_mfma_f32_16x16x32_bf16 a[176:179], v[36:39], v[68:71], a[176:179]
  ds_read_b128 v[68:71], v4 offset:24064
  s_waitcnt lgkmcnt(7)
  v_mfma_f32_16x16x32_bf16 a[208:211], v[40:43], v[72:75], a[208:211]
  ds_read_b128 v[72:75], v4 offset:28672
  s_waitcnt lgkmcnt(7)
  v_mfma_f32_16x16x32_bf16 a[240:243], v[44:47], v[76:79], a[240:243]
  ds_read_b128 v[76:79], v4 offset:33280
  s_waitcnt lgkmcnt(7)
  v_mfma_f32_16x16x32_bf16 a[20:23], v[16:19], v[48:51], a[20:23]
  ds_read_b128 v[48:51], v4 offset:512
  s_waitcnt lgkmcnt(7)
  v_mfma_f32_16x16x32_bf16 a[52:55], v[20:23], v[52:55], a[52:55]
  ds_read_b128 v[52:55], v4 offset:5120
  s_waitcnt lgkmcnt(7)
  v_mfma_f32_16x16x32_bf16 a[84:87], v[24:27], v[56:59], a[84:87]
  ds_read_b128 v[56:59], v4 offset:9728
  s_waitcnt lgkmcnt(7)
  v_mfma_f32_16x16x32_bf16 a[116:119], v[28:31], v[60:63], a[116:119]
  ds_read_b128 v[60:63], v4 offset:14336
  s_waitcnt lgkmcnt(7)
  v_mfma_f32_16x16x32_bf16 a[148:151], v[32:35], v[64:67], a[148:151]
  ds_read_b128 v[64:67], v4 offset:18944
  s_waitcnt lgkmcnt(7)
  v_mfma_f32_16x16x32_bf16 a[180:183], v[36:39], v[68:71], a[180:183]
  ds_read_b128 v[68:71], v4 offset:23552
  s_waitcnt lgkmcnt(7)
  v_mfma_f32_16x16x32_bf16 a[212:215], v[40:43], v[72:75], a[212:215]
  ds_read_b128 v[72:75], v4 offset:28160
  s_waitcnt lgkmcnt(7)
  v_mfma_f32_16x16x32_bf16 a[244:247], v[44:47], v[76:79], a[244:247]
  ds_read_b128 v[76:79], v4 offset:32768
  s_waitcnt lgkmcnt(7)
  v_mfma_f32_16x16x32_bf16 a[24:27], v[16:19], v[48:51], a[24:27]
  ds_read_b128 v[48:51], v4 offset:0
  s_waitcnt lgkmcnt(7)
  v_mfma_f32_16x16x32_bf16 a[56:59], v[20:23], v[52:55], a[56:59]
  ds_read_b128 v[52:55], v4 offset:4608
  s_waitcnt lgkmcnt(7)
  v_mfma_f32_16x16x32_bf16 a[88:91], v[24:27], v[56:59], a[88:91]
  ds_read_b128 v[56:59], v4 offset:9216
  s_waitcnt lgkmcnt(7)
  v_mfma_f32_16x16x32_bf16 a[120:123], v[28:31], v[60:63], a[120:123]
  ds_read_b128 v[60:63], v4 offset:13824
  s_waitcnt lgkmcnt(7)
  v_mfma_f32_16x16x32_bf16 a[152:155], v[32:35], v[64:67], a[152:155]
  ds_read_b128 v[64:67], v4 offset:18432
  s_waitcnt lgkmcnt(7)
  v_mfma_f32_16x16x32_bf16 a[184:187], v[36:39], v[68:71], a[184:187]
  ds_read_b128 v[68:71], v4 offset:23040
  s_waitcnt lgkmcnt(7)
  v_mfma_f32_16x16x32_bf16 a[216:219], v[40:43], v[72:75], a[216:219]
  ds_read_b128 v[72:75], v4 offset:27648
  s_waitcnt lgkmcnt(7)
  v_mfma_f32_16x16x32_bf16 a[248:251], v[44:47], v[76:79], a[248:251]
  ds_read_b128 v[76:79], v4 offset:32256
  s_waitcnt lgkmcnt(7)
  v_mfma_f32_16x16x32_bf16 a[28:31], v[16:19], v[48:51], a[28:31]
  s_waitcnt lgkmcnt(6)
  v_mfma_f32_16x16x32_bf16 a[60:63], v[20:23], v[52:55], a[60:63]
  s_waitcnt lgkmcnt(5)
  v_mfma_f32_16x16x32_bf16 a[92:95], v[24:27], v[56:59], a[92:95]
  s_waitcnt lgkmcnt(4)
  v_mfma_f32_16x16x32_bf16 a[124:127], v[28:31], v[60:63], a[124:127]
  s_waitcnt lgkmcnt(3)
  v_mfma_f32_16x16x32_bf16 a[156:159], v[32:35], v[64:67], a[156:159]
  s_waitcnt lgkmcnt(2)
  v_mfma_f32_16x16x32_bf16 a[188:191], v[36:39], v[68:71], a[188:191]
  s_waitcnt lgkmcnt(1)
  v_mfma_f32_16x16x32_bf16 a[220:223], v[40:43], v[72:75], a[220:223]
  s_waitcnt lgkmcnt(0)
  v_mfma_f32_16x16x32_bf16 a[252:255], v[44:47], v[76:79], a[252:255]
  v_add_u32 v104, 64, v104
  v_add_u32 v105, 64, v105
  v_add_u32 v106, 64, v106
  v_add_u32 v107, 64, v107
  v_add_u32 v108, 64, v108
  v_add_u32 v109, 64, v109
  v_add_u32 v110, 64, v110
  v_add_u32 v111, 64, v111
  v_add_u32 v4, 64, v4
  v_add_u32 v8, 64, v8
  s_add_u32 s40, s40, 0x8000
  s_waitcnt vmcnt(0)
  s_mov_b64 exec, 1
  buffer_store_dword v13, v1, s[8:11], s39 offen sc1
  s_mov_b64 exec, -1
  ds_write_b32 v14, v13 offset:16
  s_add_u32 s32, s32, 1
  s_and_b32 s6, s32, 7
  s_cbranch_scc1 L_c_conv1
L_c_conv2:
  s_add_u32 s33, s32, 1
  s_and_b32 s6, s32, 7
  s_lshl_b32 s7, s6, 10
  s_add_u32 s7, s7, s35
  v_add_u32 v9, s7, v10
  s_lshl_b32 s6, s6, 1
  s_lshl_b32 s42, 0x30003, s6
  v_mov_b32 v13, s33
  ds_read_b128 v[48:51], v4 offset:2560
  ds_read_b128 v[52:55], v4 offset:7168
  ds_read_b128 v[56:59], v4 offset:11776
  ds_read_b128 v[60:63], v4 offset:16384
  ds_read_b128 v[64:67], v4 offset:20992
  ds_read_b128 v[68:71], v4 offset:25600
  ds_read_b128 v[72:75], v4 offset:30208
  ds_read_b128 v[76:79], v4 offset:34816
  s_mov_b32 s7, 0
L_lw_124:
  ds_read_b32 v88, v2 offset:0
  s_waitcnt lgkmcnt(0)
  v_cmp_gt_i32 vcc, s33, v88
  s_cbranch_vccz L_lwo_125
  s_add_u32 s7, s7, 1
  s_cmp_lt_u32 s7, 131072
  s_cbranch_scc1 L_lw_124
  s_mov_b32 s6, 42
  s_branch L_err
L_lwo_125:
  ds_read2_b32 v[112:113], v104 offset0:0 offset1:1
  ds_read2_b32 v[114:115], v104 offset0:2 offset1:3
  ds_read_b32 v116, v104 offset:16
  ds_read2_b32 v[118:119], v105 offset0:0 offset1:1
  ds_read2_b32 v[120:121], v105 offset0:2 offset1:3
  ds_read_b32 v122, v105 offset:16
  ds_read2_b32 v[124:125], v106 offset0:0 offset1:1
  ds_read2_b32 v[126:127], v106 offset0:2 offset1:3
  ds_read_b32 v128, v106 offset:16
  ds_read2_b32 v[130:131], v107 offset0:0 offset1:1
  ds_read2_b32 v[132:133], v107 offset0:2 offset1:3
  ds_read_b32 v134, v107 offset:16
  s_waitcnt lgkmcnt(9)
  v_alignbyte_b32 v16, v113, v112, v15
  v_alignbyte_b32 v17, v114, v113, v15
  v_alignbyte_b32 v18, v115, v114, v15
  v_alignbyte_b32 v19, v116, v115, v15
  ds_read2_b32 v[112:113], v108 offset0:0 offset1:1
  ds_read2_b32 v[114:115], v108 offset0:2 offset1:3
  ds_read_b32 v116, v108 offset:16
  s_waitcnt lgkmcnt(9)
  v_alignbyte_b32 v20, v119, v118, v15
  v_alignbyte_b32 v21, v120, v119, v15
  v_alignbyte_b32 v22, v121, v120, v15
  v_alignbyte_b32 v23, v122, v121, v15
  ds_read2_b32 v[118:119], v109 offset0:0 offset1:1
  ds_read2_b32 v[120:121], v109 offset0:2 offset1:3
  ds_read_b32 v122, v109 offset:16
  v_mfma_f32_16x16x32_bf16 a[8:11], v[16:19], v[48:51], a[8:11]
  s_waitcnt lgkmcnt(9)
  v_alignbyte_b32 v24, v125, v124, v15
  v_alignbyte_b32 v25, v126, v125, v15
  v_alignbyte_b32 v26, v127, v126, v15
  v_alignbyte_b32 v27, v128, v127, v15
  ds_read2_b32 v[124:125], v110 offset0:0 offset1:1
  ds_read2_b32 v[126:127], v110 offset0:2 offset1:3
  ds_read_b32 v128, v110 offset:16
  v_mfma_f32_16x16x32_bf16 a[40:43], v[20:23], v[52:55], a[40:43]
  s_waitcnt lgkmcnt(9)
  v_alignbyte_b32 v28, v131, v130, v15
  v_alignbyte_b32 v29, v132, v131, v15
  v_alignbyte_b32 v30, v133, v132, v15
  v_alignbyte_b32 v31, v134, v133, v15
  ds_read2_b32 v[130:131], v111 offset0:0 offset1:1
  ds_read2_b32 v[132:133], v111 offset0:2 offset1:3
  ds_read_b32 v134, v111 offset:16
  v_mfma_f32_16x16x32_bf16 a[72:75], v[24:27], v[56:59], a[72:75]
  s_waitcnt lgkmcnt(9)
  v_alignbyte_b32 v32, v113, v112, v15
  v_alignbyte_b32 v33, v114, v113, v15
  v_alignbyte_b32 v34, v115, v114, v15
  v_alignbyte_b32 v35, v116, v115, v15
  ds_read_b64 v[84:85], v8
  ds_read_b64 v[86:87], v9
  v_mfma_f32_16x16x32_bf16 a[104:107], v[28:31], v[60:63], a[104:107]
  s_waitcnt lgkmcnt(8)
  v_alignbyte_b32 v36, v119, v118, v15
  v_alignbyte_b32 v37, v120, v119, v15
  v_alignbyte_b32 v38, v121, v120, v15
  v_alignbyte_b32 v39, v122, v121, v15
  v_mfma_f32_16x16x32_bf16 a[136:139], v[32:35], v[64:67], a[136:139]
  s_waitcnt lgkmcnt(5)
  v_alignbyte_b32 v40, v125, v124, v15
  v_alignbyte_b32 v41, v126, v125, v15
  v_alignbyte_b32 v42, v127, v126, v15
  v_alignbyte_b32 v43, v128, v127, v15
  v_mfma_f32_16x16x32_bf16 a[168:171], v[36:39], v[68:71], a[168:171]
  s_waitcnt lgkmcnt(2)
  v_alignbyte_b32 v44, v131, v130, v15
  v_alignbyte_b32 v45, v132, v131, v15
  v_alignbyte_b32 v46, v133, v132, v15
  v_alignbyte_b32 v47, v134, v133, v15
  v_mfma_f32_16x16x32_bf16 a[200:203], v[40:43], v[72:75], a[200:203]
  s_nop 0
  v_mfma_f32_16x16x32_bf16 a[232:235], v[44:47], v[76:79], a[232:235]
  s_waitcnt lgkmcnt(0)
  ds_read_b128 v[48:51], v4 offset:2048
  ds_read_b128 v[52:55], v4 offset:6656
  ds_read_b128 v[56:59], v4 offset:11264
  ds_read_b128 v[60:63], v4 offset:15872
  ds_read_b128 v[64:67], v4 offset:20480
  ds_read_b128 v[68:71], v4 offset:25088
  ds_read_b128 v[72:75], v4 offset:29696
  ds_read_b128 v[76:79], v4 offset:34304
  s_mov_b32 exec_lo, s42
  s_mov_b32 exec_hi, s42
  ds_write_b128 v6, a[8:11] offset:0
  ds_write_b128 v6, a[40:43] offset:128
  ds_write_b128 v6, a[72:75] offset:256
  ds_write_b128 v6, a[104:107] offset:384
  ds_write_b128 v6, a[136:139] offset:512
  ds_write_b128 v6, a[168:171] offset:640
  ds_write_b128 v6, a[200:203] offset:768
  ds_write_b128 v6, a[232:235] offset:896
  s_mov_b64 exec, -1
  ds_read_b128 v[80:83], v7
  ds_write_b32 v14, v13 offset:8
  v_lshlrev_b32 v88, 16, v84
  v_and_b32 v89, 0xffff0000, v84
  v_lshlrev_b32 v90, 16, v85
  v_and_b32 v91, 0xffff0000, v85
  v_lshlrev_b32 v96, 16, v86
  v_and_b32 v97, 0xffff0000, v86
  v_lshlrev_b32 v98, 16, v87
  v_and_b32 v99, 0xffff0000, v87
  v_mul_f32 v92, v88, v12
  v_mul_f32 v93, v89, v12
  v_mul_f32 v94, v90, v12
  v_mul_f32 v95, v91, v12
  v_cvt_pk_bf16_f32 v84, v92, v93
  v_cvt_pk_bf16_f32 v85, v94, v95
  v_lshlrev_b32 v92, 16, v84
  v_and_b32 v93, 0xffff0000, v84
  v_lshlrev_b32 v94, 16, v85
  v_and_b32 v95, 0xffff0000, v85
  s_waitcnt lgkmcnt(1)
  v_fmac_f32 v80, v88, v11
  v_fmac_f32 v81, v89, v11
  v_fmac_f32 v82, v90, v11
  v_fmac_f32 v83, v91, v11
  v_cvt_pk_bf16_f32 v84, v80, v81
  v_cvt_pk_bf16_f32 v85, v82, v83
  v_lshlrev_b32 v80, 16, v84
  v_and_b32 v81, 0xffff0000, v84
  v_lshlrev_b32 v82, 16, v85
  v_and_b32 v83, 0xffff0000, v85
  v_add_f32 v80, v80, v92
  v_add_f32 v81, v81, v93
  v_add_f32 v82, v82, v94
  v_add_f32 v83, v83, v95
  v_cvt_pk_bf16_f32 v84, v80, v81
  v_cvt_pk_bf16_f32 v85, v82, v83
  v_lshlrev_b32 v80, 16, v84
  v_and_b32 v81, 0xffff0000, v84
  v_lshlrev_b32 v82, 16, v85
  v_and_b32 v83, 0xffff0000, v85
  v_add_f32 v80, v80, v96
  v_add_f32 v81, v81, v97
  v_add_f32 v82, v82, v98
  v_add_f32 v83, v83, v99
  v_cvt_pk_bf16_f32 v84, v80, v81
  v_cvt_pk_bf16_f32 v85, v82, v83
  buffer_store_dwordx2 v[84:85], v10, s[8:11], s40 offen sc1
  v_mfma_f32_16x16x32_bf16 a[12:15], v[16:19], v[48:51], a[12:15]
  ds_read_b128 v[48:51], v4 offset:1536
  v_mfma_f32_16x16x32_bf16 a[44:47], v[20:23], v[52:55], a[44:47]
  ds_read_b128 v[52:55], v4 offset:6144
  v_mfma_f32_16x16x32_bf16 a[76:79], v[24:27], v[56:59], a[76:79]
  ds_read_b128 v[56:59], v4 offset:10752
  v_mfma_f32_16x16x32_bf16 a[108:111], v[28:31], v[60:63], a[108:111]
  ds_read_b128 v[60:63], v4 offset:15360
  v_mfma_f32_16x16x32_bf16 a[140:143], v[32:35], v[64:67], a[140:143]
  ds_read_b128 v[64:67], v4 offset:19968
  v_mfma_f32_16x16x32_bf16 a[172:175], v[36:39], v[68:71], a[172:175]
  ds_read_b128 v[68:71], v4 offset:24576
  v_mfma_f32_16x16x32_bf16 a[204:207], v[40:43], v[72:75], a[204:207]
  ds_read_b128 v[72:75], v4 offset:29184
  v_mfma_f32_16x16x32_bf16 a[236:239], v[44:47], v[76:79], a[236:239]
  ds_read_b128 v[76:79], v4 offset:33792
  s_waitcnt lgkmcnt(7)
  v_mfma_f32_16x16x32_bf16 a[16:19], v[16:19], v[48:51], a[16:19]
  ds_read_b128 v[48:51], v4 offset:1024
  s_waitcnt lgkmcnt(7)
  v_mfma_f32_16x16x32_bf16 a[48:51], v[20:23], v[52:55], a[48:51]
  ds_read_b128 v[52:55], v4 offset:5632
  s_waitcnt lgkmcnt(7)
  v_mfma_f32_16x16x32_bf16 a[80:83], v[24:27], v[56:59], a[80:83]
  ds_read_b128 v[56:59], v4 offset:10240
  s_waitcnt lgkmcnt(7)
  v_mfma_f32_16x16x32_bf16 a[112:115], v[28:31], v[60:63], a[112:115]
  ds_read_b128 v[60:63], v4 offset:14848
  s_waitcnt lgkmcnt(7)
  v_mfma_f32_16x16x32_bf16 a[144:147], v[32:35], v[64:67], a[144:147]
  ds_read_b128 v[64:67], v4 offset:19456
  s_waitcnt lgkmcnt(7)
  v_mfma_f32_16x16x32_bf16 a[176:179], v[36:39], v[68:71], a[176:179]
  ds_read_b128 v[68:71], v4 offset:24064
  s_waitcnt lgkmcnt(7)
  v_mfma_f32_16x16x32_bf16 a[208:211], v[40:43], v[72:75], a[208:211]
  ds_read_b128 v[72:75], v4 offset:28672
  s_waitcnt lgkmcnt(7)
  v_mfma_f32_16x16x32_bf16 a[240:243], v[44:47], v[76:79], a[240:243]
  ds_read_b128 v[76:79], v4 offset:33280
  s_waitcnt lgkmcnt(7)
  v_mfma_f32_16x16x32_bf16 a[20:23], v[16:19], v[48:51], a[20:23]
  ds_read_b128 v[48:51], v4 offset:512
  s_waitcnt lgkmcnt(7)
  v_mfma_f32_16x16x32_bf16 a[52:55], v[20:23], v[52:55], a[52:55]
  ds_read_b128 v[52:55], v4 offset:5120
  s_waitcnt lgkmcnt(7)
  v_mfma_f32_16x16x32_bf16 a[84:87], v[24:27], v[56:59], a[84:87]
  ds_read_b128 v[56:59], v4 offset:9728
  s_waitcnt lgkmcnt(7)
  v_mfma_f32_16x16x32_bf16 a[116:119], v[28:31], v[60:63], a[116:119]
  ds_read_b128 v[60:63], v4 offset:14336
  s_waitcnt lgkmcnt(7)
  v_mfma_f32_16x16x32_bf16 a[148:151], v[32:35], v[64:67], a[148:151]
  ds_read_b128 v[64:67], v4 offset:18944
  s_waitcnt lgkmcnt(7)
  v_mfma_f32_16x16x32_bf16 a[180:183], v[36:39], v[68:71], a[180:183]
  ds_read_b128 v[68:71], v4 offset:23552
  s_waitcnt lgkmcnt(7)
  v_mfma_f32_16x16x32_bf16 a[212:215], v[40:43], v[72:75], a[212:215]
  ds_read_b128 v[72:75], v4 offset:28160
  s_waitcnt lgkmcnt(7)
  v_mfma_f32_16x16x32_bf16 a[244:247], v[44:47], v[76:79], a[244:247]
  ds_read_b128 v[76:79], v4 offset:32768
  s_waitcnt lgkmcnt(7)
  v_mfma_f32_16x16x32_bf16 a[24:27], v[16:19], v[48:51], a[24:27]
  ds_read_b128 v[48:51], v4 offset:0
  s_waitcnt lgkmcnt(7)
  v_mfma_f32_16x16x32_bf16 a[56:59], v[20:23], v[52:55], a[56:59]
  ds_read_b128 v[52:55], v4 offset:4608
  s_waitcnt lgkmcnt(7)
  v_mfma_f32_16x16x32_bf16 a[88:91], v[24:27], v[56:59], a[88:91]
  ds_read_b128 v[56:59], v4 offset:9216
  s_waitcnt lgkmcnt(7)
  v_mfma_f32_16x16x32_bf16 a[120:123], v[28:31], v[60:63], a[120:123]
  ds_read_b128 v[60:63], v4 offset:13824
  s_waitcnt lgkmcnt(7)
  v_mfma_f32_16x16x32_bf16 a[152:155], v[32:35], v[64:67], a[152:155]
  ds_read_b128 v[64:67], v4 offset:18432
  s_waitcnt lgkmcnt(7)
  v_mfma_f32_16x16x32_bf16 a[184:187], v[36:39], v[68:71], a[184:187]
  ds_read_b128 v[68:71], v4 offset:23040
  s_waitcnt lgkmcnt(7)
  v_mfma_f32_16x16x32_bf16 a[216:219], v[40:43], v[72:75], a[216:219]
  ds_read_b128 v[72:75], v4 offset:27648
  s_waitcnt lgkmcnt(7)
  v_mfma_f32_16x16x32_bf16 a[248:251], v[44:47], v[76:79], a[248:251]
  ds_read_b128 v[76:79], v4 offset:32256
  s_waitcnt lgkmcnt(7)
  v_mfma_f32_16x16x32_bf16 a[28:31], v[16:19], v[48:51], a[28:31]
  s_waitcnt lgkmcnt(6)
  v_mfma_f32_16x16x32_bf16 a[60:63], v[20:23], v[52:55], a[60:63]
  s_waitcnt lgkmcnt(5)
  v_mfma_f32_16x16x32_bf16 a[92:95], v[24:27], v[56:59], a[92:95]
  s_waitcnt lgkmcnt(4)
  v_mfma_f32_16x16x32_bf16 a[124:127], v[28:31], v[60:63], a[124:127]
  s_waitcnt lgkmcnt(3)
  v_mfma_f32_16x16x32_bf16 a[156:159], v[32:35], v[64:67], a[156:159]
  s_waitcnt lgkmcnt(2)
  v_mfma_f32_16x16x32_bf16 a[188:191], v[36:39], v[68:71], a[188:191]
  s_waitcnt lgkmcnt(1)
  v_mfma_f32_16x16x32_bf16 a[220:223], v[40:43], v[72:75], a[220:223]
  s_waitcnt lgkmcnt(0)
  v_mfma_f32_16x16x32_bf16 a[252:255], v[44:47], v[76:79], a[252:255]
  v_add_u32 v104, 64, v104
  v_add_u32 v105, 64, v105
  v_add_u32 v106, 64, v106
  v_add_u32 v107, 64, v107
  v_add_u32 v108, 64, v108
  v_add_u32 v109, 64, v109
  v_add_u32 v110, 64, v110
  v_add_u32 v111, 64, v111
  v_add_u32 v4, 64, v4
  v_add_u32 v8, 64, v8
  s_add_u32 s40, s40, 0x8000
  s_waitcnt vmcnt(0)
  s_mov_b64 exec, 1
  buffer_store_dword v13, v1, s[8:11], s39 offen sc1
  s_mov_b64 exec, -1
  ds_write_b32 v14, v13 offset:16
  s_add_u32 s32, s32, 1
  s_and_b32 s6, s32, 7
  s_cbranch_scc1 L_c_conv2
L_c_conv3:
  s_add_u32 s33, s32, 1
  s_and_b32 s6, s32, 7
  s_lshl_b32 s7, s6, 10
  s_add_u32 s7, s7, s35
  v_add_u32 v9, s7, v10
  s_lshl_b32 s6, s6, 1
  s_lshl_b32 s42, 0x30003, s6
  v_mov_b32 v13, s33
  ds_read_b128 v[48:51], v4 offset:2048
  ds_read_b128 v[52:55], v4 offset:6656
  ds_read_b128 v[56:59], v4 offset:11264
  ds_read_b128 v[60:63], v4 offset:15872
  ds_read_b128 v[64:67], v4 offset:20480
  ds_read_b128 v[68:71], v4 offset:25088
  ds_read_b128 v[72:75], v4 offset:29696
  ds_read_b128 v[76:79], v4 offset:34304
  s_mov_b32 s7, 0
L_lw_126:
  ds_read_b32 v88, v2 offset:0
  s_waitcnt lgkmcnt(0)
  v_cmp_gt_i32 vcc, s33, v88
  s_cbranch_vccz L_lwo_127
  s_add_u32 s7, s7, 1
  s_cmp_lt_u32 s7, 131072
  s_cbranch_scc1 L_lw_126
  s_mov_b32 s6, 42
  s_branch L_err
L_lwo_127:
  ds_read2_b32 v[112:113], v104 offset0:0 offset1:1
  ds_read2_b32 v[114:115], v104 offset0:2 offset1:3
  ds_read_b32 v116, v104 offset:16
  ds_read2_b32 v[118:119], v105 offset0:0 offset1:1
  ds_read2_b32 v[120:121], v105 offset0:2 offset1:3
  ds_read_b32 v122, v105 offset:16
  ds_read2_b32 v[124:125], v106 offset0:0 offset1:1
  ds_read2_b32 v[126:127], v106 offset0:2 offset1:3
  ds_read_b32 v128, v106 offset:16
  ds_read2_b32 v[130:131], v107 offset0:0 offset1:1
  ds_read2_b32 v[132:133], v107 offset0:2 offset1:3
  ds_read_b32 v134, v107 offset:16
  s_waitcnt lgkmcnt(9)
  v_alignbyte_b32 v16, v113, v112, v15
  v_alignbyte_b32 v17, v114, v113, v15
  v_alignbyte_b32 v18, v115, v114, v15
  v_alignbyte_b32 v19, v116, v115, v15
  ds_read2_b32 v[112:113], v108 offset0:0 offset1:1
  ds_read2_b32 v[114:115], v108 offset0:2 offset1:3
  ds_read_b32 v116, v108 offset:16
  s_waitcnt lgkmcnt(9)
  v_alignbyte_b32 v20, v119, v118, v15
  v_alignbyte_b32 v21, v120, v119, v15
  v_alignbyte_b32 v22, v121, v120, v15
  v_alignbyte_b32 v23, v122, v121, v15
  ds_read2_b32 v[118:119], v109 offset0:0 offset1:1
  ds_read2_b32 v[120:121], v109 offset0:2 offset1:3
  ds_read_b32 v122, v109 offset:16
  v_mfma_f32_16x16x32_bf16 a[12:15], v[16:19], v[48:51], a[12:15]
  s_waitcnt lgkmcnt(9)
  v_alignbyte_b32 v24, v125, v124, v15
  v_alignbyte_b32 v25, v126, v125, v15
  v_alignbyte_b32 v26, v127, v126, v15
  v_alignbyte_b32 v27, v128, v127, v15
  ds_read2_b32 v[124:125], v110 offset0:0 offset1:1
  ds_read2_b32 v[126:127], v110 offset0:2 offset1:3
  ds_read_b32 v128, v110 offset:16
  v_mfma_f32_16x16x32_bf16 a[44:47], v[20:23], v[52:55], a[44:47]
  s_waitcnt lgkmcnt(9)
  v_alignbyte_b32 v28, v131, v130, v15
  v_alignbyte_b32 v29, v132, v131, v15
  v_alignbyte_b32 v30, v133, v132, v15
  v_alignbyte_b32 v31, v134, v133, v15
  ds_read2_b32 v[130:131], v111 offset0:0 offset1:1
  ds_read2_b32 v[132:133], v111 offset0:2 offset1:3
  ds_read_b32 v134, v111 offset:16
  v_mfma_f32_16x16x32_bf16 a[76:79], v[24:27], v[56:59], a[76:79]
  s_waitcnt lgkmcnt(9)
  v_alignbyte_b32 v32, v113, v112, v15
  v_alignbyte_b32 v33, v114, v113, v15
  v_alignbyte_b32 v34, v115, v114, v15
  v_alignbyte_b32 v35, v116, v115, v15
  ds_read_b64 v[84:85], v8
  ds_read_b64 v[86:87], v9
  v_mfma_f32_16x16x32_bf16 a[108:111], v[28:31], v[60:63], a[108:111]
  s_waitcnt lgkmcnt(8)
  v_alignbyte_b32 v36, v119, v118, v15
  v_alignbyte_b32 v37, v120, v119, v15
  v_alignbyte_b32 v38, v121, v120, v15
  v_alignbyte_b32 v39, v122, v121, v15
  v_mfma_f32_16x16x32_bf16 a[140:143], v[32:35], v[64:67], a[140:143]
  s_waitcnt lgkmcnt(5)
  v_alignbyte_b32 v40, v125, v124, v15
  v_alignbyte_b32 v41, v126, v125, v15
  v_alignbyte_b32 v42, v127, v126, v15
  v_alignbyte_b32 v43, v128, v127, v15
  v_mfma_f32_16x16x32_bf16 a[172:175], v[36:39], v[68:71], a[172:175]
  s_waitcnt lgkmcnt(2)
  v_alignbyte_b32 v44, v131, v130, v15
  v_alignbyte_b32 v45, v132, v131, v15
  v_alignbyte_b32 v46, v133, v132, v15
  v_alignbyte_b32 v47, v134, v133, v15
  v_mfma_f32_16x16x32_bf16 a[204:207], v[40:43], v[72:75], a[204:207]
  s_nop 0
  v_mfma_f32_16x16x32_bf16 a[236:239], v[44:47], v[76:79], a[236:239]
  s_waitcnt lgkmcnt(0)
  ds_read_b128 v[48:51], v4 offset:1536
  ds_read_b128 v[52:55], v4 offset:6144
  ds_read_b128 v[56:59], v4 offset:10752
  ds_read_b128 v[60:63], v4 offset:15360
  ds_read_b128 v[64:67], v4 offset:19968
  ds_read_b128 v[68:71], v4 offset:24576
  ds_read_b128 v[72:75], v4 offset:29184
  ds_read_b128 v[76:79], v4 offset:33792
  s_mov_b32 exec_lo, s42
  s_mov_b32 exec_hi, s42
  ds_write_b128 v6, a[12:15] offset:0
  ds_write_b128 v6, a[44:47] offset:128
  ds_write_b128 v6, a[76:79] offset:256
  ds_write_b128 v6, a[108:111] offset:384
  ds_write_b128 v6, a[140:143] offset:512
  ds_write_b128 v6, a[172:175] offset:640
  ds_write_b128 v6, a[204:207] offset:768
  ds_write_b128 v6, a[236:239] offset:896
  s_mov_b64 exec, -1
  ds_read_b128 v[80:83], v7
  ds_write_b32 v14, v13 offset:8
  v_lshlrev_b32 v88, 16, v84
  v_and_b32 v89, 0xffff0000, v84
  v_lshlrev_b32 v90, 16, v85
  v_and_b32 v91, 0xffff0000, v85
  v_lshlrev_b32 v96, 16, v86
  v_and_b32 v97, 0xffff0000, v86
  v_lshlrev_b32 v98, 16, v87
  v_and_b32 v99, 0xffff0000, v87
  v_mul_f32 v92, v88, v12
  v_mul_f32 v93, v89, v12
  v_mul_f32 v94, v90, v12
  v_mul_f32 v95, v91, v12
  v_cvt_pk_bf16_f32 v84, v92, v93
  v_cvt_pk_bf16_f32 v85, v94, v95
  v_lshlrev_b32 v92, 16, v84
  v_and_b32 v93, 0xffff0000, v84
  v_lshlrev_b32 v94, 16, v85
  v_and_b32 v95, 0xffff0000, v85
  s_waitcnt lgkmcnt(1)
  v_fmac_f32 v80, v88, v11
  v_fmac_f32 v81, v89, v11
  v_fmac_f32 v82, v90, v11
  v_fmac_f32 v83, v91, v11
  v_cvt_pk_bf16_f32 v84, v80, v81
  v_cvt_pk_bf16_f32 v85, v82, v83
  v_lshlrev_b32 v80, 16, v84
  v_and_b32 v81, 0xffff0000, v84
  v_lshlrev_b32 v82, 16, v85
  v_and_b32 v83, 0xffff0000, v85
  v_add_f32 v80, v80, v92
  v_add_f32 v81, v81, v93
  v_add_f32 v82, v82, v94
  v_add_f32 v83, v83, v95
  v_cvt_pk_bf16_f32 v84, v80, v81
  v_cvt_pk_bf16_f32 v85, v82, v83
  v_lshlrev_b32 v80, 16, v84
  v_and_b32 v81, 0xffff0000, v84
  v_lshlrev_b32 v82, 16, v85
  v_and_b32 v83, 0xffff0000, v85
  v_add_f32 v80, v80, v96
  v_add_f32 v81, v81, v97
  v_add_f32 v82, v82, v98
  v_add_f32 v83, v83, v99
  v_cvt_pk_bf16_f32 v84, v80, v81
  v_cvt_pk_bf16_f32 v85, v82, v83
  buffer_store_dwordx2 v[84:85], v10, s[8:11], s40 offen sc1
  v_mfma_f32_16x16x32_bf16 a[16:19], v[16:19], v[48:51], a[16:19]
  ds_read_b128 v[48:51], v4 offset:1024
  v_mfma_f32_16x16x32_bf16 a[48:51], v[20:23], v[52:55], a[48:51]
  ds_read_b128 v[52:55], v4 offset:5632
  v_mfma_f32_16x16x32_bf16 a[80:83], v[24:27], v[56:59], a[80:83]
  ds_read_b128 v[56:59], v4 offset:10240
  v_mfma_f32_16x16x32_bf16 a[112:115], v[28:31], v[60:63], a[112:115]
  ds_read_b128 v[60:63], v4 offset:14848
  v_mfma_f32_16x16x32_bf16 a[144:147], v[32:35], v[64:67], a[144:147]
  ds_read_b128 v[64:67], v4 offset:19456
  v_mfma_f32_16x16x32_bf16 a[176:179], v[36:39], v[68:71], a[176:179]
  ds_read_b128 v[68:71], v4 offset:24064
  v_mfma_f32_16x16x32_bf16 a[208:211], v[40:43], v[72:75], a[208:211]
  ds_read_b128 v[72:75], v4 offset:28672
  v_mfma_f32_16x16x32_bf16 a[240:243], v[44:47], v[76:79], a[240:243]
  ds_read_b128 v[76:79], v4 offset:33280
  s_waitcnt lgkmcnt(7)
  v_mfma_f32_16x16x32_bf16 a[20:23], v[16:19], v[48:51], a[20:23]
  ds_read_b128 v[48:51], v4 offset:512
  s_waitcnt lgkmcnt(7)
  v_mfma_f32_16x16x32_bf16 a[52:55], v[20:23], v[52:55], a[52:55]
  ds_read_b128 v[52:55], v4 offset:5120
  s_waitcnt lgkmcnt(7)
  v_mfma_f32_16x16x32_bf16 a[84:87], v[24:27], v[56:59], a[84:87]
  ds_read_b128 v[56:59], v4 offset:9728
  s_waitcnt lgkmcnt(7)
  v_mfma_f32_16x16x32_bf16 a[116:119], v[28:31], v[60:63], a[116:119]
  ds_read_b128 v[60:63], v4 offset:14336
  s_waitcnt lgkmcnt(7)
  v_mfma_f32_16x16x32_bf16 a[148:151], v[32:35], v[64:67], a[148:151]
  ds_read_b128 v[64:67], v4 offset:18944
  s_waitcnt lgkmcnt(7)
  v_mfma_f32_16x16x32_bf16 a[180:183], v[36:39], v[68:71], a[180:183]
  ds_read_b128 v[68:71], v4 offset:23552
  s_waitcnt lgkmcnt(7)
  v_mfma_f32_16x16x32_bf16 a[212:215], v[40:43], v[72:75], a[212:215]
  ds_read_b128 v[72:75], v4 offset:28160
  s_waitcnt lgkmcnt(7)
  v_mfma_f32_16x16x32_bf16 a[244:247], v[44:47], v[76:79], a[244:247]
  ds_read_b128 v[76:79], v4 offset:32768
  s_waitcnt lgkmcnt(7)
  v_mfma_f32_16x16x32_bf16 a[24:27], v[16:19], v[48:51], a[24:27]
  ds_read_b128 v[48:51], v4 offset:0
  s_waitcnt lgkmcnt(7)
  v_mfma_f32_16x16x32_bf16 a[56:59], v[20:23], v[52:55], a[56:59]
  ds_read_b128 v[52:55], v4 offset:4608
  s_waitcnt lgkmcnt(7)
  v_mfma_f32_16x16x32_bf16 a[88:91], v[24:27], v[56:59], a[88:91]
  ds_read_b128 v[56:59], v4 offset:9216
  s_waitcnt lgkmcnt(7)
  v_mfma_f32_16x16x32_bf16 a[120:123], v[28:31], v[60:63], a[120:123]
  ds_read_b128 v[60:63], v4 offset:13824
  s_waitcnt lgkmcnt(7)
  v_mfma_f32_16x16x32_bf16 a[152:155], v[32:35], v[64:67], a[152:155]
  ds_read_b128 v[64:67], v4 offset:18432
  s_waitcnt lgkmcnt(7)
  v_mfma_f32_16x16x32_bf16 a[184:187], v[36:39], v[68:71], a[184:187]
  ds_read_b128 v[68:71], v4 offset:23040
  s_waitcnt lgkmcnt(7)
  v_mfma_f32_16x16x32_bf16 a[216:219], v[40:43], v[72:75], a[216:219]
  ds_read_b128 v[72:75], v4 offset:27648
  s_waitcnt lgkmcnt(7)
  v_mfma_f32_16x16x32_bf16 a[248:251], v[44:47], v[76:79], a[248:251]
  ds_read_b128 v[76:79], v4 offset:32256
  s_waitcnt lgkmcnt(7)
  v_mfma_f32_16x16x32_bf16 a[28:31], v[16:19], v[48:51], a[28:31]
  s_waitcnt lgkmcnt(6)
  v_mfma_f32_16x16x32_bf16 a[60:63], v[20:23], v[52:55], a[60:63]
  s_waitcnt lgkmcnt(5)
  v_mfma_f32_16x16x32_bf16 a[92:95], v[24:27], v[56:59], a[92:95]
  s_waitcnt lgkmcnt(4)
  v_mfma_f32_16x16x32_bf16 a[124:127], v[28:31], v[60:63], a[124:127]
  s_waitcnt lgkmcnt(3)
  v_mfma_f32_16x16x32_bf16 a[156:159], v[32:35], v[64:67], a[156:159]
  s_waitcnt lgkmcnt(2)
  v_mfma_f32_16x16x32_bf16 a[188:191], v[36:39], v[68:71], a[188:191]
  s_waitcnt lgkmcnt(1)
  v_mfma_f32_16x16x32_bf16 a[220:223], v[40:43], v[72:75], a[220:223]
  s_waitcnt lgkmcnt(0)
  v_mfma_f32_16x16x32_bf16 a[252:255], v[44:47], v[76:79], a[252:255]
  v_add_u32 v104, 64, v104
  v_add_u32 v105, 64, v105
  v_add_u32 v106, 64, v106
  v_add_u32 v107, 64, v107
  v_add_u32 v108, 64, v108
  v_add_u32 v109, 64, v109
  v_add_u32 v110, 64, v110
  v_add_u32 v111, 64, v111
  v_add_u32 v4, 64, v4
  v_add_u32 v8, 64, v8
  s_add_u32 s40, s40, 0x8000
  s_waitcnt vmcnt(0)
  s_mov_b64 exec, 1
  buffer_store_dword v13, v1, s[8:11], s39 offen sc1
  s_mov_b64 exec, -1
  ds_write_b32 v14, v13 offset:16
  s_add_u32 s32, s32, 1
  s_and_b32 s6, s32, 7
  s_cbranch_scc1 L_c_conv3
L_c_conv4:
  s_add_u32 s33, s32, 1
  s_and_b32 s6, s32, 7
  s_lshl_b32 s7, s6, 10
  s_add_u32 s7, s7, s35
  v_add_u32 v9, s7, v10
  s_lshl_b32 s6, s6, 1
  s_lshl_b32 s42, 0x30003, s6
  v_mov_b32 v13, s33
  ds_read_b128 v[48:51], v4 offset:1536
  ds_read_b128 v[52:55], v4 offset:6144
  ds_read_b128 v[56:59], v4 offset:10752
  ds_read_b128 v[60:63], v4 offset:15360
  ds_read_b128 v[64:67], v4 offset:19968
  ds_read_b128 v[68:71], v4 offset:24576
  ds_read_b128 v[72:75], v4 offset:29184
  ds_read_b128 v[76:79], v4 offset:33792
  s_mov_b32 s7, 0
L_lw_128:
  ds_read_b32 v88, v2 offset:0
  s_waitcnt lgkmcnt(0)
  v_cmp_gt_i32 vcc, s33, v88
  s_cbranch_vccz L_lwo_129
  s_add_u32 s7, s7, 1
  s_cmp_lt_u32 s7, 131072
  s_cbranch_scc1 L_lw_128
  s_mov_b32 s6, 42
  s_branch L_err
L_lwo_129:
  ds_read2_b32 v[112:113], v104 offset0:0 offset1:1
  ds_read2_b32 v[114:115], v104 offset0:2 offset1:3
  ds_read_b32 v116, v104 offset:16
  ds_read2_b32 v[118:119], v105 offset0:0 offset1:1
  ds_read2_b32 v[120:121], v105 offset0:2 offset1:3
  ds_read_b32 v122, v105 offset:16
  ds_read2_b32 v[124:125], v106 offset0:0 offset1:1
  ds_read2_b32 v[126:127], v106 offset0:2 offset1:3
  ds_read_b32 v128, v106 offset:16
  ds_read2_b32 v[130:131], v107 offset0:0 offset1:1
  ds_read2_b32 v[132:133], v107 offset0:2 offset1:3
  ds_read_b32 v134, v107 offset:16
  s_waitcnt lgkmcnt(9)
  v_alignbyte_b32 v16, v113, v112, v15
  v_alignbyte_b32 v17, v114, v113, v15
  v_alignbyte_b32 v18, v115, v114, v15
  v_alignbyte_b32 v19, v116, v115, v15
  ds_read2_b32 v[112:113], v108 offset0:0 offset1:1
  ds_read2_b32 v[114:115], v108 offset0:2 offset1:3
  ds_read_b32 v116, v108 offset:16
  s_waitcnt lgkmcnt(9)
  v_alignbyte_b32 v20, v119, v118, v15
  v_alignbyte_b32 v21, v120, v119, v15
  v_alignbyte_b32 v22, v121, v120, v15
  v_alignbyte_b32 v23, v122, v121, v15
  ds_read2_b32 v[118:119], v109 offset0:0 offset1:1
  ds_read2_b32 v[120:121], v109 offset0:2 offset1:3
  ds_read_b32 v122, v109 offset:16
  v_mfma_f32_16x16x32_bf16 a[16:19], v[16:19], v[48:51], a[16:19]
  s_waitcnt lgkmcnt(9)
  v_alignbyte_b32 v24, v125, v124, v15
  v_alignbyte_b32 v25, v126, v125, v15
  v_alignbyte_b32 v26, v127, v126, v15
  v_alignbyte_b32 v27, v128, v127, v15
  ds_read2_b32 v[124:125], v110 offset0:0 offset1:1
  ds_read2_b32 v[126:127], v110 offset0:2 offset1:3
  ds_read_b32 v128, v110 offset:16
  v_mfma_f32_16x16x32_bf16 a[48:51], v[20:23], v[52:55], a[48:51]
  s_waitcnt lgkmcnt(9)
  v_alignbyte_b32 v28, v131, v130, v15
  v_alignbyte_b32 v29, v132, v131, v15
  v_alignbyte_b32 v30, v133, v132, v15
  v_alignbyte_b32 v31, v134, v133, v15
  ds_read2_b32 v[130:131], v111 offset0:0 offset1:1
  ds_read2_b32 v[132:133], v111 offset0:2 offset1:3
  ds_read_b32 v134, v111 offset:16
  v_mfma_f32_16x16x32_bf16 a[80:83], v[24:27], v[56:59], a[80:83]
  s_waitcnt lgkmcnt(9)
  v_alignbyte_b32 v32, v113, v112, v15
  v_alignbyte_b32 v33, v114, v113, v15
  v_alignbyte_b32 v34, v115, v114, v15
  v_alignbyte_b32 v35, v116, v115, v15
  ds_read_b64 v[84:85], v8
  ds_read_b64 v[86:87], v9
  v_mfma_f32_16x16x32_bf16 a[112:115], v[28:31], v[60:63], a[112:115]
  s_waitcnt lgkmcnt(8)
  v_alignbyte_b32 v36, v119, v118, v15
  v_alignbyte_b32 v37, v120, v119, v15
  v_alignbyte_b32 v38, v121, v120, v15
  v_alignbyte_b32 v39, v122, v121, v15
  v_mfma_f32_16x16x32_bf16 a[144:147], v[32:35], v[64:67], a[144:147]
  s_waitcnt lgkmcnt(5)
  v_alignbyte_b32 v40, v125, v124, v15
  v_alignbyte_b32 v41, v126, v125, v15
  v_alignbyte_b32 v42, v127, v126, v15
  v_alignbyte_b32 v43, v128, v127, v15
  v_mfma_f32_16x16x32_bf16 a[176:179], v[36:39], v[68:71], a[176:179]
  s_waitcnt lgkmcnt(2)
  v_alignbyte_b32 v44, v131, v130, v15
  v_alignbyte_b32 v45, v132, v131, v15
  v_alignbyte_b32 v46, v133, v132, v15
  v_alignbyte_b32 v47, v134, v133, v15
  v_mfma_f32_16x16x32_bf16 a[208:211], v[40:43], v[72:75], a[208:211]
  s_nop 0
  v_mfma_f32_16x16x32_bf16 a[240:243], v[44:47], v[76:79], a[240:243]
  s_waitcnt lgkmcnt(0)
  ds_read_b128 v[48:51], v4 offset:1024
  ds_read_b128 v[52:55], v4 offset:5632
  ds_read_b128 v[56:59], v4 offset:10240
  ds_read_b128 v[60:63], v4 offset:14848
  ds_read_b128 v[64:67], v4 offset:19456
  ds_read_b128 v[68:71], v4 offset:24064
  ds_read_b128 v[72:75], v4 offset:28672
  ds_read_b128 v[76:79], v4 offset:33280
  s_mov_b32 exec_lo, s42
  s_mov_b32 exec_hi, s42
  ds_write_b128 v6, a[16:19] offset:0
  ds_write_b128 v6, a[48:51] offset:128
  ds_write_b128 v6, a[80:83] offset:256
  ds_write_b128 v6, a[112:115] offset:384
  ds_write_b128 v6, a[144:147] offset:512
  ds_write_b128 v6, a[176:179] offset:640
  ds_write_b128 v6, a[208:211] offset:768
  ds_write_b128 v6, a[240:243] offset:896
  s_mov_b64 exec, -1
  ds_read_b128 v[80:83], v7
  ds_write_b32 v14, v13 offset:8
  v_lshlrev_b32 v88, 16, v84
  v_and_b32 v89, 0xffff0000, v84
  v_lshlrev_b32 v90, 16, v85
  v_and_b32 v91, 0xffff0000, v85
  v_lshlrev_b32 v96, 16, v86
  v_and_b32 v97, 0xffff0000, v86
  v_lshlrev_b32 v98, 16, v87
  v_and_b32 v99, 0xffff0000, v87
  v_mul_f32 v92, v88, v12
  v_mul_f32 v93, v89, v12
  v_mul_f32 v94, v90, v12
  v_mul_f32 v95, v91, v12
  v_cvt_pk_bf16_f32 v84, v92, v93
  v_cvt_pk_bf16_f32 v85, v94, v95
  v_lshlrev_b32 v92, 16, v84
  v_and_b32 v93, 0xffff0000, v84
  v_lshlrev_b32 v94, 16, v85
  v_and_b32 v95, 0xffff0000, v85
  s_waitcnt lgkmcnt(1)
  v_fmac_f32 v80, v88, v11
  v_fmac_f32 v81, v89, v11
  v_fmac_f32 v82, v90, v11
  v_fmac_f32 v83, v91, v11
  v_cvt_pk_bf16_f32 v84, v80, v81
  v_cvt_pk_bf16_f32 v85, v82, v83
  v_lshlrev_b32 v80, 16, v84
  v_and_b32 v81, 0xffff0000, v84
  v_lshlrev_b32 v82, 16, v85
  v_and_b32 v83, 0xffff0000, v85
  v_add_f32 v80, v80, v92
  v_add_f32 v81, v81, v93
  v_add_f32 v82, v82, v94
  v_add_f32 v83, v83, v95
  v_cvt_pk_bf16_f32 v84, v80, v81
  v_cvt_pk_bf16_f32 v85, v82, v83
  v_lshlrev_b32 v80, 16, v84
  v_and_b32 v81, 0xffff0000, v84
  v_lshlrev_b32 v82, 16, v85
  v_and_b32 v83, 0xffff0000, v85
  v_add_f32 v80, v80, v96
  v_add_f32 v81, v81, v97
  v_add_f32 v82, v82, v98
  v_add_f32 v83, v83, v99
  v_cvt_pk_bf16_f32 v84, v80, v81
  v_cvt_pk_bf16_f32 v85, v82, v83
  buffer_store_dwordx2 v[84:85], v10, s[8:11], s40 offen sc1
  v_mfma_f32_16x16x32_bf16 a[20:23], v[16:19], v[48:51], a[20:23]
  ds_read_b128 v[48:51], v4 offset:512
  v_mfma_f32_16x16x32_bf16 a[52:55], v[20:23], v[52:55], a[52:55]
  ds_read_b128 v[52:55], v4 offset:5120
  v_mfma_f32_16x16x32_bf16 a[84:87], v[24:27], v[56:59], a[84:87]
  ds_read_b128 v[56:59], v4 offset:9728
  v_mfma_f32_16x16x32_bf16 a[116:119], v[28:31], v[60:63], a[116:119]
  ds_read_b128 v[60:63], v4 offset:14336
  v_mfma_f32_16x16x32_bf16 a[148:151], v[32:35], v[64:67], a[148:151]
  ds_read_b128 v[64:67], v4 offset:18944
  v_mfma_f32_16x16x32_bf16 a[180:183], v[36:39], v[68:71], a[180:183]
  ds_read_b128 v[68:71], v4 offset:23552
  v_mfma_f32_16x16x32_bf16 a[212:215], v[40:43], v[72:75], a[212:215]
  ds_read_b128 v[72:75], v4 offset:28160
  v_mfma_f32_16x16x32_bf16 a[244:247], v[44:47], v[76:79], a[244:247]
  ds_read_b128 v[76:79], v4 offset:32768
  s_waitcnt lgkmcnt(7)
  v_mfma_f32_16x16x32_bf16 a[24:27], v[16:19], v[48:51], a[24:27]
  ds_read_b128 v[48:51], v4 offset:0
  s_waitcnt lgkmcnt(7)
  v_mfma_f32_16x16x32_bf16 a[56:59], v[20:23], v[52:55], a[56:59]
  ds_read_b128 v[52:55], v4 offset:4608
  s_waitcnt lgkmcnt(7)
  v_mfma_f32_16x16x32_bf16 a[88:91], v[24:27], v[56:59], a[88:91]
  ds_read_b128 v[56:59], v4 offset:9216
  s_waitcnt lgkmcnt(7)
  v_mfma_f32_16x16x32_bf16 a[120:123], v[28:31], v[60:63], a[120:123]
  ds_read_b128 v[60:63], v4 offset:13824
  s_waitcnt lgkmcnt(7)
  v_mfma_f32_16x16x32_bf16 a[152:155], v[32:35], v[64:67], a[152:155]
  ds_read_b128 v[64:67], v4 offset:18432
  s_waitcnt lgkmcnt(7)
  v_mfma_f32_16x16x32_bf16 a[184:187], v[36:39], v[68:71], a[184:187]
  ds_read_b128 v[68:71], v4 offset:23040
  s_waitcnt lgkmcnt(7)
  v_mfma_f32_16x16x32_bf16 a[216:219], v[40:43], v[72:75], a[216:219]
  ds_read_b128 v[72:75], v4 offset:27648
  s_waitcnt lgkmcnt(7)
  v_mfma_f32_16x16x32_bf16 a[248:251], v[44:47], v[76:79], a[248:251]
  ds_read_b128 v[76:79], v4 offset:32256
  s_waitcnt lgkmcnt(7)
  v_mfma_f32_16x16x32_bf16 a[28:31], v[16:19], v[48:51], a[28:31]
  s_waitcnt lgkmcnt(6)
  v_mfma_f32_16x16x32_bf16 a[60:63], v[20:23], v[52:55], a[60:63]
  s_waitcnt lgkmcnt(5)
  v_mfma_f32_16x16x32_bf16 a[92:95], v[24:27], v[56:59], a[92:95]
  s_waitcnt lgkmcnt(4)
  v_mfma_f32_16x16x32_bf16 a[124:127], v[28:31], v[60:63], a[124:127]
  s_waitcnt lgkmcnt(3)
  v_mfma_f32_16x16x32_bf16 a[156:159], v[32:35], v[64:67], a[156:159]
  s_waitcnt lgkmcnt(2)
  v_mfma_f32_16x16x32_bf16 a[188:191], v[36:39], v[68:71], a[188:191]
  s_waitcnt lgkmcnt(1)
  v_mfma_f32_16x16x32_bf16 a[220:223], v[40:43], v[72:75], a[220:223]
  s_waitcnt lgkmcnt(0)
  v_mfma_f32_16x16x32_bf16 a[252:255], v[44:47], v[76:79], a[252:255]
  v_add_u32 v104, 64, v104
  v_add_u32 v105, 64, v105
  v_add_u32 v106, 64, v106
  v_add_u32 v107, 64, v107
  v_add_u32 v108, 64, v108
  v_add_u32 v109, 64, v109
  v_add_u32 v110, 64, v110
  v_add_u32 v111, 64, v111
  v_add_u32 v4, 64, v4
  v_add_u32 v8, 64, v8
  s_add_u32 s40, s40, 0x8000
  s_waitcnt vmcnt(0)
  s_mov_b64 exec, 1
  buffer_store_dword v13, v1, s[8:11], s39 offen sc1
  s_mov_b64 exec, -1
  ds_write_b32 v14, v13 offset:16
  s_add_u32 s32, s32, 1
  s_and_b32 s6, s32, 7
  s_cbranch_scc1 L_c_conv4
L_c_conv5:
  s_add_u32 s33, s32, 1
  s_and_b32 s6, s32, 7
  s_lshl_b32 s7, s6, 10
  s_add_u32 s7, s7, s35
  v_add_u32 v9, s7, v10
  s_lshl_b32 s6, s6, 1
  s_lshl_b32 s42, 0x30003, s6
  v_mov_b32 v13, s33
  ds_read_b128 v[48:51], v4 offset:1024
  ds_read_b128 v[52:55], v4 offset:5632
  ds_read_b128 v[56:59], v4 offset:10240
  ds_read_b128 v[60:63], v4 offset:14848
  ds_read_b128 v[64:67], v4 offset:19456
  ds_read_b128 v[68:71], v4 offset:24064
  ds_read_b128 v[72:75], v4 offset:28672
  ds_read_b128 v[76:79], v4 offset:33280
  s_mov_b32 s7, 0
L_lw_130:
  ds_read_b32 v88, v2 offset:0
  s_waitcnt lgkmcnt(0)
  v_cmp_gt_i32 vcc, s33, v88
  s_cbranch_vccz L_lwo_131
  s_add_u32 s7, s7, 1
  s_cmp_lt_u32 s7, 131072
  s_cbranch_scc1 L_lw_130
  s_mov_b32 s6, 42
  s_branch L_err
L_lwo_131:
  ds_read2_b32 v[112:113], v104 offset0:0 offset1:1
  ds_read2_b32 v[114:115], v104 offset0:2 offset1:3
  ds_read_b32 v116, v104 offset:16
  ds_read2_b32 v[118:119], v105 offset0:0 offset1:1
  ds_read2_b32 v[120:121], v105 offset0:2 offset1:3
  ds_read_b32 v122, v105 offset:16
  ds_read2_b32 v[124:125], v106 offset0:0 offset1:1
  ds_read2_b32 v[126:127], v106 offset0:2 offset1:3
  ds_read_b32 v128, v106 offset:16
  ds_read2_b32 v[130:131], v107 offset0:0 offset1:1
  ds_read2_b32 v[132:133], v107 offset0:2 offset1:3
  ds_read_b32 v134, v107 offset:16
  s_waitcnt lgkmcnt(9)
  v_alignbyte_b32 v16, v113, v112, v15
  v_alignbyte_b32 v17, v114, v113, v15
  v_alignbyte_b32 v18, v115, v114, v15
  v_alignbyte_b32 v19, v116, v115, v15
  ds_read2_b32 v[112:113], v108 offset0:0 offset1:1
  ds_read2_b32 v[114:115], v108 offset0:2 offset1:3
  ds_read_b32 v116, v108 offset:16
  s_waitcnt lgkmcnt(9)
  v_alignbyte_b32 v20, v119, v118, v15
  v_alignbyte_b32 v21, v120, v119, v15
  v_alignbyte_b32 v22, v121, v120, v15
  v_alignbyte_b32 v23, v122, v121, v15
  ds_read2_b32 v[118:119], v109 offset0:0 offset1:1
  ds_read2_b32 v[120:121], v109 offset0:2 offset1:3
  ds_read_b32 v122, v109 offset:16
  v_mfma_f32_16x16x32_bf16 a[20:23], v[16:19], v[48:51], a[20:23]
  s_waitcnt lgkmcnt(9)
  v_alignbyte_b32 v24, v125, v124, v15
  v_alignbyte_b32 v25, v126, v125, v15
  v_alignbyte_b32 v26, v127, v126, v15
  v_alignbyte_b32 v27, v128, v127, v15
  ds_read2_b32 v[124:125], v110 offset0:0 offset1:1
  ds_read2_b32 v[126:127], v110 offset0:2 offset1:3
  ds_read_b32 v128, v110 offset:16
  v_mfma_f32_16x16x32_bf16 a[52:55], v[20:23], v[52:55], a[52:55]
  s_waitcnt lgkmcnt(9)
  v_alignbyte_b32 v28, v131, v130, v15
  v_alignbyte_b32 v29, v132, v131, v15
  v_alignbyte_b32 v30, v133, v132, v15
  v_alignbyte_b32 v31, v134, v133, v15
  ds_read2_b32 v[130:131], v111 offset0:0 offset1:1
  ds_read2_b32 v[132:133], v111 offset0:2 offset1:3
  ds_read_b32 v134, v111 offset:16
  v_mfma_f32_16x16x32_bf16 a[84:87], v[24:27], v[56:59], a[84:87]
  s_waitcnt lgkmcnt(9)
  v_alignbyte_b32 v32, v113, v112, v15
  v_alignbyte_b32 v33, v114, v113, v15
  v_alignbyte_b32 v34, v115, v114, v15
  v_alignbyte_b32 v35, v116, v115, v15
  ds_read_b64 v[84:85], v8
  ds_read_b64 v[86:87], v9
  v_mfma_f32_16x16x32_bf16 a[116:119], v[28:31], v[60:63], a[116:119]
  s_waitcnt lgkmcnt(8)
  v_alignbyte_b32 v36, v119, v118, v15
  v_alignbyte_b32 v37, v120, v119, v15
  v_alignbyte_b32 v38, v121, v120, v15
  v_alignbyte_b32 v39, v122, v121, v15
  v_mfma_f32_16x16x32_bf16 a[148:151], v[32:35], v[64:67], a[148:151]
  s_waitcnt lgkmcnt(5)
  v_alignbyte_b32 v40, v125, v124, v15
  v_alignbyte_b32 v41, v126, v125, v15
  v_alignbyte_b32 v42, v127, v126, v15
  v_alignbyte_b32 v43, v128, v127, v15
  v_mfma_f32_16x16x32_bf16 a[180:183], v[36:39], v[68:71], a[180:183]
  s_waitcnt lgkmcnt(2)
  v_alignbyte_b32 v44, v131, v130, v15
  v_alignbyte_b32 v45, v132, v131, v15
  v_alignbyte_b32 v46, v133, v132, v15
  v_alignbyte_b32 v47, v134, v133, v15
  v_mfma_f32_16x16x32_bf16 a[212:215], v[40:43], v[72:75], a[212:215]
  s_nop 0
  v_mfma_f32_16x16x32_bf16 a[244:247], v[44:47], v[76:79], a[244:247]
  s_waitcnt lgkmcnt(0)
  ds_read_b128 v[48:51], v4 offset:512
  ds_read_b128 v[52:55], v4 offset:5120
  ds_read_b128 v[56:59], v4 offset:9728
  ds_read_b128 v[60:63], v4 offset:14336
  ds_read_b128 v[64:67], v4 offset:18944
  ds_read_b128 v[68:71], v4 offset:23552
  ds_read_b128 v[72:75], v4 offset:28160
  ds_read_b128 v[76:79], v4 offset:32768
  s_mov_b32 exec_lo, s42
  s_mov_b32 exec_hi, s42
  ds_write_b128 v6, a[20:23] offset:0
  ds_write_b128 v6, a[52:55] offset:128
  ds_write_b128 v6, a[84:87] offset:256
  ds_write_b128 v6, a[116:119] offset:384
  ds_write_b128 v6, a[148:151] offset:512
  ds_write_b128 v6, a[180:183] offset:640
  ds_write_b128 v6, a[212:215] offset:768
  ds_write_b128 v6, a[244:247] offset:896
  s_mov_b64 exec, -1
  ds_read_b128 v[80:83], v7
  ds_write_b32 v14, v13 offset:8
  v_lshlrev_b32 v88, 16, v84
  v_and_b32 v89, 0xffff0000, v84
  v_lshlrev_b32 v90, 16, v85
  v_and_b32 v91, 0xffff0000, v85
  v_lshlrev_b32 v96, 16, v86
  v_and_b32 v97, 0xffff0000, v86
  v_lshlrev_b32 v98, 16, v87
  v_and_b32 v99, 0xffff0000, v87
  v_mul_f32 v92, v88, v12
  v_mul_f32 v93, v89, v12
  v_mul_f32 v94, v90, v12
  v_mul_f32 v95, v91, v12
  v_cvt_pk_bf16_f32 v84, v92, v93
  v_cvt_pk_bf16_f32 v85, v94, v95
  v_lshlrev_b32 v92, 16, v84
  v_and_b32 v93, 0xffff0000, v84
  v_lshlrev_b32 v94, 16, v85
  v_and_b32 v95, 0xffff0000, v85
  s_waitcnt lgkmcnt(1)
  v_fmac_f32 v80, v88, v11
  v_fmac_f32 v81, v89, v11
  v_fmac_f32 v82, v90, v11
  v_fmac_f32 v83, v91, v11
  v_cvt_pk_bf16_f32 v84, v80, v81
  v_cvt_pk_bf16_f32 v85, v82, v83
  v_lshlrev_b32 v80, 16, v84
  v_and_b32 v81, 0xffff0000, v84
  v_lshlrev_b32 v82, 16, v85
  v_and_b32 v83, 0xffff0000, v85
  v_add_f32 v80, v80, v92
  v_add_f32 v81, v81, v93
  v_add_f32 v82, v82, v94
  v_add_f32 v83, v83, v95
  v_cvt_pk_bf16_f32 v84, v80, v81
  v_cvt_pk_bf16_f32 v85, v82, v83
  v_lshlrev_b32 v80, 16, v84
  v_and_b32 v81, 0xffff0000, v84
  v_lshlrev_b32 v82, 16, v85
  v_and_b32 v83, 0xffff0000, v85
  v_add_f32 v80, v80, v96
  v_add_f32 v81, v81, v97
  v_add_f32 v82, v82, v98
  v_add_f32 v83, v83, v99
  v_cvt_pk_bf16_f32 v84, v80, v81
  v_cvt_pk_bf16_f32 v85, v82, v83
  buffer_store_dwordx2 v[84:85], v10, s[8:11], s40 offen sc1
  v_mfma_f32_16x16x32_bf16 a[24:27], v[16:19], v[48:51], a[24:27]
  ds_read_b128 v[48:51], v4 offset:0
  v_mfma_f32_16x16x32_bf16 a[56:59], v[20:23], v[52:55], a[56:59]
  ds_read_b128 v[52:55], v4 offset:4608
  v_mfma_f32_16x16x32_bf16 a[88:91], v[24:27], v[56:59], a[88:91]
  ds_read_b128 v[56:59], v4 offset:9216
  v_mfma_f32_16x16x32_bf16 a[120:123], v[28:31], v[60:63], a[120:123]
  ds_read_b128 v[60:63], v4 offset:13824
  v_mfma_f32_16x16x32_bf16 a[152:155], v[32:35], v[64:67], a[152:155]
  ds_read_b128 v[64:67], v4 offset:18432
  v_mfma_f32_16x16x32_bf16 a[184:187], v[36:39], v[68:71], a[184:187]
  ds_read_b128 v[68:71], v4 offset:23040
  v_mfma_f32_16x16x32_bf16 a[216:219], v[40:43], v[72:75], a[216:219]
  ds_read_b128 v[72:75], v4 offset:27648
  v_mfma_f32_16x16x32_bf16 a[248:251], v[44:47], v[76:79], a[248:251]
  ds_read_b128 v[76:79], v4 offset:32256
  s_waitcnt lgkmcnt(7)
  v_mfma_f32_16x16x32_bf16 a[28:31], v[16:19], v[48:51], a[28:31]
  s_waitcnt lgkmcnt(6)
  v_mfma_f32_16x16x32_bf16 a[60:63], v[20:23], v[52:55], a[60:63]
  s_waitcnt lgkmcnt(5)
  v_mfma_f32_16x16x32_bf16 a[92:95], v[24:27], v[56:59], a[92:95]
  s_waitcnt lgkmcnt(4)
  v_mfma_f32_16x16x32_bf16 a[124:127], v[28:31], v[60:63], a[124:127]
  s_waitcnt lgkmcnt(3)
  v_mfma_f32_16x16x32_bf16 a[156:159], v[32:35], v[64:67], a[156:159]
  s_waitcnt lgkmcnt(2)
  v_mfma_f32_16x16x32_bf16 a[188:191], v[36:39], v[68:71], a[188:191]
  s_waitcnt lgkmcnt(1)
  v_mfma_f32_16x16x32_bf16 a[220:223], v[40:43], v[72:75], a[220:223]
  s_waitcnt lgkmcnt(0)
  v_mfma_f32_16x16x32_bf16 a[252:255], v[44:47], v[76:79], a[252:255]
  v_add_u32 v104, 64, v104
  v_add_u32 v105, 64, v105
  v_add_u32 v106, 64, v106
  v_add_u32 v107, 64, v107
  v_add_u32 v108, 64, v108
  v_add_u32 v109, 64, v109
  v_add_u32 v110, 64, v110
  v_add_u32 v111, 64, v111
  v_add_u32 v4, 64, v4
  v_add_u32 v8, 64, v8
  s_add_u32 s40, s40, 0x8000
  s_waitcnt vmcnt(0)
  s_mov_b64 exec, 1
  buffer_store_dword v13, v1, s[8:11], s39 offen sc1
  s_mov_b64 exec, -1
  ds_write_b32 v14, v13 offset:16
  s_add_u32 s32, s32, 1
  s_and_b32 s6, s32, 7
  s_cbranch_scc1 L_c_conv5
L_c_conv6:
  s_add_u32 s33, s32, 1
  s_and_b32 s6, s32, 7
  s_lshl_b32 s7, s6, 10
  s_add_u32 s7, s7, s35
  v_add_u32 v9, s7, v10
  s_lshl_b32 s6, s6, 1
  s_lshl_b32 s42, 0x30003, s6
  v_mov_b32 v13, s33
  ds_read_b128 v[48:51], v4 offset:512
  ds_read_b128 v[52:55], v4 offset:5120
  ds_read_b128 v[56:59], v4 offset:9728
  ds_read_b128 v[60:63], v4 offset:14336
  ds_read_b128 v[64:67], v4 offset:18944
  ds_read_b128 v[68:71], v4 offset:23552
  ds_read_b128 v[72:75], v4 offset:28160
  ds_read_b128 v[76:79], v4 offset:32768
  s_mov_b32 s7, 0
L_lw_132:
  ds_read_b32 v88, v2 offset:0
  s_waitcnt lgkmcnt(0)
  v_cmp_gt_i32 vcc, s33, v88
  s_cbranch_vccz L_lwo_133
  s_add_u32 s7, s7, 1
  s_cmp_lt_u32 s7, 131072
  s_cbranch_scc1 L_lw_132
  s_mov_b32 s6, 42
  s_branch L_err
L_lwo_133:
  ds_read2_b32 v[112:113], v104 offset0:0 offset1:1
  ds_read2_b32 v[114:115], v104 offset0:2 offset1:3
  ds_read_b32 v116, v104 offset:16
  ds_read2_b32 v[118:119], v105 offset0:0 offset1:1
  ds_read2_b32 v[120:121], v105 offset0:2 offset1:3
  ds_read_b32 v122, v105 offset:16
  ds_read2_b32 v[124:125], v106 offset0:0 offset1:1
  ds_read2_b32 v[126:127], v106 offset0:2 offset1:3
  ds_read_b32 v128, v106 offset:16
  ds_read2_b32 v[130:131], v107 offset0:0 offset1:1
  ds_read2_b32 v[132:133], v107 offset0:2 offset1:3
  ds_read_b32 v134, v107 offset:16
  s_waitcnt lgkmcnt(9)
  v_alignbyte_b32 v16, v113, v112, v15
  v_alignbyte_b32 v17, v114, v113, v15
  v_alignbyte_b32 v18, v115, v114, v15
  v_alignbyte_b32 v19, v116, v115, v15
  ds_read2_b32 v[112:113], v108 offset0:0 offset1:1
  ds_read2_b32 v[114:115], v108 offset0:2 offset1:3
  ds_read_b32 v116, v108 offset:16
  s_waitcnt lgkmcnt(9)
  v_alignbyte_b32 v20, v119, v118, v15
  v_alignbyte_b32 v21, v120, v119, v15
  v_alignbyte_b32 v22, v121, v120, v15
  v_alignbyte_b32 v23, v122, v121, v15
  ds_read2_b32 v[118:119], v109 offset0:0 offset1:1
  ds_read2_b32 v[120:121], v109 offset0:2 offset1:3
  ds_read_b32 v122, v109 offset:16
  v_mfma_f32_16x16x32_bf16 a[24:27], v[16:19], v[48:51], a[24:27]
  s_waitcnt lgkmcnt(9)
  v_alignbyte_b32 v24, v125, v124, v15
  v_alignbyte_b32 v25, v126, v125, v15
  v_alignbyte_b32 v26, v127, v126, v15
  v_alignbyte_b32 v27, v128, v127, v15
  ds_read2_b32 v[124:125], v110 offset0:0 offset1:1
  ds_read2_b32 v[126:127], v110 offset0:2 offset1:3
  ds_read_b32 v128, v110 offset:16
  v_mfma_f32_16x16x32_bf16 a[56:59], v[20:23], v[52:55], a[56:59]
  s_waitcnt lgkmcnt(9)
  v_alignbyte_b32 v28, v131, v130, v15
  v_alignbyte_b32 v29, v132, v131, v15
  v_alignbyte_b32 v30, v133, v132, v15
  v_alignbyte_b32 v31, v134, v133, v15
  ds_read2_b32 v[130:131], v111 offset0:0 offset1:1
  ds_read2_b32 v[132:133], v111 offset0:2 offset1:3
  ds_read_b32 v134, v111 offset:16
  v_mfma_f32_16x16x32_bf16 a[88:91], v[24:27], v[56:59], a[88:91]
  s_waitcnt lgkmcnt(9)
  v_alignbyte_b32 v32, v113, v112, v15
  v_alignbyte_b32 v33, v114, v113, v15
  v_alignbyte_b32 v34, v115, v114, v15
  v_alignbyte_b32 v35, v116, v115, v15
  ds_read_b64 v[84:85], v8
  ds_read_b64 v[86:87], v9
  v_mfma_f32_16x16x32_bf16 a[120:123], v[28:31], v[60:63], a[120:123]
  s_waitcnt lgkmcnt(8)
  v_alignbyte_b32 v36, v119, v118, v15
  v_alignbyte_b32 v37, v120, v119, v15
  v_alignbyte_b32 v38, v121, v120, v15
  v_alignbyte_b32 v39, v122, v121, v15
  v_mfma_f32_16x16x32_bf16 a[152:155], v[32:35], v[64:67], a[152:155]
  s_waitcnt lgkmcnt(5)
  v_alignbyte_b32 v40, v125, v124, v15
  v_alignbyte_b32 v41, v126, v125, v15
  v_alignbyte_b32 v42, v127, v126, v15
  v_alignbyte_b32 v43, v128, v127, v15
  v_mfma_f32_16x16x32_bf16 a[184:187], v[36:39], v[68:71], a[184:187]
  s_waitcnt lgkmcnt(2)
  v_alignbyte_b32 v44, v131, v130, v15
  v_alignbyte_b32 v45, v132, v131, v15
  v_alignbyte_b32 v46, v133, v132, v15
  v_alignbyte_b32 v47, v134, v133, v15
  v_mfma_f32_16x16x32_bf16 a[216:219], v[40:43], v[72:75], a[216:219]
  s_nop 0
  v_mfma_f32_16x16x32_bf16 a[248:251], v[44:47], v[76:79], a[248:251]
  s_waitcnt lgkmcnt(0)
  ds_read_b128 v[48:51], v4 offset:0
  ds_read_b128 v[52:55], v4 offset:4608
  ds_read_b128 v[56:59], v4 offset:9216
  ds_read_b128 v[60:63], v4 offset:13824
  ds_read_b128 v[64:67], v4 offset:18432
  ds_read_b128 v[68:71], v4 offset:23040
  ds_read_b128 v[72:75], v4 offset:27648
  ds_read_b128 v[76:79], v4 offset:32256
  s_mov_b32 exec_lo, s42
  s_mov_b32 exec_hi, s42
  ds_write_b128 v6, a[24:27] offset:0
  ds_write_b128 v6, a[56:59] offset:128
  ds_write_b128 v6, a[88:91] offset:256
  ds_write_b128 v6, a[120:123] offset:384
  ds_write_b128 v6, a[152:155] offset:512
  ds_write_b128 v6, a[184:187] offset:640
  ds_write_b128 v6, a[216:219] offset:768
  ds_write_b128 v6, a[248:251] offset:896
  s_mov_b64 exec, -1
  ds_read_b128 v[80:83], v7
  ds_write_b32 v14, v13 offset:8
  v_lshlrev_b32 v88, 16, v84
  v_and_b32 v89, 0xffff0000, v84
  v_lshlrev_b32 v90, 16, v85
  v_and_b32 v91, 0xffff0000, v85
  v_lshlrev_b32 v96, 16, v86
  v_and_b32 v97, 0xffff0000, v86
  v_lshlrev_b32 v98, 16, v87
  v_and_b32 v99, 0xffff0000, v87
  v_mul_f32 v92, v88, v12
  v_mul_f32 v93, v89, v12
  v_mul_f32 v94, v90, v12
  v_mul_f32 v95, v91, v12
  v_cvt_pk_bf16_f32 v84, v92, v93
  v_cvt_pk_bf16_f32 v85, v94, v95
  v_lshlrev_b32 v92, 16, v84
  v_and_b32 v93, 0xffff0000, v84
  v_lshlrev_b32 v94, 16, v85
  v_and_b32 v95, 0xffff0000, v85
  s_waitcnt lgkmcnt(1)
  v_fmac_f32 v80, v88, v11
  v_fmac_f32 v81, v89, v11
  v_fmac_f32 v82, v90, v11
  v_fmac_f32 v83, v91, v11
  v_cvt_pk_bf16_f32 v84, v80, v81
  v_cvt_pk_bf16_f32 v85, v82, v83
  v_lshlrev_b32 v80, 16, v84
  v_and_b32 v81, 0xffff0000, v84
  v_lshlrev_b32 v82, 16, v85
  v_and_b32 v83, 0xffff0000, v85
  v_add_f32 v80, v80, v92
  v_add_f32 v81, v81, v93
  v_add_f32 v82, v82, v94
  v_add_f32 v83, v83, v95
  v_cvt_pk_bf16_f32 v84, v80, v81
  v_cvt_pk_bf16_f32 v85, v82, v83
  v_lshlrev_b32 v80, 16, v84
  v_and_b32 v81, 0xffff0000, v84
  v_lshlrev_b32 v82, 16, v85
  v_and_b32 v83, 0xffff0000, v85
  v_add_f32 v80, v80, v96
  v_add_f32 v81, v81, v97
  v_add_f32 v82, v82, v98
  v_add_f32 v83, v83, v99
  v_cvt_pk_bf16_f32 v84, v80, v81
  v_cvt_pk_bf16_f32 v85, v82, v83
  buffer_store_dwordx2 v[84:85], v10, s[8:11], s40 offen sc1
  v_mfma_f32_16x16x32_bf16 a[28:31], v[16:19], v[48:51], a[28:31]
  v_mfma_f32_16x16x32_bf16 a[60:63], v[20:23], v[52:55], a[60:63]
  v_mfma_f32_16x16x32_bf16 a[92:95], v[24:27], v[56:59], a[92:95]
  v_mfma_f32_16x16x32_bf16 a[124:127], v[28:31], v[60:63], a[124:127]
  v_mfma_f32_16x16x32_bf16 a[156:159], v[32:35], v[64:67], a[156:159]
  v_mfma_f32_16x16x32_bf16 a[188:191], v[36:39], v[68:71], a[188:191]
  v_mfma_f32_16x16x32_bf16 a[220:223], v[40:43], v[72:75], a[220:223]
  v_mfma_f32_16x16x32_bf16 a[252:255], v[44:47], v[76:79], a[252:255]
  v_add_u32 v104, 64, v104
  v_add_u32 v105, 64, v105
  v_add_u32 v106, 64, v106
  v_add_u32 v107, 64, v107
  v_add_u32 v108, 64, v108
  v_add_u32 v109, 64, v109
  v_add_u32 v110, 64, v110
  v_add_u32 v111, 64, v111
  v_add_u32 v4, 64, v4
  v_add_u32 v8, 64, v8
  s_add_u32 s40, s40, 0x8000
  s_waitcnt vmcnt(0)
  s_mov_b64 exec, 1
  buffer_store_dword v13, v1, s[8:11], s39 offen sc1
  s_mov_b64 exec, -1
  ds_write_b32 v14, v13 offset:16
  s_add_u32 s32, s32, 1
  s_and_b32 s6, s32, 7
  s_cbranch_scc1 L_c_conv6
L_c_conv7:
  s_add_u32 s33, s32, 1
  s_and_b32 s6, s32, 7
  s_lshl_b32 s7, s6, 10
  s_add_u32 s7, s7, s35
  v_add_u32 v9, s7, v10
  s_lshl_b32 s6, s6, 1
  s_lshl_b32 s42, 0x30003, s6
  v_mov_b32 v13, s33
  ds_read_b128 v[48:51], v4 offset:0
  ds_read_b128 v[52:55], v4 offset:4608
  ds_read_b128 v[56:59], v4 offset:9216
  ds_read_b128 v[60:63], v4 offset:13824
  ds_read_b128 v[64:67], v4 offset:18432
  ds_read_b128 v[68:71], v4 offset:23040
  ds_read_b128 v[72:75], v4 offset:27648
  ds_read_b128 v[76:79], v4 offset:32256
  s_mov_b32 s7, 0
L_lw_134:
  ds_read_b32 v88, v2 offset:0
  s_waitcnt lgkmcnt(0)
  v_cmp_gt_i32 vcc, s33, v88
  s_cbranch_vccz L_lwo_135
  s_add_u32 s7, s7, 1
  s_cmp_lt_u32 s7, 131072
  s_cbranch_scc1 L_lw_134
  s_mov_b32 s6, 42
  s_branch L_err
L_lwo_135:
  ds_read2_b32 v[112:113], v104 offset0:0 offset1:1
  ds_read2_b32 v[114:115], v104 offset0:2 offset1:3
  ds_read_b32 v116, v104 offset:16
  ds_read2_b32 v[118:119], v105 offset0:0 offset1:1
  ds_read2_b32 v[120:121], v105 offset0:2 offset1:3
  ds_read_b32 v122, v105 offset:16
  ds_read2_b32 v[124:125], v106 offset0:0 offset1:1
  ds_read2_b32 v[126:127], v106 offset0:2 offset1:3
  ds_read_b32 v128, v106 offset:16
  ds_read2_b32 v[130:131], v107 offset0:0 offset1:1
  ds_read2_b32 v[132:133], v107 offset0:2 offset1:3
  ds_read_b32 v134, v107 offset:16
  s_waitcnt lgkmcnt(9)
  v_alignbyte_b32 v16, v113, v112, v15
  v_alignbyte_b32 v17, v114, v113, v15
  v_alignbyte_b32 v18, v115, v114, v15
  v_alignbyte_b32 v19, v116, v115, v15
  ds_read2_b32 v[112:113], v108 offset0:0 offset1:1
  ds_read2_b32 v[114:115], v108 offset0:2 offset1:3
  ds_read_b32 v116, v108 offset:16
  s_waitcnt lgkmcnt(9)
  v_alignbyte_b32 v20, v119, v118, v15
  v_alignbyte_b32 v21, v120, v119, v15
  v_alignbyte_b32 v22, v121, v120, v15
  v_alignbyte_b32 v23, v122, v121, v15
  ds_read2_b32 v[118:119], v109 offset0:0 offset1:1
  ds_read2_b32 v[120:121], v109 offset0:2 offset1:3
  ds_read_b32 v122, v109 offset:16
  v_mfma_f32_16x16x32_bf16 a[28:31], v[16:19], v[48:51], a[28:31]
  s_waitcnt lgkmcnt(9)
  v_alignbyte_b32 v24, v125, v124, v15
  v_alignbyte_b32 v25, v126, v125, v15
  v_alignbyte_b32 v26, v127, v126, v15
  v_alignbyte_b32 v27, v128, v127, v15
  ds_read2_b32 v[124:125], v110 offset0:0 offset1:1
  ds_read2_b32 v[126:127], v110 offset0:2 offset1:3
  ds_read_b32 v128, v110 offset:16
  v_mfma_f32_16x16x32_bf16 a[60:63], v[20:23], v[52:55], a[60:63]
  s_waitcnt lgkmcnt(9)
  v_alignbyte_b32 v28, v131, v130, v15
  v_alignbyte_b32 v29, v132, v131, v15
  v_alignbyte_b32 v30, v133, v132, v15
  v_alignbyte_b32 v31, v134, v133, v15
  ds_read2_b32 v[130:131], v111 offset0:0 offset1:1
  ds_read2_b32 v[132:133], v111 offset0:2 offset1:3
  ds_read_b32 v134, v111 offset:16
  v_mfma_f32_16x16x32_bf16 a[92:95], v[24:27], v[56:59], a[92:95]
  s_waitcnt lgkmcnt(9)
  v_alignbyte_b32 v32, v113, v112, v15
  v_alignbyte_b32 v33, v114, v113, v15
  v_alignbyte_b32 v34, v115, v114, v15
  v_alignbyte_b32 v35, v116, v115, v15
  ds_read_b64 v[84:85], v8
  ds_read_b64 v[86:87], v9
  v_mfma_f32_16x16x32_bf16 a[124:127], v[28:31], v[60:63], a[124:127]
  s_waitcnt lgkmcnt(8)
  v_alignbyte_b32 v36, v119, v118, v15
  v_alignbyte_b32 v37, v120, v119, v15
  v_alignbyte_b32 v38, v121, v120, v15
  v_alignbyte_b32 v39, v122, v121, v15
  v_mfma_f32_16x16x32_bf16 a[156:159], v[32:35], v[64:67], a[156:159]
  s_waitcnt lgkmcnt(5)
  v_alignbyte_b32 v40, v125, v124, v15
  v_alignbyte_b32 v41, v126, v125, v15
  v_alignbyte_b32 v42, v127, v126, v15
  v_alignbyte_b32 v43, v128, v127, v15
  v_mfma_f32_16x16x32_bf16 a[188:191], v[36:39], v[68:71], a[188:191]
  s_waitcnt lgkmcnt(2)
  v_alignbyte_b32 v44, v131, v130, v15
  v_alignbyte_b32 v45, v132, v131, v15
  v_alignbyte_b32 v46, v133, v132, v15
  v_alignbyte_b32 v47, v134, v133, v15
  v_mfma_f32_16x16x32_bf16 a[220:223], v[40:43], v[72:75], a[220:223]
  s_nop 0
  v_mfma_f32_16x16x32_bf16 a[252:255], v[44:47], v[76:79], a[252:255]
  s_waitcnt lgkmcnt(0)
  s_mov_b32 exec_lo, s42
  s_mov_b32 exec_hi, s42
  ds_write_b128 v6, a[28:31] offset:0
  ds_write_b128 v6, a[60:63] offset:128
  ds_write_b128 v6, a[92:95] offset:256
  ds_write_b128 v6, a[124:127] offset:384
  ds_write_b128 v6, a[156:159] offset:512
  ds_write_b128 v6, a[188:191] offset:640
  ds_write_b128 v6, a[220:223] offset:768
  ds_write_b128 v6, a[252:255] offset:896
  s_mov_b64 exec, -1
  ds_read_b128 v[80:83], v7
  ds_write_b32 v14, v13 offset:8
  v_lshlrev_b32 v88, 16, v84
  v_and_b32 v89, 0xffff0000, v84
  v_lshlrev_b32 v90, 16, v85
  v_and_b32 v91, 0xffff0000, v85
  v_lshlrev_b32 v96, 16, v86
  v_and_b32 v97, 0xffff0000, v86
  v_lshlrev_b32 v98, 16, v87
  v_and_b32 v99, 0xffff0000, v87
  v_mul_f32 v92, v88, v12
  v_mul_f32 v93, v89, v12
  v_mul_f32 v94, v90, v12
  v_mul_f32 v95, v91, v12
  v_cvt_pk_bf16_f32 v84, v92, v93
  v_cvt_pk_bf16_f32 v85, v94, v95
  v_lshlrev_b32 v92, 16, v84
  v_and_b32 v93, 0xffff0000, v84
  v_lshlrev_b32 v94, 16, v85
  v_and_b32 v95, 0xffff0000, v85
  s_waitcnt lgkmcnt(1)
  v_fmac_f32 v80, v88, v11
  v_fmac_f32 v81, v89, v11
  v_fmac_f32 v82, v90, v11
  v_fmac_f32 v83, v91, v11
  v_cvt_pk_bf16_f32 v84, v80, v81
  v_cvt_pk_bf16_f32 v85, v82, v83
  v_lshlrev_b32 v80, 16, v84
  v_and_b32 v81, 0xffff0000, v84
  v_lshlrev_b32 v82, 16, v85
  v_and_b32 v83, 0xffff0000, v85
  v_add_f32 v80, v80, v92
  v_add_f32 v81, v81, v93
  v_add_f32 v82, v82, v94
  v_add_f32 v83, v83, v95
  v_cvt_pk_bf16_f32 v84, v80, v81
  v_cvt_pk_bf16_f32 v85, v82, v83
  v_lshlrev_b32 v80, 16, v84
  v_and_b32 v81, 0xffff0000, v84
  v_lshlrev_b32 v82, 16, v85
  v_and_b32 v83, 0xffff0000, v85
  v_add_f32 v80, v80, v96
  v_add_f32 v81, v81, v97
  v_add_f32 v82, v82, v98
  v_add_f32 v83, v83, v99
  v_cvt_pk_bf16_f32 v84, v80, v81
  v_cvt_pk_bf16_f32 v85, v82, v83
  buffer_store_dwordx2 v[84:85], v10, s[8:11], s40 offen sc1
  v_add_u32 v104, 64, v104
  v_add_u32 v105, 64, v105
  v_add_u32 v106, 64, v106
  v_add_u32 v107, 64, v107
  v_add_u32 v108, 64, v108
  v_add_u32 v109, 64, v109
  v_add_u32 v110, 64, v110
  v_add_u32 v111, 64, v111
  v_add_u32 v4, 64, v4
  v_add_u32 v8, 64, v8
  s_add_u32 s40, s40, 0x8000
  s_waitcnt vmcnt(0)
  s_mov_b64 exec, 1
  buffer_store_dword v13, v1, s[8:11], s39 offen sc1
  s_mov_b64 exec, -1
  ds_write_b32 v14, v13 offset:16
  s_add_u32 s32, s32, 1
  s_and_b32 s6, s32, 7
  s_cbranch_scc1 L_c_conv7
  s_waitcnt vmcnt(0)
  s_endpgm
L_c_res:
  s_mov_b32 s16, s92
  s_mov_b32 s17, s93
  s_mov_b32 s18, 0x200000
  s_mov_b32 s19, 0x20000
  s_and_b32 s6, s3, 1
  s_mul_i32 s37, s6, 0x200000
  s_mul_i32 s38, s6, 0x800000
  s_lshl_b32 s7, s5, 10
  s_add_u32 s37, s37, s7
  s_add_u32 s37, s37, 0x0
  s_add_u32 s38, s38, s7
  s_add_u32 s38, s38, 0x8800000
  s_lshl_b32 s6, s5, 3
  s_add_u32 s39, s6, 0x710900
  s_lshl_b32 s41, s5, 5
  v_bfe_u32 v16, v0, 4, 5
  v_lshrrev_b32 v17, 9, v0
  v_lshlrev_b32 v18, 1, v16
  v_lshl_or_b32 v4, v17, 8, v18
  v_add_u32 v8, 139776, v4
  v_mul_u32_u24 v19, 16512, v17
  v_add_u32 v19, v19, v18
  v_add_u32 v7, 73760, v19
  v_bfe_u32 v5, v0, 2, 3
  v_bfe_u32 v6, v0, 8, 1
  v_lshlrev_b32 v6, 3, v6
  v_and_b32 v19, 0xf0, v0
  v_or_b32 v6, v19, v6
  v_lshlrev_b32 v19, 10, v16
  v_lshl_or_b32 v9, v17, 3, v19
  s_mov_b32 s43, 0
  s_mov_b32 s46, 0
  s_mov_b32 s23, 0
  s_mov_b32 s20, 0x3f80
  s_mov_b32 s21, 0x3f800000
  s_mov_b32 s22, 0x3f803f80
  v_bfe_u32 v10, v0, 4, 2
  v_lshlrev_b32 v10, 15, v10
  v_mov_b32 v32, 0
  v_mov_b32 v33, 0
  v_mov_b32 v34, 0
  v_mov_b32 v35, 0
  v_mov_b32 v36, 0
  v_mov_b32 v37, 0
  v_mov_b32 v38, 0
  v_mov_b32 v39, 0
  s_cmp_eq_u32 s3, 2
  s_cbranch_scc0 L_c_r5
L_c_rf:
  s_cmp_eq_u32 s3, 2
  s_cbranch_scc1 L_ga_136
  s_mov_b32 s47, 0
L_gl_138:
  ds_read_b32 v52, v2 offset:24
  s_waitcnt lgkmcnt(0)
  v_readfirstlane_b32 s6, v52
  s_cmp_gt_i32 s6, s46
  s_cbranch_scc1 L_gb_137
  s_add_u32 s47, s47, 1
  s_cmp_lt_u32 s47, 131072
  s_cbranch_scc1 L_gl_138
  s_mov_b32 s6, 47
  s_branch L_err
L_ga_136:
  s_add_u32 s6, s46, 1
  v_mov_b32 v52, s6
  ds_write_b32 v2, v52 offset:24
L_gb_137:
  s_min_i32 s46, s6, 0x7ffffffe
  buffer_load_short_d16_hi v32, v4, s[8:11], s37 offen offset:0
  buffer_load_short_d16_hi v33, v4, s[8:11], s37 offen offset:64
  buffer_load_short_d16_hi v34, v4, s[8:11], s37 offen offset:128
  buffer_load_short_d16_hi v35, v4, s[8:11], s37 offen offset:192
  buffer_load_short_d16_hi v36, v4, s[8:11], s37 offen offset:512
  buffer_load_short_d16_hi v37, v4, s[8:11], s37 offen offset:576
  buffer_load_short_d16_hi v38, v4, s[8:11], s37 offen offset:640
  buffer_load_short_d16_hi v39, v4, s[8:11], s37 offen offset:704
  s_and_b32 s6, s43, 3
  s_lshl_b32 s6, s6, 17
  s_add_u32 s44, s38, s6
  s_lshr_b32 s6, s43, 2
  s_andn2_b32 s45, 1, s6
  s_add_u32 s6, s44, 0
  buffer_load_dwordx4 v[16:19], v0, s[8:11], s6 offen sc1
  s_add_u32 s6, s44, 32768
  buffer_load_dwordx4 v[20:23], v0, s[8:11], s6 offen sc1
  s_add_u32 s6, s44, 65536
  buffer_load_dwordx4 v[24:27], v0, s[8:11], s6 offen sc1
  s_add_u32 s6, s44, 98304
  buffer_load_dwordx4 v[28:31], v0, s[8:11], s6 offen sc1
  s_add_u32 s37, s37, 0x8000
  s_add_u32 s43, s43, 1
L_c_rloop:
  s_mov_b32 s7, 0
L_c_rp:
  s_waitcnt vmcnt(0)
  v_bitop3_b32 v52, v16, v20, s45 bitop3:0x7e
  v_bitop3_b32 v53, v24, v28, s45 bitop3:0x7e
  v_bitop3_b32 v52, v52, v53, 1 bitop3:0xa8
  v_cmp_ne_u32 vcc, 0, v52
  s_cbranch_vccz L_c_rok
  s_cmp_eq_u32 s3, 2
  s_cbranch_scc1 L_ga_139
  s_mov_b32 s47, 0
L_gl_141:
  ds_read_b32 v52, v2 offset:24
  s_waitcnt lgkmcnt(0)
  v_readfirstlane_b32 s6, v52
  s_cmp_gt_i32 s6, s46
  s_cbranch_scc1 L_gb_140
  s_add_u32 s47, s47, 1
  s_cmp_lt_u32 s47, 131072
  s_cbranch_scc1 L_gl_141
  s_mov_b32 s6, 47
  s_branch L_err
L_gb_140:
  s_min_i32 s46, s6, 0x7ffffffe
L_ga_139:
  s_add_u32 s6, s44, 0
  s_nop 0
  buffer_load_dwordx4 v[16:19], v0, s[8:11], s6 offen sc1
  s_add_u32 s6, s44, 32768
  buffer_load_dwordx4 v[20:23], v0, s[8:11], s6 offen sc1
  s_add_u32 s6, s44, 65536
  buffer_load_dwordx4 v[24:27], v0, s[8:11], s6 offen sc1
  s_add_u32 s6, s44, 98304
  buffer_load_dwordx4 v[28:31], v0, s[8:11], s6 offen sc1
  s_add_u32 s7, s7, 1
  s_cmp_lt_u32 s7, 131072
  s_cbranch_scc1 L_c_rp
  s_mov_b32 s6, 43
  s_branch L_err
L_c_rok:
  v_dot2_f32_bf16 v40, v16, s20, 0
  v_dot2_f32_bf16 v41, v16, s21, 0
  v_dot2_f32_bf16 v42, v17, s20, 0
  v_dot2_f32_bf16 v43, v17, s21, 0
  v_dot2_f32_bf16 v44, v18, s20, 0
  v_dot2_f32_bf16 v45, v18, s21, 0
  v_dot2_f32_bf16 v46, v19, s20, 0
  v_dot2_f32_bf16 v47, v19, s21, 0
  v_dot2_f32_bf16 v40, v20, s20, v40
  v_dot2_f32_bf16 v41, v20, s21, v41
  v_dot2_f32_bf16 v42, v21, s20, v42
  v_dot2_f32_bf16 v43, v21, s21, v43
  v_dot2_f32_bf16 v44, v22, s20, v44
  v_dot2_f32_bf16 v45, v22, s21, v45
  v_dot2_f32_bf16 v46, v23, s20, v46
  v_dot2_f32_bf16 v47, v23, s21, v47
  v_dot2_f32_bf16 v40, v24, s20, v40
  v_dot2_f32_bf16 v41, v24, s21, v41
  v_dot2_f32_bf16 v42, v25, s20, v42
  v_dot2_f32_bf16 v43, v25, s21, v43
  v_dot2_f32_bf16 v44, v26, s20, v44
  v_dot2_f32_bf16 v45, v26, s21, v45
  v_dot2_f32_bf16 v46, v27, s20, v46
  v_dot2_f32_bf16 v47, v27, s21, v47
  v_dot2_f32_bf16 v40, v28, s20, v40
  v_dot2_f32_bf16 v41, v28, s21, v41
  v_dot2_f32_bf16 v42, v29, s20, v42
  v_dot2_f32_bf16 v43, v29, s21, v43
  v_dot2_f32_bf16 v44, v30, s20, v44
  v_dot2_f32_bf16 v45, v30, s21, v45
  v_dot2_f32_bf16 v46, v31, s20, v46
  v_dot2_f32_bf16 v47, v31, s21, v47
  v_cvt_pk_bf16_f32 v48, v40, v41
  v_cvt_pk_bf16_f32 v49, v42, v43
  v_cvt_pk_bf16_f32 v50, v44, v45
  v_cvt_pk_bf16_f32 v51, v46, v47
  v_dot2_f32_bf16 v40, v48, s20, v32
  v_dot2_f32_bf16 v41, v48, s21, v33
  v_dot2_f32_bf16 v42, v49, s20, v34
  v_dot2_f32_bf16 v43, v49, s21, v35
  v_dot2_f32_bf16 v44, v50, s20, v36
  v_dot2_f32_bf16 v45, v50, s21, v37
  v_dot2_f32_bf16 v46, v51, s20, v38
  v_dot2_f32_bf16 v47, v51, s21, v39
  v_cvt_pk_bf16_f32 v48, v40, v41
  v_cvt_pk_bf16_f32 v49, v42, v43
  v_cvt_pk_bf16_f32 v50, v44, v45
  v_cvt_pk_bf16_f32 v51, v46, v47
  s_cmp_eq_u32 s3, 2
  s_cbranch_scc1 L_c_ln
  buffer_store_dwordx2 v[48:49], v9, s[16:19], s41 offen
  buffer_store_dwordx2 v[50:51], v9, s[16:19], s41 offen offset:16
  s_add_u32 s41, s41, 0x8000
  v_mov_b32 v52, s43
  s_mov_b64 exec, 3
  buffer_store_dword v52, v5, s[8:11], s39 offen sc1
  s_mov_b64 exec, -1
  s_add_u32 s32, s32, 1
  s_cmp_eq_u32 s32, 64
  s_cbranch_scc1 L_c_rend
L_c_r5:
  s_add_u32 s33, s32, 1
  s_mov_b32 s7, 0
L_lw_142:
  ds_read_b64 v[52:53], v2 offset:16
  s_waitcnt lgkmcnt(0)
  v_min_i32 v52, v52, v53
  v_cmp_gt_i32 vcc, s33, v52
  s_cbranch_vccz L_lwo_143
  s_add_u32 s7, s7, 1
  s_cmp_lt_u32 s7, 131072
  s_cbranch_scc1 L_lw_142
  s_mov_b32 s6, 46
  s_branch L_err
L_lwo_143:
  s_branch L_c_rf
L_c_ln:
  s_cmp_eq_u32 s32, 63
  s_cbranch_scc0 L_cf_144
  v_mov_b32 v52, 0x7fffffff
  ds_write_b32 v2, v52 offset:24
  s_branch L_cnf_145
L_cf_144:
L_ga_146:
  s_add_u32 s6, s46, 1
  v_mov_b32 v52, s6
  ds_write_b32 v2, v52 offset:24
L_gb_147:
  s_min_i32 s46, s6, 0x7ffffffe
  buffer_load_short_d16_hi v32, v4, s[8:11], s37 offen offset:0
  buffer_load_short_d16_hi v33, v4, s[8:11], s37 offen offset:64
  buffer_load_short_d16_hi v34, v4, s[8:11], s37 offen offset:128
  buffer_load_short_d16_hi v35, v4, s[8:11], s37 offen offset:192
  buffer_load_short_d16_hi v36, v4, s[8:11], s37 offen offset:512
  buffer_load_short_d16_hi v37, v4, s[8:11], s37 offen offset:576
  buffer_load_short_d16_hi v38, v4, s[8:11], s37 offen offset:640
  buffer_load_short_d16_hi v39, v4, s[8:11], s37 offen offset:704
  s_and_b32 s6, s43, 3
  s_lshl_b32 s6, s6, 17
  s_add_u32 s44, s38, s6
  s_lshr_b32 s6, s43, 2
  s_andn2_b32 s45, 1, s6
  s_add_u32 s6, s44, 0
  buffer_load_dwordx4 v[16:19], v0, s[8:11], s6 offen sc1
  s_add_u32 s6, s44, 32768
  buffer_load_dwordx4 v[20:23], v0, s[8:11], s6 offen sc1
  s_add_u32 s6, s44, 65536
  buffer_load_dwordx4 v[24:27], v0, s[8:11], s6 offen sc1
  s_add_u32 s6, s44, 98304
  buffer_load_dwordx4 v[28:31], v0, s[8:11], s6 offen sc1
  s_add_u32 s37, s37, 0x8000
  s_add_u32 s43, s43, 1
L_cnf_145:
  v_dot2_f32_bf16 v52, v48, s22, 0
  v_dot2_f32_bf16 v53, v48, v48, 0
  v_dot2_f32_bf16 v52, v49, s22, v52
  v_dot2_f32_bf16 v53, v49, v49, v53
  v_dot2_f32_bf16 v52, v50, s22, v52
  v_dot2_f32_bf16 v53, v50, v50, v53
  v_dot2_f32_bf16 v52, v51, s22, v52
  v_dot2_f32_bf16 v53, v51, v51, v53
  s_lshr_b32 s6, s32, 2
  s_andn2_b32 s36, 1, s6
  s_and_b32 s6, s32, 3
  s_lshl_b32 s6, s6, 13
  s_add_u32 s34, s6, 0x738000
  s_lshl_b32 s6, s5, 8
  s_add_u32 s6, s6, s34
  v_mov_b32 v54, v52
  v_mov_b32 v55, v53
  s_nop 0
  v_permlane32_swap_b32 v52, v54
  v_permlane32_swap_b32 v53, v55
  v_add_f32 v52, v52, v54
  v_add_f32 v53, v53, v55
  v_bfi_b32 v53, 1, s36, v53
  s_mov_b32 exec_hi, 0
  buffer_store_dwordx2 v[52:53], v6, s[8:11], s6 offen
  s_cmp_lt_u32 s32, 62
  s_cbranch_scc1 L_cnl_149
  buffer_store_dwordx2 v[52:53], v6, s[8:11], s6 offen sc1
L_cnl_149:
  s_mov_b32 exec_hi, -1
  s_add_u32 s35, s34, 4096
  s_sub_u32 s33, s32, 7
  s_mov_b32 s7, 0
L_lw_150:
  ds_read_b64 v[52:53], v2 offset:8
  s_waitcnt lgkmcnt(0)
  v_min_i32 v52, v52, v53
  v_cmp_gt_i32 vcc, s33, v52
  s_cbranch_vccz L_lwo_151
  s_add_u32 s7, s7, 1
  s_cmp_lt_u32 s7, 131072
  s_cbranch_scc1 L_lw_150
  s_mov_b32 s6, 44
  s_branch L_err
L_lwo_151:
  s_and_b32 s6, s32, 7
  s_lshl_b32 s6, s6, 10
  v_add_u32 v52, s6, v8
  ds_write_b16 v52, v48 offset:0
  ds_write_b16_d16_hi v52, v48 offset:64
  ds_write_b16 v52, v49 offset:128
  ds_write_b16_d16_hi v52, v49 offset:192
  ds_write_b16 v52, v50 offset:512
  ds_write_b16_d16_hi v52, v50 offset:576
  ds_write_b16 v52, v51 offset:640
  ds_write_b16_d16_hi v52, v51 offset:704
  buffer_load_dwordx4 v[64:67], v0, s[8:11], s34 offen offset:0 sc1
  buffer_load_dwordx4 v[68:71], v0, s[8:11], s34 offen offset:1024 sc1
  buffer_load_dwordx4 v[72:75], v0, s[8:11], s34 offen offset:2048 sc1
  buffer_load_dwordx4 v[76:79], v0, s[8:11], s34 offen offset:3072 sc1
  buffer_load_dwordx4 v[80:83], v0, s[8:11], s35 offen offset:0 sc1
  buffer_load_dwordx4 v[84:87], v0, s[8:11], s35 offen offset:1024 sc1
  buffer_load_dwordx4 v[88:91], v0, s[8:11], s35 offen offset:2048 sc1
  buffer_load_dwordx4 v[92:95], v0, s[8:11], s35 offen offset:3072 sc1
  s_mov_b32 s7, 0
L_c_g:
  s_waitcnt vmcnt(0)
L_c_g1:
  v_bitop3_b32 v56, v65, v67, s36 bitop3:0x7e
  v_bitop3_b32 v57, v69, v71, s36 bitop3:0x7e
  v_bitop3_b32 v58, v73, v75, s36 bitop3:0x7e
  v_bitop3_b32 v59, v77, v79, s36 bitop3:0x7e
  v_bitop3_b32 v60, v81, v83, s36 bitop3:0x7e
  v_bitop3_b32 v61, v85, v87, s36 bitop3:0x7e
  v_bitop3_b32 v62, v89, v91, s36 bitop3:0x7e
  v_bitop3_b32 v63, v93, v95, s36 bitop3:0x7e
  v_or3_b32 v52, v56, v57, v58
  v_or3_b32 v53, v59, v60, v61
  v_or3_b32 v52, v52, v62, v63
  v_bitop3_b32 v52, v52, v53, 1 bitop3:0xa8
  v_cmp_ne_u32 vcc, 0, v52
  s_cbranch_vccz L_c_gok0
  v_and_b32 v56, 1, v56
  v_and_b32 v57, 1, v57
  v_and_b32 v58, 1, v58
  v_and_b32 v59, 1, v59
  v_and_b32 v60, 1, v60
  v_and_b32 v61, 1, v61
  v_and_b32 v62, 1, v62
  v_and_b32 v63, 1, v63
  v_cmp_ne_u32 s[48:49], 0, v56
  v_cmp_ne_u32 s[50:51], 0, v57
  v_cmp_ne_u32 s[52:53], 0, v58
  v_cmp_ne_u32 s[54:55], 0, v59
  v_cmp_ne_u32 s[56:57], 0, v60
  v_cmp_ne_u32 s[58:59], 0, v61
  v_cmp_ne_u32 s[60:61], 0, v62
  v_cmp_ne_u32 s[62:63], 0, v63
  s_or_b64 exec, s[48:49], 1
  buffer_load_dwordx4 v[64:67], v0, s[8:11], s34 offen offset:0 sc1
  s_or_b64 exec, s[50:51], 1
  buffer_load_dwordx4 v[68:71], v0, s[8:11], s34 offen offset:1024 sc1
  s_or_b64 exec, s[52:53], 1
  buffer_load_dwordx4 v[72:75], v0, s[8:11], s34 offen offset:2048 sc1
  s_or_b64 exec, s[54:55], 1
  buffer_load_dwordx4 v[76:79], v0, s[8:11], s34 offen offset:3072 sc1
  s_or_b64 exec, s[56:57], 1
  buffer_load_dwordx4 v[80:83], v0, s[8:11], s35 offen offset:0 sc1
  s_or_b64 exec, s[58:59], 1
  buffer_load_dwordx4 v[84:87], v0, s[8:11], s35 offen offset:1024 sc1
  s_or_b64 exec, s[60:61], 1
  buffer_load_dwordx4 v[88:91], v0, s[8:11], s35 offen offset:2048 sc1
  s_or_b64 exec, s[62:63], 1
  buffer_load_dwordx4 v[92:95], v0, s[8:11], s35 offen offset:3072 sc1
  s_mov_b64 exec, -1
  s_cmp_lg_u32 s23, 0
  s_cbranch_scc1 L_c_na
  s_cmp_eq_u32 s32, 63
  s_cbranch_scc1 L_c_na
  s_waitcnt vmcnt(8)
  v_bitop3_b32 v52, v16, v20, s45 bitop3:0x7e
  v_bitop3_b32 v53, v24, v28, s45 bitop3:0x7e
  v_bitop3_b32 v52, v52, v53, 1 bitop3:0xa8
  v_cmp_ne_u32 vcc, 0, v52
  s_cbranch_vccz L_c_pa
  s_cmp_lg_u32 s7, 0
  s_cbranch_scc1 L_c_na
  s_add_u32 s6, s44, 0
  buffer_load_dwordx4 v[16:19], v0, s[8:11], s6 offen sc1
  s_add_u32 s6, s44, 32768
  buffer_load_dwordx4 v[20:23], v0, s[8:11], s6 offen sc1
  s_add_u32 s6, s44, 65536
  buffer_load_dwordx4 v[24:27], v0, s[8:11], s6 offen sc1
  s_add_u32 s6, s44, 98304
  buffer_load_dwordx4 v[28:31], v0, s[8:11], s6 offen sc1
  s_mov_b32 s7, 1
  s_waitcnt vmcnt(4)
  s_branch L_c_g1
L_c_pa:
  s_cbranch_vccnz L_c_na
  s_add_u32 s26, s32, 1
  s_mov_b32 s23, 1
  v_dot2_f32_bf16 v40, v16, s20, 0
  v_dot2_f32_bf16 v41, v16, s21, 0
  v_dot2_f32_bf16 v42, v17, s20, 0
  v_dot2_f32_bf16 v43, v17, s21, 0
  v_dot2_f32_bf16 v44, v18, s20, 0
  v_dot2_f32_bf16 v45, v18, s21, 0
  v_dot2_f32_bf16 v46, v19, s20, 0
  v_dot2_f32_bf16 v47, v19, s21, 0
  v_dot2_f32_bf16 v40, v20, s20, v40
  v_dot2_f32_bf16 v41, v20, s21, v41
  v_dot2_f32_bf16 v42, v21, s20, v42
  v_dot2_f32_bf16 v43, v21, s21, v43
  v_dot2_f32_bf16 v44, v22, s20, v44
  v_dot2_f32_bf16 v45, v22, s21, v45
  v_dot2_f32_bf16 v46, v23, s20, v46
  v_dot2_f32_bf16 v47, v23, s21, v47
  v_dot2_f32_bf16 v40, v24, s20, v40
  v_dot2_f32_bf16 v41, v24, s21, v41
  v_dot2_f32_bf16 v42, v25, s20, v42
  v_dot2_f32_bf16 v43, v25, s21, v43
  v_dot2_f32_bf16 v44, v26, s20, v44
  v_dot2_f32_bf16 v45, v26, s21, v45
  v_dot2_f32_bf16 v46, v27, s20, v46
  v_dot2_f32_bf16 v47, v27, s21, v47
  v_dot2_f32_bf16 v40, v28, s20, v40
  v_dot2_f32_bf16 v41, v28, s21, v41
  v_dot2_f32_bf16 v42, v29, s20, v42
  v_dot2_f32_bf16 v43, v29, s21, v43
  v_dot2_f32_bf16 v44, v30, s20, v44
  v_dot2_f32_bf16 v45, v30, s21, v45
  v_dot2_f32_bf16 v46, v31, s20, v46
  v_dot2_f32_bf16 v47, v31, s21, v47
  v_cvt_pk_bf16_f32 v96, v40, v41
  v_cvt_pk_bf16_f32 v97, v42, v43
  v_cvt_pk_bf16_f32 v98, v44, v45
  v_cvt_pk_bf16_f32 v99, v46, v47
  v_dot2_f32_bf16 v40, v96, s20, v32
  v_dot2_f32_bf16 v41, v96, s21, v33
  v_dot2_f32_bf16 v42, v97, s20, v34
  v_dot2_f32_bf16 v43, v97, s21, v35
  v_dot2_f32_bf16 v44, v98, s20, v36
  v_dot2_f32_bf16 v45, v98, s21, v37
  v_dot2_f32_bf16 v46, v99, s20, v38
  v_dot2_f32_bf16 v47, v99, s21, v39
  v_cvt_pk_bf16_f32 v96, v40, v41
  v_cvt_pk_bf16_f32 v97, v42, v43
  v_cvt_pk_bf16_f32 v98, v44, v45
  v_cvt_pk_bf16_f32 v99, v46, v47
  v_dot2_f32_bf16 v52, v96, s22, 0
  v_dot2_f32_bf16 v53, v96, v96, 0
  v_dot2_f32_bf16 v52, v97, s22, v52
  v_dot2_f32_bf16 v53, v97, v97, v53
  v_dot2_f32_bf16 v52, v98, s22, v52
  v_dot2_f32_bf16 v53, v98, v98, v53
  v_dot2_f32_bf16 v52, v99, s22, v52
  v_dot2_f32_bf16 v53, v99, v99, v53
  s_lshr_b32 s6, s26, 2
  s_andn2_b32 s24, 1, s6
  s_and_b32 s6, s26, 3
  s_lshl_b32 s6, s6, 13
  s_add_u32 s25, s6, 0x738000
  s_lshl_b32 s6, s5, 8
  s_add_u32 s6, s6, s25
  v_mov_b32 v54, v52
  v_mov_b32 v55, v53
  s_nop 0
  v_permlane32_swap_b32 v52, v54
  v_permlane32_swap_b32 v53, v55
  v_add_f32 v52, v52, v54
  v_add_f32 v53, v53, v55
  v_bfi_b32 v53, 1, s24, v53
  s_mov_b32 exec_hi, 0
  buffer_store_dwordx2 v[52:53], v6, s[8:11], s6 offen
  s_cmp_lt_u32 s26, 62
  s_cbranch_scc1 L_cnl_152
  buffer_store_dwordx2 v[52:53], v6, s[8:11], s6 offen sc1
  s_waitcnt vmcnt(1)
L_cnl_152:
  s_mov_b32 exec_hi, -1
  s_sub_u32 s33, s26, 7
  s_mov_b32 s7, 0
L_lw_153:
  ds_read_b64 v[52:53], v2 offset:8
  s_waitcnt lgkmcnt(0)
  v_min_i32 v52, v52, v53
  v_cmp_gt_i32 vcc, s33, v52
  s_cbranch_vccz L_lwo_154
  s_add_u32 s7, s7, 1
  s_cmp_lt_u32 s7, 131072
  s_cbranch_scc1 L_lw_153
  s_mov_b32 s6, 44
  s_branch L_err
L_lwo_154:
  s_and_b32 s6, s26, 7
  s_lshl_b32 s6, s6, 10
  v_add_u32 v52, s6, v8
  ds_write_b16 v52, v96 offset:0
  ds_write_b16_d16_hi v52, v96 offset:64
  ds_write_b16 v52, v97 offset:128
  ds_write_b16_d16_hi v52, v97 offset:192
  ds_write_b16 v52, v98 offset:512
  ds_write_b16_d16_hi v52, v98 offset:576
  ds_write_b16 v52, v99 offset:640
  ds_write_b16_d16_hi v52, v99 offset:704
  s_waitcnt vmcnt(1)
  s_branch L_c_g1
L_c_pre:
  s_mov_b32 s23, 0
  s_mov_b32 s36, s24
  s_mov_b32 s34, s25
  s_add_u32 s35, s25, 4096
  s_mov_b32 s7, 0
  buffer_load_dwordx4 v[64:67], v0, s[8:11], s34 offen offset:0 sc1
  buffer_load_dwordx4 v[68:71], v0, s[8:11], s34 offen offset:1024 sc1
  buffer_load_dwordx4 v[72:75], v0, s[8:11], s34 offen offset:2048 sc1
  buffer_load_dwordx4 v[76:79], v0, s[8:11], s34 offen offset:3072 sc1
  buffer_load_dwordx4 v[80:83], v0, s[8:11], s35 offen offset:0 sc1
  buffer_load_dwordx4 v[84:87], v0, s[8:11], s35 offen offset:1024 sc1
  buffer_load_dwordx4 v[88:91], v0, s[8:11], s35 offen offset:2048 sc1
  buffer_load_dwordx4 v[92:95], v0, s[8:11], s35 offen offset:3072 sc1
  v_mov_b32 v48, v96
  v_mov_b32 v49, v97
  v_mov_b32 v50, v98
  v_mov_b32 v51, v99
  s_cmp_eq_u32 s32, 63
  s_cbranch_scc0 L_cf_155
  v_mov_b32 v52, 0x7fffffff
  ds_write_b32 v2, v52 offset:24
  s_waitcnt vmcnt(0)
  s_branch L_cnf_156
L_cf_155:
L_ga_157:
  s_add_u32 s6, s46, 1
  v_mov_b32 v52, s6
  ds_write_b32 v2, v52 offset:24
L_gb_158:
  s_min_i32 s46, s6, 0x7ffffffe
  buffer_load_short_d16_hi v32, v4, s[8:11], s37 offen offset:0
  buffer_load_short_d16_hi v33, v4, s[8:11], s37 offen offset:64
  buffer_load_short_d16_hi v34, v4, s[8:11], s37 offen offset:128
  buffer_load_short_d16_hi v35, v4, s[8:11], s37 offen offset:192
  buffer_load_short_d16_hi v36, v4, s[8:11], s37 offen offset:512
  buffer_load_short_d16_hi v37, v4, s[8:11], s37 offen offset:576
  buffer_load_short_d16_hi v38, v4, s[8:11], s37 offen offset:640
  buffer_load_short_d16_hi v39, v4, s[8:11], s37 offen offset:704
  s_and_b32 s6, s43, 3
  s_lshl_b32 s6, s6, 17
  s_add_u32 s44, s38, s6
  s_lshr_b32 s6, s43, 2
  s_andn2_b32 s45, 1, s6
  s_add_u32 s6, s44, 0
  buffer_load_dwordx4 v[16:19], v0, s[8:11], s6 offen sc1
  s_add_u32 s6, s44, 32768
  buffer_load_dwordx4 v[20:23], v0, s[8:11], s6 offen sc1
  s_add_u32 s6, s44, 65536
  buffer_load_dwordx4 v[24:27], v0, s[8:11], s6 offen sc1
  s_add_u32 s6, s44, 98304
  buffer_load_dwordx4 v[28:31], v0, s[8:11], s6 offen sc1
  s_add_u32 s37, s37, 0x8000
  s_add_u32 s43, s43, 1
L_cnf_156:
  s_waitcnt vmcnt(12)
  s_branch L_c_g1
L_c_na:
  s_and_b32 s6, s7, 31
  s_cmp_lg_u32 s6, 31
  s_cbranch_scc1 L_tf_160
  buffer_wbl2 sc1
  s_waitcnt vmcnt(0)
  buffer_inv sc1
  s_waitcnt vmcnt(0)
L_tf_160:
  s_add_u32 s7, s7, 1
  s_cmp_lt_u32 s7, 131072
  s_cbranch_scc1 L_c_g
  s_mov_b32 s6, 45
  s_branch L_err
L_c_gok0:
  v_pk_add_f32 v[64:65], v[64:65], v[80:81]
  v_pk_add_f32 v[66:67], v[66:67], v[82:83]
  v_pk_add_f32 v[68:69], v[68:69], v[84:85]
  v_pk_add_f32 v[70:71], v[70:71], v[86:87]
  v_pk_add_f32 v[72:73], v[72:73], v[88:89]
  v_pk_add_f32 v[74:75], v[74:75], v[90:91]
  v_pk_add_f32 v[76:77], v[76:77], v[92:93]
  v_pk_add_f32 v[78:79], v[78:79], v[94:95]
L_c_gok:
  v_pk_add_f32 v[64:65], v[64:65], v[72:73]
  v_pk_add_f32 v[66:67], v[66:67], v[74:75]
  v_pk_add_f32 v[68:69], v[68:69], v[76:77]
  v_pk_add_f32 v[70:71], v[70:71], v[78:79]
  v_pk_add_f32 v[64:65], v[64:65], v[68:69]
  v_pk_add_f32 v[66:67], v[66:67], v[70:71]
  s_nop 1
  v_permlane16_swap_b32 v64, v66
  v_permlane16_swap_b32 v65, v67
  v_pk_add_f32 v[52:53], v[64:65], v[66:67]
  v_mov_b32 v54, v52
  v_mov_b32 v55, v53
  s_nop 0
  v_permlane32_swap_b32 v52, v54
  v_permlane32_swap_b32 v53, v55
  v_add_f32 v52, v52, v54
  v_add_f32 v53, v53, v55
  v_mul_f32 v52, 0x3b000000, v52
  v_mul_f32 v54, v52, v52
  v_mul_f32 v53, 0x3b000000, v53
  v_sub_f32 v53, v53, v54
  v_max_f32 v53, 0, v53
  v_cvt_pk_bf16_f32 v53, v53, v53
  v_and_b32 v53, 0xffff0000, v53
  v_add_f32 v53, 0x3727c5ac, v53
  v_cvt_pk_bf16_f32 v53, v53, v53
  v_and_b32 v53, 0xffff0000, v53
  v_sqrt_f32 v53, v53
  v_cvt_pk_bf16_f32 v52, v52, v52
  v_and_b32 v52, 0xffff0000, v52
  v_cvt_pk_bf16_f32 v53, v53, v53
  v_and_b32 v53, 0xffff0000, v53
  v_rcp_f32 v53, v53
  v_dot2_f32_bf16 v40, v48, s20, v52 neg_lo:[0,0,1]
  v_dot2_f32_bf16 v41, v48, s21, v52 neg_lo:[0,0,1]
  v_dot2_f32_bf16 v42, v49, s20, v52 neg_lo:[0,0,1]
  v_dot2_f32_bf16 v43, v49, s21, v52 neg_lo:[0,0,1]
  v_dot2_f32_bf16 v44, v50, s20, v52 neg_lo:[0,0,1]
  v_dot2_f32_bf16 v45, v50, s21, v52 neg_lo:[0,0,1]
  v_dot2_f32_bf16 v46, v51, s20, v52 neg_lo:[0,0,1]
  v_dot2_f32_bf16 v47, v51, s21, v52 neg_lo:[0,0,1]
  v_cvt_pk_bf16_f32 v48, v40, v41
  v_cvt_pk_bf16_f32 v49, v42, v43
  v_cvt_pk_bf16_f32 v50, v44, v45
  v_cvt_pk_bf16_f32 v51, v46, v47
  v_lshlrev_b32 v40, 16, v48
  v_and_b32 v41, 0xffff0000, v48
  v_lshlrev_b32 v42, 16, v49
  v_and_b32 v43, 0xffff0000, v49
  v_lshlrev_b32 v44, 16, v50
  v_and_b32 v45, 0xffff0000, v50
  v_lshlrev_b32 v46, 16, v51
  v_and_b32 v47, 0xffff0000, v51
  v_mul_f32 v40, v40, v53
  v_mul_f32 v41, v41, v53
  v_mul_f32 v42, v42, v53
  v_mul_f32 v43, v43, v53
  v_mul_f32 v44, v44, v53
  v_mul_f32 v45, v45, v53
  v_mul_f32 v46, v46, v53
  v_mul_f32 v47, v47, v53
  v_cvt_pk_bf16_f32 v48, v40, v41
  v_cvt_pk_bf16_f32 v49, v42, v43
  v_cvt_pk_bf16_f32 v50, v44, v45
  v_cvt_pk_bf16_f32 v51, v46, v47
  s_add_u32 s6, s32, 1
  v_mov_b32 v52, s6
  ds_write_b16 v7, v48 offset:0
  ds_write_b16_d16_hi v7, v48 offset:4128
  ds_write_b16 v7, v49 offset:8256
  ds_write_b16_d16_hi v7, v49 offset:12384
  ds_write_b16 v7, v50 offset:33024
  ds_write_b16_d16_hi v7, v50 offset:37152
  ds_write_b16 v7, v51 offset:41280
  ds_write_b16_d16_hi v7, v51 offset:45408
  ds_write_b32 v2, v52
  v_add_u32 v7, 64, v7
  s_add_u32 s32, s32, 1
  s_cmp_lg_u32 s23, 0
  s_cbranch_scc1 L_c_pre
  s_cmp_lt_u32 s32, 64
  s_cbranch_scc1 L_c_rloop
L_c_rend:
  s_waitcnt vmcnt(0)
  s_endpgm
.section .rodata,"a"
.p2align 6
.amdhsa_kernel interleave_layers__ssm_conv_s4d__memory_aug_recurrent_mem_tr__prompt_kernel
  .amdhsa_next_free_vgpr 512
  .amdhsa_next_free_sgpr 102
  .amdhsa_accum_offset 256
  .amdhsa_group_segment_fixed_size 0
  .amdhsa_kernarg_size 136
  .amdhsa_user_sgpr_count 2
  .amdhsa_user_sgpr_kernarg_segment_ptr 1
  .amdhsa_system_sgpr_workgroup_id_x 1
.end_amdhsa_kernel
```
